```python
import torch

def _softmax(x, axis=-1):
    return torch.softmax(x, dim=axis)
def _gelu(x):
    return torch.nn.functional.gelu(x, approximate="tanh")
def _silu(x):
    return torch.nn.functional.silu(x)
def _sigmoid(x):
    return torch.sigmoid(x)
def _layernorm(x, axis=-1, eps=1e-5):
    m = x.mean(dim=axis, keepdim=True)
    v = x.var(dim=axis, keepdim=True, unbiased=False)
    return (x - m) / torch.sqrt(v + eps)
def _scatter_add(tgt, idx, src, axis=0):
    return tgt.clone().index_add_(axis, idx, src)
def _segment_sum(src, seg, n):
    out = torch.zeros((n,) + src.shape[1:], dtype=src.dtype)
    return out.index_add_(0, seg, src)
def _pad(x, pw):
    flat = tuple(v for pair in reversed(pw) for v in pair)
    return torch.nn.functional.pad(x, flat)

kernel_name = 'recurrent_scan__compressed_kv_cla__dense_activation_relu__prompt'

def setup_inputs():

    _w = (lambda a: (lambda t: t.to(torch.bfloat16) if t.is_floating_point() else t)(torch.as_tensor(a)))
    def _A_setup():
        B, H, Sq, Sk, D, M = 1, 32, 2048, 2048, 128, 512
        Dc = 4 * D
        return {
            "x": _w((lambda *s: torch.randn(*s, dtype=torch.bfloat16) * 0.05)(B, Sq, M)),
            "c_kv": _w((lambda *s: torch.randn(*s, dtype=torch.bfloat16) * 0.2)(B, Sk, Dc)),
            "w_q": _w((lambda *s: torch.randn(*s, dtype=torch.bfloat16) * 3.2)(M, H, D) * (M ** -0.5)),
            "w_uk": _w((lambda *s: torch.randn(*s, dtype=torch.bfloat16) * 3.2)(Dc, H, D) * (Dc ** -0.5)),
            "w_uv": _w((lambda *s: torch.randn(*s, dtype=torch.bfloat16) * 0.2)(Dc, H, D) * (Dc ** -0.5)),
            "w_o": _w((lambda *s: torch.randn(*s, dtype=torch.bfloat16) * 0.2)(H, D, M) * ((H * D) ** -0.5)),
        }
    _A_in = _A_setup()

    def _B_setup():
        B, S, D, Dff = 1, 2048, 512, 1376
        return {
            "x": _w((lambda *s: torch.randn(*s, dtype=torch.bfloat16) * 0.05)(B, S, D)),
            "w1": _w((lambda *s: torch.randn(*s, dtype=torch.bfloat16) * 0.1)(D, Dff)),
            "w2": _w((lambda *s: torch.randn(*s, dtype=torch.bfloat16) * 0.1)(Dff, D)),
        }
    _B_in = _B_setup()

    return {
        "A_x": _A_in["x"],
        "A_c_kv": _A_in["c_kv"],
        "A_w_q": _A_in["w_q"],
        "A_w_uk": _A_in["w_uk"],
        "A_w_uv": _A_in["w_uv"],
        "A_w_o": _A_in["w_o"],
        "B_x": _B_in["x"],
        "B_w1": _B_in["w1"],
        "B_w2": _B_in["w2"],
    }

def reference(A_x, A_c_kv, A_w_q, A_w_uk, A_w_uv, A_w_o, B_x, B_w1, B_w2):
    def _A_ref(x, c_kv, w_q, w_uk, w_uv, w_o):
        B, Sq, M = x.shape[0], x.shape[1], x.shape[2]
        Sk = c_kv.shape[1]
        H, D = w_q.shape[1], w_q.shape[2]
        q = torch.einsum("bqm,mhd->bhqd", x, w_q)
        k = torch.einsum("bkc,chd->bhkd", c_kv, w_uk)
        v = torch.einsum("bkc,chd->bhkd", c_kv, w_uv)
        scores = torch.einsum("bhqd,bhkd->bhqk", q, k) * (D ** -0.5)
        off = Sk - Sq
        qi = torch.arange(Sq)[:, None]
        kj = torch.arange(Sk)[None, :]
        cmask = kj <= (qi + off)
        scores = torch.where(cmask[None, None], scores, -1e9)
        p = _softmax(scores, axis=-1)
        ctx = torch.einsum("bhqk,bhkd->bhqd", p, v)
        return torch.einsum("bhqd,hdm->bqm", ctx, w_o)

    def _B_ref(x, w1, w2):
        h = torch.einsum("bsd,df->bsf", x, w1)
        zero = torch.zeros_like(h)
        h = torch.maximum(h, zero)
        return torch.einsum("bsf,fd->bsd", h, w2)

    x = A_x
    xn = _layernorm(x, axis=-1)
    s = _A_ref(xn, A_c_kv, A_w_q, A_w_uk, A_w_uv, A_w_o)
    g = _silu(_B_ref(xn, B_w1, B_w2))
    return x + s * g
```

```asm
; @launch kernel=kab_kernel grid=(256,1,1) block=(512,1,1) lds=163840
.amdgcn_target "amdgcn-amd-amdhsa--gfx950"
.text
.globl kab_kernel
.p2align 8
.type kab_kernel,@function
kab_kernel:
 s_cmp_lt_u32 s2, 256
 s_cbranch_scc1 KA_GO
 s_endpgm
KA_GO:
 s_mov_b32 s92, 0
 s_mov_b32 s93, s2
 s_mov_b32 s88, 0
KA_AGAIN:
 s_mov_b32 s101, 0
 s_memrealtime s[50:51]
 s_load_dwordx4 s[72:75], s[0:1], 0
 s_load_dwordx2 s[76:77], s[0:1], 16
 s_load_dwordx4 s[80:83], s[0:1], 24
 s_load_dwordx2 s[84:85], s[0:1], 56
 s_load_dwordx2 s[86:87], s[0:1], 88
 s_load_dwordx2 s[46:47], s[0:1], 80
 s_load_dwordx2 s[4:5], s[0:1], 88
 s_load_dwordx2 s[6:7], s[0:1], 16
 s_load_dwordx2 s[52:53], s[0:1], 56
 v_lshrrev_b32 v180, 6, v0
 v_and_b32 v0, 63, v0
 v_readfirstlane_b32 s32, v180
 s_mov_b32 s55, s32
 s_cmp_eq_u32 s32, 0
 s_cbranch_scc0 CT_kab_kernel_N
 s_getpc_b64 s[28:29]
CT_kab_kernel:
 s_sub_u32 s28, s28, CT_kab_kernel-kab_kernel
 s_subb_u32 s29, s29, 0
 s_and_b32 s29, s29, 0xffff
 s_mov_b32 s30, TEXT_END-kab_kernel
 s_mov_b32 s31, 0x00020000
 s_lshr_b32 s37, s2, 3
 s_mul_i32 s37, s37, 4096
 v_mul_u32_u24 v229, 64, v0
 buffer_load_dword v228, v229, s[28:31], s37 offen
 s_add_u32 s37, s37, 0x20000
 buffer_load_dword v228, v229, s[28:31], s37 offen
CT_kab_kernel_N:
 s_lshr_b32 s40, s2, 7
 s_and_b32 s37, s2, 7
 s_bfe_u32 s38, s2, 0x30003
 s_lshl_b32 s33, s38, 3
 s_add_u32 s33, s33, s32
 s_lshr_b32 s42, s2, 6
 s_lshl_b32 s42, s42, 1
 s_add_u32 s42, s42, s38
 s_bfe_u32 s38, s2, 0x10006
 s_lshl_b32 s37, s37, 1
 s_add_u32 s37, s37, s38
 s_lshl_b32 s91, s37, 4
 s_lshl_b32 s3, s40, 3
 s_add_u32 s91, s91, s3
 s_lshl_b32 s91, s91, 3
 s_add_u32 s91, s91, s33
 s_lshl_b32 s91, s91, 3
 s_add_u32 s91, s91, 4096
 v_lshlrev_b32 v253, 4, v0
 v_and_b32 v253, 0x70, v253
 s_lshl_b32 s35, s37, 9
 s_and_b32 s42, s42, 0
 s_lshl_b32 s38, s42, 1
 s_add_u32 s38, s38, s32
 s_and_b32 s38, s38, 15
 s_xor_b32 s39, s38, 8
 s_lshl_b32 s39, s39, 18
 s_add_u32 s43, s35, s39
 s_lshl_b32 s38, s38, 18
 s_add_u32 s35, s35, s38
 s_lshl_b32 s42, s42, 7
 s_lshl_b32 s95, s37, 20
 s_lshl_b32 s38, s33, 13
 s_lshr_b32 s39, s33, 1
 s_lshl_b32 s39, s39, 14
 s_and_b32 s3, s33, 1
 s_lshl_b32 s3, s3, 11
 s_add_u32 s39, s39, s3
 s_cmp_eq_u32 s40, 0
 s_cselect_b32 s38, s38, s39
 s_add_u32 s95, s95, s38
 s_lshl_b32 s36, s32, 12
 s_lshl_b32 s41, s33, 15
 v_lshlrev_b32 v246, 4, v0
 s_lshl_b32 s37, s2, 3
 s_add_u32 s37, s37, s32
 s_lshl_b32 s37, s37, 10
 v_lshrrev_b32 v181, 3, v0
 v_and_b32 v180, 7, v0
 v_xor_b32 v170, v180, v181
 v_lshlrev_b32 v170, 4, v170
 v_lshl_add_u32 v170, v181, 10, v170
 s_waitcnt lgkmcnt(0)
 s_mov_b32 s20, s72
 s_and_b32 s21, s73, 0xffff
 s_mov_b32 s22, 0x200000
 s_mov_b32 s23, 0x00020000
 buffer_load_dwordx4 v[196:199], v246, s[20:23], s37 offen
 s_mov_b32 s12, s74
 s_and_b32 s13, s75, 0xffff
 s_mov_b32 s14, 0x200000
 s_mov_b32 s15, 0x00020000
 buffer_load_dwordx4 v[228:231], v246, s[12:15], s37 offen
 s_add_u32 m0, s36, 131072
 s_add_u32 s3, s42, 0
 s_and_b32 s3, s3, 1023
 s_add_u32 s3, s3, s41
 s_add_u32 s39, s3, 0
 buffer_load_dwordx4 v170, s[12:15], s39 offen offset:0 lds
 s_add_u32 s39, s3, 7168
 buffer_load_dwordx4 v170, s[12:15], s39 offen offset:1024 lds
 s_add_u32 s39, s3, 14336
 buffer_load_dwordx4 v170, s[12:15], s39 offen offset:2048 lds
 s_add_u32 s39, s3, 21504
 buffer_load_dwordx4 v170, s[12:15], s39 offen offset:3072 lds
 s_add_u32 m0, s36, 0
 s_add_u32 s3, s42, 128
 s_and_b32 s3, s3, 1023
 s_add_u32 s3, s3, s41
 s_add_u32 s39, s3, 0
 buffer_load_dwordx4 v170, s[12:15], s39 offen offset:0 lds
 s_add_u32 s39, s3, 7168
 buffer_load_dwordx4 v170, s[12:15], s39 offen offset:1024 lds
 s_add_u32 s39, s3, 14336
 buffer_load_dwordx4 v170, s[12:15], s39 offen offset:2048 lds
 s_add_u32 s39, s3, 21504
 buffer_load_dwordx4 v170, s[12:15], s39 offen offset:3072 lds
 v_bfe_u32 v182, v0, 4, 1
 v_lshlrev_b32 v182, 2, v182
 v_xor_b32 v182, v182, v180
 v_lshlrev_b32 v182, 4, v182
 v_lshl_add_u32 v244, v181, 13, v182
 v_xor_b32 v245, 16, v244
 s_mov_b64 s[48:49], s[80:81]
 s_cmp_eq_u32 s40, 0
 s_cselect_b32 s80, s80, s82
 s_cselect_b32 s81, s81, s83
 s_mov_b32 s8, s80
 s_and_b32 s9, s81, 0xffff
 s_mov_b32 s10, 0x400000
 s_mov_b32 s11, 0x00020000
 s_add_u32 m0, s36, 65536
 s_add_u32 s39, s35, 0
 buffer_load_dwordx4 v244, s[8:11], s39 offen offset:0 lds
 s_add_u32 s39, s35, 64512
 buffer_load_dwordx4 v245, s[8:11], s39 offen offset:1024 lds
 s_add_u32 s39, s35, 129024
 buffer_load_dwordx4 v244, s[8:11], s39 offen offset:2048 lds
 s_add_u32 s39, s35, 193536
 buffer_load_dwordx4 v245, s[8:11], s39 offen offset:3072 lds
 s_add_u32 m0, s36, 98304
 s_add_u32 s39, s43, 0
 buffer_load_dwordx4 v244, s[8:11], s39 offen offset:0 lds
 s_add_u32 s39, s43, 64512
 buffer_load_dwordx4 v245, s[8:11], s39 offen offset:1024 lds
 s_add_u32 s39, s43, 129024
 buffer_load_dwordx4 v244, s[8:11], s39 offen offset:2048 lds
 s_add_u32 s39, s43, 193536
 buffer_load_dwordx4 v245, s[8:11], s39 offen offset:3072 lds
 v_lshrrev_b32 v182, 4, v0
 v_bfe_u32 v180, v0, 2, 2
 v_lshl_add_u32 v183, v182, 3, v180
 v_lshlrev_b32 v183, 7, v183
 v_and_b32 v181, 1, v0
 v_lshl_add_u32 v183, v181, 3, v183
 v_bfe_u32 v181, v0, 1, 1
 v_lshl_add_u32 v183, v181, 5, v183
 v_bfe_u32 v181, v0, 3, 1
 v_lshl_add_u32 v183, v181, 6, v183
 v_and_b32 v181, 1, v182
 v_lshl_add_u32 v232, v181, 4, v183
 v_xor_b32 v233, 16, v232
 v_xor_b32 v234, 64, v232
 v_xor_b32 v235, 80, v232
 v_add_u32 v236, 0x10000, v232
 v_add_u32 v237, 0x10000, v233
 v_add_u32 v238, 0x10000, v234
 v_add_u32 v239, 0x10000, v235
 v_add_u32 v240, 0x20000, v232
 v_add_u32 v241, 0x20000, v233
 v_add_u32 v242, 0x20000, v234
 v_add_u32 v243, 0x20000, v235
 v_lshrrev_b32 v184, 5, v0
 v_lshlrev_b32 v247, 10, v184
 v_lshl_add_u32 v247, v181, 9, v247
 v_bfe_u32 v180, v0, 3, 1
 v_lshl_add_u32 v247, v180, 8, v247
 v_and_b32 v180, 7, v0
 v_lshl_add_u32 v247, v180, 4, v247
 v_and_b32 v180, 7, v0
 v_lshrrev_b32 v181, 4, v0
 v_xor_b32 v181, v181, v180
 v_lshlrev_b32 v181, 4, v181
 v_lshl_add_u32 v181, v180, 7, v181
 v_bfe_u32 v182, v0, 3, 1
 v_lshl_add_u32 v181, v182, 11, v181
 v_add_u32 v181, s36, v181
 v_add_u32 v164, 0x20000, v181
 v_xor_b32 v165, 64, v164
 v_add_u32 v166, 0x0, v181
 v_xor_b32 v167, 64, v166
 v_add_u32 v168, 0x8000, v181
 v_xor_b32 v169, 64, v168
 v_lshrrev_b32 v181, 3, v0
 v_mul_u32_u24 v171, 144, v180
 v_lshl_add_u32 v171, v181, 12, v171
 s_lshl_b32 s37, s32, 4
 s_add_u32 s37, s37, 32768
 v_add_u32 v171, s37, v171
 v_mul_u32_u24 v172, 144, v181
 v_lshl_add_u32 v172, v180, 4, v172
 s_add_u32 s37, s36, 32768
 v_add_u32 v172, s37, v172
 s_lshl_b32 s37, s32, 3
 v_add_u32 v181, s37, v181
 v_lshrrev_b32 v173, 2, v181
 v_lshlrev_b32 v173, 11, v173
 v_and_b32 v181, 3, v181
 v_lshl_add_u32 v173, v181, 8, v173
 v_lshl_add_u32 v173, v180, 4, v173
 s_lshl_b32 s37, s40, 24
 s_add_u32 s37, s37, 0x1200000
 s_add_u32 s16, s86, s37
 s_addc_u32 s17, s87, 0
 s_and_b32 s17, s17, 0xffff
 s_mov_b32 s18, 0x1000000
 s_mov_b32 s19, 0x00020000
 s_mov_b32 s24, s86
 s_and_b32 s25, s87, 0xffff
 s_mov_b32 s26, 0x200000
 s_mov_b32 s27, 0x00020000
 s_mov_b32 s96, s46
 s_and_b32 s97, s47, 0xffff
 s_mov_b32 s98, 0x100
 s_mov_b32 s99, 0x00020000
 s_waitcnt vmcnt(17)
 v_lshlrev_b32 v132, 16, v196
 v_and_b32 v133, 0xffff0000, v196
 v_lshlrev_b32 v134, 16, v197
 v_and_b32 v135, 0xffff0000, v197
 v_lshlrev_b32 v136, 16, v198
 v_and_b32 v137, 0xffff0000, v198
 v_lshlrev_b32 v138, 16, v199
 v_and_b32 v139, 0xffff0000, v199
 v_add_f32 v156, v132, v133
 v_add_f32 v156, v156, v134
 v_add_f32 v156, v156, v135
 v_add_f32 v156, v156, v136
 v_add_f32 v156, v156, v137
 v_add_f32 v156, v156, v138
 v_add_f32 v156, v156, v139
 ds_swizzle_b32 v157, v156 offset:0x041f
 s_waitcnt lgkmcnt(0)
 v_add_f32 v156, v156, v157
 ds_swizzle_b32 v157, v156 offset:0x081f
 s_waitcnt lgkmcnt(0)
 v_add_f32 v156, v156, v157
 ds_swizzle_b32 v157, v156 offset:0x101f
 s_waitcnt lgkmcnt(0)
 v_add_f32 v156, v156, v157
 ds_swizzle_b32 v157, v156 offset:0x201f
 s_waitcnt lgkmcnt(0)
 v_add_f32 v156, v156, v157
 ds_swizzle_b32 v157, v156 offset:0x401f
 s_waitcnt lgkmcnt(0)
 v_add_f32 v156, v156, v157
 s_nop 0
 v_readlane_b32 s44, v156, 0
 v_readlane_b32 s45, v156, 32
 s_nop 0
 v_mov_b32 v156, s44
 v_add_f32 v156, s45, v156
 s_waitcnt vmcnt(12)
 ds_read_b128 v[4:7], v164 offset:0
 ds_read_b128 v[8:11], v164 offset:1024
 ds_read_b128 v[12:15], v165 offset:0
 ds_read_b128 v[16:19], v165 offset:1024
 s_waitcnt lgkmcnt(0)
 s_add_u32 m0, s36, 131072
 s_add_u32 s3, s42, 256
 s_and_b32 s3, s3, 1023
 s_add_u32 s3, s3, s41
 s_add_u32 s39, s3, 0
 buffer_load_dwordx4 v170, s[12:15], s39 offen offset:0 lds
 s_add_u32 s39, s3, 7168
 buffer_load_dwordx4 v170, s[12:15], s39 offen offset:1024 lds
 s_add_u32 s39, s3, 14336
 buffer_load_dwordx4 v170, s[12:15], s39 offen offset:2048 lds
 s_add_u32 s39, s3, 21504
 buffer_load_dwordx4 v170, s[12:15], s39 offen offset:3072 lds
 v_mul_f32 v156, 0x3b000000, v156
 v_sub_f32 v140, v132, v156
 v_sub_f32 v141, v133, v156
 v_sub_f32 v142, v134, v156
 v_sub_f32 v143, v135, v156
 v_sub_f32 v144, v136, v156
 v_sub_f32 v145, v137, v156
 v_sub_f32 v146, v138, v156
 v_sub_f32 v147, v139, v156
 v_mul_f32 v158, v140, v140
 v_fmac_f32 v158, v141, v141
 v_fmac_f32 v158, v142, v142
 v_fmac_f32 v158, v143, v143
 v_fmac_f32 v158, v144, v144
 v_fmac_f32 v158, v145, v145
 v_fmac_f32 v158, v146, v146
 v_fmac_f32 v158, v147, v147
 ds_swizzle_b32 v157, v158 offset:0x041f
 s_waitcnt lgkmcnt(0)
 v_add_f32 v158, v158, v157
 ds_swizzle_b32 v157, v158 offset:0x081f
 s_waitcnt lgkmcnt(0)
 v_add_f32 v158, v158, v157
 ds_swizzle_b32 v157, v158 offset:0x101f
 s_waitcnt lgkmcnt(0)
 v_add_f32 v158, v158, v157
 ds_swizzle_b32 v157, v158 offset:0x201f
 s_waitcnt lgkmcnt(0)
 v_add_f32 v158, v158, v157
 ds_swizzle_b32 v157, v158 offset:0x401f
 s_waitcnt lgkmcnt(0)
 v_add_f32 v158, v158, v157
 s_nop 0
 v_readlane_b32 s44, v158, 0
 v_readlane_b32 s45, v158, 32
 s_nop 0
 v_mov_b32 v158, s44
 v_add_f32 v158, s45, v158
 s_waitcnt vmcnt(12)
 ds_read_b128 v[20:23], v166 offset:0
 ds_read_b128 v[24:27], v166 offset:1024
 ds_read_b128 v[28:31], v167 offset:0
 ds_read_b128 v[32:35], v167 offset:1024
 s_waitcnt lgkmcnt(0)
 s_add_u32 m0, s36, 0
 s_add_u32 s3, s42, 384
 s_and_b32 s3, s3, 1023
 s_add_u32 s3, s3, s41
 s_add_u32 s39, s3, 0
 buffer_load_dwordx4 v170, s[12:15], s39 offen offset:0 lds
 s_add_u32 s39, s3, 7168
 buffer_load_dwordx4 v170, s[12:15], s39 offen offset:1024 lds
 s_add_u32 s39, s3, 14336
 buffer_load_dwordx4 v170, s[12:15], s39 offen offset:2048 lds
 s_add_u32 s39, s3, 21504
 buffer_load_dwordx4 v170, s[12:15], s39 offen offset:3072 lds
 v_mul_f32 v158, 0x3b000000, v158
 v_cvt_pk_bf16_f32 v158, v158, v158
 v_lshlrev_b32 v158, 16, v158
 v_add_f32 v158, 0x3727c5ac, v158
 v_cvt_pk_bf16_f32 v158, v158, v158
 v_lshlrev_b32 v158, 16, v158
 v_sqrt_f32 v158, v158
 s_nop 0
 v_cvt_pk_bf16_f32 v158, v158, v158
 v_lshlrev_b32 v158, 16, v158
 v_rcp_f32 v159, v158
 v_cvt_pk_bf16_f32 v156, v156, v156
 v_lshlrev_b32 v156, 16, v156
 v_sub_f32 v140, v132, v156
 v_sub_f32 v141, v133, v156
 v_sub_f32 v142, v134, v156
 v_sub_f32 v143, v135, v156
 v_sub_f32 v144, v136, v156
 v_sub_f32 v145, v137, v156
 v_sub_f32 v146, v138, v156
 v_sub_f32 v147, v139, v156
 v_cvt_pk_bf16_f32 v140, v140, v140
 v_lshlrev_b32 v140, 16, v140
 v_cvt_pk_bf16_f32 v141, v141, v141
 v_lshlrev_b32 v141, 16, v141
 v_cvt_pk_bf16_f32 v142, v142, v142
 v_lshlrev_b32 v142, 16, v142
 v_cvt_pk_bf16_f32 v143, v143, v143
 v_lshlrev_b32 v143, 16, v143
 v_cvt_pk_bf16_f32 v144, v144, v144
 v_lshlrev_b32 v144, 16, v144
 v_cvt_pk_bf16_f32 v145, v145, v145
 v_lshlrev_b32 v145, 16, v145
 v_cvt_pk_bf16_f32 v146, v146, v146
 v_lshlrev_b32 v146, 16, v146
 v_cvt_pk_bf16_f32 v147, v147, v147
 v_lshlrev_b32 v147, 16, v147
 v_mul_f32 v148, v140, v159
 v_mul_f32 v149, v141, v159
 v_mul_f32 v150, v142, v159
 v_mul_f32 v151, v143, v159
 v_mul_f32 v152, v144, v159
 v_mul_f32 v153, v145, v159
 v_mul_f32 v154, v146, v159
 v_mul_f32 v155, v147, v159
 v_fma_f32 v140, -v148, v158, v140
 v_fma_f32 v141, -v149, v158, v141
 v_fma_f32 v142, -v150, v158, v142
 v_fma_f32 v143, -v151, v158, v143
 v_fma_f32 v144, -v152, v158, v144
 v_fma_f32 v145, -v153, v158, v145
 v_fma_f32 v146, -v154, v158, v146
 v_fma_f32 v147, -v155, v158, v147
 v_fma_f32 v148, v140, v159, v148
 v_fma_f32 v149, v141, v159, v149
 v_fma_f32 v150, v142, v159, v150
 v_fma_f32 v151, v143, v159, v151
 v_fma_f32 v152, v144, v159, v152
 v_fma_f32 v153, v145, v159, v153
 v_fma_f32 v154, v146, v159, v154
 v_fma_f32 v155, v147, v159, v155
 v_cvt_pk_bf16_f32 v196, v148, v149
 v_cvt_pk_bf16_f32 v197, v150, v151
 v_cvt_pk_bf16_f32 v198, v152, v153
 v_cvt_pk_bf16_f32 v199, v154, v155
 ds_write_b128 v171, v[196:199]
 s_lshr_b32 s37, s2, 2
 s_lshl_b32 s37, s37, 15
 s_and_b32 s38, s2, 1
 s_lshl_b32 s38, s38, 10
 s_add_u32 s37, s37, s38
 s_bfe_u32 s38, s2, 0x10001
 s_lshl_b32 s38, s38, 7
 s_add_u32 s37, s37, s38
 s_waitcnt vmcnt(8) lgkmcnt(0)
 s_barrier
 ds_read_b128 v[228:231], v172
 ds_read_b64_tr_b16 v[196:197], v236 offset:0
 ds_read_b64_tr_b16 v[198:199], v236 offset:512
 ds_read_b64_tr_b16 v[200:201], v237 offset:0
 ds_read_b64_tr_b16 v[202:203], v237 offset:512
 ds_read_b64_tr_b16 v[204:205], v238 offset:0
 ds_read_b64_tr_b16 v[206:207], v238 offset:512
 ds_read_b64_tr_b16 v[208:209], v239 offset:0
 ds_read_b64_tr_b16 v[210:211], v239 offset:512
 ds_read_b64_tr_b16 v[212:213], v236 offset:4096
 ds_read_b64_tr_b16 v[214:215], v236 offset:4608
 ds_read_b64_tr_b16 v[216:217], v237 offset:4096
 ds_read_b64_tr_b16 v[218:219], v237 offset:4608
 s_waitcnt lgkmcnt(12)
 buffer_store_dwordx4 v[228:231], v173, s[24:27], s37 offen sc1
 s_add_u32 m0, s36, 32768
 s_add_u32 s3, s42, 512
 s_and_b32 s3, s3, 1023
 s_add_u32 s3, s3, s41
 s_add_u32 s39, s3, 0
 buffer_load_dwordx4 v170, s[12:15], s39 offen offset:0 lds
 s_add_u32 s39, s3, 7168
 buffer_load_dwordx4 v170, s[12:15], s39 offen offset:1024 lds
 s_add_u32 s39, s3, 14336
 buffer_load_dwordx4 v170, s[12:15], s39 offen offset:2048 lds
 s_add_u32 s39, s3, 21504
 buffer_load_dwordx4 v170, s[12:15], s39 offen offset:3072 lds
 s_waitcnt lgkmcnt(10)
 s_cmp_eq_u32 s40, 0
 s_cbranch_scc0 KA_V1
KA_V0:
 v_mfma_f32_16x16x32_bf16 v[132:135], v[196:199], v[4:7], 0
 ds_read_b64_tr_b16 v[220:221], v238 offset:4096
 v_mfma_f32_16x16x32_bf16 v[140:143], v[196:199], v[8:11], 0
 ds_read_b64_tr_b16 v[222:223], v238 offset:4608
 s_waitcnt lgkmcnt(10)
 v_mfma_f32_16x16x32_bf16 v[136:139], v[200:203], v[4:7], 0
 ds_read_b64_tr_b16 v[224:225], v239 offset:4096
 v_mfma_f32_16x16x32_bf16 v[144:147], v[200:203], v[8:11], 0
 ds_read_b64_tr_b16 v[226:227], v239 offset:4608
 s_waitcnt lgkmcnt(10)
 v_mfma_f32_16x16x32_bf16 v[148:151], v[204:207], v[4:7], 0
 ds_read_b64_tr_b16 v[196:197], v236 offset:8192
 v_mfma_f32_16x16x32_bf16 v[156:159], v[204:207], v[8:11], 0
 ds_read_b64_tr_b16 v[198:199], v236 offset:8704
 s_waitcnt lgkmcnt(10)
 v_mfma_f32_16x16x32_bf16 v[152:155], v[208:211], v[4:7], 0
 ds_read_b64_tr_b16 v[200:201], v237 offset:8192
 v_mfma_f32_16x16x32_bf16 v[160:163], v[208:211], v[8:11], 0
 ds_read_b64_tr_b16 v[202:203], v237 offset:8704
 s_waitcnt lgkmcnt(10)
 v_mfma_f32_16x16x32_bf16 v[132:135], v[212:215], v[12:15], v[132:135]
 ds_read_b64_tr_b16 v[204:205], v238 offset:8192
 v_mfma_f32_16x16x32_bf16 v[140:143], v[212:215], v[16:19], v[140:143]
 ds_read_b64_tr_b16 v[206:207], v238 offset:8704
 s_waitcnt lgkmcnt(10)
 v_mfma_f32_16x16x32_bf16 v[136:139], v[216:219], v[12:15], v[136:139]
 ds_read_b64_tr_b16 v[208:209], v239 offset:8192
 v_mfma_f32_16x16x32_bf16 v[144:147], v[216:219], v[16:19], v[144:147]
 ds_read_b64_tr_b16 v[210:211], v239 offset:8704
 s_waitcnt lgkmcnt(10)
 v_mfma_f32_16x16x32_bf16 v[148:151], v[220:223], v[12:15], v[148:151]
 ds_read_b64_tr_b16 v[212:213], v236 offset:12288
 v_mfma_f32_16x16x32_bf16 v[156:159], v[220:223], v[16:19], v[156:159]
 ds_read_b64_tr_b16 v[214:215], v236 offset:12800
 s_waitcnt lgkmcnt(10)
 v_mfma_f32_16x16x32_bf16 v[152:155], v[224:227], v[12:15], v[152:155]
 ds_read_b64_tr_b16 v[216:217], v237 offset:12288
 v_mfma_f32_16x16x32_bf16 v[160:163], v[224:227], v[16:19], v[160:163]
 ds_read_b64_tr_b16 v[218:219], v237 offset:12800
 s_waitcnt lgkmcnt(10)
 s_waitcnt vmcnt(9)
 ds_read_b128 v[36:39], v164 offset:0
 ds_read_b128 v[40:43], v164 offset:1024
 ds_read_b128 v[44:47], v165 offset:0
 ds_read_b128 v[48:51], v165 offset:1024
 v_mfma_f32_16x16x32_bf16 v[132:135], v[196:199], v[20:23], v[132:135]
 ds_read_b64_tr_b16 v[220:221], v238 offset:12288
 v_mfma_f32_16x16x32_bf16 v[140:143], v[196:199], v[24:27], v[140:143]
 ds_read_b64_tr_b16 v[222:223], v238 offset:12800
 s_waitcnt lgkmcnt(14)
 v_mfma_f32_16x16x32_bf16 v[136:139], v[200:203], v[20:23], v[136:139]
 ds_read_b64_tr_b16 v[224:225], v239 offset:12288
 v_mfma_f32_16x16x32_bf16 v[144:147], v[200:203], v[24:27], v[144:147]
 ds_read_b64_tr_b16 v[226:227], v239 offset:12800
 s_waitcnt lgkmcnt(4)
 s_add_u32 m0, s36, 131072
 s_add_u32 s3, s42, 640
 s_and_b32 s3, s3, 1023
 s_add_u32 s3, s3, s41
 s_add_u32 s39, s3, 0
 buffer_load_dwordx4 v170, s[12:15], s39 offen offset:0 lds
 s_add_u32 s39, s3, 7168
 buffer_load_dwordx4 v170, s[12:15], s39 offen offset:1024 lds
 s_add_u32 s39, s3, 14336
 buffer_load_dwordx4 v170, s[12:15], s39 offen offset:2048 lds
 s_add_u32 s39, s3, 21504
 buffer_load_dwordx4 v170, s[12:15], s39 offen offset:3072 lds
 v_mfma_f32_16x16x32_bf16 v[148:151], v[204:207], v[20:23], v[148:151]
 ds_read_b64_tr_b16 v[196:197], v236 offset:16384
 v_mfma_f32_16x16x32_bf16 v[156:159], v[204:207], v[24:27], v[156:159]
 ds_read_b64_tr_b16 v[198:199], v236 offset:16896
 s_waitcnt lgkmcnt(14)
 v_mfma_f32_16x16x32_bf16 v[152:155], v[208:211], v[20:23], v[152:155]
 ds_read_b64_tr_b16 v[200:201], v237 offset:16384
 v_mfma_f32_16x16x32_bf16 v[160:163], v[208:211], v[24:27], v[160:163]
 ds_read_b64_tr_b16 v[202:203], v237 offset:16896
 s_waitcnt lgkmcnt(14)
 v_mfma_f32_16x16x32_bf16 v[132:135], v[212:215], v[28:31], v[132:135]
 ds_read_b64_tr_b16 v[204:205], v238 offset:16384
 v_mfma_f32_16x16x32_bf16 v[140:143], v[212:215], v[32:35], v[140:143]
 ds_read_b64_tr_b16 v[206:207], v238 offset:16896
 s_waitcnt lgkmcnt(14)
 v_mfma_f32_16x16x32_bf16 v[136:139], v[216:219], v[28:31], v[136:139]
 ds_read_b64_tr_b16 v[208:209], v239 offset:16384
 v_mfma_f32_16x16x32_bf16 v[144:147], v[216:219], v[32:35], v[144:147]
 ds_read_b64_tr_b16 v[210:211], v239 offset:16896
 s_waitcnt lgkmcnt(10)
 v_mfma_f32_16x16x32_bf16 v[148:151], v[220:223], v[28:31], v[148:151]
 ds_read_b64_tr_b16 v[212:213], v236 offset:20480
 v_mfma_f32_16x16x32_bf16 v[156:159], v[220:223], v[32:35], v[156:159]
 ds_read_b64_tr_b16 v[214:215], v236 offset:20992
 s_waitcnt lgkmcnt(10)
 v_mfma_f32_16x16x32_bf16 v[152:155], v[224:227], v[28:31], v[152:155]
 ds_read_b64_tr_b16 v[216:217], v237 offset:20480
 v_mfma_f32_16x16x32_bf16 v[160:163], v[224:227], v[32:35], v[160:163]
 ds_read_b64_tr_b16 v[218:219], v237 offset:20992
 s_waitcnt lgkmcnt(10)
 s_lshr_b32 s38, s2, 3
 s_lshl_b32 s38, s38, 3
 s_add_u32 s38, s38, s32
 s_lshl_b32 s38, s38, 14
 s_and_b32 s39, s2, 7
 s_lshl_b32 s39, s39, 10
 s_add_u32 s38, s38, s39
 s_add_u32 s39, s38, 8192
 v_and_b32 v230, 7, v0
 v_lshlrev_b32 v230, 7, v230
 v_bfe_u32 v231, v0, 3, 1
 v_lshl_add_u32 v230, v231, 13, v230
 s_mov_b32 s28, s48
 s_and_b32 s29, s49, 0xffff
 s_mov_b32 s30, 0x400000
 s_mov_b32 s31, 0x00020000
 s_mov_b64 exec, 0xffff
 buffer_load_dword v228, v230, s[28:31], s38 offen
 s_mov_b64 exec, -1
 s_mov_b32 s28, s82
 s_and_b32 s29, s83, 0xffff
 s_mov_b32 s30, 0x400000
 s_mov_b32 s31, 0x00020000
 s_mov_b64 exec, 0xffff
 buffer_load_dword v228, v230, s[28:31], s38 offen
 s_mov_b64 exec, -1
 s_waitcnt vmcnt(11)
 ds_read_b128 v[52:55], v166 offset:0
 ds_read_b128 v[56:59], v166 offset:1024
 ds_read_b128 v[60:63], v167 offset:0
 ds_read_b128 v[64:67], v167 offset:1024
 v_mfma_f32_16x16x32_bf16 v[132:135], v[196:199], v[36:39], v[132:135]
 ds_read_b64_tr_b16 v[220:221], v238 offset:20480
 v_mfma_f32_16x16x32_bf16 v[140:143], v[196:199], v[40:43], v[140:143]
 ds_read_b64_tr_b16 v[222:223], v238 offset:20992
 s_waitcnt lgkmcnt(14)
 v_mfma_f32_16x16x32_bf16 v[136:139], v[200:203], v[36:39], v[136:139]
 ds_read_b64_tr_b16 v[224:225], v239 offset:20480
 v_mfma_f32_16x16x32_bf16 v[144:147], v[200:203], v[40:43], v[144:147]
 ds_read_b64_tr_b16 v[226:227], v239 offset:20992
 s_waitcnt lgkmcnt(4)
 s_add_u32 m0, s36, 0
 s_add_u32 s3, s42, 768
 s_and_b32 s3, s3, 1023
 s_add_u32 s3, s3, s41
 s_add_u32 s39, s3, 0
 buffer_load_dwordx4 v170, s[12:15], s39 offen offset:0 lds
 s_add_u32 s39, s3, 7168
 buffer_load_dwordx4 v170, s[12:15], s39 offen offset:1024 lds
 s_add_u32 s39, s3, 14336
 buffer_load_dwordx4 v170, s[12:15], s39 offen offset:2048 lds
 s_add_u32 s39, s3, 21504
 buffer_load_dwordx4 v170, s[12:15], s39 offen offset:3072 lds
 v_mfma_f32_16x16x32_bf16 v[148:151], v[204:207], v[36:39], v[148:151]
 ds_read_b64_tr_b16 v[196:197], v236 offset:24576
 v_mfma_f32_16x16x32_bf16 v[156:159], v[204:207], v[40:43], v[156:159]
 ds_read_b64_tr_b16 v[198:199], v236 offset:25088
 s_waitcnt lgkmcnt(14)
 v_mfma_f32_16x16x32_bf16 v[152:155], v[208:211], v[36:39], v[152:155]
 ds_read_b64_tr_b16 v[200:201], v237 offset:24576
 v_mfma_f32_16x16x32_bf16 v[160:163], v[208:211], v[40:43], v[160:163]
 ds_read_b64_tr_b16 v[202:203], v237 offset:25088
 s_waitcnt lgkmcnt(14)
 v_mfma_f32_16x16x32_bf16 v[132:135], v[212:215], v[44:47], v[132:135]
 ds_read_b64_tr_b16 v[204:205], v238 offset:24576
 v_mfma_f32_16x16x32_bf16 v[140:143], v[212:215], v[48:51], v[140:143]
 ds_read_b64_tr_b16 v[206:207], v238 offset:25088
 s_waitcnt lgkmcnt(14)
 v_mfma_f32_16x16x32_bf16 v[136:139], v[216:219], v[44:47], v[136:139]
 ds_read_b64_tr_b16 v[208:209], v239 offset:24576
 v_mfma_f32_16x16x32_bf16 v[144:147], v[216:219], v[48:51], v[144:147]
 ds_read_b64_tr_b16 v[210:211], v239 offset:25088
 s_waitcnt lgkmcnt(10)
 v_mfma_f32_16x16x32_bf16 v[148:151], v[220:223], v[44:47], v[148:151]
 ds_read_b64_tr_b16 v[212:213], v236 offset:28672
 v_mfma_f32_16x16x32_bf16 v[156:159], v[220:223], v[48:51], v[156:159]
 ds_read_b64_tr_b16 v[214:215], v236 offset:29184
 s_waitcnt lgkmcnt(10)
 v_mfma_f32_16x16x32_bf16 v[152:155], v[224:227], v[44:47], v[152:155]
 ds_read_b64_tr_b16 v[216:217], v237 offset:28672
 v_mfma_f32_16x16x32_bf16 v[160:163], v[224:227], v[48:51], v[160:163]
 ds_read_b64_tr_b16 v[218:219], v237 offset:29184
 s_waitcnt lgkmcnt(10)
 s_waitcnt vmcnt(10)
 ds_read_b128 v[68:71], v168 offset:0
 ds_read_b128 v[72:75], v168 offset:1024
 ds_read_b128 v[76:79], v169 offset:0
 ds_read_b128 v[80:83], v169 offset:1024
 v_mfma_f32_16x16x32_bf16 v[132:135], v[196:199], v[52:55], v[132:135]
 ds_read_b64_tr_b16 v[220:221], v238 offset:28672
 v_mfma_f32_16x16x32_bf16 v[140:143], v[196:199], v[56:59], v[140:143]
 ds_read_b64_tr_b16 v[222:223], v238 offset:29184
 s_waitcnt lgkmcnt(14)
 v_mfma_f32_16x16x32_bf16 v[136:139], v[200:203], v[52:55], v[136:139]
 ds_read_b64_tr_b16 v[224:225], v239 offset:28672
 v_mfma_f32_16x16x32_bf16 v[144:147], v[200:203], v[56:59], v[144:147]
 ds_read_b64_tr_b16 v[226:227], v239 offset:29184
 s_waitcnt lgkmcnt(4)
 s_add_u32 m0, s36, 32768
 s_add_u32 s3, s42, 896
 s_and_b32 s3, s3, 1023
 s_add_u32 s3, s3, s41
 s_add_u32 s39, s3, 0
 buffer_load_dwordx4 v170, s[12:15], s39 offen offset:0 lds
 s_add_u32 s39, s3, 7168
 buffer_load_dwordx4 v170, s[12:15], s39 offen offset:1024 lds
 s_add_u32 s39, s3, 14336
 buffer_load_dwordx4 v170, s[12:15], s39 offen offset:2048 lds
 s_add_u32 s39, s3, 21504
 buffer_load_dwordx4 v170, s[12:15], s39 offen offset:3072 lds
 v_mfma_f32_16x16x32_bf16 v[148:151], v[204:207], v[52:55], v[148:151]
 ds_read_b64_tr_b16 v[196:197], v236 offset:32768
 v_mfma_f32_16x16x32_bf16 v[156:159], v[204:207], v[56:59], v[156:159]
 ds_read_b64_tr_b16 v[198:199], v236 offset:33280
 s_waitcnt lgkmcnt(14)
 v_mfma_f32_16x16x32_bf16 v[152:155], v[208:211], v[52:55], v[152:155]
 ds_read_b64_tr_b16 v[200:201], v237 offset:32768
 v_mfma_f32_16x16x32_bf16 v[160:163], v[208:211], v[56:59], v[160:163]
 ds_read_b64_tr_b16 v[202:203], v237 offset:33280
 s_waitcnt lgkmcnt(14)
 v_mfma_f32_16x16x32_bf16 v[132:135], v[212:215], v[60:63], v[132:135]
 ds_read_b64_tr_b16 v[204:205], v238 offset:32768
 v_mfma_f32_16x16x32_bf16 v[140:143], v[212:215], v[64:67], v[140:143]
 ds_read_b64_tr_b16 v[206:207], v238 offset:33280
 s_waitcnt lgkmcnt(14)
 v_mfma_f32_16x16x32_bf16 v[136:139], v[216:219], v[60:63], v[136:139]
 ds_read_b64_tr_b16 v[208:209], v239 offset:32768
 v_mfma_f32_16x16x32_bf16 v[144:147], v[216:219], v[64:67], v[144:147]
 ds_read_b64_tr_b16 v[210:211], v239 offset:33280
 s_waitcnt lgkmcnt(10)
 v_mfma_f32_16x16x32_bf16 v[148:151], v[220:223], v[60:63], v[148:151]
 ds_read_b64_tr_b16 v[212:213], v236 offset:36864
 v_mfma_f32_16x16x32_bf16 v[156:159], v[220:223], v[64:67], v[156:159]
 ds_read_b64_tr_b16 v[214:215], v236 offset:37376
 s_waitcnt lgkmcnt(10)
 v_mfma_f32_16x16x32_bf16 v[152:155], v[224:227], v[60:63], v[152:155]
 ds_read_b64_tr_b16 v[216:217], v237 offset:36864
 v_mfma_f32_16x16x32_bf16 v[160:163], v[224:227], v[64:67], v[160:163]
 ds_read_b64_tr_b16 v[218:219], v237 offset:37376
 s_waitcnt lgkmcnt(10)
 s_waitcnt vmcnt(10)
 ds_read_b128 v[84:87], v164 offset:0
 ds_read_b128 v[88:91], v164 offset:1024
 ds_read_b128 v[92:95], v165 offset:0
 ds_read_b128 v[96:99], v165 offset:1024
 v_mfma_f32_16x16x32_bf16 v[132:135], v[196:199], v[68:71], v[132:135]
 ds_read_b64_tr_b16 v[220:221], v238 offset:36864
 v_mfma_f32_16x16x32_bf16 v[140:143], v[196:199], v[72:75], v[140:143]
 ds_read_b64_tr_b16 v[222:223], v238 offset:37376
 s_waitcnt lgkmcnt(14)
 v_mfma_f32_16x16x32_bf16 v[136:139], v[200:203], v[68:71], v[136:139]
 ds_read_b64_tr_b16 v[224:225], v239 offset:36864
 v_mfma_f32_16x16x32_bf16 v[144:147], v[200:203], v[72:75], v[144:147]
 ds_read_b64_tr_b16 v[226:227], v239 offset:37376
 s_waitcnt lgkmcnt(4)
 s_add_u32 m0, s36, 131072
 s_add_u32 s39, s35, 128
 buffer_load_dwordx4 v244, s[8:11], s39 offen offset:0 lds
 s_add_u32 s39, s35, 64640
 buffer_load_dwordx4 v245, s[8:11], s39 offen offset:1024 lds
 s_add_u32 s39, s35, 129152
 buffer_load_dwordx4 v244, s[8:11], s39 offen offset:2048 lds
 s_add_u32 s39, s35, 193664
 buffer_load_dwordx4 v245, s[8:11], s39 offen offset:3072 lds
 v_mfma_f32_16x16x32_bf16 v[148:151], v[204:207], v[68:71], v[148:151]
 ds_read_b64_tr_b16 v[196:197], v236 offset:40960
 v_mfma_f32_16x16x32_bf16 v[156:159], v[204:207], v[72:75], v[156:159]
 ds_read_b64_tr_b16 v[198:199], v236 offset:41472
 s_waitcnt lgkmcnt(14)
 v_mfma_f32_16x16x32_bf16 v[152:155], v[208:211], v[68:71], v[152:155]
 ds_read_b64_tr_b16 v[200:201], v237 offset:40960
 v_mfma_f32_16x16x32_bf16 v[160:163], v[208:211], v[72:75], v[160:163]
 ds_read_b64_tr_b16 v[202:203], v237 offset:41472
 s_waitcnt lgkmcnt(14)
 v_mfma_f32_16x16x32_bf16 v[132:135], v[212:215], v[76:79], v[132:135]
 ds_read_b64_tr_b16 v[204:205], v238 offset:40960
 v_mfma_f32_16x16x32_bf16 v[140:143], v[212:215], v[80:83], v[140:143]
 ds_read_b64_tr_b16 v[206:207], v238 offset:41472
 s_waitcnt lgkmcnt(14)
 v_mfma_f32_16x16x32_bf16 v[136:139], v[216:219], v[76:79], v[136:139]
 ds_read_b64_tr_b16 v[208:209], v239 offset:40960
 v_mfma_f32_16x16x32_bf16 v[144:147], v[216:219], v[80:83], v[144:147]
 ds_read_b64_tr_b16 v[210:211], v239 offset:41472
 s_waitcnt lgkmcnt(10)
 v_mfma_f32_16x16x32_bf16 v[148:151], v[220:223], v[76:79], v[148:151]
 ds_read_b64_tr_b16 v[212:213], v236 offset:45056
 v_mfma_f32_16x16x32_bf16 v[156:159], v[220:223], v[80:83], v[156:159]
 ds_read_b64_tr_b16 v[214:215], v236 offset:45568
 s_waitcnt lgkmcnt(10)
 v_mfma_f32_16x16x32_bf16 v[152:155], v[224:227], v[76:79], v[152:155]
 ds_read_b64_tr_b16 v[216:217], v237 offset:45056
 v_mfma_f32_16x16x32_bf16 v[160:163], v[224:227], v[80:83], v[160:163]
 ds_read_b64_tr_b16 v[218:219], v237 offset:45568
 s_waitcnt lgkmcnt(10)
 s_waitcnt vmcnt(8)
 ds_read_b128 v[100:103], v166 offset:0
 ds_read_b128 v[104:107], v166 offset:1024
 ds_read_b128 v[108:111], v167 offset:0
 ds_read_b128 v[112:115], v167 offset:1024
 v_mfma_f32_16x16x32_bf16 v[132:135], v[196:199], v[84:87], v[132:135]
 ds_read_b64_tr_b16 v[220:221], v238 offset:45056
 v_mfma_f32_16x16x32_bf16 v[140:143], v[196:199], v[88:91], v[140:143]
 ds_read_b64_tr_b16 v[222:223], v238 offset:45568
 s_waitcnt lgkmcnt(14)
 v_mfma_f32_16x16x32_bf16 v[136:139], v[200:203], v[84:87], v[136:139]
 ds_read_b64_tr_b16 v[224:225], v239 offset:45056
 v_mfma_f32_16x16x32_bf16 v[144:147], v[200:203], v[88:91], v[144:147]
 ds_read_b64_tr_b16 v[226:227], v239 offset:45568
 s_waitcnt lgkmcnt(4)
 s_add_u32 m0, s36, 0
 s_add_u32 s39, s43, 128
 buffer_load_dwordx4 v244, s[8:11], s39 offen offset:0 lds
 s_add_u32 s39, s43, 64640
 buffer_load_dwordx4 v245, s[8:11], s39 offen offset:1024 lds
 s_add_u32 s39, s43, 129152
 buffer_load_dwordx4 v244, s[8:11], s39 offen offset:2048 lds
 s_add_u32 s39, s43, 193664
 buffer_load_dwordx4 v245, s[8:11], s39 offen offset:3072 lds
 v_mfma_f32_16x16x32_bf16 v[148:151], v[204:207], v[84:87], v[148:151]
 ds_read_b64_tr_b16 v[196:197], v236 offset:49152
 v_mfma_f32_16x16x32_bf16 v[156:159], v[204:207], v[88:91], v[156:159]
 ds_read_b64_tr_b16 v[198:199], v236 offset:49664
 s_waitcnt lgkmcnt(14)
 v_mfma_f32_16x16x32_bf16 v[152:155], v[208:211], v[84:87], v[152:155]
 ds_read_b64_tr_b16 v[200:201], v237 offset:49152
 v_mfma_f32_16x16x32_bf16 v[160:163], v[208:211], v[88:91], v[160:163]
 ds_read_b64_tr_b16 v[202:203], v237 offset:49664
 s_waitcnt lgkmcnt(14)
 v_mfma_f32_16x16x32_bf16 v[132:135], v[212:215], v[92:95], v[132:135]
 ds_read_b64_tr_b16 v[204:205], v238 offset:49152
 v_mfma_f32_16x16x32_bf16 v[140:143], v[212:215], v[96:99], v[140:143]
 ds_read_b64_tr_b16 v[206:207], v238 offset:49664
 s_waitcnt lgkmcnt(14)
 v_mfma_f32_16x16x32_bf16 v[136:139], v[216:219], v[92:95], v[136:139]
 ds_read_b64_tr_b16 v[208:209], v239 offset:49152
 v_mfma_f32_16x16x32_bf16 v[144:147], v[216:219], v[96:99], v[144:147]
 ds_read_b64_tr_b16 v[210:211], v239 offset:49664
 s_waitcnt lgkmcnt(10)
 v_mfma_f32_16x16x32_bf16 v[148:151], v[220:223], v[92:95], v[148:151]
 ds_read_b64_tr_b16 v[212:213], v236 offset:53248
 v_mfma_f32_16x16x32_bf16 v[156:159], v[220:223], v[96:99], v[156:159]
 ds_read_b64_tr_b16 v[214:215], v236 offset:53760
 s_waitcnt lgkmcnt(10)
 v_mfma_f32_16x16x32_bf16 v[152:155], v[224:227], v[92:95], v[152:155]
 ds_read_b64_tr_b16 v[216:217], v237 offset:53248
 v_mfma_f32_16x16x32_bf16 v[160:163], v[224:227], v[96:99], v[160:163]
 ds_read_b64_tr_b16 v[218:219], v237 offset:53760
 s_waitcnt lgkmcnt(10)
 s_waitcnt vmcnt(8)
 ds_read_b128 v[116:119], v168 offset:0
 ds_read_b128 v[120:123], v168 offset:1024
 ds_read_b128 v[124:127], v169 offset:0
 ds_read_b128 v[128:131], v169 offset:1024
 v_mfma_f32_16x16x32_bf16 v[132:135], v[196:199], v[100:103], v[132:135]
 ds_read_b64_tr_b16 v[220:221], v238 offset:53248
 v_mfma_f32_16x16x32_bf16 v[140:143], v[196:199], v[104:107], v[140:143]
 ds_read_b64_tr_b16 v[222:223], v238 offset:53760
 s_waitcnt lgkmcnt(14)
 v_mfma_f32_16x16x32_bf16 v[136:139], v[200:203], v[100:103], v[136:139]
 ds_read_b64_tr_b16 v[224:225], v239 offset:53248
 v_mfma_f32_16x16x32_bf16 v[144:147], v[200:203], v[104:107], v[144:147]
 ds_read_b64_tr_b16 v[226:227], v239 offset:53760
 s_waitcnt lgkmcnt(4)
 s_add_u32 m0, s36, 32768
 s_add_u32 s39, s35, 256
 buffer_load_dwordx4 v244, s[8:11], s39 offen offset:0 lds
 s_add_u32 s39, s35, 64768
 buffer_load_dwordx4 v245, s[8:11], s39 offen offset:1024 lds
 s_add_u32 s39, s35, 129280
 buffer_load_dwordx4 v244, s[8:11], s39 offen offset:2048 lds
 s_add_u32 s39, s35, 193792
 buffer_load_dwordx4 v245, s[8:11], s39 offen offset:3072 lds
 v_mfma_f32_16x16x32_bf16 v[148:151], v[204:207], v[100:103], v[148:151]
 ds_read_b64_tr_b16 v[196:197], v236 offset:57344
 v_mfma_f32_16x16x32_bf16 v[156:159], v[204:207], v[104:107], v[156:159]
 ds_read_b64_tr_b16 v[198:199], v236 offset:57856
 s_waitcnt lgkmcnt(14)
 v_mfma_f32_16x16x32_bf16 v[152:155], v[208:211], v[100:103], v[152:155]
 ds_read_b64_tr_b16 v[200:201], v237 offset:57344
 v_mfma_f32_16x16x32_bf16 v[160:163], v[208:211], v[104:107], v[160:163]
 ds_read_b64_tr_b16 v[202:203], v237 offset:57856
 s_waitcnt lgkmcnt(14)
 v_mfma_f32_16x16x32_bf16 v[132:135], v[212:215], v[108:111], v[132:135]
 ds_read_b64_tr_b16 v[204:205], v238 offset:57344
 v_mfma_f32_16x16x32_bf16 v[140:143], v[212:215], v[112:115], v[140:143]
 ds_read_b64_tr_b16 v[206:207], v238 offset:57856
 s_waitcnt lgkmcnt(14)
 v_mfma_f32_16x16x32_bf16 v[136:139], v[216:219], v[108:111], v[136:139]
 ds_read_b64_tr_b16 v[208:209], v239 offset:57344
 v_mfma_f32_16x16x32_bf16 v[144:147], v[216:219], v[112:115], v[144:147]
 ds_read_b64_tr_b16 v[210:211], v239 offset:57856
 s_waitcnt lgkmcnt(10)
 v_mfma_f32_16x16x32_bf16 v[148:151], v[220:223], v[108:111], v[148:151]
 ds_read_b64_tr_b16 v[212:213], v236 offset:61440
 v_mfma_f32_16x16x32_bf16 v[156:159], v[220:223], v[112:115], v[156:159]
 ds_read_b64_tr_b16 v[214:215], v236 offset:61952
 s_waitcnt lgkmcnt(10)
 v_mfma_f32_16x16x32_bf16 v[152:155], v[224:227], v[108:111], v[152:155]
 ds_read_b64_tr_b16 v[216:217], v237 offset:61440
 v_mfma_f32_16x16x32_bf16 v[160:163], v[224:227], v[112:115], v[160:163]
 ds_read_b64_tr_b16 v[218:219], v237 offset:61952
 s_waitcnt lgkmcnt(10)
 v_mfma_f32_16x16x32_bf16 v[132:135], v[196:199], v[116:119], v[132:135]
 ds_read_b64_tr_b16 v[220:221], v238 offset:61440
 v_mfma_f32_16x16x32_bf16 v[140:143], v[196:199], v[120:123], v[140:143]
 ds_read_b64_tr_b16 v[222:223], v238 offset:61952
 s_waitcnt lgkmcnt(10)
 s_waitcnt vmcnt(8)
 s_barrier
 s_cmp_eq_u32 s32, 0
 s_cbranch_scc0 KA_NSG0
 s_or_b32 s51, s51, 0x80000000
 v_mov_b32 v248, s50
 v_mov_b32 v249, s51
 v_mov_b32 v250, 0
 v_mov_b32 v251, 0
 s_mov_b64 exec, 1
 buffer_atomic_cmpswap_x2 v[248:251], off, s[96:99], 0 sc0
 s_mov_b64 exec, -1
KA_NSG0:
 v_mfma_f32_16x16x32_bf16 v[136:139], v[200:203], v[116:119], v[136:139]
 ds_read_b64_tr_b16 v[224:225], v239 offset:61440
 v_mfma_f32_16x16x32_bf16 v[144:147], v[200:203], v[120:123], v[144:147]
 ds_read_b64_tr_b16 v[226:227], v239 offset:61952
 s_waitcnt lgkmcnt(10)
 v_mfma_f32_16x16x32_bf16 v[148:151], v[204:207], v[116:119], v[148:151]
 ds_read_b64_tr_b16 v[196:197], v240 offset:0
 v_mfma_f32_16x16x32_bf16 v[156:159], v[204:207], v[120:123], v[156:159]
 ds_read_b64_tr_b16 v[198:199], v240 offset:512
 s_waitcnt lgkmcnt(10)
 v_mfma_f32_16x16x32_bf16 v[152:155], v[208:211], v[116:119], v[152:155]
 ds_read_b64_tr_b16 v[200:201], v241 offset:0
 v_mfma_f32_16x16x32_bf16 v[160:163], v[208:211], v[120:123], v[160:163]
 ds_read_b64_tr_b16 v[202:203], v241 offset:512
 s_waitcnt lgkmcnt(10)
 v_mfma_f32_16x16x32_bf16 v[132:135], v[212:215], v[124:127], v[132:135]
 ds_read_b64_tr_b16 v[204:205], v242 offset:0
 v_mfma_f32_16x16x32_bf16 v[140:143], v[212:215], v[128:131], v[140:143]
 ds_read_b64_tr_b16 v[206:207], v242 offset:512
 s_waitcnt lgkmcnt(10)
 v_mfma_f32_16x16x32_bf16 v[136:139], v[216:219], v[124:127], v[136:139]
 ds_read_b64_tr_b16 v[208:209], v243 offset:0
 v_mfma_f32_16x16x32_bf16 v[144:147], v[216:219], v[128:131], v[144:147]
 ds_read_b64_tr_b16 v[210:211], v243 offset:512
 s_waitcnt lgkmcnt(10)
 v_mfma_f32_16x16x32_bf16 v[148:151], v[220:223], v[124:127], v[148:151]
 ds_read_b64_tr_b16 v[212:213], v240 offset:4096
 v_mfma_f32_16x16x32_bf16 v[156:159], v[220:223], v[128:131], v[156:159]
 ds_read_b64_tr_b16 v[214:215], v240 offset:4608
 s_waitcnt lgkmcnt(10)
 v_mfma_f32_16x16x32_bf16 v[152:155], v[224:227], v[124:127], v[152:155]
 ds_read_b64_tr_b16 v[216:217], v241 offset:4096
 v_mfma_f32_16x16x32_bf16 v[160:163], v[224:227], v[128:131], v[160:163]
 ds_read_b64_tr_b16 v[218:219], v241 offset:4608
 s_waitcnt lgkmcnt(10)
 v_mfma_f32_16x16x32_bf16 v[164:167], v[196:199], v[4:7], 0
 ds_read_b64_tr_b16 v[220:221], v242 offset:4096
 v_mfma_f32_16x16x32_bf16 v[172:175], v[196:199], v[8:11], 0
 ds_read_b64_tr_b16 v[222:223], v242 offset:4608
 s_waitcnt lgkmcnt(10)
 v_mfma_f32_16x16x32_bf16 v[168:171], v[200:203], v[4:7], 0
 ds_read_b64_tr_b16 v[224:225], v243 offset:4096
 v_mfma_f32_16x16x32_bf16 v[176:179], v[200:203], v[8:11], 0
 ds_read_b64_tr_b16 v[226:227], v243 offset:4608
 s_waitcnt lgkmcnt(10)
 v_mfma_f32_16x16x32_bf16 v[180:183], v[204:207], v[4:7], 0
 ds_read_b64_tr_b16 v[196:197], v240 offset:8192
 v_mfma_f32_16x16x32_bf16 v[188:191], v[204:207], v[8:11], 0
 ds_read_b64_tr_b16 v[198:199], v240 offset:8704
 s_waitcnt lgkmcnt(10)
 v_mfma_f32_16x16x32_bf16 v[184:187], v[208:211], v[4:7], 0
 ds_read_b64_tr_b16 v[200:201], v241 offset:8192
 v_mfma_f32_16x16x32_bf16 v[192:195], v[208:211], v[8:11], 0
 ds_read_b64_tr_b16 v[202:203], v241 offset:8704
 s_waitcnt lgkmcnt(10)
 v_mfma_f32_16x16x32_bf16 v[164:167], v[212:215], v[12:15], v[164:167]
 ds_read_b64_tr_b16 v[204:205], v242 offset:8192
 v_mfma_f32_16x16x32_bf16 v[172:175], v[212:215], v[16:19], v[172:175]
 ds_read_b64_tr_b16 v[206:207], v242 offset:8704
 s_waitcnt lgkmcnt(10)
 v_mfma_f32_16x16x32_bf16 v[168:171], v[216:219], v[12:15], v[168:171]
 ds_read_b64_tr_b16 v[208:209], v243 offset:8192
 v_mfma_f32_16x16x32_bf16 v[176:179], v[216:219], v[16:19], v[176:179]
 ds_read_b64_tr_b16 v[210:211], v243 offset:8704
 s_waitcnt lgkmcnt(10)
 v_mfma_f32_16x16x32_bf16 v[180:183], v[220:223], v[12:15], v[180:183]
 ds_read_b64_tr_b16 v[212:213], v240 offset:12288
 v_mfma_f32_16x16x32_bf16 v[188:191], v[220:223], v[16:19], v[188:191]
 ds_read_b64_tr_b16 v[214:215], v240 offset:12800
 s_waitcnt lgkmcnt(10)
 s_add_u32 s94, s95, 0x0
 v_mfma_f32_16x16x32_bf16 v[184:187], v[224:227], v[12:15], v[184:187]
 ds_read_b64_tr_b16 v[216:217], v241 offset:12288
 v_mfma_f32_16x16x32_bf16 v[192:195], v[224:227], v[16:19], v[192:195]
 ds_read_b64_tr_b16 v[218:219], v241 offset:12800
 s_waitcnt lgkmcnt(10)
 v_mfma_f32_16x16x32_bf16 v[164:167], v[196:199], v[20:23], v[164:167]
 ds_read_b64_tr_b16 v[220:221], v242 offset:12288
 v_mfma_f32_16x16x32_bf16 v[172:175], v[196:199], v[24:27], v[172:175]
 ds_read_b64_tr_b16 v[222:223], v242 offset:12800
 s_waitcnt lgkmcnt(10)
 v_cvt_pk_bf16_f32 v132, v132, v133
 v_mfma_f32_16x16x32_bf16 v[168:171], v[200:203], v[20:23], v[168:171]
 ds_read_b64_tr_b16 v[224:225], v243 offset:12288
 v_mfma_f32_16x16x32_bf16 v[176:179], v[200:203], v[24:27], v[176:179]
 ds_read_b64_tr_b16 v[226:227], v243 offset:12800
 s_waitcnt lgkmcnt(10)
 v_mfma_f32_16x16x32_bf16 v[180:183], v[204:207], v[20:23], v[180:183]
 ds_read_b64_tr_b16 v[196:197], v240 offset:16384
 v_mfma_f32_16x16x32_bf16 v[188:191], v[204:207], v[24:27], v[188:191]
 ds_read_b64_tr_b16 v[198:199], v240 offset:16896
 s_waitcnt lgkmcnt(10)
 v_cvt_pk_bf16_f32 v133, v134, v135
 v_mfma_f32_16x16x32_bf16 v[184:187], v[208:211], v[20:23], v[184:187]
 ds_read_b64_tr_b16 v[200:201], v241 offset:16384
 v_mfma_f32_16x16x32_bf16 v[192:195], v[208:211], v[24:27], v[192:195]
 ds_read_b64_tr_b16 v[202:203], v241 offset:16896
 s_waitcnt lgkmcnt(10)
 v_mfma_f32_16x16x32_bf16 v[164:167], v[212:215], v[28:31], v[164:167]
 ds_read_b64_tr_b16 v[204:205], v242 offset:16384
 v_mfma_f32_16x16x32_bf16 v[172:175], v[212:215], v[32:35], v[172:175]
 ds_read_b64_tr_b16 v[206:207], v242 offset:16896
 s_waitcnt lgkmcnt(10)
 v_cvt_pk_bf16_f32 v134, v136, v137
 v_mfma_f32_16x16x32_bf16 v[168:171], v[216:219], v[28:31], v[168:171]
 ds_read_b64_tr_b16 v[208:209], v243 offset:16384
 v_mfma_f32_16x16x32_bf16 v[176:179], v[216:219], v[32:35], v[176:179]
 ds_read_b64_tr_b16 v[210:211], v243 offset:16896
 s_waitcnt lgkmcnt(10)
 v_mfma_f32_16x16x32_bf16 v[180:183], v[220:223], v[28:31], v[180:183]
 ds_read_b64_tr_b16 v[212:213], v240 offset:20480
 v_mfma_f32_16x16x32_bf16 v[188:191], v[220:223], v[32:35], v[188:191]
 ds_read_b64_tr_b16 v[214:215], v240 offset:20992
 s_waitcnt lgkmcnt(10)
 v_cvt_pk_bf16_f32 v135, v138, v139
 v_mfma_f32_16x16x32_bf16 v[184:187], v[224:227], v[28:31], v[184:187]
 ds_read_b64_tr_b16 v[216:217], v241 offset:20480
 v_mfma_f32_16x16x32_bf16 v[192:195], v[224:227], v[32:35], v[192:195]
 ds_read_b64_tr_b16 v[218:219], v241 offset:20992
 s_waitcnt lgkmcnt(10)
 v_mfma_f32_16x16x32_bf16 v[164:167], v[196:199], v[36:39], v[164:167]
 ds_read_b64_tr_b16 v[220:221], v242 offset:20480
 v_mfma_f32_16x16x32_bf16 v[172:175], v[196:199], v[40:43], v[172:175]
 ds_read_b64_tr_b16 v[222:223], v242 offset:20992
 s_waitcnt lgkmcnt(10)
 v_mfma_f32_16x16x32_bf16 v[168:171], v[200:203], v[36:39], v[168:171]
 ds_read_b64_tr_b16 v[224:225], v243 offset:20480
 v_mfma_f32_16x16x32_bf16 v[176:179], v[200:203], v[40:43], v[176:179]
 ds_read_b64_tr_b16 v[226:227], v243 offset:20992
 s_waitcnt lgkmcnt(10)
 buffer_store_dwordx4 v[132:135], v247, s[16:19], s94 offen offset:0 sc1
 v_mfma_f32_16x16x32_bf16 v[180:183], v[204:207], v[36:39], v[180:183]
 ds_read_b64_tr_b16 v[196:197], v240 offset:24576
 v_mfma_f32_16x16x32_bf16 v[188:191], v[204:207], v[40:43], v[188:191]
 ds_read_b64_tr_b16 v[198:199], v240 offset:25088
 s_waitcnt lgkmcnt(10)
 v_mfma_f32_16x16x32_bf16 v[184:187], v[208:211], v[36:39], v[184:187]
 ds_read_b64_tr_b16 v[200:201], v241 offset:24576
 v_mfma_f32_16x16x32_bf16 v[192:195], v[208:211], v[40:43], v[192:195]
 ds_read_b64_tr_b16 v[202:203], v241 offset:25088
 s_waitcnt lgkmcnt(10)
 v_cvt_pk_bf16_f32 v136, v140, v141
 v_mfma_f32_16x16x32_bf16 v[164:167], v[212:215], v[44:47], v[164:167]
 ds_read_b64_tr_b16 v[204:205], v242 offset:24576
 v_mfma_f32_16x16x32_bf16 v[172:175], v[212:215], v[48:51], v[172:175]
 ds_read_b64_tr_b16 v[206:207], v242 offset:25088
 s_waitcnt lgkmcnt(10)
 v_mfma_f32_16x16x32_bf16 v[168:171], v[216:219], v[44:47], v[168:171]
 ds_read_b64_tr_b16 v[208:209], v243 offset:24576
 v_mfma_f32_16x16x32_bf16 v[176:179], v[216:219], v[48:51], v[176:179]
 ds_read_b64_tr_b16 v[210:211], v243 offset:25088
 s_waitcnt lgkmcnt(10)
 v_cvt_pk_bf16_f32 v137, v142, v143
 v_mfma_f32_16x16x32_bf16 v[180:183], v[220:223], v[44:47], v[180:183]
 ds_read_b64_tr_b16 v[212:213], v240 offset:28672
 v_mfma_f32_16x16x32_bf16 v[188:191], v[220:223], v[48:51], v[188:191]
 ds_read_b64_tr_b16 v[214:215], v240 offset:29184
 s_waitcnt lgkmcnt(10)
 v_mfma_f32_16x16x32_bf16 v[184:187], v[224:227], v[44:47], v[184:187]
 ds_read_b64_tr_b16 v[216:217], v241 offset:28672
 v_mfma_f32_16x16x32_bf16 v[192:195], v[224:227], v[48:51], v[192:195]
 ds_read_b64_tr_b16 v[218:219], v241 offset:29184
 s_waitcnt lgkmcnt(10)
 v_cvt_pk_bf16_f32 v138, v144, v145
 v_mfma_f32_16x16x32_bf16 v[164:167], v[196:199], v[52:55], v[164:167]
 ds_read_b64_tr_b16 v[220:221], v242 offset:28672
 v_mfma_f32_16x16x32_bf16 v[172:175], v[196:199], v[56:59], v[172:175]
 ds_read_b64_tr_b16 v[222:223], v242 offset:29184
 s_waitcnt lgkmcnt(10)
 s_waitcnt vmcnt(5)
 s_barrier
 v_mfma_f32_16x16x32_bf16 v[168:171], v[200:203], v[52:55], v[168:171]
 ds_read_b64_tr_b16 v[224:225], v243 offset:28672
 v_mfma_f32_16x16x32_bf16 v[176:179], v[200:203], v[56:59], v[176:179]
 ds_read_b64_tr_b16 v[226:227], v243 offset:29184
 s_waitcnt lgkmcnt(10)
 v_cvt_pk_bf16_f32 v139, v146, v147
 v_mfma_f32_16x16x32_bf16 v[180:183], v[204:207], v[52:55], v[180:183]
 ds_read_b64_tr_b16 v[196:197], v232 offset:0
 v_mfma_f32_16x16x32_bf16 v[188:191], v[204:207], v[56:59], v[188:191]
 ds_read_b64_tr_b16 v[198:199], v232 offset:512
 s_waitcnt lgkmcnt(10)
 v_mfma_f32_16x16x32_bf16 v[184:187], v[208:211], v[52:55], v[184:187]
 ds_read_b64_tr_b16 v[200:201], v233 offset:0
 v_mfma_f32_16x16x32_bf16 v[192:195], v[208:211], v[56:59], v[192:195]
 ds_read_b64_tr_b16 v[202:203], v233 offset:512
 s_waitcnt lgkmcnt(10)
 buffer_store_dwordx4 v[136:139], v247, s[16:19], s94 offen offset:128 sc1
 v_mfma_f32_16x16x32_bf16 v[164:167], v[212:215], v[60:63], v[164:167]
 ds_read_b64_tr_b16 v[204:205], v234 offset:0
 v_mfma_f32_16x16x32_bf16 v[172:175], v[212:215], v[64:67], v[172:175]
 ds_read_b64_tr_b16 v[206:207], v234 offset:512
 s_waitcnt lgkmcnt(10)
 v_mfma_f32_16x16x32_bf16 v[168:171], v[216:219], v[60:63], v[168:171]
 ds_read_b64_tr_b16 v[208:209], v235 offset:0
 v_mfma_f32_16x16x32_bf16 v[176:179], v[216:219], v[64:67], v[176:179]
 ds_read_b64_tr_b16 v[210:211], v235 offset:512
 s_waitcnt lgkmcnt(10)
 v_mfma_f32_16x16x32_bf16 v[180:183], v[220:223], v[60:63], v[180:183]
 ds_read_b64_tr_b16 v[212:213], v232 offset:4096
 v_mfma_f32_16x16x32_bf16 v[188:191], v[220:223], v[64:67], v[188:191]
 ds_read_b64_tr_b16 v[214:215], v232 offset:4608
 s_waitcnt lgkmcnt(10)
 s_add_u32 s94, s95, 0x800
 v_mfma_f32_16x16x32_bf16 v[184:187], v[224:227], v[60:63], v[184:187]
 ds_read_b64_tr_b16 v[216:217], v233 offset:4096
 v_mfma_f32_16x16x32_bf16 v[192:195], v[224:227], v[64:67], v[192:195]
 ds_read_b64_tr_b16 v[218:219], v233 offset:4608
 s_waitcnt lgkmcnt(10)
 v_mfma_f32_16x16x32_bf16 v[164:167], v[196:199], v[68:71], v[164:167]
 ds_read_b64_tr_b16 v[220:221], v234 offset:4096
 v_mfma_f32_16x16x32_bf16 v[172:175], v[196:199], v[72:75], v[172:175]
 ds_read_b64_tr_b16 v[222:223], v234 offset:4608
 s_waitcnt lgkmcnt(10)
 v_cvt_pk_bf16_f32 v148, v148, v149
 v_mfma_f32_16x16x32_bf16 v[168:171], v[200:203], v[68:71], v[168:171]
 ds_read_b64_tr_b16 v[224:225], v235 offset:4096
 v_mfma_f32_16x16x32_bf16 v[176:179], v[200:203], v[72:75], v[176:179]
 ds_read_b64_tr_b16 v[226:227], v235 offset:4608
 s_waitcnt lgkmcnt(10)
 v_mfma_f32_16x16x32_bf16 v[180:183], v[204:207], v[68:71], v[180:183]
 ds_read_b64_tr_b16 v[196:197], v232 offset:8192
 v_mfma_f32_16x16x32_bf16 v[188:191], v[204:207], v[72:75], v[188:191]
 ds_read_b64_tr_b16 v[198:199], v232 offset:8704
 s_waitcnt lgkmcnt(10)
 v_cvt_pk_bf16_f32 v149, v150, v151
 v_mfma_f32_16x16x32_bf16 v[184:187], v[208:211], v[68:71], v[184:187]
 ds_read_b64_tr_b16 v[200:201], v233 offset:8192
 v_mfma_f32_16x16x32_bf16 v[192:195], v[208:211], v[72:75], v[192:195]
 ds_read_b64_tr_b16 v[202:203], v233 offset:8704
 s_waitcnt lgkmcnt(10)
 s_mov_b32 s28, s76
 s_and_b32 s29, s77, 0xffff
 s_mov_b32 s30, 0x400000
 s_mov_b32 s31, 0x00020000
 s_lshl_b32 s38, s2, 14
 s_lshl_b32 s39, s32, 11
 s_add_u32 s38, s38, s39
 s_lshr_b32 s3, s2, 3
 s_lshl_b32 s3, s3, 3
 s_add_u32 s3, s3, s32
 s_lshl_b32 s3, s3, 14
 s_and_b32 s39, s2, 7
 s_lshl_b32 s39, s39, 10
 s_add_u32 s3, s3, s39
 v_and_b32 v229, 7, v0
 v_lshlrev_b32 v229, 7, v229
 v_bfe_u32 v231, v0, 3, 1
 v_lshl_add_u32 v229, v231, 13, v229
 v_lshlrev_b32 v230, 7, v0
 s_mov_b64 exec, 0xffff
 buffer_load_dword v228, v229, s[28:31], s3 offen
 s_mov_b32 s20, s84
 s_and_b32 s21, s85, 0xffff
 s_mov_b32 s22, 0x158000
 s_mov_b32 s23, 0x00020000
 s_lshr_b32 s38, s38, 1
 s_mov_b64 exec, 0xff
 buffer_load_dword v228, v230, s[20:23], s38 offen
 s_mov_b64 exec, -1
 v_mfma_f32_16x16x32_bf16 v[164:167], v[212:215], v[76:79], v[164:167]
 ds_read_b64_tr_b16 v[204:205], v234 offset:8192
 v_mfma_f32_16x16x32_bf16 v[172:175], v[212:215], v[80:83], v[172:175]
 ds_read_b64_tr_b16 v[206:207], v234 offset:8704
 s_waitcnt lgkmcnt(10)
 v_cvt_pk_bf16_f32 v150, v152, v153
 v_mfma_f32_16x16x32_bf16 v[168:171], v[216:219], v[76:79], v[168:171]
 ds_read_b64_tr_b16 v[208:209], v235 offset:8192
 v_mfma_f32_16x16x32_bf16 v[176:179], v[216:219], v[80:83], v[176:179]
 ds_read_b64_tr_b16 v[210:211], v235 offset:8704
 s_waitcnt lgkmcnt(10)
 v_mfma_f32_16x16x32_bf16 v[180:183], v[220:223], v[76:79], v[180:183]
 ds_read_b64_tr_b16 v[212:213], v232 offset:12288
 v_mfma_f32_16x16x32_bf16 v[188:191], v[220:223], v[80:83], v[188:191]
 ds_read_b64_tr_b16 v[214:215], v232 offset:12800
 s_waitcnt lgkmcnt(10)
 v_cvt_pk_bf16_f32 v151, v154, v155
 v_mfma_f32_16x16x32_bf16 v[184:187], v[224:227], v[76:79], v[184:187]
 ds_read_b64_tr_b16 v[216:217], v233 offset:12288
 v_mfma_f32_16x16x32_bf16 v[192:195], v[224:227], v[80:83], v[192:195]
 ds_read_b64_tr_b16 v[218:219], v233 offset:12800
 s_waitcnt lgkmcnt(10)
 v_mfma_f32_16x16x32_bf16 v[164:167], v[196:199], v[84:87], v[164:167]
 ds_read_b64_tr_b16 v[220:221], v234 offset:12288
 v_mfma_f32_16x16x32_bf16 v[172:175], v[196:199], v[88:91], v[172:175]
 ds_read_b64_tr_b16 v[222:223], v234 offset:12800
 s_waitcnt lgkmcnt(10)
 v_mfma_f32_16x16x32_bf16 v[168:171], v[200:203], v[84:87], v[168:171]
 ds_read_b64_tr_b16 v[224:225], v235 offset:12288
 v_mfma_f32_16x16x32_bf16 v[176:179], v[200:203], v[88:91], v[176:179]
 ds_read_b64_tr_b16 v[226:227], v235 offset:12800
 s_waitcnt lgkmcnt(10)
 buffer_store_dwordx4 v[148:151], v247, s[16:19], s94 offen offset:0 sc1
 v_mfma_f32_16x16x32_bf16 v[180:183], v[204:207], v[84:87], v[180:183]
 ds_read_b64_tr_b16 v[196:197], v232 offset:16384
 v_mfma_f32_16x16x32_bf16 v[188:191], v[204:207], v[88:91], v[188:191]
 ds_read_b64_tr_b16 v[198:199], v232 offset:16896
 s_waitcnt lgkmcnt(10)
 v_mfma_f32_16x16x32_bf16 v[184:187], v[208:211], v[84:87], v[184:187]
 ds_read_b64_tr_b16 v[200:201], v233 offset:16384
 v_mfma_f32_16x16x32_bf16 v[192:195], v[208:211], v[88:91], v[192:195]
 ds_read_b64_tr_b16 v[202:203], v233 offset:16896
 s_waitcnt lgkmcnt(10)
 v_cvt_pk_bf16_f32 v152, v156, v157
 v_mfma_f32_16x16x32_bf16 v[164:167], v[212:215], v[92:95], v[164:167]
 ds_read_b64_tr_b16 v[204:205], v234 offset:16384
 v_mfma_f32_16x16x32_bf16 v[172:175], v[212:215], v[96:99], v[172:175]
 ds_read_b64_tr_b16 v[206:207], v234 offset:16896
 s_waitcnt lgkmcnt(10)
 v_mfma_f32_16x16x32_bf16 v[168:171], v[216:219], v[92:95], v[168:171]
 ds_read_b64_tr_b16 v[208:209], v235 offset:16384
 v_mfma_f32_16x16x32_bf16 v[176:179], v[216:219], v[96:99], v[176:179]
 ds_read_b64_tr_b16 v[210:211], v235 offset:16896
 s_waitcnt lgkmcnt(10)
 v_cvt_pk_bf16_f32 v153, v158, v159
 v_mfma_f32_16x16x32_bf16 v[180:183], v[220:223], v[92:95], v[180:183]
 ds_read_b64_tr_b16 v[212:213], v232 offset:20480
 v_mfma_f32_16x16x32_bf16 v[188:191], v[220:223], v[96:99], v[188:191]
 ds_read_b64_tr_b16 v[214:215], v232 offset:20992
 s_waitcnt lgkmcnt(10)
 v_mfma_f32_16x16x32_bf16 v[184:187], v[224:227], v[92:95], v[184:187]
 ds_read_b64_tr_b16 v[216:217], v233 offset:20480
 v_mfma_f32_16x16x32_bf16 v[192:195], v[224:227], v[96:99], v[192:195]
 ds_read_b64_tr_b16 v[218:219], v233 offset:20992
 s_waitcnt lgkmcnt(10)
 v_cvt_pk_bf16_f32 v154, v160, v161
 v_mfma_f32_16x16x32_bf16 v[164:167], v[196:199], v[100:103], v[164:167]
 ds_read_b64_tr_b16 v[220:221], v234 offset:20480
 v_mfma_f32_16x16x32_bf16 v[172:175], v[196:199], v[104:107], v[172:175]
 ds_read_b64_tr_b16 v[222:223], v234 offset:20992
 s_waitcnt lgkmcnt(10)
 v_mfma_f32_16x16x32_bf16 v[168:171], v[200:203], v[100:103], v[168:171]
 ds_read_b64_tr_b16 v[224:225], v235 offset:20480
 v_mfma_f32_16x16x32_bf16 v[176:179], v[200:203], v[104:107], v[176:179]
 ds_read_b64_tr_b16 v[226:227], v235 offset:20992
 s_waitcnt lgkmcnt(10)
 v_cvt_pk_bf16_f32 v155, v162, v163
 v_mfma_f32_16x16x32_bf16 v[180:183], v[204:207], v[100:103], v[180:183]
 ds_read_b64_tr_b16 v[196:197], v232 offset:24576
 v_mfma_f32_16x16x32_bf16 v[188:191], v[204:207], v[104:107], v[188:191]
 ds_read_b64_tr_b16 v[198:199], v232 offset:25088
 s_waitcnt lgkmcnt(10)
 v_mfma_f32_16x16x32_bf16 v[184:187], v[208:211], v[100:103], v[184:187]
 ds_read_b64_tr_b16 v[200:201], v233 offset:24576
 v_mfma_f32_16x16x32_bf16 v[192:195], v[208:211], v[104:107], v[192:195]
 ds_read_b64_tr_b16 v[202:203], v233 offset:25088
 s_waitcnt lgkmcnt(10)
 buffer_store_dwordx4 v[152:155], v247, s[16:19], s94 offen offset:128 sc1
 v_mfma_f32_16x16x32_bf16 v[164:167], v[212:215], v[108:111], v[164:167]
 ds_read_b64_tr_b16 v[204:205], v234 offset:24576
 v_mfma_f32_16x16x32_bf16 v[172:175], v[212:215], v[112:115], v[172:175]
 ds_read_b64_tr_b16 v[206:207], v234 offset:25088
 s_waitcnt lgkmcnt(10)
 v_mfma_f32_16x16x32_bf16 v[168:171], v[216:219], v[108:111], v[168:171]
 ds_read_b64_tr_b16 v[208:209], v235 offset:24576
 v_mfma_f32_16x16x32_bf16 v[176:179], v[216:219], v[112:115], v[176:179]
 ds_read_b64_tr_b16 v[210:211], v235 offset:25088
 s_waitcnt lgkmcnt(10)
 v_mfma_f32_16x16x32_bf16 v[180:183], v[220:223], v[108:111], v[180:183]
 ds_read_b64_tr_b16 v[212:213], v232 offset:28672
 v_mfma_f32_16x16x32_bf16 v[188:191], v[220:223], v[112:115], v[188:191]
 ds_read_b64_tr_b16 v[214:215], v232 offset:29184
 s_waitcnt lgkmcnt(10)
 v_mfma_f32_16x16x32_bf16 v[184:187], v[224:227], v[108:111], v[184:187]
 ds_read_b64_tr_b16 v[216:217], v233 offset:28672
 v_mfma_f32_16x16x32_bf16 v[192:195], v[224:227], v[112:115], v[192:195]
 ds_read_b64_tr_b16 v[218:219], v233 offset:29184
 s_waitcnt lgkmcnt(10)
 v_mfma_f32_16x16x32_bf16 v[164:167], v[196:199], v[116:119], v[164:167]
 ds_read_b64_tr_b16 v[220:221], v234 offset:28672
 v_mfma_f32_16x16x32_bf16 v[172:175], v[196:199], v[120:123], v[172:175]
 ds_read_b64_tr_b16 v[222:223], v234 offset:29184
 s_waitcnt lgkmcnt(10)
 s_waitcnt vmcnt(6)
 s_barrier
 s_add_u32 m0, s36, 65536
 s_add_u32 s39, s43, 256
 buffer_load_dwordx4 v244, s[8:11], s39 offen offset:0 lds
 s_add_u32 s39, s43, 64768
 buffer_load_dwordx4 v245, s[8:11], s39 offen offset:1024 lds
 s_add_u32 s39, s43, 129280
 buffer_load_dwordx4 v244, s[8:11], s39 offen offset:2048 lds
 s_add_u32 s39, s43, 193792
 buffer_load_dwordx4 v245, s[8:11], s39 offen offset:3072 lds
 s_cmp_eq_u32 s32, 0
 s_cbranch_scc0 KA_NTK0
 s_waitcnt vmcnt(10)
 v_readfirstlane_b32 s46, v248
 v_readfirstlane_b32 s47, v249
 s_or_b32 s38, s46, s47
 s_cselect_b64 s[50:51], s[46:47], s[50:51]
 v_mov_b32 v254, s50
 v_mov_b32 v255, s51
 s_add_u32 s28, s86, 0x200000
 s_addc_u32 s29, s87, 0
 s_and_b32 s29, s29, 0xffff
 s_mov_b32 s30, 0x14000
 s_mov_b32 s31, 0x00020000
 s_lshl_b32 s39, s2, 3
 s_and_b32 s38, s2, 7
 s_lshl_b32 s38, s38, 4
 v_mov_b32 v252, 1
 s_mov_b64 exec, 1
 buffer_store_dwordx2 v[254:255], off, s[28:31], s39 sc1
 s_cmp_eq_u32 s92, 0
 s_cbranch_scc0 KA_NTJ0
 buffer_atomic_add v252, off, s[96:99], s38 offset:128 sc0
KA_NTJ0:
 s_mov_b64 exec, -1
KA_NTK0:
 s_add_u32 s96, s86, 0x200000
 s_addc_u32 s97, s87, 0
 s_and_b32 s97, s97, 0xffff
 s_mov_b32 s98, 0x14000
 s_mov_b32 s99, 0x00020000
 v_mfma_f32_16x16x32_bf16 v[168:171], v[200:203], v[116:119], v[168:171]
 ds_read_b64_tr_b16 v[224:225], v235 offset:28672
 v_mfma_f32_16x16x32_bf16 v[176:179], v[200:203], v[120:123], v[176:179]
 ds_read_b64_tr_b16 v[226:227], v235 offset:29184
 s_waitcnt lgkmcnt(10)
 v_mfma_f32_16x16x32_bf16 v[180:183], v[204:207], v[116:119], v[180:183]
 ds_read_b64_tr_b16 v[196:197], v232 offset:32768
 v_mfma_f32_16x16x32_bf16 v[188:191], v[204:207], v[120:123], v[188:191]
 ds_read_b64_tr_b16 v[198:199], v232 offset:33280
 s_waitcnt lgkmcnt(10)
 v_mfma_f32_16x16x32_bf16 v[184:187], v[208:211], v[116:119], v[184:187]
 ds_read_b64_tr_b16 v[200:201], v233 offset:32768
 v_mfma_f32_16x16x32_bf16 v[192:195], v[208:211], v[120:123], v[192:195]
 ds_read_b64_tr_b16 v[202:203], v233 offset:33280
 s_waitcnt lgkmcnt(10)
 v_mfma_f32_16x16x32_bf16 v[164:167], v[212:215], v[124:127], v[164:167]
 ds_read_b64_tr_b16 v[204:205], v234 offset:32768
 v_mfma_f32_16x16x32_bf16 v[172:175], v[212:215], v[128:131], v[172:175]
 ds_read_b64_tr_b16 v[206:207], v234 offset:33280
 s_waitcnt lgkmcnt(10)
 v_mfma_f32_16x16x32_bf16 v[168:171], v[216:219], v[124:127], v[168:171]
 ds_read_b64_tr_b16 v[208:209], v235 offset:32768
 v_mfma_f32_16x16x32_bf16 v[176:179], v[216:219], v[128:131], v[176:179]
 ds_read_b64_tr_b16 v[210:211], v235 offset:33280
 s_waitcnt lgkmcnt(10)
 v_mfma_f32_16x16x32_bf16 v[180:183], v[220:223], v[124:127], v[180:183]
 ds_read_b64_tr_b16 v[212:213], v232 offset:36864
 v_mfma_f32_16x16x32_bf16 v[188:191], v[220:223], v[128:131], v[188:191]
 ds_read_b64_tr_b16 v[214:215], v232 offset:37376
 s_waitcnt lgkmcnt(10)
 v_mfma_f32_16x16x32_bf16 v[184:187], v[224:227], v[124:127], v[184:187]
 ds_read_b64_tr_b16 v[216:217], v233 offset:36864
 v_mfma_f32_16x16x32_bf16 v[192:195], v[224:227], v[128:131], v[192:195]
 ds_read_b64_tr_b16 v[218:219], v233 offset:37376
 s_waitcnt lgkmcnt(10)
 v_mfma_f32_16x16x32_bf16 v[132:135], v[196:199], v[4:7], 0
 ds_read_b64_tr_b16 v[220:221], v234 offset:36864
 v_mfma_f32_16x16x32_bf16 v[140:143], v[196:199], v[8:11], 0
 ds_read_b64_tr_b16 v[222:223], v234 offset:37376
 s_waitcnt lgkmcnt(10)
 v_mfma_f32_16x16x32_bf16 v[136:139], v[200:203], v[4:7], 0
 ds_read_b64_tr_b16 v[224:225], v235 offset:36864
 v_mfma_f32_16x16x32_bf16 v[144:147], v[200:203], v[8:11], 0
 ds_read_b64_tr_b16 v[226:227], v235 offset:37376
 s_waitcnt lgkmcnt(10)
 v_mfma_f32_16x16x32_bf16 v[148:151], v[204:207], v[4:7], 0
 ds_read_b64_tr_b16 v[196:197], v232 offset:40960
 v_mfma_f32_16x16x32_bf16 v[156:159], v[204:207], v[8:11], 0
 ds_read_b64_tr_b16 v[198:199], v232 offset:41472
 s_waitcnt lgkmcnt(10)
 v_mfma_f32_16x16x32_bf16 v[152:155], v[208:211], v[4:7], 0
 ds_read_b64_tr_b16 v[200:201], v233 offset:40960
 v_mfma_f32_16x16x32_bf16 v[160:163], v[208:211], v[8:11], 0
 ds_read_b64_tr_b16 v[202:203], v233 offset:41472
 s_waitcnt lgkmcnt(10)
 v_mfma_f32_16x16x32_bf16 v[132:135], v[212:215], v[12:15], v[132:135]
 ds_read_b64_tr_b16 v[204:205], v234 offset:40960
 v_mfma_f32_16x16x32_bf16 v[140:143], v[212:215], v[16:19], v[140:143]
 ds_read_b64_tr_b16 v[206:207], v234 offset:41472
 s_waitcnt lgkmcnt(10)
 v_mfma_f32_16x16x32_bf16 v[136:139], v[216:219], v[12:15], v[136:139]
 ds_read_b64_tr_b16 v[208:209], v235 offset:40960
 v_mfma_f32_16x16x32_bf16 v[144:147], v[216:219], v[16:19], v[144:147]
 ds_read_b64_tr_b16 v[210:211], v235 offset:41472
 s_waitcnt lgkmcnt(10)
 v_mfma_f32_16x16x32_bf16 v[148:151], v[220:223], v[12:15], v[148:151]
 ds_read_b64_tr_b16 v[212:213], v232 offset:45056
 v_mfma_f32_16x16x32_bf16 v[156:159], v[220:223], v[16:19], v[156:159]
 ds_read_b64_tr_b16 v[214:215], v232 offset:45568
 s_waitcnt lgkmcnt(10)
 s_add_u32 s94, s95, 0x1000
 v_mfma_f32_16x16x32_bf16 v[152:155], v[224:227], v[12:15], v[152:155]
 ds_read_b64_tr_b16 v[216:217], v233 offset:45056
 v_mfma_f32_16x16x32_bf16 v[160:163], v[224:227], v[16:19], v[160:163]
 ds_read_b64_tr_b16 v[218:219], v233 offset:45568
 s_waitcnt lgkmcnt(10)
 v_mfma_f32_16x16x32_bf16 v[132:135], v[196:199], v[20:23], v[132:135]
 ds_read_b64_tr_b16 v[220:221], v234 offset:45056
 v_mfma_f32_16x16x32_bf16 v[140:143], v[196:199], v[24:27], v[140:143]
 ds_read_b64_tr_b16 v[222:223], v234 offset:45568
 s_waitcnt lgkmcnt(10)
 v_cvt_pk_bf16_f32 v164, v164, v165
 v_mfma_f32_16x16x32_bf16 v[136:139], v[200:203], v[20:23], v[136:139]
 ds_read_b64_tr_b16 v[224:225], v235 offset:45056
 v_mfma_f32_16x16x32_bf16 v[144:147], v[200:203], v[24:27], v[144:147]
 ds_read_b64_tr_b16 v[226:227], v235 offset:45568
 s_waitcnt lgkmcnt(10)
 v_mfma_f32_16x16x32_bf16 v[148:151], v[204:207], v[20:23], v[148:151]
 ds_read_b64_tr_b16 v[196:197], v232 offset:49152
 v_mfma_f32_16x16x32_bf16 v[156:159], v[204:207], v[24:27], v[156:159]
 ds_read_b64_tr_b16 v[198:199], v232 offset:49664
 s_waitcnt lgkmcnt(10)
 v_cvt_pk_bf16_f32 v165, v166, v167
 v_mfma_f32_16x16x32_bf16 v[152:155], v[208:211], v[20:23], v[152:155]
 ds_read_b64_tr_b16 v[200:201], v233 offset:49152
 v_mfma_f32_16x16x32_bf16 v[160:163], v[208:211], v[24:27], v[160:163]
 ds_read_b64_tr_b16 v[202:203], v233 offset:49664
 s_waitcnt lgkmcnt(10)
 v_mfma_f32_16x16x32_bf16 v[132:135], v[212:215], v[28:31], v[132:135]
 ds_read_b64_tr_b16 v[204:205], v234 offset:49152
 v_mfma_f32_16x16x32_bf16 v[140:143], v[212:215], v[32:35], v[140:143]
 ds_read_b64_tr_b16 v[206:207], v234 offset:49664
 s_waitcnt lgkmcnt(10)
 v_cvt_pk_bf16_f32 v166, v168, v169
 v_mfma_f32_16x16x32_bf16 v[136:139], v[216:219], v[28:31], v[136:139]
 ds_read_b64_tr_b16 v[208:209], v235 offset:49152
 v_mfma_f32_16x16x32_bf16 v[144:147], v[216:219], v[32:35], v[144:147]
 ds_read_b64_tr_b16 v[210:211], v235 offset:49664
 s_waitcnt lgkmcnt(10)
 v_mfma_f32_16x16x32_bf16 v[148:151], v[220:223], v[28:31], v[148:151]
 ds_read_b64_tr_b16 v[212:213], v232 offset:53248
 v_mfma_f32_16x16x32_bf16 v[156:159], v[220:223], v[32:35], v[156:159]
 ds_read_b64_tr_b16 v[214:215], v232 offset:53760
 s_waitcnt lgkmcnt(10)
 v_cvt_pk_bf16_f32 v167, v170, v171
 v_mfma_f32_16x16x32_bf16 v[152:155], v[224:227], v[28:31], v[152:155]
 ds_read_b64_tr_b16 v[216:217], v233 offset:53248
 v_mfma_f32_16x16x32_bf16 v[160:163], v[224:227], v[32:35], v[160:163]
 ds_read_b64_tr_b16 v[218:219], v233 offset:53760
 s_waitcnt lgkmcnt(10)
 v_mfma_f32_16x16x32_bf16 v[132:135], v[196:199], v[36:39], v[132:135]
 ds_read_b64_tr_b16 v[220:221], v234 offset:53248
 v_mfma_f32_16x16x32_bf16 v[140:143], v[196:199], v[40:43], v[140:143]
 ds_read_b64_tr_b16 v[222:223], v234 offset:53760
 s_waitcnt lgkmcnt(10)
 v_mfma_f32_16x16x32_bf16 v[136:139], v[200:203], v[36:39], v[136:139]
 ds_read_b64_tr_b16 v[224:225], v235 offset:53248
 v_mfma_f32_16x16x32_bf16 v[144:147], v[200:203], v[40:43], v[144:147]
 ds_read_b64_tr_b16 v[226:227], v235 offset:53760
 s_waitcnt lgkmcnt(10)
 buffer_store_dwordx4 v[164:167], v247, s[16:19], s94 offen offset:0 sc1
 v_mfma_f32_16x16x32_bf16 v[148:151], v[204:207], v[36:39], v[148:151]
 ds_read_b64_tr_b16 v[196:197], v232 offset:57344
 v_mfma_f32_16x16x32_bf16 v[156:159], v[204:207], v[40:43], v[156:159]
 ds_read_b64_tr_b16 v[198:199], v232 offset:57856
 s_waitcnt lgkmcnt(10)
 v_mfma_f32_16x16x32_bf16 v[152:155], v[208:211], v[36:39], v[152:155]
 ds_read_b64_tr_b16 v[200:201], v233 offset:57344
 v_mfma_f32_16x16x32_bf16 v[160:163], v[208:211], v[40:43], v[160:163]
 ds_read_b64_tr_b16 v[202:203], v233 offset:57856
 s_waitcnt lgkmcnt(10)
 v_cvt_pk_bf16_f32 v168, v172, v173
 v_mfma_f32_16x16x32_bf16 v[132:135], v[212:215], v[44:47], v[132:135]
 ds_read_b64_tr_b16 v[204:205], v234 offset:57344
 v_mfma_f32_16x16x32_bf16 v[140:143], v[212:215], v[48:51], v[140:143]
 ds_read_b64_tr_b16 v[206:207], v234 offset:57856
 s_waitcnt lgkmcnt(10)
 v_mfma_f32_16x16x32_bf16 v[136:139], v[216:219], v[44:47], v[136:139]
 ds_read_b64_tr_b16 v[208:209], v235 offset:57344
 v_mfma_f32_16x16x32_bf16 v[144:147], v[216:219], v[48:51], v[144:147]
 ds_read_b64_tr_b16 v[210:211], v235 offset:57856
 s_waitcnt lgkmcnt(10)
 v_cvt_pk_bf16_f32 v169, v174, v175
 v_mfma_f32_16x16x32_bf16 v[148:151], v[220:223], v[44:47], v[148:151]
 ds_read_b64_tr_b16 v[212:213], v232 offset:61440
 v_mfma_f32_16x16x32_bf16 v[156:159], v[220:223], v[48:51], v[156:159]
 ds_read_b64_tr_b16 v[214:215], v232 offset:61952
 s_waitcnt lgkmcnt(10)
 v_mfma_f32_16x16x32_bf16 v[152:155], v[224:227], v[44:47], v[152:155]
 ds_read_b64_tr_b16 v[216:217], v233 offset:61440
 v_mfma_f32_16x16x32_bf16 v[160:163], v[224:227], v[48:51], v[160:163]
 ds_read_b64_tr_b16 v[218:219], v233 offset:61952
 s_waitcnt lgkmcnt(10)
 v_cvt_pk_bf16_f32 v170, v176, v177
 v_mfma_f32_16x16x32_bf16 v[132:135], v[196:199], v[52:55], v[132:135]
 ds_read_b64_tr_b16 v[220:221], v234 offset:61440
 v_mfma_f32_16x16x32_bf16 v[140:143], v[196:199], v[56:59], v[140:143]
 ds_read_b64_tr_b16 v[222:223], v234 offset:61952
 s_waitcnt lgkmcnt(10)
 s_waitcnt vmcnt(1)
 s_barrier
 s_add_u32 m0, s36, 98304
 s_add_u32 s39, s35, 384
 buffer_load_dwordx4 v244, s[8:11], s39 offen offset:0 lds
 s_add_u32 s39, s35, 64896
 buffer_load_dwordx4 v245, s[8:11], s39 offen offset:1024 lds
 s_add_u32 s39, s35, 129408
 buffer_load_dwordx4 v244, s[8:11], s39 offen offset:2048 lds
 s_add_u32 s39, s35, 193920
 buffer_load_dwordx4 v245, s[8:11], s39 offen offset:3072 lds
 s_cmp_eq_u32 s32, 0
 s_cbranch_scc0 KA_NTL0
 v_mov_b32 v251, 0
 s_waitcnt vmcnt(5)
 s_mov_b64 exec, 1
 ds_write_b32 v251, v252
 ds_write_b64 v251, v[254:255] offset:8
 s_mov_b64 exec, -1
 s_waitcnt lgkmcnt(0)
KA_NTL0:
 v_mfma_f32_16x16x32_bf16 v[136:139], v[200:203], v[52:55], v[136:139]
 ds_read_b64_tr_b16 v[224:225], v235 offset:61440
 v_mfma_f32_16x16x32_bf16 v[144:147], v[200:203], v[56:59], v[144:147]
 ds_read_b64_tr_b16 v[226:227], v235 offset:61952
 s_waitcnt lgkmcnt(10)
 v_cvt_pk_bf16_f32 v171, v178, v179
 v_mfma_f32_16x16x32_bf16 v[148:151], v[204:207], v[52:55], v[148:151]
 ds_read_b64_tr_b16 v[196:197], v236 offset:0
 v_mfma_f32_16x16x32_bf16 v[156:159], v[204:207], v[56:59], v[156:159]
 ds_read_b64_tr_b16 v[198:199], v236 offset:512
 s_waitcnt lgkmcnt(10)
 v_mfma_f32_16x16x32_bf16 v[152:155], v[208:211], v[52:55], v[152:155]
 ds_read_b64_tr_b16 v[200:201], v237 offset:0
 v_mfma_f32_16x16x32_bf16 v[160:163], v[208:211], v[56:59], v[160:163]
 ds_read_b64_tr_b16 v[202:203], v237 offset:512
 s_waitcnt lgkmcnt(10)
 buffer_store_dwordx4 v[168:171], v247, s[16:19], s94 offen offset:128 sc1
 v_mfma_f32_16x16x32_bf16 v[132:135], v[212:215], v[60:63], v[132:135]
 ds_read_b64_tr_b16 v[204:205], v238 offset:0
 v_mfma_f32_16x16x32_bf16 v[140:143], v[212:215], v[64:67], v[140:143]
 ds_read_b64_tr_b16 v[206:207], v238 offset:512
 s_waitcnt lgkmcnt(10)
 v_mfma_f32_16x16x32_bf16 v[136:139], v[216:219], v[60:63], v[136:139]
 ds_read_b64_tr_b16 v[208:209], v239 offset:0
 v_mfma_f32_16x16x32_bf16 v[144:147], v[216:219], v[64:67], v[144:147]
 ds_read_b64_tr_b16 v[210:211], v239 offset:512
 s_waitcnt lgkmcnt(10)
 v_mfma_f32_16x16x32_bf16 v[148:151], v[220:223], v[60:63], v[148:151]
 ds_read_b64_tr_b16 v[212:213], v236 offset:4096
 v_mfma_f32_16x16x32_bf16 v[156:159], v[220:223], v[64:67], v[156:159]
 ds_read_b64_tr_b16 v[214:215], v236 offset:4608
 s_waitcnt lgkmcnt(10)
 s_add_u32 s94, s95, 0x1800
 v_mfma_f32_16x16x32_bf16 v[152:155], v[224:227], v[60:63], v[152:155]
 ds_read_b64_tr_b16 v[216:217], v237 offset:4096
 v_mfma_f32_16x16x32_bf16 v[160:163], v[224:227], v[64:67], v[160:163]
 ds_read_b64_tr_b16 v[218:219], v237 offset:4608
 s_waitcnt lgkmcnt(10)
 v_mfma_f32_16x16x32_bf16 v[132:135], v[196:199], v[68:71], v[132:135]
 ds_read_b64_tr_b16 v[220:221], v238 offset:4096
 v_mfma_f32_16x16x32_bf16 v[140:143], v[196:199], v[72:75], v[140:143]
 ds_read_b64_tr_b16 v[222:223], v238 offset:4608
 s_waitcnt lgkmcnt(10)
 v_cvt_pk_bf16_f32 v180, v180, v181
 v_mfma_f32_16x16x32_bf16 v[136:139], v[200:203], v[68:71], v[136:139]
 ds_read_b64_tr_b16 v[224:225], v239 offset:4096
 v_mfma_f32_16x16x32_bf16 v[144:147], v[200:203], v[72:75], v[144:147]
 ds_read_b64_tr_b16 v[226:227], v239 offset:4608
 s_waitcnt lgkmcnt(10)
 v_mfma_f32_16x16x32_bf16 v[148:151], v[204:207], v[68:71], v[148:151]
 ds_read_b64_tr_b16 v[196:197], v236 offset:8192
 v_mfma_f32_16x16x32_bf16 v[156:159], v[204:207], v[72:75], v[156:159]
 ds_read_b64_tr_b16 v[198:199], v236 offset:8704
 s_waitcnt lgkmcnt(10)
 v_cvt_pk_bf16_f32 v181, v182, v183
 v_mfma_f32_16x16x32_bf16 v[152:155], v[208:211], v[68:71], v[152:155]
 ds_read_b64_tr_b16 v[200:201], v237 offset:8192
 v_mfma_f32_16x16x32_bf16 v[160:163], v[208:211], v[72:75], v[160:163]
 ds_read_b64_tr_b16 v[202:203], v237 offset:8704
 s_waitcnt lgkmcnt(10)
 v_mfma_f32_16x16x32_bf16 v[132:135], v[212:215], v[76:79], v[132:135]
 ds_read_b64_tr_b16 v[204:205], v238 offset:8192
 v_mfma_f32_16x16x32_bf16 v[140:143], v[212:215], v[80:83], v[140:143]
 ds_read_b64_tr_b16 v[206:207], v238 offset:8704
 s_waitcnt lgkmcnt(10)
 v_cvt_pk_bf16_f32 v182, v184, v185
 v_mfma_f32_16x16x32_bf16 v[136:139], v[216:219], v[76:79], v[136:139]
 ds_read_b64_tr_b16 v[208:209], v239 offset:8192
 v_mfma_f32_16x16x32_bf16 v[144:147], v[216:219], v[80:83], v[144:147]
 ds_read_b64_tr_b16 v[210:211], v239 offset:8704
 s_waitcnt lgkmcnt(10)
 v_mfma_f32_16x16x32_bf16 v[148:151], v[220:223], v[76:79], v[148:151]
 ds_read_b64_tr_b16 v[212:213], v236 offset:12288
 v_mfma_f32_16x16x32_bf16 v[156:159], v[220:223], v[80:83], v[156:159]
 ds_read_b64_tr_b16 v[214:215], v236 offset:12800
 s_waitcnt lgkmcnt(10)
 v_cvt_pk_bf16_f32 v183, v186, v187
 v_mfma_f32_16x16x32_bf16 v[152:155], v[224:227], v[76:79], v[152:155]
 ds_read_b64_tr_b16 v[216:217], v237 offset:12288
 v_mfma_f32_16x16x32_bf16 v[160:163], v[224:227], v[80:83], v[160:163]
 ds_read_b64_tr_b16 v[218:219], v237 offset:12800
 s_waitcnt lgkmcnt(10)
 v_mfma_f32_16x16x32_bf16 v[132:135], v[196:199], v[84:87], v[132:135]
 ds_read_b64_tr_b16 v[220:221], v238 offset:12288
 v_mfma_f32_16x16x32_bf16 v[140:143], v[196:199], v[88:91], v[140:143]
 ds_read_b64_tr_b16 v[222:223], v238 offset:12800
 s_waitcnt lgkmcnt(10)
 v_mfma_f32_16x16x32_bf16 v[136:139], v[200:203], v[84:87], v[136:139]
 ds_read_b64_tr_b16 v[224:225], v239 offset:12288
 v_mfma_f32_16x16x32_bf16 v[144:147], v[200:203], v[88:91], v[144:147]
 ds_read_b64_tr_b16 v[226:227], v239 offset:12800
 s_waitcnt lgkmcnt(10)
 buffer_store_dwordx4 v[180:183], v247, s[16:19], s94 offen offset:0 sc1
 v_mfma_f32_16x16x32_bf16 v[148:151], v[204:207], v[84:87], v[148:151]
 ds_read_b64_tr_b16 v[196:197], v236 offset:16384
 v_mfma_f32_16x16x32_bf16 v[156:159], v[204:207], v[88:91], v[156:159]
 ds_read_b64_tr_b16 v[198:199], v236 offset:16896
 s_waitcnt lgkmcnt(10)
 v_mfma_f32_16x16x32_bf16 v[152:155], v[208:211], v[84:87], v[152:155]
 ds_read_b64_tr_b16 v[200:201], v237 offset:16384
 v_mfma_f32_16x16x32_bf16 v[160:163], v[208:211], v[88:91], v[160:163]
 ds_read_b64_tr_b16 v[202:203], v237 offset:16896
 s_waitcnt lgkmcnt(10)
 v_cvt_pk_bf16_f32 v184, v188, v189
 v_mfma_f32_16x16x32_bf16 v[132:135], v[212:215], v[92:95], v[132:135]
 ds_read_b64_tr_b16 v[204:205], v238 offset:16384
 v_mfma_f32_16x16x32_bf16 v[140:143], v[212:215], v[96:99], v[140:143]
 ds_read_b64_tr_b16 v[206:207], v238 offset:16896
 s_waitcnt lgkmcnt(10)
 v_mfma_f32_16x16x32_bf16 v[136:139], v[216:219], v[92:95], v[136:139]
 ds_read_b64_tr_b16 v[208:209], v239 offset:16384
 v_mfma_f32_16x16x32_bf16 v[144:147], v[216:219], v[96:99], v[144:147]
 ds_read_b64_tr_b16 v[210:211], v239 offset:16896
 s_waitcnt lgkmcnt(10)
 v_cvt_pk_bf16_f32 v185, v190, v191
 v_mfma_f32_16x16x32_bf16 v[148:151], v[220:223], v[92:95], v[148:151]
 ds_read_b64_tr_b16 v[212:213], v236 offset:20480
 v_mfma_f32_16x16x32_bf16 v[156:159], v[220:223], v[96:99], v[156:159]
 ds_read_b64_tr_b16 v[214:215], v236 offset:20992
 s_waitcnt lgkmcnt(10)
 v_mfma_f32_16x16x32_bf16 v[152:155], v[224:227], v[92:95], v[152:155]
 ds_read_b64_tr_b16 v[216:217], v237 offset:20480
 v_mfma_f32_16x16x32_bf16 v[160:163], v[224:227], v[96:99], v[160:163]
 ds_read_b64_tr_b16 v[218:219], v237 offset:20992
 s_waitcnt lgkmcnt(10)
 v_cvt_pk_bf16_f32 v186, v192, v193
 v_mfma_f32_16x16x32_bf16 v[132:135], v[196:199], v[100:103], v[132:135]
 ds_read_b64_tr_b16 v[220:221], v238 offset:20480
 v_mfma_f32_16x16x32_bf16 v[140:143], v[196:199], v[104:107], v[140:143]
 ds_read_b64_tr_b16 v[222:223], v238 offset:20992
 s_waitcnt lgkmcnt(10)
 v_mfma_f32_16x16x32_bf16 v[136:139], v[200:203], v[100:103], v[136:139]
 ds_read_b64_tr_b16 v[224:225], v239 offset:20480
 v_mfma_f32_16x16x32_bf16 v[144:147], v[200:203], v[104:107], v[144:147]
 ds_read_b64_tr_b16 v[226:227], v239 offset:20992
 s_waitcnt lgkmcnt(10)
 v_cvt_pk_bf16_f32 v187, v194, v195
 v_mfma_f32_16x16x32_bf16 v[148:151], v[204:207], v[100:103], v[148:151]
 ds_read_b64_tr_b16 v[196:197], v236 offset:24576
 v_mfma_f32_16x16x32_bf16 v[156:159], v[204:207], v[104:107], v[156:159]
 ds_read_b64_tr_b16 v[198:199], v236 offset:25088
 s_waitcnt lgkmcnt(10)
 v_mfma_f32_16x16x32_bf16 v[152:155], v[208:211], v[100:103], v[152:155]
 ds_read_b64_tr_b16 v[200:201], v237 offset:24576
 v_mfma_f32_16x16x32_bf16 v[160:163], v[208:211], v[104:107], v[160:163]
 ds_read_b64_tr_b16 v[202:203], v237 offset:25088
 s_waitcnt lgkmcnt(10)
 buffer_store_dwordx4 v[184:187], v247, s[16:19], s94 offen offset:128 sc1
 v_mfma_f32_16x16x32_bf16 v[132:135], v[212:215], v[108:111], v[132:135]
 ds_read_b64_tr_b16 v[204:205], v238 offset:24576
 v_mfma_f32_16x16x32_bf16 v[140:143], v[212:215], v[112:115], v[140:143]
 ds_read_b64_tr_b16 v[206:207], v238 offset:25088
 s_waitcnt lgkmcnt(10)
 v_mfma_f32_16x16x32_bf16 v[136:139], v[216:219], v[108:111], v[136:139]
 ds_read_b64_tr_b16 v[208:209], v239 offset:24576
 v_mfma_f32_16x16x32_bf16 v[144:147], v[216:219], v[112:115], v[144:147]
 ds_read_b64_tr_b16 v[210:211], v239 offset:25088
 s_waitcnt lgkmcnt(10)
 v_mfma_f32_16x16x32_bf16 v[148:151], v[220:223], v[108:111], v[148:151]
 ds_read_b64_tr_b16 v[212:213], v236 offset:28672
 v_mfma_f32_16x16x32_bf16 v[156:159], v[220:223], v[112:115], v[156:159]
 ds_read_b64_tr_b16 v[214:215], v236 offset:29184
 s_waitcnt lgkmcnt(10)
 v_mfma_f32_16x16x32_bf16 v[152:155], v[224:227], v[108:111], v[152:155]
 ds_read_b64_tr_b16 v[216:217], v237 offset:28672
 v_mfma_f32_16x16x32_bf16 v[160:163], v[224:227], v[112:115], v[160:163]
 ds_read_b64_tr_b16 v[218:219], v237 offset:29184
 s_waitcnt lgkmcnt(10)
 v_mfma_f32_16x16x32_bf16 v[132:135], v[196:199], v[116:119], v[132:135]
 ds_read_b64_tr_b16 v[220:221], v238 offset:28672
 v_mfma_f32_16x16x32_bf16 v[140:143], v[196:199], v[120:123], v[140:143]
 ds_read_b64_tr_b16 v[222:223], v238 offset:29184
 s_waitcnt lgkmcnt(10)
 s_waitcnt vmcnt(3)
 s_barrier
 s_add_u32 m0, s36, 131072
 s_add_u32 s39, s43, 384
 buffer_load_dwordx4 v244, s[8:11], s39 offen offset:0 lds
 s_add_u32 s39, s43, 64896
 buffer_load_dwordx4 v245, s[8:11], s39 offen offset:1024 lds
 s_add_u32 s39, s43, 129408
 buffer_load_dwordx4 v244, s[8:11], s39 offen offset:2048 lds
 s_add_u32 s39, s43, 193920
 buffer_load_dwordx4 v245, s[8:11], s39 offen offset:3072 lds
 v_mov_b32 v251, 0
 ds_read_b32 v252, v251
 ds_read_b64 v[254:255], v251 offset:8
 v_mfma_f32_16x16x32_bf16 v[136:139], v[200:203], v[116:119], v[136:139]
 ds_read_b64_tr_b16 v[224:225], v239 offset:28672
 v_mfma_f32_16x16x32_bf16 v[144:147], v[200:203], v[120:123], v[144:147]
 ds_read_b64_tr_b16 v[226:227], v239 offset:29184
 s_waitcnt lgkmcnt(12)
 v_mfma_f32_16x16x32_bf16 v[148:151], v[204:207], v[116:119], v[148:151]
 ds_read_b64_tr_b16 v[196:197], v236 offset:32768
 v_mfma_f32_16x16x32_bf16 v[156:159], v[204:207], v[120:123], v[156:159]
 ds_read_b64_tr_b16 v[198:199], v236 offset:33280
 s_waitcnt lgkmcnt(12)
 v_mfma_f32_16x16x32_bf16 v[152:155], v[208:211], v[116:119], v[152:155]
 ds_read_b64_tr_b16 v[200:201], v237 offset:32768
 v_mfma_f32_16x16x32_bf16 v[160:163], v[208:211], v[120:123], v[160:163]
 ds_read_b64_tr_b16 v[202:203], v237 offset:33280
 s_waitcnt lgkmcnt(12)
 v_mfma_f32_16x16x32_bf16 v[132:135], v[212:215], v[124:127], v[132:135]
 ds_read_b64_tr_b16 v[204:205], v238 offset:32768
 v_mfma_f32_16x16x32_bf16 v[140:143], v[212:215], v[128:131], v[140:143]
 ds_read_b64_tr_b16 v[206:207], v238 offset:33280
 s_waitcnt lgkmcnt(12)
 v_mfma_f32_16x16x32_bf16 v[136:139], v[216:219], v[124:127], v[136:139]
 ds_read_b64_tr_b16 v[208:209], v239 offset:32768
 v_mfma_f32_16x16x32_bf16 v[144:147], v[216:219], v[128:131], v[144:147]
 ds_read_b64_tr_b16 v[210:211], v239 offset:33280
 s_waitcnt lgkmcnt(12)
 v_mfma_f32_16x16x32_bf16 v[148:151], v[220:223], v[124:127], v[148:151]
 ds_read_b64_tr_b16 v[212:213], v236 offset:36864
 v_mfma_f32_16x16x32_bf16 v[156:159], v[220:223], v[128:131], v[156:159]
 ds_read_b64_tr_b16 v[214:215], v236 offset:37376
 s_waitcnt lgkmcnt(10)
 s_waitcnt lgkmcnt(12)
 s_cmp_eq_u32 s92, 0
 s_cbranch_scc0 KA_NTD0
 v_readfirstlane_b32 s38, v252
 s_mov_b32 s46, 0x2010800
 s_mov_b32 s47, 0xc04030a
 s_lshr_b32 s39, s38, 3
 s_mov_b32 s48, 0x9051810
 s_mov_b32 s49, 0xe061911
 s_cmp_eq_u32 s39, 1
 s_cselect_b64 s[46:47], s[48:49], s[46:47]
 s_mov_b32 s48, 0xb071a12
 s_mov_b32 s49, 0x1c141b13
 s_cmp_eq_u32 s39, 2
 s_cselect_b64 s[46:47], s[48:49], s[46:47]
 s_mov_b32 s48, 0x161d150d
 s_mov_b32 s49, 0x1f170f1e
 s_cmp_eq_u32 s39, 3
 s_cselect_b64 s[46:47], s[48:49], s[46:47]
 s_and_b32 s38, s38, 7
 s_lshl_b32 s38, s38, 3
 s_lshr_b64 s[46:47], s[46:47], s38
 s_and_b32 s46, s46, 31
 s_bfe_u32 s38, s2, 0x10002
 s_xor_b32 s46, s46, s38
 s_lshl_b32 s46, s46, 3
 s_and_b32 s38, s2, 7
 s_or_b32 s46, s46, s38
 s_lshl_b32 s46, s46, 8
 s_or_b32 s93, s46, s2
KA_NTD0:
 s_bfe_u32 s90, s93, 0x3000b
 s_sub_u32 s3, 15, s90
 s_cmp_lt_u32 s32, 4
 s_cselect_b32 s90, s3, s90
 s_lshl_b32 s90, s90, 7
 v_mfma_f32_16x16x32_bf16 v[152:155], v[224:227], v[124:127], v[152:155]
 ds_read_b64_tr_b16 v[216:217], v237 offset:36864
 v_mfma_f32_16x16x32_bf16 v[160:163], v[224:227], v[128:131], v[160:163]
 ds_read_b64_tr_b16 v[218:219], v237 offset:37376
 s_waitcnt lgkmcnt(10)
 buffer_load_dwordx4 v[248:251], v253, s[96:99], s90 offen sc1
 v_mfma_f32_16x16x32_bf16 v[164:167], v[196:199], v[4:7], 0
 ds_read_b64_tr_b16 v[220:221], v238 offset:36864
 v_mfma_f32_16x16x32_bf16 v[172:175], v[196:199], v[8:11], 0
 ds_read_b64_tr_b16 v[222:223], v238 offset:37376
 s_waitcnt lgkmcnt(10)
 v_mfma_f32_16x16x32_bf16 v[168:171], v[200:203], v[4:7], 0
 ds_read_b64_tr_b16 v[224:225], v239 offset:36864
 v_mfma_f32_16x16x32_bf16 v[176:179], v[200:203], v[8:11], 0
 ds_read_b64_tr_b16 v[226:227], v239 offset:37376
 s_waitcnt lgkmcnt(10)
 s_lshr_b32 s54, s55, 2
 s_and_b32 s24, s55, 3
 s_lshr_b32 s77, s93, 8
 s_and_b32 s41, s77, 7
 s_lshl_b32 s41, s41, 2
 s_lshr_b32 s42, s77, 6
 s_add_u32 s25, s41, s42
 s_lshr_b32 s43, s77, 3
 s_and_b32 s43, s43, 7
 s_sub_u32 s26, 15, s43
 s_lshl_b32 s27, s26, 1
 s_add_u32 s27, s27, 2
 s_lshl_b32 s28, s43, 1
 s_add_u32 s28, s28, 2
 s_mov_b32 s29, s27
 s_lshl_b32 s40, s24, 12
 s_lshl_b32 s39, s25, 19
 s_add_u32 s39, s39, s40
 s_cmp_eq_u32 s54, 0
 s_cselect_b32 s26, s26, s43
 s_cselect_b32 s27, s27, s28
 s_mov_b32 s75, s26
 s_lshl_b32 s75, s75, 2
 s_add_u32 s75, s75, s24
 s_lshl_b32 s72, s55, 16
 s_lshl_b32 s41, s25, 8
 s_add_u32 s72, s72, s41
 s_lshl_b32 s74, s55, 11
 s_mul_i32 s76, s75, 90112
 s_mov_b32 s78, s25
 v_mfma_f32_16x16x32_bf16 v[180:183], v[204:207], v[4:7], 0
 ds_read_b64_tr_b16 v[196:197], v236 offset:40960
 v_mfma_f32_16x16x32_bf16 v[188:191], v[204:207], v[8:11], 0
 ds_read_b64_tr_b16 v[198:199], v236 offset:41472
 s_waitcnt lgkmcnt(10)
 s_lshr_b32 s41, s25, 2
 s_and_b32 s42, s25, 3
 s_lshr_b32 s77, s41, 2
 s_xor_b32 s77, s77, s43
 s_and_b32 s77, s77, 1
 s_lshl_b32 s77, s77, 1
 s_add_u32 s37, s42, s77
 s_cmp_eq_u32 s42, 0
 s_cselect_b32 s37, 0, s37
 s_add_u32 s79, s41, 32
 s_and_b32 s41, s41, 3
 s_add_u32 s41, s41, 40
 s_cmp_eq_u32 s42, 0
 s_cselect_b32 s79, s79, s41
 s_cmp_eq_u32 s54, 0
 s_cselect_b32 s41, s78, s79
 s_lshl_b32 s73, s41, 6
 s_mul_i32 s77, s24, 44032
 s_add_u32 s73, s73, s77
 s_cmp_ge_u32 s41, 43
 s_cselect_b32 s73, 0x40000000, s73
 v_mfma_f32_16x16x32_bf16 v[184:187], v[208:211], v[4:7], 0
 ds_read_b64_tr_b16 v[200:201], v237 offset:40960
 v_mfma_f32_16x16x32_bf16 v[192:195], v[208:211], v[8:11], 0
 ds_read_b64_tr_b16 v[202:203], v237 offset:41472
 s_waitcnt lgkmcnt(10)
 s_mov_b32 s60, s6
 s_and_b32 s61, s7, 0xffff
 s_mov_b32 s62, 0x400000
 s_mov_b32 s63, 0x00020000
 s_mov_b32 s8, s4
 s_and_b32 s9, s5, 0xffff
 s_mov_b32 s10, 0x200000
 s_mov_b32 s11, 0x00020000
 s_mov_b32 s31, s39
 s_mov_b32 s33, s39
 s_mov_b32 s35, s40
 s_add_u32 s36, s40, 16384
 s_mov_b32 s32, 3
 s_mov_b32 s64, s52
 s_and_b32 s65, s53, 0xffff
 s_mov_b32 s66, 0x158000
 s_mov_b32 s67, 0x00020000
 v_mfma_f32_16x16x32_bf16 v[164:167], v[212:215], v[12:15], v[164:167]
 ds_read_b64_tr_b16 v[204:205], v238 offset:40960
 v_mfma_f32_16x16x32_bf16 v[172:175], v[212:215], v[16:19], v[172:175]
 ds_read_b64_tr_b16 v[206:207], v238 offset:41472
 s_waitcnt lgkmcnt(10)
 v_lshrrev_b32 v230, 5, v0
 v_lshrrev_b32 v228, 2, v0
 v_and_b32 v229, 3, v0
 v_xor_b32 v229, v229, v230
 v_lshlrev_b32 v229, 4, v229
 v_mul_u32_u24 v228, 2752, v228
 v_add_u32 v245, v228, v229
 v_lshrrev_b32 v229, 3, v0
 v_and_b32 v228, 7, v0
 v_bfe_u32 v230, v0, 4, 1
 v_lshlrev_b32 v230, 2, v230
 v_xor_b32 v230, v230, v228
 s_and_b32 s3, s55, 1
 v_xor_b32 v230, s3, v230
 v_lshlrev_b32 v230, 4, v230
 v_lshl_add_u32 v244, v229, 13, v230
 v_mfma_f32_16x16x32_bf16 v[168:171], v[216:219], v[12:15], v[168:171]
 ds_read_b64_tr_b16 v[208:209], v239 offset:40960
 v_mfma_f32_16x16x32_bf16 v[176:179], v[216:219], v[16:19], v[176:179]
 ds_read_b64_tr_b16 v[210:211], v239 offset:41472
 s_waitcnt lgkmcnt(10)
 s_add_u32 m0, s74, 896
 s_add_u32 s41, s72, 0
 buffer_load_dwordx4 v244, s[60:63], s41 offen offset:128 lds
 s_add_u32 s94, s95, 0x80000
 v_mfma_f32_16x16x32_bf16 v[180:183], v[220:223], v[12:15], v[180:183]
 ds_read_b64_tr_b16 v[212:213], v236 offset:45056
 v_mfma_f32_16x16x32_bf16 v[188:191], v[220:223], v[16:19], v[188:191]
 ds_read_b64_tr_b16 v[214:215], v236 offset:45568
 s_waitcnt lgkmcnt(10)
 v_mfma_f32_16x16x32_bf16 v[184:187], v[224:227], v[12:15], v[184:187]
 ds_read_b64_tr_b16 v[216:217], v237 offset:45056
 v_mfma_f32_16x16x32_bf16 v[192:195], v[224:227], v[16:19], v[192:195]
 ds_read_b64_tr_b16 v[218:219], v237 offset:45568
 s_waitcnt lgkmcnt(10)
 v_cvt_pk_bf16_f32 v132, v132, v133
 v_mfma_f32_16x16x32_bf16 v[164:167], v[196:199], v[20:23], v[164:167]
 ds_read_b64_tr_b16 v[220:221], v238 offset:45056
 v_mfma_f32_16x16x32_bf16 v[172:175], v[196:199], v[24:27], v[172:175]
 ds_read_b64_tr_b16 v[222:223], v238 offset:45568
 s_waitcnt lgkmcnt(10)
 v_mfma_f32_16x16x32_bf16 v[168:171], v[200:203], v[20:23], v[168:171]
 ds_read_b64_tr_b16 v[224:225], v239 offset:45056
 v_mfma_f32_16x16x32_bf16 v[176:179], v[200:203], v[24:27], v[176:179]
 ds_read_b64_tr_b16 v[226:227], v239 offset:45568
 s_waitcnt lgkmcnt(10)
 s_lshr_b32 s41, s74, 1
 s_add_u32 m0, s41, 16384
 s_add_u32 s41, s73, 0
 buffer_load_dwordx4 v245, s[64:67], s41 offen lds
 v_cvt_pk_bf16_f32 v133, v134, v135
 v_mfma_f32_16x16x32_bf16 v[180:183], v[204:207], v[20:23], v[180:183]
 ds_read_b64_tr_b16 v[196:197], v236 offset:49152
 v_mfma_f32_16x16x32_bf16 v[188:191], v[204:207], v[24:27], v[188:191]
 ds_read_b64_tr_b16 v[198:199], v236 offset:49664
 s_waitcnt lgkmcnt(10)
 v_cvt_pk_bf16_f32 v134, v136, v137
 v_mfma_f32_16x16x32_bf16 v[184:187], v[208:211], v[20:23], v[184:187]
 ds_read_b64_tr_b16 v[200:201], v237 offset:49152
 v_mfma_f32_16x16x32_bf16 v[192:195], v[208:211], v[24:27], v[192:195]
 ds_read_b64_tr_b16 v[202:203], v237 offset:49664
 s_waitcnt lgkmcnt(10)
 v_mfma_f32_16x16x32_bf16 v[164:167], v[212:215], v[28:31], v[164:167]
 ds_read_b64_tr_b16 v[204:205], v238 offset:49152
 v_mfma_f32_16x16x32_bf16 v[172:175], v[212:215], v[32:35], v[172:175]
 ds_read_b64_tr_b16 v[206:207], v238 offset:49664
 s_waitcnt lgkmcnt(10)
 v_cvt_pk_bf16_f32 v135, v138, v139
 v_mfma_f32_16x16x32_bf16 v[168:171], v[216:219], v[28:31], v[168:171]
 ds_read_b64_tr_b16 v[208:209], v239 offset:49152
 v_mfma_f32_16x16x32_bf16 v[176:179], v[216:219], v[32:35], v[176:179]
 ds_read_b64_tr_b16 v[210:211], v239 offset:49664
 s_waitcnt lgkmcnt(10)
 s_add_u32 m0, s74, 24576
 s_add_u32 s41, s72, 524288
 buffer_load_dwordx4 v244, s[60:63], s41 offen offset:0 lds
 v_mfma_f32_16x16x32_bf16 v[180:183], v[220:223], v[28:31], v[180:183]
 ds_read_b64_tr_b16 v[212:213], v236 offset:53248
 v_mfma_f32_16x16x32_bf16 v[188:191], v[220:223], v[32:35], v[188:191]
 ds_read_b64_tr_b16 v[214:215], v236 offset:53760
 s_waitcnt lgkmcnt(10)
 buffer_store_dwordx4 v[132:135], v247, s[16:19], s94 offen offset:0 sc1
 v_mfma_f32_16x16x32_bf16 v[184:187], v[224:227], v[28:31], v[184:187]
 ds_read_b64_tr_b16 v[216:217], v237 offset:53248
 v_mfma_f32_16x16x32_bf16 v[192:195], v[224:227], v[32:35], v[192:195]
 ds_read_b64_tr_b16 v[218:219], v237 offset:53760
 s_waitcnt lgkmcnt(10)
 v_mfma_f32_16x16x32_bf16 v[164:167], v[196:199], v[36:39], v[164:167]
 ds_read_b64_tr_b16 v[220:221], v238 offset:53248
 v_mfma_f32_16x16x32_bf16 v[172:175], v[196:199], v[40:43], v[172:175]
 ds_read_b64_tr_b16 v[222:223], v238 offset:53760
 s_waitcnt lgkmcnt(10)
 v_cvt_pk_bf16_f32 v136, v140, v141
 v_mfma_f32_16x16x32_bf16 v[168:171], v[200:203], v[36:39], v[168:171]
 ds_read_b64_tr_b16 v[224:225], v239 offset:53248
 v_mfma_f32_16x16x32_bf16 v[176:179], v[200:203], v[40:43], v[176:179]
 ds_read_b64_tr_b16 v[226:227], v239 offset:53760
 s_waitcnt lgkmcnt(10)
 s_add_u32 m0, s74, 25472
 s_add_u32 s41, s72, 524288
 buffer_load_dwordx4 v244, s[60:63], s41 offen offset:128 lds
 v_cvt_pk_bf16_f32 v137, v142, v143
 v_mfma_f32_16x16x32_bf16 v[180:183], v[204:207], v[36:39], v[180:183]
 ds_read_b64_tr_b16 v[196:197], v236 offset:57344
 v_mfma_f32_16x16x32_bf16 v[188:191], v[204:207], v[40:43], v[188:191]
 ds_read_b64_tr_b16 v[198:199], v236 offset:57856
 s_waitcnt lgkmcnt(10)
 v_mfma_f32_16x16x32_bf16 v[184:187], v[208:211], v[36:39], v[184:187]
 ds_read_b64_tr_b16 v[200:201], v237 offset:57344
 v_mfma_f32_16x16x32_bf16 v[192:195], v[208:211], v[40:43], v[192:195]
 ds_read_b64_tr_b16 v[202:203], v237 offset:57856
 s_waitcnt lgkmcnt(10)
 v_cvt_pk_bf16_f32 v138, v144, v145
 v_mfma_f32_16x16x32_bf16 v[164:167], v[212:215], v[44:47], v[164:167]
 ds_read_b64_tr_b16 v[204:205], v238 offset:57344
 v_mfma_f32_16x16x32_bf16 v[172:175], v[212:215], v[48:51], v[172:175]
 ds_read_b64_tr_b16 v[206:207], v238 offset:57856
 s_waitcnt lgkmcnt(10)
 v_mfma_f32_16x16x32_bf16 v[168:171], v[216:219], v[44:47], v[168:171]
 ds_read_b64_tr_b16 v[208:209], v239 offset:57344
 v_mfma_f32_16x16x32_bf16 v[176:179], v[216:219], v[48:51], v[176:179]
 ds_read_b64_tr_b16 v[210:211], v239 offset:57856
 s_waitcnt lgkmcnt(10)
 s_lshr_b32 s41, s74, 1
 s_add_u32 m0, s41, 40960
 s_add_u32 s41, s73, 176128
 buffer_load_dwordx4 v245, s[64:67], s41 offen lds
 v_cvt_pk_bf16_f32 v139, v146, v147
 v_mfma_f32_16x16x32_bf16 v[180:183], v[220:223], v[44:47], v[180:183]
 ds_read_b64_tr_b16 v[212:213], v236 offset:61440
 v_mfma_f32_16x16x32_bf16 v[188:191], v[220:223], v[48:51], v[188:191]
 ds_read_b64_tr_b16 v[214:215], v236 offset:61952
 s_waitcnt lgkmcnt(10)
 buffer_store_dwordx4 v[136:139], v247, s[16:19], s94 offen offset:128 sc1
 v_mfma_f32_16x16x32_bf16 v[184:187], v[224:227], v[44:47], v[184:187]
 ds_read_b64_tr_b16 v[216:217], v237 offset:61440
 v_mfma_f32_16x16x32_bf16 v[192:195], v[224:227], v[48:51], v[192:195]
 ds_read_b64_tr_b16 v[218:219], v237 offset:61952
 s_waitcnt lgkmcnt(10)
 v_mfma_f32_16x16x32_bf16 v[164:167], v[196:199], v[52:55], v[164:167]
 ds_read_b64_tr_b16 v[220:221], v238 offset:61440
 v_mfma_f32_16x16x32_bf16 v[172:175], v[196:199], v[56:59], v[172:175]
 ds_read_b64_tr_b16 v[222:223], v238 offset:61952
 s_waitcnt lgkmcnt(10)
 s_add_u32 s94, s95, 0x80800
 s_waitcnt vmcnt(8)
 s_barrier
 v_mfma_f32_16x16x32_bf16 v[168:171], v[200:203], v[52:55], v[168:171]
 ds_read_b64_tr_b16 v[224:225], v239 offset:61440
 v_mfma_f32_16x16x32_bf16 v[176:179], v[200:203], v[56:59], v[176:179]
 ds_read_b64_tr_b16 v[226:227], v239 offset:61952
 s_waitcnt lgkmcnt(10)
 v_mfma_f32_16x16x32_bf16 v[180:183], v[204:207], v[52:55], v[180:183]
 ds_read_b64_tr_b16 v[196:197], v240 offset:0
 v_mfma_f32_16x16x32_bf16 v[188:191], v[204:207], v[56:59], v[188:191]
 ds_read_b64_tr_b16 v[198:199], v240 offset:512
 s_waitcnt lgkmcnt(10)
 s_add_u32 m0, s74, 0
 s_add_u32 s41, s72, 0
 buffer_load_dwordx4 v244, s[60:63], s41 offen offset:0 lds
 v_cvt_pk_bf16_f32 v148, v148, v149
 v_mfma_f32_16x16x32_bf16 v[184:187], v[208:211], v[52:55], v[184:187]
 ds_read_b64_tr_b16 v[200:201], v241 offset:0
 v_mfma_f32_16x16x32_bf16 v[192:195], v[208:211], v[56:59], v[192:195]
 ds_read_b64_tr_b16 v[202:203], v241 offset:512
 s_waitcnt lgkmcnt(10)
 v_mfma_f32_16x16x32_bf16 v[164:167], v[212:215], v[60:63], v[164:167]
 ds_read_b64_tr_b16 v[204:205], v242 offset:0
 v_mfma_f32_16x16x32_bf16 v[172:175], v[212:215], v[64:67], v[172:175]
 ds_read_b64_tr_b16 v[206:207], v242 offset:512
 s_waitcnt lgkmcnt(10)
 v_cvt_pk_bf16_f32 v149, v150, v151
 v_mfma_f32_16x16x32_bf16 v[168:171], v[216:219], v[60:63], v[168:171]
 ds_read_b64_tr_b16 v[208:209], v243 offset:0
 v_mfma_f32_16x16x32_bf16 v[176:179], v[216:219], v[64:67], v[176:179]
 ds_read_b64_tr_b16 v[210:211], v243 offset:512
 s_waitcnt lgkmcnt(10)
 v_cvt_pk_bf16_f32 v150, v152, v153
 v_mfma_f32_16x16x32_bf16 v[180:183], v[220:223], v[60:63], v[180:183]
 ds_read_b64_tr_b16 v[212:213], v240 offset:4096
 v_mfma_f32_16x16x32_bf16 v[188:191], v[220:223], v[64:67], v[188:191]
 ds_read_b64_tr_b16 v[214:215], v240 offset:4608
 s_waitcnt lgkmcnt(10)
 v_mfma_f32_16x16x32_bf16 v[184:187], v[224:227], v[60:63], v[184:187]
 ds_read_b64_tr_b16 v[216:217], v241 offset:4096
 v_mfma_f32_16x16x32_bf16 v[192:195], v[224:227], v[64:67], v[192:195]
 ds_read_b64_tr_b16 v[218:219], v241 offset:4608
 s_waitcnt lgkmcnt(10)
 v_cvt_pk_bf16_f32 v151, v154, v155
 v_mfma_f32_16x16x32_bf16 v[164:167], v[196:199], v[68:71], v[164:167]
 ds_read_b64_tr_b16 v[220:221], v242 offset:4096
 v_mfma_f32_16x16x32_bf16 v[172:175], v[196:199], v[72:75], v[172:175]
 ds_read_b64_tr_b16 v[222:223], v242 offset:4608
 s_waitcnt lgkmcnt(10)
 v_lshrrev_b32 v24, 5, v0
 v_lshrrev_b32 v20, 2, v0
 v_and_b32 v21, 3, v0
 v_xor_b32 v21, v21, v24
 v_lshlrev_b32 v21, 4, v21
 v_lshl_add_u32 v16, v20, 13, v21
 v_mul_u32_u24 v20, 2752, v20
 v_add_u32 v17, v20, v21
 v_lshrrev_b32 v22, 4, v0
 v_bfe_u32 v20, v0, 2, 2
 v_lshl_add_u32 v23, v22, 3, v20
 v_lshlrev_b32 v23, 6, v23
 v_and_b32 v21, 1, v0
 v_lshl_add_u32 v23, v21, 3, v23
 v_bfe_u32 v21, v0, 1, 1
 v_lshl_add_u32 v23, v21, 5, v23
 v_and_b32 v21, 1, v22
 v_lshl_add_u32 v12, v21, 4, v23
 v_xor_b32 v13, 16, v12
 v_lshlrev_b32 v18, 10, v24
 v_lshl_add_u32 v18, v21, 9, v18
 v_bfe_u32 v20, v0, 3, 1
 v_lshl_add_u32 v18, v20, 8, v18
 v_and_b32 v20, 7, v0
 v_lshl_add_u32 v18, v20, 4, v18
 v_lshrrev_b32 v21, 3, v0
 v_and_b32 v20, 7, v0
 v_mfma_f32_16x16x32_bf16 v[168:171], v[200:203], v[68:71], v[168:171]
 ds_read_b64_tr_b16 v[224:225], v243 offset:4096
 v_mfma_f32_16x16x32_bf16 v[176:179], v[200:203], v[72:75], v[176:179]
 ds_read_b64_tr_b16 v[226:227], v243 offset:4608
 s_waitcnt lgkmcnt(10)
 v_bfe_u32 v22, v0, 4, 1
 v_lshlrev_b32 v22, 2, v22
 v_xor_b32 v22, v22, v20
 s_and_b32 s3, s55, 1
 v_xor_b32 v22, s3, v22
 v_lshlrev_b32 v22, 4, v22
 v_lshl_add_u32 v16, v21, 13, v22
 s_lshl_b32 s34, s55, 13
 s_add_u32 s34, s34, 98304
 s_cmp_eq_u32 s55, 7
 s_cselect_b32 s34, 0x10000, s34
 v_add_u32 v19, s34, v18
 buffer_store_dwordx4 v[148:151], v247, s[16:19], s94 offen offset:0 sc1
 v_mfma_f32_16x16x32_bf16 v[180:183], v[204:207], v[68:71], v[180:183]
 ds_read_b64_tr_b16 v[196:197], v240 offset:8192
 v_mfma_f32_16x16x32_bf16 v[188:191], v[204:207], v[72:75], v[188:191]
 ds_read_b64_tr_b16 v[198:199], v240 offset:8704
 s_waitcnt lgkmcnt(10)
 v_mfma_f32_16x16x32_bf16 v[184:187], v[208:211], v[68:71], v[184:187]
 ds_read_b64_tr_b16 v[200:201], v241 offset:8192
 v_mfma_f32_16x16x32_bf16 v[192:195], v[208:211], v[72:75], v[192:195]
 ds_read_b64_tr_b16 v[202:203], v241 offset:8704
 s_waitcnt lgkmcnt(10)
 v_cvt_pk_bf16_f32 v152, v156, v157
 v_mfma_f32_16x16x32_bf16 v[164:167], v[212:215], v[76:79], v[164:167]
 ds_read_b64_tr_b16 v[204:205], v242 offset:8192
 v_mfma_f32_16x16x32_bf16 v[172:175], v[212:215], v[80:83], v[172:175]
 ds_read_b64_tr_b16 v[206:207], v242 offset:8704
 s_waitcnt lgkmcnt(10)
 v_cvt_pk_bf16_f32 v153, v158, v159
 v_mfma_f32_16x16x32_bf16 v[168:171], v[216:219], v[76:79], v[168:171]
 ds_read_b64_tr_b16 v[208:209], v243 offset:8192
 v_mfma_f32_16x16x32_bf16 v[176:179], v[216:219], v[80:83], v[176:179]
 ds_read_b64_tr_b16 v[210:211], v243 offset:8704
 s_waitcnt lgkmcnt(10)
 v_mfma_f32_16x16x32_bf16 v[180:183], v[220:223], v[76:79], v[180:183]
 ds_read_b64_tr_b16 v[212:213], v240 offset:12288
 v_mfma_f32_16x16x32_bf16 v[188:191], v[220:223], v[80:83], v[188:191]
 ds_read_b64_tr_b16 v[214:215], v240 offset:12800
 s_waitcnt lgkmcnt(10)
 v_cvt_pk_bf16_f32 v154, v160, v161
 v_mfma_f32_16x16x32_bf16 v[184:187], v[224:227], v[76:79], v[184:187]
 ds_read_b64_tr_b16 v[216:217], v241 offset:12288
 v_mfma_f32_16x16x32_bf16 v[192:195], v[224:227], v[80:83], v[192:195]
 ds_read_b64_tr_b16 v[218:219], v241 offset:12800
 s_waitcnt lgkmcnt(10)
 v_mfma_f32_16x16x32_bf16 v[164:167], v[196:199], v[84:87], v[164:167]
 ds_read_b64_tr_b16 v[220:221], v242 offset:12288
 v_mfma_f32_16x16x32_bf16 v[172:175], v[196:199], v[88:91], v[172:175]
 ds_read_b64_tr_b16 v[222:223], v242 offset:12800
 s_waitcnt lgkmcnt(10)
 v_cvt_pk_bf16_f32 v155, v162, v163
 v_mfma_f32_16x16x32_bf16 v[168:171], v[200:203], v[84:87], v[168:171]
 ds_read_b64_tr_b16 v[224:225], v243 offset:12288
 v_mfma_f32_16x16x32_bf16 v[176:179], v[200:203], v[88:91], v[176:179]
 ds_read_b64_tr_b16 v[226:227], v243 offset:12800
 s_waitcnt lgkmcnt(10)
 buffer_store_dwordx4 v[152:155], v247, s[16:19], s94 offen offset:128 sc1
 v_mfma_f32_16x16x32_bf16 v[180:183], v[204:207], v[84:87], v[180:183]
 ds_read_b64_tr_b16 v[196:197], v240 offset:16384
 v_mfma_f32_16x16x32_bf16 v[188:191], v[204:207], v[88:91], v[188:191]
 ds_read_b64_tr_b16 v[198:199], v240 offset:16896
 s_waitcnt lgkmcnt(10)
 v_mfma_f32_16x16x32_bf16 v[184:187], v[208:211], v[84:87], v[184:187]
 ds_read_b64_tr_b16 v[200:201], v241 offset:16384
 v_mfma_f32_16x16x32_bf16 v[192:195], v[208:211], v[88:91], v[192:195]
 ds_read_b64_tr_b16 v[202:203], v241 offset:16896
 s_waitcnt lgkmcnt(10)
 v_lshrrev_b32 v22, 4, v0
 v_bfe_u32 v20, v0, 2, 2
 v_lshl_add_u32 v23, v22, 4, v20
 v_lshlrev_b32 v23, 7, v23
 v_and_b32 v21, 1, v0
 v_lshl_add_u32 v23, v21, 3, v23
 v_bfe_u32 v21, v0, 1, 1
 v_lshl_add_u32 v23, v21, 5, v23
 v_bfe_u32 v21, v0, 3, 1
 v_lshl_add_u32 v23, v21, 6, v23
 v_and_b32 v21, 1, v22
 v_lshl_add_u32 v4, v21, 4, v23
 v_xor_b32 v5, 16, v4
 v_xor_b32 v6, 64, v4
 v_xor_b32 v7, 80, v4
 v_add_u32 v8, 0xc000, v4
 v_add_u32 v9, 0xc000, v5
 v_add_u32 v10, 0xc000, v6
 v_add_u32 v11, 0xc000, v7
 v_add_u32 v12, 0x4000, v12
 v_add_u32 v14, 0xc000, v12
 v_add_u32 v13, 0x4000, v13
 v_add_u32 v15, 0xc000, v13
 v_mfma_f32_16x16x32_bf16 v[164:167], v[212:215], v[92:95], v[164:167]
 ds_read_b64_tr_b16 v[204:205], v242 offset:16384
 v_mfma_f32_16x16x32_bf16 v[172:175], v[212:215], v[96:99], v[172:175]
 ds_read_b64_tr_b16 v[206:207], v242 offset:16896
 s_waitcnt lgkmcnt(10)
 s_waitcnt vmcnt(10)
 s_cmp_lg_u32 s92, 0
 s_cbranch_scc1 KB_SQX0
 s_mov_b32 s77, 4096
KB_SPX0:
 v_cmp_ne_u64 vcc, v[248:249], v[254:255]
 v_cmp_ne_u64 s[46:47], v[250:251], v[254:255]
 s_or_b64 s[46:47], vcc, s[46:47]
 s_cbranch_scc0 KB_SQX0
 s_sleep 2
 buffer_load_dwordx4 v[248:251], v253, s[96:99], s90 offen sc1
 s_sub_u32 s77, s77, 1
 s_cmp_eq_u32 s77, 0
 s_waitcnt vmcnt(0)
 s_cbranch_scc0 KB_SPX0
 s_mov_b32 s101, 1
KB_SQX0:
 s_lshl_b32 s42, s75, 15
 s_add_u32 s42, s42, 0
 buffer_load_dwordx4 v[132:135], v246, s[8:11], s42 offen offset:0 sc1
 v_mfma_f32_16x16x32_bf16 v[168:171], v[216:219], v[92:95], v[168:171]
 ds_read_b64_tr_b16 v[208:209], v243 offset:16384
 v_mfma_f32_16x16x32_bf16 v[176:179], v[216:219], v[96:99], v[176:179]
 ds_read_b64_tr_b16 v[210:211], v243 offset:16896
 s_waitcnt lgkmcnt(10)
 buffer_load_dwordx4 v[136:139], v246, s[8:11], s42 offen offset:1024 sc1
 v_mfma_f32_16x16x32_bf16 v[180:183], v[220:223], v[92:95], v[180:183]
 ds_read_b64_tr_b16 v[212:213], v240 offset:20480
 v_mfma_f32_16x16x32_bf16 v[188:191], v[220:223], v[96:99], v[188:191]
 ds_read_b64_tr_b16 v[214:215], v240 offset:20992
 s_waitcnt lgkmcnt(10)
 buffer_load_dwordx4 v[140:143], v246, s[8:11], s42 offen offset:2048 sc1
 v_mfma_f32_16x16x32_bf16 v[184:187], v[224:227], v[92:95], v[184:187]
 ds_read_b64_tr_b16 v[216:217], v241 offset:20480
 v_mfma_f32_16x16x32_bf16 v[192:195], v[224:227], v[96:99], v[192:195]
 ds_read_b64_tr_b16 v[218:219], v241 offset:20992
 s_waitcnt lgkmcnt(10)
 buffer_load_dwordx4 v[144:147], v246, s[8:11], s42 offen offset:3072 sc1
 v_mfma_f32_16x16x32_bf16 v[164:167], v[196:199], v[100:103], v[164:167]
 ds_read_b64_tr_b16 v[220:221], v242 offset:20480
 v_mfma_f32_16x16x32_bf16 v[172:175], v[196:199], v[104:107], v[172:175]
 ds_read_b64_tr_b16 v[222:223], v242 offset:20992
 s_waitcnt lgkmcnt(10)
 s_lshl_b32 s42, s75, 15
 s_add_u32 s42, s42, 4096
 buffer_load_dwordx4 v[148:151], v246, s[8:11], s42 offen offset:0 sc1
 v_mfma_f32_16x16x32_bf16 v[168:171], v[200:203], v[100:103], v[168:171]
 ds_read_b64_tr_b16 v[224:225], v243 offset:20480
 v_mfma_f32_16x16x32_bf16 v[176:179], v[200:203], v[104:107], v[176:179]
 ds_read_b64_tr_b16 v[226:227], v243 offset:20992
 s_waitcnt lgkmcnt(10)
 buffer_load_dwordx4 v[152:155], v246, s[8:11], s42 offen offset:1024 sc1
 v_mfma_f32_16x16x32_bf16 v[180:183], v[204:207], v[100:103], v[180:183]
 ds_read_b64_tr_b16 v[196:197], v240 offset:24576
 v_mfma_f32_16x16x32_bf16 v[188:191], v[204:207], v[104:107], v[188:191]
 ds_read_b64_tr_b16 v[198:199], v240 offset:25088
 s_waitcnt lgkmcnt(10)
 buffer_load_dwordx4 v[156:159], v246, s[8:11], s42 offen offset:2048 sc1
 v_mfma_f32_16x16x32_bf16 v[184:187], v[208:211], v[100:103], v[184:187]
 ds_read_b64_tr_b16 v[200:201], v241 offset:24576
 v_mfma_f32_16x16x32_bf16 v[192:195], v[208:211], v[104:107], v[192:195]
 ds_read_b64_tr_b16 v[202:203], v241 offset:25088
 s_waitcnt lgkmcnt(10)
 buffer_load_dwordx4 v[160:163], v246, s[8:11], s42 offen offset:3072 sc1
 v_mfma_f32_16x16x32_bf16 v[164:167], v[212:215], v[108:111], v[164:167]
 ds_read_b64_tr_b16 v[204:205], v242 offset:24576
 v_mfma_f32_16x16x32_bf16 v[172:175], v[212:215], v[112:115], v[172:175]
 ds_read_b64_tr_b16 v[206:207], v242 offset:25088
 s_waitcnt lgkmcnt(10)
 v_mfma_f32_16x16x32_bf16 v[168:171], v[216:219], v[108:111], v[168:171]
 ds_read_b64_tr_b16 v[208:209], v243 offset:24576
 v_mfma_f32_16x16x32_bf16 v[176:179], v[216:219], v[112:115], v[176:179]
 ds_read_b64_tr_b16 v[210:211], v243 offset:25088
 s_waitcnt lgkmcnt(10)
 v_mfma_f32_16x16x32_bf16 v[180:183], v[220:223], v[108:111], v[180:183]
 ds_read_b64_tr_b16 v[212:213], v240 offset:28672
 v_mfma_f32_16x16x32_bf16 v[188:191], v[220:223], v[112:115], v[188:191]
 ds_read_b64_tr_b16 v[214:215], v240 offset:29184
 s_waitcnt lgkmcnt(10)
 v_mfma_f32_16x16x32_bf16 v[184:187], v[224:227], v[108:111], v[184:187]
 ds_read_b64_tr_b16 v[216:217], v241 offset:28672
 v_mfma_f32_16x16x32_bf16 v[192:195], v[224:227], v[112:115], v[192:195]
 ds_read_b64_tr_b16 v[218:219], v241 offset:29184
 s_waitcnt lgkmcnt(10)
 v_mfma_f32_16x16x32_bf16 v[164:167], v[196:199], v[116:119], v[164:167]
 ds_read_b64_tr_b16 v[220:221], v242 offset:28672
 v_mfma_f32_16x16x32_bf16 v[172:175], v[196:199], v[120:123], v[172:175]
 ds_read_b64_tr_b16 v[222:223], v242 offset:29184
 s_waitcnt lgkmcnt(10)
 v_mfma_f32_16x16x32_bf16 v[168:171], v[200:203], v[116:119], v[168:171]
 ds_read_b64_tr_b16 v[224:225], v243 offset:28672
 v_mfma_f32_16x16x32_bf16 v[176:179], v[200:203], v[120:123], v[176:179]
 ds_read_b64_tr_b16 v[226:227], v243 offset:29184
 s_waitcnt lgkmcnt(10)
 v_mfma_f32_16x16x32_bf16 v[180:183], v[204:207], v[116:119], v[180:183]
 v_mfma_f32_16x16x32_bf16 v[188:191], v[204:207], v[120:123], v[188:191]
 s_waitcnt lgkmcnt(8)
 v_mfma_f32_16x16x32_bf16 v[184:187], v[208:211], v[116:119], v[184:187]
 v_mfma_f32_16x16x32_bf16 v[192:195], v[208:211], v[120:123], v[192:195]
 s_waitcnt lgkmcnt(6)
 v_mfma_f32_16x16x32_bf16 v[164:167], v[212:215], v[124:127], v[164:167]
 v_mfma_f32_16x16x32_bf16 v[172:175], v[212:215], v[128:131], v[172:175]
 s_waitcnt lgkmcnt(4)
 v_mfma_f32_16x16x32_bf16 v[168:171], v[216:219], v[124:127], v[168:171]
 v_mfma_f32_16x16x32_bf16 v[176:179], v[216:219], v[128:131], v[176:179]
 s_waitcnt lgkmcnt(2)
 v_mfma_f32_16x16x32_bf16 v[180:183], v[220:223], v[124:127], v[180:183]
 v_mfma_f32_16x16x32_bf16 v[188:191], v[220:223], v[128:131], v[188:191]
 s_waitcnt lgkmcnt(0)
 v_mfma_f32_16x16x32_bf16 v[184:187], v[224:227], v[124:127], v[184:187]
 v_mfma_f32_16x16x32_bf16 v[192:195], v[224:227], v[128:131], v[192:195]
 s_add_u32 s94, s95, 0x81000
 v_cvt_pk_bf16_f32 v164, v164, v165
 v_cvt_pk_bf16_f32 v165, v166, v167
 v_cvt_pk_bf16_f32 v166, v168, v169
 v_cvt_pk_bf16_f32 v167, v170, v171
 buffer_store_dwordx4 v[164:167], v247, s[16:19], s94 offen offset:0 sc1
 v_cvt_pk_bf16_f32 v168, v172, v173
 v_cvt_pk_bf16_f32 v169, v174, v175
 v_cvt_pk_bf16_f32 v170, v176, v177
 v_cvt_pk_bf16_f32 v171, v178, v179
 buffer_store_dwordx4 v[168:171], v247, s[16:19], s94 offen offset:128 sc1
 s_add_u32 s94, s95, 0x81800
 v_cvt_pk_bf16_f32 v180, v180, v181
 v_cvt_pk_bf16_f32 v181, v182, v183
 v_cvt_pk_bf16_f32 v182, v184, v185
 v_cvt_pk_bf16_f32 v183, v186, v187
 buffer_store_dwordx4 v[180:183], v247, s[16:19], s94 offen offset:0 sc1
 v_cvt_pk_bf16_f32 v184, v188, v189
 v_cvt_pk_bf16_f32 v185, v190, v191
 v_cvt_pk_bf16_f32 v186, v192, v193
 v_cvt_pk_bf16_f32 v187, v194, v195
 buffer_store_dwordx4 v[184:187], v247, s[16:19], s94 offen offset:128 sc1
 s_branch KA_FIN
KA_V1:
 v_mfma_f32_16x16x32_bf16 v[132:135], v[4:7], v[196:199], 0
 ds_read_b64_tr_b16 v[220:221], v238 offset:4096
 v_mfma_f32_16x16x32_bf16 v[136:139], v[8:11], v[196:199], 0
 ds_read_b64_tr_b16 v[222:223], v238 offset:4608
 s_waitcnt lgkmcnt(10)
 v_mfma_f32_16x16x32_bf16 v[140:143], v[4:7], v[200:203], 0
 ds_read_b64_tr_b16 v[224:225], v239 offset:4096
 v_mfma_f32_16x16x32_bf16 v[144:147], v[8:11], v[200:203], 0
 ds_read_b64_tr_b16 v[226:227], v239 offset:4608
 s_waitcnt lgkmcnt(10)
 v_mfma_f32_16x16x32_bf16 v[148:151], v[4:7], v[204:207], 0
 ds_read_b64_tr_b16 v[196:197], v236 offset:8192
 v_mfma_f32_16x16x32_bf16 v[152:155], v[8:11], v[204:207], 0
 ds_read_b64_tr_b16 v[198:199], v236 offset:8704
 s_waitcnt lgkmcnt(10)
 v_mfma_f32_16x16x32_bf16 v[156:159], v[4:7], v[208:211], 0
 ds_read_b64_tr_b16 v[200:201], v237 offset:8192
 v_mfma_f32_16x16x32_bf16 v[160:163], v[8:11], v[208:211], 0
 ds_read_b64_tr_b16 v[202:203], v237 offset:8704
 s_waitcnt lgkmcnt(10)
 v_mfma_f32_16x16x32_bf16 v[132:135], v[12:15], v[212:215], v[132:135]
 ds_read_b64_tr_b16 v[204:205], v238 offset:8192
 v_mfma_f32_16x16x32_bf16 v[136:139], v[16:19], v[212:215], v[136:139]
 ds_read_b64_tr_b16 v[206:207], v238 offset:8704
 s_waitcnt lgkmcnt(10)
 v_mfma_f32_16x16x32_bf16 v[140:143], v[12:15], v[216:219], v[140:143]
 ds_read_b64_tr_b16 v[208:209], v239 offset:8192
 v_mfma_f32_16x16x32_bf16 v[144:147], v[16:19], v[216:219], v[144:147]
 ds_read_b64_tr_b16 v[210:211], v239 offset:8704
 s_waitcnt lgkmcnt(10)
 v_mfma_f32_16x16x32_bf16 v[148:151], v[12:15], v[220:223], v[148:151]
 ds_read_b64_tr_b16 v[212:213], v236 offset:12288
 v_mfma_f32_16x16x32_bf16 v[152:155], v[16:19], v[220:223], v[152:155]
 ds_read_b64_tr_b16 v[214:215], v236 offset:12800
 s_waitcnt lgkmcnt(10)
 v_mfma_f32_16x16x32_bf16 v[156:159], v[12:15], v[224:227], v[156:159]
 ds_read_b64_tr_b16 v[216:217], v237 offset:12288
 v_mfma_f32_16x16x32_bf16 v[160:163], v[16:19], v[224:227], v[160:163]
 ds_read_b64_tr_b16 v[218:219], v237 offset:12800
 s_waitcnt lgkmcnt(10)
 s_waitcnt vmcnt(9)
 ds_read_b128 v[36:39], v164 offset:0
 ds_read_b128 v[40:43], v164 offset:1024
 ds_read_b128 v[44:47], v165 offset:0
 ds_read_b128 v[48:51], v165 offset:1024
 v_mfma_f32_16x16x32_bf16 v[132:135], v[20:23], v[196:199], v[132:135]
 ds_read_b64_tr_b16 v[220:221], v238 offset:12288
 v_mfma_f32_16x16x32_bf16 v[136:139], v[24:27], v[196:199], v[136:139]
 ds_read_b64_tr_b16 v[222:223], v238 offset:12800
 s_waitcnt lgkmcnt(14)
 v_mfma_f32_16x16x32_bf16 v[140:143], v[20:23], v[200:203], v[140:143]
 ds_read_b64_tr_b16 v[224:225], v239 offset:12288
 v_mfma_f32_16x16x32_bf16 v[144:147], v[24:27], v[200:203], v[144:147]
 ds_read_b64_tr_b16 v[226:227], v239 offset:12800
 s_waitcnt lgkmcnt(4)
 s_add_u32 m0, s36, 131072
 s_add_u32 s3, s42, 640
 s_and_b32 s3, s3, 1023
 s_add_u32 s3, s3, s41
 s_add_u32 s39, s3, 0
 buffer_load_dwordx4 v170, s[12:15], s39 offen offset:0 lds
 s_add_u32 s39, s3, 7168
 buffer_load_dwordx4 v170, s[12:15], s39 offen offset:1024 lds
 s_add_u32 s39, s3, 14336
 buffer_load_dwordx4 v170, s[12:15], s39 offen offset:2048 lds
 s_add_u32 s39, s3, 21504
 buffer_load_dwordx4 v170, s[12:15], s39 offen offset:3072 lds
 v_mfma_f32_16x16x32_bf16 v[148:151], v[20:23], v[204:207], v[148:151]
 ds_read_b64_tr_b16 v[196:197], v236 offset:16384
 v_mfma_f32_16x16x32_bf16 v[152:155], v[24:27], v[204:207], v[152:155]
 ds_read_b64_tr_b16 v[198:199], v236 offset:16896
 s_waitcnt lgkmcnt(14)
 v_mfma_f32_16x16x32_bf16 v[156:159], v[20:23], v[208:211], v[156:159]
 ds_read_b64_tr_b16 v[200:201], v237 offset:16384
 v_mfma_f32_16x16x32_bf16 v[160:163], v[24:27], v[208:211], v[160:163]
 ds_read_b64_tr_b16 v[202:203], v237 offset:16896
 s_waitcnt lgkmcnt(14)
 v_mfma_f32_16x16x32_bf16 v[132:135], v[28:31], v[212:215], v[132:135]
 ds_read_b64_tr_b16 v[204:205], v238 offset:16384
 v_mfma_f32_16x16x32_bf16 v[136:139], v[32:35], v[212:215], v[136:139]
 ds_read_b64_tr_b16 v[206:207], v238 offset:16896
 s_waitcnt lgkmcnt(14)
 v_mfma_f32_16x16x32_bf16 v[140:143], v[28:31], v[216:219], v[140:143]
 ds_read_b64_tr_b16 v[208:209], v239 offset:16384
 v_mfma_f32_16x16x32_bf16 v[144:147], v[32:35], v[216:219], v[144:147]
 ds_read_b64_tr_b16 v[210:211], v239 offset:16896
 s_waitcnt lgkmcnt(10)
 v_mfma_f32_16x16x32_bf16 v[148:151], v[28:31], v[220:223], v[148:151]
 ds_read_b64_tr_b16 v[212:213], v236 offset:20480
 v_mfma_f32_16x16x32_bf16 v[152:155], v[32:35], v[220:223], v[152:155]
 ds_read_b64_tr_b16 v[214:215], v236 offset:20992
 s_waitcnt lgkmcnt(10)
 v_mfma_f32_16x16x32_bf16 v[156:159], v[28:31], v[224:227], v[156:159]
 ds_read_b64_tr_b16 v[216:217], v237 offset:20480
 v_mfma_f32_16x16x32_bf16 v[160:163], v[32:35], v[224:227], v[160:163]
 ds_read_b64_tr_b16 v[218:219], v237 offset:20992
 s_waitcnt lgkmcnt(10)
 s_lshr_b32 s38, s2, 3
 s_lshl_b32 s38, s38, 3
 s_add_u32 s38, s38, s32
 s_lshl_b32 s38, s38, 14
 s_and_b32 s39, s2, 7
 s_lshl_b32 s39, s39, 10
 s_add_u32 s38, s38, s39
 s_add_u32 s39, s38, 8192
 v_and_b32 v230, 7, v0
 v_lshlrev_b32 v230, 7, v230
 v_bfe_u32 v231, v0, 3, 1
 v_lshl_add_u32 v230, v231, 13, v230
 s_mov_b32 s28, s48
 s_and_b32 s29, s49, 0xffff
 s_mov_b32 s30, 0x400000
 s_mov_b32 s31, 0x00020000
 s_mov_b64 exec, 0xffff
 buffer_load_dword v228, v230, s[28:31], s38 offen
 s_mov_b64 exec, -1
 s_mov_b32 s28, s82
 s_and_b32 s29, s83, 0xffff
 s_mov_b32 s30, 0x400000
 s_mov_b32 s31, 0x00020000
 s_mov_b64 exec, 0xffff
 buffer_load_dword v228, v230, s[28:31], s38 offen
 s_mov_b64 exec, -1
 s_waitcnt vmcnt(11)
 ds_read_b128 v[52:55], v166 offset:0
 ds_read_b128 v[56:59], v166 offset:1024
 ds_read_b128 v[60:63], v167 offset:0
 ds_read_b128 v[64:67], v167 offset:1024
 v_mfma_f32_16x16x32_bf16 v[132:135], v[36:39], v[196:199], v[132:135]
 ds_read_b64_tr_b16 v[220:221], v238 offset:20480
 v_mfma_f32_16x16x32_bf16 v[136:139], v[40:43], v[196:199], v[136:139]
 ds_read_b64_tr_b16 v[222:223], v238 offset:20992
 s_waitcnt lgkmcnt(14)
 v_mfma_f32_16x16x32_bf16 v[140:143], v[36:39], v[200:203], v[140:143]
 ds_read_b64_tr_b16 v[224:225], v239 offset:20480
 v_mfma_f32_16x16x32_bf16 v[144:147], v[40:43], v[200:203], v[144:147]
 ds_read_b64_tr_b16 v[226:227], v239 offset:20992
 s_waitcnt lgkmcnt(4)
 s_add_u32 m0, s36, 0
 s_add_u32 s3, s42, 768
 s_and_b32 s3, s3, 1023
 s_add_u32 s3, s3, s41
 s_add_u32 s39, s3, 0
 buffer_load_dwordx4 v170, s[12:15], s39 offen offset:0 lds
 s_add_u32 s39, s3, 7168
 buffer_load_dwordx4 v170, s[12:15], s39 offen offset:1024 lds
 s_add_u32 s39, s3, 14336
 buffer_load_dwordx4 v170, s[12:15], s39 offen offset:2048 lds
 s_add_u32 s39, s3, 21504
 buffer_load_dwordx4 v170, s[12:15], s39 offen offset:3072 lds
 v_mfma_f32_16x16x32_bf16 v[148:151], v[36:39], v[204:207], v[148:151]
 ds_read_b64_tr_b16 v[196:197], v236 offset:24576
 v_mfma_f32_16x16x32_bf16 v[152:155], v[40:43], v[204:207], v[152:155]
 ds_read_b64_tr_b16 v[198:199], v236 offset:25088
 s_waitcnt lgkmcnt(14)
 v_mfma_f32_16x16x32_bf16 v[156:159], v[36:39], v[208:211], v[156:159]
 ds_read_b64_tr_b16 v[200:201], v237 offset:24576
 v_mfma_f32_16x16x32_bf16 v[160:163], v[40:43], v[208:211], v[160:163]
 ds_read_b64_tr_b16 v[202:203], v237 offset:25088
 s_waitcnt lgkmcnt(14)
 v_mfma_f32_16x16x32_bf16 v[132:135], v[44:47], v[212:215], v[132:135]
 ds_read_b64_tr_b16 v[204:205], v238 offset:24576
 v_mfma_f32_16x16x32_bf16 v[136:139], v[48:51], v[212:215], v[136:139]
 ds_read_b64_tr_b16 v[206:207], v238 offset:25088
 s_waitcnt lgkmcnt(14)
 v_mfma_f32_16x16x32_bf16 v[140:143], v[44:47], v[216:219], v[140:143]
 ds_read_b64_tr_b16 v[208:209], v239 offset:24576
 v_mfma_f32_16x16x32_bf16 v[144:147], v[48:51], v[216:219], v[144:147]
 ds_read_b64_tr_b16 v[210:211], v239 offset:25088
 s_waitcnt lgkmcnt(10)
 v_mfma_f32_16x16x32_bf16 v[148:151], v[44:47], v[220:223], v[148:151]
 ds_read_b64_tr_b16 v[212:213], v236 offset:28672
 v_mfma_f32_16x16x32_bf16 v[152:155], v[48:51], v[220:223], v[152:155]
 ds_read_b64_tr_b16 v[214:215], v236 offset:29184
 s_waitcnt lgkmcnt(10)
 v_mfma_f32_16x16x32_bf16 v[156:159], v[44:47], v[224:227], v[156:159]
 ds_read_b64_tr_b16 v[216:217], v237 offset:28672
 v_mfma_f32_16x16x32_bf16 v[160:163], v[48:51], v[224:227], v[160:163]
 ds_read_b64_tr_b16 v[218:219], v237 offset:29184
 s_waitcnt lgkmcnt(10)
 s_waitcnt vmcnt(10)
 ds_read_b128 v[68:71], v168 offset:0
 ds_read_b128 v[72:75], v168 offset:1024
 ds_read_b128 v[76:79], v169 offset:0
 ds_read_b128 v[80:83], v169 offset:1024
 v_mfma_f32_16x16x32_bf16 v[132:135], v[52:55], v[196:199], v[132:135]
 ds_read_b64_tr_b16 v[220:221], v238 offset:28672
 v_mfma_f32_16x16x32_bf16 v[136:139], v[56:59], v[196:199], v[136:139]
 ds_read_b64_tr_b16 v[222:223], v238 offset:29184
 s_waitcnt lgkmcnt(14)
 v_mfma_f32_16x16x32_bf16 v[140:143], v[52:55], v[200:203], v[140:143]
 ds_read_b64_tr_b16 v[224:225], v239 offset:28672
 v_mfma_f32_16x16x32_bf16 v[144:147], v[56:59], v[200:203], v[144:147]
 ds_read_b64_tr_b16 v[226:227], v239 offset:29184
 s_waitcnt lgkmcnt(4)
 s_add_u32 m0, s36, 32768
 s_add_u32 s3, s42, 896
 s_and_b32 s3, s3, 1023
 s_add_u32 s3, s3, s41
 s_add_u32 s39, s3, 0
 buffer_load_dwordx4 v170, s[12:15], s39 offen offset:0 lds
 s_add_u32 s39, s3, 7168
 buffer_load_dwordx4 v170, s[12:15], s39 offen offset:1024 lds
 s_add_u32 s39, s3, 14336
 buffer_load_dwordx4 v170, s[12:15], s39 offen offset:2048 lds
 s_add_u32 s39, s3, 21504
 buffer_load_dwordx4 v170, s[12:15], s39 offen offset:3072 lds
 v_mfma_f32_16x16x32_bf16 v[148:151], v[52:55], v[204:207], v[148:151]
 ds_read_b64_tr_b16 v[196:197], v236 offset:32768
 v_mfma_f32_16x16x32_bf16 v[152:155], v[56:59], v[204:207], v[152:155]
 ds_read_b64_tr_b16 v[198:199], v236 offset:33280
 s_waitcnt lgkmcnt(14)
 v_mfma_f32_16x16x32_bf16 v[156:159], v[52:55], v[208:211], v[156:159]
 ds_read_b64_tr_b16 v[200:201], v237 offset:32768
 v_mfma_f32_16x16x32_bf16 v[160:163], v[56:59], v[208:211], v[160:163]
 ds_read_b64_tr_b16 v[202:203], v237 offset:33280
 s_waitcnt lgkmcnt(14)
 v_mfma_f32_16x16x32_bf16 v[132:135], v[60:63], v[212:215], v[132:135]
 ds_read_b64_tr_b16 v[204:205], v238 offset:32768
 v_mfma_f32_16x16x32_bf16 v[136:139], v[64:67], v[212:215], v[136:139]
 ds_read_b64_tr_b16 v[206:207], v238 offset:33280
 s_waitcnt lgkmcnt(14)
 v_mfma_f32_16x16x32_bf16 v[140:143], v[60:63], v[216:219], v[140:143]
 ds_read_b64_tr_b16 v[208:209], v239 offset:32768
 v_mfma_f32_16x16x32_bf16 v[144:147], v[64:67], v[216:219], v[144:147]
 ds_read_b64_tr_b16 v[210:211], v239 offset:33280
 s_waitcnt lgkmcnt(10)
 v_mfma_f32_16x16x32_bf16 v[148:151], v[60:63], v[220:223], v[148:151]
 ds_read_b64_tr_b16 v[212:213], v236 offset:36864
 v_mfma_f32_16x16x32_bf16 v[152:155], v[64:67], v[220:223], v[152:155]
 ds_read_b64_tr_b16 v[214:215], v236 offset:37376
 s_waitcnt lgkmcnt(10)
 v_mfma_f32_16x16x32_bf16 v[156:159], v[60:63], v[224:227], v[156:159]
 ds_read_b64_tr_b16 v[216:217], v237 offset:36864
 v_mfma_f32_16x16x32_bf16 v[160:163], v[64:67], v[224:227], v[160:163]
 ds_read_b64_tr_b16 v[218:219], v237 offset:37376
 s_waitcnt lgkmcnt(10)
 s_waitcnt vmcnt(10)
 ds_read_b128 v[84:87], v164 offset:0
 ds_read_b128 v[88:91], v164 offset:1024
 ds_read_b128 v[92:95], v165 offset:0
 ds_read_b128 v[96:99], v165 offset:1024
 v_mfma_f32_16x16x32_bf16 v[132:135], v[68:71], v[196:199], v[132:135]
 ds_read_b64_tr_b16 v[220:221], v238 offset:36864
 v_mfma_f32_16x16x32_bf16 v[136:139], v[72:75], v[196:199], v[136:139]
 ds_read_b64_tr_b16 v[222:223], v238 offset:37376
 s_waitcnt lgkmcnt(14)
 v_mfma_f32_16x16x32_bf16 v[140:143], v[68:71], v[200:203], v[140:143]
 ds_read_b64_tr_b16 v[224:225], v239 offset:36864
 v_mfma_f32_16x16x32_bf16 v[144:147], v[72:75], v[200:203], v[144:147]
 ds_read_b64_tr_b16 v[226:227], v239 offset:37376
 s_waitcnt lgkmcnt(4)
 s_add_u32 m0, s36, 131072
 s_add_u32 s39, s35, 128
 buffer_load_dwordx4 v244, s[8:11], s39 offen offset:0 lds
 s_add_u32 s39, s35, 64640
 buffer_load_dwordx4 v245, s[8:11], s39 offen offset:1024 lds
 s_add_u32 s39, s35, 129152
 buffer_load_dwordx4 v244, s[8:11], s39 offen offset:2048 lds
 s_add_u32 s39, s35, 193664
 buffer_load_dwordx4 v245, s[8:11], s39 offen offset:3072 lds
 v_mfma_f32_16x16x32_bf16 v[148:151], v[68:71], v[204:207], v[148:151]
 ds_read_b64_tr_b16 v[196:197], v236 offset:40960
 v_mfma_f32_16x16x32_bf16 v[152:155], v[72:75], v[204:207], v[152:155]
 ds_read_b64_tr_b16 v[198:199], v236 offset:41472
 s_waitcnt lgkmcnt(14)
 v_mfma_f32_16x16x32_bf16 v[156:159], v[68:71], v[208:211], v[156:159]
 ds_read_b64_tr_b16 v[200:201], v237 offset:40960
 v_mfma_f32_16x16x32_bf16 v[160:163], v[72:75], v[208:211], v[160:163]
 ds_read_b64_tr_b16 v[202:203], v237 offset:41472
 s_waitcnt lgkmcnt(14)
 v_mfma_f32_16x16x32_bf16 v[132:135], v[76:79], v[212:215], v[132:135]
 ds_read_b64_tr_b16 v[204:205], v238 offset:40960
 v_mfma_f32_16x16x32_bf16 v[136:139], v[80:83], v[212:215], v[136:139]
 ds_read_b64_tr_b16 v[206:207], v238 offset:41472
 s_waitcnt lgkmcnt(14)
 v_mfma_f32_16x16x32_bf16 v[140:143], v[76:79], v[216:219], v[140:143]
 ds_read_b64_tr_b16 v[208:209], v239 offset:40960
 v_mfma_f32_16x16x32_bf16 v[144:147], v[80:83], v[216:219], v[144:147]
 ds_read_b64_tr_b16 v[210:211], v239 offset:41472
 s_waitcnt lgkmcnt(10)
 v_mfma_f32_16x16x32_bf16 v[148:151], v[76:79], v[220:223], v[148:151]
 ds_read_b64_tr_b16 v[212:213], v236 offset:45056
 v_mfma_f32_16x16x32_bf16 v[152:155], v[80:83], v[220:223], v[152:155]
 ds_read_b64_tr_b16 v[214:215], v236 offset:45568
 s_waitcnt lgkmcnt(10)
 v_mfma_f32_16x16x32_bf16 v[156:159], v[76:79], v[224:227], v[156:159]
 ds_read_b64_tr_b16 v[216:217], v237 offset:45056
 v_mfma_f32_16x16x32_bf16 v[160:163], v[80:83], v[224:227], v[160:163]
 ds_read_b64_tr_b16 v[218:219], v237 offset:45568
 s_waitcnt lgkmcnt(10)
 s_waitcnt vmcnt(8)
 ds_read_b128 v[100:103], v166 offset:0
 ds_read_b128 v[104:107], v166 offset:1024
 ds_read_b128 v[108:111], v167 offset:0
 ds_read_b128 v[112:115], v167 offset:1024
 v_mfma_f32_16x16x32_bf16 v[132:135], v[84:87], v[196:199], v[132:135]
 ds_read_b64_tr_b16 v[220:221], v238 offset:45056
 v_mfma_f32_16x16x32_bf16 v[136:139], v[88:91], v[196:199], v[136:139]
 ds_read_b64_tr_b16 v[222:223], v238 offset:45568
 s_waitcnt lgkmcnt(14)
 v_mfma_f32_16x16x32_bf16 v[140:143], v[84:87], v[200:203], v[140:143]
 ds_read_b64_tr_b16 v[224:225], v239 offset:45056
 v_mfma_f32_16x16x32_bf16 v[144:147], v[88:91], v[200:203], v[144:147]
 ds_read_b64_tr_b16 v[226:227], v239 offset:45568
 s_waitcnt lgkmcnt(4)
 s_add_u32 m0, s36, 0
 s_add_u32 s39, s43, 128
 buffer_load_dwordx4 v244, s[8:11], s39 offen offset:0 lds
 s_add_u32 s39, s43, 64640
 buffer_load_dwordx4 v245, s[8:11], s39 offen offset:1024 lds
 s_add_u32 s39, s43, 129152
 buffer_load_dwordx4 v244, s[8:11], s39 offen offset:2048 lds
 s_add_u32 s39, s43, 193664
 buffer_load_dwordx4 v245, s[8:11], s39 offen offset:3072 lds
 v_mfma_f32_16x16x32_bf16 v[148:151], v[84:87], v[204:207], v[148:151]
 ds_read_b64_tr_b16 v[196:197], v236 offset:49152
 v_mfma_f32_16x16x32_bf16 v[152:155], v[88:91], v[204:207], v[152:155]
 ds_read_b64_tr_b16 v[198:199], v236 offset:49664
 s_waitcnt lgkmcnt(14)
 v_mfma_f32_16x16x32_bf16 v[156:159], v[84:87], v[208:211], v[156:159]
 ds_read_b64_tr_b16 v[200:201], v237 offset:49152
 v_mfma_f32_16x16x32_bf16 v[160:163], v[88:91], v[208:211], v[160:163]
 ds_read_b64_tr_b16 v[202:203], v237 offset:49664
 s_waitcnt lgkmcnt(14)
 v_mfma_f32_16x16x32_bf16 v[132:135], v[92:95], v[212:215], v[132:135]
 ds_read_b64_tr_b16 v[204:205], v238 offset:49152
 v_mfma_f32_16x16x32_bf16 v[136:139], v[96:99], v[212:215], v[136:139]
 ds_read_b64_tr_b16 v[206:207], v238 offset:49664
 s_waitcnt lgkmcnt(14)
 v_mfma_f32_16x16x32_bf16 v[140:143], v[92:95], v[216:219], v[140:143]
 ds_read_b64_tr_b16 v[208:209], v239 offset:49152
 v_mfma_f32_16x16x32_bf16 v[144:147], v[96:99], v[216:219], v[144:147]
 ds_read_b64_tr_b16 v[210:211], v239 offset:49664
 s_waitcnt lgkmcnt(10)
 v_mfma_f32_16x16x32_bf16 v[148:151], v[92:95], v[220:223], v[148:151]
 ds_read_b64_tr_b16 v[212:213], v236 offset:53248
 v_mfma_f32_16x16x32_bf16 v[152:155], v[96:99], v[220:223], v[152:155]
 ds_read_b64_tr_b16 v[214:215], v236 offset:53760
 s_waitcnt lgkmcnt(10)
 v_mfma_f32_16x16x32_bf16 v[156:159], v[92:95], v[224:227], v[156:159]
 ds_read_b64_tr_b16 v[216:217], v237 offset:53248
 v_mfma_f32_16x16x32_bf16 v[160:163], v[96:99], v[224:227], v[160:163]
 ds_read_b64_tr_b16 v[218:219], v237 offset:53760
 s_waitcnt lgkmcnt(10)
 s_waitcnt vmcnt(8)
 ds_read_b128 v[116:119], v168 offset:0
 ds_read_b128 v[120:123], v168 offset:1024
 ds_read_b128 v[124:127], v169 offset:0
 ds_read_b128 v[128:131], v169 offset:1024
 v_mfma_f32_16x16x32_bf16 v[132:135], v[100:103], v[196:199], v[132:135]
 ds_read_b64_tr_b16 v[220:221], v238 offset:53248
 v_mfma_f32_16x16x32_bf16 v[136:139], v[104:107], v[196:199], v[136:139]
 ds_read_b64_tr_b16 v[222:223], v238 offset:53760
 s_waitcnt lgkmcnt(14)
 v_mfma_f32_16x16x32_bf16 v[140:143], v[100:103], v[200:203], v[140:143]
 ds_read_b64_tr_b16 v[224:225], v239 offset:53248
 v_mfma_f32_16x16x32_bf16 v[144:147], v[104:107], v[200:203], v[144:147]
 ds_read_b64_tr_b16 v[226:227], v239 offset:53760
 s_waitcnt lgkmcnt(4)
 s_add_u32 m0, s36, 32768
 s_add_u32 s39, s35, 256
 buffer_load_dwordx4 v244, s[8:11], s39 offen offset:0 lds
 s_add_u32 s39, s35, 64768
 buffer_load_dwordx4 v245, s[8:11], s39 offen offset:1024 lds
 s_add_u32 s39, s35, 129280
 buffer_load_dwordx4 v244, s[8:11], s39 offen offset:2048 lds
 s_add_u32 s39, s35, 193792
 buffer_load_dwordx4 v245, s[8:11], s39 offen offset:3072 lds
 v_mfma_f32_16x16x32_bf16 v[148:151], v[100:103], v[204:207], v[148:151]
 ds_read_b64_tr_b16 v[196:197], v236 offset:57344
 v_mfma_f32_16x16x32_bf16 v[152:155], v[104:107], v[204:207], v[152:155]
 ds_read_b64_tr_b16 v[198:199], v236 offset:57856
 s_waitcnt lgkmcnt(14)
 v_mfma_f32_16x16x32_bf16 v[156:159], v[100:103], v[208:211], v[156:159]
 ds_read_b64_tr_b16 v[200:201], v237 offset:57344
 v_mfma_f32_16x16x32_bf16 v[160:163], v[104:107], v[208:211], v[160:163]
 ds_read_b64_tr_b16 v[202:203], v237 offset:57856
 s_waitcnt lgkmcnt(14)
 v_mfma_f32_16x16x32_bf16 v[132:135], v[108:111], v[212:215], v[132:135]
 ds_read_b64_tr_b16 v[204:205], v238 offset:57344
 v_mfma_f32_16x16x32_bf16 v[136:139], v[112:115], v[212:215], v[136:139]
 ds_read_b64_tr_b16 v[206:207], v238 offset:57856
 s_waitcnt lgkmcnt(14)
 v_mfma_f32_16x16x32_bf16 v[140:143], v[108:111], v[216:219], v[140:143]
 ds_read_b64_tr_b16 v[208:209], v239 offset:57344
 v_mfma_f32_16x16x32_bf16 v[144:147], v[112:115], v[216:219], v[144:147]
 ds_read_b64_tr_b16 v[210:211], v239 offset:57856
 s_waitcnt lgkmcnt(10)
 v_mfma_f32_16x16x32_bf16 v[148:151], v[108:111], v[220:223], v[148:151]
 ds_read_b64_tr_b16 v[212:213], v236 offset:61440
 v_mfma_f32_16x16x32_bf16 v[152:155], v[112:115], v[220:223], v[152:155]
 ds_read_b64_tr_b16 v[214:215], v236 offset:61952
 s_waitcnt lgkmcnt(10)
 v_mfma_f32_16x16x32_bf16 v[156:159], v[108:111], v[224:227], v[156:159]
 ds_read_b64_tr_b16 v[216:217], v237 offset:61440
 v_mfma_f32_16x16x32_bf16 v[160:163], v[112:115], v[224:227], v[160:163]
 ds_read_b64_tr_b16 v[218:219], v237 offset:61952
 s_waitcnt lgkmcnt(10)
 v_mfma_f32_16x16x32_bf16 v[132:135], v[116:119], v[196:199], v[132:135]
 ds_read_b64_tr_b16 v[220:221], v238 offset:61440
 v_mfma_f32_16x16x32_bf16 v[136:139], v[120:123], v[196:199], v[136:139]
 ds_read_b64_tr_b16 v[222:223], v238 offset:61952
 s_waitcnt lgkmcnt(10)
 s_waitcnt vmcnt(8)
 s_barrier
 s_cmp_eq_u32 s32, 0
 s_cbranch_scc0 KA_NSG1
 s_or_b32 s51, s51, 0x80000000
 v_mov_b32 v248, s50
 v_mov_b32 v249, s51
 v_mov_b32 v250, 0
 v_mov_b32 v251, 0
 s_mov_b64 exec, 1
 buffer_atomic_cmpswap_x2 v[248:251], off, s[96:99], 0 sc0
 s_mov_b64 exec, -1
KA_NSG1:
 v_mfma_f32_16x16x32_bf16 v[140:143], v[116:119], v[200:203], v[140:143]
 ds_read_b64_tr_b16 v[224:225], v239 offset:61440
 v_mfma_f32_16x16x32_bf16 v[144:147], v[120:123], v[200:203], v[144:147]
 ds_read_b64_tr_b16 v[226:227], v239 offset:61952
 s_waitcnt lgkmcnt(10)
 v_mfma_f32_16x16x32_bf16 v[148:151], v[116:119], v[204:207], v[148:151]
 ds_read_b64_tr_b16 v[196:197], v240 offset:0
 v_mfma_f32_16x16x32_bf16 v[152:155], v[120:123], v[204:207], v[152:155]
 ds_read_b64_tr_b16 v[198:199], v240 offset:512
 s_waitcnt lgkmcnt(10)
 v_mfma_f32_16x16x32_bf16 v[156:159], v[116:119], v[208:211], v[156:159]
 ds_read_b64_tr_b16 v[200:201], v241 offset:0
 v_mfma_f32_16x16x32_bf16 v[160:163], v[120:123], v[208:211], v[160:163]
 ds_read_b64_tr_b16 v[202:203], v241 offset:512
 s_waitcnt lgkmcnt(10)
 v_mfma_f32_16x16x32_bf16 v[132:135], v[124:127], v[212:215], v[132:135]
 ds_read_b64_tr_b16 v[204:205], v242 offset:0
 v_mfma_f32_16x16x32_bf16 v[136:139], v[128:131], v[212:215], v[136:139]
 ds_read_b64_tr_b16 v[206:207], v242 offset:512
 s_waitcnt lgkmcnt(10)
 v_mfma_f32_16x16x32_bf16 v[140:143], v[124:127], v[216:219], v[140:143]
 ds_read_b64_tr_b16 v[208:209], v243 offset:0
 v_mfma_f32_16x16x32_bf16 v[144:147], v[128:131], v[216:219], v[144:147]
 ds_read_b64_tr_b16 v[210:211], v243 offset:512
 s_waitcnt lgkmcnt(10)
 v_mfma_f32_16x16x32_bf16 v[148:151], v[124:127], v[220:223], v[148:151]
 ds_read_b64_tr_b16 v[212:213], v240 offset:4096
 v_mfma_f32_16x16x32_bf16 v[152:155], v[128:131], v[220:223], v[152:155]
 ds_read_b64_tr_b16 v[214:215], v240 offset:4608
 s_waitcnt lgkmcnt(10)
 v_mfma_f32_16x16x32_bf16 v[156:159], v[124:127], v[224:227], v[156:159]
 ds_read_b64_tr_b16 v[216:217], v241 offset:4096
 v_mfma_f32_16x16x32_bf16 v[160:163], v[128:131], v[224:227], v[160:163]
 ds_read_b64_tr_b16 v[218:219], v241 offset:4608
 s_waitcnt lgkmcnt(10)
 v_mfma_f32_16x16x32_bf16 v[164:167], v[4:7], v[196:199], 0
 ds_read_b64_tr_b16 v[220:221], v242 offset:4096
 v_mfma_f32_16x16x32_bf16 v[168:171], v[8:11], v[196:199], 0
 ds_read_b64_tr_b16 v[222:223], v242 offset:4608
 s_waitcnt lgkmcnt(10)
 v_mfma_f32_16x16x32_bf16 v[172:175], v[4:7], v[200:203], 0
 ds_read_b64_tr_b16 v[224:225], v243 offset:4096
 v_mfma_f32_16x16x32_bf16 v[176:179], v[8:11], v[200:203], 0
 ds_read_b64_tr_b16 v[226:227], v243 offset:4608
 s_waitcnt lgkmcnt(10)
 v_mfma_f32_16x16x32_bf16 v[180:183], v[4:7], v[204:207], 0
 ds_read_b64_tr_b16 v[196:197], v240 offset:8192
 v_mfma_f32_16x16x32_bf16 v[184:187], v[8:11], v[204:207], 0
 ds_read_b64_tr_b16 v[198:199], v240 offset:8704
 s_waitcnt lgkmcnt(10)
 v_mfma_f32_16x16x32_bf16 v[188:191], v[4:7], v[208:211], 0
 ds_read_b64_tr_b16 v[200:201], v241 offset:8192
 v_mfma_f32_16x16x32_bf16 v[192:195], v[8:11], v[208:211], 0
 ds_read_b64_tr_b16 v[202:203], v241 offset:8704
 s_waitcnt lgkmcnt(10)
 v_mfma_f32_16x16x32_bf16 v[164:167], v[12:15], v[212:215], v[164:167]
 ds_read_b64_tr_b16 v[204:205], v242 offset:8192
 v_mfma_f32_16x16x32_bf16 v[168:171], v[16:19], v[212:215], v[168:171]
 ds_read_b64_tr_b16 v[206:207], v242 offset:8704
 s_waitcnt lgkmcnt(10)
 v_mfma_f32_16x16x32_bf16 v[172:175], v[12:15], v[216:219], v[172:175]
 ds_read_b64_tr_b16 v[208:209], v243 offset:8192
 v_mfma_f32_16x16x32_bf16 v[176:179], v[16:19], v[216:219], v[176:179]
 ds_read_b64_tr_b16 v[210:211], v243 offset:8704
 s_waitcnt lgkmcnt(10)
 v_mfma_f32_16x16x32_bf16 v[180:183], v[12:15], v[220:223], v[180:183]
 ds_read_b64_tr_b16 v[212:213], v240 offset:12288
 v_mfma_f32_16x16x32_bf16 v[184:187], v[16:19], v[220:223], v[184:187]
 ds_read_b64_tr_b16 v[214:215], v240 offset:12800
 s_waitcnt lgkmcnt(10)
 s_add_u32 s94, s95, 0x0
 v_mfma_f32_16x16x32_bf16 v[188:191], v[12:15], v[224:227], v[188:191]
 ds_read_b64_tr_b16 v[216:217], v241 offset:12288
 v_mfma_f32_16x16x32_bf16 v[192:195], v[16:19], v[224:227], v[192:195]
 ds_read_b64_tr_b16 v[218:219], v241 offset:12800
 s_waitcnt lgkmcnt(10)
 v_mfma_f32_16x16x32_bf16 v[164:167], v[20:23], v[196:199], v[164:167]
 ds_read_b64_tr_b16 v[220:221], v242 offset:12288
 v_mfma_f32_16x16x32_bf16 v[168:171], v[24:27], v[196:199], v[168:171]
 ds_read_b64_tr_b16 v[222:223], v242 offset:12800
 s_waitcnt lgkmcnt(10)
 v_cvt_pk_bf16_f32 v132, v132, v133
 v_mfma_f32_16x16x32_bf16 v[172:175], v[20:23], v[200:203], v[172:175]
 ds_read_b64_tr_b16 v[224:225], v243 offset:12288
 v_mfma_f32_16x16x32_bf16 v[176:179], v[24:27], v[200:203], v[176:179]
 ds_read_b64_tr_b16 v[226:227], v243 offset:12800
 s_waitcnt lgkmcnt(10)
 v_mfma_f32_16x16x32_bf16 v[180:183], v[20:23], v[204:207], v[180:183]
 ds_read_b64_tr_b16 v[196:197], v240 offset:16384
 v_mfma_f32_16x16x32_bf16 v[184:187], v[24:27], v[204:207], v[184:187]
 ds_read_b64_tr_b16 v[198:199], v240 offset:16896
 s_waitcnt lgkmcnt(10)
 v_cvt_pk_bf16_f32 v133, v134, v135
 v_mfma_f32_16x16x32_bf16 v[188:191], v[20:23], v[208:211], v[188:191]
 ds_read_b64_tr_b16 v[200:201], v241 offset:16384
 v_mfma_f32_16x16x32_bf16 v[192:195], v[24:27], v[208:211], v[192:195]
 ds_read_b64_tr_b16 v[202:203], v241 offset:16896
 s_waitcnt lgkmcnt(10)
 v_mfma_f32_16x16x32_bf16 v[164:167], v[28:31], v[212:215], v[164:167]
 ds_read_b64_tr_b16 v[204:205], v242 offset:16384
 v_mfma_f32_16x16x32_bf16 v[168:171], v[32:35], v[212:215], v[168:171]
 ds_read_b64_tr_b16 v[206:207], v242 offset:16896
 s_waitcnt lgkmcnt(10)
 v_cvt_pk_bf16_f32 v134, v136, v137
 v_mfma_f32_16x16x32_bf16 v[172:175], v[28:31], v[216:219], v[172:175]
 ds_read_b64_tr_b16 v[208:209], v243 offset:16384
 v_mfma_f32_16x16x32_bf16 v[176:179], v[32:35], v[216:219], v[176:179]
 ds_read_b64_tr_b16 v[210:211], v243 offset:16896
 s_waitcnt lgkmcnt(10)
 v_mfma_f32_16x16x32_bf16 v[180:183], v[28:31], v[220:223], v[180:183]
 ds_read_b64_tr_b16 v[212:213], v240 offset:20480
 v_mfma_f32_16x16x32_bf16 v[184:187], v[32:35], v[220:223], v[184:187]
 ds_read_b64_tr_b16 v[214:215], v240 offset:20992
 s_waitcnt lgkmcnt(10)
 v_cvt_pk_bf16_f32 v135, v138, v139
 v_mfma_f32_16x16x32_bf16 v[188:191], v[28:31], v[224:227], v[188:191]
 ds_read_b64_tr_b16 v[216:217], v241 offset:20480
 v_mfma_f32_16x16x32_bf16 v[192:195], v[32:35], v[224:227], v[192:195]
 ds_read_b64_tr_b16 v[218:219], v241 offset:20992
 s_waitcnt lgkmcnt(10)
 v_mfma_f32_16x16x32_bf16 v[164:167], v[36:39], v[196:199], v[164:167]
 ds_read_b64_tr_b16 v[220:221], v242 offset:20480
 v_mfma_f32_16x16x32_bf16 v[168:171], v[40:43], v[196:199], v[168:171]
 ds_read_b64_tr_b16 v[222:223], v242 offset:20992
 s_waitcnt lgkmcnt(10)
 v_mfma_f32_16x16x32_bf16 v[172:175], v[36:39], v[200:203], v[172:175]
 ds_read_b64_tr_b16 v[224:225], v243 offset:20480
 v_mfma_f32_16x16x32_bf16 v[176:179], v[40:43], v[200:203], v[176:179]
 ds_read_b64_tr_b16 v[226:227], v243 offset:20992
 s_waitcnt lgkmcnt(10)
 buffer_store_dwordx4 v[132:135], v247, s[16:19], s94 offen offset:0 sc1
 v_mfma_f32_16x16x32_bf16 v[180:183], v[36:39], v[204:207], v[180:183]
 ds_read_b64_tr_b16 v[196:197], v240 offset:24576
 v_mfma_f32_16x16x32_bf16 v[184:187], v[40:43], v[204:207], v[184:187]
 ds_read_b64_tr_b16 v[198:199], v240 offset:25088
 s_waitcnt lgkmcnt(10)
 v_mfma_f32_16x16x32_bf16 v[188:191], v[36:39], v[208:211], v[188:191]
 ds_read_b64_tr_b16 v[200:201], v241 offset:24576
 v_mfma_f32_16x16x32_bf16 v[192:195], v[40:43], v[208:211], v[192:195]
 ds_read_b64_tr_b16 v[202:203], v241 offset:25088
 s_waitcnt lgkmcnt(10)
 v_cvt_pk_bf16_f32 v136, v140, v141
 v_mfma_f32_16x16x32_bf16 v[164:167], v[44:47], v[212:215], v[164:167]
 ds_read_b64_tr_b16 v[204:205], v242 offset:24576
 v_mfma_f32_16x16x32_bf16 v[168:171], v[48:51], v[212:215], v[168:171]
 ds_read_b64_tr_b16 v[206:207], v242 offset:25088
 s_waitcnt lgkmcnt(10)
 v_mfma_f32_16x16x32_bf16 v[172:175], v[44:47], v[216:219], v[172:175]
 ds_read_b64_tr_b16 v[208:209], v243 offset:24576
 v_mfma_f32_16x16x32_bf16 v[176:179], v[48:51], v[216:219], v[176:179]
 ds_read_b64_tr_b16 v[210:211], v243 offset:25088
 s_waitcnt lgkmcnt(10)
 v_cvt_pk_bf16_f32 v137, v142, v143
 v_mfma_f32_16x16x32_bf16 v[180:183], v[44:47], v[220:223], v[180:183]
 ds_read_b64_tr_b16 v[212:213], v240 offset:28672
 v_mfma_f32_16x16x32_bf16 v[184:187], v[48:51], v[220:223], v[184:187]
 ds_read_b64_tr_b16 v[214:215], v240 offset:29184
 s_waitcnt lgkmcnt(10)
 v_mfma_f32_16x16x32_bf16 v[188:191], v[44:47], v[224:227], v[188:191]
 ds_read_b64_tr_b16 v[216:217], v241 offset:28672
 v_mfma_f32_16x16x32_bf16 v[192:195], v[48:51], v[224:227], v[192:195]
 ds_read_b64_tr_b16 v[218:219], v241 offset:29184
 s_waitcnt lgkmcnt(10)
 v_cvt_pk_bf16_f32 v138, v144, v145
 v_mfma_f32_16x16x32_bf16 v[164:167], v[52:55], v[196:199], v[164:167]
 ds_read_b64_tr_b16 v[220:221], v242 offset:28672
 v_mfma_f32_16x16x32_bf16 v[168:171], v[56:59], v[196:199], v[168:171]
 ds_read_b64_tr_b16 v[222:223], v242 offset:29184
 s_waitcnt lgkmcnt(10)
 s_waitcnt vmcnt(5)
 s_barrier
 v_mfma_f32_16x16x32_bf16 v[172:175], v[52:55], v[200:203], v[172:175]
 ds_read_b64_tr_b16 v[224:225], v243 offset:28672
 v_mfma_f32_16x16x32_bf16 v[176:179], v[56:59], v[200:203], v[176:179]
 ds_read_b64_tr_b16 v[226:227], v243 offset:29184
 s_waitcnt lgkmcnt(10)
 v_cvt_pk_bf16_f32 v139, v146, v147
 v_mfma_f32_16x16x32_bf16 v[180:183], v[52:55], v[204:207], v[180:183]
 ds_read_b64_tr_b16 v[196:197], v232 offset:0
 v_mfma_f32_16x16x32_bf16 v[184:187], v[56:59], v[204:207], v[184:187]
 ds_read_b64_tr_b16 v[198:199], v232 offset:512
 s_waitcnt lgkmcnt(10)
 v_mfma_f32_16x16x32_bf16 v[188:191], v[52:55], v[208:211], v[188:191]
 ds_read_b64_tr_b16 v[200:201], v233 offset:0
 v_mfma_f32_16x16x32_bf16 v[192:195], v[56:59], v[208:211], v[192:195]
 ds_read_b64_tr_b16 v[202:203], v233 offset:512
 s_waitcnt lgkmcnt(10)
 buffer_store_dwordx4 v[136:139], v247, s[16:19], s94 offen offset:128 sc1
 v_mfma_f32_16x16x32_bf16 v[164:167], v[60:63], v[212:215], v[164:167]
 ds_read_b64_tr_b16 v[204:205], v234 offset:0
 v_mfma_f32_16x16x32_bf16 v[168:171], v[64:67], v[212:215], v[168:171]
 ds_read_b64_tr_b16 v[206:207], v234 offset:512
 s_waitcnt lgkmcnt(10)
 v_mfma_f32_16x16x32_bf16 v[172:175], v[60:63], v[216:219], v[172:175]
 ds_read_b64_tr_b16 v[208:209], v235 offset:0
 v_mfma_f32_16x16x32_bf16 v[176:179], v[64:67], v[216:219], v[176:179]
 ds_read_b64_tr_b16 v[210:211], v235 offset:512
 s_waitcnt lgkmcnt(10)
 v_mfma_f32_16x16x32_bf16 v[180:183], v[60:63], v[220:223], v[180:183]
 ds_read_b64_tr_b16 v[212:213], v232 offset:4096
 v_mfma_f32_16x16x32_bf16 v[184:187], v[64:67], v[220:223], v[184:187]
 ds_read_b64_tr_b16 v[214:215], v232 offset:4608
 s_waitcnt lgkmcnt(10)
 s_add_u32 s94, s95, 0x1000
 v_mfma_f32_16x16x32_bf16 v[188:191], v[60:63], v[224:227], v[188:191]
 ds_read_b64_tr_b16 v[216:217], v233 offset:4096
 v_mfma_f32_16x16x32_bf16 v[192:195], v[64:67], v[224:227], v[192:195]
 ds_read_b64_tr_b16 v[218:219], v233 offset:4608
 s_waitcnt lgkmcnt(10)
 v_mfma_f32_16x16x32_bf16 v[164:167], v[68:71], v[196:199], v[164:167]
 ds_read_b64_tr_b16 v[220:221], v234 offset:4096
 v_mfma_f32_16x16x32_bf16 v[168:171], v[72:75], v[196:199], v[168:171]
 ds_read_b64_tr_b16 v[222:223], v234 offset:4608
 s_waitcnt lgkmcnt(10)
 v_cvt_pk_bf16_f32 v148, v148, v149
 v_mfma_f32_16x16x32_bf16 v[172:175], v[68:71], v[200:203], v[172:175]
 ds_read_b64_tr_b16 v[224:225], v235 offset:4096
 v_mfma_f32_16x16x32_bf16 v[176:179], v[72:75], v[200:203], v[176:179]
 ds_read_b64_tr_b16 v[226:227], v235 offset:4608
 s_waitcnt lgkmcnt(10)
 v_mfma_f32_16x16x32_bf16 v[180:183], v[68:71], v[204:207], v[180:183]
 ds_read_b64_tr_b16 v[196:197], v232 offset:8192
 v_mfma_f32_16x16x32_bf16 v[184:187], v[72:75], v[204:207], v[184:187]
 ds_read_b64_tr_b16 v[198:199], v232 offset:8704
 s_waitcnt lgkmcnt(10)
 v_cvt_pk_bf16_f32 v149, v150, v151
 v_mfma_f32_16x16x32_bf16 v[188:191], v[68:71], v[208:211], v[188:191]
 ds_read_b64_tr_b16 v[200:201], v233 offset:8192
 v_mfma_f32_16x16x32_bf16 v[192:195], v[72:75], v[208:211], v[192:195]
 ds_read_b64_tr_b16 v[202:203], v233 offset:8704
 s_waitcnt lgkmcnt(10)
 s_mov_b32 s28, s76
 s_and_b32 s29, s77, 0xffff
 s_mov_b32 s30, 0x400000
 s_mov_b32 s31, 0x00020000
 s_lshl_b32 s38, s2, 14
 s_lshl_b32 s39, s32, 11
 s_add_u32 s38, s38, s39
 s_lshr_b32 s3, s2, 3
 s_lshl_b32 s3, s3, 3
 s_add_u32 s3, s3, s32
 s_lshl_b32 s3, s3, 14
 s_and_b32 s39, s2, 7
 s_lshl_b32 s39, s39, 10
 s_add_u32 s3, s3, s39
 v_and_b32 v229, 7, v0
 v_lshlrev_b32 v229, 7, v229
 v_bfe_u32 v231, v0, 3, 1
 v_lshl_add_u32 v229, v231, 13, v229
 v_lshlrev_b32 v230, 7, v0
 s_mov_b64 exec, 0xffff
 buffer_load_dword v228, v229, s[28:31], s3 offen
 s_mov_b32 s20, s84
 s_and_b32 s21, s85, 0xffff
 s_mov_b32 s22, 0x158000
 s_mov_b32 s23, 0x00020000
 s_lshr_b32 s38, s38, 1
 s_mov_b64 exec, 0xff
 buffer_load_dword v228, v230, s[20:23], s38 offen
 s_mov_b64 exec, -1
 v_mfma_f32_16x16x32_bf16 v[164:167], v[76:79], v[212:215], v[164:167]
 ds_read_b64_tr_b16 v[204:205], v234 offset:8192
 v_mfma_f32_16x16x32_bf16 v[168:171], v[80:83], v[212:215], v[168:171]
 ds_read_b64_tr_b16 v[206:207], v234 offset:8704
 s_waitcnt lgkmcnt(10)
 v_cvt_pk_bf16_f32 v150, v152, v153
 v_mfma_f32_16x16x32_bf16 v[172:175], v[76:79], v[216:219], v[172:175]
 ds_read_b64_tr_b16 v[208:209], v235 offset:8192
 v_mfma_f32_16x16x32_bf16 v[176:179], v[80:83], v[216:219], v[176:179]
 ds_read_b64_tr_b16 v[210:211], v235 offset:8704
 s_waitcnt lgkmcnt(10)
 v_mfma_f32_16x16x32_bf16 v[180:183], v[76:79], v[220:223], v[180:183]
 ds_read_b64_tr_b16 v[212:213], v232 offset:12288
 v_mfma_f32_16x16x32_bf16 v[184:187], v[80:83], v[220:223], v[184:187]
 ds_read_b64_tr_b16 v[214:215], v232 offset:12800
 s_waitcnt lgkmcnt(10)
 v_cvt_pk_bf16_f32 v151, v154, v155
 v_mfma_f32_16x16x32_bf16 v[188:191], v[76:79], v[224:227], v[188:191]
 ds_read_b64_tr_b16 v[216:217], v233 offset:12288
 v_mfma_f32_16x16x32_bf16 v[192:195], v[80:83], v[224:227], v[192:195]
 ds_read_b64_tr_b16 v[218:219], v233 offset:12800
 s_waitcnt lgkmcnt(10)
 v_mfma_f32_16x16x32_bf16 v[164:167], v[84:87], v[196:199], v[164:167]
 ds_read_b64_tr_b16 v[220:221], v234 offset:12288
 v_mfma_f32_16x16x32_bf16 v[168:171], v[88:91], v[196:199], v[168:171]
 ds_read_b64_tr_b16 v[222:223], v234 offset:12800
 s_waitcnt lgkmcnt(10)
 v_mfma_f32_16x16x32_bf16 v[172:175], v[84:87], v[200:203], v[172:175]
 ds_read_b64_tr_b16 v[224:225], v235 offset:12288
 v_mfma_f32_16x16x32_bf16 v[176:179], v[88:91], v[200:203], v[176:179]
 ds_read_b64_tr_b16 v[226:227], v235 offset:12800
 s_waitcnt lgkmcnt(10)
 buffer_store_dwordx4 v[148:151], v247, s[16:19], s94 offen offset:0 sc1
 v_mfma_f32_16x16x32_bf16 v[180:183], v[84:87], v[204:207], v[180:183]
 ds_read_b64_tr_b16 v[196:197], v232 offset:16384
 v_mfma_f32_16x16x32_bf16 v[184:187], v[88:91], v[204:207], v[184:187]
 ds_read_b64_tr_b16 v[198:199], v232 offset:16896
 s_waitcnt lgkmcnt(10)
 v_mfma_f32_16x16x32_bf16 v[188:191], v[84:87], v[208:211], v[188:191]
 ds_read_b64_tr_b16 v[200:201], v233 offset:16384
 v_mfma_f32_16x16x32_bf16 v[192:195], v[88:91], v[208:211], v[192:195]
 ds_read_b64_tr_b16 v[202:203], v233 offset:16896
 s_waitcnt lgkmcnt(10)
 v_cvt_pk_bf16_f32 v152, v156, v157
 v_mfma_f32_16x16x32_bf16 v[164:167], v[92:95], v[212:215], v[164:167]
 ds_read_b64_tr_b16 v[204:205], v234 offset:16384
 v_mfma_f32_16x16x32_bf16 v[168:171], v[96:99], v[212:215], v[168:171]
 ds_read_b64_tr_b16 v[206:207], v234 offset:16896
 s_waitcnt lgkmcnt(10)
 v_mfma_f32_16x16x32_bf16 v[172:175], v[92:95], v[216:219], v[172:175]
 ds_read_b64_tr_b16 v[208:209], v235 offset:16384
 v_mfma_f32_16x16x32_bf16 v[176:179], v[96:99], v[216:219], v[176:179]
 ds_read_b64_tr_b16 v[210:211], v235 offset:16896
 s_waitcnt lgkmcnt(10)
 v_cvt_pk_bf16_f32 v153, v158, v159
 v_mfma_f32_16x16x32_bf16 v[180:183], v[92:95], v[220:223], v[180:183]
 ds_read_b64_tr_b16 v[212:213], v232 offset:20480
 v_mfma_f32_16x16x32_bf16 v[184:187], v[96:99], v[220:223], v[184:187]
 ds_read_b64_tr_b16 v[214:215], v232 offset:20992
 s_waitcnt lgkmcnt(10)
 v_mfma_f32_16x16x32_bf16 v[188:191], v[92:95], v[224:227], v[188:191]
 ds_read_b64_tr_b16 v[216:217], v233 offset:20480
 v_mfma_f32_16x16x32_bf16 v[192:195], v[96:99], v[224:227], v[192:195]
 ds_read_b64_tr_b16 v[218:219], v233 offset:20992
 s_waitcnt lgkmcnt(10)
 v_cvt_pk_bf16_f32 v154, v160, v161
 v_mfma_f32_16x16x32_bf16 v[164:167], v[100:103], v[196:199], v[164:167]
 ds_read_b64_tr_b16 v[220:221], v234 offset:20480
 v_mfma_f32_16x16x32_bf16 v[168:171], v[104:107], v[196:199], v[168:171]
 ds_read_b64_tr_b16 v[222:223], v234 offset:20992
 s_waitcnt lgkmcnt(10)
 v_mfma_f32_16x16x32_bf16 v[172:175], v[100:103], v[200:203], v[172:175]
 ds_read_b64_tr_b16 v[224:225], v235 offset:20480
 v_mfma_f32_16x16x32_bf16 v[176:179], v[104:107], v[200:203], v[176:179]
 ds_read_b64_tr_b16 v[226:227], v235 offset:20992
 s_waitcnt lgkmcnt(10)
 v_cvt_pk_bf16_f32 v155, v162, v163
 v_mfma_f32_16x16x32_bf16 v[180:183], v[100:103], v[204:207], v[180:183]
 ds_read_b64_tr_b16 v[196:197], v232 offset:24576
 v_mfma_f32_16x16x32_bf16 v[184:187], v[104:107], v[204:207], v[184:187]
 ds_read_b64_tr_b16 v[198:199], v232 offset:25088
 s_waitcnt lgkmcnt(10)
 v_mfma_f32_16x16x32_bf16 v[188:191], v[100:103], v[208:211], v[188:191]
 ds_read_b64_tr_b16 v[200:201], v233 offset:24576
 v_mfma_f32_16x16x32_bf16 v[192:195], v[104:107], v[208:211], v[192:195]
 ds_read_b64_tr_b16 v[202:203], v233 offset:25088
 s_waitcnt lgkmcnt(10)
 buffer_store_dwordx4 v[152:155], v247, s[16:19], s94 offen offset:128 sc1
 v_mfma_f32_16x16x32_bf16 v[164:167], v[108:111], v[212:215], v[164:167]
 ds_read_b64_tr_b16 v[204:205], v234 offset:24576
 v_mfma_f32_16x16x32_bf16 v[168:171], v[112:115], v[212:215], v[168:171]
 ds_read_b64_tr_b16 v[206:207], v234 offset:25088
 s_waitcnt lgkmcnt(10)
 v_mfma_f32_16x16x32_bf16 v[172:175], v[108:111], v[216:219], v[172:175]
 ds_read_b64_tr_b16 v[208:209], v235 offset:24576
 v_mfma_f32_16x16x32_bf16 v[176:179], v[112:115], v[216:219], v[176:179]
 ds_read_b64_tr_b16 v[210:211], v235 offset:25088
 s_waitcnt lgkmcnt(10)
 v_mfma_f32_16x16x32_bf16 v[180:183], v[108:111], v[220:223], v[180:183]
 ds_read_b64_tr_b16 v[212:213], v232 offset:28672
 v_mfma_f32_16x16x32_bf16 v[184:187], v[112:115], v[220:223], v[184:187]
 ds_read_b64_tr_b16 v[214:215], v232 offset:29184
 s_waitcnt lgkmcnt(10)
 v_mfma_f32_16x16x32_bf16 v[188:191], v[108:111], v[224:227], v[188:191]
 ds_read_b64_tr_b16 v[216:217], v233 offset:28672
 v_mfma_f32_16x16x32_bf16 v[192:195], v[112:115], v[224:227], v[192:195]
 ds_read_b64_tr_b16 v[218:219], v233 offset:29184
 s_waitcnt lgkmcnt(10)
 v_mfma_f32_16x16x32_bf16 v[164:167], v[116:119], v[196:199], v[164:167]
 ds_read_b64_tr_b16 v[220:221], v234 offset:28672
 v_mfma_f32_16x16x32_bf16 v[168:171], v[120:123], v[196:199], v[168:171]
 ds_read_b64_tr_b16 v[222:223], v234 offset:29184
 s_waitcnt lgkmcnt(10)
 s_waitcnt vmcnt(6)
 s_barrier
 s_add_u32 m0, s36, 65536
 s_add_u32 s39, s43, 256
 buffer_load_dwordx4 v244, s[8:11], s39 offen offset:0 lds
 s_add_u32 s39, s43, 64768
 buffer_load_dwordx4 v245, s[8:11], s39 offen offset:1024 lds
 s_add_u32 s39, s43, 129280
 buffer_load_dwordx4 v244, s[8:11], s39 offen offset:2048 lds
 s_add_u32 s39, s43, 193792
 buffer_load_dwordx4 v245, s[8:11], s39 offen offset:3072 lds
 s_cmp_eq_u32 s32, 0
 s_cbranch_scc0 KA_NTK1
 s_waitcnt vmcnt(10)
 v_readfirstlane_b32 s46, v248
 v_readfirstlane_b32 s47, v249
 s_or_b32 s38, s46, s47
 s_cselect_b64 s[50:51], s[46:47], s[50:51]
 v_mov_b32 v254, s50
 v_mov_b32 v255, s51
 s_add_u32 s28, s86, 0x200000
 s_addc_u32 s29, s87, 0
 s_and_b32 s29, s29, 0xffff
 s_mov_b32 s30, 0x14000
 s_mov_b32 s31, 0x00020000
 s_lshl_b32 s39, s2, 3
 s_and_b32 s38, s2, 7
 s_lshl_b32 s38, s38, 4
 v_mov_b32 v252, 1
 s_mov_b64 exec, 1
 buffer_store_dwordx2 v[254:255], off, s[28:31], s39 sc1
 s_cmp_eq_u32 s92, 0
 s_cbranch_scc0 KA_NTJ1
 buffer_atomic_add v252, off, s[96:99], s38 offset:128 sc0
KA_NTJ1:
 s_mov_b64 exec, -1
KA_NTK1:
 s_add_u32 s96, s86, 0x200000
 s_addc_u32 s97, s87, 0
 s_and_b32 s97, s97, 0xffff
 s_mov_b32 s98, 0x14000
 s_mov_b32 s99, 0x00020000
 v_mfma_f32_16x16x32_bf16 v[172:175], v[116:119], v[200:203], v[172:175]
 ds_read_b64_tr_b16 v[224:225], v235 offset:28672
 v_mfma_f32_16x16x32_bf16 v[176:179], v[120:123], v[200:203], v[176:179]
 ds_read_b64_tr_b16 v[226:227], v235 offset:29184
 s_waitcnt lgkmcnt(10)
 v_mfma_f32_16x16x32_bf16 v[180:183], v[116:119], v[204:207], v[180:183]
 ds_read_b64_tr_b16 v[196:197], v232 offset:32768
 v_mfma_f32_16x16x32_bf16 v[184:187], v[120:123], v[204:207], v[184:187]
 ds_read_b64_tr_b16 v[198:199], v232 offset:33280
 s_waitcnt lgkmcnt(10)
 v_mfma_f32_16x16x32_bf16 v[188:191], v[116:119], v[208:211], v[188:191]
 ds_read_b64_tr_b16 v[200:201], v233 offset:32768
 v_mfma_f32_16x16x32_bf16 v[192:195], v[120:123], v[208:211], v[192:195]
 ds_read_b64_tr_b16 v[202:203], v233 offset:33280
 s_waitcnt lgkmcnt(10)
 v_mfma_f32_16x16x32_bf16 v[164:167], v[124:127], v[212:215], v[164:167]
 ds_read_b64_tr_b16 v[204:205], v234 offset:32768
 v_mfma_f32_16x16x32_bf16 v[168:171], v[128:131], v[212:215], v[168:171]
 ds_read_b64_tr_b16 v[206:207], v234 offset:33280
 s_waitcnt lgkmcnt(10)
 v_mfma_f32_16x16x32_bf16 v[172:175], v[124:127], v[216:219], v[172:175]
 ds_read_b64_tr_b16 v[208:209], v235 offset:32768
 v_mfma_f32_16x16x32_bf16 v[176:179], v[128:131], v[216:219], v[176:179]
 ds_read_b64_tr_b16 v[210:211], v235 offset:33280
 s_waitcnt lgkmcnt(10)
 v_mfma_f32_16x16x32_bf16 v[180:183], v[124:127], v[220:223], v[180:183]
 ds_read_b64_tr_b16 v[212:213], v232 offset:36864
 v_mfma_f32_16x16x32_bf16 v[184:187], v[128:131], v[220:223], v[184:187]
 ds_read_b64_tr_b16 v[214:215], v232 offset:37376
 s_waitcnt lgkmcnt(10)
 v_mfma_f32_16x16x32_bf16 v[188:191], v[124:127], v[224:227], v[188:191]
 ds_read_b64_tr_b16 v[216:217], v233 offset:36864
 v_mfma_f32_16x16x32_bf16 v[192:195], v[128:131], v[224:227], v[192:195]
 ds_read_b64_tr_b16 v[218:219], v233 offset:37376
 s_waitcnt lgkmcnt(10)
 v_mfma_f32_16x16x32_bf16 v[132:135], v[4:7], v[196:199], 0
 ds_read_b64_tr_b16 v[220:221], v234 offset:36864
 v_mfma_f32_16x16x32_bf16 v[136:139], v[8:11], v[196:199], 0
 ds_read_b64_tr_b16 v[222:223], v234 offset:37376
 s_waitcnt lgkmcnt(10)
 v_mfma_f32_16x16x32_bf16 v[140:143], v[4:7], v[200:203], 0
 ds_read_b64_tr_b16 v[224:225], v235 offset:36864
 v_mfma_f32_16x16x32_bf16 v[144:147], v[8:11], v[200:203], 0
 ds_read_b64_tr_b16 v[226:227], v235 offset:37376
 s_waitcnt lgkmcnt(10)
 v_mfma_f32_16x16x32_bf16 v[148:151], v[4:7], v[204:207], 0
 ds_read_b64_tr_b16 v[196:197], v232 offset:40960
 v_mfma_f32_16x16x32_bf16 v[152:155], v[8:11], v[204:207], 0
 ds_read_b64_tr_b16 v[198:199], v232 offset:41472
 s_waitcnt lgkmcnt(10)
 v_mfma_f32_16x16x32_bf16 v[156:159], v[4:7], v[208:211], 0
 ds_read_b64_tr_b16 v[200:201], v233 offset:40960
 v_mfma_f32_16x16x32_bf16 v[160:163], v[8:11], v[208:211], 0
 ds_read_b64_tr_b16 v[202:203], v233 offset:41472
 s_waitcnt lgkmcnt(10)
 v_mfma_f32_16x16x32_bf16 v[132:135], v[12:15], v[212:215], v[132:135]
 ds_read_b64_tr_b16 v[204:205], v234 offset:40960
 v_mfma_f32_16x16x32_bf16 v[136:139], v[16:19], v[212:215], v[136:139]
 ds_read_b64_tr_b16 v[206:207], v234 offset:41472
 s_waitcnt lgkmcnt(10)
 v_mfma_f32_16x16x32_bf16 v[140:143], v[12:15], v[216:219], v[140:143]
 ds_read_b64_tr_b16 v[208:209], v235 offset:40960
 v_mfma_f32_16x16x32_bf16 v[144:147], v[16:19], v[216:219], v[144:147]
 ds_read_b64_tr_b16 v[210:211], v235 offset:41472
 s_waitcnt lgkmcnt(10)
 v_mfma_f32_16x16x32_bf16 v[148:151], v[12:15], v[220:223], v[148:151]
 ds_read_b64_tr_b16 v[212:213], v232 offset:45056
 v_mfma_f32_16x16x32_bf16 v[152:155], v[16:19], v[220:223], v[152:155]
 ds_read_b64_tr_b16 v[214:215], v232 offset:45568
 s_waitcnt lgkmcnt(10)
 s_add_u32 s94, s95, 0x2000
 v_mfma_f32_16x16x32_bf16 v[156:159], v[12:15], v[224:227], v[156:159]
 ds_read_b64_tr_b16 v[216:217], v233 offset:45056
 v_mfma_f32_16x16x32_bf16 v[160:163], v[16:19], v[224:227], v[160:163]
 ds_read_b64_tr_b16 v[218:219], v233 offset:45568
 s_waitcnt lgkmcnt(10)
 v_mfma_f32_16x16x32_bf16 v[132:135], v[20:23], v[196:199], v[132:135]
 ds_read_b64_tr_b16 v[220:221], v234 offset:45056
 v_mfma_f32_16x16x32_bf16 v[136:139], v[24:27], v[196:199], v[136:139]
 ds_read_b64_tr_b16 v[222:223], v234 offset:45568
 s_waitcnt lgkmcnt(10)
 v_cvt_pk_bf16_f32 v164, v164, v165
 v_mfma_f32_16x16x32_bf16 v[140:143], v[20:23], v[200:203], v[140:143]
 ds_read_b64_tr_b16 v[224:225], v235 offset:45056
 v_mfma_f32_16x16x32_bf16 v[144:147], v[24:27], v[200:203], v[144:147]
 ds_read_b64_tr_b16 v[226:227], v235 offset:45568
 s_waitcnt lgkmcnt(10)
 v_mfma_f32_16x16x32_bf16 v[148:151], v[20:23], v[204:207], v[148:151]
 ds_read_b64_tr_b16 v[196:197], v232 offset:49152
 v_mfma_f32_16x16x32_bf16 v[152:155], v[24:27], v[204:207], v[152:155]
 ds_read_b64_tr_b16 v[198:199], v232 offset:49664
 s_waitcnt lgkmcnt(10)
 v_cvt_pk_bf16_f32 v165, v166, v167
 v_mfma_f32_16x16x32_bf16 v[156:159], v[20:23], v[208:211], v[156:159]
 ds_read_b64_tr_b16 v[200:201], v233 offset:49152
 v_mfma_f32_16x16x32_bf16 v[160:163], v[24:27], v[208:211], v[160:163]
 ds_read_b64_tr_b16 v[202:203], v233 offset:49664
 s_waitcnt lgkmcnt(10)
 v_mfma_f32_16x16x32_bf16 v[132:135], v[28:31], v[212:215], v[132:135]
 ds_read_b64_tr_b16 v[204:205], v234 offset:49152
 v_mfma_f32_16x16x32_bf16 v[136:139], v[32:35], v[212:215], v[136:139]
 ds_read_b64_tr_b16 v[206:207], v234 offset:49664
 s_waitcnt lgkmcnt(10)
 v_cvt_pk_bf16_f32 v166, v168, v169
 v_mfma_f32_16x16x32_bf16 v[140:143], v[28:31], v[216:219], v[140:143]
 ds_read_b64_tr_b16 v[208:209], v235 offset:49152
 v_mfma_f32_16x16x32_bf16 v[144:147], v[32:35], v[216:219], v[144:147]
 ds_read_b64_tr_b16 v[210:211], v235 offset:49664
 s_waitcnt lgkmcnt(10)
 v_mfma_f32_16x16x32_bf16 v[148:151], v[28:31], v[220:223], v[148:151]
 ds_read_b64_tr_b16 v[212:213], v232 offset:53248
 v_mfma_f32_16x16x32_bf16 v[152:155], v[32:35], v[220:223], v[152:155]
 ds_read_b64_tr_b16 v[214:215], v232 offset:53760
 s_waitcnt lgkmcnt(10)
 v_cvt_pk_bf16_f32 v167, v170, v171
 v_mfma_f32_16x16x32_bf16 v[156:159], v[28:31], v[224:227], v[156:159]
 ds_read_b64_tr_b16 v[216:217], v233 offset:53248
 v_mfma_f32_16x16x32_bf16 v[160:163], v[32:35], v[224:227], v[160:163]
 ds_read_b64_tr_b16 v[218:219], v233 offset:53760
 s_waitcnt lgkmcnt(10)
 v_mfma_f32_16x16x32_bf16 v[132:135], v[36:39], v[196:199], v[132:135]
 ds_read_b64_tr_b16 v[220:221], v234 offset:53248
 v_mfma_f32_16x16x32_bf16 v[136:139], v[40:43], v[196:199], v[136:139]
 ds_read_b64_tr_b16 v[222:223], v234 offset:53760
 s_waitcnt lgkmcnt(10)
 v_mfma_f32_16x16x32_bf16 v[140:143], v[36:39], v[200:203], v[140:143]
 ds_read_b64_tr_b16 v[224:225], v235 offset:53248
 v_mfma_f32_16x16x32_bf16 v[144:147], v[40:43], v[200:203], v[144:147]
 ds_read_b64_tr_b16 v[226:227], v235 offset:53760
 s_waitcnt lgkmcnt(10)
 buffer_store_dwordx4 v[164:167], v247, s[16:19], s94 offen offset:0 sc1
 v_mfma_f32_16x16x32_bf16 v[148:151], v[36:39], v[204:207], v[148:151]
 ds_read_b64_tr_b16 v[196:197], v232 offset:57344
 v_mfma_f32_16x16x32_bf16 v[152:155], v[40:43], v[204:207], v[152:155]
 ds_read_b64_tr_b16 v[198:199], v232 offset:57856
 s_waitcnt lgkmcnt(10)
 v_mfma_f32_16x16x32_bf16 v[156:159], v[36:39], v[208:211], v[156:159]
 ds_read_b64_tr_b16 v[200:201], v233 offset:57344
 v_mfma_f32_16x16x32_bf16 v[160:163], v[40:43], v[208:211], v[160:163]
 ds_read_b64_tr_b16 v[202:203], v233 offset:57856
 s_waitcnt lgkmcnt(10)
 v_cvt_pk_bf16_f32 v168, v172, v173
 v_mfma_f32_16x16x32_bf16 v[132:135], v[44:47], v[212:215], v[132:135]
 ds_read_b64_tr_b16 v[204:205], v234 offset:57344
 v_mfma_f32_16x16x32_bf16 v[136:139], v[48:51], v[212:215], v[136:139]
 ds_read_b64_tr_b16 v[206:207], v234 offset:57856
 s_waitcnt lgkmcnt(10)
 v_mfma_f32_16x16x32_bf16 v[140:143], v[44:47], v[216:219], v[140:143]
 ds_read_b64_tr_b16 v[208:209], v235 offset:57344
 v_mfma_f32_16x16x32_bf16 v[144:147], v[48:51], v[216:219], v[144:147]
 ds_read_b64_tr_b16 v[210:211], v235 offset:57856
 s_waitcnt lgkmcnt(10)
 v_cvt_pk_bf16_f32 v169, v174, v175
 v_mfma_f32_16x16x32_bf16 v[148:151], v[44:47], v[220:223], v[148:151]
 ds_read_b64_tr_b16 v[212:213], v232 offset:61440
 v_mfma_f32_16x16x32_bf16 v[152:155], v[48:51], v[220:223], v[152:155]
 ds_read_b64_tr_b16 v[214:215], v232 offset:61952
 s_waitcnt lgkmcnt(10)
 v_mfma_f32_16x16x32_bf16 v[156:159], v[44:47], v[224:227], v[156:159]
 ds_read_b64_tr_b16 v[216:217], v233 offset:61440
 v_mfma_f32_16x16x32_bf16 v[160:163], v[48:51], v[224:227], v[160:163]
 ds_read_b64_tr_b16 v[218:219], v233 offset:61952
 s_waitcnt lgkmcnt(10)
 v_cvt_pk_bf16_f32 v170, v176, v177
 v_mfma_f32_16x16x32_bf16 v[132:135], v[52:55], v[196:199], v[132:135]
 ds_read_b64_tr_b16 v[220:221], v234 offset:61440
 v_mfma_f32_16x16x32_bf16 v[136:139], v[56:59], v[196:199], v[136:139]
 ds_read_b64_tr_b16 v[222:223], v234 offset:61952
 s_waitcnt lgkmcnt(10)
 s_waitcnt vmcnt(1)
 s_barrier
 s_add_u32 m0, s36, 98304
 s_add_u32 s39, s35, 384
 buffer_load_dwordx4 v244, s[8:11], s39 offen offset:0 lds
 s_add_u32 s39, s35, 64896
 buffer_load_dwordx4 v245, s[8:11], s39 offen offset:1024 lds
 s_add_u32 s39, s35, 129408
 buffer_load_dwordx4 v244, s[8:11], s39 offen offset:2048 lds
 s_add_u32 s39, s35, 193920
 buffer_load_dwordx4 v245, s[8:11], s39 offen offset:3072 lds
 s_cmp_eq_u32 s32, 0
 s_cbranch_scc0 KA_NTL1
 v_mov_b32 v251, 0
 s_waitcnt vmcnt(5)
 s_mov_b64 exec, 1
 ds_write_b32 v251, v252
 ds_write_b64 v251, v[254:255] offset:8
 s_mov_b64 exec, -1
 s_waitcnt lgkmcnt(0)
KA_NTL1:
 v_mfma_f32_16x16x32_bf16 v[140:143], v[52:55], v[200:203], v[140:143]
 ds_read_b64_tr_b16 v[224:225], v235 offset:61440
 v_mfma_f32_16x16x32_bf16 v[144:147], v[56:59], v[200:203], v[144:147]
 ds_read_b64_tr_b16 v[226:227], v235 offset:61952
 s_waitcnt lgkmcnt(10)
 v_cvt_pk_bf16_f32 v171, v178, v179
 v_mfma_f32_16x16x32_bf16 v[148:151], v[52:55], v[204:207], v[148:151]
 ds_read_b64_tr_b16 v[196:197], v236 offset:0
 v_mfma_f32_16x16x32_bf16 v[152:155], v[56:59], v[204:207], v[152:155]
 ds_read_b64_tr_b16 v[198:199], v236 offset:512
 s_waitcnt lgkmcnt(10)
 v_mfma_f32_16x16x32_bf16 v[156:159], v[52:55], v[208:211], v[156:159]
 ds_read_b64_tr_b16 v[200:201], v237 offset:0
 v_mfma_f32_16x16x32_bf16 v[160:163], v[56:59], v[208:211], v[160:163]
 ds_read_b64_tr_b16 v[202:203], v237 offset:512
 s_waitcnt lgkmcnt(10)
 buffer_store_dwordx4 v[168:171], v247, s[16:19], s94 offen offset:128 sc1
 v_mfma_f32_16x16x32_bf16 v[132:135], v[60:63], v[212:215], v[132:135]
 ds_read_b64_tr_b16 v[204:205], v238 offset:0
 v_mfma_f32_16x16x32_bf16 v[136:139], v[64:67], v[212:215], v[136:139]
 ds_read_b64_tr_b16 v[206:207], v238 offset:512
 s_waitcnt lgkmcnt(10)
 v_mfma_f32_16x16x32_bf16 v[140:143], v[60:63], v[216:219], v[140:143]
 ds_read_b64_tr_b16 v[208:209], v239 offset:0
 v_mfma_f32_16x16x32_bf16 v[144:147], v[64:67], v[216:219], v[144:147]
 ds_read_b64_tr_b16 v[210:211], v239 offset:512
 s_waitcnt lgkmcnt(10)
 v_mfma_f32_16x16x32_bf16 v[148:151], v[60:63], v[220:223], v[148:151]
 ds_read_b64_tr_b16 v[212:213], v236 offset:4096
 v_mfma_f32_16x16x32_bf16 v[152:155], v[64:67], v[220:223], v[152:155]
 ds_read_b64_tr_b16 v[214:215], v236 offset:4608
 s_waitcnt lgkmcnt(10)
 s_add_u32 s94, s95, 0x3000
 v_mfma_f32_16x16x32_bf16 v[156:159], v[60:63], v[224:227], v[156:159]
 ds_read_b64_tr_b16 v[216:217], v237 offset:4096
 v_mfma_f32_16x16x32_bf16 v[160:163], v[64:67], v[224:227], v[160:163]
 ds_read_b64_tr_b16 v[218:219], v237 offset:4608
 s_waitcnt lgkmcnt(10)
 v_mfma_f32_16x16x32_bf16 v[132:135], v[68:71], v[196:199], v[132:135]
 ds_read_b64_tr_b16 v[220:221], v238 offset:4096
 v_mfma_f32_16x16x32_bf16 v[136:139], v[72:75], v[196:199], v[136:139]
 ds_read_b64_tr_b16 v[222:223], v238 offset:4608
 s_waitcnt lgkmcnt(10)
 v_cvt_pk_bf16_f32 v180, v180, v181
 v_mfma_f32_16x16x32_bf16 v[140:143], v[68:71], v[200:203], v[140:143]
 ds_read_b64_tr_b16 v[224:225], v239 offset:4096
 v_mfma_f32_16x16x32_bf16 v[144:147], v[72:75], v[200:203], v[144:147]
 ds_read_b64_tr_b16 v[226:227], v239 offset:4608
 s_waitcnt lgkmcnt(10)
 v_mfma_f32_16x16x32_bf16 v[148:151], v[68:71], v[204:207], v[148:151]
 ds_read_b64_tr_b16 v[196:197], v236 offset:8192
 v_mfma_f32_16x16x32_bf16 v[152:155], v[72:75], v[204:207], v[152:155]
 ds_read_b64_tr_b16 v[198:199], v236 offset:8704
 s_waitcnt lgkmcnt(10)
 v_cvt_pk_bf16_f32 v181, v182, v183
 v_mfma_f32_16x16x32_bf16 v[156:159], v[68:71], v[208:211], v[156:159]
 ds_read_b64_tr_b16 v[200:201], v237 offset:8192
 v_mfma_f32_16x16x32_bf16 v[160:163], v[72:75], v[208:211], v[160:163]
 ds_read_b64_tr_b16 v[202:203], v237 offset:8704
 s_waitcnt lgkmcnt(10)
 v_mfma_f32_16x16x32_bf16 v[132:135], v[76:79], v[212:215], v[132:135]
 ds_read_b64_tr_b16 v[204:205], v238 offset:8192
 v_mfma_f32_16x16x32_bf16 v[136:139], v[80:83], v[212:215], v[136:139]
 ds_read_b64_tr_b16 v[206:207], v238 offset:8704
 s_waitcnt lgkmcnt(10)
 v_cvt_pk_bf16_f32 v182, v184, v185
 v_mfma_f32_16x16x32_bf16 v[140:143], v[76:79], v[216:219], v[140:143]
 ds_read_b64_tr_b16 v[208:209], v239 offset:8192
 v_mfma_f32_16x16x32_bf16 v[144:147], v[80:83], v[216:219], v[144:147]
 ds_read_b64_tr_b16 v[210:211], v239 offset:8704
 s_waitcnt lgkmcnt(10)
 v_mfma_f32_16x16x32_bf16 v[148:151], v[76:79], v[220:223], v[148:151]
 ds_read_b64_tr_b16 v[212:213], v236 offset:12288
 v_mfma_f32_16x16x32_bf16 v[152:155], v[80:83], v[220:223], v[152:155]
 ds_read_b64_tr_b16 v[214:215], v236 offset:12800
 s_waitcnt lgkmcnt(10)
 v_cvt_pk_bf16_f32 v183, v186, v187
 v_mfma_f32_16x16x32_bf16 v[156:159], v[76:79], v[224:227], v[156:159]
 ds_read_b64_tr_b16 v[216:217], v237 offset:12288
 v_mfma_f32_16x16x32_bf16 v[160:163], v[80:83], v[224:227], v[160:163]
 ds_read_b64_tr_b16 v[218:219], v237 offset:12800
 s_waitcnt lgkmcnt(10)
 v_mfma_f32_16x16x32_bf16 v[132:135], v[84:87], v[196:199], v[132:135]
 ds_read_b64_tr_b16 v[220:221], v238 offset:12288
 v_mfma_f32_16x16x32_bf16 v[136:139], v[88:91], v[196:199], v[136:139]
 ds_read_b64_tr_b16 v[222:223], v238 offset:12800
 s_waitcnt lgkmcnt(10)
 v_mfma_f32_16x16x32_bf16 v[140:143], v[84:87], v[200:203], v[140:143]
 ds_read_b64_tr_b16 v[224:225], v239 offset:12288
 v_mfma_f32_16x16x32_bf16 v[144:147], v[88:91], v[200:203], v[144:147]
 ds_read_b64_tr_b16 v[226:227], v239 offset:12800
 s_waitcnt lgkmcnt(10)
 buffer_store_dwordx4 v[180:183], v247, s[16:19], s94 offen offset:0 sc1
 v_mfma_f32_16x16x32_bf16 v[148:151], v[84:87], v[204:207], v[148:151]
 ds_read_b64_tr_b16 v[196:197], v236 offset:16384
 v_mfma_f32_16x16x32_bf16 v[152:155], v[88:91], v[204:207], v[152:155]
 ds_read_b64_tr_b16 v[198:199], v236 offset:16896
 s_waitcnt lgkmcnt(10)
 v_mfma_f32_16x16x32_bf16 v[156:159], v[84:87], v[208:211], v[156:159]
 ds_read_b64_tr_b16 v[200:201], v237 offset:16384
 v_mfma_f32_16x16x32_bf16 v[160:163], v[88:91], v[208:211], v[160:163]
 ds_read_b64_tr_b16 v[202:203], v237 offset:16896
 s_waitcnt lgkmcnt(10)
 v_cvt_pk_bf16_f32 v184, v188, v189
 v_mfma_f32_16x16x32_bf16 v[132:135], v[92:95], v[212:215], v[132:135]
 ds_read_b64_tr_b16 v[204:205], v238 offset:16384
 v_mfma_f32_16x16x32_bf16 v[136:139], v[96:99], v[212:215], v[136:139]
 ds_read_b64_tr_b16 v[206:207], v238 offset:16896
 s_waitcnt lgkmcnt(10)
 v_mfma_f32_16x16x32_bf16 v[140:143], v[92:95], v[216:219], v[140:143]
 ds_read_b64_tr_b16 v[208:209], v239 offset:16384
 v_mfma_f32_16x16x32_bf16 v[144:147], v[96:99], v[216:219], v[144:147]
 ds_read_b64_tr_b16 v[210:211], v239 offset:16896
 s_waitcnt lgkmcnt(10)
 v_cvt_pk_bf16_f32 v185, v190, v191
 v_mfma_f32_16x16x32_bf16 v[148:151], v[92:95], v[220:223], v[148:151]
 ds_read_b64_tr_b16 v[212:213], v236 offset:20480
 v_mfma_f32_16x16x32_bf16 v[152:155], v[96:99], v[220:223], v[152:155]
 ds_read_b64_tr_b16 v[214:215], v236 offset:20992
 s_waitcnt lgkmcnt(10)
 v_mfma_f32_16x16x32_bf16 v[156:159], v[92:95], v[224:227], v[156:159]
 ds_read_b64_tr_b16 v[216:217], v237 offset:20480
 v_mfma_f32_16x16x32_bf16 v[160:163], v[96:99], v[224:227], v[160:163]
 ds_read_b64_tr_b16 v[218:219], v237 offset:20992
 s_waitcnt lgkmcnt(10)
 v_cvt_pk_bf16_f32 v186, v192, v193
 v_mfma_f32_16x16x32_bf16 v[132:135], v[100:103], v[196:199], v[132:135]
 ds_read_b64_tr_b16 v[220:221], v238 offset:20480
 v_mfma_f32_16x16x32_bf16 v[136:139], v[104:107], v[196:199], v[136:139]
 ds_read_b64_tr_b16 v[222:223], v238 offset:20992
 s_waitcnt lgkmcnt(10)
 v_mfma_f32_16x16x32_bf16 v[140:143], v[100:103], v[200:203], v[140:143]
 ds_read_b64_tr_b16 v[224:225], v239 offset:20480
 v_mfma_f32_16x16x32_bf16 v[144:147], v[104:107], v[200:203], v[144:147]
 ds_read_b64_tr_b16 v[226:227], v239 offset:20992
 s_waitcnt lgkmcnt(10)
 v_cvt_pk_bf16_f32 v187, v194, v195
 v_mfma_f32_16x16x32_bf16 v[148:151], v[100:103], v[204:207], v[148:151]
 ds_read_b64_tr_b16 v[196:197], v236 offset:24576
 v_mfma_f32_16x16x32_bf16 v[152:155], v[104:107], v[204:207], v[152:155]
 ds_read_b64_tr_b16 v[198:199], v236 offset:25088
 s_waitcnt lgkmcnt(10)
 v_mfma_f32_16x16x32_bf16 v[156:159], v[100:103], v[208:211], v[156:159]
 ds_read_b64_tr_b16 v[200:201], v237 offset:24576
 v_mfma_f32_16x16x32_bf16 v[160:163], v[104:107], v[208:211], v[160:163]
 ds_read_b64_tr_b16 v[202:203], v237 offset:25088
 s_waitcnt lgkmcnt(10)
 buffer_store_dwordx4 v[184:187], v247, s[16:19], s94 offen offset:128 sc1
 v_mfma_f32_16x16x32_bf16 v[132:135], v[108:111], v[212:215], v[132:135]
 ds_read_b64_tr_b16 v[204:205], v238 offset:24576
 v_mfma_f32_16x16x32_bf16 v[136:139], v[112:115], v[212:215], v[136:139]
 ds_read_b64_tr_b16 v[206:207], v238 offset:25088
 s_waitcnt lgkmcnt(10)
 v_mfma_f32_16x16x32_bf16 v[140:143], v[108:111], v[216:219], v[140:143]
 ds_read_b64_tr_b16 v[208:209], v239 offset:24576
 v_mfma_f32_16x16x32_bf16 v[144:147], v[112:115], v[216:219], v[144:147]
 ds_read_b64_tr_b16 v[210:211], v239 offset:25088
 s_waitcnt lgkmcnt(10)
 v_mfma_f32_16x16x32_bf16 v[148:151], v[108:111], v[220:223], v[148:151]
 ds_read_b64_tr_b16 v[212:213], v236 offset:28672
 v_mfma_f32_16x16x32_bf16 v[152:155], v[112:115], v[220:223], v[152:155]
 ds_read_b64_tr_b16 v[214:215], v236 offset:29184
 s_waitcnt lgkmcnt(10)
 v_mfma_f32_16x16x32_bf16 v[156:159], v[108:111], v[224:227], v[156:159]
 ds_read_b64_tr_b16 v[216:217], v237 offset:28672
 v_mfma_f32_16x16x32_bf16 v[160:163], v[112:115], v[224:227], v[160:163]
 ds_read_b64_tr_b16 v[218:219], v237 offset:29184
 s_waitcnt lgkmcnt(10)
 v_mfma_f32_16x16x32_bf16 v[132:135], v[116:119], v[196:199], v[132:135]
 ds_read_b64_tr_b16 v[220:221], v238 offset:28672
 v_mfma_f32_16x16x32_bf16 v[136:139], v[120:123], v[196:199], v[136:139]
 ds_read_b64_tr_b16 v[222:223], v238 offset:29184
 s_waitcnt lgkmcnt(10)
 s_waitcnt vmcnt(3)
 s_barrier
 s_add_u32 m0, s36, 131072
 s_add_u32 s39, s43, 384
 buffer_load_dwordx4 v244, s[8:11], s39 offen offset:0 lds
 s_add_u32 s39, s43, 64896
 buffer_load_dwordx4 v245, s[8:11], s39 offen offset:1024 lds
 s_add_u32 s39, s43, 129408
 buffer_load_dwordx4 v244, s[8:11], s39 offen offset:2048 lds
 s_add_u32 s39, s43, 193920
 buffer_load_dwordx4 v245, s[8:11], s39 offen offset:3072 lds
 v_mov_b32 v251, 0
 ds_read_b32 v252, v251
 ds_read_b64 v[254:255], v251 offset:8
 v_mfma_f32_16x16x32_bf16 v[140:143], v[116:119], v[200:203], v[140:143]
 ds_read_b64_tr_b16 v[224:225], v239 offset:28672
 v_mfma_f32_16x16x32_bf16 v[144:147], v[120:123], v[200:203], v[144:147]
 ds_read_b64_tr_b16 v[226:227], v239 offset:29184
 s_waitcnt lgkmcnt(12)
 v_mfma_f32_16x16x32_bf16 v[148:151], v[116:119], v[204:207], v[148:151]
 ds_read_b64_tr_b16 v[196:197], v236 offset:32768
 v_mfma_f32_16x16x32_bf16 v[152:155], v[120:123], v[204:207], v[152:155]
 ds_read_b64_tr_b16 v[198:199], v236 offset:33280
 s_waitcnt lgkmcnt(12)
 v_mfma_f32_16x16x32_bf16 v[156:159], v[116:119], v[208:211], v[156:159]
 ds_read_b64_tr_b16 v[200:201], v237 offset:32768
 v_mfma_f32_16x16x32_bf16 v[160:163], v[120:123], v[208:211], v[160:163]
 ds_read_b64_tr_b16 v[202:203], v237 offset:33280
 s_waitcnt lgkmcnt(12)
 v_mfma_f32_16x16x32_bf16 v[132:135], v[124:127], v[212:215], v[132:135]
 ds_read_b64_tr_b16 v[204:205], v238 offset:32768
 v_mfma_f32_16x16x32_bf16 v[136:139], v[128:131], v[212:215], v[136:139]
 ds_read_b64_tr_b16 v[206:207], v238 offset:33280
 s_waitcnt lgkmcnt(12)
 v_mfma_f32_16x16x32_bf16 v[140:143], v[124:127], v[216:219], v[140:143]
 ds_read_b64_tr_b16 v[208:209], v239 offset:32768
 v_mfma_f32_16x16x32_bf16 v[144:147], v[128:131], v[216:219], v[144:147]
 ds_read_b64_tr_b16 v[210:211], v239 offset:33280
 s_waitcnt lgkmcnt(12)
 v_mfma_f32_16x16x32_bf16 v[148:151], v[124:127], v[220:223], v[148:151]
 ds_read_b64_tr_b16 v[212:213], v236 offset:36864
 v_mfma_f32_16x16x32_bf16 v[152:155], v[128:131], v[220:223], v[152:155]
 ds_read_b64_tr_b16 v[214:215], v236 offset:37376
 s_waitcnt lgkmcnt(10)
 s_waitcnt lgkmcnt(12)
 s_cmp_eq_u32 s92, 0
 s_cbranch_scc0 KA_NTD1
 v_readfirstlane_b32 s38, v252
 s_mov_b32 s46, 0x2010800
 s_mov_b32 s47, 0xc04030a
 s_lshr_b32 s39, s38, 3
 s_mov_b32 s48, 0x9051810
 s_mov_b32 s49, 0xe061911
 s_cmp_eq_u32 s39, 1
 s_cselect_b64 s[46:47], s[48:49], s[46:47]
 s_mov_b32 s48, 0xb071a12
 s_mov_b32 s49, 0x1c141b13
 s_cmp_eq_u32 s39, 2
 s_cselect_b64 s[46:47], s[48:49], s[46:47]
 s_mov_b32 s48, 0x161d150d
 s_mov_b32 s49, 0x1f170f1e
 s_cmp_eq_u32 s39, 3
 s_cselect_b64 s[46:47], s[48:49], s[46:47]
 s_and_b32 s38, s38, 7
 s_lshl_b32 s38, s38, 3
 s_lshr_b64 s[46:47], s[46:47], s38
 s_and_b32 s46, s46, 31
 s_bfe_u32 s38, s2, 0x10002
 s_xor_b32 s46, s46, s38
 s_lshl_b32 s46, s46, 3
 s_and_b32 s38, s2, 7
 s_or_b32 s46, s46, s38
 s_lshl_b32 s46, s46, 8
 s_or_b32 s93, s46, s2
KA_NTD1:
 s_bfe_u32 s90, s93, 0x3000b
 s_sub_u32 s3, 15, s90
 s_cmp_lt_u32 s32, 4
 s_cselect_b32 s90, s3, s90
 s_lshl_b32 s90, s90, 7
 v_mfma_f32_16x16x32_bf16 v[156:159], v[124:127], v[224:227], v[156:159]
 ds_read_b64_tr_b16 v[216:217], v237 offset:36864
 v_mfma_f32_16x16x32_bf16 v[160:163], v[128:131], v[224:227], v[160:163]
 ds_read_b64_tr_b16 v[218:219], v237 offset:37376
 s_waitcnt lgkmcnt(10)
 buffer_load_dwordx4 v[248:251], v253, s[96:99], s90 offen sc1
 v_mfma_f32_16x16x32_bf16 v[164:167], v[4:7], v[196:199], 0
 ds_read_b64_tr_b16 v[220:221], v238 offset:36864
 v_mfma_f32_16x16x32_bf16 v[168:171], v[8:11], v[196:199], 0
 ds_read_b64_tr_b16 v[222:223], v238 offset:37376
 s_waitcnt lgkmcnt(10)
 v_mfma_f32_16x16x32_bf16 v[172:175], v[4:7], v[200:203], 0
 ds_read_b64_tr_b16 v[224:225], v239 offset:36864
 v_mfma_f32_16x16x32_bf16 v[176:179], v[8:11], v[200:203], 0
 ds_read_b64_tr_b16 v[226:227], v239 offset:37376
 s_waitcnt lgkmcnt(10)
 s_lshr_b32 s54, s55, 2
 s_and_b32 s24, s55, 3
 s_lshr_b32 s77, s93, 8
 s_and_b32 s41, s77, 7
 s_lshl_b32 s41, s41, 2
 s_lshr_b32 s42, s77, 6
 s_add_u32 s25, s41, s42
 s_lshr_b32 s43, s77, 3
 s_and_b32 s43, s43, 7
 s_sub_u32 s26, 15, s43
 s_lshl_b32 s27, s26, 1
 s_add_u32 s27, s27, 2
 s_lshl_b32 s28, s43, 1
 s_add_u32 s28, s28, 2
 s_mov_b32 s29, s27
 s_lshl_b32 s40, s24, 12
 s_lshl_b32 s39, s25, 19
 s_add_u32 s39, s39, s40
 s_cmp_eq_u32 s54, 0
 s_cselect_b32 s26, s26, s43
 s_cselect_b32 s27, s27, s28
 s_mov_b32 s75, s26
 s_lshl_b32 s75, s75, 2
 s_add_u32 s75, s75, s24
 s_lshl_b32 s72, s55, 16
 s_lshl_b32 s41, s25, 8
 s_add_u32 s72, s72, s41
 s_lshl_b32 s74, s55, 11
 s_mul_i32 s76, s75, 90112
 s_mov_b32 s78, s25
 v_mfma_f32_16x16x32_bf16 v[180:183], v[4:7], v[204:207], 0
 ds_read_b64_tr_b16 v[196:197], v236 offset:40960
 v_mfma_f32_16x16x32_bf16 v[184:187], v[8:11], v[204:207], 0
 ds_read_b64_tr_b16 v[198:199], v236 offset:41472
 s_waitcnt lgkmcnt(10)
 s_lshr_b32 s41, s25, 2
 s_and_b32 s42, s25, 3
 s_lshr_b32 s77, s41, 2
 s_xor_b32 s77, s77, s43
 s_and_b32 s77, s77, 1
 s_lshl_b32 s77, s77, 1
 s_add_u32 s37, s42, s77
 s_cmp_eq_u32 s42, 0
 s_cselect_b32 s37, 0, s37
 s_add_u32 s79, s41, 32
 s_and_b32 s41, s41, 3
 s_add_u32 s41, s41, 40
 s_cmp_eq_u32 s42, 0
 s_cselect_b32 s79, s79, s41
 s_cmp_eq_u32 s54, 0
 s_cselect_b32 s41, s78, s79
 s_lshl_b32 s73, s41, 6
 s_mul_i32 s77, s24, 44032
 s_add_u32 s73, s73, s77
 s_cmp_ge_u32 s41, 43
 s_cselect_b32 s73, 0x40000000, s73
 v_mfma_f32_16x16x32_bf16 v[188:191], v[4:7], v[208:211], 0
 ds_read_b64_tr_b16 v[200:201], v237 offset:40960
 v_mfma_f32_16x16x32_bf16 v[192:195], v[8:11], v[208:211], 0
 ds_read_b64_tr_b16 v[202:203], v237 offset:41472
 s_waitcnt lgkmcnt(10)
 s_mov_b32 s60, s6
 s_and_b32 s61, s7, 0xffff
 s_mov_b32 s62, 0x400000
 s_mov_b32 s63, 0x00020000
 s_mov_b32 s8, s4
 s_and_b32 s9, s5, 0xffff
 s_mov_b32 s10, 0x200000
 s_mov_b32 s11, 0x00020000
 s_mov_b32 s31, s39
 s_mov_b32 s33, s39
 s_mov_b32 s35, s40
 s_add_u32 s36, s40, 16384
 s_mov_b32 s32, 3
 s_mov_b32 s64, s52
 s_and_b32 s65, s53, 0xffff
 s_mov_b32 s66, 0x158000
 s_mov_b32 s67, 0x00020000
 v_mfma_f32_16x16x32_bf16 v[164:167], v[12:15], v[212:215], v[164:167]
 ds_read_b64_tr_b16 v[204:205], v238 offset:40960
 v_mfma_f32_16x16x32_bf16 v[168:171], v[16:19], v[212:215], v[168:171]
 ds_read_b64_tr_b16 v[206:207], v238 offset:41472
 s_waitcnt lgkmcnt(10)
 v_lshrrev_b32 v230, 5, v0
 v_lshrrev_b32 v228, 2, v0
 v_and_b32 v229, 3, v0
 v_xor_b32 v229, v229, v230
 v_lshlrev_b32 v229, 4, v229
 v_mul_u32_u24 v228, 2752, v228
 v_add_u32 v245, v228, v229
 v_lshrrev_b32 v229, 3, v0
 v_and_b32 v228, 7, v0
 v_bfe_u32 v230, v0, 4, 1
 v_lshlrev_b32 v230, 2, v230
 v_xor_b32 v230, v230, v228
 s_and_b32 s3, s55, 1
 v_xor_b32 v230, s3, v230
 v_lshlrev_b32 v230, 4, v230
 v_lshl_add_u32 v244, v229, 13, v230
 v_mfma_f32_16x16x32_bf16 v[172:175], v[12:15], v[216:219], v[172:175]
 ds_read_b64_tr_b16 v[208:209], v239 offset:40960
 v_mfma_f32_16x16x32_bf16 v[176:179], v[16:19], v[216:219], v[176:179]
 ds_read_b64_tr_b16 v[210:211], v239 offset:41472
 s_waitcnt lgkmcnt(10)
 s_add_u32 m0, s74, 896
 s_add_u32 s41, s72, 0
 buffer_load_dwordx4 v244, s[60:63], s41 offen offset:128 lds
 s_add_u32 s94, s95, 0x80000
 v_mfma_f32_16x16x32_bf16 v[180:183], v[12:15], v[220:223], v[180:183]
 ds_read_b64_tr_b16 v[212:213], v236 offset:45056
 v_mfma_f32_16x16x32_bf16 v[184:187], v[16:19], v[220:223], v[184:187]
 ds_read_b64_tr_b16 v[214:215], v236 offset:45568
 s_waitcnt lgkmcnt(10)
 v_mfma_f32_16x16x32_bf16 v[188:191], v[12:15], v[224:227], v[188:191]
 ds_read_b64_tr_b16 v[216:217], v237 offset:45056
 v_mfma_f32_16x16x32_bf16 v[192:195], v[16:19], v[224:227], v[192:195]
 ds_read_b64_tr_b16 v[218:219], v237 offset:45568
 s_waitcnt lgkmcnt(10)
 v_cvt_pk_bf16_f32 v132, v132, v133
 v_mfma_f32_16x16x32_bf16 v[164:167], v[20:23], v[196:199], v[164:167]
 ds_read_b64_tr_b16 v[220:221], v238 offset:45056
 v_mfma_f32_16x16x32_bf16 v[168:171], v[24:27], v[196:199], v[168:171]
 ds_read_b64_tr_b16 v[222:223], v238 offset:45568
 s_waitcnt lgkmcnt(10)
 v_mfma_f32_16x16x32_bf16 v[172:175], v[20:23], v[200:203], v[172:175]
 ds_read_b64_tr_b16 v[224:225], v239 offset:45056
 v_mfma_f32_16x16x32_bf16 v[176:179], v[24:27], v[200:203], v[176:179]
 ds_read_b64_tr_b16 v[226:227], v239 offset:45568
 s_waitcnt lgkmcnt(10)
 s_lshr_b32 s41, s74, 1
 s_add_u32 m0, s41, 16384
 s_add_u32 s41, s73, 0
 buffer_load_dwordx4 v245, s[64:67], s41 offen lds
 v_cvt_pk_bf16_f32 v133, v134, v135
 v_mfma_f32_16x16x32_bf16 v[180:183], v[20:23], v[204:207], v[180:183]
 ds_read_b64_tr_b16 v[196:197], v236 offset:49152
 v_mfma_f32_16x16x32_bf16 v[184:187], v[24:27], v[204:207], v[184:187]
 ds_read_b64_tr_b16 v[198:199], v236 offset:49664
 s_waitcnt lgkmcnt(10)
 v_cvt_pk_bf16_f32 v134, v136, v137
 v_mfma_f32_16x16x32_bf16 v[188:191], v[20:23], v[208:211], v[188:191]
 ds_read_b64_tr_b16 v[200:201], v237 offset:49152
 v_mfma_f32_16x16x32_bf16 v[192:195], v[24:27], v[208:211], v[192:195]
 ds_read_b64_tr_b16 v[202:203], v237 offset:49664
 s_waitcnt lgkmcnt(10)
 v_mfma_f32_16x16x32_bf16 v[164:167], v[28:31], v[212:215], v[164:167]
 ds_read_b64_tr_b16 v[204:205], v238 offset:49152
 v_mfma_f32_16x16x32_bf16 v[168:171], v[32:35], v[212:215], v[168:171]
 ds_read_b64_tr_b16 v[206:207], v238 offset:49664
 s_waitcnt lgkmcnt(10)
 v_cvt_pk_bf16_f32 v135, v138, v139
 v_mfma_f32_16x16x32_bf16 v[172:175], v[28:31], v[216:219], v[172:175]
 ds_read_b64_tr_b16 v[208:209], v239 offset:49152
 v_mfma_f32_16x16x32_bf16 v[176:179], v[32:35], v[216:219], v[176:179]
 ds_read_b64_tr_b16 v[210:211], v239 offset:49664
 s_waitcnt lgkmcnt(10)
 s_add_u32 m0, s74, 24576
 s_add_u32 s41, s72, 524288
 buffer_load_dwordx4 v244, s[60:63], s41 offen offset:0 lds
 v_mfma_f32_16x16x32_bf16 v[180:183], v[28:31], v[220:223], v[180:183]
 ds_read_b64_tr_b16 v[212:213], v236 offset:53248
 v_mfma_f32_16x16x32_bf16 v[184:187], v[32:35], v[220:223], v[184:187]
 ds_read_b64_tr_b16 v[214:215], v236 offset:53760
 s_waitcnt lgkmcnt(10)
 buffer_store_dwordx4 v[132:135], v247, s[16:19], s94 offen offset:0 sc1
 v_mfma_f32_16x16x32_bf16 v[188:191], v[28:31], v[224:227], v[188:191]
 ds_read_b64_tr_b16 v[216:217], v237 offset:53248
 v_mfma_f32_16x16x32_bf16 v[192:195], v[32:35], v[224:227], v[192:195]
 ds_read_b64_tr_b16 v[218:219], v237 offset:53760
 s_waitcnt lgkmcnt(10)
 v_mfma_f32_16x16x32_bf16 v[164:167], v[36:39], v[196:199], v[164:167]
 ds_read_b64_tr_b16 v[220:221], v238 offset:53248
 v_mfma_f32_16x16x32_bf16 v[168:171], v[40:43], v[196:199], v[168:171]
 ds_read_b64_tr_b16 v[222:223], v238 offset:53760
 s_waitcnt lgkmcnt(10)
 v_cvt_pk_bf16_f32 v136, v140, v141
 v_mfma_f32_16x16x32_bf16 v[172:175], v[36:39], v[200:203], v[172:175]
 ds_read_b64_tr_b16 v[224:225], v239 offset:53248
 v_mfma_f32_16x16x32_bf16 v[176:179], v[40:43], v[200:203], v[176:179]
 ds_read_b64_tr_b16 v[226:227], v239 offset:53760
 s_waitcnt lgkmcnt(10)
 s_add_u32 m0, s74, 25472
 s_add_u32 s41, s72, 524288
 buffer_load_dwordx4 v244, s[60:63], s41 offen offset:128 lds
 v_cvt_pk_bf16_f32 v137, v142, v143
 v_mfma_f32_16x16x32_bf16 v[180:183], v[36:39], v[204:207], v[180:183]
 ds_read_b64_tr_b16 v[196:197], v236 offset:57344
 v_mfma_f32_16x16x32_bf16 v[184:187], v[40:43], v[204:207], v[184:187]
 ds_read_b64_tr_b16 v[198:199], v236 offset:57856
 s_waitcnt lgkmcnt(10)
 v_mfma_f32_16x16x32_bf16 v[188:191], v[36:39], v[208:211], v[188:191]
 ds_read_b64_tr_b16 v[200:201], v237 offset:57344
 v_mfma_f32_16x16x32_bf16 v[192:195], v[40:43], v[208:211], v[192:195]
 ds_read_b64_tr_b16 v[202:203], v237 offset:57856
 s_waitcnt lgkmcnt(10)
 v_cvt_pk_bf16_f32 v138, v144, v145
 v_mfma_f32_16x16x32_bf16 v[164:167], v[44:47], v[212:215], v[164:167]
 ds_read_b64_tr_b16 v[204:205], v238 offset:57344
 v_mfma_f32_16x16x32_bf16 v[168:171], v[48:51], v[212:215], v[168:171]
 ds_read_b64_tr_b16 v[206:207], v238 offset:57856
 s_waitcnt lgkmcnt(10)
 v_mfma_f32_16x16x32_bf16 v[172:175], v[44:47], v[216:219], v[172:175]
 ds_read_b64_tr_b16 v[208:209], v239 offset:57344
 v_mfma_f32_16x16x32_bf16 v[176:179], v[48:51], v[216:219], v[176:179]
 ds_read_b64_tr_b16 v[210:211], v239 offset:57856
 s_waitcnt lgkmcnt(10)
 s_lshr_b32 s41, s74, 1
 s_add_u32 m0, s41, 40960
 s_add_u32 s41, s73, 176128
 buffer_load_dwordx4 v245, s[64:67], s41 offen lds
 v_cvt_pk_bf16_f32 v139, v146, v147
 v_mfma_f32_16x16x32_bf16 v[180:183], v[44:47], v[220:223], v[180:183]
 ds_read_b64_tr_b16 v[212:213], v236 offset:61440
 v_mfma_f32_16x16x32_bf16 v[184:187], v[48:51], v[220:223], v[184:187]
 ds_read_b64_tr_b16 v[214:215], v236 offset:61952
 s_waitcnt lgkmcnt(10)
 buffer_store_dwordx4 v[136:139], v247, s[16:19], s94 offen offset:128 sc1
 v_mfma_f32_16x16x32_bf16 v[188:191], v[44:47], v[224:227], v[188:191]
 ds_read_b64_tr_b16 v[216:217], v237 offset:61440
 v_mfma_f32_16x16x32_bf16 v[192:195], v[48:51], v[224:227], v[192:195]
 ds_read_b64_tr_b16 v[218:219], v237 offset:61952
 s_waitcnt lgkmcnt(10)
 v_mfma_f32_16x16x32_bf16 v[164:167], v[52:55], v[196:199], v[164:167]
 ds_read_b64_tr_b16 v[220:221], v238 offset:61440
 v_mfma_f32_16x16x32_bf16 v[168:171], v[56:59], v[196:199], v[168:171]
 ds_read_b64_tr_b16 v[222:223], v238 offset:61952
 s_waitcnt lgkmcnt(10)
 s_add_u32 s94, s95, 0x81000
 s_waitcnt vmcnt(8)
 s_barrier
 v_mfma_f32_16x16x32_bf16 v[172:175], v[52:55], v[200:203], v[172:175]
 ds_read_b64_tr_b16 v[224:225], v239 offset:61440
 v_mfma_f32_16x16x32_bf16 v[176:179], v[56:59], v[200:203], v[176:179]
 ds_read_b64_tr_b16 v[226:227], v239 offset:61952
 s_waitcnt lgkmcnt(10)
 v_mfma_f32_16x16x32_bf16 v[180:183], v[52:55], v[204:207], v[180:183]
 ds_read_b64_tr_b16 v[196:197], v240 offset:0
 v_mfma_f32_16x16x32_bf16 v[184:187], v[56:59], v[204:207], v[184:187]
 ds_read_b64_tr_b16 v[198:199], v240 offset:512
 s_waitcnt lgkmcnt(10)
 s_add_u32 m0, s74, 0
 s_add_u32 s41, s72, 0
 buffer_load_dwordx4 v244, s[60:63], s41 offen offset:0 lds
 v_cvt_pk_bf16_f32 v148, v148, v149
 v_mfma_f32_16x16x32_bf16 v[188:191], v[52:55], v[208:211], v[188:191]
 ds_read_b64_tr_b16 v[200:201], v241 offset:0
 v_mfma_f32_16x16x32_bf16 v[192:195], v[56:59], v[208:211], v[192:195]
 ds_read_b64_tr_b16 v[202:203], v241 offset:512
 s_waitcnt lgkmcnt(10)
 v_mfma_f32_16x16x32_bf16 v[164:167], v[60:63], v[212:215], v[164:167]
 ds_read_b64_tr_b16 v[204:205], v242 offset:0
 v_mfma_f32_16x16x32_bf16 v[168:171], v[64:67], v[212:215], v[168:171]
 ds_read_b64_tr_b16 v[206:207], v242 offset:512
 s_waitcnt lgkmcnt(10)
 v_cvt_pk_bf16_f32 v149, v150, v151
 v_mfma_f32_16x16x32_bf16 v[172:175], v[60:63], v[216:219], v[172:175]
 ds_read_b64_tr_b16 v[208:209], v243 offset:0
 v_mfma_f32_16x16x32_bf16 v[176:179], v[64:67], v[216:219], v[176:179]
 ds_read_b64_tr_b16 v[210:211], v243 offset:512
 s_waitcnt lgkmcnt(10)
 v_cvt_pk_bf16_f32 v150, v152, v153
 v_mfma_f32_16x16x32_bf16 v[180:183], v[60:63], v[220:223], v[180:183]
 ds_read_b64_tr_b16 v[212:213], v240 offset:4096
 v_mfma_f32_16x16x32_bf16 v[184:187], v[64:67], v[220:223], v[184:187]
 ds_read_b64_tr_b16 v[214:215], v240 offset:4608
 s_waitcnt lgkmcnt(10)
 v_mfma_f32_16x16x32_bf16 v[188:191], v[60:63], v[224:227], v[188:191]
 ds_read_b64_tr_b16 v[216:217], v241 offset:4096
 v_mfma_f32_16x16x32_bf16 v[192:195], v[64:67], v[224:227], v[192:195]
 ds_read_b64_tr_b16 v[218:219], v241 offset:4608
 s_waitcnt lgkmcnt(10)
 v_cvt_pk_bf16_f32 v151, v154, v155
 v_mfma_f32_16x16x32_bf16 v[164:167], v[68:71], v[196:199], v[164:167]
 ds_read_b64_tr_b16 v[220:221], v242 offset:4096
 v_mfma_f32_16x16x32_bf16 v[168:171], v[72:75], v[196:199], v[168:171]
 ds_read_b64_tr_b16 v[222:223], v242 offset:4608
 s_waitcnt lgkmcnt(10)
 v_lshrrev_b32 v24, 5, v0
 v_lshrrev_b32 v20, 2, v0
 v_and_b32 v21, 3, v0
 v_xor_b32 v21, v21, v24
 v_lshlrev_b32 v21, 4, v21
 v_lshl_add_u32 v16, v20, 13, v21
 v_mul_u32_u24 v20, 2752, v20
 v_add_u32 v17, v20, v21
 v_lshrrev_b32 v22, 4, v0
 v_bfe_u32 v20, v0, 2, 2
 v_lshl_add_u32 v23, v22, 3, v20
 v_lshlrev_b32 v23, 6, v23
 v_and_b32 v21, 1, v0
 v_lshl_add_u32 v23, v21, 3, v23
 v_bfe_u32 v21, v0, 1, 1
 v_lshl_add_u32 v23, v21, 5, v23
 v_and_b32 v21, 1, v22
 v_lshl_add_u32 v12, v21, 4, v23
 v_xor_b32 v13, 16, v12
 v_lshlrev_b32 v18, 10, v24
 v_lshl_add_u32 v18, v21, 9, v18
 v_bfe_u32 v20, v0, 3, 1
 v_lshl_add_u32 v18, v20, 8, v18
 v_and_b32 v20, 7, v0
 v_lshl_add_u32 v18, v20, 4, v18
 v_lshrrev_b32 v21, 3, v0
 v_and_b32 v20, 7, v0
 v_mfma_f32_16x16x32_bf16 v[172:175], v[68:71], v[200:203], v[172:175]
 ds_read_b64_tr_b16 v[224:225], v243 offset:4096
 v_mfma_f32_16x16x32_bf16 v[176:179], v[72:75], v[200:203], v[176:179]
 ds_read_b64_tr_b16 v[226:227], v243 offset:4608
 s_waitcnt lgkmcnt(10)
 v_bfe_u32 v22, v0, 4, 1
 v_lshlrev_b32 v22, 2, v22
 v_xor_b32 v22, v22, v20
 s_and_b32 s3, s55, 1
 v_xor_b32 v22, s3, v22
 v_lshlrev_b32 v22, 4, v22
 v_lshl_add_u32 v16, v21, 13, v22
 s_lshl_b32 s34, s55, 13
 s_add_u32 s34, s34, 98304
 s_cmp_eq_u32 s55, 7
 s_cselect_b32 s34, 0x10000, s34
 v_add_u32 v19, s34, v18
 buffer_store_dwordx4 v[148:151], v247, s[16:19], s94 offen offset:0 sc1
 v_mfma_f32_16x16x32_bf16 v[180:183], v[68:71], v[204:207], v[180:183]
 ds_read_b64_tr_b16 v[196:197], v240 offset:8192
 v_mfma_f32_16x16x32_bf16 v[184:187], v[72:75], v[204:207], v[184:187]
 ds_read_b64_tr_b16 v[198:199], v240 offset:8704
 s_waitcnt lgkmcnt(10)
 v_mfma_f32_16x16x32_bf16 v[188:191], v[68:71], v[208:211], v[188:191]
 ds_read_b64_tr_b16 v[200:201], v241 offset:8192
 v_mfma_f32_16x16x32_bf16 v[192:195], v[72:75], v[208:211], v[192:195]
 ds_read_b64_tr_b16 v[202:203], v241 offset:8704
 s_waitcnt lgkmcnt(10)
 v_cvt_pk_bf16_f32 v152, v156, v157
 v_mfma_f32_16x16x32_bf16 v[164:167], v[76:79], v[212:215], v[164:167]
 ds_read_b64_tr_b16 v[204:205], v242 offset:8192
 v_mfma_f32_16x16x32_bf16 v[168:171], v[80:83], v[212:215], v[168:171]
 ds_read_b64_tr_b16 v[206:207], v242 offset:8704
 s_waitcnt lgkmcnt(10)
 v_cvt_pk_bf16_f32 v153, v158, v159
 v_mfma_f32_16x16x32_bf16 v[172:175], v[76:79], v[216:219], v[172:175]
 ds_read_b64_tr_b16 v[208:209], v243 offset:8192
 v_mfma_f32_16x16x32_bf16 v[176:179], v[80:83], v[216:219], v[176:179]
 ds_read_b64_tr_b16 v[210:211], v243 offset:8704
 s_waitcnt lgkmcnt(10)
 v_mfma_f32_16x16x32_bf16 v[180:183], v[76:79], v[220:223], v[180:183]
 ds_read_b64_tr_b16 v[212:213], v240 offset:12288
 v_mfma_f32_16x16x32_bf16 v[184:187], v[80:83], v[220:223], v[184:187]
 ds_read_b64_tr_b16 v[214:215], v240 offset:12800
 s_waitcnt lgkmcnt(10)
 v_cvt_pk_bf16_f32 v154, v160, v161
 v_mfma_f32_16x16x32_bf16 v[188:191], v[76:79], v[224:227], v[188:191]
 ds_read_b64_tr_b16 v[216:217], v241 offset:12288
 v_mfma_f32_16x16x32_bf16 v[192:195], v[80:83], v[224:227], v[192:195]
 ds_read_b64_tr_b16 v[218:219], v241 offset:12800
 s_waitcnt lgkmcnt(10)
 v_mfma_f32_16x16x32_bf16 v[164:167], v[84:87], v[196:199], v[164:167]
 ds_read_b64_tr_b16 v[220:221], v242 offset:12288
 v_mfma_f32_16x16x32_bf16 v[168:171], v[88:91], v[196:199], v[168:171]
 ds_read_b64_tr_b16 v[222:223], v242 offset:12800
 s_waitcnt lgkmcnt(10)
 v_cvt_pk_bf16_f32 v155, v162, v163
 v_mfma_f32_16x16x32_bf16 v[172:175], v[84:87], v[200:203], v[172:175]
 ds_read_b64_tr_b16 v[224:225], v243 offset:12288
 v_mfma_f32_16x16x32_bf16 v[176:179], v[88:91], v[200:203], v[176:179]
 ds_read_b64_tr_b16 v[226:227], v243 offset:12800
 s_waitcnt lgkmcnt(10)
 buffer_store_dwordx4 v[152:155], v247, s[16:19], s94 offen offset:128 sc1
 v_mfma_f32_16x16x32_bf16 v[180:183], v[84:87], v[204:207], v[180:183]
 ds_read_b64_tr_b16 v[196:197], v240 offset:16384
 v_mfma_f32_16x16x32_bf16 v[184:187], v[88:91], v[204:207], v[184:187]
 ds_read_b64_tr_b16 v[198:199], v240 offset:16896
 s_waitcnt lgkmcnt(10)
 v_mfma_f32_16x16x32_bf16 v[188:191], v[84:87], v[208:211], v[188:191]
 ds_read_b64_tr_b16 v[200:201], v241 offset:16384
 v_mfma_f32_16x16x32_bf16 v[192:195], v[88:91], v[208:211], v[192:195]
 ds_read_b64_tr_b16 v[202:203], v241 offset:16896
 s_waitcnt lgkmcnt(10)
 v_lshrrev_b32 v22, 4, v0
 v_bfe_u32 v20, v0, 2, 2
 v_lshl_add_u32 v23, v22, 4, v20
 v_lshlrev_b32 v23, 7, v23
 v_and_b32 v21, 1, v0
 v_lshl_add_u32 v23, v21, 3, v23
 v_bfe_u32 v21, v0, 1, 1
 v_lshl_add_u32 v23, v21, 5, v23
 v_bfe_u32 v21, v0, 3, 1
 v_lshl_add_u32 v23, v21, 6, v23
 v_and_b32 v21, 1, v22
 v_lshl_add_u32 v4, v21, 4, v23
 v_xor_b32 v5, 16, v4
 v_xor_b32 v6, 64, v4
 v_xor_b32 v7, 80, v4
 v_add_u32 v8, 0xc000, v4
 v_add_u32 v9, 0xc000, v5
 v_add_u32 v10, 0xc000, v6
 v_add_u32 v11, 0xc000, v7
 v_add_u32 v12, 0x4000, v12
 v_add_u32 v14, 0xc000, v12
 v_add_u32 v13, 0x4000, v13
 v_add_u32 v15, 0xc000, v13
 v_mfma_f32_16x16x32_bf16 v[164:167], v[92:95], v[212:215], v[164:167]
 ds_read_b64_tr_b16 v[204:205], v242 offset:16384
 v_mfma_f32_16x16x32_bf16 v[168:171], v[96:99], v[212:215], v[168:171]
 ds_read_b64_tr_b16 v[206:207], v242 offset:16896
 s_waitcnt lgkmcnt(10)
 s_waitcnt vmcnt(10)
 s_cmp_lg_u32 s92, 0
 s_cbranch_scc1 KB_SQX1
 s_mov_b32 s77, 4096
KB_SPX1:
 v_cmp_ne_u64 vcc, v[248:249], v[254:255]
 v_cmp_ne_u64 s[46:47], v[250:251], v[254:255]
 s_or_b64 s[46:47], vcc, s[46:47]
 s_cbranch_scc0 KB_SQX1
 s_sleep 2
 buffer_load_dwordx4 v[248:251], v253, s[96:99], s90 offen sc1
 s_sub_u32 s77, s77, 1
 s_cmp_eq_u32 s77, 0
 s_waitcnt vmcnt(0)
 s_cbranch_scc0 KB_SPX1
 s_mov_b32 s101, 1
KB_SQX1:
 s_lshl_b32 s42, s75, 15
 s_add_u32 s42, s42, 0
 buffer_load_dwordx4 v[132:135], v246, s[8:11], s42 offen offset:0 sc1
 v_mfma_f32_16x16x32_bf16 v[172:175], v[92:95], v[216:219], v[172:175]
 ds_read_b64_tr_b16 v[208:209], v243 offset:16384
 v_mfma_f32_16x16x32_bf16 v[176:179], v[96:99], v[216:219], v[176:179]
 ds_read_b64_tr_b16 v[210:211], v243 offset:16896
 s_waitcnt lgkmcnt(10)
 buffer_load_dwordx4 v[136:139], v246, s[8:11], s42 offen offset:1024 sc1
 v_mfma_f32_16x16x32_bf16 v[180:183], v[92:95], v[220:223], v[180:183]
 ds_read_b64_tr_b16 v[212:213], v240 offset:20480
 v_mfma_f32_16x16x32_bf16 v[184:187], v[96:99], v[220:223], v[184:187]
 ds_read_b64_tr_b16 v[214:215], v240 offset:20992
 s_waitcnt lgkmcnt(10)
 buffer_load_dwordx4 v[140:143], v246, s[8:11], s42 offen offset:2048 sc1
 v_mfma_f32_16x16x32_bf16 v[188:191], v[92:95], v[224:227], v[188:191]
 ds_read_b64_tr_b16 v[216:217], v241 offset:20480
 v_mfma_f32_16x16x32_bf16 v[192:195], v[96:99], v[224:227], v[192:195]
 ds_read_b64_tr_b16 v[218:219], v241 offset:20992
 s_waitcnt lgkmcnt(10)
 buffer_load_dwordx4 v[144:147], v246, s[8:11], s42 offen offset:3072 sc1
 v_mfma_f32_16x16x32_bf16 v[164:167], v[100:103], v[196:199], v[164:167]
 ds_read_b64_tr_b16 v[220:221], v242 offset:20480
 v_mfma_f32_16x16x32_bf16 v[168:171], v[104:107], v[196:199], v[168:171]
 ds_read_b64_tr_b16 v[222:223], v242 offset:20992
 s_waitcnt lgkmcnt(10)
 s_lshl_b32 s42, s75, 15
 s_add_u32 s42, s42, 4096
 buffer_load_dwordx4 v[148:151], v246, s[8:11], s42 offen offset:0 sc1
 v_mfma_f32_16x16x32_bf16 v[172:175], v[100:103], v[200:203], v[172:175]
 ds_read_b64_tr_b16 v[224:225], v243 offset:20480
 v_mfma_f32_16x16x32_bf16 v[176:179], v[104:107], v[200:203], v[176:179]
 ds_read_b64_tr_b16 v[226:227], v243 offset:20992
 s_waitcnt lgkmcnt(10)
 buffer_load_dwordx4 v[152:155], v246, s[8:11], s42 offen offset:1024 sc1
 v_mfma_f32_16x16x32_bf16 v[180:183], v[100:103], v[204:207], v[180:183]
 ds_read_b64_tr_b16 v[196:197], v240 offset:24576
 v_mfma_f32_16x16x32_bf16 v[184:187], v[104:107], v[204:207], v[184:187]
 ds_read_b64_tr_b16 v[198:199], v240 offset:25088
 s_waitcnt lgkmcnt(10)
 buffer_load_dwordx4 v[156:159], v246, s[8:11], s42 offen offset:2048 sc1
 v_mfma_f32_16x16x32_bf16 v[188:191], v[100:103], v[208:211], v[188:191]
 ds_read_b64_tr_b16 v[200:201], v241 offset:24576
 v_mfma_f32_16x16x32_bf16 v[192:195], v[104:107], v[208:211], v[192:195]
 ds_read_b64_tr_b16 v[202:203], v241 offset:25088
 s_waitcnt lgkmcnt(10)
 buffer_load_dwordx4 v[160:163], v246, s[8:11], s42 offen offset:3072 sc1
 v_mfma_f32_16x16x32_bf16 v[164:167], v[108:111], v[212:215], v[164:167]
 ds_read_b64_tr_b16 v[204:205], v242 offset:24576
 v_mfma_f32_16x16x32_bf16 v[168:171], v[112:115], v[212:215], v[168:171]
 ds_read_b64_tr_b16 v[206:207], v242 offset:25088
 s_waitcnt lgkmcnt(10)
 v_mfma_f32_16x16x32_bf16 v[172:175], v[108:111], v[216:219], v[172:175]
 ds_read_b64_tr_b16 v[208:209], v243 offset:24576
 v_mfma_f32_16x16x32_bf16 v[176:179], v[112:115], v[216:219], v[176:179]
 ds_read_b64_tr_b16 v[210:211], v243 offset:25088
 s_waitcnt lgkmcnt(10)
 v_mfma_f32_16x16x32_bf16 v[180:183], v[108:111], v[220:223], v[180:183]
 ds_read_b64_tr_b16 v[212:213], v240 offset:28672
 v_mfma_f32_16x16x32_bf16 v[184:187], v[112:115], v[220:223], v[184:187]
 ds_read_b64_tr_b16 v[214:215], v240 offset:29184
 s_waitcnt lgkmcnt(10)
 v_mfma_f32_16x16x32_bf16 v[188:191], v[108:111], v[224:227], v[188:191]
 ds_read_b64_tr_b16 v[216:217], v241 offset:28672
 v_mfma_f32_16x16x32_bf16 v[192:195], v[112:115], v[224:227], v[192:195]
 ds_read_b64_tr_b16 v[218:219], v241 offset:29184
 s_waitcnt lgkmcnt(10)
 v_mfma_f32_16x16x32_bf16 v[164:167], v[116:119], v[196:199], v[164:167]
 ds_read_b64_tr_b16 v[220:221], v242 offset:28672
 v_mfma_f32_16x16x32_bf16 v[168:171], v[120:123], v[196:199], v[168:171]
 ds_read_b64_tr_b16 v[222:223], v242 offset:29184
 s_waitcnt lgkmcnt(10)
 v_mfma_f32_16x16x32_bf16 v[172:175], v[116:119], v[200:203], v[172:175]
 ds_read_b64_tr_b16 v[224:225], v243 offset:28672
 v_mfma_f32_16x16x32_bf16 v[176:179], v[120:123], v[200:203], v[176:179]
 ds_read_b64_tr_b16 v[226:227], v243 offset:29184
 s_waitcnt lgkmcnt(10)
 v_mfma_f32_16x16x32_bf16 v[180:183], v[116:119], v[204:207], v[180:183]
 v_mfma_f32_16x16x32_bf16 v[184:187], v[120:123], v[204:207], v[184:187]
 s_waitcnt lgkmcnt(8)
 v_mfma_f32_16x16x32_bf16 v[188:191], v[116:119], v[208:211], v[188:191]
 v_mfma_f32_16x16x32_bf16 v[192:195], v[120:123], v[208:211], v[192:195]
 s_waitcnt lgkmcnt(6)
 v_mfma_f32_16x16x32_bf16 v[164:167], v[124:127], v[212:215], v[164:167]
 v_mfma_f32_16x16x32_bf16 v[168:171], v[128:131], v[212:215], v[168:171]
 s_waitcnt lgkmcnt(4)
 v_mfma_f32_16x16x32_bf16 v[172:175], v[124:127], v[216:219], v[172:175]
 v_mfma_f32_16x16x32_bf16 v[176:179], v[128:131], v[216:219], v[176:179]
 s_waitcnt lgkmcnt(2)
 v_mfma_f32_16x16x32_bf16 v[180:183], v[124:127], v[220:223], v[180:183]
 v_mfma_f32_16x16x32_bf16 v[184:187], v[128:131], v[220:223], v[184:187]
 s_waitcnt lgkmcnt(0)
 v_mfma_f32_16x16x32_bf16 v[188:191], v[124:127], v[224:227], v[188:191]
 v_mfma_f32_16x16x32_bf16 v[192:195], v[128:131], v[224:227], v[192:195]
 s_add_u32 s94, s95, 0x82000
 v_cvt_pk_bf16_f32 v164, v164, v165
 v_cvt_pk_bf16_f32 v165, v166, v167
 v_cvt_pk_bf16_f32 v166, v168, v169
 v_cvt_pk_bf16_f32 v167, v170, v171
 buffer_store_dwordx4 v[164:167], v247, s[16:19], s94 offen offset:0 sc1
 v_cvt_pk_bf16_f32 v168, v172, v173
 v_cvt_pk_bf16_f32 v169, v174, v175
 v_cvt_pk_bf16_f32 v170, v176, v177
 v_cvt_pk_bf16_f32 v171, v178, v179
 buffer_store_dwordx4 v[168:171], v247, s[16:19], s94 offen offset:128 sc1
 s_add_u32 s94, s95, 0x83000
 v_cvt_pk_bf16_f32 v180, v180, v181
 v_cvt_pk_bf16_f32 v181, v182, v183
 v_cvt_pk_bf16_f32 v182, v184, v185
 v_cvt_pk_bf16_f32 v183, v186, v187
 buffer_store_dwordx4 v[180:183], v247, s[16:19], s94 offen offset:0 sc1
 v_cvt_pk_bf16_f32 v184, v188, v189
 v_cvt_pk_bf16_f32 v185, v190, v191
 v_cvt_pk_bf16_f32 v186, v192, v193
 v_cvt_pk_bf16_f32 v187, v194, v195
 buffer_store_dwordx4 v[184:187], v247, s[16:19], s94 offen offset:128 sc1
KA_FIN:
 s_cmp_eq_u32 s92, 1
 s_cbranch_scc1 KAB_NEXT
 v_lshlrev_b32 v232, 4, v0
 v_and_b32 v237, 15, v0
 v_lshrrev_b32 v238, 5, v0
 v_lshlrev_b32 v196, 10, v238
 v_lshl_add_u32 v196, v237, 4, v196
 v_lshlrev_b32 v238, 4, v238
 v_sub_u32 v244, v237, v238
 v_bfe_u32 v238, v0, 4, 1
 v_lshl_add_u32 v196, v238, 9, v196
 v_lshlrev_b32 v238, 2, v238
 v_sub_u32 v244, v244, v238
 v_and_b32 v197, 0x270, v232
 v_bfe_u32 v238, v0, 3, 1
 v_lshl_add_u32 v197, v238, 8, v197
 v_bfe_u32 v238, v0, 4, 1
 v_lshl_add_u32 v197, v238, 7, v197
 v_mov_b32 v245, v244
 s_lshl_b32 s41, s55, 8
 s_add_u32 s41, s41, 155648
 v_lshlrev_b32 v244, 2, v0
 v_add_u32 v244, s41, v244
 v_mov_b32 v239, 0
 v_mov_b32 v246, 0xf149f2ca
 s_lshr_b32 s90, s25, 1
 s_lshl_b32 s90, s90, 10
 s_add_u32 s90, s90, 4096
 s_cmp_le_u32 s37, 1
 s_cbranch_scc1 KB_Q6
 s_add_u32 s68, s4, 0x3200000
 s_addc_u32 s69, s5, 0
 s_and_b32 s69, s69, 0xffff
 s_mov_b32 s70, 0x580000
 s_mov_b32 s71, 0x00020000
 s_add_u32 s12, s4, 0x1200000
 s_addc_u32 s13, s5, 0
 s_and_b32 s13, s13, 0xffff
 s_mov_b32 s14, 0x1000000
 s_mov_b32 s15, 0x00020000
 s_add_u32 s16, s4, 0x2200000
 s_addc_u32 s17, s5, 0
 s_and_b32 s17, s17, 0xffff
 s_mov_b32 s18, 0x1000000
 s_mov_b32 s19, 0x00020000
 s_add_u32 s20, s4, 0x6000000
 s_addc_u32 s21, s5, 0
 s_and_b32 s21, s21, 0xffff
 s_mov_b32 s22, 0x1044000
 s_mov_b32 s23, 0x00020000
 s_waitcnt vmcnt(14)
 s_barrier
 ds_write_b32 v244, v239
 ds_write_b32 v244, v239 offset:1024
 ds_write_b32 v244, v239 offset:3072
 ds_read_b64_tr_b16 v[200:201], v4 offset:0
 ds_read_b64_tr_b16 v[202:203], v4 offset:512
 ds_read_b64_tr_b16 v[204:205], v5 offset:0
 ds_read_b64_tr_b16 v[206:207], v5 offset:512
 ds_read_b64_tr_b16 v[208:209], v6 offset:0
 ds_read_b64_tr_b16 v[210:211], v6 offset:512
 ds_read_b64_tr_b16 v[212:213], v7 offset:0
 ds_read_b64_tr_b16 v[214:215], v7 offset:512
 ds_read_b64_tr_b16 v[216:217], v4 offset:1024
 ds_read_b64_tr_b16 v[218:219], v4 offset:1536
 ds_read_b64_tr_b16 v[220:221], v5 offset:1024
 ds_read_b64_tr_b16 v[222:223], v5 offset:1536
 s_waitcnt vmcnt(10) lgkmcnt(10)
 v_mfma_f32_16x16x32_bf16 v[36:39], v[200:203], v[132:135], 0
 ds_read_b64_tr_b16 v[224:225], v6 offset:1024
 v_mfma_f32_16x16x32_bf16 v[44:47], v[200:203], v[136:139], 0
 ds_read_b64_tr_b16 v[226:227], v6 offset:1536
 s_waitcnt lgkmcnt(10)
 s_add_u32 m0, s74, 49152
 s_add_u32 s41, s72, 1048576
 buffer_load_dwordx4 v16, s[60:63], s41 offen offset:0 lds
 v_mfma_f32_16x16x32_bf16 v[40:43], v[204:207], v[132:135], 0
 ds_read_b64_tr_b16 v[228:229], v7 offset:1024
 v_mfma_f32_16x16x32_bf16 v[48:51], v[204:207], v[136:139], 0
 ds_read_b64_tr_b16 v[230:231], v7 offset:1536
 s_waitcnt lgkmcnt(10)
 v_mfma_f32_16x16x32_bf16 v[52:55], v[208:211], v[132:135], 0
 ds_read_b64_tr_b16 v[200:201], v12 offset:0
 v_mfma_f32_16x16x32_bf16 v[60:63], v[208:211], v[136:139], 0
 ds_read_b64_tr_b16 v[202:203], v12 offset:256
 s_waitcnt lgkmcnt(10)
 s_add_u32 m0, s74, 50048
 s_add_u32 s41, s72, 1048576
 buffer_load_dwordx4 v16, s[60:63], s41 offen offset:128 lds
 v_mfma_f32_16x16x32_bf16 v[56:59], v[212:215], v[132:135], 0
 ds_read_b64_tr_b16 v[204:205], v13 offset:0
 v_mfma_f32_16x16x32_bf16 v[64:67], v[212:215], v[136:139], 0
 ds_read_b64_tr_b16 v[206:207], v13 offset:256
 s_waitcnt lgkmcnt(10)
 v_mfma_f32_16x16x32_bf16 v[68:71], v[216:219], v[132:135], 0
 ds_read_b64_tr_b16 v[208:209], v4 offset:8192
 v_mfma_f32_16x16x32_bf16 v[76:79], v[216:219], v[136:139], 0
 ds_read_b64_tr_b16 v[210:211], v4 offset:8704
 s_waitcnt lgkmcnt(10)
 s_lshr_b32 s41, s74, 1
 s_add_u32 m0, s41, 65536
 s_add_u32 s41, s73, 352256
 buffer_load_dwordx4 v17, s[64:67], s41 offen lds
 v_mfma_f32_16x16x32_bf16 v[72:75], v[220:223], v[132:135], 0
 ds_read_b64_tr_b16 v[212:213], v5 offset:8192
 v_mfma_f32_16x16x32_bf16 v[80:83], v[220:223], v[136:139], 0
 ds_read_b64_tr_b16 v[214:215], v5 offset:8704
 s_waitcnt lgkmcnt(10)
 s_waitcnt vmcnt(3)
 s_cmp_eq_u32 s92, 0
 s_cbranch_scc0 KB_NSG_N1
 s_mov_b64 exec, 1
 buffer_store_dwordx2 v[254:255], off, s[96:99], s91 sc1
 s_mov_b64 exec, -1
KB_NSG_N1:
 v_mfma_f32_16x16x32_bf16 v[84:87], v[224:227], v[132:135], 0
 ds_read_b64_tr_b16 v[216:217], v6 offset:8192
 v_mfma_f32_16x16x32_bf16 v[92:95], v[224:227], v[136:139], 0
 ds_read_b64_tr_b16 v[218:219], v6 offset:8704
 s_waitcnt lgkmcnt(10)
 s_lshl_b32 s42, s75, 15
 s_add_u32 s42, s42, 8192
 buffer_load_dwordx4 v[164:167], v232, s[8:11], s42 offen offset:0 sc1
 v_mfma_f32_16x16x32_bf16 v[88:91], v[228:231], v[132:135], 0
 ds_read_b64_tr_b16 v[220:221], v7 offset:8192
 v_mfma_f32_16x16x32_bf16 v[96:99], v[228:231], v[136:139], 0
 ds_read_b64_tr_b16 v[222:223], v7 offset:8704
 s_waitcnt lgkmcnt(10)
 v_mfma_f32_16x16x32_bf16 v[100:103], v[200:203], v[132:135], 0
 ds_read_b64_tr_b16 v[224:225], v4 offset:9216
 v_mfma_f32_16x16x32_bf16 v[108:111], v[200:203], v[136:139], 0
 ds_read_b64_tr_b16 v[226:227], v4 offset:9728
 s_waitcnt lgkmcnt(10)
 buffer_load_dwordx4 v[168:171], v232, s[8:11], s42 offen offset:1024 sc1
 v_mfma_f32_16x16x32_bf16 v[104:107], v[204:207], v[132:135], 0
 ds_read_b64_tr_b16 v[228:229], v5 offset:9216
 v_mfma_f32_16x16x32_bf16 v[112:115], v[204:207], v[136:139], 0
 ds_read_b64_tr_b16 v[230:231], v5 offset:9728
 s_waitcnt vmcnt(13) lgkmcnt(10)
 v_mfma_f32_16x16x32_bf16 v[36:39], v[208:211], v[140:143], v[36:39]
 ds_read_b64_tr_b16 v[200:201], v6 offset:9216
 v_mfma_f32_16x16x32_bf16 v[44:47], v[208:211], v[144:147], v[44:47]
 ds_read_b64_tr_b16 v[202:203], v6 offset:9728
 s_waitcnt lgkmcnt(10)
 buffer_load_dwordx4 v[172:175], v232, s[8:11], s42 offen offset:2048 sc1
 v_mfma_f32_16x16x32_bf16 v[40:43], v[212:215], v[140:143], v[40:43]
 ds_read_b64_tr_b16 v[204:205], v7 offset:9216
 v_mfma_f32_16x16x32_bf16 v[48:51], v[212:215], v[144:147], v[48:51]
 ds_read_b64_tr_b16 v[206:207], v7 offset:9728
 s_waitcnt lgkmcnt(10)
 v_mfma_f32_16x16x32_bf16 v[52:55], v[216:219], v[140:143], v[52:55]
 ds_read_b64_tr_b16 v[208:209], v12 offset:2048
 v_mfma_f32_16x16x32_bf16 v[60:63], v[216:219], v[144:147], v[60:63]
 ds_read_b64_tr_b16 v[210:211], v12 offset:2304
 s_waitcnt lgkmcnt(10)
 buffer_load_dwordx4 v[176:179], v232, s[8:11], s42 offen offset:3072 sc1
 s_waitcnt vmcnt(23)
 s_barrier
 v_mfma_f32_16x16x32_bf16 v[56:59], v[220:223], v[140:143], v[56:59]
 ds_read_b64_tr_b16 v[212:213], v13 offset:2048
 v_mfma_f32_16x16x32_bf16 v[64:67], v[220:223], v[144:147], v[64:67]
 ds_read_b64_tr_b16 v[214:215], v13 offset:2304
 s_waitcnt lgkmcnt(10)
 v_mfma_f32_16x16x32_bf16 v[68:71], v[224:227], v[140:143], v[68:71]
 ds_read_b64_tr_b16 v[216:217], v4 offset:24576
 v_mfma_f32_16x16x32_bf16 v[76:79], v[224:227], v[144:147], v[76:79]
 ds_read_b64_tr_b16 v[218:219], v4 offset:25088
 s_waitcnt lgkmcnt(10)
 v_mfma_f32_16x16x32_bf16 v[72:75], v[228:231], v[140:143], v[72:75]
 ds_read_b64_tr_b16 v[220:221], v5 offset:24576
 v_mfma_f32_16x16x32_bf16 v[80:83], v[228:231], v[144:147], v[80:83]
 ds_read_b64_tr_b16 v[222:223], v5 offset:25088
 s_waitcnt lgkmcnt(10)
 v_mfma_f32_16x16x32_bf16 v[84:87], v[200:203], v[140:143], v[84:87]
 ds_read_b64_tr_b16 v[224:225], v6 offset:24576
 v_mfma_f32_16x16x32_bf16 v[92:95], v[200:203], v[144:147], v[92:95]
 ds_read_b64_tr_b16 v[226:227], v6 offset:25088
 s_waitcnt lgkmcnt(10)
 v_mfma_f32_16x16x32_bf16 v[88:91], v[204:207], v[140:143], v[88:91]
 ds_read_b64_tr_b16 v[228:229], v7 offset:24576
 v_mfma_f32_16x16x32_bf16 v[96:99], v[204:207], v[144:147], v[96:99]
 ds_read_b64_tr_b16 v[230:231], v7 offset:25088
 s_waitcnt lgkmcnt(10)
 v_mfma_f32_16x16x32_bf16 v[100:103], v[208:211], v[140:143], v[100:103]
 ds_read_b64_tr_b16 v[200:201], v4 offset:25600
 v_mfma_f32_16x16x32_bf16 v[108:111], v[208:211], v[144:147], v[108:111]
 ds_read_b64_tr_b16 v[202:203], v4 offset:26112
 s_waitcnt lgkmcnt(10)
 v_mfma_f32_16x16x32_bf16 v[104:107], v[212:215], v[140:143], v[104:107]
 ds_read_b64_tr_b16 v[204:205], v5 offset:25600
 v_mfma_f32_16x16x32_bf16 v[112:115], v[212:215], v[144:147], v[112:115]
 ds_read_b64_tr_b16 v[206:207], v5 offset:26112
 s_waitcnt vmcnt(13) lgkmcnt(10)
 v_mfma_f32_16x16x32_bf16 v[36:39], v[216:219], v[148:151], v[36:39]
 ds_read_b64_tr_b16 v[208:209], v6 offset:25600
 v_mfma_f32_16x16x32_bf16 v[44:47], v[216:219], v[152:155], v[44:47]
 ds_read_b64_tr_b16 v[210:211], v6 offset:26112
 s_waitcnt lgkmcnt(10)
 s_add_u32 m0, s74, 73728
 s_add_u32 s41, s72, 1572864
 buffer_load_dwordx4 v16, s[60:63], s41 offen offset:0 lds
 v_mfma_f32_16x16x32_bf16 v[40:43], v[220:223], v[148:151], v[40:43]
 ds_read_b64_tr_b16 v[212:213], v7 offset:25600
 v_mfma_f32_16x16x32_bf16 v[48:51], v[220:223], v[152:155], v[48:51]
 ds_read_b64_tr_b16 v[214:215], v7 offset:26112
 s_waitcnt lgkmcnt(10)
 v_mfma_f32_16x16x32_bf16 v[52:55], v[224:227], v[148:151], v[52:55]
 ds_read_b64_tr_b16 v[216:217], v12 offset:24576
 v_mfma_f32_16x16x32_bf16 v[60:63], v[224:227], v[152:155], v[60:63]
 ds_read_b64_tr_b16 v[218:219], v12 offset:24832
 s_waitcnt lgkmcnt(10)
 s_add_u32 m0, s74, 74624
 s_add_u32 s41, s72, 1572864
 buffer_load_dwordx4 v16, s[60:63], s41 offen offset:128 lds
 v_mfma_f32_16x16x32_bf16 v[56:59], v[228:231], v[148:151], v[56:59]
 ds_read_b64_tr_b16 v[220:221], v13 offset:24576
 v_mfma_f32_16x16x32_bf16 v[64:67], v[228:231], v[152:155], v[64:67]
 ds_read_b64_tr_b16 v[222:223], v13 offset:24832
 s_waitcnt lgkmcnt(10)
 v_mfma_f32_16x16x32_bf16 v[68:71], v[200:203], v[148:151], v[68:71]
 ds_read_b64_tr_b16 v[224:225], v4 offset:32768
 v_mfma_f32_16x16x32_bf16 v[76:79], v[200:203], v[152:155], v[76:79]
 ds_read_b64_tr_b16 v[226:227], v4 offset:33280
 s_waitcnt lgkmcnt(10)
 s_lshr_b32 s41, s74, 1
 s_add_u32 m0, s41, 90112
 s_add_u32 s41, s73, 528384
 buffer_load_dwordx4 v17, s[64:67], s41 offen lds
 v_mfma_f32_16x16x32_bf16 v[72:75], v[204:207], v[148:151], v[72:75]
 ds_read_b64_tr_b16 v[228:229], v5 offset:32768
 v_mfma_f32_16x16x32_bf16 v[80:83], v[204:207], v[152:155], v[80:83]
 ds_read_b64_tr_b16 v[230:231], v5 offset:33280
 s_waitcnt lgkmcnt(10)
 v_mfma_f32_16x16x32_bf16 v[84:87], v[208:211], v[148:151], v[84:87]
 ds_read_b64_tr_b16 v[200:201], v6 offset:32768
 v_mfma_f32_16x16x32_bf16 v[92:95], v[208:211], v[152:155], v[92:95]
 ds_read_b64_tr_b16 v[202:203], v6 offset:33280
 s_waitcnt lgkmcnt(10)
 s_lshl_b32 s42, s75, 15
 s_add_u32 s42, s42, 12288
 buffer_load_dwordx4 v[180:183], v232, s[8:11], s42 offen offset:0 sc1
 v_mfma_f32_16x16x32_bf16 v[88:91], v[212:215], v[148:151], v[88:91]
 ds_read_b64_tr_b16 v[204:205], v7 offset:32768
 v_mfma_f32_16x16x32_bf16 v[96:99], v[212:215], v[152:155], v[96:99]
 ds_read_b64_tr_b16 v[206:207], v7 offset:33280
 s_waitcnt lgkmcnt(10)
 v_mfma_f32_16x16x32_bf16 v[100:103], v[216:219], v[148:151], v[100:103]
 ds_read_b64_tr_b16 v[208:209], v4 offset:33792
 v_mfma_f32_16x16x32_bf16 v[108:111], v[216:219], v[152:155], v[108:111]
 ds_read_b64_tr_b16 v[210:211], v4 offset:34304
 s_waitcnt lgkmcnt(10)
 buffer_load_dwordx4 v[184:187], v232, s[8:11], s42 offen offset:1024 sc1
 v_mfma_f32_16x16x32_bf16 v[104:107], v[220:223], v[148:151], v[104:107]
 ds_read_b64_tr_b16 v[212:213], v5 offset:33792
 v_mfma_f32_16x16x32_bf16 v[112:115], v[220:223], v[152:155], v[112:115]
 ds_read_b64_tr_b16 v[214:215], v5 offset:34304
 s_waitcnt vmcnt(16) lgkmcnt(10)
 v_mfma_f32_16x16x32_bf16 v[36:39], v[224:227], v[156:159], v[36:39]
 ds_read_b64_tr_b16 v[216:217], v6 offset:33792
 v_mfma_f32_16x16x32_bf16 v[44:47], v[224:227], v[160:163], v[44:47]
 ds_read_b64_tr_b16 v[218:219], v6 offset:34304
 s_waitcnt lgkmcnt(10)
 buffer_load_dwordx4 v[188:191], v232, s[8:11], s42 offen offset:2048 sc1
 v_mfma_f32_16x16x32_bf16 v[40:43], v[228:231], v[156:159], v[40:43]
 ds_read_b64_tr_b16 v[220:221], v7 offset:33792
 v_mfma_f32_16x16x32_bf16 v[48:51], v[228:231], v[160:163], v[48:51]
 ds_read_b64_tr_b16 v[222:223], v7 offset:34304
 s_waitcnt lgkmcnt(10)
 v_mfma_f32_16x16x32_bf16 v[52:55], v[200:203], v[156:159], v[52:55]
 ds_read_b64_tr_b16 v[224:225], v12 offset:26624
 v_mfma_f32_16x16x32_bf16 v[60:63], v[200:203], v[160:163], v[60:63]
 ds_read_b64_tr_b16 v[226:227], v12 offset:26880
 s_waitcnt lgkmcnt(10)
 buffer_load_dwordx4 v[192:195], v232, s[8:11], s42 offen offset:3072 sc1
 s_waitcnt vmcnt(11)
 s_barrier
 v_mfma_f32_16x16x32_bf16 v[56:59], v[204:207], v[156:159], v[56:59]
 ds_read_b64_tr_b16 v[228:229], v13 offset:26624
 v_mfma_f32_16x16x32_bf16 v[64:67], v[204:207], v[160:163], v[64:67]
 ds_read_b64_tr_b16 v[230:231], v13 offset:26880
 s_waitcnt lgkmcnt(10)
 v_mfma_f32_16x16x32_bf16 v[68:71], v[208:211], v[156:159], v[68:71]
 ds_read_b64_tr_b16 v[200:201], v8 offset:0
 v_mfma_f32_16x16x32_bf16 v[76:79], v[208:211], v[160:163], v[76:79]
 ds_read_b64_tr_b16 v[202:203], v8 offset:512
 s_waitcnt lgkmcnt(10)
 v_mfma_f32_16x16x32_bf16 v[72:75], v[212:215], v[156:159], v[72:75]
 ds_read_b64_tr_b16 v[204:205], v9 offset:0
 v_mfma_f32_16x16x32_bf16 v[80:83], v[212:215], v[160:163], v[80:83]
 ds_read_b64_tr_b16 v[206:207], v9 offset:512
 s_waitcnt lgkmcnt(10)
 v_mfma_f32_16x16x32_bf16 v[84:87], v[216:219], v[156:159], v[84:87]
 ds_read_b64_tr_b16 v[208:209], v10 offset:0
 v_mfma_f32_16x16x32_bf16 v[92:95], v[216:219], v[160:163], v[92:95]
 ds_read_b64_tr_b16 v[210:211], v10 offset:512
 s_waitcnt lgkmcnt(10)
 v_mfma_f32_16x16x32_bf16 v[88:91], v[220:223], v[156:159], v[88:91]
 ds_read_b64_tr_b16 v[212:213], v11 offset:0
 v_mfma_f32_16x16x32_bf16 v[96:99], v[220:223], v[160:163], v[96:99]
 ds_read_b64_tr_b16 v[214:215], v11 offset:512
 s_waitcnt lgkmcnt(10)
 v_mfma_f32_16x16x32_bf16 v[100:103], v[224:227], v[156:159], v[100:103]
 ds_read_b64_tr_b16 v[216:217], v8 offset:1024
 v_mfma_f32_16x16x32_bf16 v[108:111], v[224:227], v[160:163], v[108:111]
 ds_read_b64_tr_b16 v[218:219], v8 offset:1536
 s_waitcnt lgkmcnt(10)
 v_mfma_f32_16x16x32_bf16 v[104:107], v[228:231], v[156:159], v[104:107]
 ds_read_b64_tr_b16 v[220:221], v9 offset:1024
 v_mfma_f32_16x16x32_bf16 v[112:115], v[228:231], v[160:163], v[112:115]
 ds_read_b64_tr_b16 v[222:223], v9 offset:1536
 s_waitcnt vmcnt(9) lgkmcnt(10)
 v_mfma_f32_16x16x32_bf16 v[36:39], v[200:203], v[164:167], v[36:39]
 ds_read_b64_tr_b16 v[224:225], v10 offset:1024
 v_mfma_f32_16x16x32_bf16 v[44:47], v[200:203], v[168:171], v[44:47]
 ds_read_b64_tr_b16 v[226:227], v10 offset:1536
 s_waitcnt lgkmcnt(10)
 s_add_u32 m0, s74, 0
 s_add_u32 s41, s72, 2097152
 buffer_load_dwordx4 v16, s[60:63], s41 offen offset:0 lds
 v_mfma_f32_16x16x32_bf16 v[40:43], v[204:207], v[164:167], v[40:43]
 ds_read_b64_tr_b16 v[228:229], v11 offset:1024
 v_mfma_f32_16x16x32_bf16 v[48:51], v[204:207], v[168:171], v[48:51]
 ds_read_b64_tr_b16 v[230:231], v11 offset:1536
 s_waitcnt lgkmcnt(10)
 v_mfma_f32_16x16x32_bf16 v[52:55], v[208:211], v[164:167], v[52:55]
 ds_read_b64_tr_b16 v[200:201], v14 offset:0
 v_mfma_f32_16x16x32_bf16 v[60:63], v[208:211], v[168:171], v[60:63]
 ds_read_b64_tr_b16 v[202:203], v14 offset:256
 s_waitcnt lgkmcnt(10)
 s_add_u32 m0, s74, 896
 s_add_u32 s41, s72, 2097152
 buffer_load_dwordx4 v16, s[60:63], s41 offen offset:128 lds
 v_mfma_f32_16x16x32_bf16 v[56:59], v[212:215], v[164:167], v[56:59]
 ds_read_b64_tr_b16 v[204:205], v15 offset:0
 v_mfma_f32_16x16x32_bf16 v[64:67], v[212:215], v[168:171], v[64:67]
 ds_read_b64_tr_b16 v[206:207], v15 offset:256
 s_waitcnt lgkmcnt(10)
 v_mfma_f32_16x16x32_bf16 v[68:71], v[216:219], v[164:167], v[68:71]
 ds_read_b64_tr_b16 v[208:209], v8 offset:8192
 v_mfma_f32_16x16x32_bf16 v[76:79], v[216:219], v[168:171], v[76:79]
 ds_read_b64_tr_b16 v[210:211], v8 offset:8704
 s_waitcnt lgkmcnt(10)
 s_lshr_b32 s41, s74, 1
 s_add_u32 m0, s41, 16384
 s_add_u32 s41, s73, 704512
 buffer_load_dwordx4 v17, s[64:67], s41 offen lds
 v_mfma_f32_16x16x32_bf16 v[72:75], v[220:223], v[164:167], v[72:75]
 ds_read_b64_tr_b16 v[212:213], v9 offset:8192
 v_mfma_f32_16x16x32_bf16 v[80:83], v[220:223], v[168:171], v[80:83]
 ds_read_b64_tr_b16 v[214:215], v9 offset:8704
 s_waitcnt lgkmcnt(10)
 v_mfma_f32_16x16x32_bf16 v[84:87], v[224:227], v[164:167], v[84:87]
 ds_read_b64_tr_b16 v[216:217], v10 offset:8192
 v_mfma_f32_16x16x32_bf16 v[92:95], v[224:227], v[168:171], v[92:95]
 ds_read_b64_tr_b16 v[218:219], v10 offset:8704
 s_waitcnt lgkmcnt(10)
 s_lshl_b32 s42, s75, 15
 s_add_u32 s42, s42, 16384
 buffer_load_dwordx4 v[132:135], v232, s[8:11], s42 offen offset:0 sc1
 v_mfma_f32_16x16x32_bf16 v[88:91], v[228:231], v[164:167], v[88:91]
 ds_read_b64_tr_b16 v[220:221], v11 offset:8192
 v_mfma_f32_16x16x32_bf16 v[96:99], v[228:231], v[168:171], v[96:99]
 ds_read_b64_tr_b16 v[222:223], v11 offset:8704
 s_waitcnt lgkmcnt(10)
 v_mfma_f32_16x16x32_bf16 v[100:103], v[200:203], v[164:167], v[100:103]
 ds_read_b64_tr_b16 v[224:225], v8 offset:9216
 v_mfma_f32_16x16x32_bf16 v[108:111], v[200:203], v[168:171], v[108:111]
 ds_read_b64_tr_b16 v[226:227], v8 offset:9728
 s_waitcnt lgkmcnt(10)
 buffer_load_dwordx4 v[136:139], v232, s[8:11], s42 offen offset:1024 sc1
 v_mfma_f32_16x16x32_bf16 v[104:107], v[204:207], v[164:167], v[104:107]
 ds_read_b64_tr_b16 v[228:229], v9 offset:9216
 v_mfma_f32_16x16x32_bf16 v[112:115], v[204:207], v[168:171], v[112:115]
 ds_read_b64_tr_b16 v[230:231], v9 offset:9728
 s_waitcnt vmcnt(12) lgkmcnt(10)
 v_mfma_f32_16x16x32_bf16 v[36:39], v[208:211], v[172:175], v[36:39]
 ds_read_b64_tr_b16 v[200:201], v10 offset:9216
 v_mfma_f32_16x16x32_bf16 v[44:47], v[208:211], v[176:179], v[44:47]
 ds_read_b64_tr_b16 v[202:203], v10 offset:9728
 s_waitcnt lgkmcnt(10)
 buffer_load_dwordx4 v[140:143], v232, s[8:11], s42 offen offset:2048 sc1
 v_mfma_f32_16x16x32_bf16 v[40:43], v[212:215], v[172:175], v[40:43]
 ds_read_b64_tr_b16 v[204:205], v11 offset:9216
 v_mfma_f32_16x16x32_bf16 v[48:51], v[212:215], v[176:179], v[48:51]
 ds_read_b64_tr_b16 v[206:207], v11 offset:9728
 s_waitcnt lgkmcnt(10)
 v_mfma_f32_16x16x32_bf16 v[52:55], v[216:219], v[172:175], v[52:55]
 ds_read_b64_tr_b16 v[208:209], v14 offset:2048
 v_mfma_f32_16x16x32_bf16 v[60:63], v[216:219], v[176:179], v[60:63]
 ds_read_b64_tr_b16 v[210:211], v14 offset:2304
 s_waitcnt lgkmcnt(10)
 buffer_load_dwordx4 v[144:147], v232, s[8:11], s42 offen offset:3072 sc1
 s_waitcnt vmcnt(11)
 s_barrier
 v_mfma_f32_16x16x32_bf16 v[56:59], v[220:223], v[172:175], v[56:59]
 ds_read_b64_tr_b16 v[212:213], v15 offset:2048
 v_mfma_f32_16x16x32_bf16 v[64:67], v[220:223], v[176:179], v[64:67]
 ds_read_b64_tr_b16 v[214:215], v15 offset:2304
 s_waitcnt lgkmcnt(10)
 v_mfma_f32_16x16x32_bf16 v[68:71], v[224:227], v[172:175], v[68:71]
 ds_read_b64_tr_b16 v[216:217], v8 offset:24576
 v_mfma_f32_16x16x32_bf16 v[76:79], v[224:227], v[176:179], v[76:79]
 ds_read_b64_tr_b16 v[218:219], v8 offset:25088
 s_waitcnt lgkmcnt(10)
 v_mfma_f32_16x16x32_bf16 v[72:75], v[228:231], v[172:175], v[72:75]
 ds_read_b64_tr_b16 v[220:221], v9 offset:24576
 v_mfma_f32_16x16x32_bf16 v[80:83], v[228:231], v[176:179], v[80:83]
 ds_read_b64_tr_b16 v[222:223], v9 offset:25088
 s_waitcnt lgkmcnt(10)
 v_mfma_f32_16x16x32_bf16 v[84:87], v[200:203], v[172:175], v[84:87]
 ds_read_b64_tr_b16 v[224:225], v10 offset:24576
 v_mfma_f32_16x16x32_bf16 v[92:95], v[200:203], v[176:179], v[92:95]
 ds_read_b64_tr_b16 v[226:227], v10 offset:25088
 s_waitcnt lgkmcnt(10)
 v_mfma_f32_16x16x32_bf16 v[88:91], v[204:207], v[172:175], v[88:91]
 ds_read_b64_tr_b16 v[228:229], v11 offset:24576
 v_mfma_f32_16x16x32_bf16 v[96:99], v[204:207], v[176:179], v[96:99]
 ds_read_b64_tr_b16 v[230:231], v11 offset:25088
 s_waitcnt lgkmcnt(10)
 v_mfma_f32_16x16x32_bf16 v[100:103], v[208:211], v[172:175], v[100:103]
 ds_read_b64_tr_b16 v[200:201], v8 offset:25600
 v_mfma_f32_16x16x32_bf16 v[108:111], v[208:211], v[176:179], v[108:111]
 ds_read_b64_tr_b16 v[202:203], v8 offset:26112
 s_waitcnt lgkmcnt(10)
 v_mfma_f32_16x16x32_bf16 v[104:107], v[212:215], v[172:175], v[104:107]
 ds_read_b64_tr_b16 v[204:205], v9 offset:25600
 v_mfma_f32_16x16x32_bf16 v[112:115], v[212:215], v[176:179], v[112:115]
 ds_read_b64_tr_b16 v[206:207], v9 offset:26112
 s_waitcnt vmcnt(9) lgkmcnt(10)
 v_mfma_f32_16x16x32_bf16 v[36:39], v[216:219], v[180:183], v[36:39]
 ds_read_b64_tr_b16 v[208:209], v10 offset:25600
 v_mfma_f32_16x16x32_bf16 v[44:47], v[216:219], v[184:187], v[44:47]
 ds_read_b64_tr_b16 v[210:211], v10 offset:26112
 s_waitcnt lgkmcnt(10)
 s_add_u32 m0, s74, 24576
 s_add_u32 s41, s72, 2621440
 buffer_load_dwordx4 v16, s[60:63], s41 offen offset:0 lds
 v_mfma_f32_16x16x32_bf16 v[40:43], v[220:223], v[180:183], v[40:43]
 ds_read_b64_tr_b16 v[212:213], v11 offset:25600
 v_mfma_f32_16x16x32_bf16 v[48:51], v[220:223], v[184:187], v[48:51]
 ds_read_b64_tr_b16 v[214:215], v11 offset:26112
 s_waitcnt lgkmcnt(10)
 v_mfma_f32_16x16x32_bf16 v[52:55], v[224:227], v[180:183], v[52:55]
 ds_read_b64_tr_b16 v[216:217], v14 offset:24576
 v_mfma_f32_16x16x32_bf16 v[60:63], v[224:227], v[184:187], v[60:63]
 ds_read_b64_tr_b16 v[218:219], v14 offset:24832
 s_waitcnt lgkmcnt(10)
 s_add_u32 m0, s74, 25472
 s_add_u32 s41, s72, 2621440
 buffer_load_dwordx4 v16, s[60:63], s41 offen offset:128 lds
 v_mfma_f32_16x16x32_bf16 v[56:59], v[228:231], v[180:183], v[56:59]
 ds_read_b64_tr_b16 v[220:221], v15 offset:24576
 v_mfma_f32_16x16x32_bf16 v[64:67], v[228:231], v[184:187], v[64:67]
 ds_read_b64_tr_b16 v[222:223], v15 offset:24832
 s_waitcnt lgkmcnt(10)
 v_mfma_f32_16x16x32_bf16 v[68:71], v[200:203], v[180:183], v[68:71]
 ds_read_b64_tr_b16 v[224:225], v8 offset:32768
 v_mfma_f32_16x16x32_bf16 v[76:79], v[200:203], v[184:187], v[76:79]
 ds_read_b64_tr_b16 v[226:227], v8 offset:33280
 s_waitcnt lgkmcnt(10)
 s_lshr_b32 s41, s74, 1
 s_add_u32 m0, s41, 40960
 s_add_u32 s41, s73, 880640
 buffer_load_dwordx4 v17, s[64:67], s41 offen lds
 v_mfma_f32_16x16x32_bf16 v[72:75], v[204:207], v[180:183], v[72:75]
 ds_read_b64_tr_b16 v[228:229], v9 offset:32768
 v_mfma_f32_16x16x32_bf16 v[80:83], v[204:207], v[184:187], v[80:83]
 ds_read_b64_tr_b16 v[230:231], v9 offset:33280
 s_waitcnt lgkmcnt(10)
 v_mfma_f32_16x16x32_bf16 v[84:87], v[208:211], v[180:183], v[84:87]
 ds_read_b64_tr_b16 v[200:201], v10 offset:32768
 v_mfma_f32_16x16x32_bf16 v[92:95], v[208:211], v[184:187], v[92:95]
 ds_read_b64_tr_b16 v[202:203], v10 offset:33280
 s_waitcnt lgkmcnt(10)
 s_lshl_b32 s42, s75, 15
 s_add_u32 s42, s42, 20480
 buffer_load_dwordx4 v[148:151], v232, s[8:11], s42 offen offset:0 sc1
 v_mfma_f32_16x16x32_bf16 v[88:91], v[212:215], v[180:183], v[88:91]
 ds_read_b64_tr_b16 v[204:205], v11 offset:32768
 v_mfma_f32_16x16x32_bf16 v[96:99], v[212:215], v[184:187], v[96:99]
 ds_read_b64_tr_b16 v[206:207], v11 offset:33280
 s_waitcnt lgkmcnt(10)
 v_mfma_f32_16x16x32_bf16 v[100:103], v[216:219], v[180:183], v[100:103]
 ds_read_b64_tr_b16 v[208:209], v8 offset:33792
 v_mfma_f32_16x16x32_bf16 v[108:111], v[216:219], v[184:187], v[108:111]
 ds_read_b64_tr_b16 v[210:211], v8 offset:34304
 s_waitcnt lgkmcnt(10)
 buffer_load_dwordx4 v[152:155], v232, s[8:11], s42 offen offset:1024 sc1
 v_mfma_f32_16x16x32_bf16 v[104:107], v[220:223], v[180:183], v[104:107]
 ds_read_b64_tr_b16 v[212:213], v9 offset:33792
 v_mfma_f32_16x16x32_bf16 v[112:115], v[220:223], v[184:187], v[112:115]
 ds_read_b64_tr_b16 v[214:215], v9 offset:34304
 s_waitcnt vmcnt(12) lgkmcnt(10)
 v_mfma_f32_16x16x32_bf16 v[36:39], v[224:227], v[188:191], v[36:39]
 ds_read_b64_tr_b16 v[216:217], v10 offset:33792
 v_mfma_f32_16x16x32_bf16 v[44:47], v[224:227], v[192:195], v[44:47]
 ds_read_b64_tr_b16 v[218:219], v10 offset:34304
 s_waitcnt lgkmcnt(10)
 buffer_load_dwordx4 v[156:159], v232, s[8:11], s42 offen offset:2048 sc1
 v_mfma_f32_16x16x32_bf16 v[40:43], v[228:231], v[188:191], v[40:43]
 ds_read_b64_tr_b16 v[220:221], v11 offset:33792
 v_mfma_f32_16x16x32_bf16 v[48:51], v[228:231], v[192:195], v[48:51]
 ds_read_b64_tr_b16 v[222:223], v11 offset:34304
 s_waitcnt lgkmcnt(10)
 v_mfma_f32_16x16x32_bf16 v[52:55], v[200:203], v[188:191], v[52:55]
 ds_read_b64_tr_b16 v[224:225], v14 offset:26624
 v_mfma_f32_16x16x32_bf16 v[60:63], v[200:203], v[192:195], v[60:63]
 ds_read_b64_tr_b16 v[226:227], v14 offset:26880
 s_waitcnt lgkmcnt(10)
 buffer_load_dwordx4 v[160:163], v232, s[8:11], s42 offen offset:3072 sc1
 s_waitcnt vmcnt(11)
 s_barrier
 v_mfma_f32_16x16x32_bf16 v[56:59], v[204:207], v[188:191], v[56:59]
 ds_read_b64_tr_b16 v[228:229], v15 offset:26624
 v_mfma_f32_16x16x32_bf16 v[64:67], v[204:207], v[192:195], v[64:67]
 ds_read_b64_tr_b16 v[230:231], v15 offset:26880
 s_waitcnt lgkmcnt(10)
 v_mfma_f32_16x16x32_bf16 v[68:71], v[208:211], v[188:191], v[68:71]
 ds_read_b64_tr_b16 v[200:201], v4 offset:0
 v_mfma_f32_16x16x32_bf16 v[76:79], v[208:211], v[192:195], v[76:79]
 ds_read_b64_tr_b16 v[202:203], v4 offset:512
 s_waitcnt lgkmcnt(10)
 v_mfma_f32_16x16x32_bf16 v[72:75], v[212:215], v[188:191], v[72:75]
 ds_read_b64_tr_b16 v[204:205], v5 offset:0
 v_mfma_f32_16x16x32_bf16 v[80:83], v[212:215], v[192:195], v[80:83]
 ds_read_b64_tr_b16 v[206:207], v5 offset:512
 s_waitcnt lgkmcnt(10)
 v_mfma_f32_16x16x32_bf16 v[84:87], v[216:219], v[188:191], v[84:87]
 ds_read_b64_tr_b16 v[208:209], v6 offset:0
 v_mfma_f32_16x16x32_bf16 v[92:95], v[216:219], v[192:195], v[92:95]
 ds_read_b64_tr_b16 v[210:211], v6 offset:512
 s_waitcnt lgkmcnt(10)
 v_mfma_f32_16x16x32_bf16 v[88:91], v[220:223], v[188:191], v[88:91]
 ds_read_b64_tr_b16 v[212:213], v7 offset:0
 v_mfma_f32_16x16x32_bf16 v[96:99], v[220:223], v[192:195], v[96:99]
 ds_read_b64_tr_b16 v[214:215], v7 offset:512
 s_waitcnt lgkmcnt(10)
 v_mfma_f32_16x16x32_bf16 v[100:103], v[224:227], v[188:191], v[100:103]
 ds_read_b64_tr_b16 v[216:217], v4 offset:1024
 v_mfma_f32_16x16x32_bf16 v[108:111], v[224:227], v[192:195], v[108:111]
 ds_read_b64_tr_b16 v[218:219], v4 offset:1536
 s_waitcnt lgkmcnt(10)
 v_mfma_f32_16x16x32_bf16 v[104:107], v[228:231], v[188:191], v[104:107]
 ds_read_b64_tr_b16 v[220:221], v5 offset:1024
 v_mfma_f32_16x16x32_bf16 v[112:115], v[228:231], v[192:195], v[112:115]
 ds_read_b64_tr_b16 v[222:223], v5 offset:1536
 s_waitcnt vmcnt(9) lgkmcnt(10)
 v_mfma_f32_16x16x32_bf16 v[36:39], v[200:203], v[132:135], v[36:39]
 ds_read_b64_tr_b16 v[224:225], v6 offset:1024
 v_mfma_f32_16x16x32_bf16 v[44:47], v[200:203], v[136:139], v[44:47]
 ds_read_b64_tr_b16 v[226:227], v6 offset:1536
 s_waitcnt lgkmcnt(10)
 s_add_u32 m0, s74, 49152
 s_add_u32 s41, s72, 3145728
 buffer_load_dwordx4 v16, s[60:63], s41 offen offset:0 lds
 v_mfma_f32_16x16x32_bf16 v[40:43], v[204:207], v[132:135], v[40:43]
 ds_read_b64_tr_b16 v[228:229], v7 offset:1024
 v_mfma_f32_16x16x32_bf16 v[48:51], v[204:207], v[136:139], v[48:51]
 ds_read_b64_tr_b16 v[230:231], v7 offset:1536
 s_waitcnt lgkmcnt(10)
 v_mfma_f32_16x16x32_bf16 v[52:55], v[208:211], v[132:135], v[52:55]
 ds_read_b64_tr_b16 v[200:201], v12 offset:0
 v_mfma_f32_16x16x32_bf16 v[60:63], v[208:211], v[136:139], v[60:63]
 ds_read_b64_tr_b16 v[202:203], v12 offset:256
 s_waitcnt lgkmcnt(10)
 s_add_u32 m0, s74, 50048
 s_add_u32 s41, s72, 3145728
 buffer_load_dwordx4 v16, s[60:63], s41 offen offset:128 lds
 v_mfma_f32_16x16x32_bf16 v[56:59], v[212:215], v[132:135], v[56:59]
 ds_read_b64_tr_b16 v[204:205], v13 offset:0
 v_mfma_f32_16x16x32_bf16 v[64:67], v[212:215], v[136:139], v[64:67]
 ds_read_b64_tr_b16 v[206:207], v13 offset:256
 s_waitcnt lgkmcnt(10)
 v_mfma_f32_16x16x32_bf16 v[68:71], v[216:219], v[132:135], v[68:71]
 ds_read_b64_tr_b16 v[208:209], v4 offset:8192
 v_mfma_f32_16x16x32_bf16 v[76:79], v[216:219], v[136:139], v[76:79]
 ds_read_b64_tr_b16 v[210:211], v4 offset:8704
 s_waitcnt lgkmcnt(10)
 s_lshr_b32 s41, s74, 1
 s_add_u32 m0, s41, 65536
 s_add_u32 s41, s73, 1056768
 buffer_load_dwordx4 v17, s[64:67], s41 offen lds
 v_mfma_f32_16x16x32_bf16 v[72:75], v[220:223], v[132:135], v[72:75]
 ds_read_b64_tr_b16 v[212:213], v5 offset:8192
 v_mfma_f32_16x16x32_bf16 v[80:83], v[220:223], v[136:139], v[80:83]
 ds_read_b64_tr_b16 v[214:215], v5 offset:8704
 s_waitcnt lgkmcnt(10)
 v_mfma_f32_16x16x32_bf16 v[84:87], v[224:227], v[132:135], v[84:87]
 ds_read_b64_tr_b16 v[216:217], v6 offset:8192
 v_mfma_f32_16x16x32_bf16 v[92:95], v[224:227], v[136:139], v[92:95]
 ds_read_b64_tr_b16 v[218:219], v6 offset:8704
 s_waitcnt lgkmcnt(10)
 s_lshl_b32 s42, s75, 15
 s_add_u32 s42, s42, 24576
 buffer_load_dwordx4 v[164:167], v232, s[8:11], s42 offen offset:0 sc1
 v_mfma_f32_16x16x32_bf16 v[88:91], v[228:231], v[132:135], v[88:91]
 ds_read_b64_tr_b16 v[220:221], v7 offset:8192
 v_mfma_f32_16x16x32_bf16 v[96:99], v[228:231], v[136:139], v[96:99]
 ds_read_b64_tr_b16 v[222:223], v7 offset:8704
 s_waitcnt lgkmcnt(10)
 v_mfma_f32_16x16x32_bf16 v[100:103], v[200:203], v[132:135], v[100:103]
 ds_read_b64_tr_b16 v[224:225], v4 offset:9216
 v_mfma_f32_16x16x32_bf16 v[108:111], v[200:203], v[136:139], v[108:111]
 ds_read_b64_tr_b16 v[226:227], v4 offset:9728
 s_waitcnt lgkmcnt(10)
 buffer_load_dwordx4 v[168:171], v232, s[8:11], s42 offen offset:1024 sc1
 v_mfma_f32_16x16x32_bf16 v[104:107], v[204:207], v[132:135], v[104:107]
 ds_read_b64_tr_b16 v[228:229], v5 offset:9216
 v_mfma_f32_16x16x32_bf16 v[112:115], v[204:207], v[136:139], v[112:115]
 ds_read_b64_tr_b16 v[230:231], v5 offset:9728
 s_waitcnt vmcnt(12) lgkmcnt(10)
 v_mfma_f32_16x16x32_bf16 v[36:39], v[208:211], v[140:143], v[36:39]
 ds_read_b64_tr_b16 v[200:201], v6 offset:9216
 v_mfma_f32_16x16x32_bf16 v[44:47], v[208:211], v[144:147], v[44:47]
 ds_read_b64_tr_b16 v[202:203], v6 offset:9728
 s_waitcnt lgkmcnt(10)
 buffer_load_dwordx4 v[172:175], v232, s[8:11], s42 offen offset:2048 sc1
 v_mfma_f32_16x16x32_bf16 v[40:43], v[212:215], v[140:143], v[40:43]
 ds_read_b64_tr_b16 v[204:205], v7 offset:9216
 v_mfma_f32_16x16x32_bf16 v[48:51], v[212:215], v[144:147], v[48:51]
 ds_read_b64_tr_b16 v[206:207], v7 offset:9728
 s_waitcnt lgkmcnt(10)
 v_mfma_f32_16x16x32_bf16 v[52:55], v[216:219], v[140:143], v[52:55]
 ds_read_b64_tr_b16 v[208:209], v12 offset:2048
 v_mfma_f32_16x16x32_bf16 v[60:63], v[216:219], v[144:147], v[60:63]
 ds_read_b64_tr_b16 v[210:211], v12 offset:2304
 s_waitcnt lgkmcnt(10)
 buffer_load_dwordx4 v[176:179], v232, s[8:11], s42 offen offset:3072 sc1
 s_waitcnt vmcnt(11)
 s_barrier
 v_mfma_f32_16x16x32_bf16 v[56:59], v[220:223], v[140:143], v[56:59]
 ds_read_b64_tr_b16 v[212:213], v13 offset:2048
 v_mfma_f32_16x16x32_bf16 v[64:67], v[220:223], v[144:147], v[64:67]
 ds_read_b64_tr_b16 v[214:215], v13 offset:2304
 s_waitcnt lgkmcnt(10)
 v_mfma_f32_16x16x32_bf16 v[68:71], v[224:227], v[140:143], v[68:71]
 ds_read_b64_tr_b16 v[216:217], v4 offset:24576
 v_mfma_f32_16x16x32_bf16 v[76:79], v[224:227], v[144:147], v[76:79]
 ds_read_b64_tr_b16 v[218:219], v4 offset:25088
 s_waitcnt lgkmcnt(10)
 v_mfma_f32_16x16x32_bf16 v[72:75], v[228:231], v[140:143], v[72:75]
 ds_read_b64_tr_b16 v[220:221], v5 offset:24576
 v_mfma_f32_16x16x32_bf16 v[80:83], v[228:231], v[144:147], v[80:83]
 ds_read_b64_tr_b16 v[222:223], v5 offset:25088
 s_waitcnt lgkmcnt(10)
 v_mfma_f32_16x16x32_bf16 v[84:87], v[200:203], v[140:143], v[84:87]
 ds_read_b64_tr_b16 v[224:225], v6 offset:24576
 v_mfma_f32_16x16x32_bf16 v[92:95], v[200:203], v[144:147], v[92:95]
 ds_read_b64_tr_b16 v[226:227], v6 offset:25088
 s_waitcnt lgkmcnt(10)
 v_mfma_f32_16x16x32_bf16 v[88:91], v[204:207], v[140:143], v[88:91]
 ds_read_b64_tr_b16 v[228:229], v7 offset:24576
 v_mfma_f32_16x16x32_bf16 v[96:99], v[204:207], v[144:147], v[96:99]
 ds_read_b64_tr_b16 v[230:231], v7 offset:25088
 s_waitcnt lgkmcnt(10)
 v_mfma_f32_16x16x32_bf16 v[100:103], v[208:211], v[140:143], v[100:103]
 ds_read_b64_tr_b16 v[200:201], v4 offset:25600
 v_mfma_f32_16x16x32_bf16 v[108:111], v[208:211], v[144:147], v[108:111]
 ds_read_b64_tr_b16 v[202:203], v4 offset:26112
 s_waitcnt lgkmcnt(10)
 v_mfma_f32_16x16x32_bf16 v[104:107], v[212:215], v[140:143], v[104:107]
 ds_read_b64_tr_b16 v[204:205], v5 offset:25600
 v_mfma_f32_16x16x32_bf16 v[112:115], v[212:215], v[144:147], v[112:115]
 ds_read_b64_tr_b16 v[206:207], v5 offset:26112
 s_waitcnt vmcnt(9) lgkmcnt(10)
 buffer_load_dwordx4 v[248:251], v232, s[96:99], s90 offen sc1
 v_mfma_f32_16x16x32_bf16 v[36:39], v[216:219], v[148:151], v[36:39]
 ds_read_b64_tr_b16 v[208:209], v6 offset:25600
 v_mfma_f32_16x16x32_bf16 v[44:47], v[216:219], v[152:155], v[44:47]
 ds_read_b64_tr_b16 v[210:211], v6 offset:26112
 s_waitcnt lgkmcnt(10)
 s_add_u32 m0, s74, 73728
 s_add_u32 s41, s72, 3670016
 buffer_load_dwordx4 v16, s[60:63], s41 offen offset:0 lds
 v_mfma_f32_16x16x32_bf16 v[40:43], v[220:223], v[148:151], v[40:43]
 ds_read_b64_tr_b16 v[212:213], v7 offset:25600
 v_mfma_f32_16x16x32_bf16 v[48:51], v[220:223], v[152:155], v[48:51]
 ds_read_b64_tr_b16 v[214:215], v7 offset:26112
 s_waitcnt lgkmcnt(10)
 v_mfma_f32_16x16x32_bf16 v[52:55], v[224:227], v[148:151], v[52:55]
 ds_read_b64_tr_b16 v[216:217], v12 offset:24576
 v_mfma_f32_16x16x32_bf16 v[60:63], v[224:227], v[152:155], v[60:63]
 ds_read_b64_tr_b16 v[218:219], v12 offset:24832
 s_waitcnt lgkmcnt(10)
 s_add_u32 m0, s74, 74624
 s_add_u32 s41, s72, 3670016
 buffer_load_dwordx4 v16, s[60:63], s41 offen offset:128 lds
 v_mfma_f32_16x16x32_bf16 v[56:59], v[228:231], v[148:151], v[56:59]
 ds_read_b64_tr_b16 v[220:221], v13 offset:24576
 v_mfma_f32_16x16x32_bf16 v[64:67], v[228:231], v[152:155], v[64:67]
 ds_read_b64_tr_b16 v[222:223], v13 offset:24832
 s_waitcnt lgkmcnt(10)
 v_mfma_f32_16x16x32_bf16 v[68:71], v[200:203], v[148:151], v[68:71]
 ds_read_b64_tr_b16 v[224:225], v4 offset:32768
 v_mfma_f32_16x16x32_bf16 v[76:79], v[200:203], v[152:155], v[76:79]
 ds_read_b64_tr_b16 v[226:227], v4 offset:33280
 s_waitcnt lgkmcnt(10)
 s_lshr_b32 s41, s74, 1
 s_add_u32 m0, s41, 90112
 s_add_u32 s41, s73, 1232896
 buffer_load_dwordx4 v17, s[64:67], s41 offen lds
 v_mfma_f32_16x16x32_bf16 v[72:75], v[204:207], v[148:151], v[72:75]
 ds_read_b64_tr_b16 v[228:229], v5 offset:32768
 v_mfma_f32_16x16x32_bf16 v[80:83], v[204:207], v[152:155], v[80:83]
 ds_read_b64_tr_b16 v[230:231], v5 offset:33280
 s_waitcnt lgkmcnt(10)
 v_mfma_f32_16x16x32_bf16 v[84:87], v[208:211], v[148:151], v[84:87]
 ds_read_b64_tr_b16 v[200:201], v6 offset:32768
 v_mfma_f32_16x16x32_bf16 v[92:95], v[208:211], v[152:155], v[92:95]
 ds_read_b64_tr_b16 v[202:203], v6 offset:33280
 s_waitcnt lgkmcnt(10)
 s_lshl_b32 s42, s75, 15
 s_add_u32 s42, s42, 28672
 buffer_load_dwordx4 v[180:183], v232, s[8:11], s42 offen offset:0 sc1
 v_mfma_f32_16x16x32_bf16 v[88:91], v[212:215], v[148:151], v[88:91]
 ds_read_b64_tr_b16 v[204:205], v7 offset:32768
 v_mfma_f32_16x16x32_bf16 v[96:99], v[212:215], v[152:155], v[96:99]
 ds_read_b64_tr_b16 v[206:207], v7 offset:33280
 s_waitcnt lgkmcnt(10)
 v_mfma_f32_16x16x32_bf16 v[100:103], v[216:219], v[148:151], v[100:103]
 ds_read_b64_tr_b16 v[208:209], v4 offset:33792
 v_mfma_f32_16x16x32_bf16 v[108:111], v[216:219], v[152:155], v[108:111]
 ds_read_b64_tr_b16 v[210:211], v4 offset:34304
 s_waitcnt lgkmcnt(10)
 buffer_load_dwordx4 v[184:187], v232, s[8:11], s42 offen offset:1024 sc1
 v_mfma_f32_16x16x32_bf16 v[104:107], v[220:223], v[148:151], v[104:107]
 ds_read_b64_tr_b16 v[212:213], v5 offset:33792
 v_mfma_f32_16x16x32_bf16 v[112:115], v[220:223], v[152:155], v[112:115]
 ds_read_b64_tr_b16 v[214:215], v5 offset:34304
 s_waitcnt vmcnt(13) lgkmcnt(10)
 v_mfma_f32_16x16x32_bf16 v[36:39], v[224:227], v[156:159], v[36:39]
 ds_read_b64_tr_b16 v[216:217], v6 offset:33792
 v_mfma_f32_16x16x32_bf16 v[44:47], v[224:227], v[160:163], v[44:47]
 ds_read_b64_tr_b16 v[218:219], v6 offset:34304
 s_waitcnt lgkmcnt(10)
 buffer_load_dwordx4 v[188:191], v232, s[8:11], s42 offen offset:2048 sc1
 v_mfma_f32_16x16x32_bf16 v[40:43], v[228:231], v[156:159], v[40:43]
 ds_read_b64_tr_b16 v[220:221], v7 offset:33792
 v_mfma_f32_16x16x32_bf16 v[48:51], v[228:231], v[160:163], v[48:51]
 ds_read_b64_tr_b16 v[222:223], v7 offset:34304
 s_waitcnt lgkmcnt(10)
 v_mfma_f32_16x16x32_bf16 v[52:55], v[200:203], v[156:159], v[52:55]
 ds_read_b64_tr_b16 v[224:225], v12 offset:26624
 v_mfma_f32_16x16x32_bf16 v[60:63], v[200:203], v[160:163], v[60:63]
 ds_read_b64_tr_b16 v[226:227], v12 offset:26880
 s_waitcnt lgkmcnt(10)
 buffer_load_dwordx4 v[192:195], v232, s[8:11], s42 offen offset:3072 sc1
 s_waitcnt vmcnt(12)
 s_barrier
 v_mfma_f32_16x16x32_bf16 v[56:59], v[204:207], v[156:159], v[56:59]
 ds_read_b64_tr_b16 v[228:229], v13 offset:26624
 v_mfma_f32_16x16x32_bf16 v[64:67], v[204:207], v[160:163], v[64:67]
 ds_read_b64_tr_b16 v[230:231], v13 offset:26880
 s_waitcnt lgkmcnt(10)
 v_mfma_f32_16x16x32_bf16 v[68:71], v[208:211], v[156:159], v[68:71]
 ds_read_b64_tr_b16 v[200:201], v8 offset:0
 v_mfma_f32_16x16x32_bf16 v[76:79], v[208:211], v[160:163], v[76:79]
 ds_read_b64_tr_b16 v[202:203], v8 offset:512
 s_waitcnt lgkmcnt(10)
 v_mfma_f32_16x16x32_bf16 v[72:75], v[212:215], v[156:159], v[72:75]
 ds_read_b64_tr_b16 v[204:205], v9 offset:0
 v_mfma_f32_16x16x32_bf16 v[80:83], v[212:215], v[160:163], v[80:83]
 ds_read_b64_tr_b16 v[206:207], v9 offset:512
 s_waitcnt lgkmcnt(10)
 v_mfma_f32_16x16x32_bf16 v[84:87], v[216:219], v[156:159], v[84:87]
 ds_read_b64_tr_b16 v[208:209], v10 offset:0
 v_mfma_f32_16x16x32_bf16 v[92:95], v[216:219], v[160:163], v[92:95]
 ds_read_b64_tr_b16 v[210:211], v10 offset:512
 s_waitcnt lgkmcnt(10)
 v_mfma_f32_16x16x32_bf16 v[88:91], v[220:223], v[156:159], v[88:91]
 ds_read_b64_tr_b16 v[212:213], v11 offset:0
 v_mfma_f32_16x16x32_bf16 v[96:99], v[220:223], v[160:163], v[96:99]
 ds_read_b64_tr_b16 v[214:215], v11 offset:512
 s_waitcnt lgkmcnt(10)
 v_mfma_f32_16x16x32_bf16 v[100:103], v[224:227], v[156:159], v[100:103]
 ds_read_b64_tr_b16 v[216:217], v8 offset:1024
 v_mfma_f32_16x16x32_bf16 v[108:111], v[224:227], v[160:163], v[108:111]
 ds_read_b64_tr_b16 v[218:219], v8 offset:1536
 s_waitcnt lgkmcnt(10)
 v_mfma_f32_16x16x32_bf16 v[104:107], v[228:231], v[156:159], v[104:107]
 ds_read_b64_tr_b16 v[220:221], v9 offset:1024
 v_mfma_f32_16x16x32_bf16 v[112:115], v[228:231], v[160:163], v[112:115]
 ds_read_b64_tr_b16 v[222:223], v9 offset:1536
 s_waitcnt vmcnt(10) lgkmcnt(10)
 v_mfma_f32_16x16x32_bf16 v[36:39], v[200:203], v[164:167], v[36:39]
 ds_read_b64_tr_b16 v[224:225], v10 offset:1024
 v_mfma_f32_16x16x32_bf16 v[44:47], v[200:203], v[168:171], v[44:47]
 ds_read_b64_tr_b16 v[226:227], v10 offset:1536
 s_waitcnt lgkmcnt(10)
 v_mfma_f32_16x16x32_bf16 v[40:43], v[204:207], v[164:167], v[40:43]
 ds_read_b64_tr_b16 v[228:229], v11 offset:1024
 v_mfma_f32_16x16x32_bf16 v[48:51], v[204:207], v[168:171], v[48:51]
 ds_read_b64_tr_b16 v[230:231], v11 offset:1536
 s_waitcnt lgkmcnt(10)
 v_mfma_f32_16x16x32_bf16 v[52:55], v[208:211], v[164:167], v[52:55]
 ds_read_b64_tr_b16 v[200:201], v14 offset:0
 v_mfma_f32_16x16x32_bf16 v[60:63], v[208:211], v[168:171], v[60:63]
 ds_read_b64_tr_b16 v[202:203], v14 offset:256
 s_waitcnt lgkmcnt(10)
 v_mfma_f32_16x16x32_bf16 v[56:59], v[212:215], v[164:167], v[56:59]
 ds_read_b64_tr_b16 v[204:205], v15 offset:0
 v_mfma_f32_16x16x32_bf16 v[64:67], v[212:215], v[168:171], v[64:67]
 ds_read_b64_tr_b16 v[206:207], v15 offset:256
 s_waitcnt lgkmcnt(10)
 v_mfma_f32_16x16x32_bf16 v[68:71], v[216:219], v[164:167], v[68:71]
 ds_read_b64_tr_b16 v[208:209], v8 offset:8192
 v_mfma_f32_16x16x32_bf16 v[76:79], v[216:219], v[168:171], v[76:79]
 ds_read_b64_tr_b16 v[210:211], v8 offset:8704
 s_waitcnt lgkmcnt(10)
 v_mfma_f32_16x16x32_bf16 v[72:75], v[220:223], v[164:167], v[72:75]
 ds_read_b64_tr_b16 v[212:213], v9 offset:8192
 v_mfma_f32_16x16x32_bf16 v[80:83], v[220:223], v[168:171], v[80:83]
 ds_read_b64_tr_b16 v[214:215], v9 offset:8704
 s_waitcnt lgkmcnt(10)
 v_mfma_f32_16x16x32_bf16 v[84:87], v[224:227], v[164:167], v[84:87]
 ds_read_b64_tr_b16 v[216:217], v10 offset:8192
 v_mfma_f32_16x16x32_bf16 v[92:95], v[224:227], v[168:171], v[92:95]
 ds_read_b64_tr_b16 v[218:219], v10 offset:8704
 s_waitcnt lgkmcnt(10)
 v_mfma_f32_16x16x32_bf16 v[88:91], v[228:231], v[164:167], v[88:91]
 ds_read_b64_tr_b16 v[220:221], v11 offset:8192
 v_mfma_f32_16x16x32_bf16 v[96:99], v[228:231], v[168:171], v[96:99]
 ds_read_b64_tr_b16 v[222:223], v11 offset:8704
 s_waitcnt lgkmcnt(10)
 v_mfma_f32_16x16x32_bf16 v[100:103], v[200:203], v[164:167], v[100:103]
 ds_read_b64_tr_b16 v[224:225], v8 offset:9216
 v_mfma_f32_16x16x32_bf16 v[108:111], v[200:203], v[168:171], v[108:111]
 ds_read_b64_tr_b16 v[226:227], v8 offset:9728
 s_waitcnt lgkmcnt(10)
 v_mfma_f32_16x16x32_bf16 v[104:107], v[204:207], v[164:167], v[104:107]
 ds_read_b64_tr_b16 v[228:229], v9 offset:9216
 v_mfma_f32_16x16x32_bf16 v[112:115], v[204:207], v[168:171], v[112:115]
 ds_read_b64_tr_b16 v[230:231], v9 offset:9728
 s_waitcnt vmcnt(8) lgkmcnt(10)
 v_mfma_f32_16x16x32_bf16 v[36:39], v[208:211], v[172:175], v[36:39]
 ds_read_b64_tr_b16 v[200:201], v10 offset:9216
 v_mfma_f32_16x16x32_bf16 v[44:47], v[208:211], v[176:179], v[44:47]
 ds_read_b64_tr_b16 v[202:203], v10 offset:9728
 s_waitcnt lgkmcnt(10)
 v_mfma_f32_16x16x32_bf16 v[40:43], v[212:215], v[172:175], v[40:43]
 ds_read_b64_tr_b16 v[204:205], v11 offset:9216
 v_mfma_f32_16x16x32_bf16 v[48:51], v[212:215], v[176:179], v[48:51]
 ds_read_b64_tr_b16 v[206:207], v11 offset:9728
 s_waitcnt lgkmcnt(10)
 v_mfma_f32_16x16x32_bf16 v[52:55], v[216:219], v[172:175], v[52:55]
 ds_read_b64_tr_b16 v[208:209], v14 offset:2048
 v_mfma_f32_16x16x32_bf16 v[60:63], v[216:219], v[176:179], v[60:63]
 ds_read_b64_tr_b16 v[210:211], v14 offset:2304
 s_waitcnt lgkmcnt(10)
 s_waitcnt vmcnt(0)
 s_barrier
 s_cmp_eq_u32 s54, 0
 s_cbranch_scc1 KB_NKV6_N1
 s_waitcnt vmcnt(7)
 s_cmp_lg_u32 s92, 0
 s_cbranch_scc1 KB_SQKN1
 s_mov_b32 s77, 4096
KB_SPKN1:
 v_cmp_ne_u64 vcc, v[248:249], v[254:255]
 v_cmp_ne_u64 s[46:47], v[250:251], v[254:255]
 s_or_b64 s[46:47], vcc, s[46:47]
 s_cbranch_scc0 KB_SQKN1
 s_sleep 2
 buffer_load_dwordx4 v[248:251], v232, s[96:99], s90 offen sc1
 s_sub_u32 s77, s77, 1
 s_cmp_eq_u32 s77, 0
 s_waitcnt vmcnt(0)
 s_cbranch_scc0 KB_SPKN1
 s_mov_b32 s101, 1
KB_SQKN1:
 s_mov_b32 m0, s35
 s_nop 0
 buffer_load_dwordx4 v197, s[12:15], s31 offen offset:0 sc1 lds
 buffer_load_dwordx4 v197, s[12:15], s31 offen offset:1024 sc1 lds
 buffer_load_dwordx4 v197, s[12:15], s31 offen offset:2048 sc1 lds
 buffer_load_dwordx4 v197, s[12:15], s31 offen offset:3072 sc1 lds
 s_add_u32 s31, s31, 16384
 s_add_u32 s35, s35, 32768
 s_and_b32 s35, s35, 0x1ffff
 s_mov_b32 m0, s36
 s_nop 0
 buffer_load_dwordx4 v197, s[16:19], s33 offen offset:0 sc1 lds
 buffer_load_dwordx4 v197, s[16:19], s33 offen offset:1024 sc1 lds
 buffer_load_dwordx4 v197, s[16:19], s33 offen offset:2048 sc1 lds
 buffer_load_dwordx4 v197, s[16:19], s33 offen offset:3072 sc1 lds
 s_add_u32 s33, s33, 16384
 s_add_u32 s36, s36, 32768
 s_and_b32 s36, s36, 0x1ffff
KB_NKV6_N1:
 v_mfma_f32_16x16x32_bf16 v[56:59], v[220:223], v[172:175], v[56:59]
 ds_read_b64_tr_b16 v[212:213], v15 offset:2048
 v_mfma_f32_16x16x32_bf16 v[64:67], v[220:223], v[176:179], v[64:67]
 ds_read_b64_tr_b16 v[214:215], v15 offset:2304
 s_waitcnt lgkmcnt(10)
 v_mfma_f32_16x16x32_bf16 v[68:71], v[224:227], v[172:175], v[68:71]
 ds_read_b64_tr_b16 v[216:217], v14 offset:24576
 v_mfma_f32_16x16x32_bf16 v[76:79], v[224:227], v[176:179], v[76:79]
 ds_read_b64_tr_b16 v[218:219], v14 offset:24832
 s_waitcnt lgkmcnt(10)
 v_mfma_f32_16x16x32_bf16 v[72:75], v[228:231], v[172:175], v[72:75]
 ds_read_b64_tr_b16 v[220:221], v14 offset:26624
 v_mfma_f32_16x16x32_bf16 v[80:83], v[228:231], v[176:179], v[80:83]
 ds_read_b64_tr_b16 v[222:223], v14 offset:26880
 s_waitcnt lgkmcnt(10)
 v_mfma_f32_16x16x32_bf16 v[84:87], v[200:203], v[172:175], v[84:87]
 ds_read_b64_tr_b16 v[224:225], v15 offset:24576
 v_mfma_f32_16x16x32_bf16 v[92:95], v[200:203], v[176:179], v[92:95]
 ds_read_b64_tr_b16 v[226:227], v15 offset:24832
 s_waitcnt lgkmcnt(10)
 v_mfma_f32_16x16x32_bf16 v[88:91], v[204:207], v[172:175], v[88:91]
 ds_read_b64_tr_b16 v[228:229], v15 offset:26624
 v_mfma_f32_16x16x32_bf16 v[96:99], v[204:207], v[176:179], v[96:99]
 ds_read_b64_tr_b16 v[230:231], v15 offset:26880
 s_waitcnt lgkmcnt(10)
 v_mfma_f32_16x16x32_bf16 v[100:103], v[208:211], v[172:175], v[100:103]
 ds_read_b64_tr_b16 v[200:201], v8 offset:24576
 v_mfma_f32_16x16x32_bf16 v[108:111], v[208:211], v[176:179], v[108:111]
 ds_read_b64_tr_b16 v[202:203], v8 offset:25088
 s_waitcnt lgkmcnt(10)
 v_mfma_f32_16x16x32_bf16 v[104:107], v[212:215], v[172:175], v[104:107]
 ds_read_b64_tr_b16 v[204:205], v8 offset:32768
 v_mfma_f32_16x16x32_bf16 v[112:115], v[212:215], v[176:179], v[112:115]
 ds_read_b64_tr_b16 v[206:207], v8 offset:33280
 s_waitcnt lgkmcnt(10)
 v_mfma_f32_16x16x32_bf16 v[100:103], v[216:219], v[180:183], v[100:103]
 ds_read_b64_tr_b16 v[208:209], v9 offset:24576
 v_mfma_f32_16x16x32_bf16 v[108:111], v[216:219], v[184:187], v[108:111]
 ds_read_b64_tr_b16 v[210:211], v9 offset:25088
 s_waitcnt lgkmcnt(10)
 v_mfma_f32_16x16x32_bf16 v[100:103], v[220:223], v[188:191], v[100:103]
 ds_read_b64_tr_b16 v[212:213], v9 offset:32768
 v_mfma_f32_16x16x32_bf16 v[108:111], v[220:223], v[192:195], v[108:111]
 ds_read_b64_tr_b16 v[214:215], v9 offset:33280
 s_waitcnt lgkmcnt(10)
 v_mfma_f32_16x16x32_bf16 v[104:107], v[224:227], v[180:183], v[104:107]
 ds_read_b64_tr_b16 v[216:217], v10 offset:24576
 v_mfma_f32_16x16x32_bf16 v[112:115], v[224:227], v[184:187], v[112:115]
 ds_read_b64_tr_b16 v[218:219], v10 offset:25088
 s_waitcnt lgkmcnt(10)
 s_barrier
 s_cmp_eq_u32 s54, 0
 s_cbranch_scc1 KB_NKV7_N1
 s_mov_b32 m0, s35
 s_nop 0
 buffer_load_dwordx4 v197, s[12:15], s31 offen offset:0 sc1 lds
 buffer_load_dwordx4 v197, s[12:15], s31 offen offset:1024 sc1 lds
 buffer_load_dwordx4 v197, s[12:15], s31 offen offset:2048 sc1 lds
 buffer_load_dwordx4 v197, s[12:15], s31 offen offset:3072 sc1 lds
 s_add_u32 s31, s31, 16384
 s_add_u32 s35, s35, 32768
 s_and_b32 s35, s35, 0x1ffff
 s_mov_b32 m0, s36
 s_nop 0
 buffer_load_dwordx4 v197, s[16:19], s33 offen offset:0 sc1 lds
 buffer_load_dwordx4 v197, s[16:19], s33 offen offset:1024 sc1 lds
 buffer_load_dwordx4 v197, s[16:19], s33 offen offset:2048 sc1 lds
 buffer_load_dwordx4 v197, s[16:19], s33 offen offset:3072 sc1 lds
 s_add_u32 s33, s33, 16384
 s_add_u32 s36, s36, 32768
 s_and_b32 s36, s36, 0x1ffff
KB_NKV7_N1:
 v_mfma_f32_16x16x32_bf16 v[104:107], v[228:231], v[188:191], v[104:107]
 ds_read_b64_tr_b16 v[220:221], v10 offset:32768
 v_mfma_f32_16x16x32_bf16 v[112:115], v[228:231], v[192:195], v[112:115]
 ds_read_b64_tr_b16 v[222:223], v10 offset:33280
 s_waitcnt lgkmcnt(10)
 v_mfma_f32_16x16x32_bf16 v[36:39], v[200:203], v[180:183], v[36:39]
 ds_read_b64_tr_b16 v[224:225], v11 offset:24576
 v_mfma_f32_16x16x32_bf16 v[44:47], v[200:203], v[184:187], v[44:47]
 ds_read_b64_tr_b16 v[226:227], v11 offset:25088
 s_waitcnt lgkmcnt(10)
 v_mfma_f32_16x16x32_bf16 v[36:39], v[204:207], v[188:191], v[36:39]
 ds_read_b64_tr_b16 v[228:229], v11 offset:32768
 v_mfma_f32_16x16x32_bf16 v[44:47], v[204:207], v[192:195], v[44:47]
 ds_read_b64_tr_b16 v[230:231], v11 offset:33280
 s_waitcnt lgkmcnt(10)
 s_lshl_b32 s77, s78, 11
 s_add_u32 s77, s77, s76
 v_max_f32 v100, 0, v100
 v_max_f32 v101, 0, v101
 v_cvt_pk_bf16_f32 v100, v100, v101
 v_max_f32 v102, 0, v102
 v_max_f32 v103, 0, v103
 v_cvt_pk_bf16_f32 v101, v102, v103
 v_mfma_f32_16x16x32_bf16 v[40:43], v[208:211], v[180:183], v[40:43]
 ds_read_b64_tr_b16 v[200:201], v8 offset:25600
 v_mfma_f32_16x16x32_bf16 v[48:51], v[208:211], v[184:187], v[48:51]
 ds_read_b64_tr_b16 v[202:203], v8 offset:26112
 s_waitcnt lgkmcnt(10)
 v_max_f32 v104, 0, v104
 v_max_f32 v105, 0, v105
 v_cvt_pk_bf16_f32 v102, v104, v105
 v_max_f32 v106, 0, v106
 v_max_f32 v107, 0, v107
 v_cvt_pk_bf16_f32 v103, v106, v107
 buffer_store_dwordx4 v[100:103], v18, s[68:71], s77 offen offset:0 sc1
 v_max_f32 v108, 0, v108
 v_mfma_f32_16x16x32_bf16 v[40:43], v[212:215], v[188:191], v[40:43]
 ds_read_b64_tr_b16 v[204:205], v8 offset:33792
 v_mfma_f32_16x16x32_bf16 v[48:51], v[212:215], v[192:195], v[48:51]
 ds_read_b64_tr_b16 v[206:207], v8 offset:34304
 s_waitcnt lgkmcnt(10)
 v_max_f32 v109, 0, v109
 v_cvt_pk_bf16_f32 v104, v108, v109
 v_max_f32 v110, 0, v110
 v_max_f32 v111, 0, v111
 v_cvt_pk_bf16_f32 v105, v110, v111
 v_max_f32 v112, 0, v112
 v_max_f32 v113, 0, v113
 v_cvt_pk_bf16_f32 v106, v112, v113
 v_mfma_f32_16x16x32_bf16 v[52:55], v[216:219], v[180:183], v[52:55]
 ds_read_b64_tr_b16 v[208:209], v9 offset:25600
 v_mfma_f32_16x16x32_bf16 v[60:63], v[216:219], v[184:187], v[60:63]
 ds_read_b64_tr_b16 v[210:211], v9 offset:26112
 s_waitcnt lgkmcnt(10)
 v_max_f32 v114, 0, v114
 v_max_f32 v115, 0, v115
 v_cvt_pk_bf16_f32 v107, v114, v115
 buffer_store_dwordx4 v[104:107], v18, s[68:71], s77 offen offset:128 sc1
 v_mfma_f32_16x16x32_bf16 v[52:55], v[220:223], v[188:191], v[52:55]
 ds_read_b64_tr_b16 v[212:213], v9 offset:33792
 v_mfma_f32_16x16x32_bf16 v[60:63], v[220:223], v[192:195], v[60:63]
 ds_read_b64_tr_b16 v[214:215], v9 offset:34304
 s_waitcnt lgkmcnt(10)
 v_mul_f32 v36, 0x3e0293ee, v36
 v_mul_f32 v37, 0x3e0293ee, v37
 v_cvt_pk_bf16_f32 v36, v36, v37
 v_mul_f32 v38, 0x3e0293ee, v38
 v_mul_f32 v39, 0x3e0293ee, v39
 v_cvt_pk_bf16_f32 v37, v38, v39
 v_mul_f32 v40, 0x3e0293ee, v40
 v_mul_f32 v41, 0x3e0293ee, v41
 v_mfma_f32_16x16x32_bf16 v[56:59], v[224:227], v[180:183], v[56:59]
 ds_read_b64_tr_b16 v[216:217], v10 offset:25600
 v_mfma_f32_16x16x32_bf16 v[64:67], v[224:227], v[184:187], v[64:67]
 ds_read_b64_tr_b16 v[218:219], v10 offset:26112
 s_waitcnt lgkmcnt(10)
 v_cvt_pk_bf16_f32 v38, v40, v41
 v_mul_f32 v42, 0x3e0293ee, v42
 v_mul_f32 v43, 0x3e0293ee, v43
 v_cvt_pk_bf16_f32 v39, v42, v43
 ds_write_b128 v19, v[36:39] offset:0
 v_mul_f32 v44, 0x3e0293ee, v44
 v_mul_f32 v45, 0x3e0293ee, v45
 v_cvt_pk_bf16_f32 v40, v44, v45
 v_mfma_f32_16x16x32_bf16 v[56:59], v[228:231], v[188:191], v[56:59]
 ds_read_b64_tr_b16 v[220:221], v10 offset:33792
 v_mfma_f32_16x16x32_bf16 v[64:67], v[228:231], v[192:195], v[64:67]
 ds_read_b64_tr_b16 v[222:223], v10 offset:34304
 s_waitcnt lgkmcnt(11)
 v_mul_f32 v46, 0x3e0293ee, v46
 v_mul_f32 v47, 0x3e0293ee, v47
 v_cvt_pk_bf16_f32 v41, v46, v47
 v_mul_f32 v48, 0x3e0293ee, v48
 v_mul_f32 v49, 0x3e0293ee, v49
 v_cvt_pk_bf16_f32 v42, v48, v49
 v_mul_f32 v50, 0x3e0293ee, v50
 v_mul_f32 v51, 0x3e0293ee, v51
 v_mfma_f32_16x16x32_bf16 v[68:71], v[200:203], v[180:183], v[68:71]
 ds_read_b64_tr_b16 v[224:225], v11 offset:25600
 v_mfma_f32_16x16x32_bf16 v[76:79], v[200:203], v[184:187], v[76:79]
 ds_read_b64_tr_b16 v[226:227], v11 offset:26112
 s_waitcnt lgkmcnt(11)
 v_cvt_pk_bf16_f32 v43, v50, v51
 ds_write_b128 v19, v[40:43] offset:128
 v_mfma_f32_16x16x32_bf16 v[68:71], v[204:207], v[188:191], v[68:71]
 ds_read_b64_tr_b16 v[228:229], v11 offset:33792
 v_mfma_f32_16x16x32_bf16 v[76:79], v[204:207], v[192:195], v[76:79]
 ds_read_b64_tr_b16 v[230:231], v11 offset:34304
 s_waitcnt lgkmcnt(12)
 v_mul_f32 v52, 0x3e0293ee, v52
 v_mul_f32 v53, 0x3e0293ee, v53
 v_cvt_pk_bf16_f32 v52, v52, v53
 v_mul_f32 v54, 0x3e0293ee, v54
 v_mul_f32 v55, 0x3e0293ee, v55
 v_cvt_pk_bf16_f32 v53, v54, v55
 v_mul_f32 v56, 0x3e0293ee, v56
 v_mul_f32 v57, 0x3e0293ee, v57
 v_mfma_f32_16x16x32_bf16 v[72:75], v[208:211], v[180:183], v[72:75]
 v_mfma_f32_16x16x32_bf16 v[80:83], v[208:211], v[184:187], v[80:83]
 s_waitcnt lgkmcnt(10)
 v_cvt_pk_bf16_f32 v54, v56, v57
 v_mul_f32 v58, 0x3e0293ee, v58
 v_mul_f32 v59, 0x3e0293ee, v59
 v_cvt_pk_bf16_f32 v55, v58, v59
 ds_write_b128 v19, v[52:55] offset:2048
 v_mul_f32 v60, 0x3e0293ee, v60
 v_mul_f32 v61, 0x3e0293ee, v61
 v_cvt_pk_bf16_f32 v56, v60, v61
 v_mfma_f32_16x16x32_bf16 v[72:75], v[212:215], v[188:191], v[72:75]
 v_mfma_f32_16x16x32_bf16 v[80:83], v[212:215], v[192:195], v[80:83]
 s_waitcnt lgkmcnt(9)
 v_mul_f32 v62, 0x3e0293ee, v62
 v_mul_f32 v63, 0x3e0293ee, v63
 v_cvt_pk_bf16_f32 v57, v62, v63
 v_mul_f32 v64, 0x3e0293ee, v64
 v_mul_f32 v65, 0x3e0293ee, v65
 v_cvt_pk_bf16_f32 v58, v64, v65
 v_mul_f32 v66, 0x3e0293ee, v66
 v_mul_f32 v67, 0x3e0293ee, v67
 v_mfma_f32_16x16x32_bf16 v[84:87], v[216:219], v[180:183], v[84:87]
 v_mfma_f32_16x16x32_bf16 v[92:95], v[216:219], v[184:187], v[92:95]
 s_waitcnt lgkmcnt(6)
 v_cvt_pk_bf16_f32 v59, v66, v67
 ds_write_b128 v19, v[56:59] offset:2176
 v_mfma_f32_16x16x32_bf16 v[84:87], v[220:223], v[188:191], v[84:87]
 v_mfma_f32_16x16x32_bf16 v[92:95], v[220:223], v[192:195], v[92:95]
 s_waitcnt lgkmcnt(5)
 v_mul_f32 v68, 0x3e0293ee, v68
 v_mul_f32 v69, 0x3e0293ee, v69
 v_cvt_pk_bf16_f32 v68, v68, v69
 v_mul_f32 v70, 0x3e0293ee, v70
 v_mul_f32 v71, 0x3e0293ee, v71
 v_cvt_pk_bf16_f32 v69, v70, v71
 v_mul_f32 v72, 0x3e0293ee, v72
 v_mul_f32 v73, 0x3e0293ee, v73
 v_mfma_f32_16x16x32_bf16 v[88:91], v[224:227], v[180:183], v[88:91]
 v_mfma_f32_16x16x32_bf16 v[96:99], v[224:227], v[184:187], v[96:99]
 s_waitcnt lgkmcnt(2)
 v_cvt_pk_bf16_f32 v70, v72, v73
 v_mul_f32 v74, 0x3e0293ee, v74
 v_mul_f32 v75, 0x3e0293ee, v75
 v_cvt_pk_bf16_f32 v71, v74, v75
 ds_write_b128 v19, v[68:71] offset:4096
 v_mul_f32 v76, 0x3e0293ee, v76
 v_mul_f32 v77, 0x3e0293ee, v77
 v_cvt_pk_bf16_f32 v72, v76, v77
 v_mfma_f32_16x16x32_bf16 v[88:91], v[228:231], v[188:191], v[88:91]
 v_mfma_f32_16x16x32_bf16 v[96:99], v[228:231], v[192:195], v[96:99]
 v_mul_f32 v78, 0x3e0293ee, v78
 v_mul_f32 v79, 0x3e0293ee, v79
 v_cvt_pk_bf16_f32 v73, v78, v79
 v_mul_f32 v80, 0x3e0293ee, v80
 v_mul_f32 v81, 0x3e0293ee, v81
 v_cvt_pk_bf16_f32 v74, v80, v81
 v_mul_f32 v82, 0x3e0293ee, v82
 v_mul_f32 v83, 0x3e0293ee, v83
 v_cvt_pk_bf16_f32 v75, v82, v83
 ds_write_b128 v19, v[72:75] offset:4224
 v_mul_f32 v84, 0x3e0293ee, v84
 v_mul_f32 v85, 0x3e0293ee, v85
 v_cvt_pk_bf16_f32 v84, v84, v85
 v_mul_f32 v86, 0x3e0293ee, v86
 v_mul_f32 v87, 0x3e0293ee, v87
 v_cvt_pk_bf16_f32 v85, v86, v87
 v_mul_f32 v88, 0x3e0293ee, v88
 v_mul_f32 v89, 0x3e0293ee, v89
 v_cvt_pk_bf16_f32 v86, v88, v89
 v_mul_f32 v90, 0x3e0293ee, v90
 v_mul_f32 v91, 0x3e0293ee, v91
 v_cvt_pk_bf16_f32 v87, v90, v91
 ds_write_b128 v19, v[84:87] offset:6144
 v_mul_f32 v92, 0x3e0293ee, v92
 v_mul_f32 v93, 0x3e0293ee, v93
 v_cvt_pk_bf16_f32 v88, v92, v93
 v_mul_f32 v94, 0x3e0293ee, v94
 v_mul_f32 v95, 0x3e0293ee, v95
 v_cvt_pk_bf16_f32 v89, v94, v95
 v_mul_f32 v96, 0x3e0293ee, v96
 v_mul_f32 v97, 0x3e0293ee, v97
 v_cvt_pk_bf16_f32 v90, v96, v97
 v_mul_f32 v98, 0x3e0293ee, v98
 v_mul_f32 v99, 0x3e0293ee, v99
 v_cvt_pk_bf16_f32 v91, v98, v99
 ds_write_b128 v19, v[88:91] offset:6272
 s_mov_b32 s30, 6
 s_branch KB_PJ
KA_TRAMP:
 s_branch KA_AGAIN
KB_Q6:
 s_add_u32 s68, s4, 0x3200000
 s_addc_u32 s69, s5, 0
 s_and_b32 s69, s69, 0xffff
 s_mov_b32 s70, 0x580000
 s_mov_b32 s71, 0x00020000
 s_add_u32 s12, s4, 0x1200000
 s_addc_u32 s13, s5, 0
 s_and_b32 s13, s13, 0xffff
 s_mov_b32 s14, 0x1000000
 s_mov_b32 s15, 0x00020000
 s_add_u32 s16, s4, 0x2200000
 s_addc_u32 s17, s5, 0
 s_and_b32 s17, s17, 0xffff
 s_mov_b32 s18, 0x1000000
 s_mov_b32 s19, 0x00020000
 s_add_u32 s20, s4, 0x6000000
 s_addc_u32 s21, s5, 0
 s_and_b32 s21, s21, 0xffff
 s_mov_b32 s22, 0x1044000
 s_mov_b32 s23, 0x00020000
 s_waitcnt vmcnt(14)
 s_barrier
 ds_write_b32 v244, v239
 ds_write_b32 v244, v239 offset:1024
 ds_write_b32 v244, v239 offset:3072
 ds_read_b64_tr_b16 v[200:201], v4 offset:0
 ds_read_b64_tr_b16 v[202:203], v4 offset:512
 ds_read_b64_tr_b16 v[204:205], v5 offset:0
 ds_read_b64_tr_b16 v[206:207], v5 offset:512
 ds_read_b64_tr_b16 v[208:209], v6 offset:0
 ds_read_b64_tr_b16 v[210:211], v6 offset:512
 ds_read_b64_tr_b16 v[212:213], v7 offset:0
 ds_read_b64_tr_b16 v[214:215], v7 offset:512
 ds_read_b64_tr_b16 v[216:217], v4 offset:1024
 ds_read_b64_tr_b16 v[218:219], v4 offset:1536
 ds_read_b64_tr_b16 v[220:221], v5 offset:1024
 ds_read_b64_tr_b16 v[222:223], v5 offset:1536
 s_waitcnt vmcnt(10) lgkmcnt(10)
 v_mfma_f32_16x16x32_bf16 v[36:39], v[200:203], v[132:135], 0
 ds_read_b64_tr_b16 v[224:225], v6 offset:1024
 v_mfma_f32_16x16x32_bf16 v[44:47], v[200:203], v[136:139], 0
 ds_read_b64_tr_b16 v[226:227], v6 offset:1536
 s_waitcnt lgkmcnt(10)
 s_add_u32 m0, s74, 49152
 s_add_u32 s41, s72, 1048576
 buffer_load_dwordx4 v16, s[60:63], s41 offen offset:0 lds
 v_mfma_f32_16x16x32_bf16 v[40:43], v[204:207], v[132:135], 0
 ds_read_b64_tr_b16 v[228:229], v7 offset:1024
 v_mfma_f32_16x16x32_bf16 v[48:51], v[204:207], v[136:139], 0
 ds_read_b64_tr_b16 v[230:231], v7 offset:1536
 s_waitcnt lgkmcnt(10)
 v_mfma_f32_16x16x32_bf16 v[52:55], v[208:211], v[132:135], 0
 ds_read_b64_tr_b16 v[200:201], v12 offset:0
 v_mfma_f32_16x16x32_bf16 v[60:63], v[208:211], v[136:139], 0
 ds_read_b64_tr_b16 v[202:203], v12 offset:256
 s_waitcnt lgkmcnt(10)
 s_add_u32 m0, s74, 50048
 s_add_u32 s41, s72, 1048576
 buffer_load_dwordx4 v16, s[60:63], s41 offen offset:128 lds
 v_mfma_f32_16x16x32_bf16 v[56:59], v[212:215], v[132:135], 0
 ds_read_b64_tr_b16 v[204:205], v13 offset:0
 v_mfma_f32_16x16x32_bf16 v[64:67], v[212:215], v[136:139], 0
 ds_read_b64_tr_b16 v[206:207], v13 offset:256
 s_waitcnt lgkmcnt(10)
 v_mfma_f32_16x16x32_bf16 v[68:71], v[216:219], v[132:135], 0
 ds_read_b64_tr_b16 v[208:209], v12 offset:4096
 v_mfma_f32_16x16x32_bf16 v[76:79], v[216:219], v[136:139], 0
 ds_read_b64_tr_b16 v[210:211], v12 offset:4352
 s_waitcnt lgkmcnt(10)
 s_lshr_b32 s41, s74, 1
 s_add_u32 m0, s41, 65536
 s_add_u32 s41, s73, 352256
 buffer_load_dwordx4 v17, s[64:67], s41 offen lds
 v_mfma_f32_16x16x32_bf16 v[72:75], v[220:223], v[132:135], 0
 ds_read_b64_tr_b16 v[212:213], v13 offset:4096
 v_mfma_f32_16x16x32_bf16 v[80:83], v[220:223], v[136:139], 0
 ds_read_b64_tr_b16 v[214:215], v13 offset:4352
 s_waitcnt lgkmcnt(10)
 s_waitcnt vmcnt(3)
 s_cmp_eq_u32 s92, 0
 s_cbranch_scc0 KB_NSG_N2
 s_mov_b64 exec, 1
 buffer_store_dwordx2 v[254:255], off, s[96:99], s91 sc1
 s_mov_b64 exec, -1
KB_NSG_N2:
 v_mfma_f32_16x16x32_bf16 v[84:87], v[224:227], v[132:135], 0
 ds_read_b64_tr_b16 v[216:217], v4 offset:8192
 v_mfma_f32_16x16x32_bf16 v[92:95], v[224:227], v[136:139], 0
 ds_read_b64_tr_b16 v[218:219], v4 offset:8704
 s_waitcnt lgkmcnt(10)
 s_lshl_b32 s42, s75, 15
 s_add_u32 s42, s42, 8192
 buffer_load_dwordx4 v[164:167], v232, s[8:11], s42 offen offset:0 sc1
 v_mfma_f32_16x16x32_bf16 v[88:91], v[228:231], v[132:135], 0
 ds_read_b64_tr_b16 v[220:221], v5 offset:8192
 v_mfma_f32_16x16x32_bf16 v[96:99], v[228:231], v[136:139], 0
 ds_read_b64_tr_b16 v[222:223], v5 offset:8704
 s_waitcnt lgkmcnt(10)
 v_mfma_f32_16x16x32_bf16 v[100:103], v[200:203], v[132:135], 0
 ds_read_b64_tr_b16 v[224:225], v6 offset:8192
 v_mfma_f32_16x16x32_bf16 v[108:111], v[200:203], v[136:139], 0
 ds_read_b64_tr_b16 v[226:227], v6 offset:8704
 s_waitcnt lgkmcnt(10)
 buffer_load_dwordx4 v[168:171], v232, s[8:11], s42 offen offset:1024 sc1
 v_mfma_f32_16x16x32_bf16 v[104:107], v[204:207], v[132:135], 0
 ds_read_b64_tr_b16 v[228:229], v7 offset:8192
 v_mfma_f32_16x16x32_bf16 v[112:115], v[204:207], v[136:139], 0
 ds_read_b64_tr_b16 v[230:231], v7 offset:8704
 s_waitcnt lgkmcnt(10)
 v_mfma_f32_16x16x32_bf16 v[116:119], v[208:211], v[132:135], 0
 ds_read_b64_tr_b16 v[200:201], v4 offset:9216
 v_mfma_f32_16x16x32_bf16 v[124:127], v[208:211], v[136:139], 0
 ds_read_b64_tr_b16 v[202:203], v4 offset:9728
 s_waitcnt lgkmcnt(10)
 buffer_load_dwordx4 v[172:175], v232, s[8:11], s42 offen offset:2048 sc1
 v_mfma_f32_16x16x32_bf16 v[120:123], v[212:215], v[132:135], 0
 ds_read_b64_tr_b16 v[204:205], v5 offset:9216
 v_mfma_f32_16x16x32_bf16 v[128:131], v[212:215], v[136:139], 0
 ds_read_b64_tr_b16 v[206:207], v5 offset:9728
 s_waitcnt vmcnt(14) lgkmcnt(10)
 v_mfma_f32_16x16x32_bf16 v[36:39], v[216:219], v[140:143], v[36:39]
 ds_read_b64_tr_b16 v[208:209], v6 offset:9216
 v_mfma_f32_16x16x32_bf16 v[44:47], v[216:219], v[144:147], v[44:47]
 ds_read_b64_tr_b16 v[210:211], v6 offset:9728
 s_waitcnt lgkmcnt(10)
 buffer_load_dwordx4 v[176:179], v232, s[8:11], s42 offen offset:3072 sc1
 v_mfma_f32_16x16x32_bf16 v[40:43], v[220:223], v[140:143], v[40:43]
 ds_read_b64_tr_b16 v[212:213], v7 offset:9216
 v_mfma_f32_16x16x32_bf16 v[48:51], v[220:223], v[144:147], v[48:51]
 ds_read_b64_tr_b16 v[214:215], v7 offset:9728
 s_waitcnt lgkmcnt(10)
 v_mfma_f32_16x16x32_bf16 v[52:55], v[224:227], v[140:143], v[52:55]
 ds_read_b64_tr_b16 v[216:217], v12 offset:2048
 v_mfma_f32_16x16x32_bf16 v[60:63], v[224:227], v[144:147], v[60:63]
 ds_read_b64_tr_b16 v[218:219], v12 offset:2304
 s_waitcnt lgkmcnt(10)
 v_mfma_f32_16x16x32_bf16 v[56:59], v[228:231], v[140:143], v[56:59]
 ds_read_b64_tr_b16 v[220:221], v13 offset:2048
 v_mfma_f32_16x16x32_bf16 v[64:67], v[228:231], v[144:147], v[64:67]
 ds_read_b64_tr_b16 v[222:223], v13 offset:2304
 s_waitcnt lgkmcnt(10)
 v_mfma_f32_16x16x32_bf16 v[68:71], v[200:203], v[140:143], v[68:71]
 ds_read_b64_tr_b16 v[224:225], v12 offset:6144
 v_mfma_f32_16x16x32_bf16 v[76:79], v[200:203], v[144:147], v[76:79]
 ds_read_b64_tr_b16 v[226:227], v12 offset:6400
 s_waitcnt lgkmcnt(10)
 s_waitcnt vmcnt(23)
 s_barrier
 v_mfma_f32_16x16x32_bf16 v[72:75], v[204:207], v[140:143], v[72:75]
 ds_read_b64_tr_b16 v[228:229], v13 offset:6144
 v_mfma_f32_16x16x32_bf16 v[80:83], v[204:207], v[144:147], v[80:83]
 ds_read_b64_tr_b16 v[230:231], v13 offset:6400
 s_waitcnt lgkmcnt(10)
 v_mfma_f32_16x16x32_bf16 v[84:87], v[208:211], v[140:143], v[84:87]
 ds_read_b64_tr_b16 v[200:201], v4 offset:24576
 v_mfma_f32_16x16x32_bf16 v[92:95], v[208:211], v[144:147], v[92:95]
 ds_read_b64_tr_b16 v[202:203], v4 offset:25088
 s_waitcnt lgkmcnt(10)
 v_mfma_f32_16x16x32_bf16 v[88:91], v[212:215], v[140:143], v[88:91]
 ds_read_b64_tr_b16 v[204:205], v5 offset:24576
 v_mfma_f32_16x16x32_bf16 v[96:99], v[212:215], v[144:147], v[96:99]
 ds_read_b64_tr_b16 v[206:207], v5 offset:25088
 s_waitcnt lgkmcnt(10)
 v_mfma_f32_16x16x32_bf16 v[100:103], v[216:219], v[140:143], v[100:103]
 ds_read_b64_tr_b16 v[208:209], v6 offset:24576
 v_mfma_f32_16x16x32_bf16 v[108:111], v[216:219], v[144:147], v[108:111]
 ds_read_b64_tr_b16 v[210:211], v6 offset:25088
 s_waitcnt lgkmcnt(10)
 v_mfma_f32_16x16x32_bf16 v[104:107], v[220:223], v[140:143], v[104:107]
 ds_read_b64_tr_b16 v[212:213], v7 offset:24576
 v_mfma_f32_16x16x32_bf16 v[112:115], v[220:223], v[144:147], v[112:115]
 ds_read_b64_tr_b16 v[214:215], v7 offset:25088
 s_waitcnt lgkmcnt(10)
 v_mfma_f32_16x16x32_bf16 v[116:119], v[224:227], v[140:143], v[116:119]
 ds_read_b64_tr_b16 v[216:217], v4 offset:25600
 v_mfma_f32_16x16x32_bf16 v[124:127], v[224:227], v[144:147], v[124:127]
 ds_read_b64_tr_b16 v[218:219], v4 offset:26112
 s_waitcnt lgkmcnt(10)
 v_mfma_f32_16x16x32_bf16 v[120:123], v[228:231], v[140:143], v[120:123]
 ds_read_b64_tr_b16 v[220:221], v5 offset:25600
 v_mfma_f32_16x16x32_bf16 v[128:131], v[228:231], v[144:147], v[128:131]
 ds_read_b64_tr_b16 v[222:223], v5 offset:26112
 s_waitcnt vmcnt(13) lgkmcnt(10)
 v_mfma_f32_16x16x32_bf16 v[36:39], v[200:203], v[148:151], v[36:39]
 ds_read_b64_tr_b16 v[224:225], v6 offset:25600
 v_mfma_f32_16x16x32_bf16 v[44:47], v[200:203], v[152:155], v[44:47]
 ds_read_b64_tr_b16 v[226:227], v6 offset:26112
 s_waitcnt lgkmcnt(10)
 s_add_u32 m0, s74, 73728
 s_add_u32 s41, s72, 1572864
 buffer_load_dwordx4 v16, s[60:63], s41 offen offset:0 lds
 v_mfma_f32_16x16x32_bf16 v[40:43], v[204:207], v[148:151], v[40:43]
 ds_read_b64_tr_b16 v[228:229], v7 offset:25600
 v_mfma_f32_16x16x32_bf16 v[48:51], v[204:207], v[152:155], v[48:51]
 ds_read_b64_tr_b16 v[230:231], v7 offset:26112
 s_waitcnt lgkmcnt(10)
 v_mfma_f32_16x16x32_bf16 v[52:55], v[208:211], v[148:151], v[52:55]
 ds_read_b64_tr_b16 v[200:201], v12 offset:24576
 v_mfma_f32_16x16x32_bf16 v[60:63], v[208:211], v[152:155], v[60:63]
 ds_read_b64_tr_b16 v[202:203], v12 offset:24832
 s_waitcnt lgkmcnt(10)
 s_add_u32 m0, s74, 74624
 s_add_u32 s41, s72, 1572864
 buffer_load_dwordx4 v16, s[60:63], s41 offen offset:128 lds
 v_mfma_f32_16x16x32_bf16 v[56:59], v[212:215], v[148:151], v[56:59]
 ds_read_b64_tr_b16 v[204:205], v13 offset:24576
 v_mfma_f32_16x16x32_bf16 v[64:67], v[212:215], v[152:155], v[64:67]
 ds_read_b64_tr_b16 v[206:207], v13 offset:24832
 s_waitcnt lgkmcnt(10)
 v_mfma_f32_16x16x32_bf16 v[68:71], v[216:219], v[148:151], v[68:71]
 ds_read_b64_tr_b16 v[208:209], v12 offset:28672
 v_mfma_f32_16x16x32_bf16 v[76:79], v[216:219], v[152:155], v[76:79]
 ds_read_b64_tr_b16 v[210:211], v12 offset:28928
 s_waitcnt lgkmcnt(10)
 s_lshr_b32 s41, s74, 1
 s_add_u32 m0, s41, 90112
 s_add_u32 s41, s73, 528384
 buffer_load_dwordx4 v17, s[64:67], s41 offen lds
 v_mfma_f32_16x16x32_bf16 v[72:75], v[220:223], v[148:151], v[72:75]
 ds_read_b64_tr_b16 v[212:213], v13 offset:28672
 v_mfma_f32_16x16x32_bf16 v[80:83], v[220:223], v[152:155], v[80:83]
 ds_read_b64_tr_b16 v[214:215], v13 offset:28928
 s_waitcnt lgkmcnt(10)
 v_mfma_f32_16x16x32_bf16 v[84:87], v[224:227], v[148:151], v[84:87]
 ds_read_b64_tr_b16 v[216:217], v4 offset:32768
 v_mfma_f32_16x16x32_bf16 v[92:95], v[224:227], v[152:155], v[92:95]
 ds_read_b64_tr_b16 v[218:219], v4 offset:33280
 s_waitcnt lgkmcnt(10)
 s_lshl_b32 s42, s75, 15
 s_add_u32 s42, s42, 12288
 buffer_load_dwordx4 v[180:183], v232, s[8:11], s42 offen offset:0 sc1
 v_mfma_f32_16x16x32_bf16 v[88:91], v[228:231], v[148:151], v[88:91]
 ds_read_b64_tr_b16 v[220:221], v5 offset:32768
 v_mfma_f32_16x16x32_bf16 v[96:99], v[228:231], v[152:155], v[96:99]
 ds_read_b64_tr_b16 v[222:223], v5 offset:33280
 s_waitcnt lgkmcnt(10)
 v_mfma_f32_16x16x32_bf16 v[100:103], v[200:203], v[148:151], v[100:103]
 ds_read_b64_tr_b16 v[224:225], v6 offset:32768
 v_mfma_f32_16x16x32_bf16 v[108:111], v[200:203], v[152:155], v[108:111]
 ds_read_b64_tr_b16 v[226:227], v6 offset:33280
 s_waitcnt lgkmcnt(10)
 buffer_load_dwordx4 v[184:187], v232, s[8:11], s42 offen offset:1024 sc1
 v_mfma_f32_16x16x32_bf16 v[104:107], v[204:207], v[148:151], v[104:107]
 ds_read_b64_tr_b16 v[228:229], v7 offset:32768
 v_mfma_f32_16x16x32_bf16 v[112:115], v[204:207], v[152:155], v[112:115]
 ds_read_b64_tr_b16 v[230:231], v7 offset:33280
 s_waitcnt lgkmcnt(10)
 v_mfma_f32_16x16x32_bf16 v[116:119], v[208:211], v[148:151], v[116:119]
 ds_read_b64_tr_b16 v[200:201], v4 offset:33792
 v_mfma_f32_16x16x32_bf16 v[124:127], v[208:211], v[152:155], v[124:127]
 ds_read_b64_tr_b16 v[202:203], v4 offset:34304
 s_waitcnt lgkmcnt(10)
 buffer_load_dwordx4 v[188:191], v232, s[8:11], s42 offen offset:2048 sc1
 v_mfma_f32_16x16x32_bf16 v[120:123], v[212:215], v[148:151], v[120:123]
 ds_read_b64_tr_b16 v[204:205], v5 offset:33792
 v_mfma_f32_16x16x32_bf16 v[128:131], v[212:215], v[152:155], v[128:131]
 ds_read_b64_tr_b16 v[206:207], v5 offset:34304
 s_waitcnt vmcnt(17) lgkmcnt(10)
 v_mfma_f32_16x16x32_bf16 v[36:39], v[216:219], v[156:159], v[36:39]
 ds_read_b64_tr_b16 v[208:209], v6 offset:33792
 v_mfma_f32_16x16x32_bf16 v[44:47], v[216:219], v[160:163], v[44:47]
 ds_read_b64_tr_b16 v[210:211], v6 offset:34304
 s_waitcnt lgkmcnt(10)
 buffer_load_dwordx4 v[192:195], v232, s[8:11], s42 offen offset:3072 sc1
 v_mfma_f32_16x16x32_bf16 v[40:43], v[220:223], v[156:159], v[40:43]
 ds_read_b64_tr_b16 v[212:213], v7 offset:33792
 v_mfma_f32_16x16x32_bf16 v[48:51], v[220:223], v[160:163], v[48:51]
 ds_read_b64_tr_b16 v[214:215], v7 offset:34304
 s_waitcnt lgkmcnt(10)
 v_mfma_f32_16x16x32_bf16 v[52:55], v[224:227], v[156:159], v[52:55]
 ds_read_b64_tr_b16 v[216:217], v12 offset:26624
 v_mfma_f32_16x16x32_bf16 v[60:63], v[224:227], v[160:163], v[60:63]
 ds_read_b64_tr_b16 v[218:219], v12 offset:26880
 s_waitcnt lgkmcnt(10)
 v_mfma_f32_16x16x32_bf16 v[56:59], v[228:231], v[156:159], v[56:59]
 ds_read_b64_tr_b16 v[220:221], v13 offset:26624
 v_mfma_f32_16x16x32_bf16 v[64:67], v[228:231], v[160:163], v[64:67]
 ds_read_b64_tr_b16 v[222:223], v13 offset:26880
 s_waitcnt lgkmcnt(10)
 v_mfma_f32_16x16x32_bf16 v[68:71], v[200:203], v[156:159], v[68:71]
 ds_read_b64_tr_b16 v[224:225], v12 offset:30720
 v_mfma_f32_16x16x32_bf16 v[76:79], v[200:203], v[160:163], v[76:79]
 ds_read_b64_tr_b16 v[226:227], v12 offset:30976
 s_waitcnt lgkmcnt(10)
 s_waitcnt vmcnt(11)
 s_barrier
 v_mfma_f32_16x16x32_bf16 v[72:75], v[204:207], v[156:159], v[72:75]
 ds_read_b64_tr_b16 v[228:229], v13 offset:30720
 v_mfma_f32_16x16x32_bf16 v[80:83], v[204:207], v[160:163], v[80:83]
 ds_read_b64_tr_b16 v[230:231], v13 offset:30976
 s_waitcnt lgkmcnt(10)
 v_mfma_f32_16x16x32_bf16 v[84:87], v[208:211], v[156:159], v[84:87]
 ds_read_b64_tr_b16 v[200:201], v8 offset:0
 v_mfma_f32_16x16x32_bf16 v[92:95], v[208:211], v[160:163], v[92:95]
 ds_read_b64_tr_b16 v[202:203], v8 offset:512
 s_waitcnt lgkmcnt(10)
 v_mfma_f32_16x16x32_bf16 v[88:91], v[212:215], v[156:159], v[88:91]
 ds_read_b64_tr_b16 v[204:205], v9 offset:0
 v_mfma_f32_16x16x32_bf16 v[96:99], v[212:215], v[160:163], v[96:99]
 ds_read_b64_tr_b16 v[206:207], v9 offset:512
 s_waitcnt lgkmcnt(10)
 v_mfma_f32_16x16x32_bf16 v[100:103], v[216:219], v[156:159], v[100:103]
 ds_read_b64_tr_b16 v[208:209], v10 offset:0
 v_mfma_f32_16x16x32_bf16 v[108:111], v[216:219], v[160:163], v[108:111]
 ds_read_b64_tr_b16 v[210:211], v10 offset:512
 s_waitcnt lgkmcnt(10)
 v_mfma_f32_16x16x32_bf16 v[104:107], v[220:223], v[156:159], v[104:107]
 ds_read_b64_tr_b16 v[212:213], v11 offset:0
 v_mfma_f32_16x16x32_bf16 v[112:115], v[220:223], v[160:163], v[112:115]
 ds_read_b64_tr_b16 v[214:215], v11 offset:512
 s_waitcnt lgkmcnt(10)
 v_mfma_f32_16x16x32_bf16 v[116:119], v[224:227], v[156:159], v[116:119]
 ds_read_b64_tr_b16 v[216:217], v8 offset:1024
 v_mfma_f32_16x16x32_bf16 v[124:127], v[224:227], v[160:163], v[124:127]
 ds_read_b64_tr_b16 v[218:219], v8 offset:1536
 s_waitcnt lgkmcnt(10)
 v_mfma_f32_16x16x32_bf16 v[120:123], v[228:231], v[156:159], v[120:123]
 ds_read_b64_tr_b16 v[220:221], v9 offset:1024
 v_mfma_f32_16x16x32_bf16 v[128:131], v[228:231], v[160:163], v[128:131]
 ds_read_b64_tr_b16 v[222:223], v9 offset:1536
 s_waitcnt vmcnt(9) lgkmcnt(10)
 v_mfma_f32_16x16x32_bf16 v[36:39], v[200:203], v[164:167], v[36:39]
 ds_read_b64_tr_b16 v[224:225], v10 offset:1024
 v_mfma_f32_16x16x32_bf16 v[44:47], v[200:203], v[168:171], v[44:47]
 ds_read_b64_tr_b16 v[226:227], v10 offset:1536
 s_waitcnt lgkmcnt(10)
 s_add_u32 m0, s74, 0
 s_add_u32 s41, s72, 2097152
 buffer_load_dwordx4 v16, s[60:63], s41 offen offset:0 lds
 v_mfma_f32_16x16x32_bf16 v[40:43], v[204:207], v[164:167], v[40:43]
 ds_read_b64_tr_b16 v[228:229], v11 offset:1024
 v_mfma_f32_16x16x32_bf16 v[48:51], v[204:207], v[168:171], v[48:51]
 ds_read_b64_tr_b16 v[230:231], v11 offset:1536
 s_waitcnt lgkmcnt(10)
 v_mfma_f32_16x16x32_bf16 v[52:55], v[208:211], v[164:167], v[52:55]
 ds_read_b64_tr_b16 v[200:201], v14 offset:0
 v_mfma_f32_16x16x32_bf16 v[60:63], v[208:211], v[168:171], v[60:63]
 ds_read_b64_tr_b16 v[202:203], v14 offset:256
 s_waitcnt lgkmcnt(10)
 s_add_u32 m0, s74, 896
 s_add_u32 s41, s72, 2097152
 buffer_load_dwordx4 v16, s[60:63], s41 offen offset:128 lds
 v_mfma_f32_16x16x32_bf16 v[56:59], v[212:215], v[164:167], v[56:59]
 ds_read_b64_tr_b16 v[204:205], v15 offset:0
 v_mfma_f32_16x16x32_bf16 v[64:67], v[212:215], v[168:171], v[64:67]
 ds_read_b64_tr_b16 v[206:207], v15 offset:256
 s_waitcnt lgkmcnt(10)
 v_mfma_f32_16x16x32_bf16 v[68:71], v[216:219], v[164:167], v[68:71]
 ds_read_b64_tr_b16 v[208:209], v14 offset:4096
 v_mfma_f32_16x16x32_bf16 v[76:79], v[216:219], v[168:171], v[76:79]
 ds_read_b64_tr_b16 v[210:211], v14 offset:4352
 s_waitcnt lgkmcnt(10)
 s_lshr_b32 s41, s74, 1
 s_add_u32 m0, s41, 16384
 s_add_u32 s41, s73, 704512
 buffer_load_dwordx4 v17, s[64:67], s41 offen lds
 v_mfma_f32_16x16x32_bf16 v[72:75], v[220:223], v[164:167], v[72:75]
 ds_read_b64_tr_b16 v[212:213], v15 offset:4096
 v_mfma_f32_16x16x32_bf16 v[80:83], v[220:223], v[168:171], v[80:83]
 ds_read_b64_tr_b16 v[214:215], v15 offset:4352
 s_waitcnt lgkmcnt(10)
 v_mfma_f32_16x16x32_bf16 v[84:87], v[224:227], v[164:167], v[84:87]
 ds_read_b64_tr_b16 v[216:217], v8 offset:8192
 v_mfma_f32_16x16x32_bf16 v[92:95], v[224:227], v[168:171], v[92:95]
 ds_read_b64_tr_b16 v[218:219], v8 offset:8704
 s_waitcnt lgkmcnt(10)
 s_lshl_b32 s42, s75, 15
 s_add_u32 s42, s42, 16384
 buffer_load_dwordx4 v[132:135], v232, s[8:11], s42 offen offset:0 sc1
 v_mfma_f32_16x16x32_bf16 v[88:91], v[228:231], v[164:167], v[88:91]
 ds_read_b64_tr_b16 v[220:221], v9 offset:8192
 v_mfma_f32_16x16x32_bf16 v[96:99], v[228:231], v[168:171], v[96:99]
 ds_read_b64_tr_b16 v[222:223], v9 offset:8704
 s_waitcnt lgkmcnt(10)
 v_mfma_f32_16x16x32_bf16 v[100:103], v[200:203], v[164:167], v[100:103]
 ds_read_b64_tr_b16 v[224:225], v10 offset:8192
 v_mfma_f32_16x16x32_bf16 v[108:111], v[200:203], v[168:171], v[108:111]
 ds_read_b64_tr_b16 v[226:227], v10 offset:8704
 s_waitcnt lgkmcnt(10)
 buffer_load_dwordx4 v[136:139], v232, s[8:11], s42 offen offset:1024 sc1
 v_mfma_f32_16x16x32_bf16 v[104:107], v[204:207], v[164:167], v[104:107]
 ds_read_b64_tr_b16 v[228:229], v11 offset:8192
 v_mfma_f32_16x16x32_bf16 v[112:115], v[204:207], v[168:171], v[112:115]
 ds_read_b64_tr_b16 v[230:231], v11 offset:8704
 s_waitcnt lgkmcnt(10)
 v_mfma_f32_16x16x32_bf16 v[116:119], v[208:211], v[164:167], v[116:119]
 ds_read_b64_tr_b16 v[200:201], v8 offset:9216
 v_mfma_f32_16x16x32_bf16 v[124:127], v[208:211], v[168:171], v[124:127]
 ds_read_b64_tr_b16 v[202:203], v8 offset:9728
 s_waitcnt lgkmcnt(10)
 buffer_load_dwordx4 v[140:143], v232, s[8:11], s42 offen offset:2048 sc1
 v_mfma_f32_16x16x32_bf16 v[120:123], v[212:215], v[164:167], v[120:123]
 ds_read_b64_tr_b16 v[204:205], v9 offset:9216
 v_mfma_f32_16x16x32_bf16 v[128:131], v[212:215], v[168:171], v[128:131]
 ds_read_b64_tr_b16 v[206:207], v9 offset:9728
 s_waitcnt vmcnt(13) lgkmcnt(10)
 v_mfma_f32_16x16x32_bf16 v[36:39], v[216:219], v[172:175], v[36:39]
 ds_read_b64_tr_b16 v[208:209], v10 offset:9216
 v_mfma_f32_16x16x32_bf16 v[44:47], v[216:219], v[176:179], v[44:47]
 ds_read_b64_tr_b16 v[210:211], v10 offset:9728
 s_waitcnt lgkmcnt(10)
 buffer_load_dwordx4 v[144:147], v232, s[8:11], s42 offen offset:3072 sc1
 v_mfma_f32_16x16x32_bf16 v[40:43], v[220:223], v[172:175], v[40:43]
 ds_read_b64_tr_b16 v[212:213], v11 offset:9216
 v_mfma_f32_16x16x32_bf16 v[48:51], v[220:223], v[176:179], v[48:51]
 ds_read_b64_tr_b16 v[214:215], v11 offset:9728
 s_waitcnt lgkmcnt(10)
 v_mfma_f32_16x16x32_bf16 v[52:55], v[224:227], v[172:175], v[52:55]
 ds_read_b64_tr_b16 v[216:217], v14 offset:2048
 v_mfma_f32_16x16x32_bf16 v[60:63], v[224:227], v[176:179], v[60:63]
 ds_read_b64_tr_b16 v[218:219], v14 offset:2304
 s_waitcnt lgkmcnt(10)
 v_mfma_f32_16x16x32_bf16 v[56:59], v[228:231], v[172:175], v[56:59]
 ds_read_b64_tr_b16 v[220:221], v15 offset:2048
 v_mfma_f32_16x16x32_bf16 v[64:67], v[228:231], v[176:179], v[64:67]
 ds_read_b64_tr_b16 v[222:223], v15 offset:2304
 s_waitcnt lgkmcnt(10)
 v_mfma_f32_16x16x32_bf16 v[68:71], v[200:203], v[172:175], v[68:71]
 ds_read_b64_tr_b16 v[224:225], v14 offset:6144
 v_mfma_f32_16x16x32_bf16 v[76:79], v[200:203], v[176:179], v[76:79]
 ds_read_b64_tr_b16 v[226:227], v14 offset:6400
 s_waitcnt lgkmcnt(10)
 s_waitcnt vmcnt(11)
 s_barrier
 v_mfma_f32_16x16x32_bf16 v[72:75], v[204:207], v[172:175], v[72:75]
 ds_read_b64_tr_b16 v[228:229], v15 offset:6144
 v_mfma_f32_16x16x32_bf16 v[80:83], v[204:207], v[176:179], v[80:83]
 ds_read_b64_tr_b16 v[230:231], v15 offset:6400
 s_waitcnt lgkmcnt(10)
 v_mfma_f32_16x16x32_bf16 v[84:87], v[208:211], v[172:175], v[84:87]
 ds_read_b64_tr_b16 v[200:201], v8 offset:24576
 v_mfma_f32_16x16x32_bf16 v[92:95], v[208:211], v[176:179], v[92:95]
 ds_read_b64_tr_b16 v[202:203], v8 offset:25088
 s_waitcnt lgkmcnt(10)
 v_mfma_f32_16x16x32_bf16 v[88:91], v[212:215], v[172:175], v[88:91]
 ds_read_b64_tr_b16 v[204:205], v9 offset:24576
 v_mfma_f32_16x16x32_bf16 v[96:99], v[212:215], v[176:179], v[96:99]
 ds_read_b64_tr_b16 v[206:207], v9 offset:25088
 s_waitcnt lgkmcnt(10)
 v_mfma_f32_16x16x32_bf16 v[100:103], v[216:219], v[172:175], v[100:103]
 ds_read_b64_tr_b16 v[208:209], v10 offset:24576
 v_mfma_f32_16x16x32_bf16 v[108:111], v[216:219], v[176:179], v[108:111]
 ds_read_b64_tr_b16 v[210:211], v10 offset:25088
 s_waitcnt lgkmcnt(10)
 v_mfma_f32_16x16x32_bf16 v[104:107], v[220:223], v[172:175], v[104:107]
 ds_read_b64_tr_b16 v[212:213], v11 offset:24576
 v_mfma_f32_16x16x32_bf16 v[112:115], v[220:223], v[176:179], v[112:115]
 ds_read_b64_tr_b16 v[214:215], v11 offset:25088
 s_waitcnt lgkmcnt(10)
 v_mfma_f32_16x16x32_bf16 v[116:119], v[224:227], v[172:175], v[116:119]
 ds_read_b64_tr_b16 v[216:217], v8 offset:25600
 v_mfma_f32_16x16x32_bf16 v[124:127], v[224:227], v[176:179], v[124:127]
 ds_read_b64_tr_b16 v[218:219], v8 offset:26112
 s_waitcnt lgkmcnt(10)
 v_mfma_f32_16x16x32_bf16 v[120:123], v[228:231], v[172:175], v[120:123]
 ds_read_b64_tr_b16 v[220:221], v9 offset:25600
 v_mfma_f32_16x16x32_bf16 v[128:131], v[228:231], v[176:179], v[128:131]
 ds_read_b64_tr_b16 v[222:223], v9 offset:26112
 s_waitcnt vmcnt(9) lgkmcnt(10)
 v_mfma_f32_16x16x32_bf16 v[36:39], v[200:203], v[180:183], v[36:39]
 ds_read_b64_tr_b16 v[224:225], v10 offset:25600
 v_mfma_f32_16x16x32_bf16 v[44:47], v[200:203], v[184:187], v[44:47]
 ds_read_b64_tr_b16 v[226:227], v10 offset:26112
 s_waitcnt lgkmcnt(10)
 s_add_u32 m0, s74, 24576
 s_add_u32 s41, s72, 2621440
 buffer_load_dwordx4 v16, s[60:63], s41 offen offset:0 lds
 v_mfma_f32_16x16x32_bf16 v[40:43], v[204:207], v[180:183], v[40:43]
 ds_read_b64_tr_b16 v[228:229], v11 offset:25600
 v_mfma_f32_16x16x32_bf16 v[48:51], v[204:207], v[184:187], v[48:51]
 ds_read_b64_tr_b16 v[230:231], v11 offset:26112
 s_waitcnt lgkmcnt(10)
 v_mfma_f32_16x16x32_bf16 v[52:55], v[208:211], v[180:183], v[52:55]
 ds_read_b64_tr_b16 v[200:201], v14 offset:24576
 v_mfma_f32_16x16x32_bf16 v[60:63], v[208:211], v[184:187], v[60:63]
 ds_read_b64_tr_b16 v[202:203], v14 offset:24832
 s_waitcnt lgkmcnt(10)
 s_add_u32 m0, s74, 25472
 s_add_u32 s41, s72, 2621440
 buffer_load_dwordx4 v16, s[60:63], s41 offen offset:128 lds
 v_mfma_f32_16x16x32_bf16 v[56:59], v[212:215], v[180:183], v[56:59]
 ds_read_b64_tr_b16 v[204:205], v15 offset:24576
 v_mfma_f32_16x16x32_bf16 v[64:67], v[212:215], v[184:187], v[64:67]
 ds_read_b64_tr_b16 v[206:207], v15 offset:24832
 s_waitcnt lgkmcnt(10)
 v_mfma_f32_16x16x32_bf16 v[68:71], v[216:219], v[180:183], v[68:71]
 ds_read_b64_tr_b16 v[208:209], v14 offset:28672
 v_mfma_f32_16x16x32_bf16 v[76:79], v[216:219], v[184:187], v[76:79]
 ds_read_b64_tr_b16 v[210:211], v14 offset:28928
 s_waitcnt lgkmcnt(10)
 s_lshr_b32 s41, s74, 1
 s_add_u32 m0, s41, 40960
 s_add_u32 s41, s73, 880640
 buffer_load_dwordx4 v17, s[64:67], s41 offen lds
 v_mfma_f32_16x16x32_bf16 v[72:75], v[220:223], v[180:183], v[72:75]
 ds_read_b64_tr_b16 v[212:213], v15 offset:28672
 v_mfma_f32_16x16x32_bf16 v[80:83], v[220:223], v[184:187], v[80:83]
 ds_read_b64_tr_b16 v[214:215], v15 offset:28928
 s_waitcnt lgkmcnt(10)
 v_mfma_f32_16x16x32_bf16 v[84:87], v[224:227], v[180:183], v[84:87]
 ds_read_b64_tr_b16 v[216:217], v8 offset:32768
 v_mfma_f32_16x16x32_bf16 v[92:95], v[224:227], v[184:187], v[92:95]
 ds_read_b64_tr_b16 v[218:219], v8 offset:33280
 s_waitcnt lgkmcnt(10)
 s_lshl_b32 s42, s75, 15
 s_add_u32 s42, s42, 20480
 buffer_load_dwordx4 v[148:151], v232, s[8:11], s42 offen offset:0 sc1
 v_mfma_f32_16x16x32_bf16 v[88:91], v[228:231], v[180:183], v[88:91]
 ds_read_b64_tr_b16 v[220:221], v9 offset:32768
 v_mfma_f32_16x16x32_bf16 v[96:99], v[228:231], v[184:187], v[96:99]
 ds_read_b64_tr_b16 v[222:223], v9 offset:33280
 s_waitcnt lgkmcnt(10)
 v_mfma_f32_16x16x32_bf16 v[100:103], v[200:203], v[180:183], v[100:103]
 ds_read_b64_tr_b16 v[224:225], v10 offset:32768
 v_mfma_f32_16x16x32_bf16 v[108:111], v[200:203], v[184:187], v[108:111]
 ds_read_b64_tr_b16 v[226:227], v10 offset:33280
 s_waitcnt lgkmcnt(10)
 buffer_load_dwordx4 v[152:155], v232, s[8:11], s42 offen offset:1024 sc1
 v_mfma_f32_16x16x32_bf16 v[104:107], v[204:207], v[180:183], v[104:107]
 ds_read_b64_tr_b16 v[228:229], v11 offset:32768
 v_mfma_f32_16x16x32_bf16 v[112:115], v[204:207], v[184:187], v[112:115]
 ds_read_b64_tr_b16 v[230:231], v11 offset:33280
 s_waitcnt lgkmcnt(10)
 v_mfma_f32_16x16x32_bf16 v[116:119], v[208:211], v[180:183], v[116:119]
 ds_read_b64_tr_b16 v[200:201], v8 offset:33792
 v_mfma_f32_16x16x32_bf16 v[124:127], v[208:211], v[184:187], v[124:127]
 ds_read_b64_tr_b16 v[202:203], v8 offset:34304
 s_waitcnt lgkmcnt(10)
 buffer_load_dwordx4 v[156:159], v232, s[8:11], s42 offen offset:2048 sc1
 v_mfma_f32_16x16x32_bf16 v[120:123], v[212:215], v[180:183], v[120:123]
 ds_read_b64_tr_b16 v[204:205], v9 offset:33792
 v_mfma_f32_16x16x32_bf16 v[128:131], v[212:215], v[184:187], v[128:131]
 ds_read_b64_tr_b16 v[206:207], v9 offset:34304
 s_waitcnt vmcnt(13) lgkmcnt(10)
 v_mfma_f32_16x16x32_bf16 v[36:39], v[216:219], v[188:191], v[36:39]
 ds_read_b64_tr_b16 v[208:209], v10 offset:33792
 v_mfma_f32_16x16x32_bf16 v[44:47], v[216:219], v[192:195], v[44:47]
 ds_read_b64_tr_b16 v[210:211], v10 offset:34304
 s_waitcnt lgkmcnt(10)
 buffer_load_dwordx4 v[160:163], v232, s[8:11], s42 offen offset:3072 sc1
 v_mfma_f32_16x16x32_bf16 v[40:43], v[220:223], v[188:191], v[40:43]
 ds_read_b64_tr_b16 v[212:213], v11 offset:33792
 v_mfma_f32_16x16x32_bf16 v[48:51], v[220:223], v[192:195], v[48:51]
 ds_read_b64_tr_b16 v[214:215], v11 offset:34304
 s_waitcnt lgkmcnt(10)
 v_mfma_f32_16x16x32_bf16 v[52:55], v[224:227], v[188:191], v[52:55]
 ds_read_b64_tr_b16 v[216:217], v14 offset:26624
 v_mfma_f32_16x16x32_bf16 v[60:63], v[224:227], v[192:195], v[60:63]
 ds_read_b64_tr_b16 v[218:219], v14 offset:26880
 s_waitcnt lgkmcnt(10)
 v_mfma_f32_16x16x32_bf16 v[56:59], v[228:231], v[188:191], v[56:59]
 ds_read_b64_tr_b16 v[220:221], v15 offset:26624
 v_mfma_f32_16x16x32_bf16 v[64:67], v[228:231], v[192:195], v[64:67]
 ds_read_b64_tr_b16 v[222:223], v15 offset:26880
 s_waitcnt lgkmcnt(10)
 v_mfma_f32_16x16x32_bf16 v[68:71], v[200:203], v[188:191], v[68:71]
 ds_read_b64_tr_b16 v[224:225], v14 offset:30720
 v_mfma_f32_16x16x32_bf16 v[76:79], v[200:203], v[192:195], v[76:79]
 ds_read_b64_tr_b16 v[226:227], v14 offset:30976
 s_waitcnt lgkmcnt(10)
 s_waitcnt vmcnt(11)
 s_barrier
 v_mfma_f32_16x16x32_bf16 v[72:75], v[204:207], v[188:191], v[72:75]
 ds_read_b64_tr_b16 v[228:229], v15 offset:30720
 v_mfma_f32_16x16x32_bf16 v[80:83], v[204:207], v[192:195], v[80:83]
 ds_read_b64_tr_b16 v[230:231], v15 offset:30976
 s_waitcnt lgkmcnt(10)
 v_mfma_f32_16x16x32_bf16 v[84:87], v[208:211], v[188:191], v[84:87]
 ds_read_b64_tr_b16 v[200:201], v4 offset:0
 v_mfma_f32_16x16x32_bf16 v[92:95], v[208:211], v[192:195], v[92:95]
 ds_read_b64_tr_b16 v[202:203], v4 offset:512
 s_waitcnt lgkmcnt(10)
 v_mfma_f32_16x16x32_bf16 v[88:91], v[212:215], v[188:191], v[88:91]
 ds_read_b64_tr_b16 v[204:205], v5 offset:0
 v_mfma_f32_16x16x32_bf16 v[96:99], v[212:215], v[192:195], v[96:99]
 ds_read_b64_tr_b16 v[206:207], v5 offset:512
 s_waitcnt lgkmcnt(10)
 v_mfma_f32_16x16x32_bf16 v[100:103], v[216:219], v[188:191], v[100:103]
 ds_read_b64_tr_b16 v[208:209], v6 offset:0
 v_mfma_f32_16x16x32_bf16 v[108:111], v[216:219], v[192:195], v[108:111]
 ds_read_b64_tr_b16 v[210:211], v6 offset:512
 s_waitcnt lgkmcnt(10)
 v_mfma_f32_16x16x32_bf16 v[104:107], v[220:223], v[188:191], v[104:107]
 ds_read_b64_tr_b16 v[212:213], v7 offset:0
 v_mfma_f32_16x16x32_bf16 v[112:115], v[220:223], v[192:195], v[112:115]
 ds_read_b64_tr_b16 v[214:215], v7 offset:512
 s_waitcnt lgkmcnt(10)
 v_mfma_f32_16x16x32_bf16 v[116:119], v[224:227], v[188:191], v[116:119]
 ds_read_b64_tr_b16 v[216:217], v4 offset:1024
 v_mfma_f32_16x16x32_bf16 v[124:127], v[224:227], v[192:195], v[124:127]
 ds_read_b64_tr_b16 v[218:219], v4 offset:1536
 s_waitcnt lgkmcnt(10)
 v_mfma_f32_16x16x32_bf16 v[120:123], v[228:231], v[188:191], v[120:123]
 ds_read_b64_tr_b16 v[220:221], v5 offset:1024
 v_mfma_f32_16x16x32_bf16 v[128:131], v[228:231], v[192:195], v[128:131]
 ds_read_b64_tr_b16 v[222:223], v5 offset:1536
 s_waitcnt vmcnt(9) lgkmcnt(10)
 v_mfma_f32_16x16x32_bf16 v[36:39], v[200:203], v[132:135], v[36:39]
 ds_read_b64_tr_b16 v[224:225], v6 offset:1024
 v_mfma_f32_16x16x32_bf16 v[44:47], v[200:203], v[136:139], v[44:47]
 ds_read_b64_tr_b16 v[226:227], v6 offset:1536
 s_waitcnt lgkmcnt(10)
 s_add_u32 m0, s74, 49152
 s_add_u32 s41, s72, 3145728
 buffer_load_dwordx4 v16, s[60:63], s41 offen offset:0 lds
 v_mfma_f32_16x16x32_bf16 v[40:43], v[204:207], v[132:135], v[40:43]
 ds_read_b64_tr_b16 v[228:229], v7 offset:1024
 v_mfma_f32_16x16x32_bf16 v[48:51], v[204:207], v[136:139], v[48:51]
 ds_read_b64_tr_b16 v[230:231], v7 offset:1536
 s_waitcnt lgkmcnt(10)
 v_mfma_f32_16x16x32_bf16 v[52:55], v[208:211], v[132:135], v[52:55]
 ds_read_b64_tr_b16 v[200:201], v12 offset:0
 v_mfma_f32_16x16x32_bf16 v[60:63], v[208:211], v[136:139], v[60:63]
 ds_read_b64_tr_b16 v[202:203], v12 offset:256
 s_waitcnt lgkmcnt(10)
 s_add_u32 m0, s74, 50048
 s_add_u32 s41, s72, 3145728
 buffer_load_dwordx4 v16, s[60:63], s41 offen offset:128 lds
 v_mfma_f32_16x16x32_bf16 v[56:59], v[212:215], v[132:135], v[56:59]
 ds_read_b64_tr_b16 v[204:205], v13 offset:0
 v_mfma_f32_16x16x32_bf16 v[64:67], v[212:215], v[136:139], v[64:67]
 ds_read_b64_tr_b16 v[206:207], v13 offset:256
 s_waitcnt lgkmcnt(10)
 v_mfma_f32_16x16x32_bf16 v[68:71], v[216:219], v[132:135], v[68:71]
 ds_read_b64_tr_b16 v[208:209], v12 offset:4096
 v_mfma_f32_16x16x32_bf16 v[76:79], v[216:219], v[136:139], v[76:79]
 ds_read_b64_tr_b16 v[210:211], v12 offset:4352
 s_waitcnt lgkmcnt(10)
 s_lshr_b32 s41, s74, 1
 s_add_u32 m0, s41, 65536
 s_add_u32 s41, s73, 1056768
 buffer_load_dwordx4 v17, s[64:67], s41 offen lds
 v_mfma_f32_16x16x32_bf16 v[72:75], v[220:223], v[132:135], v[72:75]
 ds_read_b64_tr_b16 v[212:213], v13 offset:4096
 v_mfma_f32_16x16x32_bf16 v[80:83], v[220:223], v[136:139], v[80:83]
 ds_read_b64_tr_b16 v[214:215], v13 offset:4352
 s_waitcnt lgkmcnt(10)
 v_mfma_f32_16x16x32_bf16 v[84:87], v[224:227], v[132:135], v[84:87]
 ds_read_b64_tr_b16 v[216:217], v4 offset:8192
 v_mfma_f32_16x16x32_bf16 v[92:95], v[224:227], v[136:139], v[92:95]
 ds_read_b64_tr_b16 v[218:219], v4 offset:8704
 s_waitcnt lgkmcnt(10)
 s_lshl_b32 s42, s75, 15
 s_add_u32 s42, s42, 24576
 buffer_load_dwordx4 v[164:167], v232, s[8:11], s42 offen offset:0 sc1
 v_mfma_f32_16x16x32_bf16 v[88:91], v[228:231], v[132:135], v[88:91]
 ds_read_b64_tr_b16 v[220:221], v5 offset:8192
 v_mfma_f32_16x16x32_bf16 v[96:99], v[228:231], v[136:139], v[96:99]
 ds_read_b64_tr_b16 v[222:223], v5 offset:8704
 s_waitcnt lgkmcnt(10)
 v_mfma_f32_16x16x32_bf16 v[100:103], v[200:203], v[132:135], v[100:103]
 ds_read_b64_tr_b16 v[224:225], v6 offset:8192
 v_mfma_f32_16x16x32_bf16 v[108:111], v[200:203], v[136:139], v[108:111]
 ds_read_b64_tr_b16 v[226:227], v6 offset:8704
 s_waitcnt lgkmcnt(10)
 buffer_load_dwordx4 v[168:171], v232, s[8:11], s42 offen offset:1024 sc1
 v_mfma_f32_16x16x32_bf16 v[104:107], v[204:207], v[132:135], v[104:107]
 ds_read_b64_tr_b16 v[228:229], v7 offset:8192
 v_mfma_f32_16x16x32_bf16 v[112:115], v[204:207], v[136:139], v[112:115]
 ds_read_b64_tr_b16 v[230:231], v7 offset:8704
 s_waitcnt lgkmcnt(10)
 v_mfma_f32_16x16x32_bf16 v[116:119], v[208:211], v[132:135], v[116:119]
 ds_read_b64_tr_b16 v[200:201], v4 offset:9216
 v_mfma_f32_16x16x32_bf16 v[124:127], v[208:211], v[136:139], v[124:127]
 ds_read_b64_tr_b16 v[202:203], v4 offset:9728
 s_waitcnt lgkmcnt(10)
 buffer_load_dwordx4 v[172:175], v232, s[8:11], s42 offen offset:2048 sc1
 v_mfma_f32_16x16x32_bf16 v[120:123], v[212:215], v[132:135], v[120:123]
 ds_read_b64_tr_b16 v[204:205], v5 offset:9216
 v_mfma_f32_16x16x32_bf16 v[128:131], v[212:215], v[136:139], v[128:131]
 ds_read_b64_tr_b16 v[206:207], v5 offset:9728
 s_waitcnt vmcnt(13) lgkmcnt(10)
 v_mfma_f32_16x16x32_bf16 v[36:39], v[216:219], v[140:143], v[36:39]
 ds_read_b64_tr_b16 v[208:209], v6 offset:9216
 v_mfma_f32_16x16x32_bf16 v[44:47], v[216:219], v[144:147], v[44:47]
 ds_read_b64_tr_b16 v[210:211], v6 offset:9728
 s_waitcnt lgkmcnt(10)
 buffer_load_dwordx4 v[176:179], v232, s[8:11], s42 offen offset:3072 sc1
 v_mfma_f32_16x16x32_bf16 v[40:43], v[220:223], v[140:143], v[40:43]
 ds_read_b64_tr_b16 v[212:213], v7 offset:9216
 v_mfma_f32_16x16x32_bf16 v[48:51], v[220:223], v[144:147], v[48:51]
 ds_read_b64_tr_b16 v[214:215], v7 offset:9728
 s_waitcnt lgkmcnt(10)
 v_mfma_f32_16x16x32_bf16 v[52:55], v[224:227], v[140:143], v[52:55]
 ds_read_b64_tr_b16 v[216:217], v12 offset:2048
 v_mfma_f32_16x16x32_bf16 v[60:63], v[224:227], v[144:147], v[60:63]
 ds_read_b64_tr_b16 v[218:219], v12 offset:2304
 s_waitcnt lgkmcnt(10)
 v_mfma_f32_16x16x32_bf16 v[56:59], v[228:231], v[140:143], v[56:59]
 ds_read_b64_tr_b16 v[220:221], v13 offset:2048
 v_mfma_f32_16x16x32_bf16 v[64:67], v[228:231], v[144:147], v[64:67]
 ds_read_b64_tr_b16 v[222:223], v13 offset:2304
 s_waitcnt lgkmcnt(10)
 v_mfma_f32_16x16x32_bf16 v[68:71], v[200:203], v[140:143], v[68:71]
 ds_read_b64_tr_b16 v[224:225], v12 offset:6144
 v_mfma_f32_16x16x32_bf16 v[76:79], v[200:203], v[144:147], v[76:79]
 ds_read_b64_tr_b16 v[226:227], v12 offset:6400
 s_waitcnt lgkmcnt(10)
 s_waitcnt vmcnt(11)
 s_barrier
 v_mfma_f32_16x16x32_bf16 v[72:75], v[204:207], v[140:143], v[72:75]
 ds_read_b64_tr_b16 v[228:229], v13 offset:6144
 v_mfma_f32_16x16x32_bf16 v[80:83], v[204:207], v[144:147], v[80:83]
 ds_read_b64_tr_b16 v[230:231], v13 offset:6400
 s_waitcnt lgkmcnt(10)
 v_mfma_f32_16x16x32_bf16 v[84:87], v[208:211], v[140:143], v[84:87]
 ds_read_b64_tr_b16 v[200:201], v4 offset:24576
 v_mfma_f32_16x16x32_bf16 v[92:95], v[208:211], v[144:147], v[92:95]
 ds_read_b64_tr_b16 v[202:203], v4 offset:25088
 s_waitcnt lgkmcnt(10)
 v_mfma_f32_16x16x32_bf16 v[88:91], v[212:215], v[140:143], v[88:91]
 ds_read_b64_tr_b16 v[204:205], v5 offset:24576
 v_mfma_f32_16x16x32_bf16 v[96:99], v[212:215], v[144:147], v[96:99]
 ds_read_b64_tr_b16 v[206:207], v5 offset:25088
 s_waitcnt lgkmcnt(10)
 v_mfma_f32_16x16x32_bf16 v[100:103], v[216:219], v[140:143], v[100:103]
 ds_read_b64_tr_b16 v[208:209], v6 offset:24576
 v_mfma_f32_16x16x32_bf16 v[108:111], v[216:219], v[144:147], v[108:111]
 ds_read_b64_tr_b16 v[210:211], v6 offset:25088
 s_waitcnt lgkmcnt(10)
 v_mfma_f32_16x16x32_bf16 v[104:107], v[220:223], v[140:143], v[104:107]
 ds_read_b64_tr_b16 v[212:213], v7 offset:24576
 v_mfma_f32_16x16x32_bf16 v[112:115], v[220:223], v[144:147], v[112:115]
 ds_read_b64_tr_b16 v[214:215], v7 offset:25088
 s_waitcnt lgkmcnt(10)
 v_mfma_f32_16x16x32_bf16 v[116:119], v[224:227], v[140:143], v[116:119]
 ds_read_b64_tr_b16 v[216:217], v4 offset:25600
 v_mfma_f32_16x16x32_bf16 v[124:127], v[224:227], v[144:147], v[124:127]
 ds_read_b64_tr_b16 v[218:219], v4 offset:26112
 s_waitcnt lgkmcnt(10)
 v_mfma_f32_16x16x32_bf16 v[120:123], v[228:231], v[140:143], v[120:123]
 ds_read_b64_tr_b16 v[220:221], v5 offset:25600
 v_mfma_f32_16x16x32_bf16 v[128:131], v[228:231], v[144:147], v[128:131]
 ds_read_b64_tr_b16 v[222:223], v5 offset:26112
 s_waitcnt vmcnt(9) lgkmcnt(10)
 buffer_load_dwordx4 v[248:251], v232, s[96:99], s90 offen sc1
 v_mfma_f32_16x16x32_bf16 v[36:39], v[200:203], v[148:151], v[36:39]
 ds_read_b64_tr_b16 v[224:225], v6 offset:25600
 v_mfma_f32_16x16x32_bf16 v[44:47], v[200:203], v[152:155], v[44:47]
 ds_read_b64_tr_b16 v[226:227], v6 offset:26112
 s_waitcnt lgkmcnt(10)
 s_add_u32 m0, s74, 73728
 s_add_u32 s41, s72, 3670016
 buffer_load_dwordx4 v16, s[60:63], s41 offen offset:0 lds
 v_mfma_f32_16x16x32_bf16 v[40:43], v[204:207], v[148:151], v[40:43]
 ds_read_b64_tr_b16 v[228:229], v7 offset:25600
 v_mfma_f32_16x16x32_bf16 v[48:51], v[204:207], v[152:155], v[48:51]
 ds_read_b64_tr_b16 v[230:231], v7 offset:26112
 s_waitcnt lgkmcnt(10)
 v_mfma_f32_16x16x32_bf16 v[52:55], v[208:211], v[148:151], v[52:55]
 ds_read_b64_tr_b16 v[200:201], v12 offset:24576
 v_mfma_f32_16x16x32_bf16 v[60:63], v[208:211], v[152:155], v[60:63]
 ds_read_b64_tr_b16 v[202:203], v12 offset:24832
 s_waitcnt lgkmcnt(10)
 s_add_u32 m0, s74, 74624
 s_add_u32 s41, s72, 3670016
 buffer_load_dwordx4 v16, s[60:63], s41 offen offset:128 lds
 v_mfma_f32_16x16x32_bf16 v[56:59], v[212:215], v[148:151], v[56:59]
 ds_read_b64_tr_b16 v[204:205], v13 offset:24576
 v_mfma_f32_16x16x32_bf16 v[64:67], v[212:215], v[152:155], v[64:67]
 ds_read_b64_tr_b16 v[206:207], v13 offset:24832
 s_waitcnt lgkmcnt(10)
 v_mfma_f32_16x16x32_bf16 v[68:71], v[216:219], v[148:151], v[68:71]
 ds_read_b64_tr_b16 v[208:209], v12 offset:28672
 v_mfma_f32_16x16x32_bf16 v[76:79], v[216:219], v[152:155], v[76:79]
 ds_read_b64_tr_b16 v[210:211], v12 offset:28928
 s_waitcnt lgkmcnt(10)
 s_lshr_b32 s41, s74, 1
 s_add_u32 m0, s41, 90112
 s_add_u32 s41, s73, 1232896
 buffer_load_dwordx4 v17, s[64:67], s41 offen lds
 v_mfma_f32_16x16x32_bf16 v[72:75], v[220:223], v[148:151], v[72:75]
 ds_read_b64_tr_b16 v[212:213], v13 offset:28672
 v_mfma_f32_16x16x32_bf16 v[80:83], v[220:223], v[152:155], v[80:83]
 ds_read_b64_tr_b16 v[214:215], v13 offset:28928
 s_waitcnt lgkmcnt(10)
 v_mfma_f32_16x16x32_bf16 v[84:87], v[224:227], v[148:151], v[84:87]
 ds_read_b64_tr_b16 v[216:217], v4 offset:32768
 v_mfma_f32_16x16x32_bf16 v[92:95], v[224:227], v[152:155], v[92:95]
 ds_read_b64_tr_b16 v[218:219], v4 offset:33280
 s_waitcnt lgkmcnt(10)
 s_lshl_b32 s42, s75, 15
 s_add_u32 s42, s42, 28672
 buffer_load_dwordx4 v[180:183], v232, s[8:11], s42 offen offset:0 sc1
 v_mfma_f32_16x16x32_bf16 v[88:91], v[228:231], v[148:151], v[88:91]
 ds_read_b64_tr_b16 v[220:221], v5 offset:32768
 v_mfma_f32_16x16x32_bf16 v[96:99], v[228:231], v[152:155], v[96:99]
 ds_read_b64_tr_b16 v[222:223], v5 offset:33280
 s_waitcnt lgkmcnt(10)
 v_mfma_f32_16x16x32_bf16 v[100:103], v[200:203], v[148:151], v[100:103]
 ds_read_b64_tr_b16 v[224:225], v6 offset:32768
 v_mfma_f32_16x16x32_bf16 v[108:111], v[200:203], v[152:155], v[108:111]
 ds_read_b64_tr_b16 v[226:227], v6 offset:33280
 s_waitcnt lgkmcnt(10)
 buffer_load_dwordx4 v[184:187], v232, s[8:11], s42 offen offset:1024 sc1
 v_mfma_f32_16x16x32_bf16 v[104:107], v[204:207], v[148:151], v[104:107]
 ds_read_b64_tr_b16 v[228:229], v7 offset:32768
 v_mfma_f32_16x16x32_bf16 v[112:115], v[204:207], v[152:155], v[112:115]
 ds_read_b64_tr_b16 v[230:231], v7 offset:33280
 s_waitcnt lgkmcnt(10)
 v_mfma_f32_16x16x32_bf16 v[116:119], v[208:211], v[148:151], v[116:119]
 ds_read_b64_tr_b16 v[200:201], v4 offset:33792
 v_mfma_f32_16x16x32_bf16 v[124:127], v[208:211], v[152:155], v[124:127]
 ds_read_b64_tr_b16 v[202:203], v4 offset:34304
 s_waitcnt lgkmcnt(10)
 buffer_load_dwordx4 v[188:191], v232, s[8:11], s42 offen offset:2048 sc1
 v_mfma_f32_16x16x32_bf16 v[120:123], v[212:215], v[148:151], v[120:123]
 ds_read_b64_tr_b16 v[204:205], v5 offset:33792
 v_mfma_f32_16x16x32_bf16 v[128:131], v[212:215], v[152:155], v[128:131]
 ds_read_b64_tr_b16 v[206:207], v5 offset:34304
 s_waitcnt vmcnt(14) lgkmcnt(10)
 v_mfma_f32_16x16x32_bf16 v[36:39], v[216:219], v[156:159], v[36:39]
 ds_read_b64_tr_b16 v[208:209], v6 offset:33792
 v_mfma_f32_16x16x32_bf16 v[44:47], v[216:219], v[160:163], v[44:47]
 ds_read_b64_tr_b16 v[210:211], v6 offset:34304
 s_waitcnt lgkmcnt(10)
 buffer_load_dwordx4 v[192:195], v232, s[8:11], s42 offen offset:3072 sc1
 v_mfma_f32_16x16x32_bf16 v[40:43], v[220:223], v[156:159], v[40:43]
 ds_read_b64_tr_b16 v[212:213], v7 offset:33792
 v_mfma_f32_16x16x32_bf16 v[48:51], v[220:223], v[160:163], v[48:51]
 ds_read_b64_tr_b16 v[214:215], v7 offset:34304
 s_waitcnt lgkmcnt(10)
 v_mfma_f32_16x16x32_bf16 v[52:55], v[224:227], v[156:159], v[52:55]
 ds_read_b64_tr_b16 v[216:217], v12 offset:26624
 v_mfma_f32_16x16x32_bf16 v[60:63], v[224:227], v[160:163], v[60:63]
 ds_read_b64_tr_b16 v[218:219], v12 offset:26880
 s_waitcnt lgkmcnt(10)
 v_mfma_f32_16x16x32_bf16 v[56:59], v[228:231], v[156:159], v[56:59]
 ds_read_b64_tr_b16 v[220:221], v13 offset:26624
 v_mfma_f32_16x16x32_bf16 v[64:67], v[228:231], v[160:163], v[64:67]
 ds_read_b64_tr_b16 v[222:223], v13 offset:26880
 s_waitcnt lgkmcnt(10)
 v_mfma_f32_16x16x32_bf16 v[68:71], v[200:203], v[156:159], v[68:71]
 ds_read_b64_tr_b16 v[224:225], v12 offset:30720
 v_mfma_f32_16x16x32_bf16 v[76:79], v[200:203], v[160:163], v[76:79]
 ds_read_b64_tr_b16 v[226:227], v12 offset:30976
 s_waitcnt lgkmcnt(10)
 s_waitcnt vmcnt(12)
 s_barrier
 v_mfma_f32_16x16x32_bf16 v[72:75], v[204:207], v[156:159], v[72:75]
 ds_read_b64_tr_b16 v[228:229], v13 offset:30720
 v_mfma_f32_16x16x32_bf16 v[80:83], v[204:207], v[160:163], v[80:83]
 ds_read_b64_tr_b16 v[230:231], v13 offset:30976
 s_waitcnt lgkmcnt(10)
 v_mfma_f32_16x16x32_bf16 v[84:87], v[208:211], v[156:159], v[84:87]
 ds_read_b64_tr_b16 v[200:201], v8 offset:0
 v_mfma_f32_16x16x32_bf16 v[92:95], v[208:211], v[160:163], v[92:95]
 ds_read_b64_tr_b16 v[202:203], v8 offset:512
 s_waitcnt lgkmcnt(10)
 v_mfma_f32_16x16x32_bf16 v[88:91], v[212:215], v[156:159], v[88:91]
 ds_read_b64_tr_b16 v[204:205], v9 offset:0
 v_mfma_f32_16x16x32_bf16 v[96:99], v[212:215], v[160:163], v[96:99]
 ds_read_b64_tr_b16 v[206:207], v9 offset:512
 s_waitcnt lgkmcnt(10)
 v_mfma_f32_16x16x32_bf16 v[100:103], v[216:219], v[156:159], v[100:103]
 ds_read_b64_tr_b16 v[208:209], v10 offset:0
 v_mfma_f32_16x16x32_bf16 v[108:111], v[216:219], v[160:163], v[108:111]
 ds_read_b64_tr_b16 v[210:211], v10 offset:512
 s_waitcnt lgkmcnt(10)
 v_mfma_f32_16x16x32_bf16 v[104:107], v[220:223], v[156:159], v[104:107]
 ds_read_b64_tr_b16 v[212:213], v11 offset:0
 v_mfma_f32_16x16x32_bf16 v[112:115], v[220:223], v[160:163], v[112:115]
 ds_read_b64_tr_b16 v[214:215], v11 offset:512
 s_waitcnt lgkmcnt(10)
 v_mfma_f32_16x16x32_bf16 v[116:119], v[224:227], v[156:159], v[116:119]
 ds_read_b64_tr_b16 v[216:217], v8 offset:1024
 v_mfma_f32_16x16x32_bf16 v[124:127], v[224:227], v[160:163], v[124:127]
 ds_read_b64_tr_b16 v[218:219], v8 offset:1536
 s_waitcnt lgkmcnt(10)
 v_mfma_f32_16x16x32_bf16 v[120:123], v[228:231], v[156:159], v[120:123]
 ds_read_b64_tr_b16 v[220:221], v9 offset:1024
 v_mfma_f32_16x16x32_bf16 v[128:131], v[228:231], v[160:163], v[128:131]
 ds_read_b64_tr_b16 v[222:223], v9 offset:1536
 s_waitcnt vmcnt(10) lgkmcnt(10)
 v_mfma_f32_16x16x32_bf16 v[36:39], v[200:203], v[164:167], v[36:39]
 ds_read_b64_tr_b16 v[224:225], v10 offset:1024
 v_mfma_f32_16x16x32_bf16 v[44:47], v[200:203], v[168:171], v[44:47]
 ds_read_b64_tr_b16 v[226:227], v10 offset:1536
 s_waitcnt lgkmcnt(10)
 v_mfma_f32_16x16x32_bf16 v[40:43], v[204:207], v[164:167], v[40:43]
 ds_read_b64_tr_b16 v[228:229], v11 offset:1024
 v_mfma_f32_16x16x32_bf16 v[48:51], v[204:207], v[168:171], v[48:51]
 ds_read_b64_tr_b16 v[230:231], v11 offset:1536
 s_waitcnt lgkmcnt(10)
 v_mfma_f32_16x16x32_bf16 v[52:55], v[208:211], v[164:167], v[52:55]
 ds_read_b64_tr_b16 v[200:201], v14 offset:0
 v_mfma_f32_16x16x32_bf16 v[60:63], v[208:211], v[168:171], v[60:63]
 ds_read_b64_tr_b16 v[202:203], v14 offset:256
 s_waitcnt lgkmcnt(10)
 v_mfma_f32_16x16x32_bf16 v[56:59], v[212:215], v[164:167], v[56:59]
 ds_read_b64_tr_b16 v[204:205], v15 offset:0
 v_mfma_f32_16x16x32_bf16 v[64:67], v[212:215], v[168:171], v[64:67]
 ds_read_b64_tr_b16 v[206:207], v15 offset:256
 s_waitcnt lgkmcnt(10)
 v_mfma_f32_16x16x32_bf16 v[68:71], v[216:219], v[164:167], v[68:71]
 ds_read_b64_tr_b16 v[208:209], v14 offset:4096
 v_mfma_f32_16x16x32_bf16 v[76:79], v[216:219], v[168:171], v[76:79]
 ds_read_b64_tr_b16 v[210:211], v14 offset:4352
 s_waitcnt lgkmcnt(10)
 v_mfma_f32_16x16x32_bf16 v[72:75], v[220:223], v[164:167], v[72:75]
 ds_read_b64_tr_b16 v[212:213], v15 offset:4096
 v_mfma_f32_16x16x32_bf16 v[80:83], v[220:223], v[168:171], v[80:83]
 ds_read_b64_tr_b16 v[214:215], v15 offset:4352
 s_waitcnt lgkmcnt(10)
 v_mfma_f32_16x16x32_bf16 v[84:87], v[224:227], v[164:167], v[84:87]
 ds_read_b64_tr_b16 v[216:217], v8 offset:8192
 v_mfma_f32_16x16x32_bf16 v[92:95], v[224:227], v[168:171], v[92:95]
 ds_read_b64_tr_b16 v[218:219], v8 offset:8704
 s_waitcnt lgkmcnt(10)
 v_mfma_f32_16x16x32_bf16 v[88:91], v[228:231], v[164:167], v[88:91]
 ds_read_b64_tr_b16 v[220:221], v9 offset:8192
 v_mfma_f32_16x16x32_bf16 v[96:99], v[228:231], v[168:171], v[96:99]
 ds_read_b64_tr_b16 v[222:223], v9 offset:8704
 s_waitcnt lgkmcnt(10)
 v_mfma_f32_16x16x32_bf16 v[100:103], v[200:203], v[164:167], v[100:103]
 ds_read_b64_tr_b16 v[224:225], v10 offset:8192
 v_mfma_f32_16x16x32_bf16 v[108:111], v[200:203], v[168:171], v[108:111]
 ds_read_b64_tr_b16 v[226:227], v10 offset:8704
 s_waitcnt lgkmcnt(10)
 v_mfma_f32_16x16x32_bf16 v[104:107], v[204:207], v[164:167], v[104:107]
 ds_read_b64_tr_b16 v[228:229], v11 offset:8192
 v_mfma_f32_16x16x32_bf16 v[112:115], v[204:207], v[168:171], v[112:115]
 ds_read_b64_tr_b16 v[230:231], v11 offset:8704
 s_waitcnt lgkmcnt(10)
 v_mfma_f32_16x16x32_bf16 v[116:119], v[208:211], v[164:167], v[116:119]
 ds_read_b64_tr_b16 v[200:201], v8 offset:9216
 v_mfma_f32_16x16x32_bf16 v[124:127], v[208:211], v[168:171], v[124:127]
 ds_read_b64_tr_b16 v[202:203], v8 offset:9728
 s_waitcnt lgkmcnt(10)
 v_mfma_f32_16x16x32_bf16 v[120:123], v[212:215], v[164:167], v[120:123]
 ds_read_b64_tr_b16 v[204:205], v9 offset:9216
 v_mfma_f32_16x16x32_bf16 v[128:131], v[212:215], v[168:171], v[128:131]
 ds_read_b64_tr_b16 v[206:207], v9 offset:9728
 s_waitcnt vmcnt(8) lgkmcnt(10)
 v_mfma_f32_16x16x32_bf16 v[36:39], v[216:219], v[172:175], v[36:39]
 ds_read_b64_tr_b16 v[208:209], v10 offset:9216
 v_mfma_f32_16x16x32_bf16 v[44:47], v[216:219], v[176:179], v[44:47]
 ds_read_b64_tr_b16 v[210:211], v10 offset:9728
 s_waitcnt lgkmcnt(10)
 v_mfma_f32_16x16x32_bf16 v[40:43], v[220:223], v[172:175], v[40:43]
 ds_read_b64_tr_b16 v[212:213], v11 offset:9216
 v_mfma_f32_16x16x32_bf16 v[48:51], v[220:223], v[176:179], v[48:51]
 ds_read_b64_tr_b16 v[214:215], v11 offset:9728
 s_waitcnt lgkmcnt(10)
 v_mfma_f32_16x16x32_bf16 v[52:55], v[224:227], v[172:175], v[52:55]
 ds_read_b64_tr_b16 v[216:217], v14 offset:2048
 v_mfma_f32_16x16x32_bf16 v[60:63], v[224:227], v[176:179], v[60:63]
 ds_read_b64_tr_b16 v[218:219], v14 offset:2304
 s_waitcnt lgkmcnt(10)
 v_mfma_f32_16x16x32_bf16 v[56:59], v[228:231], v[172:175], v[56:59]
 ds_read_b64_tr_b16 v[220:221], v15 offset:2048
 v_mfma_f32_16x16x32_bf16 v[64:67], v[228:231], v[176:179], v[64:67]
 ds_read_b64_tr_b16 v[222:223], v15 offset:2304
 s_waitcnt lgkmcnt(10)
 v_mfma_f32_16x16x32_bf16 v[68:71], v[200:203], v[172:175], v[68:71]
 ds_read_b64_tr_b16 v[224:225], v14 offset:6144
 v_mfma_f32_16x16x32_bf16 v[76:79], v[200:203], v[176:179], v[76:79]
 ds_read_b64_tr_b16 v[226:227], v14 offset:6400
 s_waitcnt lgkmcnt(10)
 s_waitcnt vmcnt(0)
 s_barrier
 s_cmp_eq_u32 s54, 0
 s_cbranch_scc1 KB_NKV6_N2
 s_waitcnt vmcnt(7)
 s_cmp_lg_u32 s92, 0
 s_cbranch_scc1 KB_SQKN2
 s_mov_b32 s77, 4096
KB_SPKN2:
 v_cmp_ne_u64 vcc, v[248:249], v[254:255]
 v_cmp_ne_u64 s[46:47], v[250:251], v[254:255]
 s_or_b64 s[46:47], vcc, s[46:47]
 s_cbranch_scc0 KB_SQKN2
 s_sleep 2
 buffer_load_dwordx4 v[248:251], v232, s[96:99], s90 offen sc1
 s_sub_u32 s77, s77, 1
 s_cmp_eq_u32 s77, 0
 s_waitcnt vmcnt(0)
 s_cbranch_scc0 KB_SPKN2
 s_mov_b32 s101, 1
KB_SQKN2:
 s_mov_b32 m0, s35
 s_nop 0
 buffer_load_dwordx4 v197, s[12:15], s31 offen offset:0 sc1 lds
 buffer_load_dwordx4 v197, s[12:15], s31 offen offset:1024 sc1 lds
 buffer_load_dwordx4 v197, s[12:15], s31 offen offset:2048 sc1 lds
 buffer_load_dwordx4 v197, s[12:15], s31 offen offset:3072 sc1 lds
 s_add_u32 s31, s31, 16384
 s_add_u32 s35, s35, 32768
 s_and_b32 s35, s35, 0x1ffff
 s_mov_b32 m0, s36
 s_nop 0
 buffer_load_dwordx4 v197, s[16:19], s33 offen offset:0 sc1 lds
 buffer_load_dwordx4 v197, s[16:19], s33 offen offset:1024 sc1 lds
 buffer_load_dwordx4 v197, s[16:19], s33 offen offset:2048 sc1 lds
 buffer_load_dwordx4 v197, s[16:19], s33 offen offset:3072 sc1 lds
 s_add_u32 s33, s33, 16384
 s_add_u32 s36, s36, 32768
 s_and_b32 s36, s36, 0x1ffff
KB_NKV6_N2:
 v_mfma_f32_16x16x32_bf16 v[72:75], v[204:207], v[172:175], v[72:75]
 ds_read_b64_tr_b16 v[228:229], v15 offset:6144
 v_mfma_f32_16x16x32_bf16 v[80:83], v[204:207], v[176:179], v[80:83]
 ds_read_b64_tr_b16 v[230:231], v15 offset:6400
 s_waitcnt lgkmcnt(10)
 v_mfma_f32_16x16x32_bf16 v[84:87], v[208:211], v[172:175], v[84:87]
 ds_read_b64_tr_b16 v[200:201], v14 offset:24576
 v_mfma_f32_16x16x32_bf16 v[92:95], v[208:211], v[176:179], v[92:95]
 ds_read_b64_tr_b16 v[202:203], v14 offset:24832
 s_waitcnt lgkmcnt(10)
 v_mfma_f32_16x16x32_bf16 v[88:91], v[212:215], v[172:175], v[88:91]
 ds_read_b64_tr_b16 v[204:205], v14 offset:26624
 v_mfma_f32_16x16x32_bf16 v[96:99], v[212:215], v[176:179], v[96:99]
 ds_read_b64_tr_b16 v[206:207], v14 offset:26880
 s_waitcnt lgkmcnt(10)
 v_mfma_f32_16x16x32_bf16 v[100:103], v[216:219], v[172:175], v[100:103]
 ds_read_b64_tr_b16 v[208:209], v15 offset:24576
 v_mfma_f32_16x16x32_bf16 v[108:111], v[216:219], v[176:179], v[108:111]
 ds_read_b64_tr_b16 v[210:211], v15 offset:24832
 s_waitcnt lgkmcnt(10)
 v_mfma_f32_16x16x32_bf16 v[104:107], v[220:223], v[172:175], v[104:107]
 ds_read_b64_tr_b16 v[212:213], v15 offset:26624
 v_mfma_f32_16x16x32_bf16 v[112:115], v[220:223], v[176:179], v[112:115]
 ds_read_b64_tr_b16 v[214:215], v15 offset:26880
 s_waitcnt lgkmcnt(10)
 v_mfma_f32_16x16x32_bf16 v[116:119], v[224:227], v[172:175], v[116:119]
 ds_read_b64_tr_b16 v[216:217], v14 offset:28672
 v_mfma_f32_16x16x32_bf16 v[124:127], v[224:227], v[176:179], v[124:127]
 ds_read_b64_tr_b16 v[218:219], v14 offset:28928
 s_waitcnt lgkmcnt(10)
 v_mfma_f32_16x16x32_bf16 v[120:123], v[228:231], v[172:175], v[120:123]
 ds_read_b64_tr_b16 v[220:221], v14 offset:30720
 v_mfma_f32_16x16x32_bf16 v[128:131], v[228:231], v[176:179], v[128:131]
 ds_read_b64_tr_b16 v[222:223], v14 offset:30976
 s_waitcnt lgkmcnt(10)
 v_mfma_f32_16x16x32_bf16 v[100:103], v[200:203], v[180:183], v[100:103]
 ds_read_b64_tr_b16 v[224:225], v15 offset:28672
 v_mfma_f32_16x16x32_bf16 v[108:111], v[200:203], v[184:187], v[108:111]
 ds_read_b64_tr_b16 v[226:227], v15 offset:28928
 s_waitcnt lgkmcnt(10)
 v_mfma_f32_16x16x32_bf16 v[100:103], v[204:207], v[188:191], v[100:103]
 ds_read_b64_tr_b16 v[228:229], v15 offset:30720
 v_mfma_f32_16x16x32_bf16 v[108:111], v[204:207], v[192:195], v[108:111]
 ds_read_b64_tr_b16 v[230:231], v15 offset:30976
 s_waitcnt lgkmcnt(10)
 v_mfma_f32_16x16x32_bf16 v[104:107], v[208:211], v[180:183], v[104:107]
 ds_read_b64_tr_b16 v[200:201], v8 offset:24576
 v_mfma_f32_16x16x32_bf16 v[112:115], v[208:211], v[184:187], v[112:115]
 ds_read_b64_tr_b16 v[202:203], v8 offset:25088
 s_waitcnt lgkmcnt(10)
 s_barrier
 s_cmp_eq_u32 s54, 0
 s_cbranch_scc1 KB_NKV7_N2
 s_mov_b32 m0, s35
 s_nop 0
 buffer_load_dwordx4 v197, s[12:15], s31 offen offset:0 sc1 lds
 buffer_load_dwordx4 v197, s[12:15], s31 offen offset:1024 sc1 lds
 buffer_load_dwordx4 v197, s[12:15], s31 offen offset:2048 sc1 lds
 buffer_load_dwordx4 v197, s[12:15], s31 offen offset:3072 sc1 lds
 s_add_u32 s31, s31, 16384
 s_add_u32 s35, s35, 32768
 s_and_b32 s35, s35, 0x1ffff
 s_mov_b32 m0, s36
 s_nop 0
 buffer_load_dwordx4 v197, s[16:19], s33 offen offset:0 sc1 lds
 buffer_load_dwordx4 v197, s[16:19], s33 offen offset:1024 sc1 lds
 buffer_load_dwordx4 v197, s[16:19], s33 offen offset:2048 sc1 lds
 buffer_load_dwordx4 v197, s[16:19], s33 offen offset:3072 sc1 lds
 s_add_u32 s33, s33, 16384
 s_add_u32 s36, s36, 32768
 s_and_b32 s36, s36, 0x1ffff
KB_NKV7_N2:
 v_mfma_f32_16x16x32_bf16 v[104:107], v[212:215], v[188:191], v[104:107]
 ds_read_b64_tr_b16 v[204:205], v8 offset:32768
 v_mfma_f32_16x16x32_bf16 v[112:115], v[212:215], v[192:195], v[112:115]
 ds_read_b64_tr_b16 v[206:207], v8 offset:33280
 s_waitcnt lgkmcnt(10)
 v_mfma_f32_16x16x32_bf16 v[116:119], v[216:219], v[180:183], v[116:119]
 ds_read_b64_tr_b16 v[208:209], v9 offset:24576
 v_mfma_f32_16x16x32_bf16 v[124:127], v[216:219], v[184:187], v[124:127]
 ds_read_b64_tr_b16 v[210:211], v9 offset:25088
 s_waitcnt lgkmcnt(10)
 v_mfma_f32_16x16x32_bf16 v[116:119], v[220:223], v[188:191], v[116:119]
 ds_read_b64_tr_b16 v[212:213], v9 offset:32768
 v_mfma_f32_16x16x32_bf16 v[124:127], v[220:223], v[192:195], v[124:127]
 ds_read_b64_tr_b16 v[214:215], v9 offset:33280
 s_waitcnt lgkmcnt(10)
 s_lshl_b32 s77, s78, 11
 s_add_u32 s77, s77, s76
 v_max_f32 v100, 0, v100
 v_max_f32 v101, 0, v101
 v_cvt_pk_bf16_f32 v100, v100, v101
 v_max_f32 v102, 0, v102
 v_max_f32 v103, 0, v103
 v_cvt_pk_bf16_f32 v101, v102, v103
 v_mfma_f32_16x16x32_bf16 v[120:123], v[224:227], v[180:183], v[120:123]
 ds_read_b64_tr_b16 v[216:217], v10 offset:24576
 v_mfma_f32_16x16x32_bf16 v[128:131], v[224:227], v[184:187], v[128:131]
 ds_read_b64_tr_b16 v[218:219], v10 offset:25088
 s_waitcnt lgkmcnt(10)
 v_max_f32 v104, 0, v104
 v_max_f32 v105, 0, v105
 v_cvt_pk_bf16_f32 v102, v104, v105
 v_max_f32 v106, 0, v106
 v_max_f32 v107, 0, v107
 v_cvt_pk_bf16_f32 v103, v106, v107
 buffer_store_dwordx4 v[100:103], v18, s[68:71], s77 offen offset:0 sc1
 v_max_f32 v108, 0, v108
 v_mfma_f32_16x16x32_bf16 v[120:123], v[228:231], v[188:191], v[120:123]
 ds_read_b64_tr_b16 v[220:221], v10 offset:32768
 v_mfma_f32_16x16x32_bf16 v[128:131], v[228:231], v[192:195], v[128:131]
 ds_read_b64_tr_b16 v[222:223], v10 offset:33280
 s_waitcnt lgkmcnt(10)
 v_max_f32 v109, 0, v109
 v_cvt_pk_bf16_f32 v104, v108, v109
 v_max_f32 v110, 0, v110
 v_max_f32 v111, 0, v111
 v_cvt_pk_bf16_f32 v105, v110, v111
 v_max_f32 v112, 0, v112
 v_max_f32 v113, 0, v113
 v_cvt_pk_bf16_f32 v106, v112, v113
 v_mfma_f32_16x16x32_bf16 v[36:39], v[200:203], v[180:183], v[36:39]
 ds_read_b64_tr_b16 v[224:225], v11 offset:24576
 v_mfma_f32_16x16x32_bf16 v[44:47], v[200:203], v[184:187], v[44:47]
 ds_read_b64_tr_b16 v[226:227], v11 offset:25088
 s_waitcnt lgkmcnt(10)
 v_max_f32 v114, 0, v114
 v_max_f32 v115, 0, v115
 v_cvt_pk_bf16_f32 v107, v114, v115
 buffer_store_dwordx4 v[104:107], v18, s[68:71], s77 offen offset:128 sc1
 v_mfma_f32_16x16x32_bf16 v[36:39], v[204:207], v[188:191], v[36:39]
 ds_read_b64_tr_b16 v[228:229], v11 offset:32768
 v_mfma_f32_16x16x32_bf16 v[44:47], v[204:207], v[192:195], v[44:47]
 ds_read_b64_tr_b16 v[230:231], v11 offset:33280
 s_waitcnt lgkmcnt(10)
 s_lshl_b32 s77, s79, 11
 s_add_u32 s77, s77, s76
 v_max_f32 v116, 0, v116
 v_max_f32 v117, 0, v117
 v_cvt_pk_bf16_f32 v116, v116, v117
 v_max_f32 v118, 0, v118
 v_max_f32 v119, 0, v119
 v_cvt_pk_bf16_f32 v117, v118, v119
 v_mfma_f32_16x16x32_bf16 v[40:43], v[208:211], v[180:183], v[40:43]
 ds_read_b64_tr_b16 v[200:201], v8 offset:25600
 v_mfma_f32_16x16x32_bf16 v[48:51], v[208:211], v[184:187], v[48:51]
 ds_read_b64_tr_b16 v[202:203], v8 offset:26112
 s_waitcnt lgkmcnt(10)
 v_max_f32 v120, 0, v120
 v_max_f32 v121, 0, v121
 v_cvt_pk_bf16_f32 v118, v120, v121
 v_max_f32 v122, 0, v122
 v_max_f32 v123, 0, v123
 v_cvt_pk_bf16_f32 v119, v122, v123
 buffer_store_dwordx4 v[116:119], v18, s[68:71], s77 offen offset:0 sc1
 v_max_f32 v124, 0, v124
 v_mfma_f32_16x16x32_bf16 v[40:43], v[212:215], v[188:191], v[40:43]
 ds_read_b64_tr_b16 v[204:205], v8 offset:33792
 v_mfma_f32_16x16x32_bf16 v[48:51], v[212:215], v[192:195], v[48:51]
 ds_read_b64_tr_b16 v[206:207], v8 offset:34304
 s_waitcnt lgkmcnt(10)
 v_max_f32 v125, 0, v125
 v_cvt_pk_bf16_f32 v120, v124, v125
 v_max_f32 v126, 0, v126
 v_max_f32 v127, 0, v127
 v_cvt_pk_bf16_f32 v121, v126, v127
 v_max_f32 v128, 0, v128
 v_max_f32 v129, 0, v129
 v_cvt_pk_bf16_f32 v122, v128, v129
 v_mfma_f32_16x16x32_bf16 v[52:55], v[216:219], v[180:183], v[52:55]
 ds_read_b64_tr_b16 v[208:209], v9 offset:25600
 v_mfma_f32_16x16x32_bf16 v[60:63], v[216:219], v[184:187], v[60:63]
 ds_read_b64_tr_b16 v[210:211], v9 offset:26112
 s_waitcnt lgkmcnt(10)
 v_max_f32 v130, 0, v130
 v_max_f32 v131, 0, v131
 v_cvt_pk_bf16_f32 v123, v130, v131
 buffer_store_dwordx4 v[120:123], v18, s[68:71], s77 offen offset:128 sc1
 v_mfma_f32_16x16x32_bf16 v[52:55], v[220:223], v[188:191], v[52:55]
 ds_read_b64_tr_b16 v[212:213], v9 offset:33792
 v_mfma_f32_16x16x32_bf16 v[60:63], v[220:223], v[192:195], v[60:63]
 ds_read_b64_tr_b16 v[214:215], v9 offset:34304
 s_waitcnt lgkmcnt(10)
 v_mul_f32 v36, 0x3e0293ee, v36
 v_mul_f32 v37, 0x3e0293ee, v37
 v_cvt_pk_bf16_f32 v36, v36, v37
 v_mul_f32 v38, 0x3e0293ee, v38
 v_mul_f32 v39, 0x3e0293ee, v39
 v_cvt_pk_bf16_f32 v37, v38, v39
 v_mul_f32 v40, 0x3e0293ee, v40
 v_mul_f32 v41, 0x3e0293ee, v41
 v_mfma_f32_16x16x32_bf16 v[56:59], v[224:227], v[180:183], v[56:59]
 ds_read_b64_tr_b16 v[216:217], v10 offset:25600
 v_mfma_f32_16x16x32_bf16 v[64:67], v[224:227], v[184:187], v[64:67]
 ds_read_b64_tr_b16 v[218:219], v10 offset:26112
 s_waitcnt lgkmcnt(10)
 v_cvt_pk_bf16_f32 v38, v40, v41
 v_mul_f32 v42, 0x3e0293ee, v42
 v_mul_f32 v43, 0x3e0293ee, v43
 v_cvt_pk_bf16_f32 v39, v42, v43
 ds_write_b128 v19, v[36:39] offset:0
 v_mul_f32 v44, 0x3e0293ee, v44
 v_mul_f32 v45, 0x3e0293ee, v45
 v_cvt_pk_bf16_f32 v40, v44, v45
 v_mfma_f32_16x16x32_bf16 v[56:59], v[228:231], v[188:191], v[56:59]
 ds_read_b64_tr_b16 v[220:221], v10 offset:33792
 v_mfma_f32_16x16x32_bf16 v[64:67], v[228:231], v[192:195], v[64:67]
 ds_read_b64_tr_b16 v[222:223], v10 offset:34304
 s_waitcnt lgkmcnt(11)
 v_mul_f32 v46, 0x3e0293ee, v46
 v_mul_f32 v47, 0x3e0293ee, v47
 v_cvt_pk_bf16_f32 v41, v46, v47
 v_mul_f32 v48, 0x3e0293ee, v48
 v_mul_f32 v49, 0x3e0293ee, v49
 v_cvt_pk_bf16_f32 v42, v48, v49
 v_mul_f32 v50, 0x3e0293ee, v50
 v_mul_f32 v51, 0x3e0293ee, v51
 v_mfma_f32_16x16x32_bf16 v[68:71], v[200:203], v[180:183], v[68:71]
 ds_read_b64_tr_b16 v[224:225], v11 offset:25600
 v_mfma_f32_16x16x32_bf16 v[76:79], v[200:203], v[184:187], v[76:79]
 ds_read_b64_tr_b16 v[226:227], v11 offset:26112
 s_waitcnt lgkmcnt(11)
 v_cvt_pk_bf16_f32 v43, v50, v51
 ds_write_b128 v19, v[40:43] offset:128
 v_mfma_f32_16x16x32_bf16 v[68:71], v[204:207], v[188:191], v[68:71]
 ds_read_b64_tr_b16 v[228:229], v11 offset:33792
 v_mfma_f32_16x16x32_bf16 v[76:79], v[204:207], v[192:195], v[76:79]
 ds_read_b64_tr_b16 v[230:231], v11 offset:34304
 s_waitcnt lgkmcnt(12)
 v_mul_f32 v52, 0x3e0293ee, v52
 v_mul_f32 v53, 0x3e0293ee, v53
 v_cvt_pk_bf16_f32 v52, v52, v53
 v_mul_f32 v54, 0x3e0293ee, v54
 v_mul_f32 v55, 0x3e0293ee, v55
 v_cvt_pk_bf16_f32 v53, v54, v55
 v_mul_f32 v56, 0x3e0293ee, v56
 v_mul_f32 v57, 0x3e0293ee, v57
 v_mfma_f32_16x16x32_bf16 v[72:75], v[208:211], v[180:183], v[72:75]
 v_mfma_f32_16x16x32_bf16 v[80:83], v[208:211], v[184:187], v[80:83]
 s_waitcnt lgkmcnt(10)
 v_cvt_pk_bf16_f32 v54, v56, v57
 v_mul_f32 v58, 0x3e0293ee, v58
 v_mul_f32 v59, 0x3e0293ee, v59
 v_cvt_pk_bf16_f32 v55, v58, v59
 ds_write_b128 v19, v[52:55] offset:2048
 v_mul_f32 v60, 0x3e0293ee, v60
 v_mul_f32 v61, 0x3e0293ee, v61
 v_cvt_pk_bf16_f32 v56, v60, v61
 v_mfma_f32_16x16x32_bf16 v[72:75], v[212:215], v[188:191], v[72:75]
 v_mfma_f32_16x16x32_bf16 v[80:83], v[212:215], v[192:195], v[80:83]
 s_waitcnt lgkmcnt(9)
 v_mul_f32 v62, 0x3e0293ee, v62
 v_mul_f32 v63, 0x3e0293ee, v63
 v_cvt_pk_bf16_f32 v57, v62, v63
 v_mul_f32 v64, 0x3e0293ee, v64
 v_mul_f32 v65, 0x3e0293ee, v65
 v_cvt_pk_bf16_f32 v58, v64, v65
 v_mul_f32 v66, 0x3e0293ee, v66
 v_mul_f32 v67, 0x3e0293ee, v67
 v_mfma_f32_16x16x32_bf16 v[84:87], v[216:219], v[180:183], v[84:87]
 v_mfma_f32_16x16x32_bf16 v[92:95], v[216:219], v[184:187], v[92:95]
 s_waitcnt lgkmcnt(6)
 v_cvt_pk_bf16_f32 v59, v66, v67
 ds_write_b128 v19, v[56:59] offset:2176
 v_mfma_f32_16x16x32_bf16 v[84:87], v[220:223], v[188:191], v[84:87]
 v_mfma_f32_16x16x32_bf16 v[92:95], v[220:223], v[192:195], v[92:95]
 s_waitcnt lgkmcnt(5)
 v_mul_f32 v68, 0x3e0293ee, v68
 v_mul_f32 v69, 0x3e0293ee, v69
 v_cvt_pk_bf16_f32 v68, v68, v69
 v_mul_f32 v70, 0x3e0293ee, v70
 v_mul_f32 v71, 0x3e0293ee, v71
 v_cvt_pk_bf16_f32 v69, v70, v71
 v_mul_f32 v72, 0x3e0293ee, v72
 v_mul_f32 v73, 0x3e0293ee, v73
 v_mfma_f32_16x16x32_bf16 v[88:91], v[224:227], v[180:183], v[88:91]
 v_mfma_f32_16x16x32_bf16 v[96:99], v[224:227], v[184:187], v[96:99]
 s_waitcnt lgkmcnt(2)
 v_cvt_pk_bf16_f32 v70, v72, v73
 v_mul_f32 v74, 0x3e0293ee, v74
 v_mul_f32 v75, 0x3e0293ee, v75
 v_cvt_pk_bf16_f32 v71, v74, v75
 ds_write_b128 v19, v[68:71] offset:4096
 v_mul_f32 v76, 0x3e0293ee, v76
 v_mul_f32 v77, 0x3e0293ee, v77
 v_cvt_pk_bf16_f32 v72, v76, v77
 v_mfma_f32_16x16x32_bf16 v[88:91], v[228:231], v[188:191], v[88:91]
 v_mfma_f32_16x16x32_bf16 v[96:99], v[228:231], v[192:195], v[96:99]
 v_mul_f32 v78, 0x3e0293ee, v78
 v_mul_f32 v79, 0x3e0293ee, v79
 v_cvt_pk_bf16_f32 v73, v78, v79
 v_mul_f32 v80, 0x3e0293ee, v80
 v_mul_f32 v81, 0x3e0293ee, v81
 v_cvt_pk_bf16_f32 v74, v80, v81
 v_mul_f32 v82, 0x3e0293ee, v82
 v_mul_f32 v83, 0x3e0293ee, v83
 v_cvt_pk_bf16_f32 v75, v82, v83
 ds_write_b128 v19, v[72:75] offset:4224
 v_mul_f32 v84, 0x3e0293ee, v84
 v_mul_f32 v85, 0x3e0293ee, v85
 v_cvt_pk_bf16_f32 v84, v84, v85
 v_mul_f32 v86, 0x3e0293ee, v86
 v_mul_f32 v87, 0x3e0293ee, v87
 v_cvt_pk_bf16_f32 v85, v86, v87
 v_mul_f32 v88, 0x3e0293ee, v88
 v_mul_f32 v89, 0x3e0293ee, v89
 v_cvt_pk_bf16_f32 v86, v88, v89
 v_mul_f32 v90, 0x3e0293ee, v90
 v_mul_f32 v91, 0x3e0293ee, v91
 v_cvt_pk_bf16_f32 v87, v90, v91
 ds_write_b128 v19, v[84:87] offset:6144
 v_mul_f32 v92, 0x3e0293ee, v92
 v_mul_f32 v93, 0x3e0293ee, v93
 v_cvt_pk_bf16_f32 v88, v92, v93
 v_mul_f32 v94, 0x3e0293ee, v94
 v_mul_f32 v95, 0x3e0293ee, v95
 v_cvt_pk_bf16_f32 v89, v94, v95
 v_mul_f32 v96, 0x3e0293ee, v96
 v_mul_f32 v97, 0x3e0293ee, v97
 v_cvt_pk_bf16_f32 v90, v96, v97
 v_mul_f32 v98, 0x3e0293ee, v98
 v_mul_f32 v99, 0x3e0293ee, v99
 v_cvt_pk_bf16_f32 v91, v98, v99
 ds_write_b128 v19, v[88:91] offset:6272
 s_mov_b32 s30, 8
 s_branch KB_PJ
KB_PJ:
 v_add_u32 v237, s34, v196
 s_waitcnt lgkmcnt(0)
 ds_read_b128 v[4:7], v237 offset:0
 ds_read_b128 v[8:11], v237 offset:256
 ds_read_b128 v[12:15], v237 offset:2048
 ds_read_b128 v[16:19], v237 offset:2304
 ds_read_b128 v[20:23], v237 offset:4096
 ds_read_b128 v[24:27], v237 offset:4352
 ds_read_b128 v[28:31], v237 offset:6144
 ds_read_b128 v[32:35], v237 offset:6400
 s_load_dwordx2 s[74:75], s[0:1], 40
 s_load_dwordx2 s[76:77], s[0:1], 64
 s_load_dwordx2 s[78:79], s[0:1], 0
 s_load_dwordx4 s[80:83], s[0:1], 72
 v_readfirstlane_b32 s90, v254
 v_readfirstlane_b32 s91, v255
 s_lshl_b32 s41, s26, 5
 s_add_u32 s41, s41, s25
 s_lshl_b32 s41, s41, 2
 s_add_u32 s41, s41, s24
 s_lshl_b32 s41, s41, 3
 s_add_u32 s89, s41, 0xc000
 s_lshl_b32 s41, s55, 2
 s_add_u32 s41, s41, 161792
 v_mov_b32 v237, s41
 v_mov_b32 v238, s101
 ds_write_b32 v237, v238
 v_mov_b32 v237, 162816
 v_mov_b32 v238, 0
 ds_write_b32 v237, v238
 ds_write_b32 v237, v238 offset:4
 v_and_b32 v164, 7, v0
 v_lshlrev_b32 v164, 2, v164
 v_mov_b32 v233, v196
 v_add_u32 v234, 0x10000, v196
 v_and_b32 v237, 3, v0
 v_mov_b32 v238, 0x3f803f80
 v_cmp_eq_u32 vcc, 0, v237
 v_cmp_eq_u32 s[44:45], 2, v237
 s_or_b64 vcc, vcc, s[44:45]
 v_cndmask_b32 v248, 0, v238, vcc
 v_cndmask_b32 v249, 0, v238, vcc
 v_cndmask_b32 v250, 0, v238, vcc
 v_cndmask_b32 v251, 0, v238, vcc
 v_cmp_eq_u32 vcc, 1, v237
 v_cmp_eq_u32 s[44:45], 2, v237
 s_or_b64 vcc, vcc, s[44:45]
 v_cndmask_b32 v252, 0, v238, vcc
 v_cndmask_b32 v253, 0, v238, vcc
 v_cndmask_b32 v254, 0, v238, vcc
 v_cndmask_b32 v255, 0, v238, vcc
 v_and_b32 v237, 3, v0
 v_mul_u32_u24 v237, 260, v237
 v_add_u32 v232, 157728, v237
 v_mov_b32 v239, 1
 s_cmp_eq_u32 s54, 0
 s_cbranch_scc1 KB_ROLEA
 v_and_b32 v237, 7, v0
 v_mul_u32_u24 v237, 260, v237
 v_add_u32 v237, 155648, v237
 v_cmp_gt_u32 vcc, 8, v0
 s_nop 1
 v_cndmask_b32 v232, v232, v237, vcc
 s_waitcnt vmcnt(6) lgkmcnt(0)
 s_barrier
 s_mov_b32 m0, s35
 s_nop 0
 buffer_load_dwordx4 v197, s[12:15], s31 offen offset:0 sc1 lds
 buffer_load_dwordx4 v197, s[12:15], s31 offen offset:1024 sc1 lds
 buffer_load_dwordx4 v197, s[12:15], s31 offen offset:2048 sc1 lds
 buffer_load_dwordx4 v197, s[12:15], s31 offen offset:3072 sc1 lds
 s_add_u32 s31, s31, 16384
 s_add_u32 s35, s35, 32768
 s_and_b32 s35, s35, 0x1ffff
 s_mov_b32 m0, s35
 s_nop 0
 buffer_load_dwordx4 v197, s[12:15], s31 offen offset:0 sc1 lds
 buffer_load_dwordx4 v197, s[12:15], s31 offen offset:1024 sc1 lds
 buffer_load_dwordx4 v197, s[12:15], s31 offen offset:2048 sc1 lds
 buffer_load_dwordx4 v197, s[12:15], s31 offen offset:3072 sc1 lds
 s_add_u32 s31, s31, 16384
 s_add_u32 s35, s35, 32768
 s_and_b32 s35, s35, 0x1ffff
 s_mov_b32 m0, s36
 s_nop 0
 buffer_load_dwordx4 v197, s[16:19], s33 offen offset:0 sc1 lds
 buffer_load_dwordx4 v197, s[16:19], s33 offen offset:1024 sc1 lds
 buffer_load_dwordx4 v197, s[16:19], s33 offen offset:2048 sc1 lds
 buffer_load_dwordx4 v197, s[16:19], s33 offen offset:3072 sc1 lds
 s_add_u32 s33, s33, 16384
 s_add_u32 s36, s36, 32768
 s_and_b32 s36, s36, 0x1ffff
 v_add_u32 v164, 161792, v164
 ds_read_b32 v164, v164
 ds_read_b128 v[200:203], v233 offset:0
 ds_read_b128 v[204:207], v233 offset:256
 ds_read_b128 v[208:211], v233 offset:2048
 ds_read_b128 v[212:215], v233 offset:2304
 ds_read_b128 v[216:219], v233 offset:4096
 ds_read_b128 v[220:223], v233 offset:4352
 ds_read_b128 v[224:227], v233 offset:6144
 ds_read_b128 v[228:231], v233 offset:6400
 s_waitcnt lgkmcnt(6)
 v_cmp_ne_u32 vcc, 0, v164
 s_cbranch_vccnz KB_RECOVER
 v_mfma_f32_16x16x32_bf16 v[100:103], v[200:203], v[4:7], 0
 v_mov_b32 v36, 0
 v_mov_b32 v37, 0
 v_mfma_f32_16x16x32_bf16 v[108:111], v[200:203], v[8:11], 0
 ds_read_b128 v[200:203], v233 offset:8192
 v_mov_b32 v38, 0
 v_mov_b32 v39, 0
 v_mfma_f32_16x16x32_bf16 v[104:107], v[204:207], v[4:7], 0
 v_mov_b32 v40, 0
 v_mov_b32 v41, 0
 v_mfma_f32_16x16x32_bf16 v[112:115], v[204:207], v[8:11], 0
 ds_read_b128 v[204:207], v233 offset:8448
 v_mov_b32 v42, 0
 v_mov_b32 v43, 0
 s_waitcnt lgkmcnt(6)
 v_mfma_f32_16x16x32_bf16 v[100:103], v[208:211], v[12:15], v[100:103]
 v_mov_b32 v44, 0
 v_mov_b32 v45, 0
 v_mfma_f32_16x16x32_bf16 v[108:111], v[208:211], v[16:19], v[108:111]
 ds_read_b128 v[208:211], v233 offset:10240
 v_mov_b32 v46, 0
 v_mov_b32 v47, 0
 v_mfma_f32_16x16x32_bf16 v[104:107], v[212:215], v[12:15], v[104:107]
 v_mov_b32 v48, 0
 v_mov_b32 v49, 0
 v_mfma_f32_16x16x32_bf16 v[112:115], v[212:215], v[16:19], v[112:115]
 ds_read_b128 v[212:215], v233 offset:10496
 v_mov_b32 v50, 0
 v_mov_b32 v51, 0
 s_waitcnt lgkmcnt(6)
 v_mfma_f32_16x16x32_bf16 v[100:103], v[216:219], v[20:23], v[100:103]
 v_mov_b32 v52, 0
 v_mov_b32 v53, 0
 v_mfma_f32_16x16x32_bf16 v[108:111], v[216:219], v[24:27], v[108:111]
 ds_read_b128 v[216:219], v233 offset:12288
 v_mov_b32 v54, 0
 v_mov_b32 v55, 0
 v_mfma_f32_16x16x32_bf16 v[104:107], v[220:223], v[20:23], v[104:107]
 v_mov_b32 v56, 0
 v_mov_b32 v57, 0
 v_mfma_f32_16x16x32_bf16 v[112:115], v[220:223], v[24:27], v[112:115]
 ds_read_b128 v[220:223], v233 offset:12544
 v_mov_b32 v58, 0
 v_mov_b32 v59, 0
 s_waitcnt lgkmcnt(6)
 v_mfma_f32_16x16x32_bf16 v[100:103], v[224:227], v[28:31], v[100:103]
 v_mov_b32 v60, 0
 v_mov_b32 v61, 0
 v_mfma_f32_16x16x32_bf16 v[108:111], v[224:227], v[32:35], v[108:111]
 ds_read_b128 v[224:227], v233 offset:14336
 v_mov_b32 v62, 0
 v_mov_b32 v63, 0
 v_mfma_f32_16x16x32_bf16 v[104:107], v[228:231], v[28:31], v[104:107]
 v_mov_b32 v64, 0
 v_mov_b32 v65, 0
 v_mfma_f32_16x16x32_bf16 v[112:115], v[228:231], v[32:35], v[112:115]
 ds_read_b128 v[228:231], v233 offset:14592
 v_mov_b32 v66, 0
 v_mov_b32 v67, 0
 s_waitcnt lgkmcnt(6)
 v_mfma_f32_16x16x32_bf16 v[116:119], v[200:203], v[4:7], 0
 v_mov_b32 v68, 0
 v_mov_b32 v69, 0
 v_mfma_f32_16x16x32_bf16 v[124:127], v[200:203], v[8:11], 0
 ds_read_b128 v[200:203], v233 offset:32768
 v_mov_b32 v70, 0
 v_mov_b32 v71, 0
 v_mfma_f32_16x16x32_bf16 v[120:123], v[204:207], v[4:7], 0
 v_mov_b32 v72, 0
 v_mov_b32 v73, 0
 v_mfma_f32_16x16x32_bf16 v[128:131], v[204:207], v[8:11], 0
 ds_read_b128 v[204:207], v233 offset:33024
 v_mov_b32 v74, 0
 v_mov_b32 v75, 0
 s_waitcnt lgkmcnt(6)
 v_mfma_f32_16x16x32_bf16 v[116:119], v[208:211], v[12:15], v[116:119]
 v_mov_b32 v76, 0
 v_mov_b32 v77, 0
 v_mfma_f32_16x16x32_bf16 v[124:127], v[208:211], v[16:19], v[124:127]
 ds_read_b128 v[208:211], v233 offset:34816
 v_mov_b32 v78, 0
 v_mov_b32 v79, 0
 v_mfma_f32_16x16x32_bf16 v[120:123], v[212:215], v[12:15], v[120:123]
 v_mov_b32 v80, 0
 v_mov_b32 v81, 0
 v_mfma_f32_16x16x32_bf16 v[128:131], v[212:215], v[16:19], v[128:131]
 ds_read_b128 v[212:215], v233 offset:35072
 v_mov_b32 v82, 0
 v_mov_b32 v83, 0
 s_waitcnt lgkmcnt(6)
 v_mfma_f32_16x16x32_bf16 v[116:119], v[216:219], v[20:23], v[116:119]
 v_mov_b32 v84, 0
 v_mov_b32 v85, 0
 v_mfma_f32_16x16x32_bf16 v[124:127], v[216:219], v[24:27], v[124:127]
 ds_read_b128 v[216:219], v233 offset:36864
 v_mov_b32 v86, 0
 v_mov_b32 v87, 0
 v_mfma_f32_16x16x32_bf16 v[120:123], v[220:223], v[20:23], v[120:123]
 v_mov_b32 v88, 0
 v_mov_b32 v89, 0
 v_mfma_f32_16x16x32_bf16 v[128:131], v[220:223], v[24:27], v[128:131]
 ds_read_b128 v[220:223], v233 offset:37120
 v_mov_b32 v90, 0
 v_mov_b32 v91, 0
 s_waitcnt lgkmcnt(6)
 v_mfma_f32_16x16x32_bf16 v[116:119], v[224:227], v[28:31], v[116:119]
 v_mov_b32 v92, 0
 v_mov_b32 v93, 0
 v_mfma_f32_16x16x32_bf16 v[124:127], v[224:227], v[32:35], v[124:127]
 ds_read_b128 v[224:227], v233 offset:38912
 v_mov_b32 v94, 0
 v_mov_b32 v95, 0
 v_mfma_f32_16x16x32_bf16 v[120:123], v[228:231], v[28:31], v[120:123]
 v_mov_b32 v96, 0
 v_mov_b32 v97, 0
 v_mfma_f32_16x16x32_bf16 v[128:131], v[228:231], v[32:35], v[128:131]
 ds_read_b128 v[228:231], v233 offset:39168
 v_mov_b32 v98, 0
 v_mov_b32 v99, 0
 s_waitcnt lgkmcnt(4)
 v_mov_b32 v188, 0
 v_mov_b32 v189, 0
 v_mov_b32 v190, 0
 v_mov_b32 v191, 0
 s_lshr_b32 s41, s24, 1
 s_or_b32 s41, s41, s26
 s_cmp_eq_u32 s41, 0
 s_cbranch_scc0 KB_PNOMASKB
 s_lshl_b32 s41, s24, 5
 v_add_u32 v237, s41, v245
 v_cmp_gt_i32 s[44:45], 0, v237
 v_cmp_gt_i32 s[46:47], 1, v237
 v_cmp_gt_i32 s[48:49], 2, v237
 v_cmp_gt_i32 s[50:51], 3, v237
 v_cndmask_b32 v100, v100, v246, s[44:45]
 v_cndmask_b32 v101, v101, v246, s[46:47]
 v_cndmask_b32 v102, v102, v246, s[48:49]
 v_cndmask_b32 v103, v103, v246, s[50:51]
 v_cmp_gt_i32 s[44:45], 8, v237
 v_cmp_gt_i32 s[46:47], 9, v237
 v_cmp_gt_i32 s[48:49], 10, v237
 v_cmp_gt_i32 s[50:51], 11, v237
 v_cndmask_b32 v104, v104, v246, s[44:45]
 v_cndmask_b32 v105, v105, v246, s[46:47]
 v_cndmask_b32 v106, v106, v246, s[48:49]
 v_cndmask_b32 v107, v107, v246, s[50:51]
 v_cmp_gt_i32 s[44:45], -16, v237
 v_cmp_gt_i32 s[46:47], -15, v237
 v_cmp_gt_i32 s[48:49], -14, v237
 v_cmp_gt_i32 s[50:51], -13, v237
 v_cndmask_b32 v108, v108, v246, s[44:45]
 v_cndmask_b32 v109, v109, v246, s[46:47]
 v_cndmask_b32 v110, v110, v246, s[48:49]
 v_cndmask_b32 v111, v111, v246, s[50:51]
 v_cmp_gt_i32 s[44:45], -8, v237
 v_cmp_gt_i32 s[46:47], -7, v237
 v_cmp_gt_i32 s[48:49], -6, v237
 v_cmp_gt_i32 s[50:51], -5, v237
 v_cndmask_b32 v112, v112, v246, s[44:45]
 v_cndmask_b32 v113, v113, v246, s[46:47]
 v_cndmask_b32 v114, v114, v246, s[48:49]
 v_cndmask_b32 v115, v115, v246, s[50:51]
 v_cmp_gt_i32 s[44:45], 32, v237
 v_cmp_gt_i32 s[46:47], 33, v237
 v_cmp_gt_i32 s[48:49], 34, v237
 v_cmp_gt_i32 s[50:51], 35, v237
 v_cndmask_b32 v116, v116, v246, s[44:45]
 v_cndmask_b32 v117, v117, v246, s[46:47]
 v_cndmask_b32 v118, v118, v246, s[48:49]
 v_cndmask_b32 v119, v119, v246, s[50:51]
 v_cmp_gt_i32 s[44:45], 40, v237
 v_cmp_gt_i32 s[46:47], 41, v237
 v_cmp_gt_i32 s[48:49], 42, v237
 v_cmp_gt_i32 s[50:51], 43, v237
 v_cndmask_b32 v120, v120, v246, s[44:45]
 v_cndmask_b32 v121, v121, v246, s[46:47]
 v_cndmask_b32 v122, v122, v246, s[48:49]
 v_cndmask_b32 v123, v123, v246, s[50:51]
 v_cmp_gt_i32 s[44:45], 16, v237
 v_cmp_gt_i32 s[46:47], 17, v237
 v_cmp_gt_i32 s[48:49], 18, v237
 v_cmp_gt_i32 s[50:51], 19, v237
 v_cndmask_b32 v124, v124, v246, s[44:45]
 v_cndmask_b32 v125, v125, v246, s[46:47]
 v_cndmask_b32 v126, v126, v246, s[48:49]
 v_cndmask_b32 v127, v127, v246, s[50:51]
 v_cmp_gt_i32 s[44:45], 24, v237
 v_cmp_gt_i32 s[46:47], 25, v237
 v_cmp_gt_i32 s[48:49], 26, v237
 v_cmp_gt_i32 s[50:51], 27, v237
 v_cndmask_b32 v128, v128, v246, s[44:45]
 v_cndmask_b32 v129, v129, v246, s[46:47]
 v_cndmask_b32 v130, v130, v246, s[48:49]
 v_cndmask_b32 v131, v131, v246, s[50:51]
KB_PNOMASKB:
 s_waitcnt vmcnt(8)
 ds_write_b32 v244, v239 offset:1024
 v_max3_f32 v236, v100, v101, v102
 v_max3_f32 v235, v108, v109, v110
 v_max3_f32 v236, v236, v103, v104
 v_max3_f32 v235, v235, v111, v112
 v_max3_f32 v236, v236, v105, v106
 v_max3_f32 v235, v235, v113, v114
 v_max3_f32 v236, v236, v107, v116
 v_max3_f32 v235, v235, v115, v124
 v_max3_f32 v236, v236, v117, v118
 v_max3_f32 v235, v235, v125, v126
 v_max3_f32 v236, v236, v119, v120
 v_max3_f32 v235, v235, v127, v128
 v_max3_f32 v236, v236, v121, v122
 v_max3_f32 v235, v235, v129, v130
 v_max_f32 v236, v236, v123
 v_max_f32 v235, v235, v131
 v_mov_b32 v237, v236
 v_mov_b32 v240, v235
 s_nop 0
 v_permlane32_swap_b32 v236, v237
 v_permlane32_swap_b32 v235, v240
 v_max_f32 v236, v236, v237
 v_max_f32 v235, v235, v240
 v_mov_b32 v237, v236
 v_mov_b32 v240, v235
 s_nop 0
 v_permlane16_swap_b32 v236, v237
 v_permlane16_swap_b32 v235, v240
 v_max_f32 v236, v236, v237
 v_max_f32 v235, v235, v240
 v_sub_f32 v180, 0, v236
 v_sub_f32 v181, 0, v236
 v_sub_f32 v182, 0, v236
 v_sub_f32 v183, 0, v236
 v_sub_f32 v184, 0, v235
 v_sub_f32 v185, 0, v235
 v_sub_f32 v186, 0, v235
 v_sub_f32 v187, 0, v235
 v_sub_f32 v100, v100, v236
 v_sub_f32 v101, v101, v236
 v_sub_f32 v102, v102, v236
 v_sub_f32 v103, v103, v236
 v_sub_f32 v104, v104, v236
 v_sub_f32 v105, v105, v236
 v_sub_f32 v106, v106, v236
 v_sub_f32 v107, v107, v236
 v_sub_f32 v108, v108, v235
 v_sub_f32 v109, v109, v235
 v_sub_f32 v110, v110, v235
 v_sub_f32 v111, v111, v235
 v_sub_f32 v112, v112, v235
 v_sub_f32 v113, v113, v235
 v_sub_f32 v114, v114, v235
 v_sub_f32 v115, v115, v235
 v_sub_f32 v116, v116, v236
 v_sub_f32 v117, v117, v236
 v_sub_f32 v118, v118, v236
 v_sub_f32 v119, v119, v236
 v_sub_f32 v120, v120, v236
 v_sub_f32 v121, v121, v236
 v_sub_f32 v122, v122, v236
 v_sub_f32 v123, v123, v236
 v_sub_f32 v124, v124, v235
 v_sub_f32 v125, v125, v235
 v_sub_f32 v126, v126, v235
 v_sub_f32 v127, v127, v235
 v_sub_f32 v128, v128, v235
 v_sub_f32 v129, v129, v235
 v_sub_f32 v130, v130, v235
 v_sub_f32 v131, v131, v235
 v_exp_f32 v240, v100
 v_exp_f32 v241, v101
 v_exp_f32 v242, v102
 v_cvt_pk_bf16_f32 v164, v240, v241
 v_exp_f32 v243, v103
 v_exp_f32 v240, v104
 v_cvt_pk_bf16_f32 v165, v242, v243
 v_exp_f32 v241, v105
 v_exp_f32 v242, v106
 v_cvt_pk_bf16_f32 v166, v240, v241
 v_exp_f32 v243, v107
 v_exp_f32 v240, v108
 v_cvt_pk_bf16_f32 v167, v242, v243
 v_exp_f32 v241, v109
 v_exp_f32 v242, v110
 v_cvt_pk_bf16_f32 v168, v240, v241
 v_exp_f32 v243, v111
 v_exp_f32 v240, v112
 v_cvt_pk_bf16_f32 v169, v242, v243
 v_exp_f32 v241, v113
 v_exp_f32 v242, v114
 v_cvt_pk_bf16_f32 v170, v240, v241
 v_exp_f32 v243, v115
 s_nop 0
 v_cvt_pk_bf16_f32 v171, v242, v243
 v_mov_b32 v242, s90
 v_mov_b32 v243, s91
 s_add_u32 s41, s89, -16384
 s_mov_b64 exec, 1
 buffer_store_dwordx2 v[242:243], off, s[96:99], s41 sc1
 s_mov_b64 exec, -1
 s_lshr_b32 s41, s24, 1
 s_add_u32 s30, s27, s41
 s_sub_u32 s30, s30, 3
 s_cmp_eq_u32 s27, 2
 s_cbranch_scc1 KB_T0B
KB_LOOPB:
 ds_write_b32 v244, v239
 v_mfma_f32_16x16x32_bf16 v[192:195], v[248:251], v[164:167], v[188:191]
 v_exp_f32 v240, v116
 v_mfma_f32_16x16x32_bf16 v[192:195], v[252:255], v[168:171], v[192:195]
 v_exp_f32 v241, v117
 v_mfma_f32_16x16x32_bf16 v[132:135], v[200:203], v[4:7], v[180:183]
 v_exp_f32 v242, v118
 v_mfma_f32_16x16x32_bf16 v[140:143], v[200:203], v[8:11], v[184:187]
 ds_read_b128 v[200:203], v233 offset:16384
 v_cvt_pk_bf16_f32 v172, v240, v241
 v_mfma_f32_16x16x32_bf16 v[136:139], v[204:207], v[4:7], v[180:183]
 v_exp_f32 v243, v119
 v_mfma_f32_16x16x32_bf16 v[144:147], v[204:207], v[8:11], v[184:187]
 ds_read_b128 v[204:207], v233 offset:16640
 v_mfma_f32_16x16x32_bf16 v[132:135], v[208:211], v[12:15], v[132:135]
 v_exp_f32 v240, v120
 v_mfma_f32_16x16x32_bf16 v[140:143], v[208:211], v[16:19], v[140:143]
 ds_read_b128 v[208:211], v233 offset:20480
 v_cvt_pk_bf16_f32 v173, v242, v243
 v_cmp_nge_f32 vcc, 0x53800000, v194
 s_cbranch_vccnz KB_RARE_UEB_0
KB_RET_UEB_0:
 v_mfma_f32_16x16x32_bf16 v[136:139], v[212:215], v[12:15], v[136:139]
 v_exp_f32 v241, v121
 v_mfma_f32_16x16x32_bf16 v[144:147], v[212:215], v[16:19], v[144:147]
 ds_read_b128 v[212:215], v233 offset:20736
 s_waitcnt lgkmcnt(5)
 v_mfma_f32_16x16x32_bf16 v[132:135], v[216:219], v[20:23], v[132:135]
 v_exp_f32 v242, v122
 v_mfma_f32_16x16x32_bf16 v[140:143], v[216:219], v[24:27], v[140:143]
 ds_read_b128 v[216:219], v233 offset:24576
 v_cvt_pk_bf16_f32 v174, v240, v241
 v_mfma_f32_16x16x32_bf16 v[136:139], v[220:223], v[20:23], v[136:139]
 v_exp_f32 v243, v123
 v_mfma_f32_16x16x32_bf16 v[144:147], v[220:223], v[24:27], v[144:147]
 ds_read_b128 v[220:223], v233 offset:24832
 v_mfma_f32_16x16x32_bf16 v[132:135], v[224:227], v[28:31], v[132:135]
 v_exp_f32 v240, v124
 v_mfma_f32_16x16x32_bf16 v[140:143], v[224:227], v[32:35], v[140:143]
 ds_read_b128 v[224:227], v233 offset:28672
 v_cvt_pk_bf16_f32 v175, v242, v243
 v_mfma_f32_16x16x32_bf16 v[136:139], v[228:231], v[28:31], v[136:139]
 v_exp_f32 v241, v125
 v_mfma_f32_16x16x32_bf16 v[144:147], v[228:231], v[32:35], v[144:147]
 ds_read_b128 v[228:231], v233 offset:28928
 s_waitcnt lgkmcnt(4)
 v_mfma_f32_16x16x32_bf16 v[36:39], v[200:203], v[164:167], v[36:39]
 v_exp_f32 v242, v126
 v_mfma_f32_16x16x32_bf16 v[44:47], v[200:203], v[168:171], v[44:47]
 ds_read_b128 v[200:203], v233 offset:40960
 v_cvt_pk_bf16_f32 v176, v240, v241
 v_mfma_f32_16x16x32_bf16 v[40:43], v[204:207], v[164:167], v[40:43]
 v_exp_f32 v243, v127
 v_mfma_f32_16x16x32_bf16 v[48:51], v[204:207], v[168:171], v[48:51]
 ds_read_b128 v[204:207], v233 offset:41216
 v_mfma_f32_16x16x32_bf16 v[52:55], v[208:211], v[164:167], v[52:55]
 v_exp_f32 v240, v128
 v_mfma_f32_16x16x32_bf16 v[60:63], v[208:211], v[168:171], v[60:63]
 ds_read_b128 v[208:211], v233 offset:43008
 v_cvt_pk_bf16_f32 v177, v242, v243
 v_mfma_f32_16x16x32_bf16 v[56:59], v[212:215], v[164:167], v[56:59]
 v_exp_f32 v241, v129
 v_mfma_f32_16x16x32_bf16 v[64:67], v[212:215], v[168:171], v[64:67]
 ds_read_b128 v[212:215], v233 offset:43264
 s_waitcnt lgkmcnt(4)
 v_mfma_f32_16x16x32_bf16 v[68:71], v[216:219], v[164:167], v[68:71]
 v_exp_f32 v242, v130
 v_mfma_f32_16x16x32_bf16 v[76:79], v[216:219], v[168:171], v[76:79]
 ds_read_b128 v[216:219], v233 offset:45056
 v_cvt_pk_bf16_f32 v178, v240, v241
 v_mfma_f32_16x16x32_bf16 v[72:75], v[220:223], v[164:167], v[72:75]
 v_exp_f32 v243, v131
 v_mfma_f32_16x16x32_bf16 v[80:83], v[220:223], v[168:171], v[80:83]
 ds_read_b128 v[220:223], v233 offset:45312
 v_cvt_pk_bf16_f32 v179, v242, v243
 v_mfma_f32_16x16x32_bf16 v[84:87], v[224:227], v[164:167], v[84:87]
 v_mfma_f32_16x16x32_bf16 v[92:95], v[224:227], v[168:171], v[92:95]
 ds_read_b128 v[224:227], v233 offset:47104
 v_mfma_f32_16x16x32_bf16 v[88:91], v[228:231], v[164:167], v[88:91]
 v_mfma_f32_16x16x32_bf16 v[96:99], v[228:231], v[168:171], v[96:99]
 ds_read_b128 v[228:231], v233 offset:47360
 s_waitcnt lgkmcnt(4)
 v_mfma_f32_16x16x32_bf16 v[188:191], v[248:251], v[172:175], v[192:195]
 v_exp_f32 v240, v132
 v_mfma_f32_16x16x32_bf16 v[188:191], v[252:255], v[176:179], v[188:191]
 v_exp_f32 v241, v133
 v_mfma_f32_16x16x32_bf16 v[148:151], v[200:203], v[4:7], v[180:183]
 v_exp_f32 v242, v134
 v_mfma_f32_16x16x32_bf16 v[156:159], v[200:203], v[8:11], v[184:187]
 ds_read_b128 v[200:203], v233 offset:18432
 v_cvt_pk_bf16_f32 v164, v240, v241
 v_mfma_f32_16x16x32_bf16 v[152:155], v[204:207], v[4:7], v[180:183]
 v_exp_f32 v243, v135
 v_mfma_f32_16x16x32_bf16 v[160:163], v[204:207], v[8:11], v[184:187]
 ds_read_b128 v[204:207], v233 offset:18688
 v_mfma_f32_16x16x32_bf16 v[148:151], v[208:211], v[12:15], v[148:151]
 v_exp_f32 v240, v136
 v_mfma_f32_16x16x32_bf16 v[156:159], v[208:211], v[16:19], v[156:159]
 ds_read_b128 v[208:211], v233 offset:22528
 v_cvt_pk_bf16_f32 v165, v242, v243
 v_cmp_nge_f32 vcc, 0x53800000, v190
 s_cbranch_vccnz KB_RARE_UEB_1
KB_RET_UEB_1:
 v_mfma_f32_16x16x32_bf16 v[152:155], v[212:215], v[12:15], v[152:155]
 v_exp_f32 v241, v137
 v_mfma_f32_16x16x32_bf16 v[160:163], v[212:215], v[16:19], v[160:163]
 ds_read_b32 v238, v232
 ds_read_b128 v[212:215], v233 offset:22784
 s_waitcnt lgkmcnt(5)
 v_mfma_f32_16x16x32_bf16 v[148:151], v[216:219], v[20:23], v[148:151]
 v_exp_f32 v242, v138
 v_mfma_f32_16x16x32_bf16 v[156:159], v[216:219], v[24:27], v[156:159]
 ds_read_b128 v[216:219], v233 offset:26624
 v_cvt_pk_bf16_f32 v166, v240, v241
 v_mfma_f32_16x16x32_bf16 v[152:155], v[220:223], v[20:23], v[152:155]
 v_exp_f32 v243, v139
 v_mfma_f32_16x16x32_bf16 v[160:163], v[220:223], v[24:27], v[160:163]
 ds_read_b128 v[220:223], v233 offset:26880
 v_mfma_f32_16x16x32_bf16 v[148:151], v[224:227], v[28:31], v[148:151]
 v_exp_f32 v240, v140
 v_mfma_f32_16x16x32_bf16 v[156:159], v[224:227], v[32:35], v[156:159]
 ds_read_b128 v[224:227], v233 offset:30720
 v_cvt_pk_bf16_f32 v167, v242, v243
 v_mfma_f32_16x16x32_bf16 v[152:155], v[228:231], v[28:31], v[152:155]
 v_exp_f32 v241, v141
 v_mfma_f32_16x16x32_bf16 v[160:163], v[228:231], v[32:35], v[160:163]
 ds_read_b128 v[228:231], v233 offset:30976
 s_waitcnt lgkmcnt(4)
 v_mfma_f32_16x16x32_bf16 v[36:39], v[200:203], v[172:175], v[36:39]
 v_cmp_lt_u32 vcc, v238, v239
 s_cbranch_vccnz KB_SPIN_UEB
KB_SPR_UEB:
 v_mfma_f32_16x16x32_bf16 v[44:47], v[200:203], v[176:179], v[44:47]
 ds_read_b128 v[200:203], v234 offset:0
 v_add_u32 v239, 1, v239
 ds_write_b32 v244, v239 offset:3072
 s_waitcnt vmcnt(0)
 ds_write_b32 v244, v239 offset:1024
 s_add_u32 s32, s32, 1
 s_mov_b32 m0, s35
 v_mfma_f32_16x16x32_bf16 v[40:43], v[204:207], v[172:175], v[40:43]
 v_exp_f32 v242, v142
 v_mfma_f32_16x16x32_bf16 v[48:51], v[204:207], v[176:179], v[48:51]
 ds_read_b128 v[204:207], v234 offset:256
 buffer_load_dwordx4 v197, s[12:15], s31 offen offset:0 sc1 lds
 v_cvt_pk_bf16_f32 v168, v240, v241
 v_mfma_f32_16x16x32_bf16 v[52:55], v[208:211], v[172:175], v[52:55]
 v_exp_f32 v243, v143
 v_mfma_f32_16x16x32_bf16 v[60:63], v[208:211], v[176:179], v[60:63]
 ds_read_b128 v[208:211], v234 offset:2048
 buffer_load_dwordx4 v197, s[12:15], s31 offen offset:1024 sc1 lds
 v_mfma_f32_16x16x32_bf16 v[56:59], v[212:215], v[172:175], v[56:59]
 v_exp_f32 v240, v144
 v_mfma_f32_16x16x32_bf16 v[64:67], v[212:215], v[176:179], v[64:67]
 ds_read_b128 v[212:215], v234 offset:2304
 buffer_load_dwordx4 v197, s[12:15], s31 offen offset:2048 sc1 lds
 s_waitcnt lgkmcnt(6)
 v_mfma_f32_16x16x32_bf16 v[68:71], v[216:219], v[172:175], v[68:71]
 v_cvt_pk_bf16_f32 v169, v242, v243
 v_mfma_f32_16x16x32_bf16 v[76:79], v[216:219], v[176:179], v[76:79]
 ds_read_b128 v[216:219], v234 offset:4096
 buffer_load_dwordx4 v197, s[12:15], s31 offen offset:3072 sc1 lds
 s_add_u32 s31, s31, 16384
 s_add_u32 s35, s35, 32768
 s_and_b32 s35, s35, 0x1ffff
 v_mfma_f32_16x16x32_bf16 v[72:75], v[220:223], v[172:175], v[72:75]
 v_exp_f32 v241, v145
 v_mfma_f32_16x16x32_bf16 v[80:83], v[220:223], v[176:179], v[80:83]
 ds_read_b128 v[220:223], v234 offset:4352
 s_mov_b32 m0, s36
 s_nop 0
 buffer_load_dwordx4 v197, s[16:19], s33 offen offset:0 sc1 lds
 v_mfma_f32_16x16x32_bf16 v[84:87], v[224:227], v[172:175], v[84:87]
 v_exp_f32 v242, v146
 v_mfma_f32_16x16x32_bf16 v[92:95], v[224:227], v[176:179], v[92:95]
 ds_read_b128 v[224:227], v234 offset:6144
 buffer_load_dwordx4 v197, s[16:19], s33 offen offset:1024 sc1 lds
 v_cvt_pk_bf16_f32 v170, v240, v241
 v_mfma_f32_16x16x32_bf16 v[88:91], v[228:231], v[172:175], v[88:91]
 v_exp_f32 v243, v147
 v_mfma_f32_16x16x32_bf16 v[96:99], v[228:231], v[176:179], v[96:99]
 ds_read_b128 v[228:231], v234 offset:6400
 buffer_load_dwordx4 v197, s[16:19], s33 offen offset:2048 sc1 lds
 s_waitcnt lgkmcnt(4)
 v_cvt_pk_bf16_f32 v171, v242, v243
 buffer_load_dwordx4 v197, s[16:19], s33 offen offset:3072 sc1 lds
 s_add_u32 s33, s33, 16384
 s_add_u32 s36, s36, 32768
 s_and_b32 s36, s36, 0x1ffff
 s_sub_u32 s30, s30, 1
 s_cmp_eq_u32 s30, 0
 s_cbranch_scc1 KB_X1B
 ds_write_b32 v244, v239
 v_mfma_f32_16x16x32_bf16 v[192:195], v[248:251], v[164:167], v[188:191]
 v_exp_f32 v240, v148
 v_mfma_f32_16x16x32_bf16 v[192:195], v[252:255], v[168:171], v[192:195]
 v_exp_f32 v241, v149
 v_mfma_f32_16x16x32_bf16 v[100:103], v[200:203], v[4:7], v[180:183]
 v_exp_f32 v242, v150
 v_mfma_f32_16x16x32_bf16 v[108:111], v[200:203], v[8:11], v[184:187]
 ds_read_b128 v[200:203], v233 offset:49152
 v_cvt_pk_bf16_f32 v172, v240, v241
 v_mfma_f32_16x16x32_bf16 v[104:107], v[204:207], v[4:7], v[180:183]
 v_exp_f32 v243, v151
 v_mfma_f32_16x16x32_bf16 v[112:115], v[204:207], v[8:11], v[184:187]
 ds_read_b128 v[204:207], v233 offset:49408
 v_mfma_f32_16x16x32_bf16 v[100:103], v[208:211], v[12:15], v[100:103]
 v_exp_f32 v240, v152
 v_mfma_f32_16x16x32_bf16 v[108:111], v[208:211], v[16:19], v[108:111]
 ds_read_b128 v[208:211], v233 offset:53248
 v_cvt_pk_bf16_f32 v173, v242, v243
 v_cmp_nge_f32 vcc, 0x53800000, v194
 s_cbranch_vccnz KB_RARE_UOB_0
KB_RET_UOB_0:
 v_mfma_f32_16x16x32_bf16 v[104:107], v[212:215], v[12:15], v[104:107]
 v_exp_f32 v241, v153
 v_mfma_f32_16x16x32_bf16 v[112:115], v[212:215], v[16:19], v[112:115]
 ds_read_b128 v[212:215], v233 offset:53504
 s_waitcnt lgkmcnt(5)
 v_mfma_f32_16x16x32_bf16 v[100:103], v[216:219], v[20:23], v[100:103]
 v_exp_f32 v242, v154
 v_mfma_f32_16x16x32_bf16 v[108:111], v[216:219], v[24:27], v[108:111]
 ds_read_b128 v[216:219], v233 offset:57344
 v_cvt_pk_bf16_f32 v174, v240, v241
 v_mfma_f32_16x16x32_bf16 v[104:107], v[220:223], v[20:23], v[104:107]
 v_exp_f32 v243, v155
 v_mfma_f32_16x16x32_bf16 v[112:115], v[220:223], v[24:27], v[112:115]
 ds_read_b128 v[220:223], v233 offset:57600
 v_mfma_f32_16x16x32_bf16 v[100:103], v[224:227], v[28:31], v[100:103]
 v_exp_f32 v240, v156
 v_mfma_f32_16x16x32_bf16 v[108:111], v[224:227], v[32:35], v[108:111]
 ds_read_b128 v[224:227], v233 offset:61440
 v_cvt_pk_bf16_f32 v175, v242, v243
 v_mfma_f32_16x16x32_bf16 v[104:107], v[228:231], v[28:31], v[104:107]
 v_exp_f32 v241, v157
 v_mfma_f32_16x16x32_bf16 v[112:115], v[228:231], v[32:35], v[112:115]
 ds_read_b128 v[228:231], v233 offset:61696
 s_waitcnt lgkmcnt(4)
 v_mfma_f32_16x16x32_bf16 v[36:39], v[200:203], v[164:167], v[36:39]
 v_exp_f32 v242, v158
 v_mfma_f32_16x16x32_bf16 v[44:47], v[200:203], v[168:171], v[44:47]
 ds_read_b128 v[200:203], v234 offset:8192
 v_cvt_pk_bf16_f32 v176, v240, v241
 v_mfma_f32_16x16x32_bf16 v[40:43], v[204:207], v[164:167], v[40:43]
 v_exp_f32 v243, v159
 v_mfma_f32_16x16x32_bf16 v[48:51], v[204:207], v[168:171], v[48:51]
 ds_read_b128 v[204:207], v234 offset:8448
 v_mfma_f32_16x16x32_bf16 v[52:55], v[208:211], v[164:167], v[52:55]
 v_exp_f32 v240, v160
 v_mfma_f32_16x16x32_bf16 v[60:63], v[208:211], v[168:171], v[60:63]
 ds_read_b128 v[208:211], v234 offset:10240
 v_cvt_pk_bf16_f32 v177, v242, v243
 v_mfma_f32_16x16x32_bf16 v[56:59], v[212:215], v[164:167], v[56:59]
 v_exp_f32 v241, v161
 v_mfma_f32_16x16x32_bf16 v[64:67], v[212:215], v[168:171], v[64:67]
 ds_read_b128 v[212:215], v234 offset:10496
 s_waitcnt lgkmcnt(4)
 v_mfma_f32_16x16x32_bf16 v[68:71], v[216:219], v[164:167], v[68:71]
 v_exp_f32 v242, v162
 v_mfma_f32_16x16x32_bf16 v[76:79], v[216:219], v[168:171], v[76:79]
 ds_read_b128 v[216:219], v234 offset:12288
 v_cvt_pk_bf16_f32 v178, v240, v241
 v_mfma_f32_16x16x32_bf16 v[72:75], v[220:223], v[164:167], v[72:75]
 v_exp_f32 v243, v163
 v_mfma_f32_16x16x32_bf16 v[80:83], v[220:223], v[168:171], v[80:83]
 ds_read_b128 v[220:223], v234 offset:12544
 v_cvt_pk_bf16_f32 v179, v242, v243
 v_mfma_f32_16x16x32_bf16 v[84:87], v[224:227], v[164:167], v[84:87]
 v_mfma_f32_16x16x32_bf16 v[92:95], v[224:227], v[168:171], v[92:95]
 ds_read_b128 v[224:227], v234 offset:14336
 v_mfma_f32_16x16x32_bf16 v[88:91], v[228:231], v[164:167], v[88:91]
 v_mfma_f32_16x16x32_bf16 v[96:99], v[228:231], v[168:171], v[96:99]
 ds_read_b128 v[228:231], v234 offset:14592
 s_waitcnt lgkmcnt(4)
 v_mfma_f32_16x16x32_bf16 v[188:191], v[248:251], v[172:175], v[192:195]
 v_exp_f32 v240, v100
 v_mfma_f32_16x16x32_bf16 v[188:191], v[252:255], v[176:179], v[188:191]
 v_exp_f32 v241, v101
 v_mfma_f32_16x16x32_bf16 v[116:119], v[200:203], v[4:7], v[180:183]
 v_exp_f32 v242, v102
 v_mfma_f32_16x16x32_bf16 v[124:127], v[200:203], v[8:11], v[184:187]
 ds_read_b128 v[200:203], v233 offset:51200
 v_cvt_pk_bf16_f32 v164, v240, v241
 v_mfma_f32_16x16x32_bf16 v[120:123], v[204:207], v[4:7], v[180:183]
 v_exp_f32 v243, v103
 v_mfma_f32_16x16x32_bf16 v[128:131], v[204:207], v[8:11], v[184:187]
 ds_read_b128 v[204:207], v233 offset:51456
 v_mfma_f32_16x16x32_bf16 v[116:119], v[208:211], v[12:15], v[116:119]
 v_exp_f32 v240, v104
 v_mfma_f32_16x16x32_bf16 v[124:127], v[208:211], v[16:19], v[124:127]
 ds_read_b128 v[208:211], v233 offset:55296
 v_cvt_pk_bf16_f32 v165, v242, v243
 v_cmp_nge_f32 vcc, 0x53800000, v190
 s_cbranch_vccnz KB_RARE_UOB_1
KB_RET_UOB_1:
 v_mfma_f32_16x16x32_bf16 v[120:123], v[212:215], v[12:15], v[120:123]
 v_exp_f32 v241, v105
 v_mfma_f32_16x16x32_bf16 v[128:131], v[212:215], v[16:19], v[128:131]
 ds_read_b32 v238, v232
 ds_read_b128 v[212:215], v233 offset:55552
 s_waitcnt lgkmcnt(5)
 v_mfma_f32_16x16x32_bf16 v[116:119], v[216:219], v[20:23], v[116:119]
 v_exp_f32 v242, v106
 v_mfma_f32_16x16x32_bf16 v[124:127], v[216:219], v[24:27], v[124:127]
 ds_read_b128 v[216:219], v233 offset:59392
 v_cvt_pk_bf16_f32 v166, v240, v241
 v_mfma_f32_16x16x32_bf16 v[120:123], v[220:223], v[20:23], v[120:123]
 v_exp_f32 v243, v107
 v_mfma_f32_16x16x32_bf16 v[128:131], v[220:223], v[24:27], v[128:131]
 ds_read_b128 v[220:223], v233 offset:59648
 v_mfma_f32_16x16x32_bf16 v[116:119], v[224:227], v[28:31], v[116:119]
 v_exp_f32 v240, v108
 v_mfma_f32_16x16x32_bf16 v[124:127], v[224:227], v[32:35], v[124:127]
 ds_read_b128 v[224:227], v233 offset:63488
 v_cvt_pk_bf16_f32 v167, v242, v243
 v_mfma_f32_16x16x32_bf16 v[120:123], v[228:231], v[28:31], v[120:123]
 v_exp_f32 v241, v109
 v_mfma_f32_16x16x32_bf16 v[128:131], v[228:231], v[32:35], v[128:131]
 ds_read_b128 v[228:231], v233 offset:63744
 v_swap_b32 v233, v234
 s_waitcnt lgkmcnt(4)
 v_mfma_f32_16x16x32_bf16 v[36:39], v[200:203], v[172:175], v[36:39]
 v_cmp_lt_u32 vcc, v238, v239
 s_cbranch_vccnz KB_SPIN_UOB
KB_SPR_UOB:
 v_mfma_f32_16x16x32_bf16 v[44:47], v[200:203], v[176:179], v[44:47]
 ds_read_b128 v[200:203], v233 offset:32768
 v_add_u32 v239, 1, v239
 ds_write_b32 v244, v239 offset:3072
 s_waitcnt vmcnt(0)
 ds_write_b32 v244, v239 offset:1024
 s_add_u32 s32, s32, 1
 s_mov_b32 m0, s35
 v_mfma_f32_16x16x32_bf16 v[40:43], v[204:207], v[172:175], v[40:43]
 v_exp_f32 v242, v110
 v_mfma_f32_16x16x32_bf16 v[48:51], v[204:207], v[176:179], v[48:51]
 ds_read_b128 v[204:207], v233 offset:33024
 buffer_load_dwordx4 v197, s[12:15], s31 offen offset:0 sc1 lds
 v_cvt_pk_bf16_f32 v168, v240, v241
 v_mfma_f32_16x16x32_bf16 v[52:55], v[208:211], v[172:175], v[52:55]
 v_exp_f32 v243, v111
 v_mfma_f32_16x16x32_bf16 v[60:63], v[208:211], v[176:179], v[60:63]
 ds_read_b128 v[208:211], v233 offset:34816
 buffer_load_dwordx4 v197, s[12:15], s31 offen offset:1024 sc1 lds
 v_mfma_f32_16x16x32_bf16 v[56:59], v[212:215], v[172:175], v[56:59]
 v_exp_f32 v240, v112
 v_mfma_f32_16x16x32_bf16 v[64:67], v[212:215], v[176:179], v[64:67]
 ds_read_b128 v[212:215], v233 offset:35072
 buffer_load_dwordx4 v197, s[12:15], s31 offen offset:2048 sc1 lds
 s_waitcnt lgkmcnt(6)
 v_mfma_f32_16x16x32_bf16 v[68:71], v[216:219], v[172:175], v[68:71]
 v_cvt_pk_bf16_f32 v169, v242, v243
 v_mfma_f32_16x16x32_bf16 v[76:79], v[216:219], v[176:179], v[76:79]
 ds_read_b128 v[216:219], v233 offset:36864
 buffer_load_dwordx4 v197, s[12:15], s31 offen offset:3072 sc1 lds
 s_add_u32 s31, s31, 16384
 s_add_u32 s35, s35, 32768
 s_and_b32 s35, s35, 0x1ffff
 v_mfma_f32_16x16x32_bf16 v[72:75], v[220:223], v[172:175], v[72:75]
 v_exp_f32 v241, v113
 v_mfma_f32_16x16x32_bf16 v[80:83], v[220:223], v[176:179], v[80:83]
 ds_read_b128 v[220:223], v233 offset:37120
 s_mov_b32 m0, s36
 s_nop 0
 buffer_load_dwordx4 v197, s[16:19], s33 offen offset:0 sc1 lds
 v_mfma_f32_16x16x32_bf16 v[84:87], v[224:227], v[172:175], v[84:87]
 v_exp_f32 v242, v114
 v_mfma_f32_16x16x32_bf16 v[92:95], v[224:227], v[176:179], v[92:95]
 ds_read_b128 v[224:227], v233 offset:38912
 buffer_load_dwordx4 v197, s[16:19], s33 offen offset:1024 sc1 lds
 v_cvt_pk_bf16_f32 v170, v240, v241
 v_mfma_f32_16x16x32_bf16 v[88:91], v[228:231], v[172:175], v[88:91]
 v_exp_f32 v243, v115
 v_mfma_f32_16x16x32_bf16 v[96:99], v[228:231], v[176:179], v[96:99]
 ds_read_b128 v[228:231], v233 offset:39168
 buffer_load_dwordx4 v197, s[16:19], s33 offen offset:2048 sc1 lds
 s_waitcnt lgkmcnt(4)
 v_cvt_pk_bf16_f32 v171, v242, v243
 buffer_load_dwordx4 v197, s[16:19], s33 offen offset:3072 sc1 lds
 s_add_u32 s33, s33, 16384
 s_add_u32 s36, s36, 32768
 s_and_b32 s36, s36, 0x1ffff
 s_sub_u32 s30, s30, 1
 s_cmp_eq_u32 s30, 0
 s_cbranch_scc0 KB_LOOPB
KB_X0B:
 s_bitcmp1_b32 s24, 0
 s_cbranch_scc0 KB_X0AB
 ds_write_b32 v244, v239
 v_mfma_f32_16x16x32_bf16 v[192:195], v[248:251], v[164:167], v[188:191]
 v_exp_f32 v240, v116
 v_mfma_f32_16x16x32_bf16 v[192:195], v[252:255], v[168:171], v[192:195]
 v_exp_f32 v241, v117
 v_mfma_f32_16x16x32_bf16 v[132:135], v[200:203], v[4:7], v[180:183]
 v_exp_f32 v242, v118
 v_mfma_f32_16x16x32_bf16 v[140:143], v[200:203], v[8:11], v[184:187]
 ds_read_b128 v[200:203], v233 offset:16384
 v_cvt_pk_bf16_f32 v172, v240, v241
 v_mfma_f32_16x16x32_bf16 v[136:139], v[204:207], v[4:7], v[180:183]
 v_exp_f32 v243, v119
 v_mfma_f32_16x16x32_bf16 v[144:147], v[204:207], v[8:11], v[184:187]
 ds_read_b128 v[204:207], v233 offset:16640
 v_mfma_f32_16x16x32_bf16 v[132:135], v[208:211], v[12:15], v[132:135]
 v_exp_f32 v240, v120
 v_mfma_f32_16x16x32_bf16 v[140:143], v[208:211], v[16:19], v[140:143]
 ds_read_b128 v[208:211], v233 offset:20480
 v_cvt_pk_bf16_f32 v173, v242, v243
 v_cmp_nge_f32 vcc, 0x53800000, v194
 s_cbranch_vccnz KB_RARE_B0B_0
KB_RET_B0B_0:
 v_mfma_f32_16x16x32_bf16 v[136:139], v[212:215], v[12:15], v[136:139]
 v_exp_f32 v241, v121
 v_mfma_f32_16x16x32_bf16 v[144:147], v[212:215], v[16:19], v[144:147]
 ds_read_b128 v[212:215], v233 offset:20736
 s_waitcnt lgkmcnt(5)
 v_mfma_f32_16x16x32_bf16 v[132:135], v[216:219], v[20:23], v[132:135]
 v_exp_f32 v242, v122
 v_mfma_f32_16x16x32_bf16 v[140:143], v[216:219], v[24:27], v[140:143]
 ds_read_b128 v[216:219], v233 offset:24576
 v_cvt_pk_bf16_f32 v174, v240, v241
 v_mfma_f32_16x16x32_bf16 v[136:139], v[220:223], v[20:23], v[136:139]
 v_exp_f32 v243, v123
 v_mfma_f32_16x16x32_bf16 v[144:147], v[220:223], v[24:27], v[144:147]
 ds_read_b128 v[220:223], v233 offset:24832
 v_mfma_f32_16x16x32_bf16 v[132:135], v[224:227], v[28:31], v[132:135]
 v_exp_f32 v240, v124
 v_mfma_f32_16x16x32_bf16 v[140:143], v[224:227], v[32:35], v[140:143]
 ds_read_b128 v[224:227], v233 offset:28672
 v_cvt_pk_bf16_f32 v175, v242, v243
 v_mfma_f32_16x16x32_bf16 v[136:139], v[228:231], v[28:31], v[136:139]
 v_exp_f32 v241, v125
 v_mfma_f32_16x16x32_bf16 v[144:147], v[228:231], v[32:35], v[144:147]
 ds_read_b128 v[228:231], v233 offset:28928
 s_waitcnt lgkmcnt(4)
 v_mfma_f32_16x16x32_bf16 v[36:39], v[200:203], v[164:167], v[36:39]
 v_exp_f32 v242, v126
 v_mfma_f32_16x16x32_bf16 v[44:47], v[200:203], v[168:171], v[44:47]
 ds_read_b128 v[200:203], v233 offset:40960
 v_cvt_pk_bf16_f32 v176, v240, v241
 v_mfma_f32_16x16x32_bf16 v[40:43], v[204:207], v[164:167], v[40:43]
 v_exp_f32 v243, v127
 v_mfma_f32_16x16x32_bf16 v[48:51], v[204:207], v[168:171], v[48:51]
 ds_read_b128 v[204:207], v233 offset:41216
 v_mfma_f32_16x16x32_bf16 v[52:55], v[208:211], v[164:167], v[52:55]
 v_exp_f32 v240, v128
 v_mfma_f32_16x16x32_bf16 v[60:63], v[208:211], v[168:171], v[60:63]
 ds_read_b128 v[208:211], v233 offset:43008
 v_cvt_pk_bf16_f32 v177, v242, v243
 v_mfma_f32_16x16x32_bf16 v[56:59], v[212:215], v[164:167], v[56:59]
 v_exp_f32 v241, v129
 v_mfma_f32_16x16x32_bf16 v[64:67], v[212:215], v[168:171], v[64:67]
 ds_read_b128 v[212:215], v233 offset:43264
 s_waitcnt lgkmcnt(4)
 v_mfma_f32_16x16x32_bf16 v[68:71], v[216:219], v[164:167], v[68:71]
 v_exp_f32 v242, v130
 v_mfma_f32_16x16x32_bf16 v[76:79], v[216:219], v[168:171], v[76:79]
 ds_read_b128 v[216:219], v233 offset:45056
 v_cvt_pk_bf16_f32 v178, v240, v241
 v_mfma_f32_16x16x32_bf16 v[72:75], v[220:223], v[164:167], v[72:75]
 v_exp_f32 v243, v131
 v_mfma_f32_16x16x32_bf16 v[80:83], v[220:223], v[168:171], v[80:83]
 ds_read_b128 v[220:223], v233 offset:45312
 v_cvt_pk_bf16_f32 v179, v242, v243
 v_mfma_f32_16x16x32_bf16 v[84:87], v[224:227], v[164:167], v[84:87]
 v_mfma_f32_16x16x32_bf16 v[92:95], v[224:227], v[168:171], v[92:95]
 ds_read_b128 v[224:227], v233 offset:47104
 v_mfma_f32_16x16x32_bf16 v[88:91], v[228:231], v[164:167], v[88:91]
 v_mfma_f32_16x16x32_bf16 v[96:99], v[228:231], v[168:171], v[96:99]
 ds_read_b128 v[228:231], v233 offset:47360
 s_waitcnt lgkmcnt(4)
 v_mfma_f32_16x16x32_bf16 v[188:191], v[248:251], v[172:175], v[192:195]
 v_exp_f32 v240, v132
 v_exp_f32 v241, v133
 v_mfma_f32_16x16x32_bf16 v[188:191], v[252:255], v[176:179], v[188:191]
 v_exp_f32 v242, v134
 v_mfma_f32_16x16x32_bf16 v[148:151], v[200:203], v[4:7], v[180:183]
 v_cvt_pk_bf16_f32 v164, v240, v241
 v_exp_f32 v243, v135
 v_mfma_f32_16x16x32_bf16 v[156:159], v[200:203], v[8:11], v[184:187]
 ds_read_b128 v[200:203], v233 offset:18432
 v_exp_f32 v240, v136
 v_mfma_f32_16x16x32_bf16 v[152:155], v[204:207], v[4:7], v[180:183]
 v_cvt_pk_bf16_f32 v165, v242, v243
 v_exp_f32 v241, v137
 v_mfma_f32_16x16x32_bf16 v[160:163], v[204:207], v[8:11], v[184:187]
 ds_read_b128 v[204:207], v233 offset:18688
 v_exp_f32 v242, v138
 v_mfma_f32_16x16x32_bf16 v[148:151], v[208:211], v[12:15], v[148:151]
 v_cvt_pk_bf16_f32 v166, v240, v241
 v_exp_f32 v243, v139
 v_mfma_f32_16x16x32_bf16 v[156:159], v[208:211], v[16:19], v[156:159]
 ds_read_b128 v[208:211], v233 offset:22528
 v_exp_f32 v240, v140
 v_cmp_nge_f32 vcc, 0x53800000, v190
 s_cbranch_vccnz KB_RARE_B0B_1
KB_RET_B0B_1:
 v_mfma_f32_16x16x32_bf16 v[152:155], v[212:215], v[12:15], v[152:155]
 v_cvt_pk_bf16_f32 v167, v242, v243
 v_exp_f32 v241, v141
 v_mfma_f32_16x16x32_bf16 v[160:163], v[212:215], v[16:19], v[160:163]
 ds_read_b32 v238, v232
 ds_read_b128 v[212:215], v233 offset:22784
 s_waitcnt lgkmcnt(5)
 v_mfma_f32_16x16x32_bf16 v[148:151], v[216:219], v[20:23], v[148:151]
 v_exp_f32 v242, v142
 v_mfma_f32_16x16x32_bf16 v[156:159], v[216:219], v[24:27], v[156:159]
 ds_read_b128 v[216:219], v233 offset:26624
 v_cvt_pk_bf16_f32 v168, v240, v241
 v_mfma_f32_16x16x32_bf16 v[152:155], v[220:223], v[20:23], v[152:155]
 v_exp_f32 v243, v143
 v_mfma_f32_16x16x32_bf16 v[160:163], v[220:223], v[24:27], v[160:163]
 ds_read_b128 v[220:223], v233 offset:26880
 v_exp_f32 v240, v144
 v_mfma_f32_16x16x32_bf16 v[148:151], v[224:227], v[28:31], v[148:151]
 v_cvt_pk_bf16_f32 v169, v242, v243
 v_exp_f32 v241, v145
 v_mfma_f32_16x16x32_bf16 v[156:159], v[224:227], v[32:35], v[156:159]
 ds_read_b128 v[224:227], v233 offset:30720
 v_exp_f32 v242, v146
 v_mfma_f32_16x16x32_bf16 v[152:155], v[228:231], v[28:31], v[152:155]
 v_cvt_pk_bf16_f32 v170, v240, v241
 v_exp_f32 v243, v147
 v_mfma_f32_16x16x32_bf16 v[160:163], v[228:231], v[32:35], v[160:163]
 ds_read_b128 v[228:231], v233 offset:30976
 s_waitcnt lgkmcnt(4)
 v_mfma_f32_16x16x32_bf16 v[36:39], v[200:203], v[172:175], v[36:39]
 v_cmp_lt_u32 vcc, v238, v239
 s_cbranch_vccnz KB_SPIN_B0B
KB_SPR_B0B:
 v_mfma_f32_16x16x32_bf16 v[44:47], v[200:203], v[176:179], v[44:47]
 ds_read_b128 v[200:203], v233 offset:49152
 v_add_u32 v239, 1, v239
 ds_write_b32 v244, v239 offset:3072
 s_waitcnt vmcnt(0)
 ds_write_b32 v244, v239 offset:1024
 s_add_u32 s32, s32, 1
 s_mov_b32 m0, s35
 v_mfma_f32_16x16x32_bf16 v[40:43], v[204:207], v[172:175], v[40:43]
 v_cvt_pk_bf16_f32 v171, v242, v243
 v_mfma_f32_16x16x32_bf16 v[48:51], v[204:207], v[176:179], v[48:51]
 ds_read_b128 v[204:207], v233 offset:49408
 buffer_load_dwordx4 v197, s[12:15], s31 offen offset:0 sc1 lds
 v_cmp_gt_i32 s[44:45], 0, v245
 v_cmp_gt_i32 s[46:47], 1, v245
 v_cmp_gt_i32 s[48:49], 2, v245
 v_mfma_f32_16x16x32_bf16 v[52:55], v[208:211], v[172:175], v[52:55]
 v_cmp_gt_i32 s[50:51], 3, v245
 v_cndmask_b32 v148, v148, v246, s[44:45]
 v_cndmask_b32 v149, v149, v246, s[46:47]
 v_mfma_f32_16x16x32_bf16 v[60:63], v[208:211], v[176:179], v[60:63]
 ds_read_b128 v[208:211], v233 offset:53248
 buffer_load_dwordx4 v197, s[12:15], s31 offen offset:1024 sc1 lds
 v_cndmask_b32 v150, v150, v246, s[48:49]
 v_cndmask_b32 v151, v151, v246, s[50:51]
 v_mfma_f32_16x16x32_bf16 v[56:59], v[212:215], v[172:175], v[56:59]
 v_cmp_gt_i32 s[44:45], 8, v245
 v_cmp_gt_i32 s[46:47], 9, v245
 v_cmp_gt_i32 s[48:49], 10, v245
 v_mfma_f32_16x16x32_bf16 v[64:67], v[212:215], v[176:179], v[64:67]
 ds_read_b128 v[212:215], v233 offset:53504
 buffer_load_dwordx4 v197, s[12:15], s31 offen offset:2048 sc1 lds
 s_waitcnt lgkmcnt(6)
 v_mfma_f32_16x16x32_bf16 v[68:71], v[216:219], v[172:175], v[68:71]
 v_cmp_gt_i32 s[50:51], 11, v245
 v_cndmask_b32 v152, v152, v246, s[44:45]
 v_cndmask_b32 v153, v153, v246, s[46:47]
 v_mfma_f32_16x16x32_bf16 v[76:79], v[216:219], v[176:179], v[76:79]
 ds_read_b128 v[216:219], v233 offset:57344
 buffer_load_dwordx4 v197, s[12:15], s31 offen offset:3072 sc1 lds
 s_add_u32 s31, s31, 16384
 s_add_u32 s35, s35, 32768
 s_and_b32 s35, s35, 0x1ffff
 v_cndmask_b32 v154, v154, v246, s[48:49]
 v_cndmask_b32 v155, v155, v246, s[50:51]
 v_mfma_f32_16x16x32_bf16 v[72:75], v[220:223], v[172:175], v[72:75]
 v_cmp_gt_i32 s[44:45], -16, v245
 v_cmp_gt_i32 s[46:47], -15, v245
 v_cmp_gt_i32 s[48:49], -14, v245
 v_mfma_f32_16x16x32_bf16 v[80:83], v[220:223], v[176:179], v[80:83]
 ds_read_b128 v[220:223], v233 offset:57600
 s_mov_b32 m0, s36
 s_nop 0
 buffer_load_dwordx4 v197, s[16:19], s33 offen offset:0 sc1 lds
 v_cmp_gt_i32 s[50:51], -13, v245
 v_mfma_f32_16x16x32_bf16 v[84:87], v[224:227], v[172:175], v[84:87]
 v_cndmask_b32 v156, v156, v246, s[44:45]
 v_cndmask_b32 v157, v157, v246, s[46:47]
 v_cndmask_b32 v158, v158, v246, s[48:49]
 v_mfma_f32_16x16x32_bf16 v[92:95], v[224:227], v[176:179], v[92:95]
 ds_read_b128 v[224:227], v233 offset:61440
 buffer_load_dwordx4 v197, s[16:19], s33 offen offset:1024 sc1 lds
 v_cndmask_b32 v159, v159, v246, s[50:51]
 v_cmp_gt_i32 s[44:45], -8, v245
 v_mfma_f32_16x16x32_bf16 v[88:91], v[228:231], v[172:175], v[88:91]
 v_cmp_gt_i32 s[46:47], -7, v245
 v_cmp_gt_i32 s[48:49], -6, v245
 v_cmp_gt_i32 s[50:51], -5, v245
 v_mfma_f32_16x16x32_bf16 v[96:99], v[228:231], v[176:179], v[96:99]
 ds_read_b128 v[228:231], v233 offset:61696
 buffer_load_dwordx4 v197, s[16:19], s33 offen offset:2048 sc1 lds
 s_waitcnt lgkmcnt(4)
 v_cndmask_b32 v160, v160, v246, s[44:45]
 v_cndmask_b32 v161, v161, v246, s[46:47]
 v_cndmask_b32 v162, v162, v246, s[48:49]
 v_cndmask_b32 v163, v163, v246, s[50:51]
 buffer_load_dwordx4 v197, s[16:19], s33 offen offset:3072 sc1 lds
 s_add_u32 s33, s33, 16384
 s_add_u32 s36, s36, 32768
 s_and_b32 s36, s36, 0x1ffff
 ds_write_b32 v244, v239
 v_mfma_f32_16x16x32_bf16 v[192:195], v[248:251], v[164:167], v[188:191]
 v_exp_f32 v240, v148
 v_exp_f32 v241, v149
 v_mfma_f32_16x16x32_bf16 v[192:195], v[252:255], v[168:171], v[192:195]
 v_exp_f32 v242, v150
 v_cvt_pk_bf16_f32 v172, v240, v241
 v_exp_f32 v243, v151
 v_exp_f32 v240, v152
 v_cvt_pk_bf16_f32 v173, v242, v243
 v_exp_f32 v241, v153
 s_nop 1
 v_cmp_nge_f32 vcc, 0x53800000, v194
 s_cbranch_vccnz KB_RARE_DB1B_0
KB_RET_DB1B_0:
 v_mfma_f32_16x16x32_bf16 v[36:39], v[200:203], v[164:167], v[36:39]
 v_exp_f32 v242, v154
 v_mfma_f32_16x16x32_bf16 v[44:47], v[200:203], v[168:171], v[44:47]
 ds_read_b128 v[200:203], v233 offset:51200
 v_cvt_pk_bf16_f32 v174, v240, v241
 v_mfma_f32_16x16x32_bf16 v[40:43], v[204:207], v[164:167], v[40:43]
 v_exp_f32 v243, v155
 v_mfma_f32_16x16x32_bf16 v[48:51], v[204:207], v[168:171], v[48:51]
 ds_read_b128 v[204:207], v233 offset:51456
 v_exp_f32 v240, v156
 v_mfma_f32_16x16x32_bf16 v[52:55], v[208:211], v[164:167], v[52:55]
 v_cvt_pk_bf16_f32 v175, v242, v243
 v_exp_f32 v241, v157
 v_mfma_f32_16x16x32_bf16 v[60:63], v[208:211], v[168:171], v[60:63]
 ds_read_b128 v[208:211], v233 offset:55296
 v_exp_f32 v242, v158
 v_mfma_f32_16x16x32_bf16 v[56:59], v[212:215], v[164:167], v[56:59]
 v_cvt_pk_bf16_f32 v176, v240, v241
 v_exp_f32 v243, v159
 v_mfma_f32_16x16x32_bf16 v[64:67], v[212:215], v[168:171], v[64:67]
 ds_read_b32 v238, v232
 ds_read_b128 v[212:215], v233 offset:55552
 s_waitcnt lgkmcnt(6)
 v_mfma_f32_16x16x32_bf16 v[68:71], v[216:219], v[164:167], v[68:71]
 v_exp_f32 v240, v160
 v_mfma_f32_16x16x32_bf16 v[76:79], v[216:219], v[168:171], v[76:79]
 ds_read_b128 v[216:219], v233 offset:59392
 v_cvt_pk_bf16_f32 v177, v242, v243
 v_mfma_f32_16x16x32_bf16 v[72:75], v[220:223], v[164:167], v[72:75]
 v_exp_f32 v241, v161
 v_mfma_f32_16x16x32_bf16 v[80:83], v[220:223], v[168:171], v[80:83]
 ds_read_b128 v[220:223], v233 offset:59648
 v_exp_f32 v242, v162
 v_mfma_f32_16x16x32_bf16 v[84:87], v[224:227], v[164:167], v[84:87]
 v_cvt_pk_bf16_f32 v178, v240, v241
 v_exp_f32 v243, v163
 v_mfma_f32_16x16x32_bf16 v[92:95], v[224:227], v[168:171], v[92:95]
 ds_read_b128 v[224:227], v233 offset:63488
 v_cvt_pk_bf16_f32 v179, v242, v243
 v_mfma_f32_16x16x32_bf16 v[88:91], v[228:231], v[164:167], v[88:91]
 v_mfma_f32_16x16x32_bf16 v[96:99], v[228:231], v[168:171], v[96:99]
 ds_read_b128 v[228:231], v233 offset:63744
 v_swap_b32 v233, v234
 s_waitcnt lgkmcnt(4)
 v_mfma_f32_16x16x32_bf16 v[188:191], v[248:251], v[172:175], v[192:195]
 v_cmp_lt_u32 vcc, v238, v239
 s_cbranch_vccnz KB_SPIN_DB1B
KB_SPR_DB1B:
 s_nop 3
 v_mfma_f32_16x16x32_bf16 v[188:191], v[252:255], v[176:179], v[188:191]
 s_nop 7
 v_cmp_nge_f32 vcc, 0x53800000, v190
 s_cbranch_vccnz KB_RARE_DB1B_1
KB_RET_DB1B_1:
 v_mfma_f32_16x16x32_bf16 v[36:39], v[200:203], v[172:175], v[36:39]
 v_mfma_f32_16x16x32_bf16 v[44:47], v[200:203], v[176:179], v[44:47]
 v_add_u32 v239, 1, v239
 ds_write_b32 v244, v239 offset:3072
 s_waitcnt vmcnt(0)
 ds_write_b32 v244, v239 offset:1024
 s_add_u32 s32, s32, 1
 s_mov_b32 m0, s35
 v_mfma_f32_16x16x32_bf16 v[40:43], v[204:207], v[172:175], v[40:43]
 v_mfma_f32_16x16x32_bf16 v[48:51], v[204:207], v[176:179], v[48:51]
 buffer_load_dwordx4 v197, s[12:15], s31 offen offset:0 sc1 lds
 v_mfma_f32_16x16x32_bf16 v[52:55], v[208:211], v[172:175], v[52:55]
 v_mfma_f32_16x16x32_bf16 v[60:63], v[208:211], v[176:179], v[60:63]
 buffer_load_dwordx4 v197, s[12:15], s31 offen offset:1024 sc1 lds
 v_mfma_f32_16x16x32_bf16 v[56:59], v[212:215], v[172:175], v[56:59]
 v_mfma_f32_16x16x32_bf16 v[64:67], v[212:215], v[176:179], v[64:67]
 buffer_load_dwordx4 v197, s[12:15], s31 offen offset:2048 sc1 lds
 s_waitcnt lgkmcnt(2)
 v_mfma_f32_16x16x32_bf16 v[68:71], v[216:219], v[172:175], v[68:71]
 v_mfma_f32_16x16x32_bf16 v[76:79], v[216:219], v[176:179], v[76:79]
 buffer_load_dwordx4 v197, s[12:15], s31 offen offset:3072 sc1 lds
 s_add_u32 s31, s31, 16384
 s_add_u32 s35, s35, 32768
 s_and_b32 s35, s35, 0x1ffff
 v_mfma_f32_16x16x32_bf16 v[72:75], v[220:223], v[172:175], v[72:75]
 v_mfma_f32_16x16x32_bf16 v[80:83], v[220:223], v[176:179], v[80:83]
 s_mov_b32 m0, s36
 s_nop 0
 buffer_load_dwordx4 v197, s[16:19], s33 offen offset:0 sc1 lds
 v_mfma_f32_16x16x32_bf16 v[84:87], v[224:227], v[172:175], v[84:87]
 v_mfma_f32_16x16x32_bf16 v[92:95], v[224:227], v[176:179], v[92:95]
 buffer_load_dwordx4 v197, s[16:19], s33 offen offset:1024 sc1 lds
 v_mfma_f32_16x16x32_bf16 v[88:91], v[228:231], v[172:175], v[88:91]
 v_mfma_f32_16x16x32_bf16 v[96:99], v[228:231], v[176:179], v[96:99]
 buffer_load_dwordx4 v197, s[16:19], s33 offen offset:2048 sc1 lds
 buffer_load_dwordx4 v197, s[16:19], s33 offen offset:3072 sc1 lds
 s_add_u32 s33, s33, 16384
 s_add_u32 s36, s36, 32768
 s_and_b32 s36, s36, 0x1ffff
KB_FINALB:
 v_mov_b32 v237, 0x7fffffff
 ds_write_b32 v244, v237
 ds_write_b32 v244, v237 offset:3072
 v_rcp_f32 v237, v188
 v_rcp_f32 v240, v189
 v_fma_f32 v238, -v188, v237, 1.0
 v_fma_f32 v241, -v189, v240, 1.0
 v_fma_f32 v237, v238, v237, v237
 v_fma_f32 v240, v241, v240, v240
 s_lshl_b32 s41, s26, 2
 s_add_u32 s41, s41, s24
 s_mul_i32 s41, s41, 266496
 s_lshl_b32 s42, s25, 13
 s_add_u32 s41, s41, s42
 s_add_u32 s42, s41, 4096
 v_mul_f32 v36, v36, v237
 v_mul_f32 v37, v37, v237
 v_mul_f32 v38, v38, v237
 v_mul_f32 v39, v39, v237
 v_mul_f32 v40, v40, v237
 v_mul_f32 v41, v41, v237
 v_mul_f32 v42, v42, v237
 v_mul_f32 v43, v43, v237
 v_cvt_pk_bf16_f32 v100, v36, v37
 v_cvt_pk_bf16_f32 v101, v38, v39
 v_cvt_pk_bf16_f32 v102, v40, v41
 v_cvt_pk_bf16_f32 v103, v42, v43
 buffer_store_dwordx4 v[100:103], v196, s[20:23], s41 offen offset:0 sc1
 v_mul_f32 v44, v44, v240
 v_mul_f32 v45, v45, v240
 v_mul_f32 v46, v46, v240
 v_mul_f32 v47, v47, v240
 v_mul_f32 v48, v48, v240
 v_mul_f32 v49, v49, v240
 v_mul_f32 v50, v50, v240
 v_mul_f32 v51, v51, v240
 v_cvt_pk_bf16_f32 v104, v44, v45
 v_cvt_pk_bf16_f32 v105, v46, v47
 v_cvt_pk_bf16_f32 v106, v48, v49
 v_cvt_pk_bf16_f32 v107, v50, v51
 buffer_store_dwordx4 v[104:107], v196, s[20:23], s41 offen offset:256 sc1
 v_mul_f32 v52, v52, v237
 v_mul_f32 v53, v53, v237
 v_mul_f32 v54, v54, v237
 v_mul_f32 v55, v55, v237
 v_mul_f32 v56, v56, v237
 v_mul_f32 v57, v57, v237
 v_mul_f32 v58, v58, v237
 v_mul_f32 v59, v59, v237
 v_cvt_pk_bf16_f32 v108, v52, v53
 v_cvt_pk_bf16_f32 v109, v54, v55
 v_cvt_pk_bf16_f32 v110, v56, v57
 v_cvt_pk_bf16_f32 v111, v58, v59
 buffer_store_dwordx4 v[108:111], v196, s[20:23], s41 offen offset:2048 sc1
 v_mul_f32 v60, v60, v240
 v_mul_f32 v61, v61, v240
 v_mul_f32 v62, v62, v240
 v_mul_f32 v63, v63, v240
 v_mul_f32 v64, v64, v240
 v_mul_f32 v65, v65, v240
 v_mul_f32 v66, v66, v240
 v_mul_f32 v67, v67, v240
 v_cvt_pk_bf16_f32 v112, v60, v61
 v_cvt_pk_bf16_f32 v113, v62, v63
 v_cvt_pk_bf16_f32 v114, v64, v65
 v_cvt_pk_bf16_f32 v115, v66, v67
 buffer_store_dwordx4 v[112:115], v196, s[20:23], s41 offen offset:2304 sc1
 v_mul_f32 v68, v68, v237
 v_mul_f32 v69, v69, v237
 v_mul_f32 v70, v70, v237
 v_mul_f32 v71, v71, v237
 v_mul_f32 v72, v72, v237
 v_mul_f32 v73, v73, v237
 v_mul_f32 v74, v74, v237
 v_mul_f32 v75, v75, v237
 v_cvt_pk_bf16_f32 v116, v68, v69
 v_cvt_pk_bf16_f32 v117, v70, v71
 v_cvt_pk_bf16_f32 v118, v72, v73
 v_cvt_pk_bf16_f32 v119, v74, v75
 buffer_store_dwordx4 v[116:119], v196, s[20:23], s42 offen offset:0 sc1
 v_mul_f32 v76, v76, v240
 v_mul_f32 v77, v77, v240
 v_mul_f32 v78, v78, v240
 v_mul_f32 v79, v79, v240
 v_mul_f32 v80, v80, v240
 v_mul_f32 v81, v81, v240
 v_mul_f32 v82, v82, v240
 v_mul_f32 v83, v83, v240
 v_cvt_pk_bf16_f32 v120, v76, v77
 v_cvt_pk_bf16_f32 v121, v78, v79
 v_cvt_pk_bf16_f32 v122, v80, v81
 v_cvt_pk_bf16_f32 v123, v82, v83
 buffer_store_dwordx4 v[120:123], v196, s[20:23], s42 offen offset:256 sc1
 v_mul_f32 v84, v84, v237
 v_mul_f32 v85, v85, v237
 v_mul_f32 v86, v86, v237
 v_mul_f32 v87, v87, v237
 v_mul_f32 v88, v88, v237
 v_mul_f32 v89, v89, v237
 v_mul_f32 v90, v90, v237
 v_mul_f32 v91, v91, v237
 v_cvt_pk_bf16_f32 v124, v84, v85
 v_cvt_pk_bf16_f32 v125, v86, v87
 v_cvt_pk_bf16_f32 v126, v88, v89
 v_cvt_pk_bf16_f32 v127, v90, v91
 buffer_store_dwordx4 v[124:127], v196, s[20:23], s42 offen offset:2048 sc1
 v_mul_f32 v92, v92, v240
 v_mul_f32 v93, v93, v240
 v_mul_f32 v94, v94, v240
 v_mul_f32 v95, v95, v240
 v_mul_f32 v96, v96, v240
 v_mul_f32 v97, v97, v240
 v_mul_f32 v98, v98, v240
 v_mul_f32 v99, v99, v240
 v_cvt_pk_bf16_f32 v128, v92, v93
 v_cvt_pk_bf16_f32 v129, v94, v95
 v_cvt_pk_bf16_f32 v130, v96, v97
 v_cvt_pk_bf16_f32 v131, v98, v99
 buffer_store_dwordx4 v[128:131], v196, s[20:23], s42 offen offset:2304 sc1
 s_branch KB_LOADER
KB_X0AB:
 ds_write_b32 v244, v239
 v_mfma_f32_16x16x32_bf16 v[192:195], v[248:251], v[164:167], v[188:191]
 v_exp_f32 v240, v116
 v_mfma_f32_16x16x32_bf16 v[192:195], v[252:255], v[168:171], v[192:195]
 v_exp_f32 v241, v117
 v_mfma_f32_16x16x32_bf16 v[132:135], v[200:203], v[4:7], v[180:183]
 v_exp_f32 v242, v118
 v_mfma_f32_16x16x32_bf16 v[140:143], v[200:203], v[8:11], v[184:187]
 ds_read_b128 v[200:203], v233 offset:16384
 v_cvt_pk_bf16_f32 v172, v240, v241
 v_mfma_f32_16x16x32_bf16 v[136:139], v[204:207], v[4:7], v[180:183]
 v_exp_f32 v243, v119
 v_mfma_f32_16x16x32_bf16 v[144:147], v[204:207], v[8:11], v[184:187]
 ds_read_b128 v[204:207], v233 offset:16640
 v_mfma_f32_16x16x32_bf16 v[132:135], v[208:211], v[12:15], v[132:135]
 v_exp_f32 v240, v120
 v_mfma_f32_16x16x32_bf16 v[140:143], v[208:211], v[16:19], v[140:143]
 ds_read_b128 v[208:211], v233 offset:20480
 v_cvt_pk_bf16_f32 v173, v242, v243
 v_cmp_nge_f32 vcc, 0x53800000, v194
 s_cbranch_vccnz KB_RARE_A0B_0
KB_RET_A0B_0:
 v_mfma_f32_16x16x32_bf16 v[136:139], v[212:215], v[12:15], v[136:139]
 v_exp_f32 v241, v121
 v_mfma_f32_16x16x32_bf16 v[144:147], v[212:215], v[16:19], v[144:147]
 ds_read_b128 v[212:215], v233 offset:20736
 s_waitcnt lgkmcnt(5)
 v_mfma_f32_16x16x32_bf16 v[132:135], v[216:219], v[20:23], v[132:135]
 v_exp_f32 v242, v122
 v_mfma_f32_16x16x32_bf16 v[140:143], v[216:219], v[24:27], v[140:143]
 ds_read_b128 v[216:219], v233 offset:24576
 v_cvt_pk_bf16_f32 v174, v240, v241
 v_mfma_f32_16x16x32_bf16 v[136:139], v[220:223], v[20:23], v[136:139]
 v_exp_f32 v243, v123
 v_mfma_f32_16x16x32_bf16 v[144:147], v[220:223], v[24:27], v[144:147]
 ds_read_b128 v[220:223], v233 offset:24832
 v_mfma_f32_16x16x32_bf16 v[132:135], v[224:227], v[28:31], v[132:135]
 v_exp_f32 v240, v124
 v_mfma_f32_16x16x32_bf16 v[140:143], v[224:227], v[32:35], v[140:143]
 ds_read_b128 v[224:227], v233 offset:28672
 v_cvt_pk_bf16_f32 v175, v242, v243
 v_mfma_f32_16x16x32_bf16 v[136:139], v[228:231], v[28:31], v[136:139]
 v_exp_f32 v241, v125
 v_mfma_f32_16x16x32_bf16 v[144:147], v[228:231], v[32:35], v[144:147]
 ds_read_b128 v[228:231], v233 offset:28928
 s_waitcnt lgkmcnt(4)
 v_mfma_f32_16x16x32_bf16 v[36:39], v[200:203], v[164:167], v[36:39]
 v_exp_f32 v242, v126
 v_mfma_f32_16x16x32_bf16 v[44:47], v[200:203], v[168:171], v[44:47]
 ds_read_b128 v[200:203], v233 offset:18432
 v_cvt_pk_bf16_f32 v176, v240, v241
 v_mfma_f32_16x16x32_bf16 v[40:43], v[204:207], v[164:167], v[40:43]
 v_exp_f32 v243, v127
 v_mfma_f32_16x16x32_bf16 v[48:51], v[204:207], v[168:171], v[48:51]
 ds_read_b128 v[204:207], v233 offset:18688
 v_mfma_f32_16x16x32_bf16 v[52:55], v[208:211], v[164:167], v[52:55]
 v_exp_f32 v240, v128
 v_mfma_f32_16x16x32_bf16 v[60:63], v[208:211], v[168:171], v[60:63]
 ds_read_b128 v[208:211], v233 offset:22528
 v_cvt_pk_bf16_f32 v177, v242, v243
 v_mfma_f32_16x16x32_bf16 v[56:59], v[212:215], v[164:167], v[56:59]
 v_exp_f32 v241, v129
 v_mfma_f32_16x16x32_bf16 v[64:67], v[212:215], v[168:171], v[64:67]
 ds_read_b32 v238, v232
 ds_read_b128 v[212:215], v233 offset:22784
 s_waitcnt lgkmcnt(5)
 v_mfma_f32_16x16x32_bf16 v[68:71], v[216:219], v[164:167], v[68:71]
 v_exp_f32 v242, v130
 v_mfma_f32_16x16x32_bf16 v[76:79], v[216:219], v[168:171], v[76:79]
 ds_read_b128 v[216:219], v233 offset:26624
 v_cvt_pk_bf16_f32 v178, v240, v241
 v_mfma_f32_16x16x32_bf16 v[72:75], v[220:223], v[164:167], v[72:75]
 v_exp_f32 v243, v131
 v_mfma_f32_16x16x32_bf16 v[80:83], v[220:223], v[168:171], v[80:83]
 ds_read_b128 v[220:223], v233 offset:26880
 v_cvt_pk_bf16_f32 v179, v242, v243
 v_mfma_f32_16x16x32_bf16 v[84:87], v[224:227], v[164:167], v[84:87]
 v_mfma_f32_16x16x32_bf16 v[92:95], v[224:227], v[168:171], v[92:95]
 ds_read_b128 v[224:227], v233 offset:30720
 v_mfma_f32_16x16x32_bf16 v[88:91], v[228:231], v[164:167], v[88:91]
 v_mfma_f32_16x16x32_bf16 v[96:99], v[228:231], v[168:171], v[96:99]
 ds_read_b128 v[228:231], v233 offset:30976
 s_waitcnt lgkmcnt(4)
 v_mfma_f32_16x16x32_bf16 v[188:191], v[248:251], v[172:175], v[192:195]
 v_cmp_lt_u32 vcc, v238, v239
 s_cbranch_vccnz KB_SPIN_A0B
KB_SPR_A0B:
 v_cmp_gt_i32 s[44:45], 0, v245
 v_cmp_gt_i32 s[46:47], 1, v245
 v_cmp_gt_i32 s[48:49], 2, v245
 s_nop 0
 v_mfma_f32_16x16x32_bf16 v[188:191], v[252:255], v[176:179], v[188:191]
 v_cmp_gt_i32 s[50:51], 3, v245
 v_cndmask_b32 v132, v132, v246, s[44:45]
 v_cndmask_b32 v133, v133, v246, s[46:47]
 v_cndmask_b32 v134, v134, v246, s[48:49]
 v_cndmask_b32 v135, v135, v246, s[50:51]
 s_nop 2
 v_cmp_nge_f32 vcc, 0x53800000, v190
 s_cbranch_vccnz KB_RARE_A0B_1
KB_RET_A0B_1:
 v_mfma_f32_16x16x32_bf16 v[36:39], v[200:203], v[172:175], v[36:39]
 v_cmp_gt_i32 s[44:45], 8, v245
 v_cmp_gt_i32 s[46:47], 9, v245
 v_mfma_f32_16x16x32_bf16 v[44:47], v[200:203], v[176:179], v[44:47]
 ds_read_b128 v[200:203], v233 offset:49152
 v_add_u32 v239, 1, v239
 ds_write_b32 v244, v239 offset:3072
 s_waitcnt vmcnt(0)
 ds_write_b32 v244, v239 offset:1024
 s_add_u32 s32, s32, 1
 s_mov_b32 m0, s35
 v_cmp_gt_i32 s[48:49], 10, v245
 v_cmp_gt_i32 s[50:51], 11, v245
 v_cndmask_b32 v136, v136, v246, s[44:45]
 v_mfma_f32_16x16x32_bf16 v[40:43], v[204:207], v[172:175], v[40:43]
 v_cndmask_b32 v137, v137, v246, s[46:47]
 v_cndmask_b32 v138, v138, v246, s[48:49]
 v_cndmask_b32 v139, v139, v246, s[50:51]
 v_cmp_gt_i32 s[44:45], -16, v245
 v_cmp_gt_i32 s[46:47], -15, v245
 v_mfma_f32_16x16x32_bf16 v[48:51], v[204:207], v[176:179], v[48:51]
 ds_read_b128 v[204:207], v233 offset:49408
 buffer_load_dwordx4 v197, s[12:15], s31 offen offset:0 sc1 lds
 v_cmp_gt_i32 s[48:49], -14, v245
 v_cmp_gt_i32 s[50:51], -13, v245
 v_cndmask_b32 v140, v140, v246, s[44:45]
 v_mfma_f32_16x16x32_bf16 v[52:55], v[208:211], v[172:175], v[52:55]
 v_cndmask_b32 v141, v141, v246, s[46:47]
 v_cndmask_b32 v142, v142, v246, s[48:49]
 v_cndmask_b32 v143, v143, v246, s[50:51]
 v_cmp_gt_i32 s[44:45], -8, v245
 v_cmp_gt_i32 s[46:47], -7, v245
 v_mfma_f32_16x16x32_bf16 v[60:63], v[208:211], v[176:179], v[60:63]
 ds_read_b128 v[208:211], v233 offset:53248
 buffer_load_dwordx4 v197, s[12:15], s31 offen offset:1024 sc1 lds
 v_cmp_gt_i32 s[48:49], -6, v245
 v_cmp_gt_i32 s[50:51], -5, v245
 v_cndmask_b32 v144, v144, v246, s[44:45]
 v_cndmask_b32 v145, v145, v246, s[46:47]
 v_mfma_f32_16x16x32_bf16 v[56:59], v[212:215], v[172:175], v[56:59]
 v_cndmask_b32 v146, v146, v246, s[48:49]
 v_cndmask_b32 v147, v147, v246, s[50:51]
 v_exp_f32 v240, v132
 v_mfma_f32_16x16x32_bf16 v[64:67], v[212:215], v[176:179], v[64:67]
 ds_read_b128 v[212:215], v233 offset:53504
 buffer_load_dwordx4 v197, s[12:15], s31 offen offset:2048 sc1 lds
 v_exp_f32 v241, v133
 v_exp_f32 v242, v134
 s_waitcnt lgkmcnt(6)
 v_mfma_f32_16x16x32_bf16 v[68:71], v[216:219], v[172:175], v[68:71]
 v_cvt_pk_bf16_f32 v164, v240, v241
 v_exp_f32 v243, v135
 v_exp_f32 v240, v136
 v_mfma_f32_16x16x32_bf16 v[76:79], v[216:219], v[176:179], v[76:79]
 ds_read_b128 v[216:219], v233 offset:57344
 buffer_load_dwordx4 v197, s[12:15], s31 offen offset:3072 sc1 lds
 s_add_u32 s31, s31, 16384
 s_add_u32 s35, s35, 32768
 s_and_b32 s35, s35, 0x1ffff
 v_cvt_pk_bf16_f32 v165, v242, v243
 v_exp_f32 v241, v137
 v_mfma_f32_16x16x32_bf16 v[72:75], v[220:223], v[172:175], v[72:75]
 v_exp_f32 v242, v138
 v_cvt_pk_bf16_f32 v166, v240, v241
 v_exp_f32 v243, v139
 v_mfma_f32_16x16x32_bf16 v[80:83], v[220:223], v[176:179], v[80:83]
 ds_read_b128 v[220:223], v233 offset:57600
 s_mov_b32 m0, s36
 s_nop 0
 buffer_load_dwordx4 v197, s[16:19], s33 offen offset:0 sc1 lds
 v_exp_f32 v240, v140
 v_cvt_pk_bf16_f32 v167, v242, v243
 v_mfma_f32_16x16x32_bf16 v[84:87], v[224:227], v[172:175], v[84:87]
 v_exp_f32 v241, v141
 v_exp_f32 v242, v142
 v_mfma_f32_16x16x32_bf16 v[92:95], v[224:227], v[176:179], v[92:95]
 ds_read_b128 v[224:227], v233 offset:61440
 buffer_load_dwordx4 v197, s[16:19], s33 offen offset:1024 sc1 lds
 v_cvt_pk_bf16_f32 v168, v240, v241
 v_exp_f32 v243, v143
 v_exp_f32 v240, v144
 v_mfma_f32_16x16x32_bf16 v[88:91], v[228:231], v[172:175], v[88:91]
 v_cvt_pk_bf16_f32 v169, v242, v243
 v_exp_f32 v241, v145
 v_exp_f32 v242, v146
 v_mfma_f32_16x16x32_bf16 v[96:99], v[228:231], v[176:179], v[96:99]
 ds_read_b128 v[228:231], v233 offset:61696
 buffer_load_dwordx4 v197, s[16:19], s33 offen offset:2048 sc1 lds
 v_cvt_pk_bf16_f32 v170, v240, v241
 s_waitcnt lgkmcnt(4)
 v_exp_f32 v243, v147
 s_nop 0
 v_cvt_pk_bf16_f32 v171, v242, v243
 buffer_load_dwordx4 v197, s[16:19], s33 offen offset:3072 sc1 lds
 s_add_u32 s33, s33, 16384
 s_add_u32 s36, s36, 32768
 s_and_b32 s36, s36, 0x1ffff
 ds_write_b32 v244, v239
 v_swap_b32 v233, v234
 v_mfma_f32_16x16x32_bf16 v[192:195], v[248:251], v[164:167], v[188:191]
 v_mfma_f32_16x16x32_bf16 v[192:195], v[252:255], v[168:171], v[192:195]
 s_nop 7
 v_cmp_nge_f32 vcc, 0x53800000, v194
 s_cbranch_vccnz KB_RARE_DA1B_0
KB_RET_DA1B_0:
 v_mfma_f32_16x16x32_bf16 v[36:39], v[200:203], v[164:167], v[36:39]
 v_mfma_f32_16x16x32_bf16 v[44:47], v[200:203], v[168:171], v[44:47]
 ds_read_b32 v238, v232
 v_mfma_f32_16x16x32_bf16 v[40:43], v[204:207], v[164:167], v[40:43]
 v_mfma_f32_16x16x32_bf16 v[48:51], v[204:207], v[168:171], v[48:51]
 v_mfma_f32_16x16x32_bf16 v[52:55], v[208:211], v[164:167], v[52:55]
 v_mfma_f32_16x16x32_bf16 v[60:63], v[208:211], v[168:171], v[60:63]
 v_mfma_f32_16x16x32_bf16 v[56:59], v[212:215], v[164:167], v[56:59]
 v_mfma_f32_16x16x32_bf16 v[64:67], v[212:215], v[168:171], v[64:67]
 s_waitcnt lgkmcnt(0)
 v_mfma_f32_16x16x32_bf16 v[68:71], v[216:219], v[164:167], v[68:71]
 v_cmp_lt_u32 vcc, v238, v239
 s_cbranch_vccnz KB_SPIN_DA1B
KB_SPR_DA1B:
 v_mfma_f32_16x16x32_bf16 v[76:79], v[216:219], v[168:171], v[76:79]
 v_add_u32 v239, 1, v239
 ds_write_b32 v244, v239 offset:3072
 s_waitcnt vmcnt(0)
 ds_write_b32 v244, v239 offset:1024
 s_add_u32 s32, s32, 1
 s_mov_b32 m0, s35
 v_mfma_f32_16x16x32_bf16 v[72:75], v[220:223], v[164:167], v[72:75]
 v_mfma_f32_16x16x32_bf16 v[80:83], v[220:223], v[168:171], v[80:83]
 buffer_load_dwordx4 v197, s[12:15], s31 offen offset:0 sc1 lds
 v_mfma_f32_16x16x32_bf16 v[84:87], v[224:227], v[164:167], v[84:87]
 v_mfma_f32_16x16x32_bf16 v[92:95], v[224:227], v[168:171], v[92:95]
 buffer_load_dwordx4 v197, s[12:15], s31 offen offset:1024 sc1 lds
 v_mfma_f32_16x16x32_bf16 v[88:91], v[228:231], v[164:167], v[88:91]
 v_mfma_f32_16x16x32_bf16 v[96:99], v[228:231], v[168:171], v[96:99]
 buffer_load_dwordx4 v197, s[12:15], s31 offen offset:2048 sc1 lds
 buffer_load_dwordx4 v197, s[12:15], s31 offen offset:3072 sc1 lds
 s_add_u32 s31, s31, 16384
 s_add_u32 s35, s35, 32768
 s_and_b32 s35, s35, 0x1ffff
 s_mov_b32 m0, s36
 s_nop 0
 buffer_load_dwordx4 v197, s[16:19], s33 offen offset:0 sc1 lds
 buffer_load_dwordx4 v197, s[16:19], s33 offen offset:1024 sc1 lds
 buffer_load_dwordx4 v197, s[16:19], s33 offen offset:2048 sc1 lds
 buffer_load_dwordx4 v197, s[16:19], s33 offen offset:3072 sc1 lds
 s_add_u32 s33, s33, 16384
 s_add_u32 s36, s36, 32768
 s_and_b32 s36, s36, 0x1ffff
 v_mov_b32 v188, v192
 v_mov_b32 v189, v193
 s_branch KB_FINALB
KB_T0B:
 s_cmp_lt_u32 s24, 2
 s_cbranch_scc0 KB_X0B
 ds_read_b128 v[200:203], v233 offset:16384
 ds_read_b128 v[204:207], v233 offset:16640
 ds_read_b128 v[208:211], v233 offset:20480
 ds_read_b128 v[212:215], v233 offset:20736
 ds_read_b128 v[216:219], v233 offset:24576
 ds_read_b128 v[220:223], v233 offset:24832
 ds_read_b128 v[224:227], v233 offset:28672
 ds_read_b128 v[228:231], v233 offset:28928
 s_waitcnt lgkmcnt(4)
 s_bitcmp1_b32 s24, 0
 s_cbranch_scc0 KB_D0AB
 s_branch KB_D0BB
KB_X1B:
 s_bitcmp1_b32 s24, 0
 s_cbranch_scc0 KB_X1AB
 ds_write_b32 v244, v239
 v_mfma_f32_16x16x32_bf16 v[192:195], v[248:251], v[164:167], v[188:191]
 v_exp_f32 v240, v148
 v_mfma_f32_16x16x32_bf16 v[192:195], v[252:255], v[168:171], v[192:195]
 v_exp_f32 v241, v149
 v_mfma_f32_16x16x32_bf16 v[100:103], v[200:203], v[4:7], v[180:183]
 v_exp_f32 v242, v150
 v_mfma_f32_16x16x32_bf16 v[108:111], v[200:203], v[8:11], v[184:187]
 ds_read_b128 v[200:203], v233 offset:49152
 v_cvt_pk_bf16_f32 v172, v240, v241
 v_mfma_f32_16x16x32_bf16 v[104:107], v[204:207], v[4:7], v[180:183]
 v_exp_f32 v243, v151
 v_mfma_f32_16x16x32_bf16 v[112:115], v[204:207], v[8:11], v[184:187]
 ds_read_b128 v[204:207], v233 offset:49408
 v_mfma_f32_16x16x32_bf16 v[100:103], v[208:211], v[12:15], v[100:103]
 v_exp_f32 v240, v152
 v_mfma_f32_16x16x32_bf16 v[108:111], v[208:211], v[16:19], v[108:111]
 ds_read_b128 v[208:211], v233 offset:53248
 v_cvt_pk_bf16_f32 v173, v242, v243
 v_cmp_nge_f32 vcc, 0x53800000, v194
 s_cbranch_vccnz KB_RARE_B1B_0
KB_RET_B1B_0:
 v_mfma_f32_16x16x32_bf16 v[104:107], v[212:215], v[12:15], v[104:107]
 v_exp_f32 v241, v153
 v_mfma_f32_16x16x32_bf16 v[112:115], v[212:215], v[16:19], v[112:115]
 ds_read_b128 v[212:215], v233 offset:53504
 s_waitcnt lgkmcnt(5)
 v_mfma_f32_16x16x32_bf16 v[100:103], v[216:219], v[20:23], v[100:103]
 v_exp_f32 v242, v154
 v_mfma_f32_16x16x32_bf16 v[108:111], v[216:219], v[24:27], v[108:111]
 ds_read_b128 v[216:219], v233 offset:57344
 v_cvt_pk_bf16_f32 v174, v240, v241
 v_mfma_f32_16x16x32_bf16 v[104:107], v[220:223], v[20:23], v[104:107]
 v_exp_f32 v243, v155
 v_mfma_f32_16x16x32_bf16 v[112:115], v[220:223], v[24:27], v[112:115]
 ds_read_b128 v[220:223], v233 offset:57600
 v_mfma_f32_16x16x32_bf16 v[100:103], v[224:227], v[28:31], v[100:103]
 v_exp_f32 v240, v156
 v_mfma_f32_16x16x32_bf16 v[108:111], v[224:227], v[32:35], v[108:111]
 ds_read_b128 v[224:227], v233 offset:61440
 v_cvt_pk_bf16_f32 v175, v242, v243
 v_mfma_f32_16x16x32_bf16 v[104:107], v[228:231], v[28:31], v[104:107]
 v_exp_f32 v241, v157
 v_mfma_f32_16x16x32_bf16 v[112:115], v[228:231], v[32:35], v[112:115]
 ds_read_b128 v[228:231], v233 offset:61696
 s_waitcnt lgkmcnt(4)
 v_mfma_f32_16x16x32_bf16 v[36:39], v[200:203], v[164:167], v[36:39]
 v_exp_f32 v242, v158
 v_mfma_f32_16x16x32_bf16 v[44:47], v[200:203], v[168:171], v[44:47]
 ds_read_b128 v[200:203], v234 offset:8192
 v_cvt_pk_bf16_f32 v176, v240, v241
 v_mfma_f32_16x16x32_bf16 v[40:43], v[204:207], v[164:167], v[40:43]
 v_exp_f32 v243, v159
 v_mfma_f32_16x16x32_bf16 v[48:51], v[204:207], v[168:171], v[48:51]
 ds_read_b128 v[204:207], v234 offset:8448
 v_mfma_f32_16x16x32_bf16 v[52:55], v[208:211], v[164:167], v[52:55]
 v_exp_f32 v240, v160
 v_mfma_f32_16x16x32_bf16 v[60:63], v[208:211], v[168:171], v[60:63]
 ds_read_b128 v[208:211], v234 offset:10240
 v_cvt_pk_bf16_f32 v177, v242, v243
 v_mfma_f32_16x16x32_bf16 v[56:59], v[212:215], v[164:167], v[56:59]
 v_exp_f32 v241, v161
 v_mfma_f32_16x16x32_bf16 v[64:67], v[212:215], v[168:171], v[64:67]
 ds_read_b128 v[212:215], v234 offset:10496
 s_waitcnt lgkmcnt(4)
 v_mfma_f32_16x16x32_bf16 v[68:71], v[216:219], v[164:167], v[68:71]
 v_exp_f32 v242, v162
 v_mfma_f32_16x16x32_bf16 v[76:79], v[216:219], v[168:171], v[76:79]
 ds_read_b128 v[216:219], v234 offset:12288
 v_cvt_pk_bf16_f32 v178, v240, v241
 v_mfma_f32_16x16x32_bf16 v[72:75], v[220:223], v[164:167], v[72:75]
 v_exp_f32 v243, v163
 v_mfma_f32_16x16x32_bf16 v[80:83], v[220:223], v[168:171], v[80:83]
 ds_read_b128 v[220:223], v234 offset:12544
 v_cvt_pk_bf16_f32 v179, v242, v243
 v_mfma_f32_16x16x32_bf16 v[84:87], v[224:227], v[164:167], v[84:87]
 v_mfma_f32_16x16x32_bf16 v[92:95], v[224:227], v[168:171], v[92:95]
 ds_read_b128 v[224:227], v234 offset:14336
 v_mfma_f32_16x16x32_bf16 v[88:91], v[228:231], v[164:167], v[88:91]
 v_mfma_f32_16x16x32_bf16 v[96:99], v[228:231], v[168:171], v[96:99]
 ds_read_b128 v[228:231], v234 offset:14592
 s_waitcnt lgkmcnt(4)
 v_mfma_f32_16x16x32_bf16 v[188:191], v[248:251], v[172:175], v[192:195]
 v_exp_f32 v240, v100
 v_exp_f32 v241, v101
 v_mfma_f32_16x16x32_bf16 v[188:191], v[252:255], v[176:179], v[188:191]
 v_exp_f32 v242, v102
 v_mfma_f32_16x16x32_bf16 v[116:119], v[200:203], v[4:7], v[180:183]
 v_cvt_pk_bf16_f32 v164, v240, v241
 v_exp_f32 v243, v103
 v_mfma_f32_16x16x32_bf16 v[124:127], v[200:203], v[8:11], v[184:187]
 ds_read_b128 v[200:203], v233 offset:51200
 v_exp_f32 v240, v104
 v_mfma_f32_16x16x32_bf16 v[120:123], v[204:207], v[4:7], v[180:183]
 v_cvt_pk_bf16_f32 v165, v242, v243
 v_exp_f32 v241, v105
 v_mfma_f32_16x16x32_bf16 v[128:131], v[204:207], v[8:11], v[184:187]
 ds_read_b128 v[204:207], v233 offset:51456
 v_exp_f32 v242, v106
 v_mfma_f32_16x16x32_bf16 v[116:119], v[208:211], v[12:15], v[116:119]
 v_cvt_pk_bf16_f32 v166, v240, v241
 v_exp_f32 v243, v107
 v_mfma_f32_16x16x32_bf16 v[124:127], v[208:211], v[16:19], v[124:127]
 ds_read_b128 v[208:211], v233 offset:55296
 v_exp_f32 v240, v108
 v_cmp_nge_f32 vcc, 0x53800000, v190
 s_cbranch_vccnz KB_RARE_B1B_1
KB_RET_B1B_1:
 v_mfma_f32_16x16x32_bf16 v[120:123], v[212:215], v[12:15], v[120:123]
 v_cvt_pk_bf16_f32 v167, v242, v243
 v_exp_f32 v241, v109
 v_mfma_f32_16x16x32_bf16 v[128:131], v[212:215], v[16:19], v[128:131]
 ds_read_b32 v238, v232
 ds_read_b128 v[212:215], v233 offset:55552
 s_waitcnt lgkmcnt(5)
 v_mfma_f32_16x16x32_bf16 v[116:119], v[216:219], v[20:23], v[116:119]
 v_exp_f32 v242, v110
 v_mfma_f32_16x16x32_bf16 v[124:127], v[216:219], v[24:27], v[124:127]
 ds_read_b128 v[216:219], v233 offset:59392
 v_cvt_pk_bf16_f32 v168, v240, v241
 v_mfma_f32_16x16x32_bf16 v[120:123], v[220:223], v[20:23], v[120:123]
 v_exp_f32 v243, v111
 v_mfma_f32_16x16x32_bf16 v[128:131], v[220:223], v[24:27], v[128:131]
 ds_read_b128 v[220:223], v233 offset:59648
 v_exp_f32 v240, v112
 v_mfma_f32_16x16x32_bf16 v[116:119], v[224:227], v[28:31], v[116:119]
 v_cvt_pk_bf16_f32 v169, v242, v243
 v_exp_f32 v241, v113
 v_mfma_f32_16x16x32_bf16 v[124:127], v[224:227], v[32:35], v[124:127]
 ds_read_b128 v[224:227], v233 offset:63488
 v_exp_f32 v242, v114
 v_mfma_f32_16x16x32_bf16 v[120:123], v[228:231], v[28:31], v[120:123]
 v_cvt_pk_bf16_f32 v170, v240, v241
 v_exp_f32 v243, v115
 v_mfma_f32_16x16x32_bf16 v[128:131], v[228:231], v[32:35], v[128:131]
 ds_read_b128 v[228:231], v233 offset:63744
 v_swap_b32 v233, v234
 s_waitcnt lgkmcnt(4)
 v_mfma_f32_16x16x32_bf16 v[36:39], v[200:203], v[172:175], v[36:39]
 v_cmp_lt_u32 vcc, v238, v239
 s_cbranch_vccnz KB_SPIN_B1B
KB_SPR_B1B:
 v_mfma_f32_16x16x32_bf16 v[44:47], v[200:203], v[176:179], v[44:47]
 ds_read_b128 v[200:203], v233 offset:16384
 v_add_u32 v239, 1, v239
 ds_write_b32 v244, v239 offset:3072
 s_waitcnt vmcnt(0)
 ds_write_b32 v244, v239 offset:1024
 s_add_u32 s32, s32, 1
 s_mov_b32 m0, s35
 v_mfma_f32_16x16x32_bf16 v[40:43], v[204:207], v[172:175], v[40:43]
 v_cvt_pk_bf16_f32 v171, v242, v243
 v_mfma_f32_16x16x32_bf16 v[48:51], v[204:207], v[176:179], v[48:51]
 ds_read_b128 v[204:207], v233 offset:16640
 buffer_load_dwordx4 v197, s[12:15], s31 offen offset:0 sc1 lds
 v_cmp_gt_i32 s[44:45], 0, v245
 v_cmp_gt_i32 s[46:47], 1, v245
 v_cmp_gt_i32 s[48:49], 2, v245
 v_mfma_f32_16x16x32_bf16 v[52:55], v[208:211], v[172:175], v[52:55]
 v_cmp_gt_i32 s[50:51], 3, v245
 v_cndmask_b32 v116, v116, v246, s[44:45]
 v_cndmask_b32 v117, v117, v246, s[46:47]
 v_mfma_f32_16x16x32_bf16 v[60:63], v[208:211], v[176:179], v[60:63]
 ds_read_b128 v[208:211], v233 offset:20480
 buffer_load_dwordx4 v197, s[12:15], s31 offen offset:1024 sc1 lds
 v_cndmask_b32 v118, v118, v246, s[48:49]
 v_cndmask_b32 v119, v119, v246, s[50:51]
 v_mfma_f32_16x16x32_bf16 v[56:59], v[212:215], v[172:175], v[56:59]
 v_cmp_gt_i32 s[44:45], 8, v245
 v_cmp_gt_i32 s[46:47], 9, v245
 v_mfma_f32_16x16x32_bf16 v[64:67], v[212:215], v[176:179], v[64:67]
 ds_read_b128 v[212:215], v233 offset:20736
 buffer_load_dwordx4 v197, s[12:15], s31 offen offset:2048 sc1 lds
 v_cmp_gt_i32 s[48:49], 10, v245
 s_waitcnt lgkmcnt(6)
 v_mfma_f32_16x16x32_bf16 v[68:71], v[216:219], v[172:175], v[68:71]
 v_cmp_gt_i32 s[50:51], 11, v245
 v_cndmask_b32 v120, v120, v246, s[44:45]
 v_cndmask_b32 v121, v121, v246, s[46:47]
 v_mfma_f32_16x16x32_bf16 v[76:79], v[216:219], v[176:179], v[76:79]
 ds_read_b128 v[216:219], v233 offset:24576
 buffer_load_dwordx4 v197, s[12:15], s31 offen offset:3072 sc1 lds
 s_add_u32 s31, s31, 16384
 s_add_u32 s35, s35, 32768
 s_and_b32 s35, s35, 0x1ffff
 v_cndmask_b32 v122, v122, v246, s[48:49]
 v_cndmask_b32 v123, v123, v246, s[50:51]
 v_mfma_f32_16x16x32_bf16 v[72:75], v[220:223], v[172:175], v[72:75]
 v_cmp_gt_i32 s[44:45], -16, v245
 v_cmp_gt_i32 s[46:47], -15, v245
 v_cmp_gt_i32 s[48:49], -14, v245
 v_mfma_f32_16x16x32_bf16 v[80:83], v[220:223], v[176:179], v[80:83]
 ds_read_b128 v[220:223], v233 offset:24832
 s_mov_b32 m0, s36
 s_nop 0
 buffer_load_dwordx4 v197, s[16:19], s33 offen offset:0 sc1 lds
 v_cmp_gt_i32 s[50:51], -13, v245
 v_mfma_f32_16x16x32_bf16 v[84:87], v[224:227], v[172:175], v[84:87]
 v_cndmask_b32 v124, v124, v246, s[44:45]
 v_cndmask_b32 v125, v125, v246, s[46:47]
 v_cndmask_b32 v126, v126, v246, s[48:49]
 v_mfma_f32_16x16x32_bf16 v[92:95], v[224:227], v[176:179], v[92:95]
 ds_read_b128 v[224:227], v233 offset:28672
 buffer_load_dwordx4 v197, s[16:19], s33 offen offset:1024 sc1 lds
 v_cndmask_b32 v127, v127, v246, s[50:51]
 v_cmp_gt_i32 s[44:45], -8, v245
 v_mfma_f32_16x16x32_bf16 v[88:91], v[228:231], v[172:175], v[88:91]
 v_cmp_gt_i32 s[46:47], -7, v245
 v_cmp_gt_i32 s[48:49], -6, v245
 v_cmp_gt_i32 s[50:51], -5, v245
 v_mfma_f32_16x16x32_bf16 v[96:99], v[228:231], v[176:179], v[96:99]
 ds_read_b128 v[228:231], v233 offset:28928
 buffer_load_dwordx4 v197, s[16:19], s33 offen offset:2048 sc1 lds
 s_waitcnt lgkmcnt(4)
 v_cndmask_b32 v128, v128, v246, s[44:45]
 v_cndmask_b32 v129, v129, v246, s[46:47]
 v_cndmask_b32 v130, v130, v246, s[48:49]
 v_cndmask_b32 v131, v131, v246, s[50:51]
 buffer_load_dwordx4 v197, s[16:19], s33 offen offset:3072 sc1 lds
 s_add_u32 s33, s33, 16384
 s_add_u32 s36, s36, 32768
 s_and_b32 s36, s36, 0x1ffff
KB_D0BB:
 ds_write_b32 v244, v239
 v_mfma_f32_16x16x32_bf16 v[192:195], v[248:251], v[164:167], v[188:191]
 v_exp_f32 v240, v116
 v_exp_f32 v241, v117
 v_mfma_f32_16x16x32_bf16 v[192:195], v[252:255], v[168:171], v[192:195]
 v_exp_f32 v242, v118
 v_cvt_pk_bf16_f32 v172, v240, v241
 v_exp_f32 v243, v119
 v_exp_f32 v240, v120
 v_cvt_pk_bf16_f32 v173, v242, v243
 v_exp_f32 v241, v121
 s_nop 1
 v_cmp_nge_f32 vcc, 0x53800000, v194
 s_cbranch_vccnz KB_RARE_DB0B_0
KB_RET_DB0B_0:
 v_mfma_f32_16x16x32_bf16 v[36:39], v[200:203], v[164:167], v[36:39]
 v_exp_f32 v242, v122
 v_mfma_f32_16x16x32_bf16 v[44:47], v[200:203], v[168:171], v[44:47]
 ds_read_b128 v[200:203], v233 offset:18432
 v_cvt_pk_bf16_f32 v174, v240, v241
 v_mfma_f32_16x16x32_bf16 v[40:43], v[204:207], v[164:167], v[40:43]
 v_exp_f32 v243, v123
 v_mfma_f32_16x16x32_bf16 v[48:51], v[204:207], v[168:171], v[48:51]
 ds_read_b128 v[204:207], v233 offset:18688
 v_exp_f32 v240, v124
 v_mfma_f32_16x16x32_bf16 v[52:55], v[208:211], v[164:167], v[52:55]
 v_cvt_pk_bf16_f32 v175, v242, v243
 v_exp_f32 v241, v125
 v_mfma_f32_16x16x32_bf16 v[60:63], v[208:211], v[168:171], v[60:63]
 ds_read_b128 v[208:211], v233 offset:22528
 v_exp_f32 v242, v126
 v_mfma_f32_16x16x32_bf16 v[56:59], v[212:215], v[164:167], v[56:59]
 v_cvt_pk_bf16_f32 v176, v240, v241
 v_exp_f32 v243, v127
 v_mfma_f32_16x16x32_bf16 v[64:67], v[212:215], v[168:171], v[64:67]
 ds_read_b32 v238, v232
 ds_read_b128 v[212:215], v233 offset:22784
 s_waitcnt lgkmcnt(6)
 v_mfma_f32_16x16x32_bf16 v[68:71], v[216:219], v[164:167], v[68:71]
 v_exp_f32 v240, v128
 v_mfma_f32_16x16x32_bf16 v[76:79], v[216:219], v[168:171], v[76:79]
 ds_read_b128 v[216:219], v233 offset:26624
 v_cvt_pk_bf16_f32 v177, v242, v243
 v_mfma_f32_16x16x32_bf16 v[72:75], v[220:223], v[164:167], v[72:75]
 v_exp_f32 v241, v129
 v_mfma_f32_16x16x32_bf16 v[80:83], v[220:223], v[168:171], v[80:83]
 ds_read_b128 v[220:223], v233 offset:26880
 v_exp_f32 v242, v130
 v_mfma_f32_16x16x32_bf16 v[84:87], v[224:227], v[164:167], v[84:87]
 v_cvt_pk_bf16_f32 v178, v240, v241
 v_exp_f32 v243, v131
 v_mfma_f32_16x16x32_bf16 v[92:95], v[224:227], v[168:171], v[92:95]
 ds_read_b128 v[224:227], v233 offset:30720
 v_cvt_pk_bf16_f32 v179, v242, v243
 v_mfma_f32_16x16x32_bf16 v[88:91], v[228:231], v[164:167], v[88:91]
 v_mfma_f32_16x16x32_bf16 v[96:99], v[228:231], v[168:171], v[96:99]
 ds_read_b128 v[228:231], v233 offset:30976
 s_waitcnt lgkmcnt(4)
 v_mfma_f32_16x16x32_bf16 v[188:191], v[248:251], v[172:175], v[192:195]
 v_cmp_lt_u32 vcc, v238, v239
 s_cbranch_vccnz KB_SPIN_DB0B
KB_SPR_DB0B:
 s_nop 3
 v_mfma_f32_16x16x32_bf16 v[188:191], v[252:255], v[176:179], v[188:191]
 s_nop 7
 v_cmp_nge_f32 vcc, 0x53800000, v190
 s_cbranch_vccnz KB_RARE_DB0B_1
KB_RET_DB0B_1:
 v_mfma_f32_16x16x32_bf16 v[36:39], v[200:203], v[172:175], v[36:39]
 v_mfma_f32_16x16x32_bf16 v[44:47], v[200:203], v[176:179], v[44:47]
 v_add_u32 v239, 1, v239
 ds_write_b32 v244, v239 offset:3072
 s_waitcnt vmcnt(0)
 ds_write_b32 v244, v239 offset:1024
 s_add_u32 s32, s32, 1
 s_mov_b32 m0, s35
 v_mfma_f32_16x16x32_bf16 v[40:43], v[204:207], v[172:175], v[40:43]
 v_mfma_f32_16x16x32_bf16 v[48:51], v[204:207], v[176:179], v[48:51]
 buffer_load_dwordx4 v197, s[12:15], s31 offen offset:0 sc1 lds
 v_mfma_f32_16x16x32_bf16 v[52:55], v[208:211], v[172:175], v[52:55]
 v_mfma_f32_16x16x32_bf16 v[60:63], v[208:211], v[176:179], v[60:63]
 buffer_load_dwordx4 v197, s[12:15], s31 offen offset:1024 sc1 lds
 v_mfma_f32_16x16x32_bf16 v[56:59], v[212:215], v[172:175], v[56:59]
 v_mfma_f32_16x16x32_bf16 v[64:67], v[212:215], v[176:179], v[64:67]
 buffer_load_dwordx4 v197, s[12:15], s31 offen offset:2048 sc1 lds
 s_waitcnt lgkmcnt(2)
 v_mfma_f32_16x16x32_bf16 v[68:71], v[216:219], v[172:175], v[68:71]
 v_mfma_f32_16x16x32_bf16 v[76:79], v[216:219], v[176:179], v[76:79]
 buffer_load_dwordx4 v197, s[12:15], s31 offen offset:3072 sc1 lds
 s_add_u32 s31, s31, 16384
 s_add_u32 s35, s35, 32768
 s_and_b32 s35, s35, 0x1ffff
 v_mfma_f32_16x16x32_bf16 v[72:75], v[220:223], v[172:175], v[72:75]
 v_mfma_f32_16x16x32_bf16 v[80:83], v[220:223], v[176:179], v[80:83]
 s_mov_b32 m0, s36
 s_nop 0
 buffer_load_dwordx4 v197, s[16:19], s33 offen offset:0 sc1 lds
 v_mfma_f32_16x16x32_bf16 v[84:87], v[224:227], v[172:175], v[84:87]
 v_mfma_f32_16x16x32_bf16 v[92:95], v[224:227], v[176:179], v[92:95]
 buffer_load_dwordx4 v197, s[16:19], s33 offen offset:1024 sc1 lds
 v_mfma_f32_16x16x32_bf16 v[88:91], v[228:231], v[172:175], v[88:91]
 v_mfma_f32_16x16x32_bf16 v[96:99], v[228:231], v[176:179], v[96:99]
 buffer_load_dwordx4 v197, s[16:19], s33 offen offset:2048 sc1 lds
 buffer_load_dwordx4 v197, s[16:19], s33 offen offset:3072 sc1 lds
 s_add_u32 s33, s33, 16384
 s_add_u32 s36, s36, 32768
 s_and_b32 s36, s36, 0x1ffff
 s_branch KB_FINALB
KB_X1AB:
 ds_write_b32 v244, v239
 v_mfma_f32_16x16x32_bf16 v[192:195], v[248:251], v[164:167], v[188:191]
 v_exp_f32 v240, v148
 v_mfma_f32_16x16x32_bf16 v[192:195], v[252:255], v[168:171], v[192:195]
 v_exp_f32 v241, v149
 v_mfma_f32_16x16x32_bf16 v[100:103], v[200:203], v[4:7], v[180:183]
 v_exp_f32 v242, v150
 v_mfma_f32_16x16x32_bf16 v[108:111], v[200:203], v[8:11], v[184:187]
 ds_read_b128 v[200:203], v233 offset:49152
 v_cvt_pk_bf16_f32 v172, v240, v241
 v_mfma_f32_16x16x32_bf16 v[104:107], v[204:207], v[4:7], v[180:183]
 v_exp_f32 v243, v151
 v_mfma_f32_16x16x32_bf16 v[112:115], v[204:207], v[8:11], v[184:187]
 ds_read_b128 v[204:207], v233 offset:49408
 v_mfma_f32_16x16x32_bf16 v[100:103], v[208:211], v[12:15], v[100:103]
 v_exp_f32 v240, v152
 v_mfma_f32_16x16x32_bf16 v[108:111], v[208:211], v[16:19], v[108:111]
 ds_read_b128 v[208:211], v233 offset:53248
 v_cvt_pk_bf16_f32 v173, v242, v243
 v_cmp_nge_f32 vcc, 0x53800000, v194
 s_cbranch_vccnz KB_RARE_A1B_0
KB_RET_A1B_0:
 v_mfma_f32_16x16x32_bf16 v[104:107], v[212:215], v[12:15], v[104:107]
 v_exp_f32 v241, v153
 v_mfma_f32_16x16x32_bf16 v[112:115], v[212:215], v[16:19], v[112:115]
 ds_read_b128 v[212:215], v233 offset:53504
 s_waitcnt lgkmcnt(5)
 v_mfma_f32_16x16x32_bf16 v[100:103], v[216:219], v[20:23], v[100:103]
 v_exp_f32 v242, v154
 v_mfma_f32_16x16x32_bf16 v[108:111], v[216:219], v[24:27], v[108:111]
 ds_read_b128 v[216:219], v233 offset:57344
 v_cvt_pk_bf16_f32 v174, v240, v241
 v_mfma_f32_16x16x32_bf16 v[104:107], v[220:223], v[20:23], v[104:107]
 v_exp_f32 v243, v155
 v_mfma_f32_16x16x32_bf16 v[112:115], v[220:223], v[24:27], v[112:115]
 ds_read_b128 v[220:223], v233 offset:57600
 v_mfma_f32_16x16x32_bf16 v[100:103], v[224:227], v[28:31], v[100:103]
 v_exp_f32 v240, v156
 v_mfma_f32_16x16x32_bf16 v[108:111], v[224:227], v[32:35], v[108:111]
 ds_read_b128 v[224:227], v233 offset:61440
 v_cvt_pk_bf16_f32 v175, v242, v243
 v_mfma_f32_16x16x32_bf16 v[104:107], v[228:231], v[28:31], v[104:107]
 v_exp_f32 v241, v157
 v_mfma_f32_16x16x32_bf16 v[112:115], v[228:231], v[32:35], v[112:115]
 ds_read_b128 v[228:231], v233 offset:61696
 s_waitcnt lgkmcnt(4)
 v_mfma_f32_16x16x32_bf16 v[36:39], v[200:203], v[164:167], v[36:39]
 v_exp_f32 v242, v158
 v_mfma_f32_16x16x32_bf16 v[44:47], v[200:203], v[168:171], v[44:47]
 ds_read_b128 v[200:203], v233 offset:51200
 v_cvt_pk_bf16_f32 v176, v240, v241
 v_mfma_f32_16x16x32_bf16 v[40:43], v[204:207], v[164:167], v[40:43]
 v_exp_f32 v243, v159
 v_mfma_f32_16x16x32_bf16 v[48:51], v[204:207], v[168:171], v[48:51]
 ds_read_b128 v[204:207], v233 offset:51456
 v_mfma_f32_16x16x32_bf16 v[52:55], v[208:211], v[164:167], v[52:55]
 v_exp_f32 v240, v160
 v_mfma_f32_16x16x32_bf16 v[60:63], v[208:211], v[168:171], v[60:63]
 ds_read_b128 v[208:211], v233 offset:55296
 v_cvt_pk_bf16_f32 v177, v242, v243
 v_mfma_f32_16x16x32_bf16 v[56:59], v[212:215], v[164:167], v[56:59]
 v_exp_f32 v241, v161
 v_mfma_f32_16x16x32_bf16 v[64:67], v[212:215], v[168:171], v[64:67]
 ds_read_b32 v238, v232
 ds_read_b128 v[212:215], v233 offset:55552
 s_waitcnt lgkmcnt(5)
 v_mfma_f32_16x16x32_bf16 v[68:71], v[216:219], v[164:167], v[68:71]
 v_exp_f32 v242, v162
 v_mfma_f32_16x16x32_bf16 v[76:79], v[216:219], v[168:171], v[76:79]
 ds_read_b128 v[216:219], v233 offset:59392
 v_cvt_pk_bf16_f32 v178, v240, v241
 v_mfma_f32_16x16x32_bf16 v[72:75], v[220:223], v[164:167], v[72:75]
 v_exp_f32 v243, v163
 v_mfma_f32_16x16x32_bf16 v[80:83], v[220:223], v[168:171], v[80:83]
 ds_read_b128 v[220:223], v233 offset:59648
 v_cvt_pk_bf16_f32 v179, v242, v243
 v_mfma_f32_16x16x32_bf16 v[84:87], v[224:227], v[164:167], v[84:87]
 v_mfma_f32_16x16x32_bf16 v[92:95], v[224:227], v[168:171], v[92:95]
 ds_read_b128 v[224:227], v233 offset:63488
 v_mfma_f32_16x16x32_bf16 v[88:91], v[228:231], v[164:167], v[88:91]
 v_mfma_f32_16x16x32_bf16 v[96:99], v[228:231], v[168:171], v[96:99]
 ds_read_b128 v[228:231], v233 offset:63744
 v_swap_b32 v233, v234
 s_waitcnt lgkmcnt(4)
 v_mfma_f32_16x16x32_bf16 v[188:191], v[248:251], v[172:175], v[192:195]
 v_cmp_lt_u32 vcc, v238, v239
 s_cbranch_vccnz KB_SPIN_A1B
KB_SPR_A1B:
 v_cmp_gt_i32 s[44:45], 0, v245
 v_cmp_gt_i32 s[46:47], 1, v245
 v_cmp_gt_i32 s[48:49], 2, v245
 s_nop 0
 v_mfma_f32_16x16x32_bf16 v[188:191], v[252:255], v[176:179], v[188:191]
 v_cmp_gt_i32 s[50:51], 3, v245
 v_cndmask_b32 v100, v100, v246, s[44:45]
 v_cndmask_b32 v101, v101, v246, s[46:47]
 v_cndmask_b32 v102, v102, v246, s[48:49]
 v_cndmask_b32 v103, v103, v246, s[50:51]
 s_nop 2
 v_cmp_nge_f32 vcc, 0x53800000, v190
 s_cbranch_vccnz KB_RARE_A1B_1
KB_RET_A1B_1:
 v_mfma_f32_16x16x32_bf16 v[36:39], v[200:203], v[172:175], v[36:39]
 v_cmp_gt_i32 s[44:45], 8, v245
 v_cmp_gt_i32 s[46:47], 9, v245
 v_mfma_f32_16x16x32_bf16 v[44:47], v[200:203], v[176:179], v[44:47]
 ds_read_b128 v[200:203], v233 offset:16384
 v_add_u32 v239, 1, v239
 ds_write_b32 v244, v239 offset:3072
 s_waitcnt vmcnt(0)
 ds_write_b32 v244, v239 offset:1024
 s_add_u32 s32, s32, 1
 s_mov_b32 m0, s35
 v_cmp_gt_i32 s[48:49], 10, v245
 v_cmp_gt_i32 s[50:51], 11, v245
 v_cndmask_b32 v104, v104, v246, s[44:45]
 v_mfma_f32_16x16x32_bf16 v[40:43], v[204:207], v[172:175], v[40:43]
 v_cndmask_b32 v105, v105, v246, s[46:47]
 v_cndmask_b32 v106, v106, v246, s[48:49]
 v_cndmask_b32 v107, v107, v246, s[50:51]
 v_cmp_gt_i32 s[44:45], -16, v245
 v_cmp_gt_i32 s[46:47], -15, v245
 v_mfma_f32_16x16x32_bf16 v[48:51], v[204:207], v[176:179], v[48:51]
 ds_read_b128 v[204:207], v233 offset:16640
 buffer_load_dwordx4 v197, s[12:15], s31 offen offset:0 sc1 lds
 v_cmp_gt_i32 s[48:49], -14, v245
 v_cmp_gt_i32 s[50:51], -13, v245
 v_cndmask_b32 v108, v108, v246, s[44:45]
 v_mfma_f32_16x16x32_bf16 v[52:55], v[208:211], v[172:175], v[52:55]
 v_cndmask_b32 v109, v109, v246, s[46:47]
 v_cndmask_b32 v110, v110, v246, s[48:49]
 v_cndmask_b32 v111, v111, v246, s[50:51]
 v_cmp_gt_i32 s[44:45], -8, v245
 v_cmp_gt_i32 s[46:47], -7, v245
 v_mfma_f32_16x16x32_bf16 v[60:63], v[208:211], v[176:179], v[60:63]
 ds_read_b128 v[208:211], v233 offset:20480
 buffer_load_dwordx4 v197, s[12:15], s31 offen offset:1024 sc1 lds
 v_cmp_gt_i32 s[48:49], -6, v245
 v_cmp_gt_i32 s[50:51], -5, v245
 v_cndmask_b32 v112, v112, v246, s[44:45]
 v_cndmask_b32 v113, v113, v246, s[46:47]
 v_mfma_f32_16x16x32_bf16 v[56:59], v[212:215], v[172:175], v[56:59]
 v_cndmask_b32 v114, v114, v246, s[48:49]
 v_cndmask_b32 v115, v115, v246, s[50:51]
 v_exp_f32 v240, v100
 v_mfma_f32_16x16x32_bf16 v[64:67], v[212:215], v[176:179], v[64:67]
 ds_read_b128 v[212:215], v233 offset:20736
 buffer_load_dwordx4 v197, s[12:15], s31 offen offset:2048 sc1 lds
 v_exp_f32 v241, v101
 v_exp_f32 v242, v102
 s_waitcnt lgkmcnt(6)
 v_mfma_f32_16x16x32_bf16 v[68:71], v[216:219], v[172:175], v[68:71]
 v_cvt_pk_bf16_f32 v164, v240, v241
 v_exp_f32 v243, v103
 v_exp_f32 v240, v104
 v_mfma_f32_16x16x32_bf16 v[76:79], v[216:219], v[176:179], v[76:79]
 ds_read_b128 v[216:219], v233 offset:24576
 buffer_load_dwordx4 v197, s[12:15], s31 offen offset:3072 sc1 lds
 s_add_u32 s31, s31, 16384
 s_add_u32 s35, s35, 32768
 s_and_b32 s35, s35, 0x1ffff
 v_cvt_pk_bf16_f32 v165, v242, v243
 v_exp_f32 v241, v105
 v_mfma_f32_16x16x32_bf16 v[72:75], v[220:223], v[172:175], v[72:75]
 v_exp_f32 v242, v106
 v_cvt_pk_bf16_f32 v166, v240, v241
 v_exp_f32 v243, v107
 v_mfma_f32_16x16x32_bf16 v[80:83], v[220:223], v[176:179], v[80:83]
 ds_read_b128 v[220:223], v233 offset:24832
 s_mov_b32 m0, s36
 s_nop 0
 buffer_load_dwordx4 v197, s[16:19], s33 offen offset:0 sc1 lds
 v_exp_f32 v240, v108
 v_cvt_pk_bf16_f32 v167, v242, v243
 v_mfma_f32_16x16x32_bf16 v[84:87], v[224:227], v[172:175], v[84:87]
 v_exp_f32 v241, v109
 v_exp_f32 v242, v110
 v_mfma_f32_16x16x32_bf16 v[92:95], v[224:227], v[176:179], v[92:95]
 ds_read_b128 v[224:227], v233 offset:28672
 buffer_load_dwordx4 v197, s[16:19], s33 offen offset:1024 sc1 lds
 v_cvt_pk_bf16_f32 v168, v240, v241
 v_exp_f32 v243, v111
 v_exp_f32 v240, v112
 v_mfma_f32_16x16x32_bf16 v[88:91], v[228:231], v[172:175], v[88:91]
 v_cvt_pk_bf16_f32 v169, v242, v243
 v_exp_f32 v241, v113
 v_exp_f32 v242, v114
 v_mfma_f32_16x16x32_bf16 v[96:99], v[228:231], v[176:179], v[96:99]
 ds_read_b128 v[228:231], v233 offset:28928
 buffer_load_dwordx4 v197, s[16:19], s33 offen offset:2048 sc1 lds
 v_cvt_pk_bf16_f32 v170, v240, v241
 s_waitcnt lgkmcnt(4)
 v_exp_f32 v243, v115
 s_nop 0
 v_cvt_pk_bf16_f32 v171, v242, v243
 buffer_load_dwordx4 v197, s[16:19], s33 offen offset:3072 sc1 lds
 s_add_u32 s33, s33, 16384
 s_add_u32 s36, s36, 32768
 s_and_b32 s36, s36, 0x1ffff
KB_D0AB:
 ds_write_b32 v244, v239
 v_mfma_f32_16x16x32_bf16 v[192:195], v[248:251], v[164:167], v[188:191]
 v_mfma_f32_16x16x32_bf16 v[192:195], v[252:255], v[168:171], v[192:195]
 s_nop 7
 v_cmp_nge_f32 vcc, 0x53800000, v194
 s_cbranch_vccnz KB_RARE_DA0B_0
KB_RET_DA0B_0:
 v_mfma_f32_16x16x32_bf16 v[36:39], v[200:203], v[164:167], v[36:39]
 v_mfma_f32_16x16x32_bf16 v[44:47], v[200:203], v[168:171], v[44:47]
 ds_read_b32 v238, v232
 v_mfma_f32_16x16x32_bf16 v[40:43], v[204:207], v[164:167], v[40:43]
 v_mfma_f32_16x16x32_bf16 v[48:51], v[204:207], v[168:171], v[48:51]
 v_mfma_f32_16x16x32_bf16 v[52:55], v[208:211], v[164:167], v[52:55]
 v_mfma_f32_16x16x32_bf16 v[60:63], v[208:211], v[168:171], v[60:63]
 v_mfma_f32_16x16x32_bf16 v[56:59], v[212:215], v[164:167], v[56:59]
 v_mfma_f32_16x16x32_bf16 v[64:67], v[212:215], v[168:171], v[64:67]
 s_waitcnt lgkmcnt(0)
 v_mfma_f32_16x16x32_bf16 v[68:71], v[216:219], v[164:167], v[68:71]
 v_cmp_lt_u32 vcc, v238, v239
 s_cbranch_vccnz KB_SPIN_DA0B
KB_SPR_DA0B:
 v_mfma_f32_16x16x32_bf16 v[76:79], v[216:219], v[168:171], v[76:79]
 v_add_u32 v239, 1, v239
 ds_write_b32 v244, v239 offset:3072
 s_waitcnt vmcnt(0)
 ds_write_b32 v244, v239 offset:1024
 s_add_u32 s32, s32, 1
 s_mov_b32 m0, s35
 v_mfma_f32_16x16x32_bf16 v[72:75], v[220:223], v[164:167], v[72:75]
 v_mfma_f32_16x16x32_bf16 v[80:83], v[220:223], v[168:171], v[80:83]
 buffer_load_dwordx4 v197, s[12:15], s31 offen offset:0 sc1 lds
 v_mfma_f32_16x16x32_bf16 v[84:87], v[224:227], v[164:167], v[84:87]
 v_mfma_f32_16x16x32_bf16 v[92:95], v[224:227], v[168:171], v[92:95]
 buffer_load_dwordx4 v197, s[12:15], s31 offen offset:1024 sc1 lds
 v_mfma_f32_16x16x32_bf16 v[88:91], v[228:231], v[164:167], v[88:91]
 v_mfma_f32_16x16x32_bf16 v[96:99], v[228:231], v[168:171], v[96:99]
 buffer_load_dwordx4 v197, s[12:15], s31 offen offset:2048 sc1 lds
 buffer_load_dwordx4 v197, s[12:15], s31 offen offset:3072 sc1 lds
 s_add_u32 s31, s31, 16384
 s_add_u32 s35, s35, 32768
 s_and_b32 s35, s35, 0x1ffff
 s_mov_b32 m0, s36
 s_nop 0
 buffer_load_dwordx4 v197, s[16:19], s33 offen offset:0 sc1 lds
 buffer_load_dwordx4 v197, s[16:19], s33 offen offset:1024 sc1 lds
 buffer_load_dwordx4 v197, s[16:19], s33 offen offset:2048 sc1 lds
 buffer_load_dwordx4 v197, s[16:19], s33 offen offset:3072 sc1 lds
 s_add_u32 s33, s33, 16384
 s_add_u32 s36, s36, 32768
 s_and_b32 s36, s36, 0x1ffff
 v_mov_b32 v188, v192
 v_mov_b32 v189, v193
 s_branch KB_FINALB
KB_ROLEA:
 s_and_b32 s39, s93, 1
 s_lshl_b32 s39, s39, 3
 s_bfe_u32 s32, s93, 0x30005
 s_add_u32 s32, s32, s39
 s_bfe_u32 s33, s93, 0x20003
 s_lshr_b32 s34, s55, 2
 s_and_b32 s35, s55, 3
 s_lshl_b32 s38, s55, 12
 s_and_b32 s39, s29, 2
 s_lshl_b32 s39, s39, 15
 s_add_u32 s66, s38, s39
 s_xor_b32 s67, s66, 0x10000
 s_add_u32 s68, s38, 0x20000
 s_waitcnt lgkmcnt(0)
 s_barrier
 v_add_u32 v164, 161792, v164
 ds_read_b32 v164, v164
 ds_read_b128 v[200:203], v233 offset:0
 ds_read_b128 v[204:207], v233 offset:256
 ds_read_b128 v[208:211], v233 offset:2048
 ds_read_b128 v[212:215], v233 offset:2304
 ds_read_b128 v[216:219], v233 offset:4096
 ds_read_b128 v[220:223], v233 offset:4352
 ds_read_b128 v[224:227], v233 offset:6144
 ds_read_b128 v[228:231], v233 offset:6400
 s_waitcnt lgkmcnt(6)
 v_cmp_ne_u32 vcc, 0, v164
 s_cbranch_vccnz KB_RECOVER
 v_mfma_f32_16x16x32_bf16 v[100:103], v[200:203], v[4:7], 0
 v_mov_b32 v36, 0
 v_mov_b32 v37, 0
 v_mfma_f32_16x16x32_bf16 v[108:111], v[200:203], v[8:11], 0
 ds_read_b128 v[200:203], v233 offset:8192
 v_mov_b32 v38, 0
 v_mov_b32 v39, 0
 v_mfma_f32_16x16x32_bf16 v[104:107], v[204:207], v[4:7], 0
 v_mov_b32 v40, 0
 v_mov_b32 v41, 0
 v_mfma_f32_16x16x32_bf16 v[112:115], v[204:207], v[8:11], 0
 ds_read_b128 v[204:207], v233 offset:8448
 v_mov_b32 v42, 0
 v_mov_b32 v43, 0
 s_waitcnt lgkmcnt(6)
 v_mfma_f32_16x16x32_bf16 v[100:103], v[208:211], v[12:15], v[100:103]
 v_mov_b32 v44, 0
 v_mov_b32 v45, 0
 v_mfma_f32_16x16x32_bf16 v[108:111], v[208:211], v[16:19], v[108:111]
 ds_read_b128 v[208:211], v233 offset:10240
 v_mov_b32 v46, 0
 v_mov_b32 v47, 0
 v_mfma_f32_16x16x32_bf16 v[104:107], v[212:215], v[12:15], v[104:107]
 v_mov_b32 v48, 0
 v_mov_b32 v49, 0
 v_mfma_f32_16x16x32_bf16 v[112:115], v[212:215], v[16:19], v[112:115]
 ds_read_b128 v[212:215], v233 offset:10496
 v_mov_b32 v50, 0
 v_mov_b32 v51, 0
 s_waitcnt lgkmcnt(6)
 v_mfma_f32_16x16x32_bf16 v[100:103], v[216:219], v[20:23], v[100:103]
 v_mov_b32 v52, 0
 v_mov_b32 v53, 0
 v_mfma_f32_16x16x32_bf16 v[108:111], v[216:219], v[24:27], v[108:111]
 ds_read_b128 v[216:219], v233 offset:12288
 v_mov_b32 v54, 0
 v_mov_b32 v55, 0
 v_mfma_f32_16x16x32_bf16 v[104:107], v[220:223], v[20:23], v[104:107]
 v_mov_b32 v56, 0
 v_mov_b32 v57, 0
 v_mfma_f32_16x16x32_bf16 v[112:115], v[220:223], v[24:27], v[112:115]
 ds_read_b128 v[220:223], v233 offset:12544
 v_mov_b32 v58, 0
 v_mov_b32 v59, 0
 s_waitcnt lgkmcnt(6)
 v_mfma_f32_16x16x32_bf16 v[100:103], v[224:227], v[28:31], v[100:103]
 v_mov_b32 v60, 0
 v_mov_b32 v61, 0
 v_mfma_f32_16x16x32_bf16 v[108:111], v[224:227], v[32:35], v[108:111]
 ds_read_b128 v[224:227], v233 offset:14336
 v_mov_b32 v62, 0
 v_mov_b32 v63, 0
 v_mfma_f32_16x16x32_bf16 v[104:107], v[228:231], v[28:31], v[104:107]
 v_mov_b32 v64, 0
 v_mov_b32 v65, 0
 v_mfma_f32_16x16x32_bf16 v[112:115], v[228:231], v[32:35], v[112:115]
 ds_read_b128 v[228:231], v233 offset:14592
 v_mov_b32 v66, 0
 v_mov_b32 v67, 0
 s_waitcnt lgkmcnt(6)
 v_mfma_f32_16x16x32_bf16 v[116:119], v[200:203], v[4:7], 0
 v_mov_b32 v68, 0
 v_mov_b32 v69, 0
 v_mfma_f32_16x16x32_bf16 v[124:127], v[200:203], v[8:11], 0
 ds_read_b128 v[200:203], v233 offset:32768
 v_mov_b32 v70, 0
 v_mov_b32 v71, 0
 v_mfma_f32_16x16x32_bf16 v[120:123], v[204:207], v[4:7], 0
 v_mov_b32 v72, 0
 v_mov_b32 v73, 0
 v_mfma_f32_16x16x32_bf16 v[128:131], v[204:207], v[8:11], 0
 ds_read_b128 v[204:207], v233 offset:33024
 v_mov_b32 v74, 0
 v_mov_b32 v75, 0
 s_waitcnt lgkmcnt(6)
 v_mfma_f32_16x16x32_bf16 v[116:119], v[208:211], v[12:15], v[116:119]
 v_mov_b32 v76, 0
 v_mov_b32 v77, 0
 v_mfma_f32_16x16x32_bf16 v[124:127], v[208:211], v[16:19], v[124:127]
 ds_read_b128 v[208:211], v233 offset:34816
 v_mov_b32 v78, 0
 v_mov_b32 v79, 0
 v_mfma_f32_16x16x32_bf16 v[120:123], v[212:215], v[12:15], v[120:123]
 v_mov_b32 v80, 0
 v_mov_b32 v81, 0
 v_mfma_f32_16x16x32_bf16 v[128:131], v[212:215], v[16:19], v[128:131]
 ds_read_b128 v[212:215], v233 offset:35072
 v_mov_b32 v82, 0
 v_mov_b32 v83, 0
 s_waitcnt lgkmcnt(6)
 v_mfma_f32_16x16x32_bf16 v[116:119], v[216:219], v[20:23], v[116:119]
 v_mov_b32 v84, 0
 v_mov_b32 v85, 0
 v_mfma_f32_16x16x32_bf16 v[124:127], v[216:219], v[24:27], v[124:127]
 ds_read_b128 v[216:219], v233 offset:36864
 v_mov_b32 v86, 0
 v_mov_b32 v87, 0
 v_mfma_f32_16x16x32_bf16 v[120:123], v[220:223], v[20:23], v[120:123]
 v_mov_b32 v88, 0
 v_mov_b32 v89, 0
 v_mfma_f32_16x16x32_bf16 v[128:131], v[220:223], v[24:27], v[128:131]
 ds_read_b128 v[220:223], v233 offset:37120
 v_mov_b32 v90, 0
 v_mov_b32 v91, 0
 s_waitcnt lgkmcnt(6)
 v_mfma_f32_16x16x32_bf16 v[116:119], v[224:227], v[28:31], v[116:119]
 v_mov_b32 v92, 0
 v_mov_b32 v93, 0
 v_mfma_f32_16x16x32_bf16 v[124:127], v[224:227], v[32:35], v[124:127]
 ds_read_b128 v[224:227], v233 offset:38912
 v_mov_b32 v94, 0
 v_mov_b32 v95, 0
 v_mfma_f32_16x16x32_bf16 v[120:123], v[228:231], v[28:31], v[120:123]
 v_mov_b32 v96, 0
 v_mov_b32 v97, 0
 v_mfma_f32_16x16x32_bf16 v[128:131], v[228:231], v[32:35], v[128:131]
 ds_read_b128 v[228:231], v233 offset:39168
 v_mov_b32 v98, 0
 v_mov_b32 v99, 0
 s_waitcnt lgkmcnt(4)
 v_mov_b32 v188, 0
 v_mov_b32 v189, 0
 v_mov_b32 v190, 0
 v_mov_b32 v191, 0
 s_lshr_b32 s41, s24, 1
 s_or_b32 s41, s41, s26
 s_cmp_eq_u32 s41, 0
 s_cbranch_scc0 KB_PNOMASKA
 s_lshl_b32 s41, s24, 5
 v_add_u32 v237, s41, v245
 v_cmp_gt_i32 s[44:45], 0, v237
 v_cmp_gt_i32 s[46:47], 1, v237
 v_cmp_gt_i32 s[48:49], 2, v237
 v_cmp_gt_i32 s[50:51], 3, v237
 v_cndmask_b32 v100, v100, v246, s[44:45]
 v_cndmask_b32 v101, v101, v246, s[46:47]
 v_cndmask_b32 v102, v102, v246, s[48:49]
 v_cndmask_b32 v103, v103, v246, s[50:51]
 v_cmp_gt_i32 s[44:45], 8, v237
 v_cmp_gt_i32 s[46:47], 9, v237
 v_cmp_gt_i32 s[48:49], 10, v237
 v_cmp_gt_i32 s[50:51], 11, v237
 v_cndmask_b32 v104, v104, v246, s[44:45]
 v_cndmask_b32 v105, v105, v246, s[46:47]
 v_cndmask_b32 v106, v106, v246, s[48:49]
 v_cndmask_b32 v107, v107, v246, s[50:51]
 v_cmp_gt_i32 s[44:45], -16, v237
 v_cmp_gt_i32 s[46:47], -15, v237
 v_cmp_gt_i32 s[48:49], -14, v237
 v_cmp_gt_i32 s[50:51], -13, v237
 v_cndmask_b32 v108, v108, v246, s[44:45]
 v_cndmask_b32 v109, v109, v246, s[46:47]
 v_cndmask_b32 v110, v110, v246, s[48:49]
 v_cndmask_b32 v111, v111, v246, s[50:51]
 v_cmp_gt_i32 s[44:45], -8, v237
 v_cmp_gt_i32 s[46:47], -7, v237
 v_cmp_gt_i32 s[48:49], -6, v237
 v_cmp_gt_i32 s[50:51], -5, v237
 v_cndmask_b32 v112, v112, v246, s[44:45]
 v_cndmask_b32 v113, v113, v246, s[46:47]
 v_cndmask_b32 v114, v114, v246, s[48:49]
 v_cndmask_b32 v115, v115, v246, s[50:51]
 v_cmp_gt_i32 s[44:45], 32, v237
 v_cmp_gt_i32 s[46:47], 33, v237
 v_cmp_gt_i32 s[48:49], 34, v237
 v_cmp_gt_i32 s[50:51], 35, v237
 v_cndmask_b32 v116, v116, v246, s[44:45]
 v_cndmask_b32 v117, v117, v246, s[46:47]
 v_cndmask_b32 v118, v118, v246, s[48:49]
 v_cndmask_b32 v119, v119, v246, s[50:51]
 v_cmp_gt_i32 s[44:45], 40, v237
 v_cmp_gt_i32 s[46:47], 41, v237
 v_cmp_gt_i32 s[48:49], 42, v237
 v_cmp_gt_i32 s[50:51], 43, v237
 v_cndmask_b32 v120, v120, v246, s[44:45]
 v_cndmask_b32 v121, v121, v246, s[46:47]
 v_cndmask_b32 v122, v122, v246, s[48:49]
 v_cndmask_b32 v123, v123, v246, s[50:51]
 v_cmp_gt_i32 s[44:45], 16, v237
 v_cmp_gt_i32 s[46:47], 17, v237
 v_cmp_gt_i32 s[48:49], 18, v237
 v_cmp_gt_i32 s[50:51], 19, v237
 v_cndmask_b32 v124, v124, v246, s[44:45]
 v_cndmask_b32 v125, v125, v246, s[46:47]
 v_cndmask_b32 v126, v126, v246, s[48:49]
 v_cndmask_b32 v127, v127, v246, s[50:51]
 v_cmp_gt_i32 s[44:45], 24, v237
 v_cmp_gt_i32 s[46:47], 25, v237
 v_cmp_gt_i32 s[48:49], 26, v237
 v_cmp_gt_i32 s[50:51], 27, v237
 v_cndmask_b32 v128, v128, v246, s[44:45]
 v_cndmask_b32 v129, v129, v246, s[46:47]
 v_cndmask_b32 v130, v130, v246, s[48:49]
 v_cndmask_b32 v131, v131, v246, s[50:51]
KB_PNOMASKA:
 v_max3_f32 v236, v100, v101, v102
 v_max3_f32 v235, v108, v109, v110
 v_max3_f32 v236, v236, v103, v104
 v_max3_f32 v235, v235, v111, v112
 v_max3_f32 v236, v236, v105, v106
 v_max3_f32 v235, v235, v113, v114
 v_max3_f32 v236, v236, v107, v116
 v_max3_f32 v235, v235, v115, v124
 v_max3_f32 v236, v236, v117, v118
 v_max3_f32 v235, v235, v125, v126
 v_max3_f32 v236, v236, v119, v120
 v_max3_f32 v235, v235, v127, v128
 v_max3_f32 v236, v236, v121, v122
 v_max3_f32 v235, v235, v129, v130
 v_max_f32 v236, v236, v123
 v_max_f32 v235, v235, v131
 v_mov_b32 v237, v236
 v_mov_b32 v240, v235
 s_nop 0
 v_permlane32_swap_b32 v236, v237
 v_permlane32_swap_b32 v235, v240
 v_max_f32 v236, v236, v237
 v_max_f32 v235, v235, v240
 v_mov_b32 v237, v236
 v_mov_b32 v240, v235
 s_nop 0
 v_permlane16_swap_b32 v236, v237
 v_permlane16_swap_b32 v235, v240
 v_max_f32 v236, v236, v237
 v_max_f32 v235, v235, v240
 v_sub_f32 v180, 0, v236
 v_sub_f32 v181, 0, v236
 v_sub_f32 v182, 0, v236
 v_sub_f32 v183, 0, v236
 v_sub_f32 v184, 0, v235
 v_sub_f32 v185, 0, v235
 v_sub_f32 v186, 0, v235
 v_sub_f32 v187, 0, v235
 v_sub_f32 v100, v100, v236
 v_sub_f32 v101, v101, v236
 v_sub_f32 v102, v102, v236
 v_sub_f32 v103, v103, v236
 v_sub_f32 v104, v104, v236
 v_sub_f32 v105, v105, v236
 v_sub_f32 v106, v106, v236
 v_sub_f32 v107, v107, v236
 v_sub_f32 v108, v108, v235
 v_sub_f32 v109, v109, v235
 v_sub_f32 v110, v110, v235
 v_sub_f32 v111, v111, v235
 v_sub_f32 v112, v112, v235
 v_sub_f32 v113, v113, v235
 v_sub_f32 v114, v114, v235
 v_sub_f32 v115, v115, v235
 v_sub_f32 v116, v116, v236
 v_sub_f32 v117, v117, v236
 v_sub_f32 v118, v118, v236
 v_sub_f32 v119, v119, v236
 v_sub_f32 v120, v120, v236
 v_sub_f32 v121, v121, v236
 v_sub_f32 v122, v122, v236
 v_sub_f32 v123, v123, v236
 v_sub_f32 v124, v124, v235
 v_sub_f32 v125, v125, v235
 v_sub_f32 v126, v126, v235
 v_sub_f32 v127, v127, v235
 v_sub_f32 v128, v128, v235
 v_sub_f32 v129, v129, v235
 v_sub_f32 v130, v130, v235
 v_sub_f32 v131, v131, v235
 v_exp_f32 v240, v100
 v_exp_f32 v241, v101
 v_exp_f32 v242, v102
 v_cvt_pk_bf16_f32 v164, v240, v241
 v_exp_f32 v243, v103
 v_exp_f32 v240, v104
 v_cvt_pk_bf16_f32 v165, v242, v243
 v_exp_f32 v241, v105
 v_exp_f32 v242, v106
 v_cvt_pk_bf16_f32 v166, v240, v241
 v_exp_f32 v243, v107
 v_exp_f32 v240, v108
 v_cvt_pk_bf16_f32 v167, v242, v243
 v_exp_f32 v241, v109
 v_exp_f32 v242, v110
 v_cvt_pk_bf16_f32 v168, v240, v241
 v_exp_f32 v243, v111
 v_exp_f32 v240, v112
 v_cvt_pk_bf16_f32 v169, v242, v243
 v_exp_f32 v241, v113
 v_exp_f32 v242, v114
 v_cvt_pk_bf16_f32 v170, v240, v241
 v_exp_f32 v243, v115
 s_nop 0
 v_cvt_pk_bf16_f32 v171, v242, v243
 s_waitcnt vmcnt(0)
 v_mov_b32 v242, s90
 v_mov_b32 v243, s91
 s_add_u32 s41, s89, -16384
 s_mov_b64 exec, 1
 buffer_store_dwordx2 v[242:243], off, s[96:99], s41 sc1
 s_mov_b64 exec, -1
 s_lshr_b32 s41, s24, 1
 s_add_u32 s30, s27, s41
 s_sub_u32 s30, s30, 3
KB_LOOPA:
 ds_write_b32 v244, v239
 v_mfma_f32_16x16x32_bf16 v[192:195], v[248:251], v[164:167], v[188:191]
 v_exp_f32 v240, v116
 v_mfma_f32_16x16x32_bf16 v[192:195], v[252:255], v[168:171], v[192:195]
 v_exp_f32 v241, v117
 v_mfma_f32_16x16x32_bf16 v[132:135], v[200:203], v[4:7], v[180:183]
 v_exp_f32 v242, v118
 v_mfma_f32_16x16x32_bf16 v[140:143], v[200:203], v[8:11], v[184:187]
 ds_read_b128 v[200:203], v233 offset:16384
 v_cvt_pk_bf16_f32 v172, v240, v241
 v_mfma_f32_16x16x32_bf16 v[136:139], v[204:207], v[4:7], v[180:183]
 v_exp_f32 v243, v119
 v_mfma_f32_16x16x32_bf16 v[144:147], v[204:207], v[8:11], v[184:187]
 ds_read_b128 v[204:207], v233 offset:16640
 v_mfma_f32_16x16x32_bf16 v[132:135], v[208:211], v[12:15], v[132:135]
 v_exp_f32 v240, v120
 v_mfma_f32_16x16x32_bf16 v[140:143], v[208:211], v[16:19], v[140:143]
 ds_read_b128 v[208:211], v233 offset:20480
 v_cvt_pk_bf16_f32 v173, v242, v243
 v_cmp_nge_f32 vcc, 0x53800000, v194
 s_cbranch_vccnz KB_RARE_UEA_0
KB_RET_UEA_0:
 v_mfma_f32_16x16x32_bf16 v[136:139], v[212:215], v[12:15], v[136:139]
 v_exp_f32 v241, v121
 v_mfma_f32_16x16x32_bf16 v[144:147], v[212:215], v[16:19], v[144:147]
 ds_read_b128 v[212:215], v233 offset:20736
 s_waitcnt lgkmcnt(5)
 v_mfma_f32_16x16x32_bf16 v[132:135], v[216:219], v[20:23], v[132:135]
 v_exp_f32 v242, v122
 v_mfma_f32_16x16x32_bf16 v[140:143], v[216:219], v[24:27], v[140:143]
 ds_read_b128 v[216:219], v233 offset:24576
 v_cvt_pk_bf16_f32 v174, v240, v241
 v_mfma_f32_16x16x32_bf16 v[136:139], v[220:223], v[20:23], v[136:139]
 v_exp_f32 v243, v123
 v_mfma_f32_16x16x32_bf16 v[144:147], v[220:223], v[24:27], v[144:147]
 ds_read_b128 v[220:223], v233 offset:24832
 v_mfma_f32_16x16x32_bf16 v[132:135], v[224:227], v[28:31], v[132:135]
 v_exp_f32 v240, v124
 v_mfma_f32_16x16x32_bf16 v[140:143], v[224:227], v[32:35], v[140:143]
 ds_read_b128 v[224:227], v233 offset:28672
 v_cvt_pk_bf16_f32 v175, v242, v243
 v_mfma_f32_16x16x32_bf16 v[136:139], v[228:231], v[28:31], v[136:139]
 v_exp_f32 v241, v125
 v_mfma_f32_16x16x32_bf16 v[144:147], v[228:231], v[32:35], v[144:147]
 ds_read_b128 v[228:231], v233 offset:28928
 s_waitcnt lgkmcnt(4)
 v_mfma_f32_16x16x32_bf16 v[36:39], v[200:203], v[164:167], v[36:39]
 v_exp_f32 v242, v126
 v_mfma_f32_16x16x32_bf16 v[44:47], v[200:203], v[168:171], v[44:47]
 ds_read_b128 v[200:203], v233 offset:40960
 v_cvt_pk_bf16_f32 v176, v240, v241
 v_mfma_f32_16x16x32_bf16 v[40:43], v[204:207], v[164:167], v[40:43]
 v_exp_f32 v243, v127
 v_mfma_f32_16x16x32_bf16 v[48:51], v[204:207], v[168:171], v[48:51]
 ds_read_b128 v[204:207], v233 offset:41216
 v_mfma_f32_16x16x32_bf16 v[52:55], v[208:211], v[164:167], v[52:55]
 v_exp_f32 v240, v128
 v_mfma_f32_16x16x32_bf16 v[60:63], v[208:211], v[168:171], v[60:63]
 ds_read_b128 v[208:211], v233 offset:43008
 v_cvt_pk_bf16_f32 v177, v242, v243
 v_mfma_f32_16x16x32_bf16 v[56:59], v[212:215], v[164:167], v[56:59]
 v_exp_f32 v241, v129
 v_mfma_f32_16x16x32_bf16 v[64:67], v[212:215], v[168:171], v[64:67]
 ds_read_b128 v[212:215], v233 offset:43264
 s_waitcnt lgkmcnt(4)
 v_mfma_f32_16x16x32_bf16 v[68:71], v[216:219], v[164:167], v[68:71]
 v_exp_f32 v242, v130
 v_mfma_f32_16x16x32_bf16 v[76:79], v[216:219], v[168:171], v[76:79]
 ds_read_b128 v[216:219], v233 offset:45056
 v_cvt_pk_bf16_f32 v178, v240, v241
 v_mfma_f32_16x16x32_bf16 v[72:75], v[220:223], v[164:167], v[72:75]
 v_exp_f32 v243, v131
 v_mfma_f32_16x16x32_bf16 v[80:83], v[220:223], v[168:171], v[80:83]
 ds_read_b128 v[220:223], v233 offset:45312
 v_cvt_pk_bf16_f32 v179, v242, v243
 v_mfma_f32_16x16x32_bf16 v[84:87], v[224:227], v[164:167], v[84:87]
 v_mfma_f32_16x16x32_bf16 v[92:95], v[224:227], v[168:171], v[92:95]
 ds_read_b128 v[224:227], v233 offset:47104
 v_mfma_f32_16x16x32_bf16 v[88:91], v[228:231], v[164:167], v[88:91]
 v_mfma_f32_16x16x32_bf16 v[96:99], v[228:231], v[168:171], v[96:99]
 ds_read_b128 v[228:231], v233 offset:47360
 s_waitcnt lgkmcnt(4)
 v_mfma_f32_16x16x32_bf16 v[188:191], v[248:251], v[172:175], v[192:195]
 v_exp_f32 v240, v132
 v_mfma_f32_16x16x32_bf16 v[188:191], v[252:255], v[176:179], v[188:191]
 v_exp_f32 v241, v133
 v_mfma_f32_16x16x32_bf16 v[148:151], v[200:203], v[4:7], v[180:183]
 v_exp_f32 v242, v134
 v_mfma_f32_16x16x32_bf16 v[156:159], v[200:203], v[8:11], v[184:187]
 ds_read_b128 v[200:203], v233 offset:18432
 v_cvt_pk_bf16_f32 v164, v240, v241
 v_mfma_f32_16x16x32_bf16 v[152:155], v[204:207], v[4:7], v[180:183]
 v_exp_f32 v243, v135
 v_mfma_f32_16x16x32_bf16 v[160:163], v[204:207], v[8:11], v[184:187]
 ds_read_b128 v[204:207], v233 offset:18688
 v_mfma_f32_16x16x32_bf16 v[148:151], v[208:211], v[12:15], v[148:151]
 v_exp_f32 v240, v136
 v_mfma_f32_16x16x32_bf16 v[156:159], v[208:211], v[16:19], v[156:159]
 ds_read_b128 v[208:211], v233 offset:22528
 v_cvt_pk_bf16_f32 v165, v242, v243
 v_cmp_nge_f32 vcc, 0x53800000, v190
 s_cbranch_vccnz KB_RARE_UEA_1
KB_RET_UEA_1:
 v_mfma_f32_16x16x32_bf16 v[152:155], v[212:215], v[12:15], v[152:155]
 v_exp_f32 v241, v137
 v_mfma_f32_16x16x32_bf16 v[160:163], v[212:215], v[16:19], v[160:163]
 ds_read_b32 v238, v232
 ds_read_b128 v[212:215], v233 offset:22784
 s_waitcnt lgkmcnt(5)
 v_mfma_f32_16x16x32_bf16 v[148:151], v[216:219], v[20:23], v[148:151]
 v_exp_f32 v242, v138
 v_mfma_f32_16x16x32_bf16 v[156:159], v[216:219], v[24:27], v[156:159]
 ds_read_b128 v[216:219], v233 offset:26624
 v_cvt_pk_bf16_f32 v166, v240, v241
 v_mfma_f32_16x16x32_bf16 v[152:155], v[220:223], v[20:23], v[152:155]
 v_exp_f32 v243, v139
 v_mfma_f32_16x16x32_bf16 v[160:163], v[220:223], v[24:27], v[160:163]
 ds_read_b128 v[220:223], v233 offset:26880
 v_mfma_f32_16x16x32_bf16 v[148:151], v[224:227], v[28:31], v[148:151]
 v_exp_f32 v240, v140
 v_mfma_f32_16x16x32_bf16 v[156:159], v[224:227], v[32:35], v[156:159]
 ds_read_b128 v[224:227], v233 offset:30720
 v_cvt_pk_bf16_f32 v167, v242, v243
 v_mfma_f32_16x16x32_bf16 v[152:155], v[228:231], v[28:31], v[152:155]
 v_exp_f32 v241, v141
 v_mfma_f32_16x16x32_bf16 v[160:163], v[228:231], v[32:35], v[160:163]
 ds_read_b128 v[228:231], v233 offset:30976
 s_waitcnt lgkmcnt(4)
 v_mfma_f32_16x16x32_bf16 v[36:39], v[200:203], v[172:175], v[36:39]
 v_cmp_lt_u32 vcc, v238, v239
 s_cbranch_vccnz KB_SPIN_UEA
KB_SPR_UEA:
 v_mfma_f32_16x16x32_bf16 v[44:47], v[200:203], v[176:179], v[44:47]
 ds_read_b128 v[200:203], v234 offset:0
 v_add_u32 v239, 1, v239
 v_mfma_f32_16x16x32_bf16 v[40:43], v[204:207], v[172:175], v[40:43]
 v_exp_f32 v242, v142
 v_mfma_f32_16x16x32_bf16 v[48:51], v[204:207], v[176:179], v[48:51]
 ds_read_b128 v[204:207], v234 offset:256
 ds_write_b32 v244, v239 offset:3072
 v_mfma_f32_16x16x32_bf16 v[52:55], v[208:211], v[172:175], v[52:55]
 v_cvt_pk_bf16_f32 v168, v240, v241
 v_mfma_f32_16x16x32_bf16 v[60:63], v[208:211], v[176:179], v[60:63]
 ds_read_b128 v[208:211], v234 offset:2048
 v_mfma_f32_16x16x32_bf16 v[56:59], v[212:215], v[172:175], v[56:59]
 v_exp_f32 v243, v143
 v_mfma_f32_16x16x32_bf16 v[64:67], v[212:215], v[176:179], v[64:67]
 ds_read_b128 v[212:215], v234 offset:2304
 s_waitcnt lgkmcnt(5)
 v_mfma_f32_16x16x32_bf16 v[68:71], v[216:219], v[172:175], v[68:71]
 v_exp_f32 v240, v144
 v_mfma_f32_16x16x32_bf16 v[76:79], v[216:219], v[176:179], v[76:79]
 ds_read_b128 v[216:219], v234 offset:4096
 v_cvt_pk_bf16_f32 v169, v242, v243
 v_mfma_f32_16x16x32_bf16 v[72:75], v[220:223], v[172:175], v[72:75]
 v_exp_f32 v241, v145
 v_mfma_f32_16x16x32_bf16 v[80:83], v[220:223], v[176:179], v[80:83]
 ds_read_b128 v[220:223], v234 offset:4352
 v_mfma_f32_16x16x32_bf16 v[84:87], v[224:227], v[172:175], v[84:87]
 v_exp_f32 v242, v146
 v_mfma_f32_16x16x32_bf16 v[92:95], v[224:227], v[176:179], v[92:95]
 ds_read_b128 v[224:227], v234 offset:6144
 v_cvt_pk_bf16_f32 v170, v240, v241
 v_mfma_f32_16x16x32_bf16 v[88:91], v[228:231], v[172:175], v[88:91]
 v_exp_f32 v243, v147
 v_mfma_f32_16x16x32_bf16 v[96:99], v[228:231], v[176:179], v[96:99]
 ds_read_b128 v[228:231], v234 offset:6400
 s_waitcnt lgkmcnt(4)
 v_cvt_pk_bf16_f32 v171, v242, v243
 s_sub_u32 s30, s30, 1
 s_cmp_eq_u32 s30, 0
 s_cbranch_scc1 KB_X1A
 ds_write_b32 v244, v239
 v_mfma_f32_16x16x32_bf16 v[192:195], v[248:251], v[164:167], v[188:191]
 v_exp_f32 v240, v148
 v_mfma_f32_16x16x32_bf16 v[192:195], v[252:255], v[168:171], v[192:195]
 v_exp_f32 v241, v149
 v_mfma_f32_16x16x32_bf16 v[100:103], v[200:203], v[4:7], v[180:183]
 v_exp_f32 v242, v150
 v_mfma_f32_16x16x32_bf16 v[108:111], v[200:203], v[8:11], v[184:187]
 ds_read_b128 v[200:203], v233 offset:49152
 v_cvt_pk_bf16_f32 v172, v240, v241
 v_mfma_f32_16x16x32_bf16 v[104:107], v[204:207], v[4:7], v[180:183]
 v_exp_f32 v243, v151
 v_mfma_f32_16x16x32_bf16 v[112:115], v[204:207], v[8:11], v[184:187]
 ds_read_b128 v[204:207], v233 offset:49408
 v_mfma_f32_16x16x32_bf16 v[100:103], v[208:211], v[12:15], v[100:103]
 v_exp_f32 v240, v152
 v_mfma_f32_16x16x32_bf16 v[108:111], v[208:211], v[16:19], v[108:111]
 ds_read_b128 v[208:211], v233 offset:53248
 v_cvt_pk_bf16_f32 v173, v242, v243
 v_cmp_nge_f32 vcc, 0x53800000, v194
 s_cbranch_vccnz KB_RARE_UOA_0
KB_RET_UOA_0:
 v_mfma_f32_16x16x32_bf16 v[104:107], v[212:215], v[12:15], v[104:107]
 v_exp_f32 v241, v153
 v_mfma_f32_16x16x32_bf16 v[112:115], v[212:215], v[16:19], v[112:115]
 ds_read_b128 v[212:215], v233 offset:53504
 s_waitcnt lgkmcnt(5)
 v_mfma_f32_16x16x32_bf16 v[100:103], v[216:219], v[20:23], v[100:103]
 v_exp_f32 v242, v154
 v_mfma_f32_16x16x32_bf16 v[108:111], v[216:219], v[24:27], v[108:111]
 ds_read_b128 v[216:219], v233 offset:57344
 v_cvt_pk_bf16_f32 v174, v240, v241
 v_mfma_f32_16x16x32_bf16 v[104:107], v[220:223], v[20:23], v[104:107]
 v_exp_f32 v243, v155
 v_mfma_f32_16x16x32_bf16 v[112:115], v[220:223], v[24:27], v[112:115]
 ds_read_b128 v[220:223], v233 offset:57600
 v_mfma_f32_16x16x32_bf16 v[100:103], v[224:227], v[28:31], v[100:103]
 v_exp_f32 v240, v156
 v_mfma_f32_16x16x32_bf16 v[108:111], v[224:227], v[32:35], v[108:111]
 ds_read_b128 v[224:227], v233 offset:61440
 v_cvt_pk_bf16_f32 v175, v242, v243
 v_mfma_f32_16x16x32_bf16 v[104:107], v[228:231], v[28:31], v[104:107]
 v_exp_f32 v241, v157
 v_mfma_f32_16x16x32_bf16 v[112:115], v[228:231], v[32:35], v[112:115]
 ds_read_b128 v[228:231], v233 offset:61696
 s_waitcnt lgkmcnt(4)
 v_mfma_f32_16x16x32_bf16 v[36:39], v[200:203], v[164:167], v[36:39]
 v_exp_f32 v242, v158
 v_mfma_f32_16x16x32_bf16 v[44:47], v[200:203], v[168:171], v[44:47]
 ds_read_b128 v[200:203], v234 offset:8192
 v_cvt_pk_bf16_f32 v176, v240, v241
 v_mfma_f32_16x16x32_bf16 v[40:43], v[204:207], v[164:167], v[40:43]
 v_exp_f32 v243, v159
 v_mfma_f32_16x16x32_bf16 v[48:51], v[204:207], v[168:171], v[48:51]
 ds_read_b128 v[204:207], v234 offset:8448
 v_mfma_f32_16x16x32_bf16 v[52:55], v[208:211], v[164:167], v[52:55]
 v_exp_f32 v240, v160
 v_mfma_f32_16x16x32_bf16 v[60:63], v[208:211], v[168:171], v[60:63]
 ds_read_b128 v[208:211], v234 offset:10240
 v_cvt_pk_bf16_f32 v177, v242, v243
 v_mfma_f32_16x16x32_bf16 v[56:59], v[212:215], v[164:167], v[56:59]
 v_exp_f32 v241, v161
 v_mfma_f32_16x16x32_bf16 v[64:67], v[212:215], v[168:171], v[64:67]
 ds_read_b128 v[212:215], v234 offset:10496
 s_waitcnt lgkmcnt(4)
 v_mfma_f32_16x16x32_bf16 v[68:71], v[216:219], v[164:167], v[68:71]
 v_exp_f32 v242, v162
 v_mfma_f32_16x16x32_bf16 v[76:79], v[216:219], v[168:171], v[76:79]
 ds_read_b128 v[216:219], v234 offset:12288
 v_cvt_pk_bf16_f32 v178, v240, v241
 v_mfma_f32_16x16x32_bf16 v[72:75], v[220:223], v[164:167], v[72:75]
 v_exp_f32 v243, v163
 v_mfma_f32_16x16x32_bf16 v[80:83], v[220:223], v[168:171], v[80:83]
 ds_read_b128 v[220:223], v234 offset:12544
 v_cvt_pk_bf16_f32 v179, v242, v243
 v_mfma_f32_16x16x32_bf16 v[84:87], v[224:227], v[164:167], v[84:87]
 v_mfma_f32_16x16x32_bf16 v[92:95], v[224:227], v[168:171], v[92:95]
 ds_read_b128 v[224:227], v234 offset:14336
 v_mfma_f32_16x16x32_bf16 v[88:91], v[228:231], v[164:167], v[88:91]
 v_mfma_f32_16x16x32_bf16 v[96:99], v[228:231], v[168:171], v[96:99]
 ds_read_b128 v[228:231], v234 offset:14592
 s_waitcnt lgkmcnt(4)
 v_mfma_f32_16x16x32_bf16 v[188:191], v[248:251], v[172:175], v[192:195]
 v_exp_f32 v240, v100
 v_mfma_f32_16x16x32_bf16 v[188:191], v[252:255], v[176:179], v[188:191]
 v_exp_f32 v241, v101
 v_mfma_f32_16x16x32_bf16 v[116:119], v[200:203], v[4:7], v[180:183]
 v_exp_f32 v242, v102
 v_mfma_f32_16x16x32_bf16 v[124:127], v[200:203], v[8:11], v[184:187]
 ds_read_b128 v[200:203], v233 offset:51200
 v_cvt_pk_bf16_f32 v164, v240, v241
 v_mfma_f32_16x16x32_bf16 v[120:123], v[204:207], v[4:7], v[180:183]
 v_exp_f32 v243, v103
 v_mfma_f32_16x16x32_bf16 v[128:131], v[204:207], v[8:11], v[184:187]
 ds_read_b128 v[204:207], v233 offset:51456
 v_mfma_f32_16x16x32_bf16 v[116:119], v[208:211], v[12:15], v[116:119]
 v_exp_f32 v240, v104
 v_mfma_f32_16x16x32_bf16 v[124:127], v[208:211], v[16:19], v[124:127]
 ds_read_b128 v[208:211], v233 offset:55296
 v_cvt_pk_bf16_f32 v165, v242, v243
 v_cmp_nge_f32 vcc, 0x53800000, v190
 s_cbranch_vccnz KB_RARE_UOA_1
KB_RET_UOA_1:
 v_mfma_f32_16x16x32_bf16 v[120:123], v[212:215], v[12:15], v[120:123]
 v_exp_f32 v241, v105
 v_mfma_f32_16x16x32_bf16 v[128:131], v[212:215], v[16:19], v[128:131]
 ds_read_b32 v238, v232
 ds_read_b128 v[212:215], v233 offset:55552
 s_waitcnt lgkmcnt(5)
 v_mfma_f32_16x16x32_bf16 v[116:119], v[216:219], v[20:23], v[116:119]
 v_exp_f32 v242, v106
 v_mfma_f32_16x16x32_bf16 v[124:127], v[216:219], v[24:27], v[124:127]
 ds_read_b128 v[216:219], v233 offset:59392
 v_cvt_pk_bf16_f32 v166, v240, v241
 v_mfma_f32_16x16x32_bf16 v[120:123], v[220:223], v[20:23], v[120:123]
 v_exp_f32 v243, v107
 v_mfma_f32_16x16x32_bf16 v[128:131], v[220:223], v[24:27], v[128:131]
 ds_read_b128 v[220:223], v233 offset:59648
 v_mfma_f32_16x16x32_bf16 v[116:119], v[224:227], v[28:31], v[116:119]
 v_exp_f32 v240, v108
 v_mfma_f32_16x16x32_bf16 v[124:127], v[224:227], v[32:35], v[124:127]
 ds_read_b128 v[224:227], v233 offset:63488
 v_cvt_pk_bf16_f32 v167, v242, v243
 v_mfma_f32_16x16x32_bf16 v[120:123], v[228:231], v[28:31], v[120:123]
 v_exp_f32 v241, v109
 v_mfma_f32_16x16x32_bf16 v[128:131], v[228:231], v[32:35], v[128:131]
 ds_read_b128 v[228:231], v233 offset:63744
 v_swap_b32 v233, v234
 s_waitcnt lgkmcnt(4)
 v_mfma_f32_16x16x32_bf16 v[36:39], v[200:203], v[172:175], v[36:39]
 v_cmp_lt_u32 vcc, v238, v239
 s_cbranch_vccnz KB_SPIN_UOA
KB_SPR_UOA:
 v_mfma_f32_16x16x32_bf16 v[44:47], v[200:203], v[176:179], v[44:47]
 ds_read_b128 v[200:203], v233 offset:32768
 v_add_u32 v239, 1, v239
 v_mfma_f32_16x16x32_bf16 v[40:43], v[204:207], v[172:175], v[40:43]
 v_exp_f32 v242, v110
 v_mfma_f32_16x16x32_bf16 v[48:51], v[204:207], v[176:179], v[48:51]
 ds_read_b128 v[204:207], v233 offset:33024
 ds_write_b32 v244, v239 offset:3072
 v_mfma_f32_16x16x32_bf16 v[52:55], v[208:211], v[172:175], v[52:55]
 v_cvt_pk_bf16_f32 v168, v240, v241
 v_mfma_f32_16x16x32_bf16 v[60:63], v[208:211], v[176:179], v[60:63]
 ds_read_b128 v[208:211], v233 offset:34816
 v_mfma_f32_16x16x32_bf16 v[56:59], v[212:215], v[172:175], v[56:59]
 v_exp_f32 v243, v111
 v_mfma_f32_16x16x32_bf16 v[64:67], v[212:215], v[176:179], v[64:67]
 ds_read_b128 v[212:215], v233 offset:35072
 s_waitcnt lgkmcnt(5)
 v_mfma_f32_16x16x32_bf16 v[68:71], v[216:219], v[172:175], v[68:71]
 v_exp_f32 v240, v112
 v_mfma_f32_16x16x32_bf16 v[76:79], v[216:219], v[176:179], v[76:79]
 ds_read_b128 v[216:219], v233 offset:36864
 v_cvt_pk_bf16_f32 v169, v242, v243
 v_mfma_f32_16x16x32_bf16 v[72:75], v[220:223], v[172:175], v[72:75]
 v_exp_f32 v241, v113
 v_mfma_f32_16x16x32_bf16 v[80:83], v[220:223], v[176:179], v[80:83]
 ds_read_b128 v[220:223], v233 offset:37120
 v_mfma_f32_16x16x32_bf16 v[84:87], v[224:227], v[172:175], v[84:87]
 v_exp_f32 v242, v114
 v_mfma_f32_16x16x32_bf16 v[92:95], v[224:227], v[176:179], v[92:95]
 ds_read_b128 v[224:227], v233 offset:38912
 v_cvt_pk_bf16_f32 v170, v240, v241
 v_mfma_f32_16x16x32_bf16 v[88:91], v[228:231], v[172:175], v[88:91]
 v_exp_f32 v243, v115
 v_mfma_f32_16x16x32_bf16 v[96:99], v[228:231], v[176:179], v[96:99]
 ds_read_b128 v[228:231], v233 offset:39168
 s_waitcnt lgkmcnt(4)
 v_cvt_pk_bf16_f32 v171, v242, v243
 s_sub_u32 s30, s30, 1
 s_cmp_eq_u32 s30, 0
 s_cbranch_scc0 KB_LOOPA
KB_X0A:
 s_bitcmp1_b32 s24, 0
 s_cbranch_scc0 KB_X0AA
 ds_write_b32 v244, v239
 v_mfma_f32_16x16x32_bf16 v[192:195], v[248:251], v[164:167], v[188:191]
 v_exp_f32 v240, v116
 v_mfma_f32_16x16x32_bf16 v[192:195], v[252:255], v[168:171], v[192:195]
 v_exp_f32 v241, v117
 v_mfma_f32_16x16x32_bf16 v[132:135], v[200:203], v[4:7], v[180:183]
 v_exp_f32 v242, v118
 v_mfma_f32_16x16x32_bf16 v[140:143], v[200:203], v[8:11], v[184:187]
 ds_read_b128 v[200:203], v233 offset:16384
 v_cvt_pk_bf16_f32 v172, v240, v241
 v_mfma_f32_16x16x32_bf16 v[136:139], v[204:207], v[4:7], v[180:183]
 v_exp_f32 v243, v119
 v_mfma_f32_16x16x32_bf16 v[144:147], v[204:207], v[8:11], v[184:187]
 ds_read_b128 v[204:207], v233 offset:16640
 v_mfma_f32_16x16x32_bf16 v[132:135], v[208:211], v[12:15], v[132:135]
 v_exp_f32 v240, v120
 v_mfma_f32_16x16x32_bf16 v[140:143], v[208:211], v[16:19], v[140:143]
 ds_read_b128 v[208:211], v233 offset:20480
 v_cvt_pk_bf16_f32 v173, v242, v243
 v_cmp_nge_f32 vcc, 0x53800000, v194
 s_cbranch_vccnz KB_RARE_B0A_0
KB_RET_B0A_0:
 v_mfma_f32_16x16x32_bf16 v[136:139], v[212:215], v[12:15], v[136:139]
 v_exp_f32 v241, v121
 v_mfma_f32_16x16x32_bf16 v[144:147], v[212:215], v[16:19], v[144:147]
 ds_read_b128 v[212:215], v233 offset:20736
 s_waitcnt lgkmcnt(5)
 v_mfma_f32_16x16x32_bf16 v[132:135], v[216:219], v[20:23], v[132:135]
 v_exp_f32 v242, v122
 v_mfma_f32_16x16x32_bf16 v[140:143], v[216:219], v[24:27], v[140:143]
 ds_read_b128 v[216:219], v233 offset:24576
 v_cvt_pk_bf16_f32 v174, v240, v241
 v_mfma_f32_16x16x32_bf16 v[136:139], v[220:223], v[20:23], v[136:139]
 v_exp_f32 v243, v123
 v_mfma_f32_16x16x32_bf16 v[144:147], v[220:223], v[24:27], v[144:147]
 ds_read_b128 v[220:223], v233 offset:24832
 v_mfma_f32_16x16x32_bf16 v[132:135], v[224:227], v[28:31], v[132:135]
 v_exp_f32 v240, v124
 v_mfma_f32_16x16x32_bf16 v[140:143], v[224:227], v[32:35], v[140:143]
 ds_read_b128 v[224:227], v233 offset:28672
 v_cvt_pk_bf16_f32 v175, v242, v243
 v_mfma_f32_16x16x32_bf16 v[136:139], v[228:231], v[28:31], v[136:139]
 v_exp_f32 v241, v125
 v_mfma_f32_16x16x32_bf16 v[144:147], v[228:231], v[32:35], v[144:147]
 ds_read_b128 v[228:231], v233 offset:28928
 s_waitcnt lgkmcnt(4)
 v_mfma_f32_16x16x32_bf16 v[36:39], v[200:203], v[164:167], v[36:39]
 v_exp_f32 v242, v126
 v_mfma_f32_16x16x32_bf16 v[44:47], v[200:203], v[168:171], v[44:47]
 ds_read_b128 v[200:203], v233 offset:40960
 v_cvt_pk_bf16_f32 v176, v240, v241
 v_mfma_f32_16x16x32_bf16 v[40:43], v[204:207], v[164:167], v[40:43]
 v_exp_f32 v243, v127
 v_mfma_f32_16x16x32_bf16 v[48:51], v[204:207], v[168:171], v[48:51]
 ds_read_b128 v[204:207], v233 offset:41216
 v_mfma_f32_16x16x32_bf16 v[52:55], v[208:211], v[164:167], v[52:55]
 v_exp_f32 v240, v128
 v_mfma_f32_16x16x32_bf16 v[60:63], v[208:211], v[168:171], v[60:63]
 ds_read_b128 v[208:211], v233 offset:43008
 v_cvt_pk_bf16_f32 v177, v242, v243
 v_mfma_f32_16x16x32_bf16 v[56:59], v[212:215], v[164:167], v[56:59]
 v_exp_f32 v241, v129
 v_mfma_f32_16x16x32_bf16 v[64:67], v[212:215], v[168:171], v[64:67]
 ds_read_b128 v[212:215], v233 offset:43264
 s_waitcnt lgkmcnt(4)
 v_mfma_f32_16x16x32_bf16 v[68:71], v[216:219], v[164:167], v[68:71]
 v_exp_f32 v242, v130
 v_mfma_f32_16x16x32_bf16 v[76:79], v[216:219], v[168:171], v[76:79]
 ds_read_b128 v[216:219], v233 offset:45056
 v_cvt_pk_bf16_f32 v178, v240, v241
 v_mfma_f32_16x16x32_bf16 v[72:75], v[220:223], v[164:167], v[72:75]
 v_exp_f32 v243, v131
 v_mfma_f32_16x16x32_bf16 v[80:83], v[220:223], v[168:171], v[80:83]
 ds_read_b128 v[220:223], v233 offset:45312
 v_cvt_pk_bf16_f32 v179, v242, v243
 v_mfma_f32_16x16x32_bf16 v[84:87], v[224:227], v[164:167], v[84:87]
 v_mfma_f32_16x16x32_bf16 v[92:95], v[224:227], v[168:171], v[92:95]
 ds_read_b128 v[224:227], v233 offset:47104
 v_mfma_f32_16x16x32_bf16 v[88:91], v[228:231], v[164:167], v[88:91]
 v_mfma_f32_16x16x32_bf16 v[96:99], v[228:231], v[168:171], v[96:99]
 ds_read_b128 v[228:231], v233 offset:47360
 s_waitcnt lgkmcnt(4)
 v_mfma_f32_16x16x32_bf16 v[188:191], v[248:251], v[172:175], v[192:195]
 v_exp_f32 v240, v132
 v_exp_f32 v241, v133
 v_mfma_f32_16x16x32_bf16 v[188:191], v[252:255], v[176:179], v[188:191]
 v_exp_f32 v242, v134
 v_mfma_f32_16x16x32_bf16 v[148:151], v[200:203], v[4:7], v[180:183]
 v_cvt_pk_bf16_f32 v164, v240, v241
 v_exp_f32 v243, v135
 v_mfma_f32_16x16x32_bf16 v[156:159], v[200:203], v[8:11], v[184:187]
 ds_read_b128 v[200:203], v233 offset:18432
 v_exp_f32 v240, v136
 v_mfma_f32_16x16x32_bf16 v[152:155], v[204:207], v[4:7], v[180:183]
 v_cvt_pk_bf16_f32 v165, v242, v243
 v_exp_f32 v241, v137
 v_mfma_f32_16x16x32_bf16 v[160:163], v[204:207], v[8:11], v[184:187]
 ds_read_b128 v[204:207], v233 offset:18688
 v_exp_f32 v242, v138
 v_mfma_f32_16x16x32_bf16 v[148:151], v[208:211], v[12:15], v[148:151]
 v_cvt_pk_bf16_f32 v166, v240, v241
 v_exp_f32 v243, v139
 v_mfma_f32_16x16x32_bf16 v[156:159], v[208:211], v[16:19], v[156:159]
 ds_read_b128 v[208:211], v233 offset:22528
 v_exp_f32 v240, v140
 v_cmp_nge_f32 vcc, 0x53800000, v190
 s_cbranch_vccnz KB_RARE_B0A_1
KB_RET_B0A_1:
 v_mfma_f32_16x16x32_bf16 v[152:155], v[212:215], v[12:15], v[152:155]
 v_cvt_pk_bf16_f32 v167, v242, v243
 v_exp_f32 v241, v141
 v_mfma_f32_16x16x32_bf16 v[160:163], v[212:215], v[16:19], v[160:163]
 ds_read_b32 v238, v232
 ds_read_b128 v[212:215], v233 offset:22784
 s_waitcnt lgkmcnt(5)
 v_mfma_f32_16x16x32_bf16 v[148:151], v[216:219], v[20:23], v[148:151]
 v_exp_f32 v242, v142
 v_mfma_f32_16x16x32_bf16 v[156:159], v[216:219], v[24:27], v[156:159]
 ds_read_b128 v[216:219], v233 offset:26624
 v_cvt_pk_bf16_f32 v168, v240, v241
 v_mfma_f32_16x16x32_bf16 v[152:155], v[220:223], v[20:23], v[152:155]
 v_exp_f32 v243, v143
 v_mfma_f32_16x16x32_bf16 v[160:163], v[220:223], v[24:27], v[160:163]
 ds_read_b128 v[220:223], v233 offset:26880
 v_exp_f32 v240, v144
 v_mfma_f32_16x16x32_bf16 v[148:151], v[224:227], v[28:31], v[148:151]
 v_cvt_pk_bf16_f32 v169, v242, v243
 v_exp_f32 v241, v145
 v_mfma_f32_16x16x32_bf16 v[156:159], v[224:227], v[32:35], v[156:159]
 ds_read_b128 v[224:227], v233 offset:30720
 v_exp_f32 v242, v146
 v_mfma_f32_16x16x32_bf16 v[152:155], v[228:231], v[28:31], v[152:155]
 v_cvt_pk_bf16_f32 v170, v240, v241
 v_exp_f32 v243, v147
 v_mfma_f32_16x16x32_bf16 v[160:163], v[228:231], v[32:35], v[160:163]
 ds_read_b128 v[228:231], v233 offset:30976
 s_waitcnt lgkmcnt(4)
 v_mfma_f32_16x16x32_bf16 v[36:39], v[200:203], v[172:175], v[36:39]
 v_cmp_lt_u32 vcc, v238, v239
 s_cbranch_vccnz KB_SPIN_B0A
KB_SPR_B0A:
 v_mfma_f32_16x16x32_bf16 v[44:47], v[200:203], v[176:179], v[44:47]
 ds_read_b128 v[200:203], v233 offset:49152
 v_add_u32 v239, 1, v239
 v_mfma_f32_16x16x32_bf16 v[40:43], v[204:207], v[172:175], v[40:43]
 v_cvt_pk_bf16_f32 v171, v242, v243
 v_mfma_f32_16x16x32_bf16 v[48:51], v[204:207], v[176:179], v[48:51]
 ds_read_b128 v[204:207], v233 offset:49408
 ds_write_b32 v244, v239 offset:3072
 v_cmp_gt_i32 s[44:45], 0, v245
 v_cmp_gt_i32 s[46:47], 1, v245
 v_mfma_f32_16x16x32_bf16 v[52:55], v[208:211], v[172:175], v[52:55]
 v_cmp_gt_i32 s[48:49], 2, v245
 v_cmp_gt_i32 s[50:51], 3, v245
 v_cndmask_b32 v148, v148, v246, s[44:45]
 v_mfma_f32_16x16x32_bf16 v[60:63], v[208:211], v[176:179], v[60:63]
 ds_read_b128 v[208:211], v233 offset:53248
 v_cndmask_b32 v149, v149, v246, s[46:47]
 v_cndmask_b32 v150, v150, v246, s[48:49]
 v_mfma_f32_16x16x32_bf16 v[56:59], v[212:215], v[172:175], v[56:59]
 v_cndmask_b32 v151, v151, v246, s[50:51]
 v_cmp_gt_i32 s[44:45], 8, v245
 v_cmp_gt_i32 s[46:47], 9, v245
 v_mfma_f32_16x16x32_bf16 v[64:67], v[212:215], v[176:179], v[64:67]
 ds_read_b128 v[212:215], v233 offset:53504
 s_waitcnt lgkmcnt(5)
 v_mfma_f32_16x16x32_bf16 v[68:71], v[216:219], v[172:175], v[68:71]
 v_cmp_gt_i32 s[48:49], 10, v245
 v_cmp_gt_i32 s[50:51], 11, v245
 v_cndmask_b32 v152, v152, v246, s[44:45]
 v_mfma_f32_16x16x32_bf16 v[76:79], v[216:219], v[176:179], v[76:79]
 ds_read_b128 v[216:219], v233 offset:57344
 v_cndmask_b32 v153, v153, v246, s[46:47]
 v_cndmask_b32 v154, v154, v246, s[48:49]
 v_mfma_f32_16x16x32_bf16 v[72:75], v[220:223], v[172:175], v[72:75]
 v_cndmask_b32 v155, v155, v246, s[50:51]
 v_cmp_gt_i32 s[44:45], -16, v245
 v_cmp_gt_i32 s[46:47], -15, v245
 v_mfma_f32_16x16x32_bf16 v[80:83], v[220:223], v[176:179], v[80:83]
 ds_read_b128 v[220:223], v233 offset:57600
 v_cmp_gt_i32 s[48:49], -14, v245
 v_mfma_f32_16x16x32_bf16 v[84:87], v[224:227], v[172:175], v[84:87]
 v_cmp_gt_i32 s[50:51], -13, v245
 v_cndmask_b32 v156, v156, v246, s[44:45]
 v_cndmask_b32 v157, v157, v246, s[46:47]
 v_mfma_f32_16x16x32_bf16 v[92:95], v[224:227], v[176:179], v[92:95]
 ds_read_b128 v[224:227], v233 offset:61440
 v_cndmask_b32 v158, v158, v246, s[48:49]
 v_cndmask_b32 v159, v159, v246, s[50:51]
 v_mfma_f32_16x16x32_bf16 v[88:91], v[228:231], v[172:175], v[88:91]
 v_cmp_gt_i32 s[44:45], -8, v245
 v_cmp_gt_i32 s[46:47], -7, v245
 v_cmp_gt_i32 s[48:49], -6, v245
 v_mfma_f32_16x16x32_bf16 v[96:99], v[228:231], v[176:179], v[96:99]
 ds_read_b128 v[228:231], v233 offset:61696
 s_waitcnt lgkmcnt(4)
 v_cmp_gt_i32 s[50:51], -5, v245
 v_cndmask_b32 v160, v160, v246, s[44:45]
 v_cndmask_b32 v161, v161, v246, s[46:47]
 v_cndmask_b32 v162, v162, v246, s[48:49]
 v_cndmask_b32 v163, v163, v246, s[50:51]
 ds_write_b32 v244, v239
 v_mfma_f32_16x16x32_bf16 v[192:195], v[248:251], v[164:167], v[188:191]
 v_exp_f32 v240, v148
 v_exp_f32 v241, v149
 v_mfma_f32_16x16x32_bf16 v[192:195], v[252:255], v[168:171], v[192:195]
 v_exp_f32 v242, v150
 v_cvt_pk_bf16_f32 v172, v240, v241
 v_exp_f32 v243, v151
 v_exp_f32 v240, v152
 v_cvt_pk_bf16_f32 v173, v242, v243
 v_exp_f32 v241, v153
 s_nop 1
 v_cmp_nge_f32 vcc, 0x53800000, v194
 s_cbranch_vccnz KB_RARE_DB1A_0
KB_RET_DB1A_0:
 v_mfma_f32_16x16x32_bf16 v[36:39], v[200:203], v[164:167], v[36:39]
 v_exp_f32 v242, v154
 v_mfma_f32_16x16x32_bf16 v[44:47], v[200:203], v[168:171], v[44:47]
 ds_read_b128 v[200:203], v233 offset:51200
 v_cvt_pk_bf16_f32 v174, v240, v241
 v_mfma_f32_16x16x32_bf16 v[40:43], v[204:207], v[164:167], v[40:43]
 v_exp_f32 v243, v155
 v_mfma_f32_16x16x32_bf16 v[48:51], v[204:207], v[168:171], v[48:51]
 ds_read_b128 v[204:207], v233 offset:51456
 v_exp_f32 v240, v156
 v_mfma_f32_16x16x32_bf16 v[52:55], v[208:211], v[164:167], v[52:55]
 v_cvt_pk_bf16_f32 v175, v242, v243
 v_exp_f32 v241, v157
 v_mfma_f32_16x16x32_bf16 v[60:63], v[208:211], v[168:171], v[60:63]
 ds_read_b128 v[208:211], v233 offset:55296
 v_exp_f32 v242, v158
 v_mfma_f32_16x16x32_bf16 v[56:59], v[212:215], v[164:167], v[56:59]
 v_cvt_pk_bf16_f32 v176, v240, v241
 v_exp_f32 v243, v159
 v_mfma_f32_16x16x32_bf16 v[64:67], v[212:215], v[168:171], v[64:67]
 ds_read_b128 v[212:215], v233 offset:55552
 s_waitcnt lgkmcnt(5)
 v_mfma_f32_16x16x32_bf16 v[68:71], v[216:219], v[164:167], v[68:71]
 v_exp_f32 v240, v160
 v_mfma_f32_16x16x32_bf16 v[76:79], v[216:219], v[168:171], v[76:79]
 ds_read_b128 v[216:219], v233 offset:59392
 v_cvt_pk_bf16_f32 v177, v242, v243
 v_mfma_f32_16x16x32_bf16 v[72:75], v[220:223], v[164:167], v[72:75]
 v_exp_f32 v241, v161
 v_mfma_f32_16x16x32_bf16 v[80:83], v[220:223], v[168:171], v[80:83]
 ds_read_b128 v[220:223], v233 offset:59648
 v_exp_f32 v242, v162
 v_mfma_f32_16x16x32_bf16 v[84:87], v[224:227], v[164:167], v[84:87]
 v_cvt_pk_bf16_f32 v178, v240, v241
 v_exp_f32 v243, v163
 v_mfma_f32_16x16x32_bf16 v[92:95], v[224:227], v[168:171], v[92:95]
 ds_read_b128 v[224:227], v233 offset:63488
 v_cvt_pk_bf16_f32 v179, v242, v243
 v_mfma_f32_16x16x32_bf16 v[88:91], v[228:231], v[164:167], v[88:91]
 v_mfma_f32_16x16x32_bf16 v[96:99], v[228:231], v[168:171], v[96:99]
 ds_read_b128 v[228:231], v233 offset:63744
 v_swap_b32 v233, v234
 s_waitcnt lgkmcnt(4)
 v_mfma_f32_16x16x32_bf16 v[188:191], v[248:251], v[172:175], v[192:195]
 v_mfma_f32_16x16x32_bf16 v[188:191], v[252:255], v[176:179], v[188:191]
 s_nop 7
 v_cmp_nge_f32 vcc, 0x53800000, v190
 s_cbranch_vccnz KB_RARE_DB1A_1
KB_RET_DB1A_1:
 v_mfma_f32_16x16x32_bf16 v[36:39], v[200:203], v[172:175], v[36:39]
 v_mfma_f32_16x16x32_bf16 v[44:47], v[200:203], v[176:179], v[44:47]
 v_mfma_f32_16x16x32_bf16 v[40:43], v[204:207], v[172:175], v[40:43]
 v_mfma_f32_16x16x32_bf16 v[48:51], v[204:207], v[176:179], v[48:51]
 v_mfma_f32_16x16x32_bf16 v[52:55], v[208:211], v[172:175], v[52:55]
 v_mfma_f32_16x16x32_bf16 v[60:63], v[208:211], v[176:179], v[60:63]
 v_mfma_f32_16x16x32_bf16 v[56:59], v[212:215], v[172:175], v[56:59]
 v_mfma_f32_16x16x32_bf16 v[64:67], v[212:215], v[176:179], v[64:67]
 s_waitcnt lgkmcnt(0)
 v_mfma_f32_16x16x32_bf16 v[68:71], v[216:219], v[172:175], v[68:71]
 v_mfma_f32_16x16x32_bf16 v[76:79], v[216:219], v[176:179], v[76:79]
 v_mfma_f32_16x16x32_bf16 v[72:75], v[220:223], v[172:175], v[72:75]
 v_mfma_f32_16x16x32_bf16 v[80:83], v[220:223], v[176:179], v[80:83]
 v_mfma_f32_16x16x32_bf16 v[84:87], v[224:227], v[172:175], v[84:87]
 v_mfma_f32_16x16x32_bf16 v[92:95], v[224:227], v[176:179], v[92:95]
 v_mfma_f32_16x16x32_bf16 v[88:91], v[228:231], v[172:175], v[88:91]
 v_mfma_f32_16x16x32_bf16 v[96:99], v[228:231], v[176:179], v[96:99]
KB_FINALA:
 v_mov_b32 v237, 0x7fffffff
 ds_write_b32 v244, v237
 s_cmp_lg_u32 s88, 0
 s_cbranch_scc1 KB_JFIN
 v_lshlrev_b32 v4, 4, v0
 v_mov_b32 v5, 162816
C_GWF:
 ds_read_b32 v20, v5
 s_waitcnt lgkmcnt(0)
 v_readfirstlane_b32 s49, v20
 s_andn2_b32 s39, 0x8c000000, s49
 s_cbranch_scc1 KB_JFIN
 s_and_b32 s31, s49, 3
 s_bfe_u32 s45, s49, 0x60002
 s_bfe_u32 s46, s49, 0x60008
 s_lshl_b32 s50, s32, 10
 s_cmp_eq_u32 s31, 0
 s_mov_b32 s39, 0xc000
 s_cmov_b32 s39, 0x8000
 s_cselect_b64 s[64:65], -1, 0
 s_add_u32 s50, s50, s39
 s_cmp_eq_u32 s31, 0
 s_mov_b32 s39, 0x6000000
 s_cmov_b32 s39, 0x3200000
 s_mov_b32 s10, 0x1044000
 s_cmov_b32 s10, 0x580000
 s_mov_b32 s40, 0x41100
 s_cmov_b32 s40, 0x16000
 s_cselect_b64 s[12:13], s[76:77], s[74:75]
 s_mov_b32 s14, 0x400000
 s_cmov_b32 s14, 0x158000
 s_add_u32 s8, s4, s39
 s_addc_u32 s9, s5, 0
 s_and_b32 s9, s9, 0xffff
 s_mov_b32 s11, 0x00020000
 s_and_b32 s13, s13, 0xffff
 s_mov_b32 s15, 0x00020000
 s_lshl_b32 s39, s32, 2
 s_add_u32 s39, s39, s35
 s_mul_i32 s36, s39, s40
 s_lshl_b32 s39, s34, 12
 s_add_u32 s36, s36, s39
 s_lshl_b32 s37, s55, 14
 s_lshl_b32 s39, s33, 8
 s_add_u32 s37, s37, s39
 s_lshl_b32 s70, s45, 12
 s_add_u32 s70, s70, s36
 buffer_load_dwordx4 v[132:135], v4, s[8:11], s70 offen offset:0 sc1
 buffer_load_dwordx4 v[136:139], v4, s[8:11], s70 offen offset:1024 sc1
 buffer_load_dwordx4 v[140:143], v4, s[8:11], s70 offen offset:2048 sc1
 buffer_load_dwordx4 v[144:147], v4, s[8:11], s70 offen offset:3072 sc1
 s_lshl_b32 s70, s46, 12
 s_add_u32 s70, s70, s36
 buffer_load_dwordx4 v[148:151], v4, s[8:11], s70 offen offset:0 sc1
 buffer_load_dwordx4 v[152:155], v4, s[8:11], s70 offen offset:1024 sc1
 buffer_load_dwordx4 v[156:159], v4, s[8:11], s70 offen offset:2048 sc1
 buffer_load_dwordx4 v[160:163], v4, s[8:11], s70 offen offset:3072 sc1
 v_rcp_f32 v237, v188
 v_rcp_f32 v240, v189
 v_fma_f32 v238, -v188, v237, 1.0
 v_fma_f32 v241, -v189, v240, 1.0
 v_fma_f32 v237, v238, v237, v237
 v_fma_f32 v240, v241, v240, v240
 s_lshl_b32 s41, s26, 2
 s_add_u32 s41, s41, s24
 s_mul_i32 s41, s41, 266496
 s_lshl_b32 s42, s25, 13
 s_add_u32 s41, s41, s42
 s_add_u32 s42, s41, 4096
 v_mul_f32 v36, v36, v237
 v_mul_f32 v37, v37, v237
 v_mul_f32 v38, v38, v237
 v_mul_f32 v39, v39, v237
 v_mul_f32 v40, v40, v237
 v_mul_f32 v41, v41, v237
 v_mul_f32 v42, v42, v237
 v_mul_f32 v43, v43, v237
 v_cvt_pk_bf16_f32 v100, v36, v37
 v_cvt_pk_bf16_f32 v101, v38, v39
 v_cvt_pk_bf16_f32 v102, v40, v41
 v_cvt_pk_bf16_f32 v103, v42, v43
 buffer_store_dwordx4 v[100:103], v196, s[20:23], s41 offen offset:0 sc1
 v_mul_f32 v44, v44, v240
 v_mul_f32 v45, v45, v240
 v_mul_f32 v46, v46, v240
 v_mul_f32 v47, v47, v240
 v_mul_f32 v48, v48, v240
 v_mul_f32 v49, v49, v240
 v_mul_f32 v50, v50, v240
 v_mul_f32 v51, v51, v240
 v_cvt_pk_bf16_f32 v104, v44, v45
 v_cvt_pk_bf16_f32 v105, v46, v47
 v_cvt_pk_bf16_f32 v106, v48, v49
 v_cvt_pk_bf16_f32 v107, v50, v51
 buffer_store_dwordx4 v[104:107], v196, s[20:23], s41 offen offset:256 sc1
 v_mul_f32 v52, v52, v237
 v_mul_f32 v53, v53, v237
 v_mul_f32 v54, v54, v237
 v_mul_f32 v55, v55, v237
 v_mul_f32 v56, v56, v237
 v_mul_f32 v57, v57, v237
 v_mul_f32 v58, v58, v237
 v_mul_f32 v59, v59, v237
 v_cvt_pk_bf16_f32 v108, v52, v53
 v_cvt_pk_bf16_f32 v109, v54, v55
 v_cvt_pk_bf16_f32 v110, v56, v57
 v_cvt_pk_bf16_f32 v111, v58, v59
 buffer_store_dwordx4 v[108:111], v196, s[20:23], s41 offen offset:2048 sc1
 v_mul_f32 v60, v60, v240
 v_mul_f32 v61, v61, v240
 v_mul_f32 v62, v62, v240
 v_mul_f32 v63, v63, v240
 v_mul_f32 v64, v64, v240
 v_mul_f32 v65, v65, v240
 v_mul_f32 v66, v66, v240
 v_mul_f32 v67, v67, v240
 v_cvt_pk_bf16_f32 v112, v60, v61
 v_cvt_pk_bf16_f32 v113, v62, v63
 v_cvt_pk_bf16_f32 v114, v64, v65
 v_cvt_pk_bf16_f32 v115, v66, v67
 buffer_store_dwordx4 v[112:115], v196, s[20:23], s41 offen offset:2304 sc1
 v_mul_f32 v68, v68, v237
 v_mul_f32 v69, v69, v237
 v_mul_f32 v70, v70, v237
 v_mul_f32 v71, v71, v237
 v_mul_f32 v72, v72, v237
 v_mul_f32 v73, v73, v237
 v_mul_f32 v74, v74, v237
 v_mul_f32 v75, v75, v237
 v_cvt_pk_bf16_f32 v116, v68, v69
 v_cvt_pk_bf16_f32 v117, v70, v71
 v_cvt_pk_bf16_f32 v118, v72, v73
 v_cvt_pk_bf16_f32 v119, v74, v75
 buffer_store_dwordx4 v[116:119], v196, s[20:23], s42 offen offset:0 sc1
 v_mul_f32 v76, v76, v240
 v_mul_f32 v77, v77, v240
 v_mul_f32 v78, v78, v240
 v_mul_f32 v79, v79, v240
 v_mul_f32 v80, v80, v240
 v_mul_f32 v81, v81, v240
 v_mul_f32 v82, v82, v240
 v_mul_f32 v83, v83, v240
 v_cvt_pk_bf16_f32 v120, v76, v77
 v_cvt_pk_bf16_f32 v121, v78, v79
 v_cvt_pk_bf16_f32 v122, v80, v81
 v_cvt_pk_bf16_f32 v123, v82, v83
 buffer_store_dwordx4 v[120:123], v196, s[20:23], s42 offen offset:256 sc1
 v_mul_f32 v84, v84, v237
 v_mul_f32 v85, v85, v237
 v_mul_f32 v86, v86, v237
 v_mul_f32 v87, v87, v237
 v_mul_f32 v88, v88, v237
 v_mul_f32 v89, v89, v237
 v_mul_f32 v90, v90, v237
 v_mul_f32 v91, v91, v237
 v_cvt_pk_bf16_f32 v124, v84, v85
 v_cvt_pk_bf16_f32 v125, v86, v87
 v_cvt_pk_bf16_f32 v126, v88, v89
 v_cvt_pk_bf16_f32 v127, v90, v91
 buffer_store_dwordx4 v[124:127], v196, s[20:23], s42 offen offset:2048 sc1
 v_mul_f32 v92, v92, v240
 v_mul_f32 v93, v93, v240
 v_mul_f32 v94, v94, v240
 v_mul_f32 v95, v95, v240
 v_mul_f32 v96, v96, v240
 v_mul_f32 v97, v97, v240
 v_mul_f32 v98, v98, v240
 v_mul_f32 v99, v99, v240
 v_cvt_pk_bf16_f32 v128, v92, v93
 v_cvt_pk_bf16_f32 v129, v94, v95
 v_cvt_pk_bf16_f32 v130, v96, v97
 v_cvt_pk_bf16_f32 v131, v98, v99
 buffer_store_dwordx4 v[128:131], v196, s[20:23], s42 offen offset:2304 sc1
 v_lshrrev_b32 v20, 4, v0
 v_and_b32 v21, 15, v0
 v_lshlrev_b32 v22, 2, v20
 v_xor_b32 v21, v21, v22
 v_lshlrev_b32 v21, 4, v21
 v_lshl_add_u32 v6, v20, 10, v21
 v_bfe_u32 v20, v0, 2, 2
 v_lshrrev_b32 v21, 5, v0
 v_lshl_add_u32 v21, v21, 2, v20
 v_lshlrev_b32 v21, 8, v21
 v_and_b32 v22, 1, v0
 v_lshl_add_u32 v21, v22, 3, v21
 v_bfe_u32 v22, v0, 1, 1
 v_bfe_u32 v23, v0, 4, 1
 v_lshl_add_u32 v22, v23, 1, v22
 v_lshl_add_u32 v21, v22, 4, v21
 s_lshl_b32 s39, s34, 14
 s_sub_u32 s40, s66, s38
 s_add_u32 s40, s40, s39
 v_add_u32 v21, s40, v21
 v_xor_b32 v22, 0, v20
 v_lshl_add_u32 v8, v22, 6, v21
 v_xor_b32 v22, 1, v20
 v_lshl_add_u32 v9, v22, 6, v21
 v_xor_b32 v22, 2, v20
 v_lshl_add_u32 v10, v22, 6, v21
 v_xor_b32 v22, 3, v20
 v_lshl_add_u32 v11, v22, 6, v21
 v_xor_b32 v12, 0x10000, v8
 v_and_b32 v16, 0xffff, v8
 v_or_b32 v16, 0x20000, v16
 v_xor_b32 v13, 0x10000, v9
 v_and_b32 v17, 0xffff, v9
 v_or_b32 v17, 0x20000, v17
 v_xor_b32 v14, 0x10000, v10
 v_and_b32 v18, 0xffff, v10
 v_or_b32 v18, 0x20000, v18
 v_xor_b32 v15, 0x10000, v11
 v_and_b32 v19, 0xffff, v11
 v_or_b32 v19, 0x20000, v19
 v_mov_b32 v166, s90
 v_mov_b32 v167, s91
 v_and_b32 v164, 7, v0
 v_lshlrev_b32 v164, 12, v164
 v_mov_b32 v36, 0
 v_mov_b32 v37, 0
 v_mov_b32 v38, 0
 v_mov_b32 v39, 0
 v_mov_b32 v40, 0
 v_mov_b32 v41, 0
 v_mov_b32 v42, 0
 v_mov_b32 v43, 0
 v_mov_b32 v44, 0
 v_mov_b32 v45, 0
 v_mov_b32 v46, 0
 v_mov_b32 v47, 0
 v_mov_b32 v48, 0
 v_mov_b32 v49, 0
 v_mov_b32 v50, 0
 v_mov_b32 v51, 0
 v_mov_b32 v52, 0
 v_mov_b32 v53, 0
 v_mov_b32 v54, 0
 v_mov_b32 v55, 0
 v_mov_b32 v56, 0
 v_mov_b32 v57, 0
 v_mov_b32 v58, 0
 v_mov_b32 v59, 0
 v_mov_b32 v60, 0
 v_mov_b32 v61, 0
 v_mov_b32 v62, 0
 v_mov_b32 v63, 0
 v_mov_b32 v64, 0
 v_mov_b32 v65, 0
 v_mov_b32 v66, 0
 v_mov_b32 v67, 0
 v_mov_b32 v68, 0
 v_mov_b32 v69, 0
 v_mov_b32 v70, 0
 v_mov_b32 v71, 0
 v_mov_b32 v72, 0
 v_mov_b32 v73, 0
 v_mov_b32 v74, 0
 v_mov_b32 v75, 0
 v_mov_b32 v76, 0
 v_mov_b32 v77, 0
 v_mov_b32 v78, 0
 v_mov_b32 v79, 0
 v_mov_b32 v80, 0
 v_mov_b32 v81, 0
 v_mov_b32 v82, 0
 v_mov_b32 v83, 0
 v_mov_b32 v84, 0
 v_mov_b32 v85, 0
 v_mov_b32 v86, 0
 v_mov_b32 v87, 0
 v_mov_b32 v88, 0
 v_mov_b32 v89, 0
 v_mov_b32 v90, 0
 v_mov_b32 v91, 0
 v_mov_b32 v92, 0
 v_mov_b32 v93, 0
 v_mov_b32 v94, 0
 v_mov_b32 v95, 0
 v_mov_b32 v96, 0
 v_mov_b32 v97, 0
 v_mov_b32 v98, 0
 v_mov_b32 v99, 0
 s_waitcnt vmcnt(0)
 v_mov_b32 v242, s90
 v_mov_b32 v243, s91
 s_mov_b64 exec, 1
 buffer_store_dwordx2 v[242:243], off, s[96:99], s89 sc1
 s_mov_b64 exec, -1
 s_branch C_B1
KB_JFIN:
 v_rcp_f32 v237, v188
 v_rcp_f32 v240, v189
 v_fma_f32 v238, -v188, v237, 1.0
 v_fma_f32 v241, -v189, v240, 1.0
 v_fma_f32 v237, v238, v237, v237
 v_fma_f32 v240, v241, v240, v240
 s_lshl_b32 s41, s26, 2
 s_add_u32 s41, s41, s24
 s_mul_i32 s41, s41, 266496
 s_lshl_b32 s42, s25, 13
 s_add_u32 s41, s41, s42
 s_add_u32 s42, s41, 4096
 v_mul_f32 v36, v36, v237
 v_mul_f32 v37, v37, v237
 v_mul_f32 v38, v38, v237
 v_mul_f32 v39, v39, v237
 v_mul_f32 v40, v40, v237
 v_mul_f32 v41, v41, v237
 v_mul_f32 v42, v42, v237
 v_mul_f32 v43, v43, v237
 v_cvt_pk_bf16_f32 v100, v36, v37
 v_cvt_pk_bf16_f32 v101, v38, v39
 v_cvt_pk_bf16_f32 v102, v40, v41
 v_cvt_pk_bf16_f32 v103, v42, v43
 buffer_store_dwordx4 v[100:103], v196, s[20:23], s41 offen offset:0 sc1
 v_mul_f32 v44, v44, v240
 v_mul_f32 v45, v45, v240
 v_mul_f32 v46, v46, v240
 v_mul_f32 v47, v47, v240
 v_mul_f32 v48, v48, v240
 v_mul_f32 v49, v49, v240
 v_mul_f32 v50, v50, v240
 v_mul_f32 v51, v51, v240
 v_cvt_pk_bf16_f32 v104, v44, v45
 v_cvt_pk_bf16_f32 v105, v46, v47
 v_cvt_pk_bf16_f32 v106, v48, v49
 v_cvt_pk_bf16_f32 v107, v50, v51
 buffer_store_dwordx4 v[104:107], v196, s[20:23], s41 offen offset:256 sc1
 v_mul_f32 v52, v52, v237
 v_mul_f32 v53, v53, v237
 v_mul_f32 v54, v54, v237
 v_mul_f32 v55, v55, v237
 v_mul_f32 v56, v56, v237
 v_mul_f32 v57, v57, v237
 v_mul_f32 v58, v58, v237
 v_mul_f32 v59, v59, v237
 v_cvt_pk_bf16_f32 v108, v52, v53
 v_cvt_pk_bf16_f32 v109, v54, v55
 v_cvt_pk_bf16_f32 v110, v56, v57
 v_cvt_pk_bf16_f32 v111, v58, v59
 buffer_store_dwordx4 v[108:111], v196, s[20:23], s41 offen offset:2048 sc1
 v_mul_f32 v60, v60, v240
 v_mul_f32 v61, v61, v240
 v_mul_f32 v62, v62, v240
 v_mul_f32 v63, v63, v240
 v_mul_f32 v64, v64, v240
 v_mul_f32 v65, v65, v240
 v_mul_f32 v66, v66, v240
 v_mul_f32 v67, v67, v240
 v_cvt_pk_bf16_f32 v112, v60, v61
 v_cvt_pk_bf16_f32 v113, v62, v63
 v_cvt_pk_bf16_f32 v114, v64, v65
 v_cvt_pk_bf16_f32 v115, v66, v67
 buffer_store_dwordx4 v[112:115], v196, s[20:23], s41 offen offset:2304 sc1
 v_mul_f32 v68, v68, v237
 v_mul_f32 v69, v69, v237
 v_mul_f32 v70, v70, v237
 v_mul_f32 v71, v71, v237
 v_mul_f32 v72, v72, v237
 v_mul_f32 v73, v73, v237
 v_mul_f32 v74, v74, v237
 v_mul_f32 v75, v75, v237
 v_cvt_pk_bf16_f32 v116, v68, v69
 v_cvt_pk_bf16_f32 v117, v70, v71
 v_cvt_pk_bf16_f32 v118, v72, v73
 v_cvt_pk_bf16_f32 v119, v74, v75
 buffer_store_dwordx4 v[116:119], v196, s[20:23], s42 offen offset:0 sc1
 v_mul_f32 v76, v76, v240
 v_mul_f32 v77, v77, v240
 v_mul_f32 v78, v78, v240
 v_mul_f32 v79, v79, v240
 v_mul_f32 v80, v80, v240
 v_mul_f32 v81, v81, v240
 v_mul_f32 v82, v82, v240
 v_mul_f32 v83, v83, v240
 v_cvt_pk_bf16_f32 v120, v76, v77
 v_cvt_pk_bf16_f32 v121, v78, v79
 v_cvt_pk_bf16_f32 v122, v80, v81
 v_cvt_pk_bf16_f32 v123, v82, v83
 buffer_store_dwordx4 v[120:123], v196, s[20:23], s42 offen offset:256 sc1
 v_mul_f32 v84, v84, v237
 v_mul_f32 v85, v85, v237
 v_mul_f32 v86, v86, v237
 v_mul_f32 v87, v87, v237
 v_mul_f32 v88, v88, v237
 v_mul_f32 v89, v89, v237
 v_mul_f32 v90, v90, v237
 v_mul_f32 v91, v91, v237
 v_cvt_pk_bf16_f32 v124, v84, v85
 v_cvt_pk_bf16_f32 v125, v86, v87
 v_cvt_pk_bf16_f32 v126, v88, v89
 v_cvt_pk_bf16_f32 v127, v90, v91
 buffer_store_dwordx4 v[124:127], v196, s[20:23], s42 offen offset:2048 sc1
 v_mul_f32 v92, v92, v240
 v_mul_f32 v93, v93, v240
 v_mul_f32 v94, v94, v240
 v_mul_f32 v95, v95, v240
 v_mul_f32 v96, v96, v240
 v_mul_f32 v97, v97, v240
 v_mul_f32 v98, v98, v240
 v_mul_f32 v99, v99, v240
 v_cvt_pk_bf16_f32 v128, v92, v93
 v_cvt_pk_bf16_f32 v129, v94, v95
 v_cvt_pk_bf16_f32 v130, v96, v97
 v_cvt_pk_bf16_f32 v131, v98, v99
 buffer_store_dwordx4 v[128:131], v196, s[20:23], s42 offen offset:2304 sc1
 s_waitcnt vmcnt(0)
 v_mov_b32 v242, s90
 v_mov_b32 v243, s91
 s_mov_b64 exec, 1
 buffer_store_dwordx2 v[242:243], off, s[96:99], s89 sc1
 s_mov_b64 exec, -1
 s_cmp_lg_u32 s88, 0
 s_cbranch_scc1 KB_JOBN
C_AENT:
C_GWA:
 ds_read_b32 v20, v5
 s_waitcnt lgkmcnt(0)
 v_readfirstlane_b32 s49, v20
 s_bitcmp1_b32 s49, 31
 s_cbranch_scc0 C_GWA
 s_and_b32 s31, s49, 3
 s_bfe_u32 s45, s49, 0x60002
 s_bfe_u32 s46, s49, 0x60008
 s_lshl_b32 s50, s32, 10
 s_cmp_eq_u32 s31, 0
 s_mov_b32 s39, 0xc000
 s_cmov_b32 s39, 0x8000
 s_cselect_b64 s[64:65], -1, 0
 s_add_u32 s50, s50, s39
 s_cmp_eq_u32 s31, 0
 s_mov_b32 s39, 0x6000000
 s_cmov_b32 s39, 0x3200000
 s_mov_b32 s10, 0x1044000
 s_cmov_b32 s10, 0x580000
 s_mov_b32 s40, 0x41100
 s_cmov_b32 s40, 0x16000
 s_cselect_b64 s[12:13], s[76:77], s[74:75]
 s_mov_b32 s14, 0x400000
 s_cmov_b32 s14, 0x158000
 s_add_u32 s8, s4, s39
 s_addc_u32 s9, s5, 0
 s_and_b32 s9, s9, 0xffff
 s_mov_b32 s11, 0x00020000
 s_and_b32 s13, s13, 0xffff
 s_mov_b32 s15, 0x00020000
 s_lshl_b32 s39, s32, 2
 s_add_u32 s39, s39, s35
 s_mul_i32 s36, s39, s40
 s_lshl_b32 s39, s34, 12
 s_add_u32 s36, s36, s39
 s_lshl_b32 s37, s55, 14
 s_lshl_b32 s39, s33, 8
 s_add_u32 s37, s37, s39
 s_bitcmp1_b32 s49, 26
 s_cbranch_scc0 C_SLA0
C_SBA0:
 s_lshl_b32 s70, s45, 12
 s_add_u32 s70, s70, s36
 buffer_load_dwordx4 v[132:135], v4, s[8:11], s70 offen offset:0 sc1
 buffer_load_dwordx4 v[136:139], v4, s[8:11], s70 offen offset:1024 sc1
 buffer_load_dwordx4 v[140:143], v4, s[8:11], s70 offen offset:2048 sc1
 buffer_load_dwordx4 v[144:147], v4, s[8:11], s70 offen offset:3072 sc1
 s_bitcmp1_b32 s49, 27
 s_cbranch_scc0 C_SLA1
C_SBA1:
 s_lshl_b32 s70, s46, 12
 s_add_u32 s70, s70, s36
 buffer_load_dwordx4 v[148:151], v4, s[8:11], s70 offen offset:0 sc1
 buffer_load_dwordx4 v[152:155], v4, s[8:11], s70 offen offset:1024 sc1
 buffer_load_dwordx4 v[156:159], v4, s[8:11], s70 offen offset:2048 sc1
 buffer_load_dwordx4 v[160:163], v4, s[8:11], s70 offen offset:3072 sc1
 v_lshrrev_b32 v20, 4, v0
 v_and_b32 v21, 15, v0
 v_lshlrev_b32 v22, 2, v20
 v_xor_b32 v21, v21, v22
 v_lshlrev_b32 v21, 4, v21
 v_lshl_add_u32 v6, v20, 10, v21
 v_bfe_u32 v20, v0, 2, 2
 v_lshrrev_b32 v21, 5, v0
 v_lshl_add_u32 v21, v21, 2, v20
 v_lshlrev_b32 v21, 8, v21
 v_and_b32 v22, 1, v0
 v_lshl_add_u32 v21, v22, 3, v21
 v_bfe_u32 v22, v0, 1, 1
 v_bfe_u32 v23, v0, 4, 1
 v_lshl_add_u32 v22, v23, 1, v22
 v_lshl_add_u32 v21, v22, 4, v21
 s_lshl_b32 s39, s34, 14
 s_sub_u32 s40, s66, s38
 s_add_u32 s40, s40, s39
 v_add_u32 v21, s40, v21
 v_xor_b32 v22, 0, v20
 v_lshl_add_u32 v8, v22, 6, v21
 v_xor_b32 v22, 1, v20
 v_lshl_add_u32 v9, v22, 6, v21
 v_xor_b32 v22, 2, v20
 v_lshl_add_u32 v10, v22, 6, v21
 v_xor_b32 v22, 3, v20
 v_lshl_add_u32 v11, v22, 6, v21
 v_xor_b32 v12, 0x10000, v8
 v_and_b32 v16, 0xffff, v8
 v_or_b32 v16, 0x20000, v16
 v_xor_b32 v13, 0x10000, v9
 v_and_b32 v17, 0xffff, v9
 v_or_b32 v17, 0x20000, v17
 v_xor_b32 v14, 0x10000, v10
 v_and_b32 v18, 0xffff, v10
 v_or_b32 v18, 0x20000, v18
 v_xor_b32 v15, 0x10000, v11
 v_and_b32 v19, 0xffff, v11
 v_or_b32 v19, 0x20000, v19
 v_mov_b32 v166, s90
 v_mov_b32 v167, s91
 v_and_b32 v164, 7, v0
 v_lshlrev_b32 v164, 12, v164
 v_mov_b32 v36, 0
 v_mov_b32 v37, 0
 v_mov_b32 v38, 0
 v_mov_b32 v39, 0
 v_mov_b32 v40, 0
 v_mov_b32 v41, 0
 v_mov_b32 v42, 0
 v_mov_b32 v43, 0
 v_mov_b32 v44, 0
 v_mov_b32 v45, 0
 v_mov_b32 v46, 0
 v_mov_b32 v47, 0
 v_mov_b32 v48, 0
 v_mov_b32 v49, 0
 v_mov_b32 v50, 0
 v_mov_b32 v51, 0
 v_mov_b32 v52, 0
 v_mov_b32 v53, 0
 v_mov_b32 v54, 0
 v_mov_b32 v55, 0
 v_mov_b32 v56, 0
 v_mov_b32 v57, 0
 v_mov_b32 v58, 0
 v_mov_b32 v59, 0
 v_mov_b32 v60, 0
 v_mov_b32 v61, 0
 v_mov_b32 v62, 0
 v_mov_b32 v63, 0
 v_mov_b32 v64, 0
 v_mov_b32 v65, 0
 v_mov_b32 v66, 0
 v_mov_b32 v67, 0
 v_mov_b32 v68, 0
 v_mov_b32 v69, 0
 v_mov_b32 v70, 0
 v_mov_b32 v71, 0
 v_mov_b32 v72, 0
 v_mov_b32 v73, 0
 v_mov_b32 v74, 0
 v_mov_b32 v75, 0
 v_mov_b32 v76, 0
 v_mov_b32 v77, 0
 v_mov_b32 v78, 0
 v_mov_b32 v79, 0
 v_mov_b32 v80, 0
 v_mov_b32 v81, 0
 v_mov_b32 v82, 0
 v_mov_b32 v83, 0
 v_mov_b32 v84, 0
 v_mov_b32 v85, 0
 v_mov_b32 v86, 0
 v_mov_b32 v87, 0
 v_mov_b32 v88, 0
 v_mov_b32 v89, 0
 v_mov_b32 v90, 0
 v_mov_b32 v91, 0
 v_mov_b32 v92, 0
 v_mov_b32 v93, 0
 v_mov_b32 v94, 0
 v_mov_b32 v95, 0
 v_mov_b32 v96, 0
 v_mov_b32 v97, 0
 v_mov_b32 v98, 0
 v_mov_b32 v99, 0
 s_waitcnt vmcnt(0)
 s_branch C_B1
KB_X0AA:
 ds_write_b32 v244, v239
 v_mfma_f32_16x16x32_bf16 v[192:195], v[248:251], v[164:167], v[188:191]
 v_exp_f32 v240, v116
 v_mfma_f32_16x16x32_bf16 v[192:195], v[252:255], v[168:171], v[192:195]
 v_exp_f32 v241, v117
 v_mfma_f32_16x16x32_bf16 v[132:135], v[200:203], v[4:7], v[180:183]
 v_exp_f32 v242, v118
 v_mfma_f32_16x16x32_bf16 v[140:143], v[200:203], v[8:11], v[184:187]
 ds_read_b128 v[200:203], v233 offset:16384
 v_cvt_pk_bf16_f32 v172, v240, v241
 v_mfma_f32_16x16x32_bf16 v[136:139], v[204:207], v[4:7], v[180:183]
 v_exp_f32 v243, v119
 v_mfma_f32_16x16x32_bf16 v[144:147], v[204:207], v[8:11], v[184:187]
 ds_read_b128 v[204:207], v233 offset:16640
 v_mfma_f32_16x16x32_bf16 v[132:135], v[208:211], v[12:15], v[132:135]
 v_exp_f32 v240, v120
 v_mfma_f32_16x16x32_bf16 v[140:143], v[208:211], v[16:19], v[140:143]
 ds_read_b128 v[208:211], v233 offset:20480
 v_cvt_pk_bf16_f32 v173, v242, v243
 v_cmp_nge_f32 vcc, 0x53800000, v194
 s_cbranch_vccnz KB_RARE_A0A_0
KB_RET_A0A_0:
 v_mfma_f32_16x16x32_bf16 v[136:139], v[212:215], v[12:15], v[136:139]
 v_exp_f32 v241, v121
 v_mfma_f32_16x16x32_bf16 v[144:147], v[212:215], v[16:19], v[144:147]
 ds_read_b128 v[212:215], v233 offset:20736
 s_waitcnt lgkmcnt(5)
 v_mfma_f32_16x16x32_bf16 v[132:135], v[216:219], v[20:23], v[132:135]
 v_exp_f32 v242, v122
 v_mfma_f32_16x16x32_bf16 v[140:143], v[216:219], v[24:27], v[140:143]
 ds_read_b128 v[216:219], v233 offset:24576
 v_cvt_pk_bf16_f32 v174, v240, v241
 v_mfma_f32_16x16x32_bf16 v[136:139], v[220:223], v[20:23], v[136:139]
 v_exp_f32 v243, v123
 v_mfma_f32_16x16x32_bf16 v[144:147], v[220:223], v[24:27], v[144:147]
 ds_read_b128 v[220:223], v233 offset:24832
 v_mfma_f32_16x16x32_bf16 v[132:135], v[224:227], v[28:31], v[132:135]
 v_exp_f32 v240, v124
 v_mfma_f32_16x16x32_bf16 v[140:143], v[224:227], v[32:35], v[140:143]
 ds_read_b128 v[224:227], v233 offset:28672
 v_cvt_pk_bf16_f32 v175, v242, v243
 v_mfma_f32_16x16x32_bf16 v[136:139], v[228:231], v[28:31], v[136:139]
 v_exp_f32 v241, v125
 v_mfma_f32_16x16x32_bf16 v[144:147], v[228:231], v[32:35], v[144:147]
 ds_read_b128 v[228:231], v233 offset:28928
 s_waitcnt lgkmcnt(4)
 v_mfma_f32_16x16x32_bf16 v[36:39], v[200:203], v[164:167], v[36:39]
 v_exp_f32 v242, v126
 v_mfma_f32_16x16x32_bf16 v[44:47], v[200:203], v[168:171], v[44:47]
 ds_read_b128 v[200:203], v233 offset:18432
 v_cvt_pk_bf16_f32 v176, v240, v241
 v_mfma_f32_16x16x32_bf16 v[40:43], v[204:207], v[164:167], v[40:43]
 v_exp_f32 v243, v127
 v_mfma_f32_16x16x32_bf16 v[48:51], v[204:207], v[168:171], v[48:51]
 ds_read_b128 v[204:207], v233 offset:18688
 v_mfma_f32_16x16x32_bf16 v[52:55], v[208:211], v[164:167], v[52:55]
 v_exp_f32 v240, v128
 v_mfma_f32_16x16x32_bf16 v[60:63], v[208:211], v[168:171], v[60:63]
 ds_read_b128 v[208:211], v233 offset:22528
 v_cvt_pk_bf16_f32 v177, v242, v243
 v_mfma_f32_16x16x32_bf16 v[56:59], v[212:215], v[164:167], v[56:59]
 v_exp_f32 v241, v129
 v_mfma_f32_16x16x32_bf16 v[64:67], v[212:215], v[168:171], v[64:67]
 ds_read_b32 v238, v232
 ds_read_b128 v[212:215], v233 offset:22784
 s_waitcnt lgkmcnt(5)
 v_mfma_f32_16x16x32_bf16 v[68:71], v[216:219], v[164:167], v[68:71]
 v_exp_f32 v242, v130
 v_mfma_f32_16x16x32_bf16 v[76:79], v[216:219], v[168:171], v[76:79]
 ds_read_b128 v[216:219], v233 offset:26624
 v_cvt_pk_bf16_f32 v178, v240, v241
 v_mfma_f32_16x16x32_bf16 v[72:75], v[220:223], v[164:167], v[72:75]
 v_exp_f32 v243, v131
 v_mfma_f32_16x16x32_bf16 v[80:83], v[220:223], v[168:171], v[80:83]
 ds_read_b128 v[220:223], v233 offset:26880
 v_cvt_pk_bf16_f32 v179, v242, v243
 v_mfma_f32_16x16x32_bf16 v[84:87], v[224:227], v[164:167], v[84:87]
 v_mfma_f32_16x16x32_bf16 v[92:95], v[224:227], v[168:171], v[92:95]
 ds_read_b128 v[224:227], v233 offset:30720
 v_mfma_f32_16x16x32_bf16 v[88:91], v[228:231], v[164:167], v[88:91]
 v_mfma_f32_16x16x32_bf16 v[96:99], v[228:231], v[168:171], v[96:99]
 ds_read_b128 v[228:231], v233 offset:30976
 s_waitcnt lgkmcnt(4)
 v_mfma_f32_16x16x32_bf16 v[188:191], v[248:251], v[172:175], v[192:195]
 v_cmp_lt_u32 vcc, v238, v239
 s_cbranch_vccnz KB_SPIN_A0A
KB_SPR_A0A:
 v_cmp_gt_i32 s[44:45], 0, v245
 v_cmp_gt_i32 s[46:47], 1, v245
 v_cmp_gt_i32 s[48:49], 2, v245
 s_nop 0
 v_mfma_f32_16x16x32_bf16 v[188:191], v[252:255], v[176:179], v[188:191]
 v_cmp_gt_i32 s[50:51], 3, v245
 v_cndmask_b32 v132, v132, v246, s[44:45]
 v_cndmask_b32 v133, v133, v246, s[46:47]
 v_cndmask_b32 v134, v134, v246, s[48:49]
 v_cndmask_b32 v135, v135, v246, s[50:51]
 s_nop 2
 v_cmp_nge_f32 vcc, 0x53800000, v190
 s_cbranch_vccnz KB_RARE_A0A_1
KB_RET_A0A_1:
 v_mfma_f32_16x16x32_bf16 v[36:39], v[200:203], v[172:175], v[36:39]
 v_cmp_gt_i32 s[44:45], 8, v245
 v_cmp_gt_i32 s[46:47], 9, v245
 v_mfma_f32_16x16x32_bf16 v[44:47], v[200:203], v[176:179], v[44:47]
 ds_read_b128 v[200:203], v233 offset:49152
 v_add_u32 v239, 1, v239
 v_cmp_gt_i32 s[48:49], 10, v245
 v_cmp_gt_i32 s[50:51], 11, v245
 v_cndmask_b32 v136, v136, v246, s[44:45]
 v_mfma_f32_16x16x32_bf16 v[40:43], v[204:207], v[172:175], v[40:43]
 v_cndmask_b32 v137, v137, v246, s[46:47]
 v_cndmask_b32 v138, v138, v246, s[48:49]
 v_cndmask_b32 v139, v139, v246, s[50:51]
 v_cmp_gt_i32 s[44:45], -16, v245
 v_cmp_gt_i32 s[46:47], -15, v245
 v_mfma_f32_16x16x32_bf16 v[48:51], v[204:207], v[176:179], v[48:51]
 ds_read_b128 v[204:207], v233 offset:49408
 ds_write_b32 v244, v239 offset:3072
 v_cmp_gt_i32 s[48:49], -14, v245
 v_cmp_gt_i32 s[50:51], -13, v245
 v_mfma_f32_16x16x32_bf16 v[52:55], v[208:211], v[172:175], v[52:55]
 v_cndmask_b32 v140, v140, v246, s[44:45]
 v_cndmask_b32 v141, v141, v246, s[46:47]
 v_cndmask_b32 v142, v142, v246, s[48:49]
 v_cndmask_b32 v143, v143, v246, s[50:51]
 v_cmp_gt_i32 s[44:45], -8, v245
 v_mfma_f32_16x16x32_bf16 v[60:63], v[208:211], v[176:179], v[60:63]
 ds_read_b128 v[208:211], v233 offset:53248
 v_cmp_gt_i32 s[46:47], -7, v245
 v_cmp_gt_i32 s[48:49], -6, v245
 v_cmp_gt_i32 s[50:51], -5, v245
 v_cndmask_b32 v144, v144, v246, s[44:45]
 v_mfma_f32_16x16x32_bf16 v[56:59], v[212:215], v[172:175], v[56:59]
 v_cndmask_b32 v145, v145, v246, s[46:47]
 v_cndmask_b32 v146, v146, v246, s[48:49]
 v_cndmask_b32 v147, v147, v246, s[50:51]
 v_exp_f32 v240, v132
 v_mfma_f32_16x16x32_bf16 v[64:67], v[212:215], v[176:179], v[64:67]
 ds_read_b128 v[212:215], v233 offset:53504
 v_exp_f32 v241, v133
 s_waitcnt lgkmcnt(5)
 v_mfma_f32_16x16x32_bf16 v[68:71], v[216:219], v[172:175], v[68:71]
 v_exp_f32 v242, v134
 v_cvt_pk_bf16_f32 v164, v240, v241
 v_exp_f32 v243, v135
 v_mfma_f32_16x16x32_bf16 v[76:79], v[216:219], v[176:179], v[76:79]
 ds_read_b128 v[216:219], v233 offset:57344
 v_exp_f32 v240, v136
 v_cvt_pk_bf16_f32 v165, v242, v243
 v_mfma_f32_16x16x32_bf16 v[72:75], v[220:223], v[172:175], v[72:75]
 v_exp_f32 v241, v137
 v_exp_f32 v242, v138
 v_cvt_pk_bf16_f32 v166, v240, v241
 v_mfma_f32_16x16x32_bf16 v[80:83], v[220:223], v[176:179], v[80:83]
 ds_read_b128 v[220:223], v233 offset:57600
 v_exp_f32 v243, v139
 v_exp_f32 v240, v140
 v_mfma_f32_16x16x32_bf16 v[84:87], v[224:227], v[172:175], v[84:87]
 v_cvt_pk_bf16_f32 v167, v242, v243
 v_exp_f32 v241, v141
 v_exp_f32 v242, v142
 v_mfma_f32_16x16x32_bf16 v[92:95], v[224:227], v[176:179], v[92:95]
 ds_read_b128 v[224:227], v233 offset:61440
 v_cvt_pk_bf16_f32 v168, v240, v241
 v_exp_f32 v243, v143
 v_mfma_f32_16x16x32_bf16 v[88:91], v[228:231], v[172:175], v[88:91]
 v_exp_f32 v240, v144
 v_cvt_pk_bf16_f32 v169, v242, v243
 v_exp_f32 v241, v145
 v_mfma_f32_16x16x32_bf16 v[96:99], v[228:231], v[176:179], v[96:99]
 ds_read_b128 v[228:231], v233 offset:61696
 v_exp_f32 v242, v146
 s_waitcnt lgkmcnt(4)
 v_cvt_pk_bf16_f32 v170, v240, v241
 v_exp_f32 v243, v147
 s_nop 0
 v_cvt_pk_bf16_f32 v171, v242, v243
 ds_write_b32 v244, v239
 v_swap_b32 v233, v234
 v_mfma_f32_16x16x32_bf16 v[192:195], v[248:251], v[164:167], v[188:191]
 v_mfma_f32_16x16x32_bf16 v[192:195], v[252:255], v[168:171], v[192:195]
 s_nop 7
 v_cmp_nge_f32 vcc, 0x53800000, v194
 s_cbranch_vccnz KB_RARE_DA1A_0
KB_RET_DA1A_0:
 v_mfma_f32_16x16x32_bf16 v[36:39], v[200:203], v[164:167], v[36:39]
 v_mfma_f32_16x16x32_bf16 v[44:47], v[200:203], v[168:171], v[44:47]
 v_mfma_f32_16x16x32_bf16 v[40:43], v[204:207], v[164:167], v[40:43]
 v_mfma_f32_16x16x32_bf16 v[48:51], v[204:207], v[168:171], v[48:51]
 v_mfma_f32_16x16x32_bf16 v[52:55], v[208:211], v[164:167], v[52:55]
 v_mfma_f32_16x16x32_bf16 v[60:63], v[208:211], v[168:171], v[60:63]
 v_mfma_f32_16x16x32_bf16 v[56:59], v[212:215], v[164:167], v[56:59]
 v_mfma_f32_16x16x32_bf16 v[64:67], v[212:215], v[168:171], v[64:67]
 s_waitcnt lgkmcnt(1)
 v_mfma_f32_16x16x32_bf16 v[68:71], v[216:219], v[164:167], v[68:71]
 v_mfma_f32_16x16x32_bf16 v[76:79], v[216:219], v[168:171], v[76:79]
 v_mfma_f32_16x16x32_bf16 v[72:75], v[220:223], v[164:167], v[72:75]
 v_mfma_f32_16x16x32_bf16 v[80:83], v[220:223], v[168:171], v[80:83]
 v_mfma_f32_16x16x32_bf16 v[84:87], v[224:227], v[164:167], v[84:87]
 v_mfma_f32_16x16x32_bf16 v[92:95], v[224:227], v[168:171], v[92:95]
 v_mfma_f32_16x16x32_bf16 v[88:91], v[228:231], v[164:167], v[88:91]
 v_mfma_f32_16x16x32_bf16 v[96:99], v[228:231], v[168:171], v[96:99]
 v_mov_b32 v188, v192
 v_mov_b32 v189, v193
 s_branch KB_FINALA
KB_X1A:
 s_bitcmp1_b32 s24, 0
 s_cbranch_scc0 KB_X1AA
 ds_write_b32 v244, v239
 v_mfma_f32_16x16x32_bf16 v[192:195], v[248:251], v[164:167], v[188:191]
 v_exp_f32 v240, v148
 v_mfma_f32_16x16x32_bf16 v[192:195], v[252:255], v[168:171], v[192:195]
 v_exp_f32 v241, v149
 v_mfma_f32_16x16x32_bf16 v[100:103], v[200:203], v[4:7], v[180:183]
 v_exp_f32 v242, v150
 v_mfma_f32_16x16x32_bf16 v[108:111], v[200:203], v[8:11], v[184:187]
 ds_read_b128 v[200:203], v233 offset:49152
 v_cvt_pk_bf16_f32 v172, v240, v241
 v_mfma_f32_16x16x32_bf16 v[104:107], v[204:207], v[4:7], v[180:183]
 v_exp_f32 v243, v151
 v_mfma_f32_16x16x32_bf16 v[112:115], v[204:207], v[8:11], v[184:187]
 ds_read_b128 v[204:207], v233 offset:49408
 v_mfma_f32_16x16x32_bf16 v[100:103], v[208:211], v[12:15], v[100:103]
 v_exp_f32 v240, v152
 v_mfma_f32_16x16x32_bf16 v[108:111], v[208:211], v[16:19], v[108:111]
 ds_read_b128 v[208:211], v233 offset:53248
 v_cvt_pk_bf16_f32 v173, v242, v243
 v_cmp_nge_f32 vcc, 0x53800000, v194
 s_cbranch_vccnz KB_RARE_B1A_0
KB_RET_B1A_0:
 v_mfma_f32_16x16x32_bf16 v[104:107], v[212:215], v[12:15], v[104:107]
 v_exp_f32 v241, v153
 v_mfma_f32_16x16x32_bf16 v[112:115], v[212:215], v[16:19], v[112:115]
 ds_read_b128 v[212:215], v233 offset:53504
 s_waitcnt lgkmcnt(5)
 v_mfma_f32_16x16x32_bf16 v[100:103], v[216:219], v[20:23], v[100:103]
 v_exp_f32 v242, v154
 v_mfma_f32_16x16x32_bf16 v[108:111], v[216:219], v[24:27], v[108:111]
 ds_read_b128 v[216:219], v233 offset:57344
 v_cvt_pk_bf16_f32 v174, v240, v241
 v_mfma_f32_16x16x32_bf16 v[104:107], v[220:223], v[20:23], v[104:107]
 v_exp_f32 v243, v155
 v_mfma_f32_16x16x32_bf16 v[112:115], v[220:223], v[24:27], v[112:115]
 ds_read_b128 v[220:223], v233 offset:57600
 v_mfma_f32_16x16x32_bf16 v[100:103], v[224:227], v[28:31], v[100:103]
 v_exp_f32 v240, v156
 v_mfma_f32_16x16x32_bf16 v[108:111], v[224:227], v[32:35], v[108:111]
 ds_read_b128 v[224:227], v233 offset:61440
 v_cvt_pk_bf16_f32 v175, v242, v243
 v_mfma_f32_16x16x32_bf16 v[104:107], v[228:231], v[28:31], v[104:107]
 v_exp_f32 v241, v157
 v_mfma_f32_16x16x32_bf16 v[112:115], v[228:231], v[32:35], v[112:115]
 ds_read_b128 v[228:231], v233 offset:61696
 s_waitcnt lgkmcnt(4)
 v_mfma_f32_16x16x32_bf16 v[36:39], v[200:203], v[164:167], v[36:39]
 v_exp_f32 v242, v158
 v_mfma_f32_16x16x32_bf16 v[44:47], v[200:203], v[168:171], v[44:47]
 ds_read_b128 v[200:203], v234 offset:8192
 v_cvt_pk_bf16_f32 v176, v240, v241
 v_mfma_f32_16x16x32_bf16 v[40:43], v[204:207], v[164:167], v[40:43]
 v_exp_f32 v243, v159
 v_mfma_f32_16x16x32_bf16 v[48:51], v[204:207], v[168:171], v[48:51]
 ds_read_b128 v[204:207], v234 offset:8448
 v_mfma_f32_16x16x32_bf16 v[52:55], v[208:211], v[164:167], v[52:55]
 v_exp_f32 v240, v160
 v_mfma_f32_16x16x32_bf16 v[60:63], v[208:211], v[168:171], v[60:63]
 ds_read_b128 v[208:211], v234 offset:10240
 v_cvt_pk_bf16_f32 v177, v242, v243
 v_mfma_f32_16x16x32_bf16 v[56:59], v[212:215], v[164:167], v[56:59]
 v_exp_f32 v241, v161
 v_mfma_f32_16x16x32_bf16 v[64:67], v[212:215], v[168:171], v[64:67]
 ds_read_b128 v[212:215], v234 offset:10496
 s_waitcnt lgkmcnt(4)
 v_mfma_f32_16x16x32_bf16 v[68:71], v[216:219], v[164:167], v[68:71]
 v_exp_f32 v242, v162
 v_mfma_f32_16x16x32_bf16 v[76:79], v[216:219], v[168:171], v[76:79]
 ds_read_b128 v[216:219], v234 offset:12288
 v_cvt_pk_bf16_f32 v178, v240, v241
 v_mfma_f32_16x16x32_bf16 v[72:75], v[220:223], v[164:167], v[72:75]
 v_exp_f32 v243, v163
 v_mfma_f32_16x16x32_bf16 v[80:83], v[220:223], v[168:171], v[80:83]
 ds_read_b128 v[220:223], v234 offset:12544
 v_cvt_pk_bf16_f32 v179, v242, v243
 v_mfma_f32_16x16x32_bf16 v[84:87], v[224:227], v[164:167], v[84:87]
 v_mfma_f32_16x16x32_bf16 v[92:95], v[224:227], v[168:171], v[92:95]
 ds_read_b128 v[224:227], v234 offset:14336
 v_mfma_f32_16x16x32_bf16 v[88:91], v[228:231], v[164:167], v[88:91]
 v_mfma_f32_16x16x32_bf16 v[96:99], v[228:231], v[168:171], v[96:99]
 ds_read_b128 v[228:231], v234 offset:14592
 s_waitcnt lgkmcnt(4)
 v_mfma_f32_16x16x32_bf16 v[188:191], v[248:251], v[172:175], v[192:195]
 v_exp_f32 v240, v100
 v_exp_f32 v241, v101
 v_mfma_f32_16x16x32_bf16 v[188:191], v[252:255], v[176:179], v[188:191]
 v_exp_f32 v242, v102
 v_mfma_f32_16x16x32_bf16 v[116:119], v[200:203], v[4:7], v[180:183]
 v_cvt_pk_bf16_f32 v164, v240, v241
 v_exp_f32 v243, v103
 v_mfma_f32_16x16x32_bf16 v[124:127], v[200:203], v[8:11], v[184:187]
 ds_read_b128 v[200:203], v233 offset:51200
 v_exp_f32 v240, v104
 v_mfma_f32_16x16x32_bf16 v[120:123], v[204:207], v[4:7], v[180:183]
 v_cvt_pk_bf16_f32 v165, v242, v243
 v_exp_f32 v241, v105
 v_mfma_f32_16x16x32_bf16 v[128:131], v[204:207], v[8:11], v[184:187]
 ds_read_b128 v[204:207], v233 offset:51456
 v_exp_f32 v242, v106
 v_mfma_f32_16x16x32_bf16 v[116:119], v[208:211], v[12:15], v[116:119]
 v_cvt_pk_bf16_f32 v166, v240, v241
 v_exp_f32 v243, v107
 v_mfma_f32_16x16x32_bf16 v[124:127], v[208:211], v[16:19], v[124:127]
 ds_read_b128 v[208:211], v233 offset:55296
 v_exp_f32 v240, v108
 v_cmp_nge_f32 vcc, 0x53800000, v190
 s_cbranch_vccnz KB_RARE_B1A_1
KB_RET_B1A_1:
 v_mfma_f32_16x16x32_bf16 v[120:123], v[212:215], v[12:15], v[120:123]
 v_cvt_pk_bf16_f32 v167, v242, v243
 v_exp_f32 v241, v109
 v_mfma_f32_16x16x32_bf16 v[128:131], v[212:215], v[16:19], v[128:131]
 ds_read_b32 v238, v232
 ds_read_b128 v[212:215], v233 offset:55552
 s_waitcnt lgkmcnt(5)
 v_mfma_f32_16x16x32_bf16 v[116:119], v[216:219], v[20:23], v[116:119]
 v_exp_f32 v242, v110
 v_mfma_f32_16x16x32_bf16 v[124:127], v[216:219], v[24:27], v[124:127]
 ds_read_b128 v[216:219], v233 offset:59392
 v_cvt_pk_bf16_f32 v168, v240, v241
 v_mfma_f32_16x16x32_bf16 v[120:123], v[220:223], v[20:23], v[120:123]
 v_exp_f32 v243, v111
 v_mfma_f32_16x16x32_bf16 v[128:131], v[220:223], v[24:27], v[128:131]
 ds_read_b128 v[220:223], v233 offset:59648
 v_exp_f32 v240, v112
 v_mfma_f32_16x16x32_bf16 v[116:119], v[224:227], v[28:31], v[116:119]
 v_cvt_pk_bf16_f32 v169, v242, v243
 v_exp_f32 v241, v113
 v_mfma_f32_16x16x32_bf16 v[124:127], v[224:227], v[32:35], v[124:127]
 ds_read_b128 v[224:227], v233 offset:63488
 v_exp_f32 v242, v114
 v_mfma_f32_16x16x32_bf16 v[120:123], v[228:231], v[28:31], v[120:123]
 v_cvt_pk_bf16_f32 v170, v240, v241
 v_exp_f32 v243, v115
 v_mfma_f32_16x16x32_bf16 v[128:131], v[228:231], v[32:35], v[128:131]
 ds_read_b128 v[228:231], v233 offset:63744
 v_swap_b32 v233, v234
 s_waitcnt lgkmcnt(4)
 v_mfma_f32_16x16x32_bf16 v[36:39], v[200:203], v[172:175], v[36:39]
 v_cmp_lt_u32 vcc, v238, v239
 s_cbranch_vccnz KB_SPIN_B1A
KB_SPR_B1A:
 v_mfma_f32_16x16x32_bf16 v[44:47], v[200:203], v[176:179], v[44:47]
 ds_read_b128 v[200:203], v233 offset:16384
 v_add_u32 v239, 1, v239
 v_mfma_f32_16x16x32_bf16 v[40:43], v[204:207], v[172:175], v[40:43]
 v_cvt_pk_bf16_f32 v171, v242, v243
 v_mfma_f32_16x16x32_bf16 v[48:51], v[204:207], v[176:179], v[48:51]
 ds_read_b128 v[204:207], v233 offset:16640
 ds_write_b32 v244, v239 offset:3072
 v_cmp_gt_i32 s[44:45], 0, v245
 v_cmp_gt_i32 s[46:47], 1, v245
 v_mfma_f32_16x16x32_bf16 v[52:55], v[208:211], v[172:175], v[52:55]
 v_cmp_gt_i32 s[48:49], 2, v245
 v_cmp_gt_i32 s[50:51], 3, v245
 v_cndmask_b32 v116, v116, v246, s[44:45]
 v_mfma_f32_16x16x32_bf16 v[60:63], v[208:211], v[176:179], v[60:63]
 ds_read_b128 v[208:211], v233 offset:20480
 v_cndmask_b32 v117, v117, v246, s[46:47]
 v_cndmask_b32 v118, v118, v246, s[48:49]
 v_mfma_f32_16x16x32_bf16 v[56:59], v[212:215], v[172:175], v[56:59]
 v_cndmask_b32 v119, v119, v246, s[50:51]
 v_cmp_gt_i32 s[44:45], 8, v245
 v_mfma_f32_16x16x32_bf16 v[64:67], v[212:215], v[176:179], v[64:67]
 ds_read_b128 v[212:215], v233 offset:20736
 v_cmp_gt_i32 s[46:47], 9, v245
 s_waitcnt lgkmcnt(5)
 v_mfma_f32_16x16x32_bf16 v[68:71], v[216:219], v[172:175], v[68:71]
 v_cmp_gt_i32 s[48:49], 10, v245
 v_cmp_gt_i32 s[50:51], 11, v245
 v_cndmask_b32 v120, v120, v246, s[44:45]
 v_mfma_f32_16x16x32_bf16 v[76:79], v[216:219], v[176:179], v[76:79]
 ds_read_b128 v[216:219], v233 offset:24576
 v_cndmask_b32 v121, v121, v246, s[46:47]
 v_cndmask_b32 v122, v122, v246, s[48:49]
 v_mfma_f32_16x16x32_bf16 v[72:75], v[220:223], v[172:175], v[72:75]
 v_cndmask_b32 v123, v123, v246, s[50:51]
 v_cmp_gt_i32 s[44:45], -16, v245
 v_cmp_gt_i32 s[46:47], -15, v245
 v_mfma_f32_16x16x32_bf16 v[80:83], v[220:223], v[176:179], v[80:83]
 ds_read_b128 v[220:223], v233 offset:24832
 v_cmp_gt_i32 s[48:49], -14, v245
 v_mfma_f32_16x16x32_bf16 v[84:87], v[224:227], v[172:175], v[84:87]
 v_cmp_gt_i32 s[50:51], -13, v245
 v_cndmask_b32 v124, v124, v246, s[44:45]
 v_cndmask_b32 v125, v125, v246, s[46:47]
 v_mfma_f32_16x16x32_bf16 v[92:95], v[224:227], v[176:179], v[92:95]
 ds_read_b128 v[224:227], v233 offset:28672
 v_cndmask_b32 v126, v126, v246, s[48:49]
 v_cndmask_b32 v127, v127, v246, s[50:51]
 v_mfma_f32_16x16x32_bf16 v[88:91], v[228:231], v[172:175], v[88:91]
 v_cmp_gt_i32 s[44:45], -8, v245
 v_cmp_gt_i32 s[46:47], -7, v245
 v_cmp_gt_i32 s[48:49], -6, v245
 v_mfma_f32_16x16x32_bf16 v[96:99], v[228:231], v[176:179], v[96:99]
 ds_read_b128 v[228:231], v233 offset:28928
 s_waitcnt lgkmcnt(4)
 v_cmp_gt_i32 s[50:51], -5, v245
 v_cndmask_b32 v128, v128, v246, s[44:45]
 v_cndmask_b32 v129, v129, v246, s[46:47]
 v_cndmask_b32 v130, v130, v246, s[48:49]
 v_cndmask_b32 v131, v131, v246, s[50:51]
KB_D0BA:
 ds_write_b32 v244, v239
 v_mfma_f32_16x16x32_bf16 v[192:195], v[248:251], v[164:167], v[188:191]
 v_exp_f32 v240, v116
 v_exp_f32 v241, v117
 v_mfma_f32_16x16x32_bf16 v[192:195], v[252:255], v[168:171], v[192:195]
 v_exp_f32 v242, v118
 v_cvt_pk_bf16_f32 v172, v240, v241
 v_exp_f32 v243, v119
 v_exp_f32 v240, v120
 v_cvt_pk_bf16_f32 v173, v242, v243
 v_exp_f32 v241, v121
 s_nop 1
 v_cmp_nge_f32 vcc, 0x53800000, v194
 s_cbranch_vccnz KB_RARE_DB0A_0
KB_RET_DB0A_0:
 v_mfma_f32_16x16x32_bf16 v[36:39], v[200:203], v[164:167], v[36:39]
 v_exp_f32 v242, v122
 v_mfma_f32_16x16x32_bf16 v[44:47], v[200:203], v[168:171], v[44:47]
 ds_read_b128 v[200:203], v233 offset:18432
 v_cvt_pk_bf16_f32 v174, v240, v241
 v_mfma_f32_16x16x32_bf16 v[40:43], v[204:207], v[164:167], v[40:43]
 v_exp_f32 v243, v123
 v_mfma_f32_16x16x32_bf16 v[48:51], v[204:207], v[168:171], v[48:51]
 ds_read_b128 v[204:207], v233 offset:18688
 v_exp_f32 v240, v124
 v_mfma_f32_16x16x32_bf16 v[52:55], v[208:211], v[164:167], v[52:55]
 v_cvt_pk_bf16_f32 v175, v242, v243
 v_exp_f32 v241, v125
 v_mfma_f32_16x16x32_bf16 v[60:63], v[208:211], v[168:171], v[60:63]
 ds_read_b128 v[208:211], v233 offset:22528
 v_exp_f32 v242, v126
 v_mfma_f32_16x16x32_bf16 v[56:59], v[212:215], v[164:167], v[56:59]
 v_cvt_pk_bf16_f32 v176, v240, v241
 v_exp_f32 v243, v127
 v_mfma_f32_16x16x32_bf16 v[64:67], v[212:215], v[168:171], v[64:67]
 ds_read_b128 v[212:215], v233 offset:22784
 s_waitcnt lgkmcnt(5)
 v_mfma_f32_16x16x32_bf16 v[68:71], v[216:219], v[164:167], v[68:71]
 v_exp_f32 v240, v128
 v_mfma_f32_16x16x32_bf16 v[76:79], v[216:219], v[168:171], v[76:79]
 ds_read_b128 v[216:219], v233 offset:26624
 v_cvt_pk_bf16_f32 v177, v242, v243
 v_mfma_f32_16x16x32_bf16 v[72:75], v[220:223], v[164:167], v[72:75]
 v_exp_f32 v241, v129
 v_mfma_f32_16x16x32_bf16 v[80:83], v[220:223], v[168:171], v[80:83]
 ds_read_b128 v[220:223], v233 offset:26880
 v_exp_f32 v242, v130
 v_mfma_f32_16x16x32_bf16 v[84:87], v[224:227], v[164:167], v[84:87]
 v_cvt_pk_bf16_f32 v178, v240, v241
 v_exp_f32 v243, v131
 v_mfma_f32_16x16x32_bf16 v[92:95], v[224:227], v[168:171], v[92:95]
 ds_read_b128 v[224:227], v233 offset:30720
 v_cvt_pk_bf16_f32 v179, v242, v243
 v_mfma_f32_16x16x32_bf16 v[88:91], v[228:231], v[164:167], v[88:91]
 v_mfma_f32_16x16x32_bf16 v[96:99], v[228:231], v[168:171], v[96:99]
 ds_read_b128 v[228:231], v233 offset:30976
 s_waitcnt lgkmcnt(4)
 v_mfma_f32_16x16x32_bf16 v[188:191], v[248:251], v[172:175], v[192:195]
 v_mfma_f32_16x16x32_bf16 v[188:191], v[252:255], v[176:179], v[188:191]
 s_nop 7
 v_cmp_nge_f32 vcc, 0x53800000, v190
 s_cbranch_vccnz KB_RARE_DB0A_1
KB_RET_DB0A_1:
 v_mfma_f32_16x16x32_bf16 v[36:39], v[200:203], v[172:175], v[36:39]
 v_mfma_f32_16x16x32_bf16 v[44:47], v[200:203], v[176:179], v[44:47]
 v_mfma_f32_16x16x32_bf16 v[40:43], v[204:207], v[172:175], v[40:43]
 v_mfma_f32_16x16x32_bf16 v[48:51], v[204:207], v[176:179], v[48:51]
 v_mfma_f32_16x16x32_bf16 v[52:55], v[208:211], v[172:175], v[52:55]
 v_mfma_f32_16x16x32_bf16 v[60:63], v[208:211], v[176:179], v[60:63]
 v_mfma_f32_16x16x32_bf16 v[56:59], v[212:215], v[172:175], v[56:59]
 v_mfma_f32_16x16x32_bf16 v[64:67], v[212:215], v[176:179], v[64:67]
 s_waitcnt lgkmcnt(0)
 v_mfma_f32_16x16x32_bf16 v[68:71], v[216:219], v[172:175], v[68:71]
 v_mfma_f32_16x16x32_bf16 v[76:79], v[216:219], v[176:179], v[76:79]
 v_mfma_f32_16x16x32_bf16 v[72:75], v[220:223], v[172:175], v[72:75]
 v_mfma_f32_16x16x32_bf16 v[80:83], v[220:223], v[176:179], v[80:83]
 v_mfma_f32_16x16x32_bf16 v[84:87], v[224:227], v[172:175], v[84:87]
 v_mfma_f32_16x16x32_bf16 v[92:95], v[224:227], v[176:179], v[92:95]
 v_mfma_f32_16x16x32_bf16 v[88:91], v[228:231], v[172:175], v[88:91]
 v_mfma_f32_16x16x32_bf16 v[96:99], v[228:231], v[176:179], v[96:99]
 s_branch KB_FINALA
KB_X1AA:
 ds_write_b32 v244, v239
 v_mfma_f32_16x16x32_bf16 v[192:195], v[248:251], v[164:167], v[188:191]
 v_exp_f32 v240, v148
 v_mfma_f32_16x16x32_bf16 v[192:195], v[252:255], v[168:171], v[192:195]
 v_exp_f32 v241, v149
 v_mfma_f32_16x16x32_bf16 v[100:103], v[200:203], v[4:7], v[180:183]
 v_exp_f32 v242, v150
 v_mfma_f32_16x16x32_bf16 v[108:111], v[200:203], v[8:11], v[184:187]
 ds_read_b128 v[200:203], v233 offset:49152
 v_cvt_pk_bf16_f32 v172, v240, v241
 v_mfma_f32_16x16x32_bf16 v[104:107], v[204:207], v[4:7], v[180:183]
 v_exp_f32 v243, v151
 v_mfma_f32_16x16x32_bf16 v[112:115], v[204:207], v[8:11], v[184:187]
 ds_read_b128 v[204:207], v233 offset:49408
 v_mfma_f32_16x16x32_bf16 v[100:103], v[208:211], v[12:15], v[100:103]
 v_exp_f32 v240, v152
 v_mfma_f32_16x16x32_bf16 v[108:111], v[208:211], v[16:19], v[108:111]
 ds_read_b128 v[208:211], v233 offset:53248
 v_cvt_pk_bf16_f32 v173, v242, v243
 v_cmp_nge_f32 vcc, 0x53800000, v194
 s_cbranch_vccnz KB_RARE_A1A_0
KB_RET_A1A_0:
 v_mfma_f32_16x16x32_bf16 v[104:107], v[212:215], v[12:15], v[104:107]
 v_exp_f32 v241, v153
 v_mfma_f32_16x16x32_bf16 v[112:115], v[212:215], v[16:19], v[112:115]
 ds_read_b128 v[212:215], v233 offset:53504
 s_waitcnt lgkmcnt(5)
 v_mfma_f32_16x16x32_bf16 v[100:103], v[216:219], v[20:23], v[100:103]
 v_exp_f32 v242, v154
 v_mfma_f32_16x16x32_bf16 v[108:111], v[216:219], v[24:27], v[108:111]
 ds_read_b128 v[216:219], v233 offset:57344
 v_cvt_pk_bf16_f32 v174, v240, v241
 v_mfma_f32_16x16x32_bf16 v[104:107], v[220:223], v[20:23], v[104:107]
 v_exp_f32 v243, v155
 v_mfma_f32_16x16x32_bf16 v[112:115], v[220:223], v[24:27], v[112:115]
 ds_read_b128 v[220:223], v233 offset:57600
 v_mfma_f32_16x16x32_bf16 v[100:103], v[224:227], v[28:31], v[100:103]
 v_exp_f32 v240, v156
 v_mfma_f32_16x16x32_bf16 v[108:111], v[224:227], v[32:35], v[108:111]
 ds_read_b128 v[224:227], v233 offset:61440
 v_cvt_pk_bf16_f32 v175, v242, v243
 v_mfma_f32_16x16x32_bf16 v[104:107], v[228:231], v[28:31], v[104:107]
 v_exp_f32 v241, v157
 v_mfma_f32_16x16x32_bf16 v[112:115], v[228:231], v[32:35], v[112:115]
 ds_read_b128 v[228:231], v233 offset:61696
 s_waitcnt lgkmcnt(4)
 v_mfma_f32_16x16x32_bf16 v[36:39], v[200:203], v[164:167], v[36:39]
 v_exp_f32 v242, v158
 v_mfma_f32_16x16x32_bf16 v[44:47], v[200:203], v[168:171], v[44:47]
 ds_read_b128 v[200:203], v233 offset:51200
 v_cvt_pk_bf16_f32 v176, v240, v241
 v_mfma_f32_16x16x32_bf16 v[40:43], v[204:207], v[164:167], v[40:43]
 v_exp_f32 v243, v159
 v_mfma_f32_16x16x32_bf16 v[48:51], v[204:207], v[168:171], v[48:51]
 ds_read_b128 v[204:207], v233 offset:51456
 v_mfma_f32_16x16x32_bf16 v[52:55], v[208:211], v[164:167], v[52:55]
 v_exp_f32 v240, v160
 v_mfma_f32_16x16x32_bf16 v[60:63], v[208:211], v[168:171], v[60:63]
 ds_read_b128 v[208:211], v233 offset:55296
 v_cvt_pk_bf16_f32 v177, v242, v243
 v_mfma_f32_16x16x32_bf16 v[56:59], v[212:215], v[164:167], v[56:59]
 v_exp_f32 v241, v161
 v_mfma_f32_16x16x32_bf16 v[64:67], v[212:215], v[168:171], v[64:67]
 ds_read_b32 v238, v232
 ds_read_b128 v[212:215], v233 offset:55552
 s_waitcnt lgkmcnt(5)
 v_mfma_f32_16x16x32_bf16 v[68:71], v[216:219], v[164:167], v[68:71]
 v_exp_f32 v242, v162
 v_mfma_f32_16x16x32_bf16 v[76:79], v[216:219], v[168:171], v[76:79]
 ds_read_b128 v[216:219], v233 offset:59392
 v_cvt_pk_bf16_f32 v178, v240, v241
 v_mfma_f32_16x16x32_bf16 v[72:75], v[220:223], v[164:167], v[72:75]
 v_exp_f32 v243, v163
 v_mfma_f32_16x16x32_bf16 v[80:83], v[220:223], v[168:171], v[80:83]
 ds_read_b128 v[220:223], v233 offset:59648
 v_cvt_pk_bf16_f32 v179, v242, v243
 v_mfma_f32_16x16x32_bf16 v[84:87], v[224:227], v[164:167], v[84:87]
 v_mfma_f32_16x16x32_bf16 v[92:95], v[224:227], v[168:171], v[92:95]
 ds_read_b128 v[224:227], v233 offset:63488
 v_mfma_f32_16x16x32_bf16 v[88:91], v[228:231], v[164:167], v[88:91]
 v_mfma_f32_16x16x32_bf16 v[96:99], v[228:231], v[168:171], v[96:99]
 ds_read_b128 v[228:231], v233 offset:63744
 v_swap_b32 v233, v234
 s_waitcnt lgkmcnt(4)
 v_mfma_f32_16x16x32_bf16 v[188:191], v[248:251], v[172:175], v[192:195]
 v_cmp_lt_u32 vcc, v238, v239
 s_cbranch_vccnz KB_SPIN_A1A
KB_SPR_A1A:
 v_cmp_gt_i32 s[44:45], 0, v245
 v_cmp_gt_i32 s[46:47], 1, v245
 v_cmp_gt_i32 s[48:49], 2, v245
 s_nop 0
 v_mfma_f32_16x16x32_bf16 v[188:191], v[252:255], v[176:179], v[188:191]
 v_cmp_gt_i32 s[50:51], 3, v245
 v_cndmask_b32 v100, v100, v246, s[44:45]
 v_cndmask_b32 v101, v101, v246, s[46:47]
 v_cndmask_b32 v102, v102, v246, s[48:49]
 v_cndmask_b32 v103, v103, v246, s[50:51]
 s_nop 2
 v_cmp_nge_f32 vcc, 0x53800000, v190
 s_cbranch_vccnz KB_RARE_A1A_1
KB_RET_A1A_1:
 v_mfma_f32_16x16x32_bf16 v[36:39], v[200:203], v[172:175], v[36:39]
 v_cmp_gt_i32 s[44:45], 8, v245
 v_cmp_gt_i32 s[46:47], 9, v245
 v_mfma_f32_16x16x32_bf16 v[44:47], v[200:203], v[176:179], v[44:47]
 ds_read_b128 v[200:203], v233 offset:16384
 v_add_u32 v239, 1, v239
 v_cmp_gt_i32 s[48:49], 10, v245
 v_cmp_gt_i32 s[50:51], 11, v245
 v_cndmask_b32 v104, v104, v246, s[44:45]
 v_mfma_f32_16x16x32_bf16 v[40:43], v[204:207], v[172:175], v[40:43]
 v_cndmask_b32 v105, v105, v246, s[46:47]
 v_cndmask_b32 v106, v106, v246, s[48:49]
 v_cndmask_b32 v107, v107, v246, s[50:51]
 v_cmp_gt_i32 s[44:45], -16, v245
 v_cmp_gt_i32 s[46:47], -15, v245
 v_mfma_f32_16x16x32_bf16 v[48:51], v[204:207], v[176:179], v[48:51]
 ds_read_b128 v[204:207], v233 offset:16640
 ds_write_b32 v244, v239 offset:3072
 v_cmp_gt_i32 s[48:49], -14, v245
 v_cmp_gt_i32 s[50:51], -13, v245
 v_mfma_f32_16x16x32_bf16 v[52:55], v[208:211], v[172:175], v[52:55]
 v_cndmask_b32 v108, v108, v246, s[44:45]
 v_cndmask_b32 v109, v109, v246, s[46:47]
 v_cndmask_b32 v110, v110, v246, s[48:49]
 v_cndmask_b32 v111, v111, v246, s[50:51]
 v_cmp_gt_i32 s[44:45], -8, v245
 v_mfma_f32_16x16x32_bf16 v[60:63], v[208:211], v[176:179], v[60:63]
 ds_read_b128 v[208:211], v233 offset:20480
 v_cmp_gt_i32 s[46:47], -7, v245
 v_cmp_gt_i32 s[48:49], -6, v245
 v_cmp_gt_i32 s[50:51], -5, v245
 v_cndmask_b32 v112, v112, v246, s[44:45]
 v_mfma_f32_16x16x32_bf16 v[56:59], v[212:215], v[172:175], v[56:59]
 v_cndmask_b32 v113, v113, v246, s[46:47]
 v_cndmask_b32 v114, v114, v246, s[48:49]
 v_cndmask_b32 v115, v115, v246, s[50:51]
 v_exp_f32 v240, v100
 v_mfma_f32_16x16x32_bf16 v[64:67], v[212:215], v[176:179], v[64:67]
 ds_read_b128 v[212:215], v233 offset:20736
 v_exp_f32 v241, v101
 s_waitcnt lgkmcnt(5)
 v_mfma_f32_16x16x32_bf16 v[68:71], v[216:219], v[172:175], v[68:71]
 v_exp_f32 v242, v102
 v_cvt_pk_bf16_f32 v164, v240, v241
 v_exp_f32 v243, v103
 v_mfma_f32_16x16x32_bf16 v[76:79], v[216:219], v[176:179], v[76:79]
 ds_read_b128 v[216:219], v233 offset:24576
 v_exp_f32 v240, v104
 v_cvt_pk_bf16_f32 v165, v242, v243
 v_mfma_f32_16x16x32_bf16 v[72:75], v[220:223], v[172:175], v[72:75]
 v_exp_f32 v241, v105
 v_exp_f32 v242, v106
 v_cvt_pk_bf16_f32 v166, v240, v241
 v_mfma_f32_16x16x32_bf16 v[80:83], v[220:223], v[176:179], v[80:83]
 ds_read_b128 v[220:223], v233 offset:24832
 v_exp_f32 v243, v107
 v_exp_f32 v240, v108
 v_mfma_f32_16x16x32_bf16 v[84:87], v[224:227], v[172:175], v[84:87]
 v_cvt_pk_bf16_f32 v167, v242, v243
 v_exp_f32 v241, v109
 v_exp_f32 v242, v110
 v_mfma_f32_16x16x32_bf16 v[92:95], v[224:227], v[176:179], v[92:95]
 ds_read_b128 v[224:227], v233 offset:28672
 v_cvt_pk_bf16_f32 v168, v240, v241
 v_exp_f32 v243, v111
 v_mfma_f32_16x16x32_bf16 v[88:91], v[228:231], v[172:175], v[88:91]
 v_exp_f32 v240, v112
 v_cvt_pk_bf16_f32 v169, v242, v243
 v_exp_f32 v241, v113
 v_mfma_f32_16x16x32_bf16 v[96:99], v[228:231], v[176:179], v[96:99]
 ds_read_b128 v[228:231], v233 offset:28928
 v_exp_f32 v242, v114
 s_waitcnt lgkmcnt(4)
 v_cvt_pk_bf16_f32 v170, v240, v241
 v_exp_f32 v243, v115
 s_nop 0
 v_cvt_pk_bf16_f32 v171, v242, v243
KB_D0AA:
 ds_write_b32 v244, v239
 v_mfma_f32_16x16x32_bf16 v[192:195], v[248:251], v[164:167], v[188:191]
 v_mfma_f32_16x16x32_bf16 v[192:195], v[252:255], v[168:171], v[192:195]
 s_nop 7
 v_cmp_nge_f32 vcc, 0x53800000, v194
 s_cbranch_vccnz KB_RARE_DA0A_0
KB_RET_DA0A_0:
 v_mfma_f32_16x16x32_bf16 v[36:39], v[200:203], v[164:167], v[36:39]
 v_mfma_f32_16x16x32_bf16 v[44:47], v[200:203], v[168:171], v[44:47]
 v_mfma_f32_16x16x32_bf16 v[40:43], v[204:207], v[164:167], v[40:43]
 v_mfma_f32_16x16x32_bf16 v[48:51], v[204:207], v[168:171], v[48:51]
 v_mfma_f32_16x16x32_bf16 v[52:55], v[208:211], v[164:167], v[52:55]
 v_mfma_f32_16x16x32_bf16 v[60:63], v[208:211], v[168:171], v[60:63]
 v_mfma_f32_16x16x32_bf16 v[56:59], v[212:215], v[164:167], v[56:59]
 v_mfma_f32_16x16x32_bf16 v[64:67], v[212:215], v[168:171], v[64:67]
 s_waitcnt lgkmcnt(1)
 v_mfma_f32_16x16x32_bf16 v[68:71], v[216:219], v[164:167], v[68:71]
 v_mfma_f32_16x16x32_bf16 v[76:79], v[216:219], v[168:171], v[76:79]
 v_mfma_f32_16x16x32_bf16 v[72:75], v[220:223], v[164:167], v[72:75]
 v_mfma_f32_16x16x32_bf16 v[80:83], v[220:223], v[168:171], v[80:83]
 v_mfma_f32_16x16x32_bf16 v[84:87], v[224:227], v[164:167], v[84:87]
 v_mfma_f32_16x16x32_bf16 v[92:95], v[224:227], v[168:171], v[92:95]
 v_mfma_f32_16x16x32_bf16 v[88:91], v[228:231], v[164:167], v[88:91]
 v_mfma_f32_16x16x32_bf16 v[96:99], v[228:231], v[168:171], v[96:99]
 v_mov_b32 v188, v192
 v_mov_b32 v189, v193
 s_branch KB_FINALA
KB_SPIN_UEB:
 s_sleep 1
 ds_read_b32 v238, v232
 s_waitcnt lgkmcnt(0)
 v_cmp_lt_u32 vcc, v238, v239
 s_cbranch_vccnz KB_SPIN_UEB
 s_branch KB_SPR_UEB
KB_SPIN_UOB:
 s_sleep 1
 ds_read_b32 v238, v232
 s_waitcnt lgkmcnt(0)
 v_cmp_lt_u32 vcc, v238, v239
 s_cbranch_vccnz KB_SPIN_UOB
 s_branch KB_SPR_UOB
KB_SPIN_B0B:
 s_sleep 1
 ds_read_b32 v238, v232
 s_waitcnt lgkmcnt(0)
 v_cmp_lt_u32 vcc, v238, v239
 s_cbranch_vccnz KB_SPIN_B0B
 s_branch KB_SPR_B0B
KB_SPIN_DB1B:
 s_sleep 1
 ds_read_b32 v238, v232
 s_waitcnt lgkmcnt(0)
 v_cmp_lt_u32 vcc, v238, v239
 s_cbranch_vccnz KB_SPIN_DB1B
 s_branch KB_SPR_DB1B
KB_SPIN_A0B:
 s_sleep 1
 ds_read_b32 v238, v232
 s_waitcnt lgkmcnt(0)
 v_cmp_lt_u32 vcc, v238, v239
 s_cbranch_vccnz KB_SPIN_A0B
 s_branch KB_SPR_A0B
KB_SPIN_DA1B:
 s_sleep 1
 ds_read_b32 v238, v232
 s_waitcnt lgkmcnt(0)
 v_cmp_lt_u32 vcc, v238, v239
 s_cbranch_vccnz KB_SPIN_DA1B
 s_branch KB_SPR_DA1B
KB_SPIN_B1B:
 s_sleep 1
 ds_read_b32 v238, v232
 s_waitcnt lgkmcnt(0)
 v_cmp_lt_u32 vcc, v238, v239
 s_cbranch_vccnz KB_SPIN_B1B
 s_branch KB_SPR_B1B
KB_SPIN_DB0B:
 s_sleep 1
 ds_read_b32 v238, v232
 s_waitcnt lgkmcnt(0)
 v_cmp_lt_u32 vcc, v238, v239
 s_cbranch_vccnz KB_SPIN_DB0B
 s_branch KB_SPR_DB0B
KB_SPIN_A1B:
 s_sleep 1
 ds_read_b32 v238, v232
 s_waitcnt lgkmcnt(0)
 v_cmp_lt_u32 vcc, v238, v239
 s_cbranch_vccnz KB_SPIN_A1B
 s_branch KB_SPR_A1B
KB_SPIN_DA0B:
 s_sleep 1
 ds_read_b32 v238, v232
 s_waitcnt lgkmcnt(0)
 v_cmp_lt_u32 vcc, v238, v239
 s_cbranch_vccnz KB_SPIN_DA0B
 s_branch KB_SPR_DA0B
KB_SPIN_UEA:
 s_sleep 1
 ds_read_b32 v238, v232
 s_waitcnt lgkmcnt(0)
 v_cmp_lt_u32 vcc, v238, v239
 s_cbranch_vccnz KB_SPIN_UEA
 s_branch KB_SPR_UEA
KB_SPIN_UOA:
 s_sleep 1
 ds_read_b32 v238, v232
 s_waitcnt lgkmcnt(0)
 v_cmp_lt_u32 vcc, v238, v239
 s_cbranch_vccnz KB_SPIN_UOA
 s_branch KB_SPR_UOA
KB_SPIN_B0A:
 s_sleep 1
 ds_read_b32 v238, v232
 s_waitcnt lgkmcnt(0)
 v_cmp_lt_u32 vcc, v238, v239
 s_cbranch_vccnz KB_SPIN_B0A
 s_branch KB_SPR_B0A
KB_SPIN_A0A:
 s_sleep 1
 ds_read_b32 v238, v232
 s_waitcnt lgkmcnt(0)
 v_cmp_lt_u32 vcc, v238, v239
 s_cbranch_vccnz KB_SPIN_A0A
 s_branch KB_SPR_A0A
KB_SPIN_B1A:
 s_sleep 1
 ds_read_b32 v238, v232
 s_waitcnt lgkmcnt(0)
 v_cmp_lt_u32 vcc, v238, v239
 s_cbranch_vccnz KB_SPIN_B1A
 s_branch KB_SPR_B1A
KB_SPIN_A1A:
 s_sleep 1
 ds_read_b32 v238, v232
 s_waitcnt lgkmcnt(0)
 v_cmp_lt_u32 vcc, v238, v239
 s_cbranch_vccnz KB_SPIN_A1A
 s_branch KB_SPR_A1A
KB_RARE_UEB_0:
 v_max3_f32 v236, v100, v101, v102
 v_max3_f32 v235, v108, v109, v110
 v_max3_f32 v236, v236, v103, v104
 v_max3_f32 v235, v235, v111, v112
 v_max3_f32 v236, v236, v105, v106
 v_max3_f32 v235, v235, v113, v114
 v_max_f32 v236, v236, v107
 v_max_f32 v235, v235, v115
 v_mov_b32 v237, v236
 v_mov_b32 v240, v235
 s_nop 0
 v_permlane32_swap_b32 v236, v237
 v_permlane32_swap_b32 v235, v240
 v_max_f32 v236, v236, v237
 v_max_f32 v235, v235, v240
 v_mov_b32 v237, v236
 v_mov_b32 v240, v235
 s_nop 0
 v_permlane16_swap_b32 v236, v237
 v_permlane16_swap_b32 v235, v240
 v_max_f32 v236, v236, v237
 v_max_f32 v235, v235, v240
 v_max_f32 v237, 0, v236
 v_max_f32 v240, 0, v235
 v_exp_f32 v238, -v237
 v_exp_f32 v241, -v240
 v_sub_f32 v100, v100, v237
 v_sub_f32 v101, v101, v237
 v_sub_f32 v102, v102, v237
 v_sub_f32 v103, v103, v237
 v_sub_f32 v104, v104, v237
 v_sub_f32 v105, v105, v237
 v_sub_f32 v106, v106, v237
 v_sub_f32 v107, v107, v237
 v_sub_f32 v116, v116, v237
 v_sub_f32 v117, v117, v237
 v_sub_f32 v118, v118, v237
 v_sub_f32 v119, v119, v237
 v_sub_f32 v120, v120, v237
 v_sub_f32 v121, v121, v237
 v_sub_f32 v122, v122, v237
 v_sub_f32 v123, v123, v237
 v_sub_f32 v132, v132, v237
 v_sub_f32 v133, v133, v237
 v_sub_f32 v134, v134, v237
 v_sub_f32 v135, v135, v237
 v_sub_f32 v136, v136, v237
 v_sub_f32 v137, v137, v237
 v_sub_f32 v138, v138, v237
 v_sub_f32 v139, v139, v237
 v_mul_f32 v36, v36, v238
 v_mul_f32 v37, v37, v238
 v_mul_f32 v38, v38, v238
 v_mul_f32 v39, v39, v238
 v_mul_f32 v40, v40, v238
 v_mul_f32 v41, v41, v238
 v_mul_f32 v42, v42, v238
 v_mul_f32 v43, v43, v238
 v_mul_f32 v52, v52, v238
 v_mul_f32 v53, v53, v238
 v_mul_f32 v54, v54, v238
 v_mul_f32 v55, v55, v238
 v_mul_f32 v56, v56, v238
 v_mul_f32 v57, v57, v238
 v_mul_f32 v58, v58, v238
 v_mul_f32 v59, v59, v238
 v_mul_f32 v68, v68, v238
 v_mul_f32 v69, v69, v238
 v_mul_f32 v70, v70, v238
 v_mul_f32 v71, v71, v238
 v_mul_f32 v72, v72, v238
 v_mul_f32 v73, v73, v238
 v_mul_f32 v74, v74, v238
 v_mul_f32 v75, v75, v238
 v_mul_f32 v84, v84, v238
 v_mul_f32 v85, v85, v238
 v_mul_f32 v86, v86, v238
 v_mul_f32 v87, v87, v238
 v_mul_f32 v88, v88, v238
 v_mul_f32 v89, v89, v238
 v_mul_f32 v90, v90, v238
 v_mul_f32 v91, v91, v238
 v_mul_f32 v188, v188, v238
 v_sub_f32 v180, v180, v237
 v_sub_f32 v181, v181, v237
 v_sub_f32 v182, v182, v237
 v_sub_f32 v183, v183, v237
 v_sub_f32 v108, v108, v240
 v_sub_f32 v109, v109, v240
 v_sub_f32 v110, v110, v240
 v_sub_f32 v111, v111, v240
 v_sub_f32 v112, v112, v240
 v_sub_f32 v113, v113, v240
 v_sub_f32 v114, v114, v240
 v_sub_f32 v115, v115, v240
 v_sub_f32 v124, v124, v240
 v_sub_f32 v125, v125, v240
 v_sub_f32 v126, v126, v240
 v_sub_f32 v127, v127, v240
 v_sub_f32 v128, v128, v240
 v_sub_f32 v129, v129, v240
 v_sub_f32 v130, v130, v240
 v_sub_f32 v131, v131, v240
 v_sub_f32 v140, v140, v240
 v_sub_f32 v141, v141, v240
 v_sub_f32 v142, v142, v240
 v_sub_f32 v143, v143, v240
 v_sub_f32 v144, v144, v240
 v_sub_f32 v145, v145, v240
 v_sub_f32 v146, v146, v240
 v_sub_f32 v147, v147, v240
 v_mul_f32 v44, v44, v241
 v_mul_f32 v45, v45, v241
 v_mul_f32 v46, v46, v241
 v_mul_f32 v47, v47, v241
 v_mul_f32 v48, v48, v241
 v_mul_f32 v49, v49, v241
 v_mul_f32 v50, v50, v241
 v_mul_f32 v51, v51, v241
 v_mul_f32 v60, v60, v241
 v_mul_f32 v61, v61, v241
 v_mul_f32 v62, v62, v241
 v_mul_f32 v63, v63, v241
 v_mul_f32 v64, v64, v241
 v_mul_f32 v65, v65, v241
 v_mul_f32 v66, v66, v241
 v_mul_f32 v67, v67, v241
 v_mul_f32 v76, v76, v241
 v_mul_f32 v77, v77, v241
 v_mul_f32 v78, v78, v241
 v_mul_f32 v79, v79, v241
 v_mul_f32 v80, v80, v241
 v_mul_f32 v81, v81, v241
 v_mul_f32 v82, v82, v241
 v_mul_f32 v83, v83, v241
 v_mul_f32 v92, v92, v241
 v_mul_f32 v93, v93, v241
 v_mul_f32 v94, v94, v241
 v_mul_f32 v95, v95, v241
 v_mul_f32 v96, v96, v241
 v_mul_f32 v97, v97, v241
 v_mul_f32 v98, v98, v241
 v_mul_f32 v99, v99, v241
 v_mul_f32 v189, v189, v241
 v_sub_f32 v184, v184, v240
 v_sub_f32 v185, v185, v240
 v_sub_f32 v186, v186, v240
 v_sub_f32 v187, v187, v240
 v_exp_f32 v240, v100
 v_exp_f32 v241, v101
 v_exp_f32 v242, v102
 v_cvt_pk_bf16_f32 v164, v240, v241
 v_exp_f32 v243, v103
 v_exp_f32 v240, v104
 v_cvt_pk_bf16_f32 v165, v242, v243
 v_exp_f32 v241, v105
 v_exp_f32 v242, v106
 v_cvt_pk_bf16_f32 v166, v240, v241
 v_exp_f32 v243, v107
 v_exp_f32 v240, v108
 v_cvt_pk_bf16_f32 v167, v242, v243
 v_exp_f32 v241, v109
 v_exp_f32 v242, v110
 v_cvt_pk_bf16_f32 v168, v240, v241
 v_exp_f32 v243, v111
 v_exp_f32 v240, v112
 v_cvt_pk_bf16_f32 v169, v242, v243
 v_exp_f32 v241, v113
 v_exp_f32 v242, v114
 v_cvt_pk_bf16_f32 v170, v240, v241
 v_exp_f32 v243, v115
 s_nop 0
 v_cvt_pk_bf16_f32 v171, v242, v243
 v_add_f32 v190, v188, v189
 s_nop 1
 v_mfma_f32_16x16x32_bf16 v[192:195], v[248:251], v[164:167], v[188:191]
 v_mfma_f32_16x16x32_bf16 v[192:195], v[252:255], v[168:171], v[192:195]
 v_exp_f32 v240, v116
 v_exp_f32 v241, v117
 v_exp_f32 v242, v118
 v_cvt_pk_bf16_f32 v172, v240, v241
 v_exp_f32 v243, v119
 v_exp_f32 v240, v120
 v_cvt_pk_bf16_f32 v173, v242, v243
 s_nop 7
 s_branch KB_RET_UEB_0
KB_RARE_UEB_1:
 v_max3_f32 v236, v116, v117, v118
 v_max3_f32 v235, v124, v125, v126
 v_max3_f32 v236, v236, v119, v120
 v_max3_f32 v235, v235, v127, v128
 v_max3_f32 v236, v236, v121, v122
 v_max3_f32 v235, v235, v129, v130
 v_max_f32 v236, v236, v123
 v_max_f32 v235, v235, v131
 v_mov_b32 v237, v236
 v_mov_b32 v240, v235
 s_nop 0
 v_permlane32_swap_b32 v236, v237
 v_permlane32_swap_b32 v235, v240
 v_max_f32 v236, v236, v237
 v_max_f32 v235, v235, v240
 v_mov_b32 v237, v236
 v_mov_b32 v240, v235
 s_nop 0
 v_permlane16_swap_b32 v236, v237
 v_permlane16_swap_b32 v235, v240
 v_max_f32 v236, v236, v237
 v_max_f32 v235, v235, v240
 v_max_f32 v237, 0, v236
 v_max_f32 v240, 0, v235
 v_exp_f32 v238, -v237
 v_exp_f32 v241, -v240
 v_sub_f32 v116, v116, v237
 v_sub_f32 v117, v117, v237
 v_sub_f32 v118, v118, v237
 v_sub_f32 v119, v119, v237
 v_sub_f32 v120, v120, v237
 v_sub_f32 v121, v121, v237
 v_sub_f32 v122, v122, v237
 v_sub_f32 v123, v123, v237
 v_sub_f32 v132, v132, v237
 v_sub_f32 v133, v133, v237
 v_sub_f32 v134, v134, v237
 v_sub_f32 v135, v135, v237
 v_sub_f32 v136, v136, v237
 v_sub_f32 v137, v137, v237
 v_sub_f32 v138, v138, v237
 v_sub_f32 v139, v139, v237
 v_sub_f32 v148, v148, v237
 v_sub_f32 v149, v149, v237
 v_sub_f32 v150, v150, v237
 v_sub_f32 v151, v151, v237
 v_sub_f32 v152, v152, v237
 v_sub_f32 v153, v153, v237
 v_sub_f32 v154, v154, v237
 v_sub_f32 v155, v155, v237
 v_mul_f32 v36, v36, v238
 v_mul_f32 v37, v37, v238
 v_mul_f32 v38, v38, v238
 v_mul_f32 v39, v39, v238
 v_mul_f32 v40, v40, v238
 v_mul_f32 v41, v41, v238
 v_mul_f32 v42, v42, v238
 v_mul_f32 v43, v43, v238
 v_mul_f32 v52, v52, v238
 v_mul_f32 v53, v53, v238
 v_mul_f32 v54, v54, v238
 v_mul_f32 v55, v55, v238
 v_mul_f32 v56, v56, v238
 v_mul_f32 v57, v57, v238
 v_mul_f32 v58, v58, v238
 v_mul_f32 v59, v59, v238
 v_mul_f32 v68, v68, v238
 v_mul_f32 v69, v69, v238
 v_mul_f32 v70, v70, v238
 v_mul_f32 v71, v71, v238
 v_mul_f32 v72, v72, v238
 v_mul_f32 v73, v73, v238
 v_mul_f32 v74, v74, v238
 v_mul_f32 v75, v75, v238
 v_mul_f32 v84, v84, v238
 v_mul_f32 v85, v85, v238
 v_mul_f32 v86, v86, v238
 v_mul_f32 v87, v87, v238
 v_mul_f32 v88, v88, v238
 v_mul_f32 v89, v89, v238
 v_mul_f32 v90, v90, v238
 v_mul_f32 v91, v91, v238
 v_mul_f32 v192, v192, v238
 v_sub_f32 v180, v180, v237
 v_sub_f32 v181, v181, v237
 v_sub_f32 v182, v182, v237
 v_sub_f32 v183, v183, v237
 v_sub_f32 v124, v124, v240
 v_sub_f32 v125, v125, v240
 v_sub_f32 v126, v126, v240
 v_sub_f32 v127, v127, v240
 v_sub_f32 v128, v128, v240
 v_sub_f32 v129, v129, v240
 v_sub_f32 v130, v130, v240
 v_sub_f32 v131, v131, v240
 v_sub_f32 v140, v140, v240
 v_sub_f32 v141, v141, v240
 v_sub_f32 v142, v142, v240
 v_sub_f32 v143, v143, v240
 v_sub_f32 v144, v144, v240
 v_sub_f32 v145, v145, v240
 v_sub_f32 v146, v146, v240
 v_sub_f32 v147, v147, v240
 v_sub_f32 v156, v156, v240
 v_sub_f32 v157, v157, v240
 v_sub_f32 v158, v158, v240
 v_sub_f32 v159, v159, v240
 v_sub_f32 v160, v160, v240
 v_sub_f32 v161, v161, v240
 v_sub_f32 v162, v162, v240
 v_sub_f32 v163, v163, v240
 v_mul_f32 v44, v44, v241
 v_mul_f32 v45, v45, v241
 v_mul_f32 v46, v46, v241
 v_mul_f32 v47, v47, v241
 v_mul_f32 v48, v48, v241
 v_mul_f32 v49, v49, v241
 v_mul_f32 v50, v50, v241
 v_mul_f32 v51, v51, v241
 v_mul_f32 v60, v60, v241
 v_mul_f32 v61, v61, v241
 v_mul_f32 v62, v62, v241
 v_mul_f32 v63, v63, v241
 v_mul_f32 v64, v64, v241
 v_mul_f32 v65, v65, v241
 v_mul_f32 v66, v66, v241
 v_mul_f32 v67, v67, v241
 v_mul_f32 v76, v76, v241
 v_mul_f32 v77, v77, v241
 v_mul_f32 v78, v78, v241
 v_mul_f32 v79, v79, v241
 v_mul_f32 v80, v80, v241
 v_mul_f32 v81, v81, v241
 v_mul_f32 v82, v82, v241
 v_mul_f32 v83, v83, v241
 v_mul_f32 v92, v92, v241
 v_mul_f32 v93, v93, v241
 v_mul_f32 v94, v94, v241
 v_mul_f32 v95, v95, v241
 v_mul_f32 v96, v96, v241
 v_mul_f32 v97, v97, v241
 v_mul_f32 v98, v98, v241
 v_mul_f32 v99, v99, v241
 v_mul_f32 v193, v193, v241
 v_sub_f32 v184, v184, v240
 v_sub_f32 v185, v185, v240
 v_sub_f32 v186, v186, v240
 v_sub_f32 v187, v187, v240
 v_exp_f32 v240, v116
 v_exp_f32 v241, v117
 v_exp_f32 v242, v118
 v_cvt_pk_bf16_f32 v172, v240, v241
 v_exp_f32 v243, v119
 v_exp_f32 v240, v120
 v_cvt_pk_bf16_f32 v173, v242, v243
 v_exp_f32 v241, v121
 v_exp_f32 v242, v122
 v_cvt_pk_bf16_f32 v174, v240, v241
 v_exp_f32 v243, v123
 v_exp_f32 v240, v124
 v_cvt_pk_bf16_f32 v175, v242, v243
 v_exp_f32 v241, v125
 v_exp_f32 v242, v126
 v_cvt_pk_bf16_f32 v176, v240, v241
 v_exp_f32 v243, v127
 v_exp_f32 v240, v128
 v_cvt_pk_bf16_f32 v177, v242, v243
 v_exp_f32 v241, v129
 v_exp_f32 v242, v130
 v_cvt_pk_bf16_f32 v178, v240, v241
 v_exp_f32 v243, v131
 s_nop 0
 v_cvt_pk_bf16_f32 v179, v242, v243
 v_add_f32 v194, v192, v193
 s_nop 1
 v_mfma_f32_16x16x32_bf16 v[188:191], v[248:251], v[172:175], v[192:195]
 v_mfma_f32_16x16x32_bf16 v[188:191], v[252:255], v[176:179], v[188:191]
 v_exp_f32 v240, v132
 v_exp_f32 v241, v133
 v_exp_f32 v242, v134
 v_cvt_pk_bf16_f32 v164, v240, v241
 v_exp_f32 v243, v135
 v_exp_f32 v240, v136
 v_cvt_pk_bf16_f32 v165, v242, v243
 s_nop 7
 s_branch KB_RET_UEB_1
KB_RARE_UOB_0:
 v_max3_f32 v236, v132, v133, v134
 v_max3_f32 v235, v140, v141, v142
 v_max3_f32 v236, v236, v135, v136
 v_max3_f32 v235, v235, v143, v144
 v_max3_f32 v236, v236, v137, v138
 v_max3_f32 v235, v235, v145, v146
 v_max_f32 v236, v236, v139
 v_max_f32 v235, v235, v147
 v_mov_b32 v237, v236
 v_mov_b32 v240, v235
 s_nop 0
 v_permlane32_swap_b32 v236, v237
 v_permlane32_swap_b32 v235, v240
 v_max_f32 v236, v236, v237
 v_max_f32 v235, v235, v240
 v_mov_b32 v237, v236
 v_mov_b32 v240, v235
 s_nop 0
 v_permlane16_swap_b32 v236, v237
 v_permlane16_swap_b32 v235, v240
 v_max_f32 v236, v236, v237
 v_max_f32 v235, v235, v240
 v_max_f32 v237, 0, v236
 v_max_f32 v240, 0, v235
 v_exp_f32 v238, -v237
 v_exp_f32 v241, -v240
 v_sub_f32 v132, v132, v237
 v_sub_f32 v133, v133, v237
 v_sub_f32 v134, v134, v237
 v_sub_f32 v135, v135, v237
 v_sub_f32 v136, v136, v237
 v_sub_f32 v137, v137, v237
 v_sub_f32 v138, v138, v237
 v_sub_f32 v139, v139, v237
 v_sub_f32 v148, v148, v237
 v_sub_f32 v149, v149, v237
 v_sub_f32 v150, v150, v237
 v_sub_f32 v151, v151, v237
 v_sub_f32 v152, v152, v237
 v_sub_f32 v153, v153, v237
 v_sub_f32 v154, v154, v237
 v_sub_f32 v155, v155, v237
 v_sub_f32 v100, v100, v237
 v_sub_f32 v101, v101, v237
 v_sub_f32 v102, v102, v237
 v_sub_f32 v103, v103, v237
 v_sub_f32 v104, v104, v237
 v_sub_f32 v105, v105, v237
 v_sub_f32 v106, v106, v237
 v_sub_f32 v107, v107, v237
 v_mul_f32 v36, v36, v238
 v_mul_f32 v37, v37, v238
 v_mul_f32 v38, v38, v238
 v_mul_f32 v39, v39, v238
 v_mul_f32 v40, v40, v238
 v_mul_f32 v41, v41, v238
 v_mul_f32 v42, v42, v238
 v_mul_f32 v43, v43, v238
 v_mul_f32 v52, v52, v238
 v_mul_f32 v53, v53, v238
 v_mul_f32 v54, v54, v238
 v_mul_f32 v55, v55, v238
 v_mul_f32 v56, v56, v238
 v_mul_f32 v57, v57, v238
 v_mul_f32 v58, v58, v238
 v_mul_f32 v59, v59, v238
 v_mul_f32 v68, v68, v238
 v_mul_f32 v69, v69, v238
 v_mul_f32 v70, v70, v238
 v_mul_f32 v71, v71, v238
 v_mul_f32 v72, v72, v238
 v_mul_f32 v73, v73, v238
 v_mul_f32 v74, v74, v238
 v_mul_f32 v75, v75, v238
 v_mul_f32 v84, v84, v238
 v_mul_f32 v85, v85, v238
 v_mul_f32 v86, v86, v238
 v_mul_f32 v87, v87, v238
 v_mul_f32 v88, v88, v238
 v_mul_f32 v89, v89, v238
 v_mul_f32 v90, v90, v238
 v_mul_f32 v91, v91, v238
 v_mul_f32 v188, v188, v238
 v_sub_f32 v180, v180, v237
 v_sub_f32 v181, v181, v237
 v_sub_f32 v182, v182, v237
 v_sub_f32 v183, v183, v237
 v_sub_f32 v140, v140, v240
 v_sub_f32 v141, v141, v240
 v_sub_f32 v142, v142, v240
 v_sub_f32 v143, v143, v240
 v_sub_f32 v144, v144, v240
 v_sub_f32 v145, v145, v240
 v_sub_f32 v146, v146, v240
 v_sub_f32 v147, v147, v240
 v_sub_f32 v156, v156, v240
 v_sub_f32 v157, v157, v240
 v_sub_f32 v158, v158, v240
 v_sub_f32 v159, v159, v240
 v_sub_f32 v160, v160, v240
 v_sub_f32 v161, v161, v240
 v_sub_f32 v162, v162, v240
 v_sub_f32 v163, v163, v240
 v_sub_f32 v108, v108, v240
 v_sub_f32 v109, v109, v240
 v_sub_f32 v110, v110, v240
 v_sub_f32 v111, v111, v240
 v_sub_f32 v112, v112, v240
 v_sub_f32 v113, v113, v240
 v_sub_f32 v114, v114, v240
 v_sub_f32 v115, v115, v240
 v_mul_f32 v44, v44, v241
 v_mul_f32 v45, v45, v241
 v_mul_f32 v46, v46, v241
 v_mul_f32 v47, v47, v241
 v_mul_f32 v48, v48, v241
 v_mul_f32 v49, v49, v241
 v_mul_f32 v50, v50, v241
 v_mul_f32 v51, v51, v241
 v_mul_f32 v60, v60, v241
 v_mul_f32 v61, v61, v241
 v_mul_f32 v62, v62, v241
 v_mul_f32 v63, v63, v241
 v_mul_f32 v64, v64, v241
 v_mul_f32 v65, v65, v241
 v_mul_f32 v66, v66, v241
 v_mul_f32 v67, v67, v241
 v_mul_f32 v76, v76, v241
 v_mul_f32 v77, v77, v241
 v_mul_f32 v78, v78, v241
 v_mul_f32 v79, v79, v241
 v_mul_f32 v80, v80, v241
 v_mul_f32 v81, v81, v241
 v_mul_f32 v82, v82, v241
 v_mul_f32 v83, v83, v241
 v_mul_f32 v92, v92, v241
 v_mul_f32 v93, v93, v241
 v_mul_f32 v94, v94, v241
 v_mul_f32 v95, v95, v241
 v_mul_f32 v96, v96, v241
 v_mul_f32 v97, v97, v241
 v_mul_f32 v98, v98, v241
 v_mul_f32 v99, v99, v241
 v_mul_f32 v189, v189, v241
 v_sub_f32 v184, v184, v240
 v_sub_f32 v185, v185, v240
 v_sub_f32 v186, v186, v240
 v_sub_f32 v187, v187, v240
 v_exp_f32 v240, v132
 v_exp_f32 v241, v133
 v_exp_f32 v242, v134
 v_cvt_pk_bf16_f32 v164, v240, v241
 v_exp_f32 v243, v135
 v_exp_f32 v240, v136
 v_cvt_pk_bf16_f32 v165, v242, v243
 v_exp_f32 v241, v137
 v_exp_f32 v242, v138
 v_cvt_pk_bf16_f32 v166, v240, v241
 v_exp_f32 v243, v139
 v_exp_f32 v240, v140
 v_cvt_pk_bf16_f32 v167, v242, v243
 v_exp_f32 v241, v141
 v_exp_f32 v242, v142
 v_cvt_pk_bf16_f32 v168, v240, v241
 v_exp_f32 v243, v143
 v_exp_f32 v240, v144
 v_cvt_pk_bf16_f32 v169, v242, v243
 v_exp_f32 v241, v145
 v_exp_f32 v242, v146
 v_cvt_pk_bf16_f32 v170, v240, v241
 v_exp_f32 v243, v147
 s_nop 0
 v_cvt_pk_bf16_f32 v171, v242, v243
 v_add_f32 v190, v188, v189
 s_nop 1
 v_mfma_f32_16x16x32_bf16 v[192:195], v[248:251], v[164:167], v[188:191]
 v_mfma_f32_16x16x32_bf16 v[192:195], v[252:255], v[168:171], v[192:195]
 v_exp_f32 v240, v148
 v_exp_f32 v241, v149
 v_exp_f32 v242, v150
 v_cvt_pk_bf16_f32 v172, v240, v241
 v_exp_f32 v243, v151
 v_exp_f32 v240, v152
 v_cvt_pk_bf16_f32 v173, v242, v243
 s_nop 7
 s_branch KB_RET_UOB_0
KB_RARE_UOB_1:
 v_max3_f32 v236, v148, v149, v150
 v_max3_f32 v235, v156, v157, v158
 v_max3_f32 v236, v236, v151, v152
 v_max3_f32 v235, v235, v159, v160
 v_max3_f32 v236, v236, v153, v154
 v_max3_f32 v235, v235, v161, v162
 v_max_f32 v236, v236, v155
 v_max_f32 v235, v235, v163
 v_mov_b32 v237, v236
 v_mov_b32 v240, v235
 s_nop 0
 v_permlane32_swap_b32 v236, v237
 v_permlane32_swap_b32 v235, v240
 v_max_f32 v236, v236, v237
 v_max_f32 v235, v235, v240
 v_mov_b32 v237, v236
 v_mov_b32 v240, v235
 s_nop 0
 v_permlane16_swap_b32 v236, v237
 v_permlane16_swap_b32 v235, v240
 v_max_f32 v236, v236, v237
 v_max_f32 v235, v235, v240
 v_max_f32 v237, 0, v236
 v_max_f32 v240, 0, v235
 v_exp_f32 v238, -v237
 v_exp_f32 v241, -v240
 v_sub_f32 v148, v148, v237
 v_sub_f32 v149, v149, v237
 v_sub_f32 v150, v150, v237
 v_sub_f32 v151, v151, v237
 v_sub_f32 v152, v152, v237
 v_sub_f32 v153, v153, v237
 v_sub_f32 v154, v154, v237
 v_sub_f32 v155, v155, v237
 v_sub_f32 v100, v100, v237
 v_sub_f32 v101, v101, v237
 v_sub_f32 v102, v102, v237
 v_sub_f32 v103, v103, v237
 v_sub_f32 v104, v104, v237
 v_sub_f32 v105, v105, v237
 v_sub_f32 v106, v106, v237
 v_sub_f32 v107, v107, v237
 v_sub_f32 v116, v116, v237
 v_sub_f32 v117, v117, v237
 v_sub_f32 v118, v118, v237
 v_sub_f32 v119, v119, v237
 v_sub_f32 v120, v120, v237
 v_sub_f32 v121, v121, v237
 v_sub_f32 v122, v122, v237
 v_sub_f32 v123, v123, v237
 v_mul_f32 v36, v36, v238
 v_mul_f32 v37, v37, v238
 v_mul_f32 v38, v38, v238
 v_mul_f32 v39, v39, v238
 v_mul_f32 v40, v40, v238
 v_mul_f32 v41, v41, v238
 v_mul_f32 v42, v42, v238
 v_mul_f32 v43, v43, v238
 v_mul_f32 v52, v52, v238
 v_mul_f32 v53, v53, v238
 v_mul_f32 v54, v54, v238
 v_mul_f32 v55, v55, v238
 v_mul_f32 v56, v56, v238
 v_mul_f32 v57, v57, v238
 v_mul_f32 v58, v58, v238
 v_mul_f32 v59, v59, v238
 v_mul_f32 v68, v68, v238
 v_mul_f32 v69, v69, v238
 v_mul_f32 v70, v70, v238
 v_mul_f32 v71, v71, v238
 v_mul_f32 v72, v72, v238
 v_mul_f32 v73, v73, v238
 v_mul_f32 v74, v74, v238
 v_mul_f32 v75, v75, v238
 v_mul_f32 v84, v84, v238
 v_mul_f32 v85, v85, v238
 v_mul_f32 v86, v86, v238
 v_mul_f32 v87, v87, v238
 v_mul_f32 v88, v88, v238
 v_mul_f32 v89, v89, v238
 v_mul_f32 v90, v90, v238
 v_mul_f32 v91, v91, v238
 v_mul_f32 v192, v192, v238
 v_sub_f32 v180, v180, v237
 v_sub_f32 v181, v181, v237
 v_sub_f32 v182, v182, v237
 v_sub_f32 v183, v183, v237
 v_sub_f32 v156, v156, v240
 v_sub_f32 v157, v157, v240
 v_sub_f32 v158, v158, v240
 v_sub_f32 v159, v159, v240
 v_sub_f32 v160, v160, v240
 v_sub_f32 v161, v161, v240
 v_sub_f32 v162, v162, v240
 v_sub_f32 v163, v163, v240
 v_sub_f32 v108, v108, v240
 v_sub_f32 v109, v109, v240
 v_sub_f32 v110, v110, v240
 v_sub_f32 v111, v111, v240
 v_sub_f32 v112, v112, v240
 v_sub_f32 v113, v113, v240
 v_sub_f32 v114, v114, v240
 v_sub_f32 v115, v115, v240
 v_sub_f32 v124, v124, v240
 v_sub_f32 v125, v125, v240
 v_sub_f32 v126, v126, v240
 v_sub_f32 v127, v127, v240
 v_sub_f32 v128, v128, v240
 v_sub_f32 v129, v129, v240
 v_sub_f32 v130, v130, v240
 v_sub_f32 v131, v131, v240
 v_mul_f32 v44, v44, v241
 v_mul_f32 v45, v45, v241
 v_mul_f32 v46, v46, v241
 v_mul_f32 v47, v47, v241
 v_mul_f32 v48, v48, v241
 v_mul_f32 v49, v49, v241
 v_mul_f32 v50, v50, v241
 v_mul_f32 v51, v51, v241
 v_mul_f32 v60, v60, v241
 v_mul_f32 v61, v61, v241
 v_mul_f32 v62, v62, v241
 v_mul_f32 v63, v63, v241
 v_mul_f32 v64, v64, v241
 v_mul_f32 v65, v65, v241
 v_mul_f32 v66, v66, v241
 v_mul_f32 v67, v67, v241
 v_mul_f32 v76, v76, v241
 v_mul_f32 v77, v77, v241
 v_mul_f32 v78, v78, v241
 v_mul_f32 v79, v79, v241
 v_mul_f32 v80, v80, v241
 v_mul_f32 v81, v81, v241
 v_mul_f32 v82, v82, v241
 v_mul_f32 v83, v83, v241
 v_mul_f32 v92, v92, v241
 v_mul_f32 v93, v93, v241
 v_mul_f32 v94, v94, v241
 v_mul_f32 v95, v95, v241
 v_mul_f32 v96, v96, v241
 v_mul_f32 v97, v97, v241
 v_mul_f32 v98, v98, v241
 v_mul_f32 v99, v99, v241
 v_mul_f32 v193, v193, v241
 v_sub_f32 v184, v184, v240
 v_sub_f32 v185, v185, v240
 v_sub_f32 v186, v186, v240
 v_sub_f32 v187, v187, v240
 v_exp_f32 v240, v148
 v_exp_f32 v241, v149
 v_exp_f32 v242, v150
 v_cvt_pk_bf16_f32 v172, v240, v241
 v_exp_f32 v243, v151
 v_exp_f32 v240, v152
 v_cvt_pk_bf16_f32 v173, v242, v243
 v_exp_f32 v241, v153
 v_exp_f32 v242, v154
 v_cvt_pk_bf16_f32 v174, v240, v241
 v_exp_f32 v243, v155
 v_exp_f32 v240, v156
 v_cvt_pk_bf16_f32 v175, v242, v243
 v_exp_f32 v241, v157
 v_exp_f32 v242, v158
 v_cvt_pk_bf16_f32 v176, v240, v241
 v_exp_f32 v243, v159
 v_exp_f32 v240, v160
 v_cvt_pk_bf16_f32 v177, v242, v243
 v_exp_f32 v241, v161
 v_exp_f32 v242, v162
 v_cvt_pk_bf16_f32 v178, v240, v241
 v_exp_f32 v243, v163
 s_nop 0
 v_cvt_pk_bf16_f32 v179, v242, v243
 v_add_f32 v194, v192, v193
 s_nop 1
 v_mfma_f32_16x16x32_bf16 v[188:191], v[248:251], v[172:175], v[192:195]
 v_mfma_f32_16x16x32_bf16 v[188:191], v[252:255], v[176:179], v[188:191]
 v_exp_f32 v240, v100
 v_exp_f32 v241, v101
 v_exp_f32 v242, v102
 v_cvt_pk_bf16_f32 v164, v240, v241
 v_exp_f32 v243, v103
 v_exp_f32 v240, v104
 v_cvt_pk_bf16_f32 v165, v242, v243
 s_nop 7
 s_branch KB_RET_UOB_1
KB_RARE_B0B_0:
 v_max3_f32 v236, v100, v101, v102
 v_max3_f32 v235, v108, v109, v110
 v_max3_f32 v236, v236, v103, v104
 v_max3_f32 v235, v235, v111, v112
 v_max3_f32 v236, v236, v105, v106
 v_max3_f32 v235, v235, v113, v114
 v_max_f32 v236, v236, v107
 v_max_f32 v235, v235, v115
 v_mov_b32 v237, v236
 v_mov_b32 v240, v235
 s_nop 0
 v_permlane32_swap_b32 v236, v237
 v_permlane32_swap_b32 v235, v240
 v_max_f32 v236, v236, v237
 v_max_f32 v235, v235, v240
 v_mov_b32 v237, v236
 v_mov_b32 v240, v235
 s_nop 0
 v_permlane16_swap_b32 v236, v237
 v_permlane16_swap_b32 v235, v240
 v_max_f32 v236, v236, v237
 v_max_f32 v235, v235, v240
 v_max_f32 v237, 0, v236
 v_max_f32 v240, 0, v235
 v_exp_f32 v238, -v237
 v_exp_f32 v241, -v240
 v_sub_f32 v100, v100, v237
 v_sub_f32 v101, v101, v237
 v_sub_f32 v102, v102, v237
 v_sub_f32 v103, v103, v237
 v_sub_f32 v104, v104, v237
 v_sub_f32 v105, v105, v237
 v_sub_f32 v106, v106, v237
 v_sub_f32 v107, v107, v237
 v_sub_f32 v116, v116, v237
 v_sub_f32 v117, v117, v237
 v_sub_f32 v118, v118, v237
 v_sub_f32 v119, v119, v237
 v_sub_f32 v120, v120, v237
 v_sub_f32 v121, v121, v237
 v_sub_f32 v122, v122, v237
 v_sub_f32 v123, v123, v237
 v_sub_f32 v132, v132, v237
 v_sub_f32 v133, v133, v237
 v_sub_f32 v134, v134, v237
 v_sub_f32 v135, v135, v237
 v_sub_f32 v136, v136, v237
 v_sub_f32 v137, v137, v237
 v_sub_f32 v138, v138, v237
 v_sub_f32 v139, v139, v237
 v_mul_f32 v36, v36, v238
 v_mul_f32 v37, v37, v238
 v_mul_f32 v38, v38, v238
 v_mul_f32 v39, v39, v238
 v_mul_f32 v40, v40, v238
 v_mul_f32 v41, v41, v238
 v_mul_f32 v42, v42, v238
 v_mul_f32 v43, v43, v238
 v_mul_f32 v52, v52, v238
 v_mul_f32 v53, v53, v238
 v_mul_f32 v54, v54, v238
 v_mul_f32 v55, v55, v238
 v_mul_f32 v56, v56, v238
 v_mul_f32 v57, v57, v238
 v_mul_f32 v58, v58, v238
 v_mul_f32 v59, v59, v238
 v_mul_f32 v68, v68, v238
 v_mul_f32 v69, v69, v238
 v_mul_f32 v70, v70, v238
 v_mul_f32 v71, v71, v238
 v_mul_f32 v72, v72, v238
 v_mul_f32 v73, v73, v238
 v_mul_f32 v74, v74, v238
 v_mul_f32 v75, v75, v238
 v_mul_f32 v84, v84, v238
 v_mul_f32 v85, v85, v238
 v_mul_f32 v86, v86, v238
 v_mul_f32 v87, v87, v238
 v_mul_f32 v88, v88, v238
 v_mul_f32 v89, v89, v238
 v_mul_f32 v90, v90, v238
 v_mul_f32 v91, v91, v238
 v_mul_f32 v188, v188, v238
 v_sub_f32 v180, v180, v237
 v_sub_f32 v181, v181, v237
 v_sub_f32 v182, v182, v237
 v_sub_f32 v183, v183, v237
 v_sub_f32 v108, v108, v240
 v_sub_f32 v109, v109, v240
 v_sub_f32 v110, v110, v240
 v_sub_f32 v111, v111, v240
 v_sub_f32 v112, v112, v240
 v_sub_f32 v113, v113, v240
 v_sub_f32 v114, v114, v240
 v_sub_f32 v115, v115, v240
 v_sub_f32 v124, v124, v240
 v_sub_f32 v125, v125, v240
 v_sub_f32 v126, v126, v240
 v_sub_f32 v127, v127, v240
 v_sub_f32 v128, v128, v240
 v_sub_f32 v129, v129, v240
 v_sub_f32 v130, v130, v240
 v_sub_f32 v131, v131, v240
 v_sub_f32 v140, v140, v240
 v_sub_f32 v141, v141, v240
 v_sub_f32 v142, v142, v240
 v_sub_f32 v143, v143, v240
 v_sub_f32 v144, v144, v240
 v_sub_f32 v145, v145, v240
 v_sub_f32 v146, v146, v240
 v_sub_f32 v147, v147, v240
 v_mul_f32 v44, v44, v241
 v_mul_f32 v45, v45, v241
 v_mul_f32 v46, v46, v241
 v_mul_f32 v47, v47, v241
 v_mul_f32 v48, v48, v241
 v_mul_f32 v49, v49, v241
 v_mul_f32 v50, v50, v241
 v_mul_f32 v51, v51, v241
 v_mul_f32 v60, v60, v241
 v_mul_f32 v61, v61, v241
 v_mul_f32 v62, v62, v241
 v_mul_f32 v63, v63, v241
 v_mul_f32 v64, v64, v241
 v_mul_f32 v65, v65, v241
 v_mul_f32 v66, v66, v241
 v_mul_f32 v67, v67, v241
 v_mul_f32 v76, v76, v241
 v_mul_f32 v77, v77, v241
 v_mul_f32 v78, v78, v241
 v_mul_f32 v79, v79, v241
 v_mul_f32 v80, v80, v241
 v_mul_f32 v81, v81, v241
 v_mul_f32 v82, v82, v241
 v_mul_f32 v83, v83, v241
 v_mul_f32 v92, v92, v241
 v_mul_f32 v93, v93, v241
 v_mul_f32 v94, v94, v241
 v_mul_f32 v95, v95, v241
 v_mul_f32 v96, v96, v241
 v_mul_f32 v97, v97, v241
 v_mul_f32 v98, v98, v241
 v_mul_f32 v99, v99, v241
 v_mul_f32 v189, v189, v241
 v_sub_f32 v184, v184, v240
 v_sub_f32 v185, v185, v240
 v_sub_f32 v186, v186, v240
 v_sub_f32 v187, v187, v240
 v_exp_f32 v240, v100
 v_exp_f32 v241, v101
 v_exp_f32 v242, v102
 v_cvt_pk_bf16_f32 v164, v240, v241
 v_exp_f32 v243, v103
 v_exp_f32 v240, v104
 v_cvt_pk_bf16_f32 v165, v242, v243
 v_exp_f32 v241, v105
 v_exp_f32 v242, v106
 v_cvt_pk_bf16_f32 v166, v240, v241
 v_exp_f32 v243, v107
 v_exp_f32 v240, v108
 v_cvt_pk_bf16_f32 v167, v242, v243
 v_exp_f32 v241, v109
 v_exp_f32 v242, v110
 v_cvt_pk_bf16_f32 v168, v240, v241
 v_exp_f32 v243, v111
 v_exp_f32 v240, v112
 v_cvt_pk_bf16_f32 v169, v242, v243
 v_exp_f32 v241, v113
 v_exp_f32 v242, v114
 v_cvt_pk_bf16_f32 v170, v240, v241
 v_exp_f32 v243, v115
 s_nop 0
 v_cvt_pk_bf16_f32 v171, v242, v243
 v_add_f32 v190, v188, v189
 s_nop 1
 v_mfma_f32_16x16x32_bf16 v[192:195], v[248:251], v[164:167], v[188:191]
 v_mfma_f32_16x16x32_bf16 v[192:195], v[252:255], v[168:171], v[192:195]
 v_exp_f32 v240, v116
 v_exp_f32 v241, v117
 v_exp_f32 v242, v118
 v_cvt_pk_bf16_f32 v172, v240, v241
 v_exp_f32 v243, v119
 v_exp_f32 v240, v120
 v_cvt_pk_bf16_f32 v173, v242, v243
 s_nop 7
 s_branch KB_RET_B0B_0
KB_RARE_B0B_1:
 v_max3_f32 v236, v116, v117, v118
 v_max3_f32 v235, v124, v125, v126
 v_max3_f32 v236, v236, v119, v120
 v_max3_f32 v235, v235, v127, v128
 v_max3_f32 v236, v236, v121, v122
 v_max3_f32 v235, v235, v129, v130
 v_max_f32 v236, v236, v123
 v_max_f32 v235, v235, v131
 v_mov_b32 v237, v236
 v_mov_b32 v240, v235
 s_nop 0
 v_permlane32_swap_b32 v236, v237
 v_permlane32_swap_b32 v235, v240
 v_max_f32 v236, v236, v237
 v_max_f32 v235, v235, v240
 v_mov_b32 v237, v236
 v_mov_b32 v240, v235
 s_nop 0
 v_permlane16_swap_b32 v236, v237
 v_permlane16_swap_b32 v235, v240
 v_max_f32 v236, v236, v237
 v_max_f32 v235, v235, v240
 v_max_f32 v237, 0, v236
 v_max_f32 v240, 0, v235
 v_exp_f32 v238, -v237
 v_exp_f32 v241, -v240
 v_sub_f32 v116, v116, v237
 v_sub_f32 v117, v117, v237
 v_sub_f32 v118, v118, v237
 v_sub_f32 v119, v119, v237
 v_sub_f32 v120, v120, v237
 v_sub_f32 v121, v121, v237
 v_sub_f32 v122, v122, v237
 v_sub_f32 v123, v123, v237
 v_sub_f32 v132, v132, v237
 v_sub_f32 v133, v133, v237
 v_sub_f32 v134, v134, v237
 v_sub_f32 v135, v135, v237
 v_sub_f32 v136, v136, v237
 v_sub_f32 v137, v137, v237
 v_sub_f32 v138, v138, v237
 v_sub_f32 v139, v139, v237
 v_sub_f32 v148, v148, v237
 v_sub_f32 v149, v149, v237
 v_sub_f32 v150, v150, v237
 v_sub_f32 v151, v151, v237
 v_sub_f32 v152, v152, v237
 v_sub_f32 v153, v153, v237
 v_sub_f32 v154, v154, v237
 v_sub_f32 v155, v155, v237
 v_mul_f32 v36, v36, v238
 v_mul_f32 v37, v37, v238
 v_mul_f32 v38, v38, v238
 v_mul_f32 v39, v39, v238
 v_mul_f32 v40, v40, v238
 v_mul_f32 v41, v41, v238
 v_mul_f32 v42, v42, v238
 v_mul_f32 v43, v43, v238
 v_mul_f32 v52, v52, v238
 v_mul_f32 v53, v53, v238
 v_mul_f32 v54, v54, v238
 v_mul_f32 v55, v55, v238
 v_mul_f32 v56, v56, v238
 v_mul_f32 v57, v57, v238
 v_mul_f32 v58, v58, v238
 v_mul_f32 v59, v59, v238
 v_mul_f32 v68, v68, v238
 v_mul_f32 v69, v69, v238
 v_mul_f32 v70, v70, v238
 v_mul_f32 v71, v71, v238
 v_mul_f32 v72, v72, v238
 v_mul_f32 v73, v73, v238
 v_mul_f32 v74, v74, v238
 v_mul_f32 v75, v75, v238
 v_mul_f32 v84, v84, v238
 v_mul_f32 v85, v85, v238
 v_mul_f32 v86, v86, v238
 v_mul_f32 v87, v87, v238
 v_mul_f32 v88, v88, v238
 v_mul_f32 v89, v89, v238
 v_mul_f32 v90, v90, v238
 v_mul_f32 v91, v91, v238
 v_mul_f32 v192, v192, v238
 v_sub_f32 v180, v180, v237
 v_sub_f32 v181, v181, v237
 v_sub_f32 v182, v182, v237
 v_sub_f32 v183, v183, v237
 v_sub_f32 v124, v124, v240
 v_sub_f32 v125, v125, v240
 v_sub_f32 v126, v126, v240
 v_sub_f32 v127, v127, v240
 v_sub_f32 v128, v128, v240
 v_sub_f32 v129, v129, v240
 v_sub_f32 v130, v130, v240
 v_sub_f32 v131, v131, v240
 v_sub_f32 v140, v140, v240
 v_sub_f32 v141, v141, v240
 v_sub_f32 v142, v142, v240
 v_sub_f32 v143, v143, v240
 v_sub_f32 v144, v144, v240
 v_sub_f32 v145, v145, v240
 v_sub_f32 v146, v146, v240
 v_sub_f32 v147, v147, v240
 v_sub_f32 v156, v156, v240
 v_sub_f32 v157, v157, v240
 v_sub_f32 v158, v158, v240
 v_sub_f32 v159, v159, v240
 v_sub_f32 v160, v160, v240
 v_sub_f32 v161, v161, v240
 v_sub_f32 v162, v162, v240
 v_sub_f32 v163, v163, v240
 v_mul_f32 v44, v44, v241
 v_mul_f32 v45, v45, v241
 v_mul_f32 v46, v46, v241
 v_mul_f32 v47, v47, v241
 v_mul_f32 v48, v48, v241
 v_mul_f32 v49, v49, v241
 v_mul_f32 v50, v50, v241
 v_mul_f32 v51, v51, v241
 v_mul_f32 v60, v60, v241
 v_mul_f32 v61, v61, v241
 v_mul_f32 v62, v62, v241
 v_mul_f32 v63, v63, v241
 v_mul_f32 v64, v64, v241
 v_mul_f32 v65, v65, v241
 v_mul_f32 v66, v66, v241
 v_mul_f32 v67, v67, v241
 v_mul_f32 v76, v76, v241
 v_mul_f32 v77, v77, v241
 v_mul_f32 v78, v78, v241
 v_mul_f32 v79, v79, v241
 v_mul_f32 v80, v80, v241
 v_mul_f32 v81, v81, v241
 v_mul_f32 v82, v82, v241
 v_mul_f32 v83, v83, v241
 v_mul_f32 v92, v92, v241
 v_mul_f32 v93, v93, v241
 v_mul_f32 v94, v94, v241
 v_mul_f32 v95, v95, v241
 v_mul_f32 v96, v96, v241
 v_mul_f32 v97, v97, v241
 v_mul_f32 v98, v98, v241
 v_mul_f32 v99, v99, v241
 v_mul_f32 v193, v193, v241
 v_sub_f32 v184, v184, v240
 v_sub_f32 v185, v185, v240
 v_sub_f32 v186, v186, v240
 v_sub_f32 v187, v187, v240
 v_exp_f32 v240, v116
 v_exp_f32 v241, v117
 v_exp_f32 v242, v118
 v_cvt_pk_bf16_f32 v172, v240, v241
 v_exp_f32 v243, v119
 v_exp_f32 v240, v120
 v_cvt_pk_bf16_f32 v173, v242, v243
 v_exp_f32 v241, v121
 v_exp_f32 v242, v122
 v_cvt_pk_bf16_f32 v174, v240, v241
 v_exp_f32 v243, v123
 v_exp_f32 v240, v124
 v_cvt_pk_bf16_f32 v175, v242, v243
 v_exp_f32 v241, v125
 v_exp_f32 v242, v126
 v_cvt_pk_bf16_f32 v176, v240, v241
 v_exp_f32 v243, v127
 v_exp_f32 v240, v128
 v_cvt_pk_bf16_f32 v177, v242, v243
 v_exp_f32 v241, v129
 v_exp_f32 v242, v130
 v_cvt_pk_bf16_f32 v178, v240, v241
 v_exp_f32 v243, v131
 s_nop 0
 v_cvt_pk_bf16_f32 v179, v242, v243
 v_add_f32 v194, v192, v193
 s_nop 1
 v_mfma_f32_16x16x32_bf16 v[188:191], v[248:251], v[172:175], v[192:195]
 v_mfma_f32_16x16x32_bf16 v[188:191], v[252:255], v[176:179], v[188:191]
 v_exp_f32 v240, v132
 v_exp_f32 v241, v133
 v_exp_f32 v242, v134
 v_cvt_pk_bf16_f32 v164, v240, v241
 v_exp_f32 v243, v135
 v_exp_f32 v240, v136
 v_cvt_pk_bf16_f32 v165, v242, v243
 v_exp_f32 v241, v137
 v_exp_f32 v242, v138
 v_cvt_pk_bf16_f32 v166, v240, v241
 v_exp_f32 v243, v139
 v_exp_f32 v240, v140
 s_nop 7
 s_branch KB_RET_B0B_1
KB_RARE_DB1B_0:
 v_max3_f32 v236, v132, v133, v134
 v_max3_f32 v235, v140, v141, v142
 v_max3_f32 v236, v236, v135, v136
 v_max3_f32 v235, v235, v143, v144
 v_max3_f32 v236, v236, v137, v138
 v_max3_f32 v235, v235, v145, v146
 v_max_f32 v236, v236, v139
 v_max_f32 v235, v235, v147
 v_mov_b32 v237, v236
 v_mov_b32 v240, v235
 s_nop 0
 v_permlane32_swap_b32 v236, v237
 v_permlane32_swap_b32 v235, v240
 v_max_f32 v236, v236, v237
 v_max_f32 v235, v235, v240
 v_mov_b32 v237, v236
 v_mov_b32 v240, v235
 s_nop 0
 v_permlane16_swap_b32 v236, v237
 v_permlane16_swap_b32 v235, v240
 v_max_f32 v236, v236, v237
 v_max_f32 v235, v235, v240
 v_max_f32 v237, 0, v236
 v_max_f32 v240, 0, v235
 v_exp_f32 v238, -v237
 v_exp_f32 v241, -v240
 v_sub_f32 v132, v132, v237
 v_sub_f32 v133, v133, v237
 v_sub_f32 v134, v134, v237
 v_sub_f32 v135, v135, v237
 v_sub_f32 v136, v136, v237
 v_sub_f32 v137, v137, v237
 v_sub_f32 v138, v138, v237
 v_sub_f32 v139, v139, v237
 v_sub_f32 v148, v148, v237
 v_sub_f32 v149, v149, v237
 v_sub_f32 v150, v150, v237
 v_sub_f32 v151, v151, v237
 v_sub_f32 v152, v152, v237
 v_sub_f32 v153, v153, v237
 v_sub_f32 v154, v154, v237
 v_sub_f32 v155, v155, v237
 v_mul_f32 v36, v36, v238
 v_mul_f32 v37, v37, v238
 v_mul_f32 v38, v38, v238
 v_mul_f32 v39, v39, v238
 v_mul_f32 v40, v40, v238
 v_mul_f32 v41, v41, v238
 v_mul_f32 v42, v42, v238
 v_mul_f32 v43, v43, v238
 v_mul_f32 v52, v52, v238
 v_mul_f32 v53, v53, v238
 v_mul_f32 v54, v54, v238
 v_mul_f32 v55, v55, v238
 v_mul_f32 v56, v56, v238
 v_mul_f32 v57, v57, v238
 v_mul_f32 v58, v58, v238
 v_mul_f32 v59, v59, v238
 v_mul_f32 v68, v68, v238
 v_mul_f32 v69, v69, v238
 v_mul_f32 v70, v70, v238
 v_mul_f32 v71, v71, v238
 v_mul_f32 v72, v72, v238
 v_mul_f32 v73, v73, v238
 v_mul_f32 v74, v74, v238
 v_mul_f32 v75, v75, v238
 v_mul_f32 v84, v84, v238
 v_mul_f32 v85, v85, v238
 v_mul_f32 v86, v86, v238
 v_mul_f32 v87, v87, v238
 v_mul_f32 v88, v88, v238
 v_mul_f32 v89, v89, v238
 v_mul_f32 v90, v90, v238
 v_mul_f32 v91, v91, v238
 v_mul_f32 v188, v188, v238
 v_sub_f32 v180, v180, v237
 v_sub_f32 v181, v181, v237
 v_sub_f32 v182, v182, v237
 v_sub_f32 v183, v183, v237
 v_sub_f32 v140, v140, v240
 v_sub_f32 v141, v141, v240
 v_sub_f32 v142, v142, v240
 v_sub_f32 v143, v143, v240
 v_sub_f32 v144, v144, v240
 v_sub_f32 v145, v145, v240
 v_sub_f32 v146, v146, v240
 v_sub_f32 v147, v147, v240
 v_sub_f32 v156, v156, v240
 v_sub_f32 v157, v157, v240
 v_sub_f32 v158, v158, v240
 v_sub_f32 v159, v159, v240
 v_sub_f32 v160, v160, v240
 v_sub_f32 v161, v161, v240
 v_sub_f32 v162, v162, v240
 v_sub_f32 v163, v163, v240
 v_mul_f32 v44, v44, v241
 v_mul_f32 v45, v45, v241
 v_mul_f32 v46, v46, v241
 v_mul_f32 v47, v47, v241
 v_mul_f32 v48, v48, v241
 v_mul_f32 v49, v49, v241
 v_mul_f32 v50, v50, v241
 v_mul_f32 v51, v51, v241
 v_mul_f32 v60, v60, v241
 v_mul_f32 v61, v61, v241
 v_mul_f32 v62, v62, v241
 v_mul_f32 v63, v63, v241
 v_mul_f32 v64, v64, v241
 v_mul_f32 v65, v65, v241
 v_mul_f32 v66, v66, v241
 v_mul_f32 v67, v67, v241
 v_mul_f32 v76, v76, v241
 v_mul_f32 v77, v77, v241
 v_mul_f32 v78, v78, v241
 v_mul_f32 v79, v79, v241
 v_mul_f32 v80, v80, v241
 v_mul_f32 v81, v81, v241
 v_mul_f32 v82, v82, v241
 v_mul_f32 v83, v83, v241
 v_mul_f32 v92, v92, v241
 v_mul_f32 v93, v93, v241
 v_mul_f32 v94, v94, v241
 v_mul_f32 v95, v95, v241
 v_mul_f32 v96, v96, v241
 v_mul_f32 v97, v97, v241
 v_mul_f32 v98, v98, v241
 v_mul_f32 v99, v99, v241
 v_mul_f32 v189, v189, v241
 v_sub_f32 v184, v184, v240
 v_sub_f32 v185, v185, v240
 v_sub_f32 v186, v186, v240
 v_sub_f32 v187, v187, v240
 v_exp_f32 v240, v132
 v_exp_f32 v241, v133
 v_exp_f32 v242, v134
 v_cvt_pk_bf16_f32 v164, v240, v241
 v_exp_f32 v243, v135
 v_exp_f32 v240, v136
 v_cvt_pk_bf16_f32 v165, v242, v243
 v_exp_f32 v241, v137
 v_exp_f32 v242, v138
 v_cvt_pk_bf16_f32 v166, v240, v241
 v_exp_f32 v243, v139
 v_exp_f32 v240, v140
 v_cvt_pk_bf16_f32 v167, v242, v243
 v_exp_f32 v241, v141
 v_exp_f32 v242, v142
 v_cvt_pk_bf16_f32 v168, v240, v241
 v_exp_f32 v243, v143
 v_exp_f32 v240, v144
 v_cvt_pk_bf16_f32 v169, v242, v243
 v_exp_f32 v241, v145
 v_exp_f32 v242, v146
 v_cvt_pk_bf16_f32 v170, v240, v241
 v_exp_f32 v243, v147
 s_nop 0
 v_cvt_pk_bf16_f32 v171, v242, v243
 v_add_f32 v190, v188, v189
 s_nop 1
 v_mfma_f32_16x16x32_bf16 v[192:195], v[248:251], v[164:167], v[188:191]
 v_mfma_f32_16x16x32_bf16 v[192:195], v[252:255], v[168:171], v[192:195]
 v_exp_f32 v240, v148
 v_exp_f32 v241, v149
 v_exp_f32 v242, v150
 v_cvt_pk_bf16_f32 v172, v240, v241
 v_exp_f32 v243, v151
 v_exp_f32 v240, v152
 v_cvt_pk_bf16_f32 v173, v242, v243
 v_exp_f32 v241, v153
 s_nop 7
 s_branch KB_RET_DB1B_0
KB_RARE_DB1B_1:
 v_max3_f32 v236, v148, v149, v150
 v_max3_f32 v235, v156, v157, v158
 v_max3_f32 v236, v236, v151, v152
 v_max3_f32 v235, v235, v159, v160
 v_max3_f32 v236, v236, v153, v154
 v_max3_f32 v235, v235, v161, v162
 v_max_f32 v236, v236, v155
 v_max_f32 v235, v235, v163
 v_mov_b32 v237, v236
 v_mov_b32 v240, v235
 s_nop 0
 v_permlane32_swap_b32 v236, v237
 v_permlane32_swap_b32 v235, v240
 v_max_f32 v236, v236, v237
 v_max_f32 v235, v235, v240
 v_mov_b32 v237, v236
 v_mov_b32 v240, v235
 s_nop 0
 v_permlane16_swap_b32 v236, v237
 v_permlane16_swap_b32 v235, v240
 v_max_f32 v236, v236, v237
 v_max_f32 v235, v235, v240
 v_max_f32 v237, 0, v236
 v_max_f32 v240, 0, v235
 v_exp_f32 v238, -v237
 v_exp_f32 v241, -v240
 v_sub_f32 v148, v148, v237
 v_sub_f32 v149, v149, v237
 v_sub_f32 v150, v150, v237
 v_sub_f32 v151, v151, v237
 v_sub_f32 v152, v152, v237
 v_sub_f32 v153, v153, v237
 v_sub_f32 v154, v154, v237
 v_sub_f32 v155, v155, v237
 v_mul_f32 v36, v36, v238
 v_mul_f32 v37, v37, v238
 v_mul_f32 v38, v38, v238
 v_mul_f32 v39, v39, v238
 v_mul_f32 v40, v40, v238
 v_mul_f32 v41, v41, v238
 v_mul_f32 v42, v42, v238
 v_mul_f32 v43, v43, v238
 v_mul_f32 v52, v52, v238
 v_mul_f32 v53, v53, v238
 v_mul_f32 v54, v54, v238
 v_mul_f32 v55, v55, v238
 v_mul_f32 v56, v56, v238
 v_mul_f32 v57, v57, v238
 v_mul_f32 v58, v58, v238
 v_mul_f32 v59, v59, v238
 v_mul_f32 v68, v68, v238
 v_mul_f32 v69, v69, v238
 v_mul_f32 v70, v70, v238
 v_mul_f32 v71, v71, v238
 v_mul_f32 v72, v72, v238
 v_mul_f32 v73, v73, v238
 v_mul_f32 v74, v74, v238
 v_mul_f32 v75, v75, v238
 v_mul_f32 v84, v84, v238
 v_mul_f32 v85, v85, v238
 v_mul_f32 v86, v86, v238
 v_mul_f32 v87, v87, v238
 v_mul_f32 v88, v88, v238
 v_mul_f32 v89, v89, v238
 v_mul_f32 v90, v90, v238
 v_mul_f32 v91, v91, v238
 v_mul_f32 v192, v192, v238
 v_sub_f32 v180, v180, v237
 v_sub_f32 v181, v181, v237
 v_sub_f32 v182, v182, v237
 v_sub_f32 v183, v183, v237
 v_sub_f32 v156, v156, v240
 v_sub_f32 v157, v157, v240
 v_sub_f32 v158, v158, v240
 v_sub_f32 v159, v159, v240
 v_sub_f32 v160, v160, v240
 v_sub_f32 v161, v161, v240
 v_sub_f32 v162, v162, v240
 v_sub_f32 v163, v163, v240
 v_mul_f32 v44, v44, v241
 v_mul_f32 v45, v45, v241
 v_mul_f32 v46, v46, v241
 v_mul_f32 v47, v47, v241
 v_mul_f32 v48, v48, v241
 v_mul_f32 v49, v49, v241
 v_mul_f32 v50, v50, v241
 v_mul_f32 v51, v51, v241
 v_mul_f32 v60, v60, v241
 v_mul_f32 v61, v61, v241
 v_mul_f32 v62, v62, v241
 v_mul_f32 v63, v63, v241
 v_mul_f32 v64, v64, v241
 v_mul_f32 v65, v65, v241
 v_mul_f32 v66, v66, v241
 v_mul_f32 v67, v67, v241
 v_mul_f32 v76, v76, v241
 v_mul_f32 v77, v77, v241
 v_mul_f32 v78, v78, v241
 v_mul_f32 v79, v79, v241
 v_mul_f32 v80, v80, v241
 v_mul_f32 v81, v81, v241
 v_mul_f32 v82, v82, v241
 v_mul_f32 v83, v83, v241
 v_mul_f32 v92, v92, v241
 v_mul_f32 v93, v93, v241
 v_mul_f32 v94, v94, v241
 v_mul_f32 v95, v95, v241
 v_mul_f32 v96, v96, v241
 v_mul_f32 v97, v97, v241
 v_mul_f32 v98, v98, v241
 v_mul_f32 v99, v99, v241
 v_mul_f32 v193, v193, v241
 v_sub_f32 v184, v184, v240
 v_sub_f32 v185, v185, v240
 v_sub_f32 v186, v186, v240
 v_sub_f32 v187, v187, v240
 v_exp_f32 v240, v148
 v_exp_f32 v241, v149
 v_exp_f32 v242, v150
 v_cvt_pk_bf16_f32 v172, v240, v241
 v_exp_f32 v243, v151
 v_exp_f32 v240, v152
 v_cvt_pk_bf16_f32 v173, v242, v243
 v_exp_f32 v241, v153
 v_exp_f32 v242, v154
 v_cvt_pk_bf16_f32 v174, v240, v241
 v_exp_f32 v243, v155
 v_exp_f32 v240, v156
 v_cvt_pk_bf16_f32 v175, v242, v243
 v_exp_f32 v241, v157
 v_exp_f32 v242, v158
 v_cvt_pk_bf16_f32 v176, v240, v241
 v_exp_f32 v243, v159
 v_exp_f32 v240, v160
 v_cvt_pk_bf16_f32 v177, v242, v243
 v_exp_f32 v241, v161
 v_exp_f32 v242, v162
 v_cvt_pk_bf16_f32 v178, v240, v241
 v_exp_f32 v243, v163
 s_nop 0
 v_cvt_pk_bf16_f32 v179, v242, v243
 v_add_f32 v194, v192, v193
 s_nop 1
 v_mfma_f32_16x16x32_bf16 v[188:191], v[248:251], v[172:175], v[192:195]
 v_mfma_f32_16x16x32_bf16 v[188:191], v[252:255], v[176:179], v[188:191]
 s_nop 7
 s_branch KB_RET_DB1B_1
KB_RARE_A0B_0:
 v_max3_f32 v236, v100, v101, v102
 v_max3_f32 v235, v108, v109, v110
 v_max3_f32 v236, v236, v103, v104
 v_max3_f32 v235, v235, v111, v112
 v_max3_f32 v236, v236, v105, v106
 v_max3_f32 v235, v235, v113, v114
 v_max_f32 v236, v236, v107
 v_max_f32 v235, v235, v115
 v_mov_b32 v237, v236
 v_mov_b32 v240, v235
 s_nop 0
 v_permlane32_swap_b32 v236, v237
 v_permlane32_swap_b32 v235, v240
 v_max_f32 v236, v236, v237
 v_max_f32 v235, v235, v240
 v_mov_b32 v237, v236
 v_mov_b32 v240, v235
 s_nop 0
 v_permlane16_swap_b32 v236, v237
 v_permlane16_swap_b32 v235, v240
 v_max_f32 v236, v236, v237
 v_max_f32 v235, v235, v240
 v_max_f32 v237, 0, v236
 v_max_f32 v240, 0, v235
 v_exp_f32 v238, -v237
 v_exp_f32 v241, -v240
 v_sub_f32 v100, v100, v237
 v_sub_f32 v101, v101, v237
 v_sub_f32 v102, v102, v237
 v_sub_f32 v103, v103, v237
 v_sub_f32 v104, v104, v237
 v_sub_f32 v105, v105, v237
 v_sub_f32 v106, v106, v237
 v_sub_f32 v107, v107, v237
 v_sub_f32 v116, v116, v237
 v_sub_f32 v117, v117, v237
 v_sub_f32 v118, v118, v237
 v_sub_f32 v119, v119, v237
 v_sub_f32 v120, v120, v237
 v_sub_f32 v121, v121, v237
 v_sub_f32 v122, v122, v237
 v_sub_f32 v123, v123, v237
 v_sub_f32 v132, v132, v237
 v_sub_f32 v133, v133, v237
 v_sub_f32 v134, v134, v237
 v_sub_f32 v135, v135, v237
 v_sub_f32 v136, v136, v237
 v_sub_f32 v137, v137, v237
 v_sub_f32 v138, v138, v237
 v_sub_f32 v139, v139, v237
 v_mul_f32 v36, v36, v238
 v_mul_f32 v37, v37, v238
 v_mul_f32 v38, v38, v238
 v_mul_f32 v39, v39, v238
 v_mul_f32 v40, v40, v238
 v_mul_f32 v41, v41, v238
 v_mul_f32 v42, v42, v238
 v_mul_f32 v43, v43, v238
 v_mul_f32 v52, v52, v238
 v_mul_f32 v53, v53, v238
 v_mul_f32 v54, v54, v238
 v_mul_f32 v55, v55, v238
 v_mul_f32 v56, v56, v238
 v_mul_f32 v57, v57, v238
 v_mul_f32 v58, v58, v238
 v_mul_f32 v59, v59, v238
 v_mul_f32 v68, v68, v238
 v_mul_f32 v69, v69, v238
 v_mul_f32 v70, v70, v238
 v_mul_f32 v71, v71, v238
 v_mul_f32 v72, v72, v238
 v_mul_f32 v73, v73, v238
 v_mul_f32 v74, v74, v238
 v_mul_f32 v75, v75, v238
 v_mul_f32 v84, v84, v238
 v_mul_f32 v85, v85, v238
 v_mul_f32 v86, v86, v238
 v_mul_f32 v87, v87, v238
 v_mul_f32 v88, v88, v238
 v_mul_f32 v89, v89, v238
 v_mul_f32 v90, v90, v238
 v_mul_f32 v91, v91, v238
 v_mul_f32 v188, v188, v238
 v_sub_f32 v180, v180, v237
 v_sub_f32 v181, v181, v237
 v_sub_f32 v182, v182, v237
 v_sub_f32 v183, v183, v237
 v_sub_f32 v108, v108, v240
 v_sub_f32 v109, v109, v240
 v_sub_f32 v110, v110, v240
 v_sub_f32 v111, v111, v240
 v_sub_f32 v112, v112, v240
 v_sub_f32 v113, v113, v240
 v_sub_f32 v114, v114, v240
 v_sub_f32 v115, v115, v240
 v_sub_f32 v124, v124, v240
 v_sub_f32 v125, v125, v240
 v_sub_f32 v126, v126, v240
 v_sub_f32 v127, v127, v240
 v_sub_f32 v128, v128, v240
 v_sub_f32 v129, v129, v240
 v_sub_f32 v130, v130, v240
 v_sub_f32 v131, v131, v240
 v_sub_f32 v140, v140, v240
 v_sub_f32 v141, v141, v240
 v_sub_f32 v142, v142, v240
 v_sub_f32 v143, v143, v240
 v_sub_f32 v144, v144, v240
 v_sub_f32 v145, v145, v240
 v_sub_f32 v146, v146, v240
 v_sub_f32 v147, v147, v240
 v_mul_f32 v44, v44, v241
 v_mul_f32 v45, v45, v241
 v_mul_f32 v46, v46, v241
 v_mul_f32 v47, v47, v241
 v_mul_f32 v48, v48, v241
 v_mul_f32 v49, v49, v241
 v_mul_f32 v50, v50, v241
 v_mul_f32 v51, v51, v241
 v_mul_f32 v60, v60, v241
 v_mul_f32 v61, v61, v241
 v_mul_f32 v62, v62, v241
 v_mul_f32 v63, v63, v241
 v_mul_f32 v64, v64, v241
 v_mul_f32 v65, v65, v241
 v_mul_f32 v66, v66, v241
 v_mul_f32 v67, v67, v241
 v_mul_f32 v76, v76, v241
 v_mul_f32 v77, v77, v241
 v_mul_f32 v78, v78, v241
 v_mul_f32 v79, v79, v241
 v_mul_f32 v80, v80, v241
 v_mul_f32 v81, v81, v241
 v_mul_f32 v82, v82, v241
 v_mul_f32 v83, v83, v241
 v_mul_f32 v92, v92, v241
 v_mul_f32 v93, v93, v241
 v_mul_f32 v94, v94, v241
 v_mul_f32 v95, v95, v241
 v_mul_f32 v96, v96, v241
 v_mul_f32 v97, v97, v241
 v_mul_f32 v98, v98, v241
 v_mul_f32 v99, v99, v241
 v_mul_f32 v189, v189, v241
 v_sub_f32 v184, v184, v240
 v_sub_f32 v185, v185, v240
 v_sub_f32 v186, v186, v240
 v_sub_f32 v187, v187, v240
 v_exp_f32 v240, v100
 v_exp_f32 v241, v101
 v_exp_f32 v242, v102
 v_cvt_pk_bf16_f32 v164, v240, v241
 v_exp_f32 v243, v103
 v_exp_f32 v240, v104
 v_cvt_pk_bf16_f32 v165, v242, v243
 v_exp_f32 v241, v105
 v_exp_f32 v242, v106
 v_cvt_pk_bf16_f32 v166, v240, v241
 v_exp_f32 v243, v107
 v_exp_f32 v240, v108
 v_cvt_pk_bf16_f32 v167, v242, v243
 v_exp_f32 v241, v109
 v_exp_f32 v242, v110
 v_cvt_pk_bf16_f32 v168, v240, v241
 v_exp_f32 v243, v111
 v_exp_f32 v240, v112
 v_cvt_pk_bf16_f32 v169, v242, v243
 v_exp_f32 v241, v113
 v_exp_f32 v242, v114
 v_cvt_pk_bf16_f32 v170, v240, v241
 v_exp_f32 v243, v115
 s_nop 0
 v_cvt_pk_bf16_f32 v171, v242, v243
 v_add_f32 v190, v188, v189
 s_nop 1
 v_mfma_f32_16x16x32_bf16 v[192:195], v[248:251], v[164:167], v[188:191]
 v_mfma_f32_16x16x32_bf16 v[192:195], v[252:255], v[168:171], v[192:195]
 v_exp_f32 v240, v116
 v_exp_f32 v241, v117
 v_exp_f32 v242, v118
 v_cvt_pk_bf16_f32 v172, v240, v241
 v_exp_f32 v243, v119
 v_exp_f32 v240, v120
 v_cvt_pk_bf16_f32 v173, v242, v243
 s_nop 7
 s_branch KB_RET_A0B_0
KB_RARE_A0B_1:
 v_max3_f32 v236, v116, v117, v118
 v_max3_f32 v235, v124, v125, v126
 v_max3_f32 v236, v236, v119, v120
 v_max3_f32 v235, v235, v127, v128
 v_max3_f32 v236, v236, v121, v122
 v_max3_f32 v235, v235, v129, v130
 v_max_f32 v236, v236, v123
 v_max_f32 v235, v235, v131
 v_mov_b32 v237, v236
 v_mov_b32 v240, v235
 s_nop 0
 v_permlane32_swap_b32 v236, v237
 v_permlane32_swap_b32 v235, v240
 v_max_f32 v236, v236, v237
 v_max_f32 v235, v235, v240
 v_mov_b32 v237, v236
 v_mov_b32 v240, v235
 s_nop 0
 v_permlane16_swap_b32 v236, v237
 v_permlane16_swap_b32 v235, v240
 v_max_f32 v236, v236, v237
 v_max_f32 v235, v235, v240
 v_max_f32 v237, 0, v236
 v_max_f32 v240, 0, v235
 v_exp_f32 v238, -v237
 v_exp_f32 v241, -v240
 v_sub_f32 v116, v116, v237
 v_sub_f32 v117, v117, v237
 v_sub_f32 v118, v118, v237
 v_sub_f32 v119, v119, v237
 v_sub_f32 v120, v120, v237
 v_sub_f32 v121, v121, v237
 v_sub_f32 v122, v122, v237
 v_sub_f32 v123, v123, v237
 v_sub_f32 v132, v132, v237
 v_sub_f32 v133, v133, v237
 v_sub_f32 v134, v134, v237
 v_sub_f32 v135, v135, v237
 v_sub_f32 v136, v136, v237
 v_sub_f32 v137, v137, v237
 v_sub_f32 v138, v138, v237
 v_sub_f32 v139, v139, v237
 v_mul_f32 v36, v36, v238
 v_mul_f32 v37, v37, v238
 v_mul_f32 v38, v38, v238
 v_mul_f32 v39, v39, v238
 v_mul_f32 v40, v40, v238
 v_mul_f32 v41, v41, v238
 v_mul_f32 v42, v42, v238
 v_mul_f32 v43, v43, v238
 v_mul_f32 v52, v52, v238
 v_mul_f32 v53, v53, v238
 v_mul_f32 v54, v54, v238
 v_mul_f32 v55, v55, v238
 v_mul_f32 v56, v56, v238
 v_mul_f32 v57, v57, v238
 v_mul_f32 v58, v58, v238
 v_mul_f32 v59, v59, v238
 v_mul_f32 v68, v68, v238
 v_mul_f32 v69, v69, v238
 v_mul_f32 v70, v70, v238
 v_mul_f32 v71, v71, v238
 v_mul_f32 v72, v72, v238
 v_mul_f32 v73, v73, v238
 v_mul_f32 v74, v74, v238
 v_mul_f32 v75, v75, v238
 v_mul_f32 v84, v84, v238
 v_mul_f32 v85, v85, v238
 v_mul_f32 v86, v86, v238
 v_mul_f32 v87, v87, v238
 v_mul_f32 v88, v88, v238
 v_mul_f32 v89, v89, v238
 v_mul_f32 v90, v90, v238
 v_mul_f32 v91, v91, v238
 v_mul_f32 v192, v192, v238
 v_sub_f32 v180, v180, v237
 v_sub_f32 v181, v181, v237
 v_sub_f32 v182, v182, v237
 v_sub_f32 v183, v183, v237
 v_sub_f32 v124, v124, v240
 v_sub_f32 v125, v125, v240
 v_sub_f32 v126, v126, v240
 v_sub_f32 v127, v127, v240
 v_sub_f32 v128, v128, v240
 v_sub_f32 v129, v129, v240
 v_sub_f32 v130, v130, v240
 v_sub_f32 v131, v131, v240
 v_sub_f32 v140, v140, v240
 v_sub_f32 v141, v141, v240
 v_sub_f32 v142, v142, v240
 v_sub_f32 v143, v143, v240
 v_sub_f32 v144, v144, v240
 v_sub_f32 v145, v145, v240
 v_sub_f32 v146, v146, v240
 v_sub_f32 v147, v147, v240
 v_mul_f32 v44, v44, v241
 v_mul_f32 v45, v45, v241
 v_mul_f32 v46, v46, v241
 v_mul_f32 v47, v47, v241
 v_mul_f32 v48, v48, v241
 v_mul_f32 v49, v49, v241
 v_mul_f32 v50, v50, v241
 v_mul_f32 v51, v51, v241
 v_mul_f32 v60, v60, v241
 v_mul_f32 v61, v61, v241
 v_mul_f32 v62, v62, v241
 v_mul_f32 v63, v63, v241
 v_mul_f32 v64, v64, v241
 v_mul_f32 v65, v65, v241
 v_mul_f32 v66, v66, v241
 v_mul_f32 v67, v67, v241
 v_mul_f32 v76, v76, v241
 v_mul_f32 v77, v77, v241
 v_mul_f32 v78, v78, v241
 v_mul_f32 v79, v79, v241
 v_mul_f32 v80, v80, v241
 v_mul_f32 v81, v81, v241
 v_mul_f32 v82, v82, v241
 v_mul_f32 v83, v83, v241
 v_mul_f32 v92, v92, v241
 v_mul_f32 v93, v93, v241
 v_mul_f32 v94, v94, v241
 v_mul_f32 v95, v95, v241
 v_mul_f32 v96, v96, v241
 v_mul_f32 v97, v97, v241
 v_mul_f32 v98, v98, v241
 v_mul_f32 v99, v99, v241
 v_mul_f32 v193, v193, v241
 v_sub_f32 v184, v184, v240
 v_sub_f32 v185, v185, v240
 v_sub_f32 v186, v186, v240
 v_sub_f32 v187, v187, v240
 v_exp_f32 v240, v116
 v_exp_f32 v241, v117
 v_exp_f32 v242, v118
 v_cvt_pk_bf16_f32 v172, v240, v241
 v_exp_f32 v243, v119
 v_exp_f32 v240, v120
 v_cvt_pk_bf16_f32 v173, v242, v243
 v_exp_f32 v241, v121
 v_exp_f32 v242, v122
 v_cvt_pk_bf16_f32 v174, v240, v241
 v_exp_f32 v243, v123
 v_exp_f32 v240, v124
 v_cvt_pk_bf16_f32 v175, v242, v243
 v_exp_f32 v241, v125
 v_exp_f32 v242, v126
 v_cvt_pk_bf16_f32 v176, v240, v241
 v_exp_f32 v243, v127
 v_exp_f32 v240, v128
 v_cvt_pk_bf16_f32 v177, v242, v243
 v_exp_f32 v241, v129
 v_exp_f32 v242, v130
 v_cvt_pk_bf16_f32 v178, v240, v241
 v_exp_f32 v243, v131
 s_nop 0
 v_cvt_pk_bf16_f32 v179, v242, v243
 v_add_f32 v194, v192, v193
 s_nop 1
 v_mfma_f32_16x16x32_bf16 v[188:191], v[248:251], v[172:175], v[192:195]
 v_mfma_f32_16x16x32_bf16 v[188:191], v[252:255], v[176:179], v[188:191]
 v_cmp_gt_i32 s[44:45], 0, v245
 v_cmp_gt_i32 s[46:47], 1, v245
 v_cmp_gt_i32 s[48:49], 2, v245
 v_cmp_gt_i32 s[50:51], 3, v245
 v_cndmask_b32 v132, v132, v246, s[44:45]
 v_cndmask_b32 v133, v133, v246, s[46:47]
 v_cndmask_b32 v134, v134, v246, s[48:49]
 v_cndmask_b32 v135, v135, v246, s[50:51]
 s_nop 7
 s_branch KB_RET_A0B_1
KB_RARE_DA1B_0:
 v_max3_f32 v236, v132, v133, v134
 v_max3_f32 v235, v140, v141, v142
 v_max3_f32 v236, v236, v135, v136
 v_max3_f32 v235, v235, v143, v144
 v_max3_f32 v236, v236, v137, v138
 v_max3_f32 v235, v235, v145, v146
 v_max_f32 v236, v236, v139
 v_max_f32 v235, v235, v147
 v_mov_b32 v237, v236
 v_mov_b32 v240, v235
 s_nop 0
 v_permlane32_swap_b32 v236, v237
 v_permlane32_swap_b32 v235, v240
 v_max_f32 v236, v236, v237
 v_max_f32 v235, v235, v240
 v_mov_b32 v237, v236
 v_mov_b32 v240, v235
 s_nop 0
 v_permlane16_swap_b32 v236, v237
 v_permlane16_swap_b32 v235, v240
 v_max_f32 v236, v236, v237
 v_max_f32 v235, v235, v240
 v_max_f32 v237, 0, v236
 v_max_f32 v240, 0, v235
 v_exp_f32 v238, -v237
 v_exp_f32 v241, -v240
 v_sub_f32 v132, v132, v237
 v_sub_f32 v133, v133, v237
 v_sub_f32 v134, v134, v237
 v_sub_f32 v135, v135, v237
 v_sub_f32 v136, v136, v237
 v_sub_f32 v137, v137, v237
 v_sub_f32 v138, v138, v237
 v_sub_f32 v139, v139, v237
 v_mul_f32 v36, v36, v238
 v_mul_f32 v37, v37, v238
 v_mul_f32 v38, v38, v238
 v_mul_f32 v39, v39, v238
 v_mul_f32 v40, v40, v238
 v_mul_f32 v41, v41, v238
 v_mul_f32 v42, v42, v238
 v_mul_f32 v43, v43, v238
 v_mul_f32 v52, v52, v238
 v_mul_f32 v53, v53, v238
 v_mul_f32 v54, v54, v238
 v_mul_f32 v55, v55, v238
 v_mul_f32 v56, v56, v238
 v_mul_f32 v57, v57, v238
 v_mul_f32 v58, v58, v238
 v_mul_f32 v59, v59, v238
 v_mul_f32 v68, v68, v238
 v_mul_f32 v69, v69, v238
 v_mul_f32 v70, v70, v238
 v_mul_f32 v71, v71, v238
 v_mul_f32 v72, v72, v238
 v_mul_f32 v73, v73, v238
 v_mul_f32 v74, v74, v238
 v_mul_f32 v75, v75, v238
 v_mul_f32 v84, v84, v238
 v_mul_f32 v85, v85, v238
 v_mul_f32 v86, v86, v238
 v_mul_f32 v87, v87, v238
 v_mul_f32 v88, v88, v238
 v_mul_f32 v89, v89, v238
 v_mul_f32 v90, v90, v238
 v_mul_f32 v91, v91, v238
 v_mul_f32 v188, v188, v238
 v_sub_f32 v180, v180, v237
 v_sub_f32 v181, v181, v237
 v_sub_f32 v182, v182, v237
 v_sub_f32 v183, v183, v237
 v_sub_f32 v140, v140, v240
 v_sub_f32 v141, v141, v240
 v_sub_f32 v142, v142, v240
 v_sub_f32 v143, v143, v240
 v_sub_f32 v144, v144, v240
 v_sub_f32 v145, v145, v240
 v_sub_f32 v146, v146, v240
 v_sub_f32 v147, v147, v240
 v_mul_f32 v44, v44, v241
 v_mul_f32 v45, v45, v241
 v_mul_f32 v46, v46, v241
 v_mul_f32 v47, v47, v241
 v_mul_f32 v48, v48, v241
 v_mul_f32 v49, v49, v241
 v_mul_f32 v50, v50, v241
 v_mul_f32 v51, v51, v241
 v_mul_f32 v60, v60, v241
 v_mul_f32 v61, v61, v241
 v_mul_f32 v62, v62, v241
 v_mul_f32 v63, v63, v241
 v_mul_f32 v64, v64, v241
 v_mul_f32 v65, v65, v241
 v_mul_f32 v66, v66, v241
 v_mul_f32 v67, v67, v241
 v_mul_f32 v76, v76, v241
 v_mul_f32 v77, v77, v241
 v_mul_f32 v78, v78, v241
 v_mul_f32 v79, v79, v241
 v_mul_f32 v80, v80, v241
 v_mul_f32 v81, v81, v241
 v_mul_f32 v82, v82, v241
 v_mul_f32 v83, v83, v241
 v_mul_f32 v92, v92, v241
 v_mul_f32 v93, v93, v241
 v_mul_f32 v94, v94, v241
 v_mul_f32 v95, v95, v241
 v_mul_f32 v96, v96, v241
 v_mul_f32 v97, v97, v241
 v_mul_f32 v98, v98, v241
 v_mul_f32 v99, v99, v241
 v_mul_f32 v189, v189, v241
 v_sub_f32 v184, v184, v240
 v_sub_f32 v185, v185, v240
 v_sub_f32 v186, v186, v240
 v_sub_f32 v187, v187, v240
 v_exp_f32 v240, v132
 v_exp_f32 v241, v133
 v_exp_f32 v242, v134
 v_cvt_pk_bf16_f32 v164, v240, v241
 v_exp_f32 v243, v135
 v_exp_f32 v240, v136
 v_cvt_pk_bf16_f32 v165, v242, v243
 v_exp_f32 v241, v137
 v_exp_f32 v242, v138
 v_cvt_pk_bf16_f32 v166, v240, v241
 v_exp_f32 v243, v139
 v_exp_f32 v240, v140
 v_cvt_pk_bf16_f32 v167, v242, v243
 v_exp_f32 v241, v141
 v_exp_f32 v242, v142
 v_cvt_pk_bf16_f32 v168, v240, v241
 v_exp_f32 v243, v143
 v_exp_f32 v240, v144
 v_cvt_pk_bf16_f32 v169, v242, v243
 v_exp_f32 v241, v145
 v_exp_f32 v242, v146
 v_cvt_pk_bf16_f32 v170, v240, v241
 v_exp_f32 v243, v147
 s_nop 0
 v_cvt_pk_bf16_f32 v171, v242, v243
 v_add_f32 v190, v188, v189
 s_nop 1
 v_mfma_f32_16x16x32_bf16 v[192:195], v[248:251], v[164:167], v[188:191]
 v_mfma_f32_16x16x32_bf16 v[192:195], v[252:255], v[168:171], v[192:195]
 s_nop 7
 s_branch KB_RET_DA1B_0
KB_RARE_B1B_0:
 v_max3_f32 v236, v132, v133, v134
 v_max3_f32 v235, v140, v141, v142
 v_max3_f32 v236, v236, v135, v136
 v_max3_f32 v235, v235, v143, v144
 v_max3_f32 v236, v236, v137, v138
 v_max3_f32 v235, v235, v145, v146
 v_max_f32 v236, v236, v139
 v_max_f32 v235, v235, v147
 v_mov_b32 v237, v236
 v_mov_b32 v240, v235
 s_nop 0
 v_permlane32_swap_b32 v236, v237
 v_permlane32_swap_b32 v235, v240
 v_max_f32 v236, v236, v237
 v_max_f32 v235, v235, v240
 v_mov_b32 v237, v236
 v_mov_b32 v240, v235
 s_nop 0
 v_permlane16_swap_b32 v236, v237
 v_permlane16_swap_b32 v235, v240
 v_max_f32 v236, v236, v237
 v_max_f32 v235, v235, v240
 v_max_f32 v237, 0, v236
 v_max_f32 v240, 0, v235
 v_exp_f32 v238, -v237
 v_exp_f32 v241, -v240
 v_sub_f32 v132, v132, v237
 v_sub_f32 v133, v133, v237
 v_sub_f32 v134, v134, v237
 v_sub_f32 v135, v135, v237
 v_sub_f32 v136, v136, v237
 v_sub_f32 v137, v137, v237
 v_sub_f32 v138, v138, v237
 v_sub_f32 v139, v139, v237
 v_sub_f32 v148, v148, v237
 v_sub_f32 v149, v149, v237
 v_sub_f32 v150, v150, v237
 v_sub_f32 v151, v151, v237
 v_sub_f32 v152, v152, v237
 v_sub_f32 v153, v153, v237
 v_sub_f32 v154, v154, v237
 v_sub_f32 v155, v155, v237
 v_sub_f32 v100, v100, v237
 v_sub_f32 v101, v101, v237
 v_sub_f32 v102, v102, v237
 v_sub_f32 v103, v103, v237
 v_sub_f32 v104, v104, v237
 v_sub_f32 v105, v105, v237
 v_sub_f32 v106, v106, v237
 v_sub_f32 v107, v107, v237
 v_mul_f32 v36, v36, v238
 v_mul_f32 v37, v37, v238
 v_mul_f32 v38, v38, v238
 v_mul_f32 v39, v39, v238
 v_mul_f32 v40, v40, v238
 v_mul_f32 v41, v41, v238
 v_mul_f32 v42, v42, v238
 v_mul_f32 v43, v43, v238
 v_mul_f32 v52, v52, v238
 v_mul_f32 v53, v53, v238
 v_mul_f32 v54, v54, v238
 v_mul_f32 v55, v55, v238
 v_mul_f32 v56, v56, v238
 v_mul_f32 v57, v57, v238
 v_mul_f32 v58, v58, v238
 v_mul_f32 v59, v59, v238
 v_mul_f32 v68, v68, v238
 v_mul_f32 v69, v69, v238
 v_mul_f32 v70, v70, v238
 v_mul_f32 v71, v71, v238
 v_mul_f32 v72, v72, v238
 v_mul_f32 v73, v73, v238
 v_mul_f32 v74, v74, v238
 v_mul_f32 v75, v75, v238
 v_mul_f32 v84, v84, v238
 v_mul_f32 v85, v85, v238
 v_mul_f32 v86, v86, v238
 v_mul_f32 v87, v87, v238
 v_mul_f32 v88, v88, v238
 v_mul_f32 v89, v89, v238
 v_mul_f32 v90, v90, v238
 v_mul_f32 v91, v91, v238
 v_mul_f32 v188, v188, v238
 v_sub_f32 v180, v180, v237
 v_sub_f32 v181, v181, v237
 v_sub_f32 v182, v182, v237
 v_sub_f32 v183, v183, v237
 v_sub_f32 v140, v140, v240
 v_sub_f32 v141, v141, v240
 v_sub_f32 v142, v142, v240
 v_sub_f32 v143, v143, v240
 v_sub_f32 v144, v144, v240
 v_sub_f32 v145, v145, v240
 v_sub_f32 v146, v146, v240
 v_sub_f32 v147, v147, v240
 v_sub_f32 v156, v156, v240
 v_sub_f32 v157, v157, v240
 v_sub_f32 v158, v158, v240
 v_sub_f32 v159, v159, v240
 v_sub_f32 v160, v160, v240
 v_sub_f32 v161, v161, v240
 v_sub_f32 v162, v162, v240
 v_sub_f32 v163, v163, v240
 v_sub_f32 v108, v108, v240
 v_sub_f32 v109, v109, v240
 v_sub_f32 v110, v110, v240
 v_sub_f32 v111, v111, v240
 v_sub_f32 v112, v112, v240
 v_sub_f32 v113, v113, v240
 v_sub_f32 v114, v114, v240
 v_sub_f32 v115, v115, v240
 v_mul_f32 v44, v44, v241
 v_mul_f32 v45, v45, v241
 v_mul_f32 v46, v46, v241
 v_mul_f32 v47, v47, v241
 v_mul_f32 v48, v48, v241
 v_mul_f32 v49, v49, v241
 v_mul_f32 v50, v50, v241
 v_mul_f32 v51, v51, v241
 v_mul_f32 v60, v60, v241
 v_mul_f32 v61, v61, v241
 v_mul_f32 v62, v62, v241
 v_mul_f32 v63, v63, v241
 v_mul_f32 v64, v64, v241
 v_mul_f32 v65, v65, v241
 v_mul_f32 v66, v66, v241
 v_mul_f32 v67, v67, v241
 v_mul_f32 v76, v76, v241
 v_mul_f32 v77, v77, v241
 v_mul_f32 v78, v78, v241
 v_mul_f32 v79, v79, v241
 v_mul_f32 v80, v80, v241
 v_mul_f32 v81, v81, v241
 v_mul_f32 v82, v82, v241
 v_mul_f32 v83, v83, v241
 v_mul_f32 v92, v92, v241
 v_mul_f32 v93, v93, v241
 v_mul_f32 v94, v94, v241
 v_mul_f32 v95, v95, v241
 v_mul_f32 v96, v96, v241
 v_mul_f32 v97, v97, v241
 v_mul_f32 v98, v98, v241
 v_mul_f32 v99, v99, v241
 v_mul_f32 v189, v189, v241
 v_sub_f32 v184, v184, v240
 v_sub_f32 v185, v185, v240
 v_sub_f32 v186, v186, v240
 v_sub_f32 v187, v187, v240
 v_exp_f32 v240, v132
 v_exp_f32 v241, v133
 v_exp_f32 v242, v134
 v_cvt_pk_bf16_f32 v164, v240, v241
 v_exp_f32 v243, v135
 v_exp_f32 v240, v136
 v_cvt_pk_bf16_f32 v165, v242, v243
 v_exp_f32 v241, v137
 v_exp_f32 v242, v138
 v_cvt_pk_bf16_f32 v166, v240, v241
 v_exp_f32 v243, v139
 v_exp_f32 v240, v140
 v_cvt_pk_bf16_f32 v167, v242, v243
 v_exp_f32 v241, v141
 v_exp_f32 v242, v142
 v_cvt_pk_bf16_f32 v168, v240, v241
 v_exp_f32 v243, v143
 v_exp_f32 v240, v144
 v_cvt_pk_bf16_f32 v169, v242, v243
 v_exp_f32 v241, v145
 v_exp_f32 v242, v146
 v_cvt_pk_bf16_f32 v170, v240, v241
 v_exp_f32 v243, v147
 s_nop 0
 v_cvt_pk_bf16_f32 v171, v242, v243
 v_add_f32 v190, v188, v189
 s_nop 1
 v_mfma_f32_16x16x32_bf16 v[192:195], v[248:251], v[164:167], v[188:191]
 v_mfma_f32_16x16x32_bf16 v[192:195], v[252:255], v[168:171], v[192:195]
 v_exp_f32 v240, v148
 v_exp_f32 v241, v149
 v_exp_f32 v242, v150
 v_cvt_pk_bf16_f32 v172, v240, v241
 v_exp_f32 v243, v151
 v_exp_f32 v240, v152
 v_cvt_pk_bf16_f32 v173, v242, v243
 s_nop 7
 s_branch KB_RET_B1B_0
KB_RARE_B1B_1:
 v_max3_f32 v236, v148, v149, v150
 v_max3_f32 v235, v156, v157, v158
 v_max3_f32 v236, v236, v151, v152
 v_max3_f32 v235, v235, v159, v160
 v_max3_f32 v236, v236, v153, v154
 v_max3_f32 v235, v235, v161, v162
 v_max_f32 v236, v236, v155
 v_max_f32 v235, v235, v163
 v_mov_b32 v237, v236
 v_mov_b32 v240, v235
 s_nop 0
 v_permlane32_swap_b32 v236, v237
 v_permlane32_swap_b32 v235, v240
 v_max_f32 v236, v236, v237
 v_max_f32 v235, v235, v240
 v_mov_b32 v237, v236
 v_mov_b32 v240, v235
 s_nop 0
 v_permlane16_swap_b32 v236, v237
 v_permlane16_swap_b32 v235, v240
 v_max_f32 v236, v236, v237
 v_max_f32 v235, v235, v240
 v_max_f32 v237, 0, v236
 v_max_f32 v240, 0, v235
 v_exp_f32 v238, -v237
 v_exp_f32 v241, -v240
 v_sub_f32 v148, v148, v237
 v_sub_f32 v149, v149, v237
 v_sub_f32 v150, v150, v237
 v_sub_f32 v151, v151, v237
 v_sub_f32 v152, v152, v237
 v_sub_f32 v153, v153, v237
 v_sub_f32 v154, v154, v237
 v_sub_f32 v155, v155, v237
 v_sub_f32 v100, v100, v237
 v_sub_f32 v101, v101, v237
 v_sub_f32 v102, v102, v237
 v_sub_f32 v103, v103, v237
 v_sub_f32 v104, v104, v237
 v_sub_f32 v105, v105, v237
 v_sub_f32 v106, v106, v237
 v_sub_f32 v107, v107, v237
 v_sub_f32 v116, v116, v237
 v_sub_f32 v117, v117, v237
 v_sub_f32 v118, v118, v237
 v_sub_f32 v119, v119, v237
 v_sub_f32 v120, v120, v237
 v_sub_f32 v121, v121, v237
 v_sub_f32 v122, v122, v237
 v_sub_f32 v123, v123, v237
 v_mul_f32 v36, v36, v238
 v_mul_f32 v37, v37, v238
 v_mul_f32 v38, v38, v238
 v_mul_f32 v39, v39, v238
 v_mul_f32 v40, v40, v238
 v_mul_f32 v41, v41, v238
 v_mul_f32 v42, v42, v238
 v_mul_f32 v43, v43, v238
 v_mul_f32 v52, v52, v238
 v_mul_f32 v53, v53, v238
 v_mul_f32 v54, v54, v238
 v_mul_f32 v55, v55, v238
 v_mul_f32 v56, v56, v238
 v_mul_f32 v57, v57, v238
 v_mul_f32 v58, v58, v238
 v_mul_f32 v59, v59, v238
 v_mul_f32 v68, v68, v238
 v_mul_f32 v69, v69, v238
 v_mul_f32 v70, v70, v238
 v_mul_f32 v71, v71, v238
 v_mul_f32 v72, v72, v238
 v_mul_f32 v73, v73, v238
 v_mul_f32 v74, v74, v238
 v_mul_f32 v75, v75, v238
 v_mul_f32 v84, v84, v238
 v_mul_f32 v85, v85, v238
 v_mul_f32 v86, v86, v238
 v_mul_f32 v87, v87, v238
 v_mul_f32 v88, v88, v238
 v_mul_f32 v89, v89, v238
 v_mul_f32 v90, v90, v238
 v_mul_f32 v91, v91, v238
 v_mul_f32 v192, v192, v238
 v_sub_f32 v180, v180, v237
 v_sub_f32 v181, v181, v237
 v_sub_f32 v182, v182, v237
 v_sub_f32 v183, v183, v237
 v_sub_f32 v156, v156, v240
 v_sub_f32 v157, v157, v240
 v_sub_f32 v158, v158, v240
 v_sub_f32 v159, v159, v240
 v_sub_f32 v160, v160, v240
 v_sub_f32 v161, v161, v240
 v_sub_f32 v162, v162, v240
 v_sub_f32 v163, v163, v240
 v_sub_f32 v108, v108, v240
 v_sub_f32 v109, v109, v240
 v_sub_f32 v110, v110, v240
 v_sub_f32 v111, v111, v240
 v_sub_f32 v112, v112, v240
 v_sub_f32 v113, v113, v240
 v_sub_f32 v114, v114, v240
 v_sub_f32 v115, v115, v240
 v_sub_f32 v124, v124, v240
 v_sub_f32 v125, v125, v240
 v_sub_f32 v126, v126, v240
 v_sub_f32 v127, v127, v240
 v_sub_f32 v128, v128, v240
 v_sub_f32 v129, v129, v240
 v_sub_f32 v130, v130, v240
 v_sub_f32 v131, v131, v240
 v_mul_f32 v44, v44, v241
 v_mul_f32 v45, v45, v241
 v_mul_f32 v46, v46, v241
 v_mul_f32 v47, v47, v241
 v_mul_f32 v48, v48, v241
 v_mul_f32 v49, v49, v241
 v_mul_f32 v50, v50, v241
 v_mul_f32 v51, v51, v241
 v_mul_f32 v60, v60, v241
 v_mul_f32 v61, v61, v241
 v_mul_f32 v62, v62, v241
 v_mul_f32 v63, v63, v241
 v_mul_f32 v64, v64, v241
 v_mul_f32 v65, v65, v241
 v_mul_f32 v66, v66, v241
 v_mul_f32 v67, v67, v241
 v_mul_f32 v76, v76, v241
 v_mul_f32 v77, v77, v241
 v_mul_f32 v78, v78, v241
 v_mul_f32 v79, v79, v241
 v_mul_f32 v80, v80, v241
 v_mul_f32 v81, v81, v241
 v_mul_f32 v82, v82, v241
 v_mul_f32 v83, v83, v241
 v_mul_f32 v92, v92, v241
 v_mul_f32 v93, v93, v241
 v_mul_f32 v94, v94, v241
 v_mul_f32 v95, v95, v241
 v_mul_f32 v96, v96, v241
 v_mul_f32 v97, v97, v241
 v_mul_f32 v98, v98, v241
 v_mul_f32 v99, v99, v241
 v_mul_f32 v193, v193, v241
 v_sub_f32 v184, v184, v240
 v_sub_f32 v185, v185, v240
 v_sub_f32 v186, v186, v240
 v_sub_f32 v187, v187, v240
 v_exp_f32 v240, v148
 v_exp_f32 v241, v149
 v_exp_f32 v242, v150
 v_cvt_pk_bf16_f32 v172, v240, v241
 v_exp_f32 v243, v151
 v_exp_f32 v240, v152
 v_cvt_pk_bf16_f32 v173, v242, v243
 v_exp_f32 v241, v153
 v_exp_f32 v242, v154
 v_cvt_pk_bf16_f32 v174, v240, v241
 v_exp_f32 v243, v155
 v_exp_f32 v240, v156
 v_cvt_pk_bf16_f32 v175, v242, v243
 v_exp_f32 v241, v157
 v_exp_f32 v242, v158
 v_cvt_pk_bf16_f32 v176, v240, v241
 v_exp_f32 v243, v159
 v_exp_f32 v240, v160
 v_cvt_pk_bf16_f32 v177, v242, v243
 v_exp_f32 v241, v161
 v_exp_f32 v242, v162
 v_cvt_pk_bf16_f32 v178, v240, v241
 v_exp_f32 v243, v163
 s_nop 0
 v_cvt_pk_bf16_f32 v179, v242, v243
 v_add_f32 v194, v192, v193
 s_nop 1
 v_mfma_f32_16x16x32_bf16 v[188:191], v[248:251], v[172:175], v[192:195]
 v_mfma_f32_16x16x32_bf16 v[188:191], v[252:255], v[176:179], v[188:191]
 v_exp_f32 v240, v100
 v_exp_f32 v241, v101
 v_exp_f32 v242, v102
 v_cvt_pk_bf16_f32 v164, v240, v241
 v_exp_f32 v243, v103
 v_exp_f32 v240, v104
 v_cvt_pk_bf16_f32 v165, v242, v243
 v_exp_f32 v241, v105
 v_exp_f32 v242, v106
 v_cvt_pk_bf16_f32 v166, v240, v241
 v_exp_f32 v243, v107
 v_exp_f32 v240, v108
 s_nop 7
 s_branch KB_RET_B1B_1
KB_RARE_DB0B_0:
 v_max3_f32 v236, v100, v101, v102
 v_max3_f32 v235, v108, v109, v110
 v_max3_f32 v236, v236, v103, v104
 v_max3_f32 v235, v235, v111, v112
 v_max3_f32 v236, v236, v105, v106
 v_max3_f32 v235, v235, v113, v114
 v_max_f32 v236, v236, v107
 v_max_f32 v235, v235, v115
 v_mov_b32 v237, v236
 v_mov_b32 v240, v235
 s_nop 0
 v_permlane32_swap_b32 v236, v237
 v_permlane32_swap_b32 v235, v240
 v_max_f32 v236, v236, v237
 v_max_f32 v235, v235, v240
 v_mov_b32 v237, v236
 v_mov_b32 v240, v235
 s_nop 0
 v_permlane16_swap_b32 v236, v237
 v_permlane16_swap_b32 v235, v240
 v_max_f32 v236, v236, v237
 v_max_f32 v235, v235, v240
 v_max_f32 v237, 0, v236
 v_max_f32 v240, 0, v235
 v_exp_f32 v238, -v237
 v_exp_f32 v241, -v240
 v_sub_f32 v100, v100, v237
 v_sub_f32 v101, v101, v237
 v_sub_f32 v102, v102, v237
 v_sub_f32 v103, v103, v237
 v_sub_f32 v104, v104, v237
 v_sub_f32 v105, v105, v237
 v_sub_f32 v106, v106, v237
 v_sub_f32 v107, v107, v237
 v_sub_f32 v116, v116, v237
 v_sub_f32 v117, v117, v237
 v_sub_f32 v118, v118, v237
 v_sub_f32 v119, v119, v237
 v_sub_f32 v120, v120, v237
 v_sub_f32 v121, v121, v237
 v_sub_f32 v122, v122, v237
 v_sub_f32 v123, v123, v237
 v_mul_f32 v36, v36, v238
 v_mul_f32 v37, v37, v238
 v_mul_f32 v38, v38, v238
 v_mul_f32 v39, v39, v238
 v_mul_f32 v40, v40, v238
 v_mul_f32 v41, v41, v238
 v_mul_f32 v42, v42, v238
 v_mul_f32 v43, v43, v238
 v_mul_f32 v52, v52, v238
 v_mul_f32 v53, v53, v238
 v_mul_f32 v54, v54, v238
 v_mul_f32 v55, v55, v238
 v_mul_f32 v56, v56, v238
 v_mul_f32 v57, v57, v238
 v_mul_f32 v58, v58, v238
 v_mul_f32 v59, v59, v238
 v_mul_f32 v68, v68, v238
 v_mul_f32 v69, v69, v238
 v_mul_f32 v70, v70, v238
 v_mul_f32 v71, v71, v238
 v_mul_f32 v72, v72, v238
 v_mul_f32 v73, v73, v238
 v_mul_f32 v74, v74, v238
 v_mul_f32 v75, v75, v238
 v_mul_f32 v84, v84, v238
 v_mul_f32 v85, v85, v238
 v_mul_f32 v86, v86, v238
 v_mul_f32 v87, v87, v238
 v_mul_f32 v88, v88, v238
 v_mul_f32 v89, v89, v238
 v_mul_f32 v90, v90, v238
 v_mul_f32 v91, v91, v238
 v_mul_f32 v188, v188, v238
 v_sub_f32 v180, v180, v237
 v_sub_f32 v181, v181, v237
 v_sub_f32 v182, v182, v237
 v_sub_f32 v183, v183, v237
 v_sub_f32 v108, v108, v240
 v_sub_f32 v109, v109, v240
 v_sub_f32 v110, v110, v240
 v_sub_f32 v111, v111, v240
 v_sub_f32 v112, v112, v240
 v_sub_f32 v113, v113, v240
 v_sub_f32 v114, v114, v240
 v_sub_f32 v115, v115, v240
 v_sub_f32 v124, v124, v240
 v_sub_f32 v125, v125, v240
 v_sub_f32 v126, v126, v240
 v_sub_f32 v127, v127, v240
 v_sub_f32 v128, v128, v240
 v_sub_f32 v129, v129, v240
 v_sub_f32 v130, v130, v240
 v_sub_f32 v131, v131, v240
 v_mul_f32 v44, v44, v241
 v_mul_f32 v45, v45, v241
 v_mul_f32 v46, v46, v241
 v_mul_f32 v47, v47, v241
 v_mul_f32 v48, v48, v241
 v_mul_f32 v49, v49, v241
 v_mul_f32 v50, v50, v241
 v_mul_f32 v51, v51, v241
 v_mul_f32 v60, v60, v241
 v_mul_f32 v61, v61, v241
 v_mul_f32 v62, v62, v241
 v_mul_f32 v63, v63, v241
 v_mul_f32 v64, v64, v241
 v_mul_f32 v65, v65, v241
 v_mul_f32 v66, v66, v241
 v_mul_f32 v67, v67, v241
 v_mul_f32 v76, v76, v241
 v_mul_f32 v77, v77, v241
 v_mul_f32 v78, v78, v241
 v_mul_f32 v79, v79, v241
 v_mul_f32 v80, v80, v241
 v_mul_f32 v81, v81, v241
 v_mul_f32 v82, v82, v241
 v_mul_f32 v83, v83, v241
 v_mul_f32 v92, v92, v241
 v_mul_f32 v93, v93, v241
 v_mul_f32 v94, v94, v241
 v_mul_f32 v95, v95, v241
 v_mul_f32 v96, v96, v241
 v_mul_f32 v97, v97, v241
 v_mul_f32 v98, v98, v241
 v_mul_f32 v99, v99, v241
 v_mul_f32 v189, v189, v241
 v_sub_f32 v184, v184, v240
 v_sub_f32 v185, v185, v240
 v_sub_f32 v186, v186, v240
 v_sub_f32 v187, v187, v240
 v_exp_f32 v240, v100
 v_exp_f32 v241, v101
 v_exp_f32 v242, v102
 v_cvt_pk_bf16_f32 v164, v240, v241
 v_exp_f32 v243, v103
 v_exp_f32 v240, v104
 v_cvt_pk_bf16_f32 v165, v242, v243
 v_exp_f32 v241, v105
 v_exp_f32 v242, v106
 v_cvt_pk_bf16_f32 v166, v240, v241
 v_exp_f32 v243, v107
 v_exp_f32 v240, v108
 v_cvt_pk_bf16_f32 v167, v242, v243
 v_exp_f32 v241, v109
 v_exp_f32 v242, v110
 v_cvt_pk_bf16_f32 v168, v240, v241
 v_exp_f32 v243, v111
 v_exp_f32 v240, v112
 v_cvt_pk_bf16_f32 v169, v242, v243
 v_exp_f32 v241, v113
 v_exp_f32 v242, v114
 v_cvt_pk_bf16_f32 v170, v240, v241
 v_exp_f32 v243, v115
 s_nop 0
 v_cvt_pk_bf16_f32 v171, v242, v243
 v_add_f32 v190, v188, v189
 s_nop 1
 v_mfma_f32_16x16x32_bf16 v[192:195], v[248:251], v[164:167], v[188:191]
 v_mfma_f32_16x16x32_bf16 v[192:195], v[252:255], v[168:171], v[192:195]
 v_exp_f32 v240, v116
 v_exp_f32 v241, v117
 v_exp_f32 v242, v118
 v_cvt_pk_bf16_f32 v172, v240, v241
 v_exp_f32 v243, v119
 v_exp_f32 v240, v120
 v_cvt_pk_bf16_f32 v173, v242, v243
 v_exp_f32 v241, v121
 s_nop 7
 s_branch KB_RET_DB0B_0
KB_RARE_DB0B_1:
 v_max3_f32 v236, v116, v117, v118
 v_max3_f32 v235, v124, v125, v126
 v_max3_f32 v236, v236, v119, v120
 v_max3_f32 v235, v235, v127, v128
 v_max3_f32 v236, v236, v121, v122
 v_max3_f32 v235, v235, v129, v130
 v_max_f32 v236, v236, v123
 v_max_f32 v235, v235, v131
 v_mov_b32 v237, v236
 v_mov_b32 v240, v235
 s_nop 0
 v_permlane32_swap_b32 v236, v237
 v_permlane32_swap_b32 v235, v240
 v_max_f32 v236, v236, v237
 v_max_f32 v235, v235, v240
 v_mov_b32 v237, v236
 v_mov_b32 v240, v235
 s_nop 0
 v_permlane16_swap_b32 v236, v237
 v_permlane16_swap_b32 v235, v240
 v_max_f32 v236, v236, v237
 v_max_f32 v235, v235, v240
 v_max_f32 v237, 0, v236
 v_max_f32 v240, 0, v235
 v_exp_f32 v238, -v237
 v_exp_f32 v241, -v240
 v_sub_f32 v116, v116, v237
 v_sub_f32 v117, v117, v237
 v_sub_f32 v118, v118, v237
 v_sub_f32 v119, v119, v237
 v_sub_f32 v120, v120, v237
 v_sub_f32 v121, v121, v237
 v_sub_f32 v122, v122, v237
 v_sub_f32 v123, v123, v237
 v_mul_f32 v36, v36, v238
 v_mul_f32 v37, v37, v238
 v_mul_f32 v38, v38, v238
 v_mul_f32 v39, v39, v238
 v_mul_f32 v40, v40, v238
 v_mul_f32 v41, v41, v238
 v_mul_f32 v42, v42, v238
 v_mul_f32 v43, v43, v238
 v_mul_f32 v52, v52, v238
 v_mul_f32 v53, v53, v238
 v_mul_f32 v54, v54, v238
 v_mul_f32 v55, v55, v238
 v_mul_f32 v56, v56, v238
 v_mul_f32 v57, v57, v238
 v_mul_f32 v58, v58, v238
 v_mul_f32 v59, v59, v238
 v_mul_f32 v68, v68, v238
 v_mul_f32 v69, v69, v238
 v_mul_f32 v70, v70, v238
 v_mul_f32 v71, v71, v238
 v_mul_f32 v72, v72, v238
 v_mul_f32 v73, v73, v238
 v_mul_f32 v74, v74, v238
 v_mul_f32 v75, v75, v238
 v_mul_f32 v84, v84, v238
 v_mul_f32 v85, v85, v238
 v_mul_f32 v86, v86, v238
 v_mul_f32 v87, v87, v238
 v_mul_f32 v88, v88, v238
 v_mul_f32 v89, v89, v238
 v_mul_f32 v90, v90, v238
 v_mul_f32 v91, v91, v238
 v_mul_f32 v192, v192, v238
 v_sub_f32 v180, v180, v237
 v_sub_f32 v181, v181, v237
 v_sub_f32 v182, v182, v237
 v_sub_f32 v183, v183, v237
 v_sub_f32 v124, v124, v240
 v_sub_f32 v125, v125, v240
 v_sub_f32 v126, v126, v240
 v_sub_f32 v127, v127, v240
 v_sub_f32 v128, v128, v240
 v_sub_f32 v129, v129, v240
 v_sub_f32 v130, v130, v240
 v_sub_f32 v131, v131, v240
 v_mul_f32 v44, v44, v241
 v_mul_f32 v45, v45, v241
 v_mul_f32 v46, v46, v241
 v_mul_f32 v47, v47, v241
 v_mul_f32 v48, v48, v241
 v_mul_f32 v49, v49, v241
 v_mul_f32 v50, v50, v241
 v_mul_f32 v51, v51, v241
 v_mul_f32 v60, v60, v241
 v_mul_f32 v61, v61, v241
 v_mul_f32 v62, v62, v241
 v_mul_f32 v63, v63, v241
 v_mul_f32 v64, v64, v241
 v_mul_f32 v65, v65, v241
 v_mul_f32 v66, v66, v241
 v_mul_f32 v67, v67, v241
 v_mul_f32 v76, v76, v241
 v_mul_f32 v77, v77, v241
 v_mul_f32 v78, v78, v241
 v_mul_f32 v79, v79, v241
 v_mul_f32 v80, v80, v241
 v_mul_f32 v81, v81, v241
 v_mul_f32 v82, v82, v241
 v_mul_f32 v83, v83, v241
 v_mul_f32 v92, v92, v241
 v_mul_f32 v93, v93, v241
 v_mul_f32 v94, v94, v241
 v_mul_f32 v95, v95, v241
 v_mul_f32 v96, v96, v241
 v_mul_f32 v97, v97, v241
 v_mul_f32 v98, v98, v241
 v_mul_f32 v99, v99, v241
 v_mul_f32 v193, v193, v241
 v_sub_f32 v184, v184, v240
 v_sub_f32 v185, v185, v240
 v_sub_f32 v186, v186, v240
 v_sub_f32 v187, v187, v240
 v_exp_f32 v240, v116
 v_exp_f32 v241, v117
 v_exp_f32 v242, v118
 v_cvt_pk_bf16_f32 v172, v240, v241
 v_exp_f32 v243, v119
 v_exp_f32 v240, v120
 v_cvt_pk_bf16_f32 v173, v242, v243
 v_exp_f32 v241, v121
 v_exp_f32 v242, v122
 v_cvt_pk_bf16_f32 v174, v240, v241
 v_exp_f32 v243, v123
 v_exp_f32 v240, v124
 v_cvt_pk_bf16_f32 v175, v242, v243
 v_exp_f32 v241, v125
 v_exp_f32 v242, v126
 v_cvt_pk_bf16_f32 v176, v240, v241
 v_exp_f32 v243, v127
 v_exp_f32 v240, v128
 v_cvt_pk_bf16_f32 v177, v242, v243
 v_exp_f32 v241, v129
 v_exp_f32 v242, v130
 v_cvt_pk_bf16_f32 v178, v240, v241
 v_exp_f32 v243, v131
 s_nop 0
 v_cvt_pk_bf16_f32 v179, v242, v243
 v_add_f32 v194, v192, v193
 s_nop 1
 v_mfma_f32_16x16x32_bf16 v[188:191], v[248:251], v[172:175], v[192:195]
 v_mfma_f32_16x16x32_bf16 v[188:191], v[252:255], v[176:179], v[188:191]
 s_nop 7
 s_branch KB_RET_DB0B_1
KB_RARE_A1B_0:
 v_max3_f32 v236, v132, v133, v134
 v_max3_f32 v235, v140, v141, v142
 v_max3_f32 v236, v236, v135, v136
 v_max3_f32 v235, v235, v143, v144
 v_max3_f32 v236, v236, v137, v138
 v_max3_f32 v235, v235, v145, v146
 v_max_f32 v236, v236, v139
 v_max_f32 v235, v235, v147
 v_mov_b32 v237, v236
 v_mov_b32 v240, v235
 s_nop 0
 v_permlane32_swap_b32 v236, v237
 v_permlane32_swap_b32 v235, v240
 v_max_f32 v236, v236, v237
 v_max_f32 v235, v235, v240
 v_mov_b32 v237, v236
 v_mov_b32 v240, v235
 s_nop 0
 v_permlane16_swap_b32 v236, v237
 v_permlane16_swap_b32 v235, v240
 v_max_f32 v236, v236, v237
 v_max_f32 v235, v235, v240
 v_max_f32 v237, 0, v236
 v_max_f32 v240, 0, v235
 v_exp_f32 v238, -v237
 v_exp_f32 v241, -v240
 v_sub_f32 v132, v132, v237
 v_sub_f32 v133, v133, v237
 v_sub_f32 v134, v134, v237
 v_sub_f32 v135, v135, v237
 v_sub_f32 v136, v136, v237
 v_sub_f32 v137, v137, v237
 v_sub_f32 v138, v138, v237
 v_sub_f32 v139, v139, v237
 v_sub_f32 v148, v148, v237
 v_sub_f32 v149, v149, v237
 v_sub_f32 v150, v150, v237
 v_sub_f32 v151, v151, v237
 v_sub_f32 v152, v152, v237
 v_sub_f32 v153, v153, v237
 v_sub_f32 v154, v154, v237
 v_sub_f32 v155, v155, v237
 v_sub_f32 v100, v100, v237
 v_sub_f32 v101, v101, v237
 v_sub_f32 v102, v102, v237
 v_sub_f32 v103, v103, v237
 v_sub_f32 v104, v104, v237
 v_sub_f32 v105, v105, v237
 v_sub_f32 v106, v106, v237
 v_sub_f32 v107, v107, v237
 v_mul_f32 v36, v36, v238
 v_mul_f32 v37, v37, v238
 v_mul_f32 v38, v38, v238
 v_mul_f32 v39, v39, v238
 v_mul_f32 v40, v40, v238
 v_mul_f32 v41, v41, v238
 v_mul_f32 v42, v42, v238
 v_mul_f32 v43, v43, v238
 v_mul_f32 v52, v52, v238
 v_mul_f32 v53, v53, v238
 v_mul_f32 v54, v54, v238
 v_mul_f32 v55, v55, v238
 v_mul_f32 v56, v56, v238
 v_mul_f32 v57, v57, v238
 v_mul_f32 v58, v58, v238
 v_mul_f32 v59, v59, v238
 v_mul_f32 v68, v68, v238
 v_mul_f32 v69, v69, v238
 v_mul_f32 v70, v70, v238
 v_mul_f32 v71, v71, v238
 v_mul_f32 v72, v72, v238
 v_mul_f32 v73, v73, v238
 v_mul_f32 v74, v74, v238
 v_mul_f32 v75, v75, v238
 v_mul_f32 v84, v84, v238
 v_mul_f32 v85, v85, v238
 v_mul_f32 v86, v86, v238
 v_mul_f32 v87, v87, v238
 v_mul_f32 v88, v88, v238
 v_mul_f32 v89, v89, v238
 v_mul_f32 v90, v90, v238
 v_mul_f32 v91, v91, v238
 v_mul_f32 v188, v188, v238
 v_sub_f32 v180, v180, v237
 v_sub_f32 v181, v181, v237
 v_sub_f32 v182, v182, v237
 v_sub_f32 v183, v183, v237
 v_sub_f32 v140, v140, v240
 v_sub_f32 v141, v141, v240
 v_sub_f32 v142, v142, v240
 v_sub_f32 v143, v143, v240
 v_sub_f32 v144, v144, v240
 v_sub_f32 v145, v145, v240
 v_sub_f32 v146, v146, v240
 v_sub_f32 v147, v147, v240
 v_sub_f32 v156, v156, v240
 v_sub_f32 v157, v157, v240
 v_sub_f32 v158, v158, v240
 v_sub_f32 v159, v159, v240
 v_sub_f32 v160, v160, v240
 v_sub_f32 v161, v161, v240
 v_sub_f32 v162, v162, v240
 v_sub_f32 v163, v163, v240
 v_sub_f32 v108, v108, v240
 v_sub_f32 v109, v109, v240
 v_sub_f32 v110, v110, v240
 v_sub_f32 v111, v111, v240
 v_sub_f32 v112, v112, v240
 v_sub_f32 v113, v113, v240
 v_sub_f32 v114, v114, v240
 v_sub_f32 v115, v115, v240
 v_mul_f32 v44, v44, v241
 v_mul_f32 v45, v45, v241
 v_mul_f32 v46, v46, v241
 v_mul_f32 v47, v47, v241
 v_mul_f32 v48, v48, v241
 v_mul_f32 v49, v49, v241
 v_mul_f32 v50, v50, v241
 v_mul_f32 v51, v51, v241
 v_mul_f32 v60, v60, v241
 v_mul_f32 v61, v61, v241
 v_mul_f32 v62, v62, v241
 v_mul_f32 v63, v63, v241
 v_mul_f32 v64, v64, v241
 v_mul_f32 v65, v65, v241
 v_mul_f32 v66, v66, v241
 v_mul_f32 v67, v67, v241
 v_mul_f32 v76, v76, v241
 v_mul_f32 v77, v77, v241
 v_mul_f32 v78, v78, v241
 v_mul_f32 v79, v79, v241
 v_mul_f32 v80, v80, v241
 v_mul_f32 v81, v81, v241
 v_mul_f32 v82, v82, v241
 v_mul_f32 v83, v83, v241
 v_mul_f32 v92, v92, v241
 v_mul_f32 v93, v93, v241
 v_mul_f32 v94, v94, v241
 v_mul_f32 v95, v95, v241
 v_mul_f32 v96, v96, v241
 v_mul_f32 v97, v97, v241
 v_mul_f32 v98, v98, v241
 v_mul_f32 v99, v99, v241
 v_mul_f32 v189, v189, v241
 v_sub_f32 v184, v184, v240
 v_sub_f32 v185, v185, v240
 v_sub_f32 v186, v186, v240
 v_sub_f32 v187, v187, v240
 v_exp_f32 v240, v132
 v_exp_f32 v241, v133
 v_exp_f32 v242, v134
 v_cvt_pk_bf16_f32 v164, v240, v241
 v_exp_f32 v243, v135
 v_exp_f32 v240, v136
 v_cvt_pk_bf16_f32 v165, v242, v243
 v_exp_f32 v241, v137
 v_exp_f32 v242, v138
 v_cvt_pk_bf16_f32 v166, v240, v241
 v_exp_f32 v243, v139
 v_exp_f32 v240, v140
 v_cvt_pk_bf16_f32 v167, v242, v243
 v_exp_f32 v241, v141
 v_exp_f32 v242, v142
 v_cvt_pk_bf16_f32 v168, v240, v241
 v_exp_f32 v243, v143
 v_exp_f32 v240, v144
 v_cvt_pk_bf16_f32 v169, v242, v243
 v_exp_f32 v241, v145
 v_exp_f32 v242, v146
 v_cvt_pk_bf16_f32 v170, v240, v241
 v_exp_f32 v243, v147
 s_nop 0
 v_cvt_pk_bf16_f32 v171, v242, v243
 v_add_f32 v190, v188, v189
 s_nop 1
 v_mfma_f32_16x16x32_bf16 v[192:195], v[248:251], v[164:167], v[188:191]
 v_mfma_f32_16x16x32_bf16 v[192:195], v[252:255], v[168:171], v[192:195]
 v_exp_f32 v240, v148
 v_exp_f32 v241, v149
 v_exp_f32 v242, v150
 v_cvt_pk_bf16_f32 v172, v240, v241
 v_exp_f32 v243, v151
 v_exp_f32 v240, v152
 v_cvt_pk_bf16_f32 v173, v242, v243
 s_nop 7
 s_branch KB_RET_A1B_0
KB_RARE_A1B_1:
 v_max3_f32 v236, v148, v149, v150
 v_max3_f32 v235, v156, v157, v158
 v_max3_f32 v236, v236, v151, v152
 v_max3_f32 v235, v235, v159, v160
 v_max3_f32 v236, v236, v153, v154
 v_max3_f32 v235, v235, v161, v162
 v_max_f32 v236, v236, v155
 v_max_f32 v235, v235, v163
 v_mov_b32 v237, v236
 v_mov_b32 v240, v235
 s_nop 0
 v_permlane32_swap_b32 v236, v237
 v_permlane32_swap_b32 v235, v240
 v_max_f32 v236, v236, v237
 v_max_f32 v235, v235, v240
 v_mov_b32 v237, v236
 v_mov_b32 v240, v235
 s_nop 0
 v_permlane16_swap_b32 v236, v237
 v_permlane16_swap_b32 v235, v240
 v_max_f32 v236, v236, v237
 v_max_f32 v235, v235, v240
 v_max_f32 v237, 0, v236
 v_max_f32 v240, 0, v235
 v_exp_f32 v238, -v237
 v_exp_f32 v241, -v240
 v_sub_f32 v148, v148, v237
 v_sub_f32 v149, v149, v237
 v_sub_f32 v150, v150, v237
 v_sub_f32 v151, v151, v237
 v_sub_f32 v152, v152, v237
 v_sub_f32 v153, v153, v237
 v_sub_f32 v154, v154, v237
 v_sub_f32 v155, v155, v237
 v_sub_f32 v100, v100, v237
 v_sub_f32 v101, v101, v237
 v_sub_f32 v102, v102, v237
 v_sub_f32 v103, v103, v237
 v_sub_f32 v104, v104, v237
 v_sub_f32 v105, v105, v237
 v_sub_f32 v106, v106, v237
 v_sub_f32 v107, v107, v237
 v_mul_f32 v36, v36, v238
 v_mul_f32 v37, v37, v238
 v_mul_f32 v38, v38, v238
 v_mul_f32 v39, v39, v238
 v_mul_f32 v40, v40, v238
 v_mul_f32 v41, v41, v238
 v_mul_f32 v42, v42, v238
 v_mul_f32 v43, v43, v238
 v_mul_f32 v52, v52, v238
 v_mul_f32 v53, v53, v238
 v_mul_f32 v54, v54, v238
 v_mul_f32 v55, v55, v238
 v_mul_f32 v56, v56, v238
 v_mul_f32 v57, v57, v238
 v_mul_f32 v58, v58, v238
 v_mul_f32 v59, v59, v238
 v_mul_f32 v68, v68, v238
 v_mul_f32 v69, v69, v238
 v_mul_f32 v70, v70, v238
 v_mul_f32 v71, v71, v238
 v_mul_f32 v72, v72, v238
 v_mul_f32 v73, v73, v238
 v_mul_f32 v74, v74, v238
 v_mul_f32 v75, v75, v238
 v_mul_f32 v84, v84, v238
 v_mul_f32 v85, v85, v238
 v_mul_f32 v86, v86, v238
 v_mul_f32 v87, v87, v238
 v_mul_f32 v88, v88, v238
 v_mul_f32 v89, v89, v238
 v_mul_f32 v90, v90, v238
 v_mul_f32 v91, v91, v238
 v_mul_f32 v192, v192, v238
 v_sub_f32 v180, v180, v237
 v_sub_f32 v181, v181, v237
 v_sub_f32 v182, v182, v237
 v_sub_f32 v183, v183, v237
 v_sub_f32 v156, v156, v240
 v_sub_f32 v157, v157, v240
 v_sub_f32 v158, v158, v240
 v_sub_f32 v159, v159, v240
 v_sub_f32 v160, v160, v240
 v_sub_f32 v161, v161, v240
 v_sub_f32 v162, v162, v240
 v_sub_f32 v163, v163, v240
 v_sub_f32 v108, v108, v240
 v_sub_f32 v109, v109, v240
 v_sub_f32 v110, v110, v240
 v_sub_f32 v111, v111, v240
 v_sub_f32 v112, v112, v240
 v_sub_f32 v113, v113, v240
 v_sub_f32 v114, v114, v240
 v_sub_f32 v115, v115, v240
 v_mul_f32 v44, v44, v241
 v_mul_f32 v45, v45, v241
 v_mul_f32 v46, v46, v241
 v_mul_f32 v47, v47, v241
 v_mul_f32 v48, v48, v241
 v_mul_f32 v49, v49, v241
 v_mul_f32 v50, v50, v241
 v_mul_f32 v51, v51, v241
 v_mul_f32 v60, v60, v241
 v_mul_f32 v61, v61, v241
 v_mul_f32 v62, v62, v241
 v_mul_f32 v63, v63, v241
 v_mul_f32 v64, v64, v241
 v_mul_f32 v65, v65, v241
 v_mul_f32 v66, v66, v241
 v_mul_f32 v67, v67, v241
 v_mul_f32 v76, v76, v241
 v_mul_f32 v77, v77, v241
 v_mul_f32 v78, v78, v241
 v_mul_f32 v79, v79, v241
 v_mul_f32 v80, v80, v241
 v_mul_f32 v81, v81, v241
 v_mul_f32 v82, v82, v241
 v_mul_f32 v83, v83, v241
 v_mul_f32 v92, v92, v241
 v_mul_f32 v93, v93, v241
 v_mul_f32 v94, v94, v241
 v_mul_f32 v95, v95, v241
 v_mul_f32 v96, v96, v241
 v_mul_f32 v97, v97, v241
 v_mul_f32 v98, v98, v241
 v_mul_f32 v99, v99, v241
 v_mul_f32 v193, v193, v241
 v_sub_f32 v184, v184, v240
 v_sub_f32 v185, v185, v240
 v_sub_f32 v186, v186, v240
 v_sub_f32 v187, v187, v240
 v_exp_f32 v240, v148
 v_exp_f32 v241, v149
 v_exp_f32 v242, v150
 v_cvt_pk_bf16_f32 v172, v240, v241
 v_exp_f32 v243, v151
 v_exp_f32 v240, v152
 v_cvt_pk_bf16_f32 v173, v242, v243
 v_exp_f32 v241, v153
 v_exp_f32 v242, v154
 v_cvt_pk_bf16_f32 v174, v240, v241
 v_exp_f32 v243, v155
 v_exp_f32 v240, v156
 v_cvt_pk_bf16_f32 v175, v242, v243
 v_exp_f32 v241, v157
 v_exp_f32 v242, v158
 v_cvt_pk_bf16_f32 v176, v240, v241
 v_exp_f32 v243, v159
 v_exp_f32 v240, v160
 v_cvt_pk_bf16_f32 v177, v242, v243
 v_exp_f32 v241, v161
 v_exp_f32 v242, v162
 v_cvt_pk_bf16_f32 v178, v240, v241
 v_exp_f32 v243, v163
 s_nop 0
 v_cvt_pk_bf16_f32 v179, v242, v243
 v_add_f32 v194, v192, v193
 s_nop 1
 v_mfma_f32_16x16x32_bf16 v[188:191], v[248:251], v[172:175], v[192:195]
 v_mfma_f32_16x16x32_bf16 v[188:191], v[252:255], v[176:179], v[188:191]
 v_cmp_gt_i32 s[44:45], 0, v245
 v_cmp_gt_i32 s[46:47], 1, v245
 v_cmp_gt_i32 s[48:49], 2, v245
 v_cmp_gt_i32 s[50:51], 3, v245
 v_cndmask_b32 v100, v100, v246, s[44:45]
 v_cndmask_b32 v101, v101, v246, s[46:47]
 v_cndmask_b32 v102, v102, v246, s[48:49]
 v_cndmask_b32 v103, v103, v246, s[50:51]
 s_nop 7
 s_branch KB_RET_A1B_1
KB_RARE_DA0B_0:
 v_max3_f32 v236, v100, v101, v102
 v_max3_f32 v235, v108, v109, v110
 v_max3_f32 v236, v236, v103, v104
 v_max3_f32 v235, v235, v111, v112
 v_max3_f32 v236, v236, v105, v106
 v_max3_f32 v235, v235, v113, v114
 v_max_f32 v236, v236, v107
 v_max_f32 v235, v235, v115
 v_mov_b32 v237, v236
 v_mov_b32 v240, v235
 s_nop 0
 v_permlane32_swap_b32 v236, v237
 v_permlane32_swap_b32 v235, v240
 v_max_f32 v236, v236, v237
 v_max_f32 v235, v235, v240
 v_mov_b32 v237, v236
 v_mov_b32 v240, v235
 s_nop 0
 v_permlane16_swap_b32 v236, v237
 v_permlane16_swap_b32 v235, v240
 v_max_f32 v236, v236, v237
 v_max_f32 v235, v235, v240
 v_max_f32 v237, 0, v236
 v_max_f32 v240, 0, v235
 v_exp_f32 v238, -v237
 v_exp_f32 v241, -v240
 v_sub_f32 v100, v100, v237
 v_sub_f32 v101, v101, v237
 v_sub_f32 v102, v102, v237
 v_sub_f32 v103, v103, v237
 v_sub_f32 v104, v104, v237
 v_sub_f32 v105, v105, v237
 v_sub_f32 v106, v106, v237
 v_sub_f32 v107, v107, v237
 v_mul_f32 v36, v36, v238
 v_mul_f32 v37, v37, v238
 v_mul_f32 v38, v38, v238
 v_mul_f32 v39, v39, v238
 v_mul_f32 v40, v40, v238
 v_mul_f32 v41, v41, v238
 v_mul_f32 v42, v42, v238
 v_mul_f32 v43, v43, v238
 v_mul_f32 v52, v52, v238
 v_mul_f32 v53, v53, v238
 v_mul_f32 v54, v54, v238
 v_mul_f32 v55, v55, v238
 v_mul_f32 v56, v56, v238
 v_mul_f32 v57, v57, v238
 v_mul_f32 v58, v58, v238
 v_mul_f32 v59, v59, v238
 v_mul_f32 v68, v68, v238
 v_mul_f32 v69, v69, v238
 v_mul_f32 v70, v70, v238
 v_mul_f32 v71, v71, v238
 v_mul_f32 v72, v72, v238
 v_mul_f32 v73, v73, v238
 v_mul_f32 v74, v74, v238
 v_mul_f32 v75, v75, v238
 v_mul_f32 v84, v84, v238
 v_mul_f32 v85, v85, v238
 v_mul_f32 v86, v86, v238
 v_mul_f32 v87, v87, v238
 v_mul_f32 v88, v88, v238
 v_mul_f32 v89, v89, v238
 v_mul_f32 v90, v90, v238
 v_mul_f32 v91, v91, v238
 v_mul_f32 v188, v188, v238
 v_sub_f32 v180, v180, v237
 v_sub_f32 v181, v181, v237
 v_sub_f32 v182, v182, v237
 v_sub_f32 v183, v183, v237
 v_sub_f32 v108, v108, v240
 v_sub_f32 v109, v109, v240
 v_sub_f32 v110, v110, v240
 v_sub_f32 v111, v111, v240
 v_sub_f32 v112, v112, v240
 v_sub_f32 v113, v113, v240
 v_sub_f32 v114, v114, v240
 v_sub_f32 v115, v115, v240
 v_mul_f32 v44, v44, v241
 v_mul_f32 v45, v45, v241
 v_mul_f32 v46, v46, v241
 v_mul_f32 v47, v47, v241
 v_mul_f32 v48, v48, v241
 v_mul_f32 v49, v49, v241
 v_mul_f32 v50, v50, v241
 v_mul_f32 v51, v51, v241
 v_mul_f32 v60, v60, v241
 v_mul_f32 v61, v61, v241
 v_mul_f32 v62, v62, v241
 v_mul_f32 v63, v63, v241
 v_mul_f32 v64, v64, v241
 v_mul_f32 v65, v65, v241
 v_mul_f32 v66, v66, v241
 v_mul_f32 v67, v67, v241
 v_mul_f32 v76, v76, v241
 v_mul_f32 v77, v77, v241
 v_mul_f32 v78, v78, v241
 v_mul_f32 v79, v79, v241
 v_mul_f32 v80, v80, v241
 v_mul_f32 v81, v81, v241
 v_mul_f32 v82, v82, v241
 v_mul_f32 v83, v83, v241
 v_mul_f32 v92, v92, v241
 v_mul_f32 v93, v93, v241
 v_mul_f32 v94, v94, v241
 v_mul_f32 v95, v95, v241
 v_mul_f32 v96, v96, v241
 v_mul_f32 v97, v97, v241
 v_mul_f32 v98, v98, v241
 v_mul_f32 v99, v99, v241
 v_mul_f32 v189, v189, v241
 v_sub_f32 v184, v184, v240
 v_sub_f32 v185, v185, v240
 v_sub_f32 v186, v186, v240
 v_sub_f32 v187, v187, v240
 v_exp_f32 v240, v100
 v_exp_f32 v241, v101
 v_exp_f32 v242, v102
 v_cvt_pk_bf16_f32 v164, v240, v241
 v_exp_f32 v243, v103
 v_exp_f32 v240, v104
 v_cvt_pk_bf16_f32 v165, v242, v243
 v_exp_f32 v241, v105
 v_exp_f32 v242, v106
 v_cvt_pk_bf16_f32 v166, v240, v241
 v_exp_f32 v243, v107
 v_exp_f32 v240, v108
 v_cvt_pk_bf16_f32 v167, v242, v243
 v_exp_f32 v241, v109
 v_exp_f32 v242, v110
 v_cvt_pk_bf16_f32 v168, v240, v241
 v_exp_f32 v243, v111
 v_exp_f32 v240, v112
 v_cvt_pk_bf16_f32 v169, v242, v243
 v_exp_f32 v241, v113
 v_exp_f32 v242, v114
 v_cvt_pk_bf16_f32 v170, v240, v241
 v_exp_f32 v243, v115
 s_nop 0
 v_cvt_pk_bf16_f32 v171, v242, v243
 v_add_f32 v190, v188, v189
 s_nop 1
 v_mfma_f32_16x16x32_bf16 v[192:195], v[248:251], v[164:167], v[188:191]
 v_mfma_f32_16x16x32_bf16 v[192:195], v[252:255], v[168:171], v[192:195]
 s_nop 7
 s_branch KB_RET_DA0B_0
KB_RARE_UEA_0:
 v_max3_f32 v236, v100, v101, v102
 v_max3_f32 v235, v108, v109, v110
 v_max3_f32 v236, v236, v103, v104
 v_max3_f32 v235, v235, v111, v112
 v_max3_f32 v236, v236, v105, v106
 v_max3_f32 v235, v235, v113, v114
 v_max_f32 v236, v236, v107
 v_max_f32 v235, v235, v115
 v_mov_b32 v237, v236
 v_mov_b32 v240, v235
 s_nop 0
 v_permlane32_swap_b32 v236, v237
 v_permlane32_swap_b32 v235, v240
 v_max_f32 v236, v236, v237
 v_max_f32 v235, v235, v240
 v_mov_b32 v237, v236
 v_mov_b32 v240, v235
 s_nop 0
 v_permlane16_swap_b32 v236, v237
 v_permlane16_swap_b32 v235, v240
 v_max_f32 v236, v236, v237
 v_max_f32 v235, v235, v240
 v_max_f32 v237, 0, v236
 v_max_f32 v240, 0, v235
 v_exp_f32 v238, -v237
 v_exp_f32 v241, -v240
 v_sub_f32 v100, v100, v237
 v_sub_f32 v101, v101, v237
 v_sub_f32 v102, v102, v237
 v_sub_f32 v103, v103, v237
 v_sub_f32 v104, v104, v237
 v_sub_f32 v105, v105, v237
 v_sub_f32 v106, v106, v237
 v_sub_f32 v107, v107, v237
 v_sub_f32 v116, v116, v237
 v_sub_f32 v117, v117, v237
 v_sub_f32 v118, v118, v237
 v_sub_f32 v119, v119, v237
 v_sub_f32 v120, v120, v237
 v_sub_f32 v121, v121, v237
 v_sub_f32 v122, v122, v237
 v_sub_f32 v123, v123, v237
 v_sub_f32 v132, v132, v237
 v_sub_f32 v133, v133, v237
 v_sub_f32 v134, v134, v237
 v_sub_f32 v135, v135, v237
 v_sub_f32 v136, v136, v237
 v_sub_f32 v137, v137, v237
 v_sub_f32 v138, v138, v237
 v_sub_f32 v139, v139, v237
 v_mul_f32 v36, v36, v238
 v_mul_f32 v37, v37, v238
 v_mul_f32 v38, v38, v238
 v_mul_f32 v39, v39, v238
 v_mul_f32 v40, v40, v238
 v_mul_f32 v41, v41, v238
 v_mul_f32 v42, v42, v238
 v_mul_f32 v43, v43, v238
 v_mul_f32 v52, v52, v238
 v_mul_f32 v53, v53, v238
 v_mul_f32 v54, v54, v238
 v_mul_f32 v55, v55, v238
 v_mul_f32 v56, v56, v238
 v_mul_f32 v57, v57, v238
 v_mul_f32 v58, v58, v238
 v_mul_f32 v59, v59, v238
 v_mul_f32 v68, v68, v238
 v_mul_f32 v69, v69, v238
 v_mul_f32 v70, v70, v238
 v_mul_f32 v71, v71, v238
 v_mul_f32 v72, v72, v238
 v_mul_f32 v73, v73, v238
 v_mul_f32 v74, v74, v238
 v_mul_f32 v75, v75, v238
 v_mul_f32 v84, v84, v238
 v_mul_f32 v85, v85, v238
 v_mul_f32 v86, v86, v238
 v_mul_f32 v87, v87, v238
 v_mul_f32 v88, v88, v238
 v_mul_f32 v89, v89, v238
 v_mul_f32 v90, v90, v238
 v_mul_f32 v91, v91, v238
 v_mul_f32 v188, v188, v238
 v_sub_f32 v180, v180, v237
 v_sub_f32 v181, v181, v237
 v_sub_f32 v182, v182, v237
 v_sub_f32 v183, v183, v237
 v_sub_f32 v108, v108, v240
 v_sub_f32 v109, v109, v240
 v_sub_f32 v110, v110, v240
 v_sub_f32 v111, v111, v240
 v_sub_f32 v112, v112, v240
 v_sub_f32 v113, v113, v240
 v_sub_f32 v114, v114, v240
 v_sub_f32 v115, v115, v240
 v_sub_f32 v124, v124, v240
 v_sub_f32 v125, v125, v240
 v_sub_f32 v126, v126, v240
 v_sub_f32 v127, v127, v240
 v_sub_f32 v128, v128, v240
 v_sub_f32 v129, v129, v240
 v_sub_f32 v130, v130, v240
 v_sub_f32 v131, v131, v240
 v_sub_f32 v140, v140, v240
 v_sub_f32 v141, v141, v240
 v_sub_f32 v142, v142, v240
 v_sub_f32 v143, v143, v240
 v_sub_f32 v144, v144, v240
 v_sub_f32 v145, v145, v240
 v_sub_f32 v146, v146, v240
 v_sub_f32 v147, v147, v240
 v_mul_f32 v44, v44, v241
 v_mul_f32 v45, v45, v241
 v_mul_f32 v46, v46, v241
 v_mul_f32 v47, v47, v241
 v_mul_f32 v48, v48, v241
 v_mul_f32 v49, v49, v241
 v_mul_f32 v50, v50, v241
 v_mul_f32 v51, v51, v241
 v_mul_f32 v60, v60, v241
 v_mul_f32 v61, v61, v241
 v_mul_f32 v62, v62, v241
 v_mul_f32 v63, v63, v241
 v_mul_f32 v64, v64, v241
 v_mul_f32 v65, v65, v241
 v_mul_f32 v66, v66, v241
 v_mul_f32 v67, v67, v241
 v_mul_f32 v76, v76, v241
 v_mul_f32 v77, v77, v241
 v_mul_f32 v78, v78, v241
 v_mul_f32 v79, v79, v241
 v_mul_f32 v80, v80, v241
 v_mul_f32 v81, v81, v241
 v_mul_f32 v82, v82, v241
 v_mul_f32 v83, v83, v241
 v_mul_f32 v92, v92, v241
 v_mul_f32 v93, v93, v241
 v_mul_f32 v94, v94, v241
 v_mul_f32 v95, v95, v241
 v_mul_f32 v96, v96, v241
 v_mul_f32 v97, v97, v241
 v_mul_f32 v98, v98, v241
 v_mul_f32 v99, v99, v241
 v_mul_f32 v189, v189, v241
 v_sub_f32 v184, v184, v240
 v_sub_f32 v185, v185, v240
 v_sub_f32 v186, v186, v240
 v_sub_f32 v187, v187, v240
 v_exp_f32 v240, v100
 v_exp_f32 v241, v101
 v_exp_f32 v242, v102
 v_cvt_pk_bf16_f32 v164, v240, v241
 v_exp_f32 v243, v103
 v_exp_f32 v240, v104
 v_cvt_pk_bf16_f32 v165, v242, v243
 v_exp_f32 v241, v105
 v_exp_f32 v242, v106
 v_cvt_pk_bf16_f32 v166, v240, v241
 v_exp_f32 v243, v107
 v_exp_f32 v240, v108
 v_cvt_pk_bf16_f32 v167, v242, v243
 v_exp_f32 v241, v109
 v_exp_f32 v242, v110
 v_cvt_pk_bf16_f32 v168, v240, v241
 v_exp_f32 v243, v111
 v_exp_f32 v240, v112
 v_cvt_pk_bf16_f32 v169, v242, v243
 v_exp_f32 v241, v113
 v_exp_f32 v242, v114
 v_cvt_pk_bf16_f32 v170, v240, v241
 v_exp_f32 v243, v115
 s_nop 0
 v_cvt_pk_bf16_f32 v171, v242, v243
 v_add_f32 v190, v188, v189
 s_nop 1
 v_mfma_f32_16x16x32_bf16 v[192:195], v[248:251], v[164:167], v[188:191]
 v_mfma_f32_16x16x32_bf16 v[192:195], v[252:255], v[168:171], v[192:195]
 v_exp_f32 v240, v116
 v_exp_f32 v241, v117
 v_exp_f32 v242, v118
 v_cvt_pk_bf16_f32 v172, v240, v241
 v_exp_f32 v243, v119
 v_exp_f32 v240, v120
 v_cvt_pk_bf16_f32 v173, v242, v243
 s_nop 7
 s_branch KB_RET_UEA_0
KB_RARE_UEA_1:
 v_max3_f32 v236, v116, v117, v118
 v_max3_f32 v235, v124, v125, v126
 v_max3_f32 v236, v236, v119, v120
 v_max3_f32 v235, v235, v127, v128
 v_max3_f32 v236, v236, v121, v122
 v_max3_f32 v235, v235, v129, v130
 v_max_f32 v236, v236, v123
 v_max_f32 v235, v235, v131
 v_mov_b32 v237, v236
 v_mov_b32 v240, v235
 s_nop 0
 v_permlane32_swap_b32 v236, v237
 v_permlane32_swap_b32 v235, v240
 v_max_f32 v236, v236, v237
 v_max_f32 v235, v235, v240
 v_mov_b32 v237, v236
 v_mov_b32 v240, v235
 s_nop 0
 v_permlane16_swap_b32 v236, v237
 v_permlane16_swap_b32 v235, v240
 v_max_f32 v236, v236, v237
 v_max_f32 v235, v235, v240
 v_max_f32 v237, 0, v236
 v_max_f32 v240, 0, v235
 v_exp_f32 v238, -v237
 v_exp_f32 v241, -v240
 v_sub_f32 v116, v116, v237
 v_sub_f32 v117, v117, v237
 v_sub_f32 v118, v118, v237
 v_sub_f32 v119, v119, v237
 v_sub_f32 v120, v120, v237
 v_sub_f32 v121, v121, v237
 v_sub_f32 v122, v122, v237
 v_sub_f32 v123, v123, v237
 v_sub_f32 v132, v132, v237
 v_sub_f32 v133, v133, v237
 v_sub_f32 v134, v134, v237
 v_sub_f32 v135, v135, v237
 v_sub_f32 v136, v136, v237
 v_sub_f32 v137, v137, v237
 v_sub_f32 v138, v138, v237
 v_sub_f32 v139, v139, v237
 v_sub_f32 v148, v148, v237
 v_sub_f32 v149, v149, v237
 v_sub_f32 v150, v150, v237
 v_sub_f32 v151, v151, v237
 v_sub_f32 v152, v152, v237
 v_sub_f32 v153, v153, v237
 v_sub_f32 v154, v154, v237
 v_sub_f32 v155, v155, v237
 v_mul_f32 v36, v36, v238
 v_mul_f32 v37, v37, v238
 v_mul_f32 v38, v38, v238
 v_mul_f32 v39, v39, v238
 v_mul_f32 v40, v40, v238
 v_mul_f32 v41, v41, v238
 v_mul_f32 v42, v42, v238
 v_mul_f32 v43, v43, v238
 v_mul_f32 v52, v52, v238
 v_mul_f32 v53, v53, v238
 v_mul_f32 v54, v54, v238
 v_mul_f32 v55, v55, v238
 v_mul_f32 v56, v56, v238
 v_mul_f32 v57, v57, v238
 v_mul_f32 v58, v58, v238
 v_mul_f32 v59, v59, v238
 v_mul_f32 v68, v68, v238
 v_mul_f32 v69, v69, v238
 v_mul_f32 v70, v70, v238
 v_mul_f32 v71, v71, v238
 v_mul_f32 v72, v72, v238
 v_mul_f32 v73, v73, v238
 v_mul_f32 v74, v74, v238
 v_mul_f32 v75, v75, v238
 v_mul_f32 v84, v84, v238
 v_mul_f32 v85, v85, v238
 v_mul_f32 v86, v86, v238
 v_mul_f32 v87, v87, v238
 v_mul_f32 v88, v88, v238
 v_mul_f32 v89, v89, v238
 v_mul_f32 v90, v90, v238
 v_mul_f32 v91, v91, v238
 v_mul_f32 v192, v192, v238
 v_sub_f32 v180, v180, v237
 v_sub_f32 v181, v181, v237
 v_sub_f32 v182, v182, v237
 v_sub_f32 v183, v183, v237
 v_sub_f32 v124, v124, v240
 v_sub_f32 v125, v125, v240
 v_sub_f32 v126, v126, v240
 v_sub_f32 v127, v127, v240
 v_sub_f32 v128, v128, v240
 v_sub_f32 v129, v129, v240
 v_sub_f32 v130, v130, v240
 v_sub_f32 v131, v131, v240
 v_sub_f32 v140, v140, v240
 v_sub_f32 v141, v141, v240
 v_sub_f32 v142, v142, v240
 v_sub_f32 v143, v143, v240
 v_sub_f32 v144, v144, v240
 v_sub_f32 v145, v145, v240
 v_sub_f32 v146, v146, v240
 v_sub_f32 v147, v147, v240
 v_sub_f32 v156, v156, v240
 v_sub_f32 v157, v157, v240
 v_sub_f32 v158, v158, v240
 v_sub_f32 v159, v159, v240
 v_sub_f32 v160, v160, v240
 v_sub_f32 v161, v161, v240
 v_sub_f32 v162, v162, v240
 v_sub_f32 v163, v163, v240
 v_mul_f32 v44, v44, v241
 v_mul_f32 v45, v45, v241
 v_mul_f32 v46, v46, v241
 v_mul_f32 v47, v47, v241
 v_mul_f32 v48, v48, v241
 v_mul_f32 v49, v49, v241
 v_mul_f32 v50, v50, v241
 v_mul_f32 v51, v51, v241
 v_mul_f32 v60, v60, v241
 v_mul_f32 v61, v61, v241
 v_mul_f32 v62, v62, v241
 v_mul_f32 v63, v63, v241
 v_mul_f32 v64, v64, v241
 v_mul_f32 v65, v65, v241
 v_mul_f32 v66, v66, v241
 v_mul_f32 v67, v67, v241
 v_mul_f32 v76, v76, v241
 v_mul_f32 v77, v77, v241
 v_mul_f32 v78, v78, v241
 v_mul_f32 v79, v79, v241
 v_mul_f32 v80, v80, v241
 v_mul_f32 v81, v81, v241
 v_mul_f32 v82, v82, v241
 v_mul_f32 v83, v83, v241
 v_mul_f32 v92, v92, v241
 v_mul_f32 v93, v93, v241
 v_mul_f32 v94, v94, v241
 v_mul_f32 v95, v95, v241
 v_mul_f32 v96, v96, v241
 v_mul_f32 v97, v97, v241
 v_mul_f32 v98, v98, v241
 v_mul_f32 v99, v99, v241
 v_mul_f32 v193, v193, v241
 v_sub_f32 v184, v184, v240
 v_sub_f32 v185, v185, v240
 v_sub_f32 v186, v186, v240
 v_sub_f32 v187, v187, v240
 v_exp_f32 v240, v116
 v_exp_f32 v241, v117
 v_exp_f32 v242, v118
 v_cvt_pk_bf16_f32 v172, v240, v241
 v_exp_f32 v243, v119
 v_exp_f32 v240, v120
 v_cvt_pk_bf16_f32 v173, v242, v243
 v_exp_f32 v241, v121
 v_exp_f32 v242, v122
 v_cvt_pk_bf16_f32 v174, v240, v241
 v_exp_f32 v243, v123
 v_exp_f32 v240, v124
 v_cvt_pk_bf16_f32 v175, v242, v243
 v_exp_f32 v241, v125
 v_exp_f32 v242, v126
 v_cvt_pk_bf16_f32 v176, v240, v241
 v_exp_f32 v243, v127
 v_exp_f32 v240, v128
 v_cvt_pk_bf16_f32 v177, v242, v243
 v_exp_f32 v241, v129
 v_exp_f32 v242, v130
 v_cvt_pk_bf16_f32 v178, v240, v241
 v_exp_f32 v243, v131
 s_nop 0
 v_cvt_pk_bf16_f32 v179, v242, v243
 v_add_f32 v194, v192, v193
 s_nop 1
 v_mfma_f32_16x16x32_bf16 v[188:191], v[248:251], v[172:175], v[192:195]
 v_mfma_f32_16x16x32_bf16 v[188:191], v[252:255], v[176:179], v[188:191]
 v_exp_f32 v240, v132
 v_exp_f32 v241, v133
 v_exp_f32 v242, v134
 v_cvt_pk_bf16_f32 v164, v240, v241
 v_exp_f32 v243, v135
 v_exp_f32 v240, v136
 v_cvt_pk_bf16_f32 v165, v242, v243
 s_nop 7
 s_branch KB_RET_UEA_1
KB_RARE_UOA_0:
 v_max3_f32 v236, v132, v133, v134
 v_max3_f32 v235, v140, v141, v142
 v_max3_f32 v236, v236, v135, v136
 v_max3_f32 v235, v235, v143, v144
 v_max3_f32 v236, v236, v137, v138
 v_max3_f32 v235, v235, v145, v146
 v_max_f32 v236, v236, v139
 v_max_f32 v235, v235, v147
 v_mov_b32 v237, v236
 v_mov_b32 v240, v235
 s_nop 0
 v_permlane32_swap_b32 v236, v237
 v_permlane32_swap_b32 v235, v240
 v_max_f32 v236, v236, v237
 v_max_f32 v235, v235, v240
 v_mov_b32 v237, v236
 v_mov_b32 v240, v235
 s_nop 0
 v_permlane16_swap_b32 v236, v237
 v_permlane16_swap_b32 v235, v240
 v_max_f32 v236, v236, v237
 v_max_f32 v235, v235, v240
 v_max_f32 v237, 0, v236
 v_max_f32 v240, 0, v235
 v_exp_f32 v238, -v237
 v_exp_f32 v241, -v240
 v_sub_f32 v132, v132, v237
 v_sub_f32 v133, v133, v237
 v_sub_f32 v134, v134, v237
 v_sub_f32 v135, v135, v237
 v_sub_f32 v136, v136, v237
 v_sub_f32 v137, v137, v237
 v_sub_f32 v138, v138, v237
 v_sub_f32 v139, v139, v237
 v_sub_f32 v148, v148, v237
 v_sub_f32 v149, v149, v237
 v_sub_f32 v150, v150, v237
 v_sub_f32 v151, v151, v237
 v_sub_f32 v152, v152, v237
 v_sub_f32 v153, v153, v237
 v_sub_f32 v154, v154, v237
 v_sub_f32 v155, v155, v237
 v_sub_f32 v100, v100, v237
 v_sub_f32 v101, v101, v237
 v_sub_f32 v102, v102, v237
 v_sub_f32 v103, v103, v237
 v_sub_f32 v104, v104, v237
 v_sub_f32 v105, v105, v237
 v_sub_f32 v106, v106, v237
 v_sub_f32 v107, v107, v237
 v_mul_f32 v36, v36, v238
 v_mul_f32 v37, v37, v238
 v_mul_f32 v38, v38, v238
 v_mul_f32 v39, v39, v238
 v_mul_f32 v40, v40, v238
 v_mul_f32 v41, v41, v238
 v_mul_f32 v42, v42, v238
 v_mul_f32 v43, v43, v238
 v_mul_f32 v52, v52, v238
 v_mul_f32 v53, v53, v238
 v_mul_f32 v54, v54, v238
 v_mul_f32 v55, v55, v238
 v_mul_f32 v56, v56, v238
 v_mul_f32 v57, v57, v238
 v_mul_f32 v58, v58, v238
 v_mul_f32 v59, v59, v238
 v_mul_f32 v68, v68, v238
 v_mul_f32 v69, v69, v238
 v_mul_f32 v70, v70, v238
 v_mul_f32 v71, v71, v238
 v_mul_f32 v72, v72, v238
 v_mul_f32 v73, v73, v238
 v_mul_f32 v74, v74, v238
 v_mul_f32 v75, v75, v238
 v_mul_f32 v84, v84, v238
 v_mul_f32 v85, v85, v238
 v_mul_f32 v86, v86, v238
 v_mul_f32 v87, v87, v238
 v_mul_f32 v88, v88, v238
 v_mul_f32 v89, v89, v238
 v_mul_f32 v90, v90, v238
 v_mul_f32 v91, v91, v238
 v_mul_f32 v188, v188, v238
 v_sub_f32 v180, v180, v237
 v_sub_f32 v181, v181, v237
 v_sub_f32 v182, v182, v237
 v_sub_f32 v183, v183, v237
 v_sub_f32 v140, v140, v240
 v_sub_f32 v141, v141, v240
 v_sub_f32 v142, v142, v240
 v_sub_f32 v143, v143, v240
 v_sub_f32 v144, v144, v240
 v_sub_f32 v145, v145, v240
 v_sub_f32 v146, v146, v240
 v_sub_f32 v147, v147, v240
 v_sub_f32 v156, v156, v240
 v_sub_f32 v157, v157, v240
 v_sub_f32 v158, v158, v240
 v_sub_f32 v159, v159, v240
 v_sub_f32 v160, v160, v240
 v_sub_f32 v161, v161, v240
 v_sub_f32 v162, v162, v240
 v_sub_f32 v163, v163, v240
 v_sub_f32 v108, v108, v240
 v_sub_f32 v109, v109, v240
 v_sub_f32 v110, v110, v240
 v_sub_f32 v111, v111, v240
 v_sub_f32 v112, v112, v240
 v_sub_f32 v113, v113, v240
 v_sub_f32 v114, v114, v240
 v_sub_f32 v115, v115, v240
 v_mul_f32 v44, v44, v241
 v_mul_f32 v45, v45, v241
 v_mul_f32 v46, v46, v241
 v_mul_f32 v47, v47, v241
 v_mul_f32 v48, v48, v241
 v_mul_f32 v49, v49, v241
 v_mul_f32 v50, v50, v241
 v_mul_f32 v51, v51, v241
 v_mul_f32 v60, v60, v241
 v_mul_f32 v61, v61, v241
 v_mul_f32 v62, v62, v241
 v_mul_f32 v63, v63, v241
 v_mul_f32 v64, v64, v241
 v_mul_f32 v65, v65, v241
 v_mul_f32 v66, v66, v241
 v_mul_f32 v67, v67, v241
 v_mul_f32 v76, v76, v241
 v_mul_f32 v77, v77, v241
 v_mul_f32 v78, v78, v241
 v_mul_f32 v79, v79, v241
 v_mul_f32 v80, v80, v241
 v_mul_f32 v81, v81, v241
 v_mul_f32 v82, v82, v241
 v_mul_f32 v83, v83, v241
 v_mul_f32 v92, v92, v241
 v_mul_f32 v93, v93, v241
 v_mul_f32 v94, v94, v241
 v_mul_f32 v95, v95, v241
 v_mul_f32 v96, v96, v241
 v_mul_f32 v97, v97, v241
 v_mul_f32 v98, v98, v241
 v_mul_f32 v99, v99, v241
 v_mul_f32 v189, v189, v241
 v_sub_f32 v184, v184, v240
 v_sub_f32 v185, v185, v240
 v_sub_f32 v186, v186, v240
 v_sub_f32 v187, v187, v240
 v_exp_f32 v240, v132
 v_exp_f32 v241, v133
 v_exp_f32 v242, v134
 v_cvt_pk_bf16_f32 v164, v240, v241
 v_exp_f32 v243, v135
 v_exp_f32 v240, v136
 v_cvt_pk_bf16_f32 v165, v242, v243
 v_exp_f32 v241, v137
 v_exp_f32 v242, v138
 v_cvt_pk_bf16_f32 v166, v240, v241
 v_exp_f32 v243, v139
 v_exp_f32 v240, v140
 v_cvt_pk_bf16_f32 v167, v242, v243
 v_exp_f32 v241, v141
 v_exp_f32 v242, v142
 v_cvt_pk_bf16_f32 v168, v240, v241
 v_exp_f32 v243, v143
 v_exp_f32 v240, v144
 v_cvt_pk_bf16_f32 v169, v242, v243
 v_exp_f32 v241, v145
 v_exp_f32 v242, v146
 v_cvt_pk_bf16_f32 v170, v240, v241
 v_exp_f32 v243, v147
 s_nop 0
 v_cvt_pk_bf16_f32 v171, v242, v243
 v_add_f32 v190, v188, v189
 s_nop 1
 v_mfma_f32_16x16x32_bf16 v[192:195], v[248:251], v[164:167], v[188:191]
 v_mfma_f32_16x16x32_bf16 v[192:195], v[252:255], v[168:171], v[192:195]
 v_exp_f32 v240, v148
 v_exp_f32 v241, v149
 v_exp_f32 v242, v150
 v_cvt_pk_bf16_f32 v172, v240, v241
 v_exp_f32 v243, v151
 v_exp_f32 v240, v152
 v_cvt_pk_bf16_f32 v173, v242, v243
 s_nop 7
 s_branch KB_RET_UOA_0
KB_RARE_UOA_1:
 v_max3_f32 v236, v148, v149, v150
 v_max3_f32 v235, v156, v157, v158
 v_max3_f32 v236, v236, v151, v152
 v_max3_f32 v235, v235, v159, v160
 v_max3_f32 v236, v236, v153, v154
 v_max3_f32 v235, v235, v161, v162
 v_max_f32 v236, v236, v155
 v_max_f32 v235, v235, v163
 v_mov_b32 v237, v236
 v_mov_b32 v240, v235
 s_nop 0
 v_permlane32_swap_b32 v236, v237
 v_permlane32_swap_b32 v235, v240
 v_max_f32 v236, v236, v237
 v_max_f32 v235, v235, v240
 v_mov_b32 v237, v236
 v_mov_b32 v240, v235
 s_nop 0
 v_permlane16_swap_b32 v236, v237
 v_permlane16_swap_b32 v235, v240
 v_max_f32 v236, v236, v237
 v_max_f32 v235, v235, v240
 v_max_f32 v237, 0, v236
 v_max_f32 v240, 0, v235
 v_exp_f32 v238, -v237
 v_exp_f32 v241, -v240
 v_sub_f32 v148, v148, v237
 v_sub_f32 v149, v149, v237
 v_sub_f32 v150, v150, v237
 v_sub_f32 v151, v151, v237
 v_sub_f32 v152, v152, v237
 v_sub_f32 v153, v153, v237
 v_sub_f32 v154, v154, v237
 v_sub_f32 v155, v155, v237
 v_sub_f32 v100, v100, v237
 v_sub_f32 v101, v101, v237
 v_sub_f32 v102, v102, v237
 v_sub_f32 v103, v103, v237
 v_sub_f32 v104, v104, v237
 v_sub_f32 v105, v105, v237
 v_sub_f32 v106, v106, v237
 v_sub_f32 v107, v107, v237
 v_sub_f32 v116, v116, v237
 v_sub_f32 v117, v117, v237
 v_sub_f32 v118, v118, v237
 v_sub_f32 v119, v119, v237
 v_sub_f32 v120, v120, v237
 v_sub_f32 v121, v121, v237
 v_sub_f32 v122, v122, v237
 v_sub_f32 v123, v123, v237
 v_mul_f32 v36, v36, v238
 v_mul_f32 v37, v37, v238
 v_mul_f32 v38, v38, v238
 v_mul_f32 v39, v39, v238
 v_mul_f32 v40, v40, v238
 v_mul_f32 v41, v41, v238
 v_mul_f32 v42, v42, v238
 v_mul_f32 v43, v43, v238
 v_mul_f32 v52, v52, v238
 v_mul_f32 v53, v53, v238
 v_mul_f32 v54, v54, v238
 v_mul_f32 v55, v55, v238
 v_mul_f32 v56, v56, v238
 v_mul_f32 v57, v57, v238
 v_mul_f32 v58, v58, v238
 v_mul_f32 v59, v59, v238
 v_mul_f32 v68, v68, v238
 v_mul_f32 v69, v69, v238
 v_mul_f32 v70, v70, v238
 v_mul_f32 v71, v71, v238
 v_mul_f32 v72, v72, v238
 v_mul_f32 v73, v73, v238
 v_mul_f32 v74, v74, v238
 v_mul_f32 v75, v75, v238
 v_mul_f32 v84, v84, v238
 v_mul_f32 v85, v85, v238
 v_mul_f32 v86, v86, v238
 v_mul_f32 v87, v87, v238
 v_mul_f32 v88, v88, v238
 v_mul_f32 v89, v89, v238
 v_mul_f32 v90, v90, v238
 v_mul_f32 v91, v91, v238
 v_mul_f32 v192, v192, v238
 v_sub_f32 v180, v180, v237
 v_sub_f32 v181, v181, v237
 v_sub_f32 v182, v182, v237
 v_sub_f32 v183, v183, v237
 v_sub_f32 v156, v156, v240
 v_sub_f32 v157, v157, v240
 v_sub_f32 v158, v158, v240
 v_sub_f32 v159, v159, v240
 v_sub_f32 v160, v160, v240
 v_sub_f32 v161, v161, v240
 v_sub_f32 v162, v162, v240
 v_sub_f32 v163, v163, v240
 v_sub_f32 v108, v108, v240
 v_sub_f32 v109, v109, v240
 v_sub_f32 v110, v110, v240
 v_sub_f32 v111, v111, v240
 v_sub_f32 v112, v112, v240
 v_sub_f32 v113, v113, v240
 v_sub_f32 v114, v114, v240
 v_sub_f32 v115, v115, v240
 v_sub_f32 v124, v124, v240
 v_sub_f32 v125, v125, v240
 v_sub_f32 v126, v126, v240
 v_sub_f32 v127, v127, v240
 v_sub_f32 v128, v128, v240
 v_sub_f32 v129, v129, v240
 v_sub_f32 v130, v130, v240
 v_sub_f32 v131, v131, v240
 v_mul_f32 v44, v44, v241
 v_mul_f32 v45, v45, v241
 v_mul_f32 v46, v46, v241
 v_mul_f32 v47, v47, v241
 v_mul_f32 v48, v48, v241
 v_mul_f32 v49, v49, v241
 v_mul_f32 v50, v50, v241
 v_mul_f32 v51, v51, v241
 v_mul_f32 v60, v60, v241
 v_mul_f32 v61, v61, v241
 v_mul_f32 v62, v62, v241
 v_mul_f32 v63, v63, v241
 v_mul_f32 v64, v64, v241
 v_mul_f32 v65, v65, v241
 v_mul_f32 v66, v66, v241
 v_mul_f32 v67, v67, v241
 v_mul_f32 v76, v76, v241
 v_mul_f32 v77, v77, v241
 v_mul_f32 v78, v78, v241
 v_mul_f32 v79, v79, v241
 v_mul_f32 v80, v80, v241
 v_mul_f32 v81, v81, v241
 v_mul_f32 v82, v82, v241
 v_mul_f32 v83, v83, v241
 v_mul_f32 v92, v92, v241
 v_mul_f32 v93, v93, v241
 v_mul_f32 v94, v94, v241
 v_mul_f32 v95, v95, v241
 v_mul_f32 v96, v96, v241
 v_mul_f32 v97, v97, v241
 v_mul_f32 v98, v98, v241
 v_mul_f32 v99, v99, v241
 v_mul_f32 v193, v193, v241
 v_sub_f32 v184, v184, v240
 v_sub_f32 v185, v185, v240
 v_sub_f32 v186, v186, v240
 v_sub_f32 v187, v187, v240
 v_exp_f32 v240, v148
 v_exp_f32 v241, v149
 v_exp_f32 v242, v150
 v_cvt_pk_bf16_f32 v172, v240, v241
 v_exp_f32 v243, v151
 v_exp_f32 v240, v152
 v_cvt_pk_bf16_f32 v173, v242, v243
 v_exp_f32 v241, v153
 v_exp_f32 v242, v154
 v_cvt_pk_bf16_f32 v174, v240, v241
 v_exp_f32 v243, v155
 v_exp_f32 v240, v156
 v_cvt_pk_bf16_f32 v175, v242, v243
 v_exp_f32 v241, v157
 v_exp_f32 v242, v158
 v_cvt_pk_bf16_f32 v176, v240, v241
 v_exp_f32 v243, v159
 v_exp_f32 v240, v160
 v_cvt_pk_bf16_f32 v177, v242, v243
 v_exp_f32 v241, v161
 v_exp_f32 v242, v162
 v_cvt_pk_bf16_f32 v178, v240, v241
 v_exp_f32 v243, v163
 s_nop 0
 v_cvt_pk_bf16_f32 v179, v242, v243
 v_add_f32 v194, v192, v193
 s_nop 1
 v_mfma_f32_16x16x32_bf16 v[188:191], v[248:251], v[172:175], v[192:195]
 v_mfma_f32_16x16x32_bf16 v[188:191], v[252:255], v[176:179], v[188:191]
 v_exp_f32 v240, v100
 v_exp_f32 v241, v101
 v_exp_f32 v242, v102
 v_cvt_pk_bf16_f32 v164, v240, v241
 v_exp_f32 v243, v103
 v_exp_f32 v240, v104
 v_cvt_pk_bf16_f32 v165, v242, v243
 s_nop 7
 s_branch KB_RET_UOA_1
KB_RARE_B0A_0:
 v_max3_f32 v236, v100, v101, v102
 v_max3_f32 v235, v108, v109, v110
 v_max3_f32 v236, v236, v103, v104
 v_max3_f32 v235, v235, v111, v112
 v_max3_f32 v236, v236, v105, v106
 v_max3_f32 v235, v235, v113, v114
 v_max_f32 v236, v236, v107
 v_max_f32 v235, v235, v115
 v_mov_b32 v237, v236
 v_mov_b32 v240, v235
 s_nop 0
 v_permlane32_swap_b32 v236, v237
 v_permlane32_swap_b32 v235, v240
 v_max_f32 v236, v236, v237
 v_max_f32 v235, v235, v240
 v_mov_b32 v237, v236
 v_mov_b32 v240, v235
 s_nop 0
 v_permlane16_swap_b32 v236, v237
 v_permlane16_swap_b32 v235, v240
 v_max_f32 v236, v236, v237
 v_max_f32 v235, v235, v240
 v_max_f32 v237, 0, v236
 v_max_f32 v240, 0, v235
 v_exp_f32 v238, -v237
 v_exp_f32 v241, -v240
 v_sub_f32 v100, v100, v237
 v_sub_f32 v101, v101, v237
 v_sub_f32 v102, v102, v237
 v_sub_f32 v103, v103, v237
 v_sub_f32 v104, v104, v237
 v_sub_f32 v105, v105, v237
 v_sub_f32 v106, v106, v237
 v_sub_f32 v107, v107, v237
 v_sub_f32 v116, v116, v237
 v_sub_f32 v117, v117, v237
 v_sub_f32 v118, v118, v237
 v_sub_f32 v119, v119, v237
 v_sub_f32 v120, v120, v237
 v_sub_f32 v121, v121, v237
 v_sub_f32 v122, v122, v237
 v_sub_f32 v123, v123, v237
 v_sub_f32 v132, v132, v237
 v_sub_f32 v133, v133, v237
 v_sub_f32 v134, v134, v237
 v_sub_f32 v135, v135, v237
 v_sub_f32 v136, v136, v237
 v_sub_f32 v137, v137, v237
 v_sub_f32 v138, v138, v237
 v_sub_f32 v139, v139, v237
 v_mul_f32 v36, v36, v238
 v_mul_f32 v37, v37, v238
 v_mul_f32 v38, v38, v238
 v_mul_f32 v39, v39, v238
 v_mul_f32 v40, v40, v238
 v_mul_f32 v41, v41, v238
 v_mul_f32 v42, v42, v238
 v_mul_f32 v43, v43, v238
 v_mul_f32 v52, v52, v238
 v_mul_f32 v53, v53, v238
 v_mul_f32 v54, v54, v238
 v_mul_f32 v55, v55, v238
 v_mul_f32 v56, v56, v238
 v_mul_f32 v57, v57, v238
 v_mul_f32 v58, v58, v238
 v_mul_f32 v59, v59, v238
 v_mul_f32 v68, v68, v238
 v_mul_f32 v69, v69, v238
 v_mul_f32 v70, v70, v238
 v_mul_f32 v71, v71, v238
 v_mul_f32 v72, v72, v238
 v_mul_f32 v73, v73, v238
 v_mul_f32 v74, v74, v238
 v_mul_f32 v75, v75, v238
 v_mul_f32 v84, v84, v238
 v_mul_f32 v85, v85, v238
 v_mul_f32 v86, v86, v238
 v_mul_f32 v87, v87, v238
 v_mul_f32 v88, v88, v238
 v_mul_f32 v89, v89, v238
 v_mul_f32 v90, v90, v238
 v_mul_f32 v91, v91, v238
 v_mul_f32 v188, v188, v238
 v_sub_f32 v180, v180, v237
 v_sub_f32 v181, v181, v237
 v_sub_f32 v182, v182, v237
 v_sub_f32 v183, v183, v237
 v_sub_f32 v108, v108, v240
 v_sub_f32 v109, v109, v240
 v_sub_f32 v110, v110, v240
 v_sub_f32 v111, v111, v240
 v_sub_f32 v112, v112, v240
 v_sub_f32 v113, v113, v240
 v_sub_f32 v114, v114, v240
 v_sub_f32 v115, v115, v240
 v_sub_f32 v124, v124, v240
 v_sub_f32 v125, v125, v240
 v_sub_f32 v126, v126, v240
 v_sub_f32 v127, v127, v240
 v_sub_f32 v128, v128, v240
 v_sub_f32 v129, v129, v240
 v_sub_f32 v130, v130, v240
 v_sub_f32 v131, v131, v240
 v_sub_f32 v140, v140, v240
 v_sub_f32 v141, v141, v240
 v_sub_f32 v142, v142, v240
 v_sub_f32 v143, v143, v240
 v_sub_f32 v144, v144, v240
 v_sub_f32 v145, v145, v240
 v_sub_f32 v146, v146, v240
 v_sub_f32 v147, v147, v240
 v_mul_f32 v44, v44, v241
 v_mul_f32 v45, v45, v241
 v_mul_f32 v46, v46, v241
 v_mul_f32 v47, v47, v241
 v_mul_f32 v48, v48, v241
 v_mul_f32 v49, v49, v241
 v_mul_f32 v50, v50, v241
 v_mul_f32 v51, v51, v241
 v_mul_f32 v60, v60, v241
 v_mul_f32 v61, v61, v241
 v_mul_f32 v62, v62, v241
 v_mul_f32 v63, v63, v241
 v_mul_f32 v64, v64, v241
 v_mul_f32 v65, v65, v241
 v_mul_f32 v66, v66, v241
 v_mul_f32 v67, v67, v241
 v_mul_f32 v76, v76, v241
 v_mul_f32 v77, v77, v241
 v_mul_f32 v78, v78, v241
 v_mul_f32 v79, v79, v241
 v_mul_f32 v80, v80, v241
 v_mul_f32 v81, v81, v241
 v_mul_f32 v82, v82, v241
 v_mul_f32 v83, v83, v241
 v_mul_f32 v92, v92, v241
 v_mul_f32 v93, v93, v241
 v_mul_f32 v94, v94, v241
 v_mul_f32 v95, v95, v241
 v_mul_f32 v96, v96, v241
 v_mul_f32 v97, v97, v241
 v_mul_f32 v98, v98, v241
 v_mul_f32 v99, v99, v241
 v_mul_f32 v189, v189, v241
 v_sub_f32 v184, v184, v240
 v_sub_f32 v185, v185, v240
 v_sub_f32 v186, v186, v240
 v_sub_f32 v187, v187, v240
 v_exp_f32 v240, v100
 v_exp_f32 v241, v101
 v_exp_f32 v242, v102
 v_cvt_pk_bf16_f32 v164, v240, v241
 v_exp_f32 v243, v103
 v_exp_f32 v240, v104
 v_cvt_pk_bf16_f32 v165, v242, v243
 v_exp_f32 v241, v105
 v_exp_f32 v242, v106
 v_cvt_pk_bf16_f32 v166, v240, v241
 v_exp_f32 v243, v107
 v_exp_f32 v240, v108
 v_cvt_pk_bf16_f32 v167, v242, v243
 v_exp_f32 v241, v109
 v_exp_f32 v242, v110
 v_cvt_pk_bf16_f32 v168, v240, v241
 v_exp_f32 v243, v111
 v_exp_f32 v240, v112
 v_cvt_pk_bf16_f32 v169, v242, v243
 v_exp_f32 v241, v113
 v_exp_f32 v242, v114
 v_cvt_pk_bf16_f32 v170, v240, v241
 v_exp_f32 v243, v115
 s_nop 0
 v_cvt_pk_bf16_f32 v171, v242, v243
 v_add_f32 v190, v188, v189
 s_nop 1
 v_mfma_f32_16x16x32_bf16 v[192:195], v[248:251], v[164:167], v[188:191]
 v_mfma_f32_16x16x32_bf16 v[192:195], v[252:255], v[168:171], v[192:195]
 v_exp_f32 v240, v116
 v_exp_f32 v241, v117
 v_exp_f32 v242, v118
 v_cvt_pk_bf16_f32 v172, v240, v241
 v_exp_f32 v243, v119
 v_exp_f32 v240, v120
 v_cvt_pk_bf16_f32 v173, v242, v243
 s_nop 7
 s_branch KB_RET_B0A_0
KB_RARE_B0A_1:
 v_max3_f32 v236, v116, v117, v118
 v_max3_f32 v235, v124, v125, v126
 v_max3_f32 v236, v236, v119, v120
 v_max3_f32 v235, v235, v127, v128
 v_max3_f32 v236, v236, v121, v122
 v_max3_f32 v235, v235, v129, v130
 v_max_f32 v236, v236, v123
 v_max_f32 v235, v235, v131
 v_mov_b32 v237, v236
 v_mov_b32 v240, v235
 s_nop 0
 v_permlane32_swap_b32 v236, v237
 v_permlane32_swap_b32 v235, v240
 v_max_f32 v236, v236, v237
 v_max_f32 v235, v235, v240
 v_mov_b32 v237, v236
 v_mov_b32 v240, v235
 s_nop 0
 v_permlane16_swap_b32 v236, v237
 v_permlane16_swap_b32 v235, v240
 v_max_f32 v236, v236, v237
 v_max_f32 v235, v235, v240
 v_max_f32 v237, 0, v236
 v_max_f32 v240, 0, v235
 v_exp_f32 v238, -v237
 v_exp_f32 v241, -v240
 v_sub_f32 v116, v116, v237
 v_sub_f32 v117, v117, v237
 v_sub_f32 v118, v118, v237
 v_sub_f32 v119, v119, v237
 v_sub_f32 v120, v120, v237
 v_sub_f32 v121, v121, v237
 v_sub_f32 v122, v122, v237
 v_sub_f32 v123, v123, v237
 v_sub_f32 v132, v132, v237
 v_sub_f32 v133, v133, v237
 v_sub_f32 v134, v134, v237
 v_sub_f32 v135, v135, v237
 v_sub_f32 v136, v136, v237
 v_sub_f32 v137, v137, v237
 v_sub_f32 v138, v138, v237
 v_sub_f32 v139, v139, v237
 v_sub_f32 v148, v148, v237
 v_sub_f32 v149, v149, v237
 v_sub_f32 v150, v150, v237
 v_sub_f32 v151, v151, v237
 v_sub_f32 v152, v152, v237
 v_sub_f32 v153, v153, v237
 v_sub_f32 v154, v154, v237
 v_sub_f32 v155, v155, v237
 v_mul_f32 v36, v36, v238
 v_mul_f32 v37, v37, v238
 v_mul_f32 v38, v38, v238
 v_mul_f32 v39, v39, v238
 v_mul_f32 v40, v40, v238
 v_mul_f32 v41, v41, v238
 v_mul_f32 v42, v42, v238
 v_mul_f32 v43, v43, v238
 v_mul_f32 v52, v52, v238
 v_mul_f32 v53, v53, v238
 v_mul_f32 v54, v54, v238
 v_mul_f32 v55, v55, v238
 v_mul_f32 v56, v56, v238
 v_mul_f32 v57, v57, v238
 v_mul_f32 v58, v58, v238
 v_mul_f32 v59, v59, v238
 v_mul_f32 v68, v68, v238
 v_mul_f32 v69, v69, v238
 v_mul_f32 v70, v70, v238
 v_mul_f32 v71, v71, v238
 v_mul_f32 v72, v72, v238
 v_mul_f32 v73, v73, v238
 v_mul_f32 v74, v74, v238
 v_mul_f32 v75, v75, v238
 v_mul_f32 v84, v84, v238
 v_mul_f32 v85, v85, v238
 v_mul_f32 v86, v86, v238
 v_mul_f32 v87, v87, v238
 v_mul_f32 v88, v88, v238
 v_mul_f32 v89, v89, v238
 v_mul_f32 v90, v90, v238
 v_mul_f32 v91, v91, v238
 v_mul_f32 v192, v192, v238
 v_sub_f32 v180, v180, v237
 v_sub_f32 v181, v181, v237
 v_sub_f32 v182, v182, v237
 v_sub_f32 v183, v183, v237
 v_sub_f32 v124, v124, v240
 v_sub_f32 v125, v125, v240
 v_sub_f32 v126, v126, v240
 v_sub_f32 v127, v127, v240
 v_sub_f32 v128, v128, v240
 v_sub_f32 v129, v129, v240
 v_sub_f32 v130, v130, v240
 v_sub_f32 v131, v131, v240
 v_sub_f32 v140, v140, v240
 v_sub_f32 v141, v141, v240
 v_sub_f32 v142, v142, v240
 v_sub_f32 v143, v143, v240
 v_sub_f32 v144, v144, v240
 v_sub_f32 v145, v145, v240
 v_sub_f32 v146, v146, v240
 v_sub_f32 v147, v147, v240
 v_sub_f32 v156, v156, v240
 v_sub_f32 v157, v157, v240
 v_sub_f32 v158, v158, v240
 v_sub_f32 v159, v159, v240
 v_sub_f32 v160, v160, v240
 v_sub_f32 v161, v161, v240
 v_sub_f32 v162, v162, v240
 v_sub_f32 v163, v163, v240
 v_mul_f32 v44, v44, v241
 v_mul_f32 v45, v45, v241
 v_mul_f32 v46, v46, v241
 v_mul_f32 v47, v47, v241
 v_mul_f32 v48, v48, v241
 v_mul_f32 v49, v49, v241
 v_mul_f32 v50, v50, v241
 v_mul_f32 v51, v51, v241
 v_mul_f32 v60, v60, v241
 v_mul_f32 v61, v61, v241
 v_mul_f32 v62, v62, v241
 v_mul_f32 v63, v63, v241
 v_mul_f32 v64, v64, v241
 v_mul_f32 v65, v65, v241
 v_mul_f32 v66, v66, v241
 v_mul_f32 v67, v67, v241
 v_mul_f32 v76, v76, v241
 v_mul_f32 v77, v77, v241
 v_mul_f32 v78, v78, v241
 v_mul_f32 v79, v79, v241
 v_mul_f32 v80, v80, v241
 v_mul_f32 v81, v81, v241
 v_mul_f32 v82, v82, v241
 v_mul_f32 v83, v83, v241
 v_mul_f32 v92, v92, v241
 v_mul_f32 v93, v93, v241
 v_mul_f32 v94, v94, v241
 v_mul_f32 v95, v95, v241
 v_mul_f32 v96, v96, v241
 v_mul_f32 v97, v97, v241
 v_mul_f32 v98, v98, v241
 v_mul_f32 v99, v99, v241
 v_mul_f32 v193, v193, v241
 v_sub_f32 v184, v184, v240
 v_sub_f32 v185, v185, v240
 v_sub_f32 v186, v186, v240
 v_sub_f32 v187, v187, v240
 v_exp_f32 v240, v116
 v_exp_f32 v241, v117
 v_exp_f32 v242, v118
 v_cvt_pk_bf16_f32 v172, v240, v241
 v_exp_f32 v243, v119
 v_exp_f32 v240, v120
 v_cvt_pk_bf16_f32 v173, v242, v243
 v_exp_f32 v241, v121
 v_exp_f32 v242, v122
 v_cvt_pk_bf16_f32 v174, v240, v241
 v_exp_f32 v243, v123
 v_exp_f32 v240, v124
 v_cvt_pk_bf16_f32 v175, v242, v243
 v_exp_f32 v241, v125
 v_exp_f32 v242, v126
 v_cvt_pk_bf16_f32 v176, v240, v241
 v_exp_f32 v243, v127
 v_exp_f32 v240, v128
 v_cvt_pk_bf16_f32 v177, v242, v243
 v_exp_f32 v241, v129
 v_exp_f32 v242, v130
 v_cvt_pk_bf16_f32 v178, v240, v241
 v_exp_f32 v243, v131
 s_nop 0
 v_cvt_pk_bf16_f32 v179, v242, v243
 v_add_f32 v194, v192, v193
 s_nop 1
 v_mfma_f32_16x16x32_bf16 v[188:191], v[248:251], v[172:175], v[192:195]
 v_mfma_f32_16x16x32_bf16 v[188:191], v[252:255], v[176:179], v[188:191]
 v_exp_f32 v240, v132
 v_exp_f32 v241, v133
 v_exp_f32 v242, v134
 v_cvt_pk_bf16_f32 v164, v240, v241
 v_exp_f32 v243, v135
 v_exp_f32 v240, v136
 v_cvt_pk_bf16_f32 v165, v242, v243
 v_exp_f32 v241, v137
 v_exp_f32 v242, v138
 v_cvt_pk_bf16_f32 v166, v240, v241
 v_exp_f32 v243, v139
 v_exp_f32 v240, v140
 s_nop 7
 s_branch KB_RET_B0A_1
KB_RARE_DB1A_0:
 v_max3_f32 v236, v132, v133, v134
 v_max3_f32 v235, v140, v141, v142
 v_max3_f32 v236, v236, v135, v136
 v_max3_f32 v235, v235, v143, v144
 v_max3_f32 v236, v236, v137, v138
 v_max3_f32 v235, v235, v145, v146
 v_max_f32 v236, v236, v139
 v_max_f32 v235, v235, v147
 v_mov_b32 v237, v236
 v_mov_b32 v240, v235
 s_nop 0
 v_permlane32_swap_b32 v236, v237
 v_permlane32_swap_b32 v235, v240
 v_max_f32 v236, v236, v237
 v_max_f32 v235, v235, v240
 v_mov_b32 v237, v236
 v_mov_b32 v240, v235
 s_nop 0
 v_permlane16_swap_b32 v236, v237
 v_permlane16_swap_b32 v235, v240
 v_max_f32 v236, v236, v237
 v_max_f32 v235, v235, v240
 v_max_f32 v237, 0, v236
 v_max_f32 v240, 0, v235
 v_exp_f32 v238, -v237
 v_exp_f32 v241, -v240
 v_sub_f32 v132, v132, v237
 v_sub_f32 v133, v133, v237
 v_sub_f32 v134, v134, v237
 v_sub_f32 v135, v135, v237
 v_sub_f32 v136, v136, v237
 v_sub_f32 v137, v137, v237
 v_sub_f32 v138, v138, v237
 v_sub_f32 v139, v139, v237
 v_sub_f32 v148, v148, v237
 v_sub_f32 v149, v149, v237
 v_sub_f32 v150, v150, v237
 v_sub_f32 v151, v151, v237
 v_sub_f32 v152, v152, v237
 v_sub_f32 v153, v153, v237
 v_sub_f32 v154, v154, v237
 v_sub_f32 v155, v155, v237
 v_mul_f32 v36, v36, v238
 v_mul_f32 v37, v37, v238
 v_mul_f32 v38, v38, v238
 v_mul_f32 v39, v39, v238
 v_mul_f32 v40, v40, v238
 v_mul_f32 v41, v41, v238
 v_mul_f32 v42, v42, v238
 v_mul_f32 v43, v43, v238
 v_mul_f32 v52, v52, v238
 v_mul_f32 v53, v53, v238
 v_mul_f32 v54, v54, v238
 v_mul_f32 v55, v55, v238
 v_mul_f32 v56, v56, v238
 v_mul_f32 v57, v57, v238
 v_mul_f32 v58, v58, v238
 v_mul_f32 v59, v59, v238
 v_mul_f32 v68, v68, v238
 v_mul_f32 v69, v69, v238
 v_mul_f32 v70, v70, v238
 v_mul_f32 v71, v71, v238
 v_mul_f32 v72, v72, v238
 v_mul_f32 v73, v73, v238
 v_mul_f32 v74, v74, v238
 v_mul_f32 v75, v75, v238
 v_mul_f32 v84, v84, v238
 v_mul_f32 v85, v85, v238
 v_mul_f32 v86, v86, v238
 v_mul_f32 v87, v87, v238
 v_mul_f32 v88, v88, v238
 v_mul_f32 v89, v89, v238
 v_mul_f32 v90, v90, v238
 v_mul_f32 v91, v91, v238
 v_mul_f32 v188, v188, v238
 v_sub_f32 v180, v180, v237
 v_sub_f32 v181, v181, v237
 v_sub_f32 v182, v182, v237
 v_sub_f32 v183, v183, v237
 v_sub_f32 v140, v140, v240
 v_sub_f32 v141, v141, v240
 v_sub_f32 v142, v142, v240
 v_sub_f32 v143, v143, v240
 v_sub_f32 v144, v144, v240
 v_sub_f32 v145, v145, v240
 v_sub_f32 v146, v146, v240
 v_sub_f32 v147, v147, v240
 v_sub_f32 v156, v156, v240
 v_sub_f32 v157, v157, v240
 v_sub_f32 v158, v158, v240
 v_sub_f32 v159, v159, v240
 v_sub_f32 v160, v160, v240
 v_sub_f32 v161, v161, v240
 v_sub_f32 v162, v162, v240
 v_sub_f32 v163, v163, v240
 v_mul_f32 v44, v44, v241
 v_mul_f32 v45, v45, v241
 v_mul_f32 v46, v46, v241
 v_mul_f32 v47, v47, v241
 v_mul_f32 v48, v48, v241
 v_mul_f32 v49, v49, v241
 v_mul_f32 v50, v50, v241
 v_mul_f32 v51, v51, v241
 v_mul_f32 v60, v60, v241
 v_mul_f32 v61, v61, v241
 v_mul_f32 v62, v62, v241
 v_mul_f32 v63, v63, v241
 v_mul_f32 v64, v64, v241
 v_mul_f32 v65, v65, v241
 v_mul_f32 v66, v66, v241
 v_mul_f32 v67, v67, v241
 v_mul_f32 v76, v76, v241
 v_mul_f32 v77, v77, v241
 v_mul_f32 v78, v78, v241
 v_mul_f32 v79, v79, v241
 v_mul_f32 v80, v80, v241
 v_mul_f32 v81, v81, v241
 v_mul_f32 v82, v82, v241
 v_mul_f32 v83, v83, v241
 v_mul_f32 v92, v92, v241
 v_mul_f32 v93, v93, v241
 v_mul_f32 v94, v94, v241
 v_mul_f32 v95, v95, v241
 v_mul_f32 v96, v96, v241
 v_mul_f32 v97, v97, v241
 v_mul_f32 v98, v98, v241
 v_mul_f32 v99, v99, v241
 v_mul_f32 v189, v189, v241
 v_sub_f32 v184, v184, v240
 v_sub_f32 v185, v185, v240
 v_sub_f32 v186, v186, v240
 v_sub_f32 v187, v187, v240
 v_exp_f32 v240, v132
 v_exp_f32 v241, v133
 v_exp_f32 v242, v134
 v_cvt_pk_bf16_f32 v164, v240, v241
 v_exp_f32 v243, v135
 v_exp_f32 v240, v136
 v_cvt_pk_bf16_f32 v165, v242, v243
 v_exp_f32 v241, v137
 v_exp_f32 v242, v138
 v_cvt_pk_bf16_f32 v166, v240, v241
 v_exp_f32 v243, v139
 v_exp_f32 v240, v140
 v_cvt_pk_bf16_f32 v167, v242, v243
 v_exp_f32 v241, v141
 v_exp_f32 v242, v142
 v_cvt_pk_bf16_f32 v168, v240, v241
 v_exp_f32 v243, v143
 v_exp_f32 v240, v144
 v_cvt_pk_bf16_f32 v169, v242, v243
 v_exp_f32 v241, v145
 v_exp_f32 v242, v146
 v_cvt_pk_bf16_f32 v170, v240, v241
 v_exp_f32 v243, v147
 s_nop 0
 v_cvt_pk_bf16_f32 v171, v242, v243
 v_add_f32 v190, v188, v189
 s_nop 1
 v_mfma_f32_16x16x32_bf16 v[192:195], v[248:251], v[164:167], v[188:191]
 v_mfma_f32_16x16x32_bf16 v[192:195], v[252:255], v[168:171], v[192:195]
 v_exp_f32 v240, v148
 v_exp_f32 v241, v149
 v_exp_f32 v242, v150
 v_cvt_pk_bf16_f32 v172, v240, v241
 v_exp_f32 v243, v151
 v_exp_f32 v240, v152
 v_cvt_pk_bf16_f32 v173, v242, v243
 v_exp_f32 v241, v153
 s_nop 7
 s_branch KB_RET_DB1A_0
KB_RARE_DB1A_1:
 v_max3_f32 v236, v148, v149, v150
 v_max3_f32 v235, v156, v157, v158
 v_max3_f32 v236, v236, v151, v152
 v_max3_f32 v235, v235, v159, v160
 v_max3_f32 v236, v236, v153, v154
 v_max3_f32 v235, v235, v161, v162
 v_max_f32 v236, v236, v155
 v_max_f32 v235, v235, v163
 v_mov_b32 v237, v236
 v_mov_b32 v240, v235
 s_nop 0
 v_permlane32_swap_b32 v236, v237
 v_permlane32_swap_b32 v235, v240
 v_max_f32 v236, v236, v237
 v_max_f32 v235, v235, v240
 v_mov_b32 v237, v236
 v_mov_b32 v240, v235
 s_nop 0
 v_permlane16_swap_b32 v236, v237
 v_permlane16_swap_b32 v235, v240
 v_max_f32 v236, v236, v237
 v_max_f32 v235, v235, v240
 v_max_f32 v237, 0, v236
 v_max_f32 v240, 0, v235
 v_exp_f32 v238, -v237
 v_exp_f32 v241, -v240
 v_sub_f32 v148, v148, v237
 v_sub_f32 v149, v149, v237
 v_sub_f32 v150, v150, v237
 v_sub_f32 v151, v151, v237
 v_sub_f32 v152, v152, v237
 v_sub_f32 v153, v153, v237
 v_sub_f32 v154, v154, v237
 v_sub_f32 v155, v155, v237
 v_mul_f32 v36, v36, v238
 v_mul_f32 v37, v37, v238
 v_mul_f32 v38, v38, v238
 v_mul_f32 v39, v39, v238
 v_mul_f32 v40, v40, v238
 v_mul_f32 v41, v41, v238
 v_mul_f32 v42, v42, v238
 v_mul_f32 v43, v43, v238
 v_mul_f32 v52, v52, v238
 v_mul_f32 v53, v53, v238
 v_mul_f32 v54, v54, v238
 v_mul_f32 v55, v55, v238
 v_mul_f32 v56, v56, v238
 v_mul_f32 v57, v57, v238
 v_mul_f32 v58, v58, v238
 v_mul_f32 v59, v59, v238
 v_mul_f32 v68, v68, v238
 v_mul_f32 v69, v69, v238
 v_mul_f32 v70, v70, v238
 v_mul_f32 v71, v71, v238
 v_mul_f32 v72, v72, v238
 v_mul_f32 v73, v73, v238
 v_mul_f32 v74, v74, v238
 v_mul_f32 v75, v75, v238
 v_mul_f32 v84, v84, v238
 v_mul_f32 v85, v85, v238
 v_mul_f32 v86, v86, v238
 v_mul_f32 v87, v87, v238
 v_mul_f32 v88, v88, v238
 v_mul_f32 v89, v89, v238
 v_mul_f32 v90, v90, v238
 v_mul_f32 v91, v91, v238
 v_mul_f32 v192, v192, v238
 v_sub_f32 v180, v180, v237
 v_sub_f32 v181, v181, v237
 v_sub_f32 v182, v182, v237
 v_sub_f32 v183, v183, v237
 v_sub_f32 v156, v156, v240
 v_sub_f32 v157, v157, v240
 v_sub_f32 v158, v158, v240
 v_sub_f32 v159, v159, v240
 v_sub_f32 v160, v160, v240
 v_sub_f32 v161, v161, v240
 v_sub_f32 v162, v162, v240
 v_sub_f32 v163, v163, v240
 v_mul_f32 v44, v44, v241
 v_mul_f32 v45, v45, v241
 v_mul_f32 v46, v46, v241
 v_mul_f32 v47, v47, v241
 v_mul_f32 v48, v48, v241
 v_mul_f32 v49, v49, v241
 v_mul_f32 v50, v50, v241
 v_mul_f32 v51, v51, v241
 v_mul_f32 v60, v60, v241
 v_mul_f32 v61, v61, v241
 v_mul_f32 v62, v62, v241
 v_mul_f32 v63, v63, v241
 v_mul_f32 v64, v64, v241
 v_mul_f32 v65, v65, v241
 v_mul_f32 v66, v66, v241
 v_mul_f32 v67, v67, v241
 v_mul_f32 v76, v76, v241
 v_mul_f32 v77, v77, v241
 v_mul_f32 v78, v78, v241
 v_mul_f32 v79, v79, v241
 v_mul_f32 v80, v80, v241
 v_mul_f32 v81, v81, v241
 v_mul_f32 v82, v82, v241
 v_mul_f32 v83, v83, v241
 v_mul_f32 v92, v92, v241
 v_mul_f32 v93, v93, v241
 v_mul_f32 v94, v94, v241
 v_mul_f32 v95, v95, v241
 v_mul_f32 v96, v96, v241
 v_mul_f32 v97, v97, v241
 v_mul_f32 v98, v98, v241
 v_mul_f32 v99, v99, v241
 v_mul_f32 v193, v193, v241
 v_sub_f32 v184, v184, v240
 v_sub_f32 v185, v185, v240
 v_sub_f32 v186, v186, v240
 v_sub_f32 v187, v187, v240
 v_exp_f32 v240, v148
 v_exp_f32 v241, v149
 v_exp_f32 v242, v150
 v_cvt_pk_bf16_f32 v172, v240, v241
 v_exp_f32 v243, v151
 v_exp_f32 v240, v152
 v_cvt_pk_bf16_f32 v173, v242, v243
 v_exp_f32 v241, v153
 v_exp_f32 v242, v154
 v_cvt_pk_bf16_f32 v174, v240, v241
 v_exp_f32 v243, v155
 v_exp_f32 v240, v156
 v_cvt_pk_bf16_f32 v175, v242, v243
 v_exp_f32 v241, v157
 v_exp_f32 v242, v158
 v_cvt_pk_bf16_f32 v176, v240, v241
 v_exp_f32 v243, v159
 v_exp_f32 v240, v160
 v_cvt_pk_bf16_f32 v177, v242, v243
 v_exp_f32 v241, v161
 v_exp_f32 v242, v162
 v_cvt_pk_bf16_f32 v178, v240, v241
 v_exp_f32 v243, v163
 s_nop 0
 v_cvt_pk_bf16_f32 v179, v242, v243
 v_add_f32 v194, v192, v193
 s_nop 1
 v_mfma_f32_16x16x32_bf16 v[188:191], v[248:251], v[172:175], v[192:195]
 v_mfma_f32_16x16x32_bf16 v[188:191], v[252:255], v[176:179], v[188:191]
 s_nop 7
 s_branch KB_RET_DB1A_1
KB_RARE_A0A_0:
 v_max3_f32 v236, v100, v101, v102
 v_max3_f32 v235, v108, v109, v110
 v_max3_f32 v236, v236, v103, v104
 v_max3_f32 v235, v235, v111, v112
 v_max3_f32 v236, v236, v105, v106
 v_max3_f32 v235, v235, v113, v114
 v_max_f32 v236, v236, v107
 v_max_f32 v235, v235, v115
 v_mov_b32 v237, v236
 v_mov_b32 v240, v235
 s_nop 0
 v_permlane32_swap_b32 v236, v237
 v_permlane32_swap_b32 v235, v240
 v_max_f32 v236, v236, v237
 v_max_f32 v235, v235, v240
 v_mov_b32 v237, v236
 v_mov_b32 v240, v235
 s_nop 0
 v_permlane16_swap_b32 v236, v237
 v_permlane16_swap_b32 v235, v240
 v_max_f32 v236, v236, v237
 v_max_f32 v235, v235, v240
 v_max_f32 v237, 0, v236
 v_max_f32 v240, 0, v235
 v_exp_f32 v238, -v237
 v_exp_f32 v241, -v240
 v_sub_f32 v100, v100, v237
 v_sub_f32 v101, v101, v237
 v_sub_f32 v102, v102, v237
 v_sub_f32 v103, v103, v237
 v_sub_f32 v104, v104, v237
 v_sub_f32 v105, v105, v237
 v_sub_f32 v106, v106, v237
 v_sub_f32 v107, v107, v237
 v_sub_f32 v116, v116, v237
 v_sub_f32 v117, v117, v237
 v_sub_f32 v118, v118, v237
 v_sub_f32 v119, v119, v237
 v_sub_f32 v120, v120, v237
 v_sub_f32 v121, v121, v237
 v_sub_f32 v122, v122, v237
 v_sub_f32 v123, v123, v237
 v_sub_f32 v132, v132, v237
 v_sub_f32 v133, v133, v237
 v_sub_f32 v134, v134, v237
 v_sub_f32 v135, v135, v237
 v_sub_f32 v136, v136, v237
 v_sub_f32 v137, v137, v237
 v_sub_f32 v138, v138, v237
 v_sub_f32 v139, v139, v237
 v_mul_f32 v36, v36, v238
 v_mul_f32 v37, v37, v238
 v_mul_f32 v38, v38, v238
 v_mul_f32 v39, v39, v238
 v_mul_f32 v40, v40, v238
 v_mul_f32 v41, v41, v238
 v_mul_f32 v42, v42, v238
 v_mul_f32 v43, v43, v238
 v_mul_f32 v52, v52, v238
 v_mul_f32 v53, v53, v238
 v_mul_f32 v54, v54, v238
 v_mul_f32 v55, v55, v238
 v_mul_f32 v56, v56, v238
 v_mul_f32 v57, v57, v238
 v_mul_f32 v58, v58, v238
 v_mul_f32 v59, v59, v238
 v_mul_f32 v68, v68, v238
 v_mul_f32 v69, v69, v238
 v_mul_f32 v70, v70, v238
 v_mul_f32 v71, v71, v238
 v_mul_f32 v72, v72, v238
 v_mul_f32 v73, v73, v238
 v_mul_f32 v74, v74, v238
 v_mul_f32 v75, v75, v238
 v_mul_f32 v84, v84, v238
 v_mul_f32 v85, v85, v238
 v_mul_f32 v86, v86, v238
 v_mul_f32 v87, v87, v238
 v_mul_f32 v88, v88, v238
 v_mul_f32 v89, v89, v238
 v_mul_f32 v90, v90, v238
 v_mul_f32 v91, v91, v238
 v_mul_f32 v188, v188, v238
 v_sub_f32 v180, v180, v237
 v_sub_f32 v181, v181, v237
 v_sub_f32 v182, v182, v237
 v_sub_f32 v183, v183, v237
 v_sub_f32 v108, v108, v240
 v_sub_f32 v109, v109, v240
 v_sub_f32 v110, v110, v240
 v_sub_f32 v111, v111, v240
 v_sub_f32 v112, v112, v240
 v_sub_f32 v113, v113, v240
 v_sub_f32 v114, v114, v240
 v_sub_f32 v115, v115, v240
 v_sub_f32 v124, v124, v240
 v_sub_f32 v125, v125, v240
 v_sub_f32 v126, v126, v240
 v_sub_f32 v127, v127, v240
 v_sub_f32 v128, v128, v240
 v_sub_f32 v129, v129, v240
 v_sub_f32 v130, v130, v240
 v_sub_f32 v131, v131, v240
 v_sub_f32 v140, v140, v240
 v_sub_f32 v141, v141, v240
 v_sub_f32 v142, v142, v240
 v_sub_f32 v143, v143, v240
 v_sub_f32 v144, v144, v240
 v_sub_f32 v145, v145, v240
 v_sub_f32 v146, v146, v240
 v_sub_f32 v147, v147, v240
 v_mul_f32 v44, v44, v241
 v_mul_f32 v45, v45, v241
 v_mul_f32 v46, v46, v241
 v_mul_f32 v47, v47, v241
 v_mul_f32 v48, v48, v241
 v_mul_f32 v49, v49, v241
 v_mul_f32 v50, v50, v241
 v_mul_f32 v51, v51, v241
 v_mul_f32 v60, v60, v241
 v_mul_f32 v61, v61, v241
 v_mul_f32 v62, v62, v241
 v_mul_f32 v63, v63, v241
 v_mul_f32 v64, v64, v241
 v_mul_f32 v65, v65, v241
 v_mul_f32 v66, v66, v241
 v_mul_f32 v67, v67, v241
 v_mul_f32 v76, v76, v241
 v_mul_f32 v77, v77, v241
 v_mul_f32 v78, v78, v241
 v_mul_f32 v79, v79, v241
 v_mul_f32 v80, v80, v241
 v_mul_f32 v81, v81, v241
 v_mul_f32 v82, v82, v241
 v_mul_f32 v83, v83, v241
 v_mul_f32 v92, v92, v241
 v_mul_f32 v93, v93, v241
 v_mul_f32 v94, v94, v241
 v_mul_f32 v95, v95, v241
 v_mul_f32 v96, v96, v241
 v_mul_f32 v97, v97, v241
 v_mul_f32 v98, v98, v241
 v_mul_f32 v99, v99, v241
 v_mul_f32 v189, v189, v241
 v_sub_f32 v184, v184, v240
 v_sub_f32 v185, v185, v240
 v_sub_f32 v186, v186, v240
 v_sub_f32 v187, v187, v240
 v_exp_f32 v240, v100
 v_exp_f32 v241, v101
 v_exp_f32 v242, v102
 v_cvt_pk_bf16_f32 v164, v240, v241
 v_exp_f32 v243, v103
 v_exp_f32 v240, v104
 v_cvt_pk_bf16_f32 v165, v242, v243
 v_exp_f32 v241, v105
 v_exp_f32 v242, v106
 v_cvt_pk_bf16_f32 v166, v240, v241
 v_exp_f32 v243, v107
 v_exp_f32 v240, v108
 v_cvt_pk_bf16_f32 v167, v242, v243
 v_exp_f32 v241, v109
 v_exp_f32 v242, v110
 v_cvt_pk_bf16_f32 v168, v240, v241
 v_exp_f32 v243, v111
 v_exp_f32 v240, v112
 v_cvt_pk_bf16_f32 v169, v242, v243
 v_exp_f32 v241, v113
 v_exp_f32 v242, v114
 v_cvt_pk_bf16_f32 v170, v240, v241
 v_exp_f32 v243, v115
 s_nop 0
 v_cvt_pk_bf16_f32 v171, v242, v243
 v_add_f32 v190, v188, v189
 s_nop 1
 v_mfma_f32_16x16x32_bf16 v[192:195], v[248:251], v[164:167], v[188:191]
 v_mfma_f32_16x16x32_bf16 v[192:195], v[252:255], v[168:171], v[192:195]
 v_exp_f32 v240, v116
 v_exp_f32 v241, v117
 v_exp_f32 v242, v118
 v_cvt_pk_bf16_f32 v172, v240, v241
 v_exp_f32 v243, v119
 v_exp_f32 v240, v120
 v_cvt_pk_bf16_f32 v173, v242, v243
 s_nop 7
 s_branch KB_RET_A0A_0
KB_RARE_A0A_1:
 v_max3_f32 v236, v116, v117, v118
 v_max3_f32 v235, v124, v125, v126
 v_max3_f32 v236, v236, v119, v120
 v_max3_f32 v235, v235, v127, v128
 v_max3_f32 v236, v236, v121, v122
 v_max3_f32 v235, v235, v129, v130
 v_max_f32 v236, v236, v123
 v_max_f32 v235, v235, v131
 v_mov_b32 v237, v236
 v_mov_b32 v240, v235
 s_nop 0
 v_permlane32_swap_b32 v236, v237
 v_permlane32_swap_b32 v235, v240
 v_max_f32 v236, v236, v237
 v_max_f32 v235, v235, v240
 v_mov_b32 v237, v236
 v_mov_b32 v240, v235
 s_nop 0
 v_permlane16_swap_b32 v236, v237
 v_permlane16_swap_b32 v235, v240
 v_max_f32 v236, v236, v237
 v_max_f32 v235, v235, v240
 v_max_f32 v237, 0, v236
 v_max_f32 v240, 0, v235
 v_exp_f32 v238, -v237
 v_exp_f32 v241, -v240
 v_sub_f32 v116, v116, v237
 v_sub_f32 v117, v117, v237
 v_sub_f32 v118, v118, v237
 v_sub_f32 v119, v119, v237
 v_sub_f32 v120, v120, v237
 v_sub_f32 v121, v121, v237
 v_sub_f32 v122, v122, v237
 v_sub_f32 v123, v123, v237
 v_sub_f32 v132, v132, v237
 v_sub_f32 v133, v133, v237
 v_sub_f32 v134, v134, v237
 v_sub_f32 v135, v135, v237
 v_sub_f32 v136, v136, v237
 v_sub_f32 v137, v137, v237
 v_sub_f32 v138, v138, v237
 v_sub_f32 v139, v139, v237
 v_mul_f32 v36, v36, v238
 v_mul_f32 v37, v37, v238
 v_mul_f32 v38, v38, v238
 v_mul_f32 v39, v39, v238
 v_mul_f32 v40, v40, v238
 v_mul_f32 v41, v41, v238
 v_mul_f32 v42, v42, v238
 v_mul_f32 v43, v43, v238
 v_mul_f32 v52, v52, v238
 v_mul_f32 v53, v53, v238
 v_mul_f32 v54, v54, v238
 v_mul_f32 v55, v55, v238
 v_mul_f32 v56, v56, v238
 v_mul_f32 v57, v57, v238
 v_mul_f32 v58, v58, v238
 v_mul_f32 v59, v59, v238
 v_mul_f32 v68, v68, v238
 v_mul_f32 v69, v69, v238
 v_mul_f32 v70, v70, v238
 v_mul_f32 v71, v71, v238
 v_mul_f32 v72, v72, v238
 v_mul_f32 v73, v73, v238
 v_mul_f32 v74, v74, v238
 v_mul_f32 v75, v75, v238
 v_mul_f32 v84, v84, v238
 v_mul_f32 v85, v85, v238
 v_mul_f32 v86, v86, v238
 v_mul_f32 v87, v87, v238
 v_mul_f32 v88, v88, v238
 v_mul_f32 v89, v89, v238
 v_mul_f32 v90, v90, v238
 v_mul_f32 v91, v91, v238
 v_mul_f32 v192, v192, v238
 v_sub_f32 v180, v180, v237
 v_sub_f32 v181, v181, v237
 v_sub_f32 v182, v182, v237
 v_sub_f32 v183, v183, v237
 v_sub_f32 v124, v124, v240
 v_sub_f32 v125, v125, v240
 v_sub_f32 v126, v126, v240
 v_sub_f32 v127, v127, v240
 v_sub_f32 v128, v128, v240
 v_sub_f32 v129, v129, v240
 v_sub_f32 v130, v130, v240
 v_sub_f32 v131, v131, v240
 v_sub_f32 v140, v140, v240
 v_sub_f32 v141, v141, v240
 v_sub_f32 v142, v142, v240
 v_sub_f32 v143, v143, v240
 v_sub_f32 v144, v144, v240
 v_sub_f32 v145, v145, v240
 v_sub_f32 v146, v146, v240
 v_sub_f32 v147, v147, v240
 v_mul_f32 v44, v44, v241
 v_mul_f32 v45, v45, v241
 v_mul_f32 v46, v46, v241
 v_mul_f32 v47, v47, v241
 v_mul_f32 v48, v48, v241
 v_mul_f32 v49, v49, v241
 v_mul_f32 v50, v50, v241
 v_mul_f32 v51, v51, v241
 v_mul_f32 v60, v60, v241
 v_mul_f32 v61, v61, v241
 v_mul_f32 v62, v62, v241
 v_mul_f32 v63, v63, v241
 v_mul_f32 v64, v64, v241
 v_mul_f32 v65, v65, v241
 v_mul_f32 v66, v66, v241
 v_mul_f32 v67, v67, v241
 v_mul_f32 v76, v76, v241
 v_mul_f32 v77, v77, v241
 v_mul_f32 v78, v78, v241
 v_mul_f32 v79, v79, v241
 v_mul_f32 v80, v80, v241
 v_mul_f32 v81, v81, v241
 v_mul_f32 v82, v82, v241
 v_mul_f32 v83, v83, v241
 v_mul_f32 v92, v92, v241
 v_mul_f32 v93, v93, v241
 v_mul_f32 v94, v94, v241
 v_mul_f32 v95, v95, v241
 v_mul_f32 v96, v96, v241
 v_mul_f32 v97, v97, v241
 v_mul_f32 v98, v98, v241
 v_mul_f32 v99, v99, v241
 v_mul_f32 v193, v193, v241
 v_sub_f32 v184, v184, v240
 v_sub_f32 v185, v185, v240
 v_sub_f32 v186, v186, v240
 v_sub_f32 v187, v187, v240
 v_exp_f32 v240, v116
 v_exp_f32 v241, v117
 v_exp_f32 v242, v118
 v_cvt_pk_bf16_f32 v172, v240, v241
 v_exp_f32 v243, v119
 v_exp_f32 v240, v120
 v_cvt_pk_bf16_f32 v173, v242, v243
 v_exp_f32 v241, v121
 v_exp_f32 v242, v122
 v_cvt_pk_bf16_f32 v174, v240, v241
 v_exp_f32 v243, v123
 v_exp_f32 v240, v124
 v_cvt_pk_bf16_f32 v175, v242, v243
 v_exp_f32 v241, v125
 v_exp_f32 v242, v126
 v_cvt_pk_bf16_f32 v176, v240, v241
 v_exp_f32 v243, v127
 v_exp_f32 v240, v128
 v_cvt_pk_bf16_f32 v177, v242, v243
 v_exp_f32 v241, v129
 v_exp_f32 v242, v130
 v_cvt_pk_bf16_f32 v178, v240, v241
 v_exp_f32 v243, v131
 s_nop 0
 v_cvt_pk_bf16_f32 v179, v242, v243
 v_add_f32 v194, v192, v193
 s_nop 1
 v_mfma_f32_16x16x32_bf16 v[188:191], v[248:251], v[172:175], v[192:195]
 v_mfma_f32_16x16x32_bf16 v[188:191], v[252:255], v[176:179], v[188:191]
 v_cmp_gt_i32 s[44:45], 0, v245
 v_cmp_gt_i32 s[46:47], 1, v245
 v_cmp_gt_i32 s[48:49], 2, v245
 v_cmp_gt_i32 s[50:51], 3, v245
 v_cndmask_b32 v132, v132, v246, s[44:45]
 v_cndmask_b32 v133, v133, v246, s[46:47]
 v_cndmask_b32 v134, v134, v246, s[48:49]
 v_cndmask_b32 v135, v135, v246, s[50:51]
 s_nop 7
 s_branch KB_RET_A0A_1
KB_RARE_DA1A_0:
 v_max3_f32 v236, v132, v133, v134
 v_max3_f32 v235, v140, v141, v142
 v_max3_f32 v236, v236, v135, v136
 v_max3_f32 v235, v235, v143, v144
 v_max3_f32 v236, v236, v137, v138
 v_max3_f32 v235, v235, v145, v146
 v_max_f32 v236, v236, v139
 v_max_f32 v235, v235, v147
 v_mov_b32 v237, v236
 v_mov_b32 v240, v235
 s_nop 0
 v_permlane32_swap_b32 v236, v237
 v_permlane32_swap_b32 v235, v240
 v_max_f32 v236, v236, v237
 v_max_f32 v235, v235, v240
 v_mov_b32 v237, v236
 v_mov_b32 v240, v235
 s_nop 0
 v_permlane16_swap_b32 v236, v237
 v_permlane16_swap_b32 v235, v240
 v_max_f32 v236, v236, v237
 v_max_f32 v235, v235, v240
 v_max_f32 v237, 0, v236
 v_max_f32 v240, 0, v235
 v_exp_f32 v238, -v237
 v_exp_f32 v241, -v240
 v_sub_f32 v132, v132, v237
 v_sub_f32 v133, v133, v237
 v_sub_f32 v134, v134, v237
 v_sub_f32 v135, v135, v237
 v_sub_f32 v136, v136, v237
 v_sub_f32 v137, v137, v237
 v_sub_f32 v138, v138, v237
 v_sub_f32 v139, v139, v237
 v_mul_f32 v36, v36, v238
 v_mul_f32 v37, v37, v238
 v_mul_f32 v38, v38, v238
 v_mul_f32 v39, v39, v238
 v_mul_f32 v40, v40, v238
 v_mul_f32 v41, v41, v238
 v_mul_f32 v42, v42, v238
 v_mul_f32 v43, v43, v238
 v_mul_f32 v52, v52, v238
 v_mul_f32 v53, v53, v238
 v_mul_f32 v54, v54, v238
 v_mul_f32 v55, v55, v238
 v_mul_f32 v56, v56, v238
 v_mul_f32 v57, v57, v238
 v_mul_f32 v58, v58, v238
 v_mul_f32 v59, v59, v238
 v_mul_f32 v68, v68, v238
 v_mul_f32 v69, v69, v238
 v_mul_f32 v70, v70, v238
 v_mul_f32 v71, v71, v238
 v_mul_f32 v72, v72, v238
 v_mul_f32 v73, v73, v238
 v_mul_f32 v74, v74, v238
 v_mul_f32 v75, v75, v238
 v_mul_f32 v84, v84, v238
 v_mul_f32 v85, v85, v238
 v_mul_f32 v86, v86, v238
 v_mul_f32 v87, v87, v238
 v_mul_f32 v88, v88, v238
 v_mul_f32 v89, v89, v238
 v_mul_f32 v90, v90, v238
 v_mul_f32 v91, v91, v238
 v_mul_f32 v188, v188, v238
 v_sub_f32 v180, v180, v237
 v_sub_f32 v181, v181, v237
 v_sub_f32 v182, v182, v237
 v_sub_f32 v183, v183, v237
 v_sub_f32 v140, v140, v240
 v_sub_f32 v141, v141, v240
 v_sub_f32 v142, v142, v240
 v_sub_f32 v143, v143, v240
 v_sub_f32 v144, v144, v240
 v_sub_f32 v145, v145, v240
 v_sub_f32 v146, v146, v240
 v_sub_f32 v147, v147, v240
 v_mul_f32 v44, v44, v241
 v_mul_f32 v45, v45, v241
 v_mul_f32 v46, v46, v241
 v_mul_f32 v47, v47, v241
 v_mul_f32 v48, v48, v241
 v_mul_f32 v49, v49, v241
 v_mul_f32 v50, v50, v241
 v_mul_f32 v51, v51, v241
 v_mul_f32 v60, v60, v241
 v_mul_f32 v61, v61, v241
 v_mul_f32 v62, v62, v241
 v_mul_f32 v63, v63, v241
 v_mul_f32 v64, v64, v241
 v_mul_f32 v65, v65, v241
 v_mul_f32 v66, v66, v241
 v_mul_f32 v67, v67, v241
 v_mul_f32 v76, v76, v241
 v_mul_f32 v77, v77, v241
 v_mul_f32 v78, v78, v241
 v_mul_f32 v79, v79, v241
 v_mul_f32 v80, v80, v241
 v_mul_f32 v81, v81, v241
 v_mul_f32 v82, v82, v241
 v_mul_f32 v83, v83, v241
 v_mul_f32 v92, v92, v241
 v_mul_f32 v93, v93, v241
 v_mul_f32 v94, v94, v241
 v_mul_f32 v95, v95, v241
 v_mul_f32 v96, v96, v241
 v_mul_f32 v97, v97, v241
 v_mul_f32 v98, v98, v241
 v_mul_f32 v99, v99, v241
 v_mul_f32 v189, v189, v241
 v_sub_f32 v184, v184, v240
 v_sub_f32 v185, v185, v240
 v_sub_f32 v186, v186, v240
 v_sub_f32 v187, v187, v240
 v_exp_f32 v240, v132
 v_exp_f32 v241, v133
 v_exp_f32 v242, v134
 v_cvt_pk_bf16_f32 v164, v240, v241
 v_exp_f32 v243, v135
 v_exp_f32 v240, v136
 v_cvt_pk_bf16_f32 v165, v242, v243
 v_exp_f32 v241, v137
 v_exp_f32 v242, v138
 v_cvt_pk_bf16_f32 v166, v240, v241
 v_exp_f32 v243, v139
 v_exp_f32 v240, v140
 v_cvt_pk_bf16_f32 v167, v242, v243
 v_exp_f32 v241, v141
 v_exp_f32 v242, v142
 v_cvt_pk_bf16_f32 v168, v240, v241
 v_exp_f32 v243, v143
 v_exp_f32 v240, v144
 v_cvt_pk_bf16_f32 v169, v242, v243
 v_exp_f32 v241, v145
 v_exp_f32 v242, v146
 v_cvt_pk_bf16_f32 v170, v240, v241
 v_exp_f32 v243, v147
 s_nop 0
 v_cvt_pk_bf16_f32 v171, v242, v243
 v_add_f32 v190, v188, v189
 s_nop 1
 v_mfma_f32_16x16x32_bf16 v[192:195], v[248:251], v[164:167], v[188:191]
 v_mfma_f32_16x16x32_bf16 v[192:195], v[252:255], v[168:171], v[192:195]
 s_nop 7
 s_branch KB_RET_DA1A_0
KB_RARE_B1A_0:
 v_max3_f32 v236, v132, v133, v134
 v_max3_f32 v235, v140, v141, v142
 v_max3_f32 v236, v236, v135, v136
 v_max3_f32 v235, v235, v143, v144
 v_max3_f32 v236, v236, v137, v138
 v_max3_f32 v235, v235, v145, v146
 v_max_f32 v236, v236, v139
 v_max_f32 v235, v235, v147
 v_mov_b32 v237, v236
 v_mov_b32 v240, v235
 s_nop 0
 v_permlane32_swap_b32 v236, v237
 v_permlane32_swap_b32 v235, v240
 v_max_f32 v236, v236, v237
 v_max_f32 v235, v235, v240
 v_mov_b32 v237, v236
 v_mov_b32 v240, v235
 s_nop 0
 v_permlane16_swap_b32 v236, v237
 v_permlane16_swap_b32 v235, v240
 v_max_f32 v236, v236, v237
 v_max_f32 v235, v235, v240
 v_max_f32 v237, 0, v236
 v_max_f32 v240, 0, v235
 v_exp_f32 v238, -v237
 v_exp_f32 v241, -v240
 v_sub_f32 v132, v132, v237
 v_sub_f32 v133, v133, v237
 v_sub_f32 v134, v134, v237
 v_sub_f32 v135, v135, v237
 v_sub_f32 v136, v136, v237
 v_sub_f32 v137, v137, v237
 v_sub_f32 v138, v138, v237
 v_sub_f32 v139, v139, v237
 v_sub_f32 v148, v148, v237
 v_sub_f32 v149, v149, v237
 v_sub_f32 v150, v150, v237
 v_sub_f32 v151, v151, v237
 v_sub_f32 v152, v152, v237
 v_sub_f32 v153, v153, v237
 v_sub_f32 v154, v154, v237
 v_sub_f32 v155, v155, v237
 v_sub_f32 v100, v100, v237
 v_sub_f32 v101, v101, v237
 v_sub_f32 v102, v102, v237
 v_sub_f32 v103, v103, v237
 v_sub_f32 v104, v104, v237
 v_sub_f32 v105, v105, v237
 v_sub_f32 v106, v106, v237
 v_sub_f32 v107, v107, v237
 v_mul_f32 v36, v36, v238
 v_mul_f32 v37, v37, v238
 v_mul_f32 v38, v38, v238
 v_mul_f32 v39, v39, v238
 v_mul_f32 v40, v40, v238
 v_mul_f32 v41, v41, v238
 v_mul_f32 v42, v42, v238
 v_mul_f32 v43, v43, v238
 v_mul_f32 v52, v52, v238
 v_mul_f32 v53, v53, v238
 v_mul_f32 v54, v54, v238
 v_mul_f32 v55, v55, v238
 v_mul_f32 v56, v56, v238
 v_mul_f32 v57, v57, v238
 v_mul_f32 v58, v58, v238
 v_mul_f32 v59, v59, v238
 v_mul_f32 v68, v68, v238
 v_mul_f32 v69, v69, v238
 v_mul_f32 v70, v70, v238
 v_mul_f32 v71, v71, v238
 v_mul_f32 v72, v72, v238
 v_mul_f32 v73, v73, v238
 v_mul_f32 v74, v74, v238
 v_mul_f32 v75, v75, v238
 v_mul_f32 v84, v84, v238
 v_mul_f32 v85, v85, v238
 v_mul_f32 v86, v86, v238
 v_mul_f32 v87, v87, v238
 v_mul_f32 v88, v88, v238
 v_mul_f32 v89, v89, v238
 v_mul_f32 v90, v90, v238
 v_mul_f32 v91, v91, v238
 v_mul_f32 v188, v188, v238
 v_sub_f32 v180, v180, v237
 v_sub_f32 v181, v181, v237
 v_sub_f32 v182, v182, v237
 v_sub_f32 v183, v183, v237
 v_sub_f32 v140, v140, v240
 v_sub_f32 v141, v141, v240
 v_sub_f32 v142, v142, v240
 v_sub_f32 v143, v143, v240
 v_sub_f32 v144, v144, v240
 v_sub_f32 v145, v145, v240
 v_sub_f32 v146, v146, v240
 v_sub_f32 v147, v147, v240
 v_sub_f32 v156, v156, v240
 v_sub_f32 v157, v157, v240
 v_sub_f32 v158, v158, v240
 v_sub_f32 v159, v159, v240
 v_sub_f32 v160, v160, v240
 v_sub_f32 v161, v161, v240
 v_sub_f32 v162, v162, v240
 v_sub_f32 v163, v163, v240
 v_sub_f32 v108, v108, v240
 v_sub_f32 v109, v109, v240
 v_sub_f32 v110, v110, v240
 v_sub_f32 v111, v111, v240
 v_sub_f32 v112, v112, v240
 v_sub_f32 v113, v113, v240
 v_sub_f32 v114, v114, v240
 v_sub_f32 v115, v115, v240
 v_mul_f32 v44, v44, v241
 v_mul_f32 v45, v45, v241
 v_mul_f32 v46, v46, v241
 v_mul_f32 v47, v47, v241
 v_mul_f32 v48, v48, v241
 v_mul_f32 v49, v49, v241
 v_mul_f32 v50, v50, v241
 v_mul_f32 v51, v51, v241
 v_mul_f32 v60, v60, v241
 v_mul_f32 v61, v61, v241
 v_mul_f32 v62, v62, v241
 v_mul_f32 v63, v63, v241
 v_mul_f32 v64, v64, v241
 v_mul_f32 v65, v65, v241
 v_mul_f32 v66, v66, v241
 v_mul_f32 v67, v67, v241
 v_mul_f32 v76, v76, v241
 v_mul_f32 v77, v77, v241
 v_mul_f32 v78, v78, v241
 v_mul_f32 v79, v79, v241
 v_mul_f32 v80, v80, v241
 v_mul_f32 v81, v81, v241
 v_mul_f32 v82, v82, v241
 v_mul_f32 v83, v83, v241
 v_mul_f32 v92, v92, v241
 v_mul_f32 v93, v93, v241
 v_mul_f32 v94, v94, v241
 v_mul_f32 v95, v95, v241
 v_mul_f32 v96, v96, v241
 v_mul_f32 v97, v97, v241
 v_mul_f32 v98, v98, v241
 v_mul_f32 v99, v99, v241
 v_mul_f32 v189, v189, v241
 v_sub_f32 v184, v184, v240
 v_sub_f32 v185, v185, v240
 v_sub_f32 v186, v186, v240
 v_sub_f32 v187, v187, v240
 v_exp_f32 v240, v132
 v_exp_f32 v241, v133
 v_exp_f32 v242, v134
 v_cvt_pk_bf16_f32 v164, v240, v241
 v_exp_f32 v243, v135
 v_exp_f32 v240, v136
 v_cvt_pk_bf16_f32 v165, v242, v243
 v_exp_f32 v241, v137
 v_exp_f32 v242, v138
 v_cvt_pk_bf16_f32 v166, v240, v241
 v_exp_f32 v243, v139
 v_exp_f32 v240, v140
 v_cvt_pk_bf16_f32 v167, v242, v243
 v_exp_f32 v241, v141
 v_exp_f32 v242, v142
 v_cvt_pk_bf16_f32 v168, v240, v241
 v_exp_f32 v243, v143
 v_exp_f32 v240, v144
 v_cvt_pk_bf16_f32 v169, v242, v243
 v_exp_f32 v241, v145
 v_exp_f32 v242, v146
 v_cvt_pk_bf16_f32 v170, v240, v241
 v_exp_f32 v243, v147
 s_nop 0
 v_cvt_pk_bf16_f32 v171, v242, v243
 v_add_f32 v190, v188, v189
 s_nop 1
 v_mfma_f32_16x16x32_bf16 v[192:195], v[248:251], v[164:167], v[188:191]
 v_mfma_f32_16x16x32_bf16 v[192:195], v[252:255], v[168:171], v[192:195]
 v_exp_f32 v240, v148
 v_exp_f32 v241, v149
 v_exp_f32 v242, v150
 v_cvt_pk_bf16_f32 v172, v240, v241
 v_exp_f32 v243, v151
 v_exp_f32 v240, v152
 v_cvt_pk_bf16_f32 v173, v242, v243
 s_nop 7
 s_branch KB_RET_B1A_0
KB_RARE_B1A_1:
 v_max3_f32 v236, v148, v149, v150
 v_max3_f32 v235, v156, v157, v158
 v_max3_f32 v236, v236, v151, v152
 v_max3_f32 v235, v235, v159, v160
 v_max3_f32 v236, v236, v153, v154
 v_max3_f32 v235, v235, v161, v162
 v_max_f32 v236, v236, v155
 v_max_f32 v235, v235, v163
 v_mov_b32 v237, v236
 v_mov_b32 v240, v235
 s_nop 0
 v_permlane32_swap_b32 v236, v237
 v_permlane32_swap_b32 v235, v240
 v_max_f32 v236, v236, v237
 v_max_f32 v235, v235, v240
 v_mov_b32 v237, v236
 v_mov_b32 v240, v235
 s_nop 0
 v_permlane16_swap_b32 v236, v237
 v_permlane16_swap_b32 v235, v240
 v_max_f32 v236, v236, v237
 v_max_f32 v235, v235, v240
 v_max_f32 v237, 0, v236
 v_max_f32 v240, 0, v235
 v_exp_f32 v238, -v237
 v_exp_f32 v241, -v240
 v_sub_f32 v148, v148, v237
 v_sub_f32 v149, v149, v237
 v_sub_f32 v150, v150, v237
 v_sub_f32 v151, v151, v237
 v_sub_f32 v152, v152, v237
 v_sub_f32 v153, v153, v237
 v_sub_f32 v154, v154, v237
 v_sub_f32 v155, v155, v237
 v_sub_f32 v100, v100, v237
 v_sub_f32 v101, v101, v237
 v_sub_f32 v102, v102, v237
 v_sub_f32 v103, v103, v237
 v_sub_f32 v104, v104, v237
 v_sub_f32 v105, v105, v237
 v_sub_f32 v106, v106, v237
 v_sub_f32 v107, v107, v237
 v_sub_f32 v116, v116, v237
 v_sub_f32 v117, v117, v237
 v_sub_f32 v118, v118, v237
 v_sub_f32 v119, v119, v237
 v_sub_f32 v120, v120, v237
 v_sub_f32 v121, v121, v237
 v_sub_f32 v122, v122, v237
 v_sub_f32 v123, v123, v237
 v_mul_f32 v36, v36, v238
 v_mul_f32 v37, v37, v238
 v_mul_f32 v38, v38, v238
 v_mul_f32 v39, v39, v238
 v_mul_f32 v40, v40, v238
 v_mul_f32 v41, v41, v238
 v_mul_f32 v42, v42, v238
 v_mul_f32 v43, v43, v238
 v_mul_f32 v52, v52, v238
 v_mul_f32 v53, v53, v238
 v_mul_f32 v54, v54, v238
 v_mul_f32 v55, v55, v238
 v_mul_f32 v56, v56, v238
 v_mul_f32 v57, v57, v238
 v_mul_f32 v58, v58, v238
 v_mul_f32 v59, v59, v238
 v_mul_f32 v68, v68, v238
 v_mul_f32 v69, v69, v238
 v_mul_f32 v70, v70, v238
 v_mul_f32 v71, v71, v238
 v_mul_f32 v72, v72, v238
 v_mul_f32 v73, v73, v238
 v_mul_f32 v74, v74, v238
 v_mul_f32 v75, v75, v238
 v_mul_f32 v84, v84, v238
 v_mul_f32 v85, v85, v238
 v_mul_f32 v86, v86, v238
 v_mul_f32 v87, v87, v238
 v_mul_f32 v88, v88, v238
 v_mul_f32 v89, v89, v238
 v_mul_f32 v90, v90, v238
 v_mul_f32 v91, v91, v238
 v_mul_f32 v192, v192, v238
 v_sub_f32 v180, v180, v237
 v_sub_f32 v181, v181, v237
 v_sub_f32 v182, v182, v237
 v_sub_f32 v183, v183, v237
 v_sub_f32 v156, v156, v240
 v_sub_f32 v157, v157, v240
 v_sub_f32 v158, v158, v240
 v_sub_f32 v159, v159, v240
 v_sub_f32 v160, v160, v240
 v_sub_f32 v161, v161, v240
 v_sub_f32 v162, v162, v240
 v_sub_f32 v163, v163, v240
 v_sub_f32 v108, v108, v240
 v_sub_f32 v109, v109, v240
 v_sub_f32 v110, v110, v240
 v_sub_f32 v111, v111, v240
 v_sub_f32 v112, v112, v240
 v_sub_f32 v113, v113, v240
 v_sub_f32 v114, v114, v240
 v_sub_f32 v115, v115, v240
 v_sub_f32 v124, v124, v240
 v_sub_f32 v125, v125, v240
 v_sub_f32 v126, v126, v240
 v_sub_f32 v127, v127, v240
 v_sub_f32 v128, v128, v240
 v_sub_f32 v129, v129, v240
 v_sub_f32 v130, v130, v240
 v_sub_f32 v131, v131, v240
 v_mul_f32 v44, v44, v241
 v_mul_f32 v45, v45, v241
 v_mul_f32 v46, v46, v241
 v_mul_f32 v47, v47, v241
 v_mul_f32 v48, v48, v241
 v_mul_f32 v49, v49, v241
 v_mul_f32 v50, v50, v241
 v_mul_f32 v51, v51, v241
 v_mul_f32 v60, v60, v241
 v_mul_f32 v61, v61, v241
 v_mul_f32 v62, v62, v241
 v_mul_f32 v63, v63, v241
 v_mul_f32 v64, v64, v241
 v_mul_f32 v65, v65, v241
 v_mul_f32 v66, v66, v241
 v_mul_f32 v67, v67, v241
 v_mul_f32 v76, v76, v241
 v_mul_f32 v77, v77, v241
 v_mul_f32 v78, v78, v241
 v_mul_f32 v79, v79, v241
 v_mul_f32 v80, v80, v241
 v_mul_f32 v81, v81, v241
 v_mul_f32 v82, v82, v241
 v_mul_f32 v83, v83, v241
 v_mul_f32 v92, v92, v241
 v_mul_f32 v93, v93, v241
 v_mul_f32 v94, v94, v241
 v_mul_f32 v95, v95, v241
 v_mul_f32 v96, v96, v241
 v_mul_f32 v97, v97, v241
 v_mul_f32 v98, v98, v241
 v_mul_f32 v99, v99, v241
 v_mul_f32 v193, v193, v241
 v_sub_f32 v184, v184, v240
 v_sub_f32 v185, v185, v240
 v_sub_f32 v186, v186, v240
 v_sub_f32 v187, v187, v240
 v_exp_f32 v240, v148
 v_exp_f32 v241, v149
 v_exp_f32 v242, v150
 v_cvt_pk_bf16_f32 v172, v240, v241
 v_exp_f32 v243, v151
 v_exp_f32 v240, v152
 v_cvt_pk_bf16_f32 v173, v242, v243
 v_exp_f32 v241, v153
 v_exp_f32 v242, v154
 v_cvt_pk_bf16_f32 v174, v240, v241
 v_exp_f32 v243, v155
 v_exp_f32 v240, v156
 v_cvt_pk_bf16_f32 v175, v242, v243
 v_exp_f32 v241, v157
 v_exp_f32 v242, v158
 v_cvt_pk_bf16_f32 v176, v240, v241
 v_exp_f32 v243, v159
 v_exp_f32 v240, v160
 v_cvt_pk_bf16_f32 v177, v242, v243
 v_exp_f32 v241, v161
 v_exp_f32 v242, v162
 v_cvt_pk_bf16_f32 v178, v240, v241
 v_exp_f32 v243, v163
 s_nop 0
 v_cvt_pk_bf16_f32 v179, v242, v243
 v_add_f32 v194, v192, v193
 s_nop 1
 v_mfma_f32_16x16x32_bf16 v[188:191], v[248:251], v[172:175], v[192:195]
 v_mfma_f32_16x16x32_bf16 v[188:191], v[252:255], v[176:179], v[188:191]
 v_exp_f32 v240, v100
 v_exp_f32 v241, v101
 v_exp_f32 v242, v102
 v_cvt_pk_bf16_f32 v164, v240, v241
 v_exp_f32 v243, v103
 v_exp_f32 v240, v104
 v_cvt_pk_bf16_f32 v165, v242, v243
 v_exp_f32 v241, v105
 v_exp_f32 v242, v106
 v_cvt_pk_bf16_f32 v166, v240, v241
 v_exp_f32 v243, v107
 v_exp_f32 v240, v108
 s_nop 7
 s_branch KB_RET_B1A_1
KB_RARE_DB0A_0:
 v_max3_f32 v236, v100, v101, v102
 v_max3_f32 v235, v108, v109, v110
 v_max3_f32 v236, v236, v103, v104
 v_max3_f32 v235, v235, v111, v112
 v_max3_f32 v236, v236, v105, v106
 v_max3_f32 v235, v235, v113, v114
 v_max_f32 v236, v236, v107
 v_max_f32 v235, v235, v115
 v_mov_b32 v237, v236
 v_mov_b32 v240, v235
 s_nop 0
 v_permlane32_swap_b32 v236, v237
 v_permlane32_swap_b32 v235, v240
 v_max_f32 v236, v236, v237
 v_max_f32 v235, v235, v240
 v_mov_b32 v237, v236
 v_mov_b32 v240, v235
 s_nop 0
 v_permlane16_swap_b32 v236, v237
 v_permlane16_swap_b32 v235, v240
 v_max_f32 v236, v236, v237
 v_max_f32 v235, v235, v240
 v_max_f32 v237, 0, v236
 v_max_f32 v240, 0, v235
 v_exp_f32 v238, -v237
 v_exp_f32 v241, -v240
 v_sub_f32 v100, v100, v237
 v_sub_f32 v101, v101, v237
 v_sub_f32 v102, v102, v237
 v_sub_f32 v103, v103, v237
 v_sub_f32 v104, v104, v237
 v_sub_f32 v105, v105, v237
 v_sub_f32 v106, v106, v237
 v_sub_f32 v107, v107, v237
 v_sub_f32 v116, v116, v237
 v_sub_f32 v117, v117, v237
 v_sub_f32 v118, v118, v237
 v_sub_f32 v119, v119, v237
 v_sub_f32 v120, v120, v237
 v_sub_f32 v121, v121, v237
 v_sub_f32 v122, v122, v237
 v_sub_f32 v123, v123, v237
 v_mul_f32 v36, v36, v238
 v_mul_f32 v37, v37, v238
 v_mul_f32 v38, v38, v238
 v_mul_f32 v39, v39, v238
 v_mul_f32 v40, v40, v238
 v_mul_f32 v41, v41, v238
 v_mul_f32 v42, v42, v238
 v_mul_f32 v43, v43, v238
 v_mul_f32 v52, v52, v238
 v_mul_f32 v53, v53, v238
 v_mul_f32 v54, v54, v238
 v_mul_f32 v55, v55, v238
 v_mul_f32 v56, v56, v238
 v_mul_f32 v57, v57, v238
 v_mul_f32 v58, v58, v238
 v_mul_f32 v59, v59, v238
 v_mul_f32 v68, v68, v238
 v_mul_f32 v69, v69, v238
 v_mul_f32 v70, v70, v238
 v_mul_f32 v71, v71, v238
 v_mul_f32 v72, v72, v238
 v_mul_f32 v73, v73, v238
 v_mul_f32 v74, v74, v238
 v_mul_f32 v75, v75, v238
 v_mul_f32 v84, v84, v238
 v_mul_f32 v85, v85, v238
 v_mul_f32 v86, v86, v238
 v_mul_f32 v87, v87, v238
 v_mul_f32 v88, v88, v238
 v_mul_f32 v89, v89, v238
 v_mul_f32 v90, v90, v238
 v_mul_f32 v91, v91, v238
 v_mul_f32 v188, v188, v238
 v_sub_f32 v180, v180, v237
 v_sub_f32 v181, v181, v237
 v_sub_f32 v182, v182, v237
 v_sub_f32 v183, v183, v237
 v_sub_f32 v108, v108, v240
 v_sub_f32 v109, v109, v240
 v_sub_f32 v110, v110, v240
 v_sub_f32 v111, v111, v240
 v_sub_f32 v112, v112, v240
 v_sub_f32 v113, v113, v240
 v_sub_f32 v114, v114, v240
 v_sub_f32 v115, v115, v240
 v_sub_f32 v124, v124, v240
 v_sub_f32 v125, v125, v240
 v_sub_f32 v126, v126, v240
 v_sub_f32 v127, v127, v240
 v_sub_f32 v128, v128, v240
 v_sub_f32 v129, v129, v240
 v_sub_f32 v130, v130, v240
 v_sub_f32 v131, v131, v240
 v_mul_f32 v44, v44, v241
 v_mul_f32 v45, v45, v241
 v_mul_f32 v46, v46, v241
 v_mul_f32 v47, v47, v241
 v_mul_f32 v48, v48, v241
 v_mul_f32 v49, v49, v241
 v_mul_f32 v50, v50, v241
 v_mul_f32 v51, v51, v241
 v_mul_f32 v60, v60, v241
 v_mul_f32 v61, v61, v241
 v_mul_f32 v62, v62, v241
 v_mul_f32 v63, v63, v241
 v_mul_f32 v64, v64, v241
 v_mul_f32 v65, v65, v241
 v_mul_f32 v66, v66, v241
 v_mul_f32 v67, v67, v241
 v_mul_f32 v76, v76, v241
 v_mul_f32 v77, v77, v241
 v_mul_f32 v78, v78, v241
 v_mul_f32 v79, v79, v241
 v_mul_f32 v80, v80, v241
 v_mul_f32 v81, v81, v241
 v_mul_f32 v82, v82, v241
 v_mul_f32 v83, v83, v241
 v_mul_f32 v92, v92, v241
 v_mul_f32 v93, v93, v241
 v_mul_f32 v94, v94, v241
 v_mul_f32 v95, v95, v241
 v_mul_f32 v96, v96, v241
 v_mul_f32 v97, v97, v241
 v_mul_f32 v98, v98, v241
 v_mul_f32 v99, v99, v241
 v_mul_f32 v189, v189, v241
 v_sub_f32 v184, v184, v240
 v_sub_f32 v185, v185, v240
 v_sub_f32 v186, v186, v240
 v_sub_f32 v187, v187, v240
 v_exp_f32 v240, v100
 v_exp_f32 v241, v101
 v_exp_f32 v242, v102
 v_cvt_pk_bf16_f32 v164, v240, v241
 v_exp_f32 v243, v103
 v_exp_f32 v240, v104
 v_cvt_pk_bf16_f32 v165, v242, v243
 v_exp_f32 v241, v105
 v_exp_f32 v242, v106
 v_cvt_pk_bf16_f32 v166, v240, v241
 v_exp_f32 v243, v107
 v_exp_f32 v240, v108
 v_cvt_pk_bf16_f32 v167, v242, v243
 v_exp_f32 v241, v109
 v_exp_f32 v242, v110
 v_cvt_pk_bf16_f32 v168, v240, v241
 v_exp_f32 v243, v111
 v_exp_f32 v240, v112
 v_cvt_pk_bf16_f32 v169, v242, v243
 v_exp_f32 v241, v113
 v_exp_f32 v242, v114
 v_cvt_pk_bf16_f32 v170, v240, v241
 v_exp_f32 v243, v115
 s_nop 0
 v_cvt_pk_bf16_f32 v171, v242, v243
 v_add_f32 v190, v188, v189
 s_nop 1
 v_mfma_f32_16x16x32_bf16 v[192:195], v[248:251], v[164:167], v[188:191]
 v_mfma_f32_16x16x32_bf16 v[192:195], v[252:255], v[168:171], v[192:195]
 v_exp_f32 v240, v116
 v_exp_f32 v241, v117
 v_exp_f32 v242, v118
 v_cvt_pk_bf16_f32 v172, v240, v241
 v_exp_f32 v243, v119
 v_exp_f32 v240, v120
 v_cvt_pk_bf16_f32 v173, v242, v243
 v_exp_f32 v241, v121
 s_nop 7
 s_branch KB_RET_DB0A_0
KB_RARE_DB0A_1:
 v_max3_f32 v236, v116, v117, v118
 v_max3_f32 v235, v124, v125, v126
 v_max3_f32 v236, v236, v119, v120
 v_max3_f32 v235, v235, v127, v128
 v_max3_f32 v236, v236, v121, v122
 v_max3_f32 v235, v235, v129, v130
 v_max_f32 v236, v236, v123
 v_max_f32 v235, v235, v131
 v_mov_b32 v237, v236
 v_mov_b32 v240, v235
 s_nop 0
 v_permlane32_swap_b32 v236, v237
 v_permlane32_swap_b32 v235, v240
 v_max_f32 v236, v236, v237
 v_max_f32 v235, v235, v240
 v_mov_b32 v237, v236
 v_mov_b32 v240, v235
 s_nop 0
 v_permlane16_swap_b32 v236, v237
 v_permlane16_swap_b32 v235, v240
 v_max_f32 v236, v236, v237
 v_max_f32 v235, v235, v240
 v_max_f32 v237, 0, v236
 v_max_f32 v240, 0, v235
 v_exp_f32 v238, -v237
 v_exp_f32 v241, -v240
 v_sub_f32 v116, v116, v237
 v_sub_f32 v117, v117, v237
 v_sub_f32 v118, v118, v237
 v_sub_f32 v119, v119, v237
 v_sub_f32 v120, v120, v237
 v_sub_f32 v121, v121, v237
 v_sub_f32 v122, v122, v237
 v_sub_f32 v123, v123, v237
 v_mul_f32 v36, v36, v238
 v_mul_f32 v37, v37, v238
 v_mul_f32 v38, v38, v238
 v_mul_f32 v39, v39, v238
 v_mul_f32 v40, v40, v238
 v_mul_f32 v41, v41, v238
 v_mul_f32 v42, v42, v238
 v_mul_f32 v43, v43, v238
 v_mul_f32 v52, v52, v238
 v_mul_f32 v53, v53, v238
 v_mul_f32 v54, v54, v238
 v_mul_f32 v55, v55, v238
 v_mul_f32 v56, v56, v238
 v_mul_f32 v57, v57, v238
 v_mul_f32 v58, v58, v238
 v_mul_f32 v59, v59, v238
 v_mul_f32 v68, v68, v238
 v_mul_f32 v69, v69, v238
 v_mul_f32 v70, v70, v238
 v_mul_f32 v71, v71, v238
 v_mul_f32 v72, v72, v238
 v_mul_f32 v73, v73, v238
 v_mul_f32 v74, v74, v238
 v_mul_f32 v75, v75, v238
 v_mul_f32 v84, v84, v238
 v_mul_f32 v85, v85, v238
 v_mul_f32 v86, v86, v238
 v_mul_f32 v87, v87, v238
 v_mul_f32 v88, v88, v238
 v_mul_f32 v89, v89, v238
 v_mul_f32 v90, v90, v238
 v_mul_f32 v91, v91, v238
 v_mul_f32 v192, v192, v238
 v_sub_f32 v180, v180, v237
 v_sub_f32 v181, v181, v237
 v_sub_f32 v182, v182, v237
 v_sub_f32 v183, v183, v237
 v_sub_f32 v124, v124, v240
 v_sub_f32 v125, v125, v240
 v_sub_f32 v126, v126, v240
 v_sub_f32 v127, v127, v240
 v_sub_f32 v128, v128, v240
 v_sub_f32 v129, v129, v240
 v_sub_f32 v130, v130, v240
 v_sub_f32 v131, v131, v240
 v_mul_f32 v44, v44, v241
 v_mul_f32 v45, v45, v241
 v_mul_f32 v46, v46, v241
 v_mul_f32 v47, v47, v241
 v_mul_f32 v48, v48, v241
 v_mul_f32 v49, v49, v241
 v_mul_f32 v50, v50, v241
 v_mul_f32 v51, v51, v241
 v_mul_f32 v60, v60, v241
 v_mul_f32 v61, v61, v241
 v_mul_f32 v62, v62, v241
 v_mul_f32 v63, v63, v241
 v_mul_f32 v64, v64, v241
 v_mul_f32 v65, v65, v241
 v_mul_f32 v66, v66, v241
 v_mul_f32 v67, v67, v241
 v_mul_f32 v76, v76, v241
 v_mul_f32 v77, v77, v241
 v_mul_f32 v78, v78, v241
 v_mul_f32 v79, v79, v241
 v_mul_f32 v80, v80, v241
 v_mul_f32 v81, v81, v241
 v_mul_f32 v82, v82, v241
 v_mul_f32 v83, v83, v241
 v_mul_f32 v92, v92, v241
 v_mul_f32 v93, v93, v241
 v_mul_f32 v94, v94, v241
 v_mul_f32 v95, v95, v241
 v_mul_f32 v96, v96, v241
 v_mul_f32 v97, v97, v241
 v_mul_f32 v98, v98, v241
 v_mul_f32 v99, v99, v241
 v_mul_f32 v193, v193, v241
 v_sub_f32 v184, v184, v240
 v_sub_f32 v185, v185, v240
 v_sub_f32 v186, v186, v240
 v_sub_f32 v187, v187, v240
 v_exp_f32 v240, v116
 v_exp_f32 v241, v117
 v_exp_f32 v242, v118
 v_cvt_pk_bf16_f32 v172, v240, v241
 v_exp_f32 v243, v119
 v_exp_f32 v240, v120
 v_cvt_pk_bf16_f32 v173, v242, v243
 v_exp_f32 v241, v121
 v_exp_f32 v242, v122
 v_cvt_pk_bf16_f32 v174, v240, v241
 v_exp_f32 v243, v123
 v_exp_f32 v240, v124
 v_cvt_pk_bf16_f32 v175, v242, v243
 v_exp_f32 v241, v125
 v_exp_f32 v242, v126
 v_cvt_pk_bf16_f32 v176, v240, v241
 v_exp_f32 v243, v127
 v_exp_f32 v240, v128
 v_cvt_pk_bf16_f32 v177, v242, v243
 v_exp_f32 v241, v129
 v_exp_f32 v242, v130
 v_cvt_pk_bf16_f32 v178, v240, v241
 v_exp_f32 v243, v131
 s_nop 0
 v_cvt_pk_bf16_f32 v179, v242, v243
 v_add_f32 v194, v192, v193
 s_nop 1
 v_mfma_f32_16x16x32_bf16 v[188:191], v[248:251], v[172:175], v[192:195]
 v_mfma_f32_16x16x32_bf16 v[188:191], v[252:255], v[176:179], v[188:191]
 s_nop 7
 s_branch KB_RET_DB0A_1
KB_RARE_A1A_0:
 v_max3_f32 v236, v132, v133, v134
 v_max3_f32 v235, v140, v141, v142
 v_max3_f32 v236, v236, v135, v136
 v_max3_f32 v235, v235, v143, v144
 v_max3_f32 v236, v236, v137, v138
 v_max3_f32 v235, v235, v145, v146
 v_max_f32 v236, v236, v139
 v_max_f32 v235, v235, v147
 v_mov_b32 v237, v236
 v_mov_b32 v240, v235
 s_nop 0
 v_permlane32_swap_b32 v236, v237
 v_permlane32_swap_b32 v235, v240
 v_max_f32 v236, v236, v237
 v_max_f32 v235, v235, v240
 v_mov_b32 v237, v236
 v_mov_b32 v240, v235
 s_nop 0
 v_permlane16_swap_b32 v236, v237
 v_permlane16_swap_b32 v235, v240
 v_max_f32 v236, v236, v237
 v_max_f32 v235, v235, v240
 v_max_f32 v237, 0, v236
 v_max_f32 v240, 0, v235
 v_exp_f32 v238, -v237
 v_exp_f32 v241, -v240
 v_sub_f32 v132, v132, v237
 v_sub_f32 v133, v133, v237
 v_sub_f32 v134, v134, v237
 v_sub_f32 v135, v135, v237
 v_sub_f32 v136, v136, v237
 v_sub_f32 v137, v137, v237
 v_sub_f32 v138, v138, v237
 v_sub_f32 v139, v139, v237
 v_sub_f32 v148, v148, v237
 v_sub_f32 v149, v149, v237
 v_sub_f32 v150, v150, v237
 v_sub_f32 v151, v151, v237
 v_sub_f32 v152, v152, v237
 v_sub_f32 v153, v153, v237
 v_sub_f32 v154, v154, v237
 v_sub_f32 v155, v155, v237
 v_sub_f32 v100, v100, v237
 v_sub_f32 v101, v101, v237
 v_sub_f32 v102, v102, v237
 v_sub_f32 v103, v103, v237
 v_sub_f32 v104, v104, v237
 v_sub_f32 v105, v105, v237
 v_sub_f32 v106, v106, v237
 v_sub_f32 v107, v107, v237
 v_mul_f32 v36, v36, v238
 v_mul_f32 v37, v37, v238
 v_mul_f32 v38, v38, v238
 v_mul_f32 v39, v39, v238
 v_mul_f32 v40, v40, v238
 v_mul_f32 v41, v41, v238
 v_mul_f32 v42, v42, v238
 v_mul_f32 v43, v43, v238
 v_mul_f32 v52, v52, v238
 v_mul_f32 v53, v53, v238
 v_mul_f32 v54, v54, v238
 v_mul_f32 v55, v55, v238
 v_mul_f32 v56, v56, v238
 v_mul_f32 v57, v57, v238
 v_mul_f32 v58, v58, v238
 v_mul_f32 v59, v59, v238
 v_mul_f32 v68, v68, v238
 v_mul_f32 v69, v69, v238
 v_mul_f32 v70, v70, v238
 v_mul_f32 v71, v71, v238
 v_mul_f32 v72, v72, v238
 v_mul_f32 v73, v73, v238
 v_mul_f32 v74, v74, v238
 v_mul_f32 v75, v75, v238
 v_mul_f32 v84, v84, v238
 v_mul_f32 v85, v85, v238
 v_mul_f32 v86, v86, v238
 v_mul_f32 v87, v87, v238
 v_mul_f32 v88, v88, v238
 v_mul_f32 v89, v89, v238
 v_mul_f32 v90, v90, v238
 v_mul_f32 v91, v91, v238
 v_mul_f32 v188, v188, v238
 v_sub_f32 v180, v180, v237
 v_sub_f32 v181, v181, v237
 v_sub_f32 v182, v182, v237
 v_sub_f32 v183, v183, v237
 v_sub_f32 v140, v140, v240
 v_sub_f32 v141, v141, v240
 v_sub_f32 v142, v142, v240
 v_sub_f32 v143, v143, v240
 v_sub_f32 v144, v144, v240
 v_sub_f32 v145, v145, v240
 v_sub_f32 v146, v146, v240
 v_sub_f32 v147, v147, v240
 v_sub_f32 v156, v156, v240
 v_sub_f32 v157, v157, v240
 v_sub_f32 v158, v158, v240
 v_sub_f32 v159, v159, v240
 v_sub_f32 v160, v160, v240
 v_sub_f32 v161, v161, v240
 v_sub_f32 v162, v162, v240
 v_sub_f32 v163, v163, v240
 v_sub_f32 v108, v108, v240
 v_sub_f32 v109, v109, v240
 v_sub_f32 v110, v110, v240
 v_sub_f32 v111, v111, v240
 v_sub_f32 v112, v112, v240
 v_sub_f32 v113, v113, v240
 v_sub_f32 v114, v114, v240
 v_sub_f32 v115, v115, v240
 v_mul_f32 v44, v44, v241
 v_mul_f32 v45, v45, v241
 v_mul_f32 v46, v46, v241
 v_mul_f32 v47, v47, v241
 v_mul_f32 v48, v48, v241
 v_mul_f32 v49, v49, v241
 v_mul_f32 v50, v50, v241
 v_mul_f32 v51, v51, v241
 v_mul_f32 v60, v60, v241
 v_mul_f32 v61, v61, v241
 v_mul_f32 v62, v62, v241
 v_mul_f32 v63, v63, v241
 v_mul_f32 v64, v64, v241
 v_mul_f32 v65, v65, v241
 v_mul_f32 v66, v66, v241
 v_mul_f32 v67, v67, v241
 v_mul_f32 v76, v76, v241
 v_mul_f32 v77, v77, v241
 v_mul_f32 v78, v78, v241
 v_mul_f32 v79, v79, v241
 v_mul_f32 v80, v80, v241
 v_mul_f32 v81, v81, v241
 v_mul_f32 v82, v82, v241
 v_mul_f32 v83, v83, v241
 v_mul_f32 v92, v92, v241
 v_mul_f32 v93, v93, v241
 v_mul_f32 v94, v94, v241
 v_mul_f32 v95, v95, v241
 v_mul_f32 v96, v96, v241
 v_mul_f32 v97, v97, v241
 v_mul_f32 v98, v98, v241
 v_mul_f32 v99, v99, v241
 v_mul_f32 v189, v189, v241
 v_sub_f32 v184, v184, v240
 v_sub_f32 v185, v185, v240
 v_sub_f32 v186, v186, v240
 v_sub_f32 v187, v187, v240
 v_exp_f32 v240, v132
 v_exp_f32 v241, v133
 v_exp_f32 v242, v134
 v_cvt_pk_bf16_f32 v164, v240, v241
 v_exp_f32 v243, v135
 v_exp_f32 v240, v136
 v_cvt_pk_bf16_f32 v165, v242, v243
 v_exp_f32 v241, v137
 v_exp_f32 v242, v138
 v_cvt_pk_bf16_f32 v166, v240, v241
 v_exp_f32 v243, v139
 v_exp_f32 v240, v140
 v_cvt_pk_bf16_f32 v167, v242, v243
 v_exp_f32 v241, v141
 v_exp_f32 v242, v142
 v_cvt_pk_bf16_f32 v168, v240, v241
 v_exp_f32 v243, v143
 v_exp_f32 v240, v144
 v_cvt_pk_bf16_f32 v169, v242, v243
 v_exp_f32 v241, v145
 v_exp_f32 v242, v146
 v_cvt_pk_bf16_f32 v170, v240, v241
 v_exp_f32 v243, v147
 s_nop 0
 v_cvt_pk_bf16_f32 v171, v242, v243
 v_add_f32 v190, v188, v189
 s_nop 1
 v_mfma_f32_16x16x32_bf16 v[192:195], v[248:251], v[164:167], v[188:191]
 v_mfma_f32_16x16x32_bf16 v[192:195], v[252:255], v[168:171], v[192:195]
 v_exp_f32 v240, v148
 v_exp_f32 v241, v149
 v_exp_f32 v242, v150
 v_cvt_pk_bf16_f32 v172, v240, v241
 v_exp_f32 v243, v151
 v_exp_f32 v240, v152
 v_cvt_pk_bf16_f32 v173, v242, v243
 s_nop 7
 s_branch KB_RET_A1A_0
KB_RARE_A1A_1:
 v_max3_f32 v236, v148, v149, v150
 v_max3_f32 v235, v156, v157, v158
 v_max3_f32 v236, v236, v151, v152
 v_max3_f32 v235, v235, v159, v160
 v_max3_f32 v236, v236, v153, v154
 v_max3_f32 v235, v235, v161, v162
 v_max_f32 v236, v236, v155
 v_max_f32 v235, v235, v163
 v_mov_b32 v237, v236
 v_mov_b32 v240, v235
 s_nop 0
 v_permlane32_swap_b32 v236, v237
 v_permlane32_swap_b32 v235, v240
 v_max_f32 v236, v236, v237
 v_max_f32 v235, v235, v240
 v_mov_b32 v237, v236
 v_mov_b32 v240, v235
 s_nop 0
 v_permlane16_swap_b32 v236, v237
 v_permlane16_swap_b32 v235, v240
 v_max_f32 v236, v236, v237
 v_max_f32 v235, v235, v240
 v_max_f32 v237, 0, v236
 v_max_f32 v240, 0, v235
 v_exp_f32 v238, -v237
 v_exp_f32 v241, -v240
 v_sub_f32 v148, v148, v237
 v_sub_f32 v149, v149, v237
 v_sub_f32 v150, v150, v237
 v_sub_f32 v151, v151, v237
 v_sub_f32 v152, v152, v237
 v_sub_f32 v153, v153, v237
 v_sub_f32 v154, v154, v237
 v_sub_f32 v155, v155, v237
 v_sub_f32 v100, v100, v237
 v_sub_f32 v101, v101, v237
 v_sub_f32 v102, v102, v237
 v_sub_f32 v103, v103, v237
 v_sub_f32 v104, v104, v237
 v_sub_f32 v105, v105, v237
 v_sub_f32 v106, v106, v237
 v_sub_f32 v107, v107, v237
 v_mul_f32 v36, v36, v238
 v_mul_f32 v37, v37, v238
 v_mul_f32 v38, v38, v238
 v_mul_f32 v39, v39, v238
 v_mul_f32 v40, v40, v238
 v_mul_f32 v41, v41, v238
 v_mul_f32 v42, v42, v238
 v_mul_f32 v43, v43, v238
 v_mul_f32 v52, v52, v238
 v_mul_f32 v53, v53, v238
 v_mul_f32 v54, v54, v238
 v_mul_f32 v55, v55, v238
 v_mul_f32 v56, v56, v238
 v_mul_f32 v57, v57, v238
 v_mul_f32 v58, v58, v238
 v_mul_f32 v59, v59, v238
 v_mul_f32 v68, v68, v238
 v_mul_f32 v69, v69, v238
 v_mul_f32 v70, v70, v238
 v_mul_f32 v71, v71, v238
 v_mul_f32 v72, v72, v238
 v_mul_f32 v73, v73, v238
 v_mul_f32 v74, v74, v238
 v_mul_f32 v75, v75, v238
 v_mul_f32 v84, v84, v238
 v_mul_f32 v85, v85, v238
 v_mul_f32 v86, v86, v238
 v_mul_f32 v87, v87, v238
 v_mul_f32 v88, v88, v238
 v_mul_f32 v89, v89, v238
 v_mul_f32 v90, v90, v238
 v_mul_f32 v91, v91, v238
 v_mul_f32 v192, v192, v238
 v_sub_f32 v180, v180, v237
 v_sub_f32 v181, v181, v237
 v_sub_f32 v182, v182, v237
 v_sub_f32 v183, v183, v237
 v_sub_f32 v156, v156, v240
 v_sub_f32 v157, v157, v240
 v_sub_f32 v158, v158, v240
 v_sub_f32 v159, v159, v240
 v_sub_f32 v160, v160, v240
 v_sub_f32 v161, v161, v240
 v_sub_f32 v162, v162, v240
 v_sub_f32 v163, v163, v240
 v_sub_f32 v108, v108, v240
 v_sub_f32 v109, v109, v240
 v_sub_f32 v110, v110, v240
 v_sub_f32 v111, v111, v240
 v_sub_f32 v112, v112, v240
 v_sub_f32 v113, v113, v240
 v_sub_f32 v114, v114, v240
 v_sub_f32 v115, v115, v240
 v_mul_f32 v44, v44, v241
 v_mul_f32 v45, v45, v241
 v_mul_f32 v46, v46, v241
 v_mul_f32 v47, v47, v241
 v_mul_f32 v48, v48, v241
 v_mul_f32 v49, v49, v241
 v_mul_f32 v50, v50, v241
 v_mul_f32 v51, v51, v241
 v_mul_f32 v60, v60, v241
 v_mul_f32 v61, v61, v241
 v_mul_f32 v62, v62, v241
 v_mul_f32 v63, v63, v241
 v_mul_f32 v64, v64, v241
 v_mul_f32 v65, v65, v241
 v_mul_f32 v66, v66, v241
 v_mul_f32 v67, v67, v241
 v_mul_f32 v76, v76, v241
 v_mul_f32 v77, v77, v241
 v_mul_f32 v78, v78, v241
 v_mul_f32 v79, v79, v241
 v_mul_f32 v80, v80, v241
 v_mul_f32 v81, v81, v241
 v_mul_f32 v82, v82, v241
 v_mul_f32 v83, v83, v241
 v_mul_f32 v92, v92, v241
 v_mul_f32 v93, v93, v241
 v_mul_f32 v94, v94, v241
 v_mul_f32 v95, v95, v241
 v_mul_f32 v96, v96, v241
 v_mul_f32 v97, v97, v241
 v_mul_f32 v98, v98, v241
 v_mul_f32 v99, v99, v241
 v_mul_f32 v193, v193, v241
 v_sub_f32 v184, v184, v240
 v_sub_f32 v185, v185, v240
 v_sub_f32 v186, v186, v240
 v_sub_f32 v187, v187, v240
 v_exp_f32 v240, v148
 v_exp_f32 v241, v149
 v_exp_f32 v242, v150
 v_cvt_pk_bf16_f32 v172, v240, v241
 v_exp_f32 v243, v151
 v_exp_f32 v240, v152
 v_cvt_pk_bf16_f32 v173, v242, v243
 v_exp_f32 v241, v153
 v_exp_f32 v242, v154
 v_cvt_pk_bf16_f32 v174, v240, v241
 v_exp_f32 v243, v155
 v_exp_f32 v240, v156
 v_cvt_pk_bf16_f32 v175, v242, v243
 v_exp_f32 v241, v157
 v_exp_f32 v242, v158
 v_cvt_pk_bf16_f32 v176, v240, v241
 v_exp_f32 v243, v159
 v_exp_f32 v240, v160
 v_cvt_pk_bf16_f32 v177, v242, v243
 v_exp_f32 v241, v161
 v_exp_f32 v242, v162
 v_cvt_pk_bf16_f32 v178, v240, v241
 v_exp_f32 v243, v163
 s_nop 0
 v_cvt_pk_bf16_f32 v179, v242, v243
 v_add_f32 v194, v192, v193
 s_nop 1
 v_mfma_f32_16x16x32_bf16 v[188:191], v[248:251], v[172:175], v[192:195]
 v_mfma_f32_16x16x32_bf16 v[188:191], v[252:255], v[176:179], v[188:191]
 v_cmp_gt_i32 s[44:45], 0, v245
 v_cmp_gt_i32 s[46:47], 1, v245
 v_cmp_gt_i32 s[48:49], 2, v245
 v_cmp_gt_i32 s[50:51], 3, v245
 v_cndmask_b32 v100, v100, v246, s[44:45]
 v_cndmask_b32 v101, v101, v246, s[46:47]
 v_cndmask_b32 v102, v102, v246, s[48:49]
 v_cndmask_b32 v103, v103, v246, s[50:51]
 s_nop 7
 s_branch KB_RET_A1A_1
KB_RARE_DA0A_0:
 v_max3_f32 v236, v100, v101, v102
 v_max3_f32 v235, v108, v109, v110
 v_max3_f32 v236, v236, v103, v104
 v_max3_f32 v235, v235, v111, v112
 v_max3_f32 v236, v236, v105, v106
 v_max3_f32 v235, v235, v113, v114
 v_max_f32 v236, v236, v107
 v_max_f32 v235, v235, v115
 v_mov_b32 v237, v236
 v_mov_b32 v240, v235
 s_nop 0
 v_permlane32_swap_b32 v236, v237
 v_permlane32_swap_b32 v235, v240
 v_max_f32 v236, v236, v237
 v_max_f32 v235, v235, v240
 v_mov_b32 v237, v236
 v_mov_b32 v240, v235
 s_nop 0
 v_permlane16_swap_b32 v236, v237
 v_permlane16_swap_b32 v235, v240
 v_max_f32 v236, v236, v237
 v_max_f32 v235, v235, v240
 v_max_f32 v237, 0, v236
 v_max_f32 v240, 0, v235
 v_exp_f32 v238, -v237
 v_exp_f32 v241, -v240
 v_sub_f32 v100, v100, v237
 v_sub_f32 v101, v101, v237
 v_sub_f32 v102, v102, v237
 v_sub_f32 v103, v103, v237
 v_sub_f32 v104, v104, v237
 v_sub_f32 v105, v105, v237
 v_sub_f32 v106, v106, v237
 v_sub_f32 v107, v107, v237
 v_mul_f32 v36, v36, v238
 v_mul_f32 v37, v37, v238
 v_mul_f32 v38, v38, v238
 v_mul_f32 v39, v39, v238
 v_mul_f32 v40, v40, v238
 v_mul_f32 v41, v41, v238
 v_mul_f32 v42, v42, v238
 v_mul_f32 v43, v43, v238
 v_mul_f32 v52, v52, v238
 v_mul_f32 v53, v53, v238
 v_mul_f32 v54, v54, v238
 v_mul_f32 v55, v55, v238
 v_mul_f32 v56, v56, v238
 v_mul_f32 v57, v57, v238
 v_mul_f32 v58, v58, v238
 v_mul_f32 v59, v59, v238
 v_mul_f32 v68, v68, v238
 v_mul_f32 v69, v69, v238
 v_mul_f32 v70, v70, v238
 v_mul_f32 v71, v71, v238
 v_mul_f32 v72, v72, v238
 v_mul_f32 v73, v73, v238
 v_mul_f32 v74, v74, v238
 v_mul_f32 v75, v75, v238
 v_mul_f32 v84, v84, v238
 v_mul_f32 v85, v85, v238
 v_mul_f32 v86, v86, v238
 v_mul_f32 v87, v87, v238
 v_mul_f32 v88, v88, v238
 v_mul_f32 v89, v89, v238
 v_mul_f32 v90, v90, v238
 v_mul_f32 v91, v91, v238
 v_mul_f32 v188, v188, v238
 v_sub_f32 v180, v180, v237
 v_sub_f32 v181, v181, v237
 v_sub_f32 v182, v182, v237
 v_sub_f32 v183, v183, v237
 v_sub_f32 v108, v108, v240
 v_sub_f32 v109, v109, v240
 v_sub_f32 v110, v110, v240
 v_sub_f32 v111, v111, v240
 v_sub_f32 v112, v112, v240
 v_sub_f32 v113, v113, v240
 v_sub_f32 v114, v114, v240
 v_sub_f32 v115, v115, v240
 v_mul_f32 v44, v44, v241
 v_mul_f32 v45, v45, v241
 v_mul_f32 v46, v46, v241
 v_mul_f32 v47, v47, v241
 v_mul_f32 v48, v48, v241
 v_mul_f32 v49, v49, v241
 v_mul_f32 v50, v50, v241
 v_mul_f32 v51, v51, v241
 v_mul_f32 v60, v60, v241
 v_mul_f32 v61, v61, v241
 v_mul_f32 v62, v62, v241
 v_mul_f32 v63, v63, v241
 v_mul_f32 v64, v64, v241
 v_mul_f32 v65, v65, v241
 v_mul_f32 v66, v66, v241
 v_mul_f32 v67, v67, v241
 v_mul_f32 v76, v76, v241
 v_mul_f32 v77, v77, v241
 v_mul_f32 v78, v78, v241
 v_mul_f32 v79, v79, v241
 v_mul_f32 v80, v80, v241
 v_mul_f32 v81, v81, v241
 v_mul_f32 v82, v82, v241
 v_mul_f32 v83, v83, v241
 v_mul_f32 v92, v92, v241
 v_mul_f32 v93, v93, v241
 v_mul_f32 v94, v94, v241
 v_mul_f32 v95, v95, v241
 v_mul_f32 v96, v96, v241
 v_mul_f32 v97, v97, v241
 v_mul_f32 v98, v98, v241
 v_mul_f32 v99, v99, v241
 v_mul_f32 v189, v189, v241
 v_sub_f32 v184, v184, v240
 v_sub_f32 v185, v185, v240
 v_sub_f32 v186, v186, v240
 v_sub_f32 v187, v187, v240
 v_exp_f32 v240, v100
 v_exp_f32 v241, v101
 v_exp_f32 v242, v102
 v_cvt_pk_bf16_f32 v164, v240, v241
 v_exp_f32 v243, v103
 v_exp_f32 v240, v104
 v_cvt_pk_bf16_f32 v165, v242, v243
 v_exp_f32 v241, v105
 v_exp_f32 v242, v106
 v_cvt_pk_bf16_f32 v166, v240, v241
 v_exp_f32 v243, v107
 v_exp_f32 v240, v108
 v_cvt_pk_bf16_f32 v167, v242, v243
 v_exp_f32 v241, v109
 v_exp_f32 v242, v110
 v_cvt_pk_bf16_f32 v168, v240, v241
 v_exp_f32 v243, v111
 v_exp_f32 v240, v112
 v_cvt_pk_bf16_f32 v169, v242, v243
 v_exp_f32 v241, v113
 v_exp_f32 v242, v114
 v_cvt_pk_bf16_f32 v170, v240, v241
 v_exp_f32 v243, v115
 s_nop 0
 v_cvt_pk_bf16_f32 v171, v242, v243
 v_add_f32 v190, v188, v189
 s_nop 1
 v_mfma_f32_16x16x32_bf16 v[192:195], v[248:251], v[164:167], v[188:191]
 v_mfma_f32_16x16x32_bf16 v[192:195], v[252:255], v[168:171], v[192:195]
 s_nop 7
 s_branch KB_RET_DA0A_0
KB_LOADER:
 v_and_b32 v232, 7, v0
 v_mul_u32_u24 v232, 260, v232
 v_add_u32 v232, 155648, v232
 v_add_u32 v236, 1, v239
 s_cmp_ge_u32 s32, s29
 s_cbranch_scc0 KB_LC0
 s_waitcnt vmcnt(8)
 ds_write_b32 v244, v236 offset:1024
 s_branch KB_LT0
KB_LC0:
KB_LPOLLK0:
 ds_read_b32 v238, v232 offset:3072
 s_waitcnt lgkmcnt(0)
 v_cmp_lt_u32 vcc, v238, v239
 s_cbranch_vccz KB_LGOK0
 s_sleep 2
 s_branch KB_LPOLLK0
KB_LGOK0:
 s_mov_b32 m0, s35
 s_nop 0
 buffer_load_dwordx4 v197, s[12:15], s31 offen offset:0 sc1 lds
 buffer_load_dwordx4 v197, s[12:15], s31 offen offset:1024 sc1 lds
 buffer_load_dwordx4 v197, s[12:15], s31 offen offset:2048 sc1 lds
 buffer_load_dwordx4 v197, s[12:15], s31 offen offset:3072 sc1 lds
 s_add_u32 s31, s31, 16384
 s_add_u32 s35, s35, 32768
 s_and_b32 s35, s35, 0x1ffff
 s_waitcnt vmcnt(12)
 ds_write_b32 v244, v236 offset:1024
KB_LPOLLV0:
 ds_read_b32 v238, v232 offset:0
 s_waitcnt lgkmcnt(0)
 v_cmp_lt_u32 vcc, v238, v239
 s_cbranch_vccz KB_LGOV0
 s_sleep 2
 s_branch KB_LPOLLV0
KB_LGOV0:
 s_mov_b32 m0, s36
 s_nop 0
 buffer_load_dwordx4 v197, s[16:19], s33 offen offset:0 sc1 lds
 buffer_load_dwordx4 v197, s[16:19], s33 offen offset:1024 sc1 lds
 buffer_load_dwordx4 v197, s[16:19], s33 offen offset:2048 sc1 lds
 buffer_load_dwordx4 v197, s[16:19], s33 offen offset:3072 sc1 lds
 s_add_u32 s33, s33, 16384
 s_add_u32 s36, s36, 32768
 s_and_b32 s36, s36, 0x1ffff
 s_add_u32 s32, s32, 1
 v_mov_b32 v239, v236
 s_waitcnt vmcnt(8)
 s_branch KB_LT
KB_LT0:
 s_waitcnt vmcnt(0)
KB_LT:
 v_mov_b32 v242, s90
 v_mov_b32 v243, s91
 s_mov_b64 exec, 1
 buffer_store_dwordx2 v[242:243], off, s[96:99], s89 sc1
 s_mov_b64 exec, -1
 s_load_dwordx2 s[6:7], s[0:1], 40
 s_load_dwordx2 s[52:53], s[0:1], 64
 s_lshl_b32 s41, s2, 14
 s_add_u32 s41, s41, s40
 s_lshl_b32 s42, s2, 13
 s_lshl_b32 s3, s24, 11
 s_add_u32 s42, s42, s3
 v_lshlrev_b32 v237, 4, v0
 s_waitcnt lgkmcnt(0)
 s_mov_b32 s56, s6
 s_and_b32 s57, s7, 0xffff
 s_mov_b32 s58, 0x400000
 s_mov_b32 s59, 0x00020000
 buffer_load_dwordx4 v[200:203], v237, s[56:59], s41 offen offset:0
 buffer_load_dwordx4 v[200:203], v237, s[56:59], s41 offen offset:1024
 buffer_load_dwordx4 v[200:203], v237, s[56:59], s41 offen offset:2048
 buffer_load_dwordx4 v[200:203], v237, s[56:59], s41 offen offset:3072
 s_mov_b32 s60, s52
 s_and_b32 s61, s53, 0xffff
 s_mov_b32 s62, 0x158000
 s_mov_b32 s63, 0x00020000
 buffer_load_dwordx4 v[200:203], v237, s[60:63], s42 offen offset:0
 buffer_load_dwordx4 v[200:203], v237, s[60:63], s42 offen offset:1024
 v_add_u32 v236, 1, v239
 s_cmp_ge_u32 s32, s29
 s_cbranch_scc0 KB_LC1
 s_waitcnt vmcnt(7)
 ds_write_b32 v244, v236 offset:1024
 s_branch KB_LEND
KB_LC1:
KB_LPOLLK1:
 ds_read_b32 v238, v232 offset:3072
 s_waitcnt lgkmcnt(0)
 v_cmp_lt_u32 vcc, v238, v239
 s_cbranch_vccz KB_LGOK1
 s_sleep 2
 s_branch KB_LPOLLK1
KB_LGOK1:
 s_mov_b32 m0, s35
 s_nop 0
 buffer_load_dwordx4 v197, s[12:15], s31 offen offset:0 sc1 lds
 buffer_load_dwordx4 v197, s[12:15], s31 offen offset:1024 sc1 lds
 buffer_load_dwordx4 v197, s[12:15], s31 offen offset:2048 sc1 lds
 buffer_load_dwordx4 v197, s[12:15], s31 offen offset:3072 sc1 lds
 s_add_u32 s31, s31, 16384
 s_add_u32 s35, s35, 32768
 s_and_b32 s35, s35, 0x1ffff
 s_waitcnt vmcnt(11)
 ds_write_b32 v244, v236 offset:1024
KB_LPOLLV1:
 ds_read_b32 v238, v232 offset:0
 s_waitcnt lgkmcnt(0)
 v_cmp_lt_u32 vcc, v238, v239
 s_cbranch_vccz KB_LGOV1
 s_sleep 2
 s_branch KB_LPOLLV1
KB_LGOV1:
 s_mov_b32 m0, s36
 s_nop 0
 buffer_load_dwordx4 v197, s[16:19], s33 offen offset:0 sc1 lds
 buffer_load_dwordx4 v197, s[16:19], s33 offen offset:1024 sc1 lds
 buffer_load_dwordx4 v197, s[16:19], s33 offen offset:2048 sc1 lds
 buffer_load_dwordx4 v197, s[16:19], s33 offen offset:3072 sc1 lds
 s_add_u32 s33, s33, 16384
 s_add_u32 s36, s36, 32768
 s_and_b32 s36, s36, 0x1ffff
 s_add_u32 s32, s32, 1
 v_mov_b32 v239, v236
 s_sub_u32 s41, s55, 4
 s_or_b32 s41, s41, s43
 s_or_b32 s41, s41, s88
 s_cmp_eq_u32 s41, 0
 s_cselect_b32 s30, 24, -1
KB_LLOOP:
 v_add_u32 v236, 1, v239
 s_cmp_ge_u32 s32, s29
 s_cbranch_scc0 KB_LC2
 s_waitcnt vmcnt(0)
 ds_write_b32 v244, v236 offset:1024
 s_branch KB_LEND
KB_LC2:
KB_LPOLLK2:
 ds_read_b32 v238, v232 offset:3072
 s_waitcnt lgkmcnt(0)
 v_cmp_lt_u32 vcc, v238, v239
 s_cbranch_vccz KB_LGOK2
 s_sleep 2
 s_branch KB_LPOLLK2
KB_LGOK2:
 s_mov_b32 m0, s35
 s_nop 0
 buffer_load_dwordx4 v197, s[12:15], s31 offen offset:0 sc1 lds
 buffer_load_dwordx4 v197, s[12:15], s31 offen offset:1024 sc1 lds
 buffer_load_dwordx4 v197, s[12:15], s31 offen offset:2048 sc1 lds
 buffer_load_dwordx4 v197, s[12:15], s31 offen offset:3072 sc1 lds
 s_add_u32 s31, s31, 16384
 s_add_u32 s35, s35, 32768
 s_and_b32 s35, s35, 0x1ffff
 s_waitcnt vmcnt(4)
 ds_write_b32 v244, v236 offset:1024
KB_LPOLLV2:
 ds_read_b32 v238, v232 offset:0
 s_waitcnt lgkmcnt(0)
 v_cmp_lt_u32 vcc, v238, v239
 s_cbranch_vccz KB_LGOV2
 s_sleep 2
 s_branch KB_LPOLLV2
KB_LGOV2:
 s_mov_b32 m0, s36
 s_nop 0
 buffer_load_dwordx4 v197, s[16:19], s33 offen offset:0 sc1 lds
 buffer_load_dwordx4 v197, s[16:19], s33 offen offset:1024 sc1 lds
 buffer_load_dwordx4 v197, s[16:19], s33 offen offset:2048 sc1 lds
 buffer_load_dwordx4 v197, s[16:19], s33 offen offset:3072 sc1 lds
 s_add_u32 s33, s33, 16384
 s_add_u32 s36, s36, 32768
 s_and_b32 s36, s36, 0x1ffff
 s_add_u32 s32, s32, 1
 v_mov_b32 v239, v236
 s_cmp_eq_u32 s32, s30
 s_cbranch_scc0 KB_LLOOP
 s_mov_b32 s84, s82
 s_and_b32 s85, s83, 0xffff
 s_mov_b32 s86, 0x100
 s_mov_b32 s87, 0x00020000
 s_and_b32 s46, s93, 1
 s_lshl_b32 s46, s46, 2
 buffer_load_dword v164, off, s[84:87], s46 offset:16 sc1
 v_add_u32 v236, 1, v239
 s_cmp_ge_u32 s32, s29
 s_cbranch_scc0 KB_LC3
 s_waitcnt vmcnt(0)
 ds_write_b32 v244, v236 offset:1024
 s_branch KB_LEND
KB_LC3:
KB_LPOLLK3:
 ds_read_b32 v238, v232 offset:3072
 s_waitcnt lgkmcnt(0)
 v_cmp_lt_u32 vcc, v238, v239
 s_cbranch_vccz KB_LGOK3
 s_sleep 2
 s_branch KB_LPOLLK3
KB_LGOK3:
 s_mov_b32 m0, s35
 s_nop 0
 buffer_load_dwordx4 v197, s[12:15], s31 offen offset:0 sc1 lds
 buffer_load_dwordx4 v197, s[12:15], s31 offen offset:1024 sc1 lds
 buffer_load_dwordx4 v197, s[12:15], s31 offen offset:2048 sc1 lds
 buffer_load_dwordx4 v197, s[12:15], s31 offen offset:3072 sc1 lds
 s_add_u32 s31, s31, 16384
 s_add_u32 s35, s35, 32768
 s_and_b32 s35, s35, 0x1ffff
 s_waitcnt vmcnt(4)
 ds_write_b32 v244, v236 offset:1024
KB_LPOLLV3:
 ds_read_b32 v238, v232 offset:0
 s_waitcnt lgkmcnt(0)
 v_cmp_lt_u32 vcc, v238, v239
 s_cbranch_vccz KB_LGOV3
 s_sleep 2
 s_branch KB_LPOLLV3
KB_LGOV3:
 s_mov_b32 m0, s36
 s_nop 0
 buffer_load_dwordx4 v197, s[16:19], s33 offen offset:0 sc1 lds
 buffer_load_dwordx4 v197, s[16:19], s33 offen offset:1024 sc1 lds
 buffer_load_dwordx4 v197, s[16:19], s33 offen offset:2048 sc1 lds
 buffer_load_dwordx4 v197, s[16:19], s33 offen offset:3072 sc1 lds
 s_add_u32 s33, s33, 16384
 s_add_u32 s36, s36, 32768
 s_and_b32 s36, s36, 0x1ffff
 s_add_u32 s32, s32, 1
 v_mov_b32 v239, v236
 v_readfirstlane_b32 s44, v164
C_CLT:
 s_bfe_u32 s46, s93, 0x20001
 s_lshl_b32 s46, s46, 2
 s_add_u32 s46, s46, 4
 s_lshr_b32 s45, s44, s46
 s_and_b32 s45, s45, 15
 s_cbranch_scc1 C_CDT
 s_and_b32 s45, s44, 15
 s_add_u32 s45, s45, 1
 s_lshl_b32 s45, s45, s46
 s_add_u32 s45, s45, s44
 s_add_u32 s45, s45, 1
 v_mov_b32 v166, s45
 v_mov_b32 v167, s44
 s_and_b32 s46, s93, 1
 s_lshl_b32 s46, s46, 2
 s_mov_b64 exec, 1
 buffer_atomic_cmpswap v[166:167], off, s[84:87], s46 offset:16 sc0
 s_mov_b64 exec, -1
 v_add_u32 v236, 1, v239
 s_cmp_ge_u32 s32, s29
 s_cbranch_scc0 KB_LC4
 s_waitcnt vmcnt(0)
 ds_write_b32 v244, v236 offset:1024
 s_branch KB_LEND
KB_LC4:
KB_LPOLLK4:
 ds_read_b32 v238, v232 offset:3072
 s_waitcnt lgkmcnt(0)
 v_cmp_lt_u32 vcc, v238, v239
 s_cbranch_vccz KB_LGOK4
 s_sleep 2
 s_branch KB_LPOLLK4
KB_LGOK4:
 s_mov_b32 m0, s35
 s_nop 0
 buffer_load_dwordx4 v197, s[12:15], s31 offen offset:0 sc1 lds
 buffer_load_dwordx4 v197, s[12:15], s31 offen offset:1024 sc1 lds
 buffer_load_dwordx4 v197, s[12:15], s31 offen offset:2048 sc1 lds
 buffer_load_dwordx4 v197, s[12:15], s31 offen offset:3072 sc1 lds
 s_add_u32 s31, s31, 16384
 s_add_u32 s35, s35, 32768
 s_and_b32 s35, s35, 0x1ffff
 s_waitcnt vmcnt(4)
 ds_write_b32 v244, v236 offset:1024
KB_LPOLLV4:
 ds_read_b32 v238, v232 offset:0
 s_waitcnt lgkmcnt(0)
 v_cmp_lt_u32 vcc, v238, v239
 s_cbranch_vccz KB_LGOV4
 s_sleep 2
 s_branch KB_LPOLLV4
KB_LGOV4:
 s_mov_b32 m0, s36
 s_nop 0
 buffer_load_dwordx4 v197, s[16:19], s33 offen offset:0 sc1 lds
 buffer_load_dwordx4 v197, s[16:19], s33 offen offset:1024 sc1 lds
 buffer_load_dwordx4 v197, s[16:19], s33 offen offset:2048 sc1 lds
 buffer_load_dwordx4 v197, s[16:19], s33 offen offset:3072 sc1 lds
 s_add_u32 s33, s33, 16384
 s_add_u32 s36, s36, 32768
 s_and_b32 s36, s36, 0x1ffff
 s_add_u32 s32, s32, 1
 v_mov_b32 v239, v236
 v_readfirstlane_b32 s46, v166
 s_cmp_eq_u32 s46, s44
 s_cselect_b32 s44, s45, s46
 s_branch C_CLT
C_CDT:
 s_sub_u32 s45, s45, 1
 s_branch KB_LLOOP
KB_LEND:
 s_cmp_lg_u32 s88, 0
 s_cbranch_scc1 KB_JOBN
 s_sub_u32 s41, s29, 2
 v_mov_b32 v239, s41
 s_and_b32 s39, s93, 1
 s_lshl_b32 s39, s39, 3
 s_bfe_u32 s32, s93, 0x30005
 s_add_u32 s32, s32, s39
 s_bfe_u32 s33, s93, 0x20003
 s_lshr_b32 s34, s55, 2
 s_and_b32 s35, s55, 3
 s_lshl_b32 s38, s55, 12
 s_and_b32 s39, s29, 2
 s_lshl_b32 s39, s39, 15
 s_add_u32 s66, s38, s39
 s_xor_b32 s67, s66, 0x10000
 s_add_u32 s68, s38, 0x20000
 v_lshlrev_b32 v4, 4, v0
 v_mov_b32 v5, 162816
C_LENT:
 v_lshrrev_b32 v20, 4, v0
 v_and_b32 v21, 15, v0
 v_lshlrev_b32 v22, 2, v20
 v_xor_b32 v21, v21, v22
 v_lshlrev_b32 v21, 4, v21
 v_lshl_add_u32 v6, v20, 10, v21
 v_bfe_u32 v20, v0, 2, 2
 v_lshrrev_b32 v21, 5, v0
 v_lshl_add_u32 v21, v21, 2, v20
 v_lshlrev_b32 v21, 8, v21
 v_and_b32 v22, 1, v0
 v_lshl_add_u32 v21, v22, 3, v21
 v_bfe_u32 v22, v0, 1, 1
 v_bfe_u32 v23, v0, 4, 1
 v_lshl_add_u32 v22, v23, 1, v22
 v_lshl_add_u32 v21, v22, 4, v21
 s_lshl_b32 s39, s34, 14
 s_sub_u32 s40, s66, s38
 s_add_u32 s40, s40, s39
 v_add_u32 v21, s40, v21
 v_xor_b32 v22, 0, v20
 v_lshl_add_u32 v8, v22, 6, v21
 v_xor_b32 v22, 1, v20
 v_lshl_add_u32 v9, v22, 6, v21
 v_xor_b32 v22, 2, v20
 v_lshl_add_u32 v10, v22, 6, v21
 v_xor_b32 v22, 3, v20
 v_lshl_add_u32 v11, v22, 6, v21
 v_xor_b32 v12, 0x10000, v8
 v_and_b32 v16, 0xffff, v8
 v_or_b32 v16, 0x20000, v16
 v_xor_b32 v13, 0x10000, v9
 v_and_b32 v17, 0xffff, v9
 v_or_b32 v17, 0x20000, v17
 v_xor_b32 v14, 0x10000, v10
 v_and_b32 v18, 0xffff, v10
 v_or_b32 v18, 0x20000, v18
 v_xor_b32 v15, 0x10000, v11
 v_and_b32 v19, 0xffff, v11
 v_or_b32 v19, 0x20000, v19
 v_mov_b32 v166, s90
 v_mov_b32 v167, s91
 v_and_b32 v164, 7, v0
 v_lshlrev_b32 v164, 12, v164
 v_mov_b32 v36, 0
 v_mov_b32 v37, 0
 v_mov_b32 v38, 0
 v_mov_b32 v39, 0
 v_mov_b32 v40, 0
 v_mov_b32 v41, 0
 v_mov_b32 v42, 0
 v_mov_b32 v43, 0
 v_mov_b32 v44, 0
 v_mov_b32 v45, 0
 v_mov_b32 v46, 0
 v_mov_b32 v47, 0
 v_mov_b32 v48, 0
 v_mov_b32 v49, 0
 v_mov_b32 v50, 0
 v_mov_b32 v51, 0
 v_mov_b32 v52, 0
 v_mov_b32 v53, 0
 v_mov_b32 v54, 0
 v_mov_b32 v55, 0
 v_mov_b32 v56, 0
 v_mov_b32 v57, 0
 v_mov_b32 v58, 0
 v_mov_b32 v59, 0
 v_mov_b32 v60, 0
 v_mov_b32 v61, 0
 v_mov_b32 v62, 0
 v_mov_b32 v63, 0
 v_mov_b32 v64, 0
 v_mov_b32 v65, 0
 v_mov_b32 v66, 0
 v_mov_b32 v67, 0
 v_mov_b32 v68, 0
 v_mov_b32 v69, 0
 v_mov_b32 v70, 0
 v_mov_b32 v71, 0
 v_mov_b32 v72, 0
 v_mov_b32 v73, 0
 v_mov_b32 v74, 0
 v_mov_b32 v75, 0
 v_mov_b32 v76, 0
 v_mov_b32 v77, 0
 v_mov_b32 v78, 0
 v_mov_b32 v79, 0
 v_mov_b32 v80, 0
 v_mov_b32 v81, 0
 v_mov_b32 v82, 0
 v_mov_b32 v83, 0
 v_mov_b32 v84, 0
 v_mov_b32 v85, 0
 v_mov_b32 v86, 0
 v_mov_b32 v87, 0
 v_mov_b32 v88, 0
 v_mov_b32 v89, 0
 v_mov_b32 v90, 0
 v_mov_b32 v91, 0
 v_mov_b32 v92, 0
 v_mov_b32 v93, 0
 v_mov_b32 v94, 0
 v_mov_b32 v95, 0
 v_mov_b32 v96, 0
 v_mov_b32 v97, 0
 v_mov_b32 v98, 0
 v_mov_b32 v99, 0
 s_cmp_eq_u32 s55, 4
 s_cbranch_scc0 C_LN4
 s_waitcnt lgkmcnt(0)
 s_mov_b32 s84, s82
 s_and_b32 s85, s83, 0xffff
 s_mov_b32 s86, 0x100
 s_mov_b32 s87, 0x00020000
 s_and_b32 s44, s93, 1
 s_lshl_b32 s44, s44, 2
 buffer_load_dword v20, off, s[84:87], s44 offset:16 sc1
 s_lshl_b32 s39, s32, 10
 s_add_u32 s40, s39, 0x8000
 s_add_u32 s39, s39, 0xc000
 buffer_load_dwordx4 v[24:27], v4, s[96:99], s40 offen sc1
 buffer_load_dwordx4 v[28:31], v4, s[96:99], s39 offen sc1
 s_waitcnt vmcnt(0)
 v_readfirstlane_b32 s39, v20
C_CLP:
 s_bfe_u32 s44, s93, 0x20001
 s_lshl_b32 s44, s44, 2
 s_add_u32 s44, s44, 4
 s_lshr_b32 s40, s39, s44
 s_and_b32 s40, s40, 15
 s_cbranch_scc1 C_CDP
 s_and_b32 s40, s39, 15
 s_add_u32 s40, s40, 1
 s_lshl_b32 s40, s40, s44
 s_add_u32 s40, s40, s39
 s_add_u32 s40, s40, 1
 v_mov_b32 v32, s40
 v_mov_b32 v33, s39
 s_and_b32 s44, s93, 1
 s_lshl_b32 s44, s44, 2
 s_mov_b64 exec, 1
 buffer_atomic_cmpswap v[32:33], off, s[84:87], s44 offset:16 sc0
 s_mov_b64 exec, -1
 s_waitcnt vmcnt(0)
 v_readfirstlane_b32 s44, v32
 s_cmp_eq_u32 s44, s39
 s_cselect_b32 s39, s40, s44
 s_branch C_CLP
C_CDP:
 s_sub_u32 s40, s40, 1
 s_lshr_b32 s39, s88, 8
 s_add_u32 s39, s39, s88
 s_and_b32 s39, s39, 3
 s_cmp_eq_u32 s88, 0
 s_cselect_b32 s31, s40, s39
 s_lshl_b32 s50, s32, 10
 s_cmp_eq_u32 s31, 0
 s_mov_b32 s39, 0xc000
 s_cmov_b32 s39, 0x8000
 s_cselect_b64 s[64:65], -1, 0
 s_add_u32 s50, s50, s39
 s_cmp_eq_u32 s31, 0
 s_cselect_b64 vcc, -1, 0
 v_cndmask_b32 v28, v28, v24, vcc
 v_cndmask_b32 v29, v29, v25, vcc
 v_cndmask_b32 v30, v30, v26, vcc
 v_cndmask_b32 v31, v31, v27, vcc
 s_mov_b32 s56, 0x155555
 s_mov_b32 s57, 0x0
 s_mov_b32 s60, 0x5050505
 s_mov_b32 s61, 0x1010101
 s_cmp_eq_u32 s31, 1
 s_cselect_b64 s[56:57], s[60:61], s[56:57]
 s_mov_b32 s60, 0x10101010
 s_mov_b32 s61, 0x4141414
 s_cmp_eq_u32 s31, 2
 s_cselect_b64 s[56:57], s[60:61], s[56:57]
 s_mov_b32 s60, 0x40404040
 s_mov_b32 s61, 0x50404040
 s_cmp_eq_u32 s31, 3
 s_cselect_b64 s[56:57], s[60:61], s[56:57]
 s_mov_b32 s51, 4096
 s_branch C_DBD0
C_DAD0:
 buffer_load_dwordx4 v[28:31], v4, s[96:99], s50 offen sc1
 s_waitcnt vmcnt(0)
C_DBD0:
 ds_read_b32 v238, v232
 v_cmp_eq_u64 vcc, s[90:91], v[28:29]
 v_cmp_eq_u64 s[60:61], s[90:91], v[30:31]
 s_and_b64 s[60:61], vcc, s[60:61]
 s_lshr_b64 s[58:59], s[60:61], 1
 s_and_b64 s[58:59], s[58:59], s[60:61]
 s_andn2_b64 s[60:61], s[64:65], s[60:61]
 s_cselect_b64 s[58:59], 0, s[58:59]
 s_waitcnt lgkmcnt(0)
 v_cmp_lt_u32 vcc, v238, v239
 s_cbranch_vccnz C_DAD0
 s_and_b64 s[60:61], s[58:59], s[56:57]
 s_bcnt1_i32_b64 s39, s[60:61]
 s_sub_u32 s51, s51, 1
 s_cmp_eq_u32 s51, 0
 s_cselect_b32 s39, 2, s39
 s_cmp_lt_u32 s39, 2
 s_cbranch_scc1 C_DAD0
 s_or_b32 s39, s31, 0x80000000
 s_and_b64 s[60:61], s[58:59], s[56:57]
 s_cselect_b64 s[60:61], s[60:61], s[56:57]
 s_ff1_i32_b64 s40, s[60:61]
 s_bitset0_b64 s[56:57], s40
 s_lshl_b32 s44, s40, 2
 s_or_b32 s39, s39, s44
 s_bitcmp1_b64 s[58:59], s40
 s_cselect_b32 s44, 0x4000000, 0
 s_or_b32 s39, s39, s44
 s_and_b64 s[60:61], s[58:59], s[56:57]
 s_cselect_b64 s[60:61], s[60:61], s[56:57]
 s_ff1_i32_b64 s40, s[60:61]
 s_bitset0_b64 s[56:57], s40
 s_lshl_b32 s44, s40, 8
 s_or_b32 s39, s39, s44
 s_bitcmp1_b64 s[58:59], s40
 s_cselect_b32 s44, 0x8000000, 0
 s_or_b32 s39, s39, s44
 v_mov_b32 v165, s39
 ds_write_b32 v5, v165 offset:0
C_LN4:
C_GWL:
 ds_read_b32 v20, v5
 s_waitcnt lgkmcnt(0)
 v_readfirstlane_b32 s49, v20
 s_bitcmp1_b32 s49, 31
 s_cbranch_scc0 C_GWL
 s_and_b32 s31, s49, 3
 s_bfe_u32 s45, s49, 0x60002
 s_bfe_u32 s46, s49, 0x60008
 s_lshl_b32 s50, s32, 10
 s_cmp_eq_u32 s31, 0
 s_mov_b32 s39, 0xc000
 s_cmov_b32 s39, 0x8000
 s_cselect_b64 s[64:65], -1, 0
 s_add_u32 s50, s50, s39
 s_cmp_eq_u32 s31, 0
 s_mov_b32 s39, 0x6000000
 s_cmov_b32 s39, 0x3200000
 s_mov_b32 s10, 0x1044000
 s_cmov_b32 s10, 0x580000
 s_mov_b32 s40, 0x41100
 s_cmov_b32 s40, 0x16000
 s_cselect_b64 s[12:13], s[76:77], s[74:75]
 s_mov_b32 s14, 0x400000
 s_cmov_b32 s14, 0x158000
 s_add_u32 s8, s4, s39
 s_addc_u32 s9, s5, 0
 s_and_b32 s9, s9, 0xffff
 s_mov_b32 s11, 0x00020000
 s_and_b32 s13, s13, 0xffff
 s_mov_b32 s15, 0x00020000
 s_lshl_b32 s39, s32, 2
 s_add_u32 s39, s39, s35
 s_mul_i32 s36, s39, s40
 s_lshl_b32 s39, s34, 12
 s_add_u32 s36, s36, s39
 s_lshl_b32 s37, s55, 14
 s_lshl_b32 s39, s33, 8
 s_add_u32 s37, s37, s39
 s_waitcnt vmcnt(0)
 s_lshl_b32 s69, s45, 16
 s_lshl_b32 s39, s35, 15
 s_add_u32 s69, s69, s39
 s_lshl_b32 s39, s33, 8
 s_add_u32 s69, s69, s39
 s_sub_u32 s39, s66, s38
 s_lshl_b32 s40, s35, 13
 s_add_u32 s39, s39, s40
 s_add_u32 m0, s39, 0
 s_add_u32 s40, s69, 0
 buffer_load_dwordx4 v6, s[12:15], s40 offen offset:0 lds
 s_add_u32 s40, s69, 3072
 buffer_load_dwordx4 v6, s[12:15], s40 offen offset:1024 lds
 s_add_u32 s40, s69, 6144
 buffer_load_dwordx4 v6, s[12:15], s40 offen offset:2048 lds
 s_add_u32 s40, s69, 9216
 buffer_load_dwordx4 v6, s[12:15], s40 offen offset:3072 lds
 s_add_u32 m0, s39, 4096
 s_add_u32 s40, s69, 16384
 buffer_load_dwordx4 v6, s[12:15], s40 offen offset:0 lds
 s_add_u32 s40, s69, 19456
 buffer_load_dwordx4 v6, s[12:15], s40 offen offset:1024 lds
 s_add_u32 s40, s69, 22528
 buffer_load_dwordx4 v6, s[12:15], s40 offen offset:2048 lds
 s_add_u32 s40, s69, 25600
 buffer_load_dwordx4 v6, s[12:15], s40 offen offset:3072 lds
 v_add_u32 v239, 1, v239
KB_LPOLLW1:
 ds_read_b32 v238, v232 offset:0
 s_waitcnt lgkmcnt(0)
 v_cmp_lt_u32 vcc, v238, v239
 s_cbranch_vccz KB_LGOW1
 s_sleep 2
 s_branch KB_LPOLLW1
KB_LGOW1:
 s_lshl_b32 s69, s46, 16
 s_lshl_b32 s39, s35, 15
 s_add_u32 s69, s69, s39
 s_lshl_b32 s39, s33, 8
 s_add_u32 s69, s69, s39
 s_sub_u32 s39, s66, s38
 s_lshl_b32 s40, s35, 13
 s_add_u32 s39, s39, s40
 s_add_u32 m0, s39, 32768
 s_add_u32 s40, s69, 0
 buffer_load_dwordx4 v6, s[12:15], s40 offen offset:0 lds
 s_add_u32 s40, s69, 3072
 buffer_load_dwordx4 v6, s[12:15], s40 offen offset:1024 lds
 s_add_u32 s40, s69, 6144
 buffer_load_dwordx4 v6, s[12:15], s40 offen offset:2048 lds
 s_add_u32 s40, s69, 9216
 buffer_load_dwordx4 v6, s[12:15], s40 offen offset:3072 lds
 s_add_u32 m0, s39, 36864
 s_add_u32 s40, s69, 16384
 buffer_load_dwordx4 v6, s[12:15], s40 offen offset:0 lds
 s_add_u32 s40, s69, 19456
 buffer_load_dwordx4 v6, s[12:15], s40 offen offset:1024 lds
 s_add_u32 s40, s69, 22528
 buffer_load_dwordx4 v6, s[12:15], s40 offen offset:2048 lds
 s_add_u32 s40, s69, 25600
 buffer_load_dwordx4 v6, s[12:15], s40 offen offset:3072 lds
 v_add_u32 v239, 1, v239
 s_bitcmp1_b32 s49, 26
 s_cbranch_scc0 C_SLL0
C_SBL0:
 s_lshl_b32 s70, s45, 12
 s_add_u32 s70, s70, s36
 buffer_load_dwordx4 v[132:135], v4, s[8:11], s70 offen offset:0 sc1
 buffer_load_dwordx4 v[136:139], v4, s[8:11], s70 offen offset:1024 sc1
 buffer_load_dwordx4 v[140:143], v4, s[8:11], s70 offen offset:2048 sc1
 buffer_load_dwordx4 v[144:147], v4, s[8:11], s70 offen offset:3072 sc1
 s_bitcmp1_b32 s49, 27
 s_cbranch_scc0 C_SLL1
C_SBL1:
 s_lshl_b32 s70, s46, 12
 s_add_u32 s70, s70, s36
 buffer_load_dwordx4 v[148:151], v4, s[8:11], s70 offen offset:0 sc1
 buffer_load_dwordx4 v[152:155], v4, s[8:11], s70 offen offset:1024 sc1
 buffer_load_dwordx4 v[156:159], v4, s[8:11], s70 offen offset:2048 sc1
 buffer_load_dwordx4 v[160:163], v4, s[8:11], s70 offen offset:3072 sc1
 s_cmp_eq_u32 s55, 4
 s_cbranch_scc0 C_LN6
 s_mov_b32 s51, 4096
C_DAD1:
 buffer_load_dwordx4 v[28:31], v4, s[96:99], s50 offen sc1
 s_waitcnt vmcnt(0)
C_DBD1:
 ds_read_b32 v238, v232
 v_cmp_eq_u64 vcc, s[90:91], v[28:29]
 v_cmp_eq_u64 s[60:61], s[90:91], v[30:31]
 s_and_b64 s[60:61], vcc, s[60:61]
 s_lshr_b64 s[58:59], s[60:61], 1
 s_and_b64 s[58:59], s[58:59], s[60:61]
 s_andn2_b64 s[60:61], s[64:65], s[60:61]
 s_cselect_b64 s[58:59], 0, s[58:59]
 s_waitcnt lgkmcnt(0)
 v_cmp_lt_u32 vcc, v238, v239
 s_cbranch_vccnz C_DAD1
 s_or_b32 s39, s31, 0x80000000
 s_and_b64 s[60:61], s[58:59], s[56:57]
 s_cselect_b64 s[60:61], s[60:61], s[56:57]
 s_ff1_i32_b64 s40, s[60:61]
 s_bitset0_b64 s[56:57], s40
 s_lshl_b32 s44, s40, 14
 s_or_b32 s39, s39, s44
 s_bitcmp1_b64 s[58:59], s40
 s_cselect_b32 s44, 0x10000000, 0
 s_or_b32 s39, s39, s44
 s_and_b64 s[60:61], s[58:59], s[56:57]
 s_cselect_b64 s[60:61], s[60:61], s[56:57]
 s_ff1_i32_b64 s40, s[60:61]
 s_bitset0_b64 s[56:57], s40
 s_lshl_b32 s44, s40, 20
 s_or_b32 s39, s39, s44
 v_mov_b32 v165, s39
 ds_write_b32 v5, v165 offset:4
C_LN6:
C_GXL:
 ds_read_b32 v20, v5 offset:4
 s_waitcnt lgkmcnt(0)
 v_readfirstlane_b32 s39, v20
 s_bitcmp1_b32 s39, 31
 s_cbranch_scc0 C_GXL
 s_bfe_u32 s47, s39, 0x6000e
 s_lshl_b32 s69, s47, 16
 s_lshl_b32 s39, s35, 15
 s_add_u32 s69, s69, s39
 s_lshl_b32 s39, s33, 8
 s_add_u32 s69, s69, s39
 s_sub_u32 s39, s67, s38
 s_lshl_b32 s40, s35, 13
 s_add_u32 s39, s39, s40
 s_add_u32 m0, s39, 0
 s_add_u32 s40, s69, 0
 buffer_load_dwordx4 v6, s[12:15], s40 offen offset:0 lds
 s_add_u32 s40, s69, 3072
 buffer_load_dwordx4 v6, s[12:15], s40 offen offset:1024 lds
 s_add_u32 s40, s69, 6144
 buffer_load_dwordx4 v6, s[12:15], s40 offen offset:2048 lds
 s_add_u32 s40, s69, 9216
 buffer_load_dwordx4 v6, s[12:15], s40 offen offset:3072 lds
 s_add_u32 m0, s39, 4096
 s_add_u32 s40, s69, 16384
 buffer_load_dwordx4 v6, s[12:15], s40 offen offset:0 lds
 s_add_u32 s40, s69, 19456
 buffer_load_dwordx4 v6, s[12:15], s40 offen offset:1024 lds
 s_add_u32 s40, s69, 22528
 buffer_load_dwordx4 v6, s[12:15], s40 offen offset:2048 lds
 s_add_u32 s40, s69, 25600
 buffer_load_dwordx4 v6, s[12:15], s40 offen offset:3072 lds
 s_cmp_eq_u32 s55, 4
 s_cbranch_scc0 C_LN5
 buffer_load_dwordx4 v[24:27], v4, s[96:99], s50 offen sc1
 buffer_load_dwordx4 v[28:31], v4, s[96:99], s50 offen sc1
C_LN5:
 s_waitcnt vmcnt(24)
C_B1:
 s_barrier
 s_cmp_eq_u32 s31, 0
 s_cbranch_scc1 C_MAINN11
 s_cmp_eq_u32 s31, 2
 s_cbranch_scc1 C_MAINN11
 s_cmp_eq_u32 s31, 1
 s_cbranch_scc1 C_MAINN12
C_MAINN9:
 ds_read_b32 v169, v5 offset:4
 ds_read_b64_tr_b16 v[200:201], v8 offset:0
 ds_read_b64_tr_b16 v[202:203], v8 offset:2048
 ds_read_b64_tr_b16 v[204:205], v9 offset:0
 ds_read_b64_tr_b16 v[206:207], v9 offset:2048
 ds_read_b64_tr_b16 v[208:209], v10 offset:0
 ds_read_b64_tr_b16 v[210:211], v10 offset:2048
 ds_read_b64_tr_b16 v[212:213], v11 offset:0
 ds_read_b64_tr_b16 v[214:215], v11 offset:2048
 ds_read_b64_tr_b16 v[216:217], v8 offset:4096
 ds_read_b64_tr_b16 v[218:219], v8 offset:6144
 ds_read_b64_tr_b16 v[220:221], v9 offset:4096
 ds_read_b64_tr_b16 v[222:223], v9 offset:6144
 s_waitcnt vmcnt(15) lgkmcnt(10)
 v_readfirstlane_b32 s49, v169
 s_bfe_u32 s47, s49, 0x6000e
 s_bfe_u32 s48, s49, 0x60014
 v_mfma_f32_32x32x16_bf16 v[36:51], v[200:203], v[132:135], v[36:51]
 ds_read_b64_tr_b16 v[224:225], v10 offset:4096
 ds_read_b64_tr_b16 v[226:227], v10 offset:6144
 s_waitcnt lgkmcnt(10)
 v_mfma_f32_32x32x16_bf16 v[52:67], v[204:207], v[132:135], v[52:67]
 ds_read_b64_tr_b16 v[228:229], v11 offset:4096
 ds_read_b64_tr_b16 v[230:231], v11 offset:6144
 s_lshl_b32 s69, s48, 16
 s_add_u32 s69, s69, s37
 s_add_u32 m0, s67, 32768
 s_add_u32 s39, s69, 0
 buffer_load_dwordx4 v6, s[12:15], s39 offen offset:0 lds
 s_waitcnt lgkmcnt(10)
 s_cmp_eq_u32 s55, 4
 s_cbranch_scc0 C_NDN9_0
 s_waitcnt vmcnt(2)
 v_cmp_eq_u64 vcc, s[90:91], v[24:25]
 v_cmp_eq_u64 s[60:61], s[90:91], v[26:27]
 s_and_b64 s[60:61], vcc, s[60:61]
 s_lshr_b64 s[58:59], s[60:61], 1
 s_and_b64 s[58:59], s[58:59], s[60:61]
 s_andn2_b64 s[60:61], s[64:65], s[60:61]
 s_cselect_b64 s[58:59], 0, s[58:59]
 s_and_b64 s[60:61], s[58:59], s[56:57]
 s_cselect_b64 s[60:61], s[60:61], s[56:57]
 s_ff1_i32_b64 s40, s[60:61]
 s_bitset0_b64 s[56:57], s40
 s_bitcmp1_b64 s[58:59], s48
 s_cselect_b32 s44, 0x10000000, 0
 s_or_b32 s40, s40, s44
 v_mov_b32 v165, s40
 s_sub_u32 s44, s67, 0x4000
 v_add_u32 v20, s44, v164
 ds_write_b32 v20, v165 offset:35840
 buffer_load_dwordx4 v[24:27], v4, s[96:99], s50 offen sc1
C_NDN9_0:
 v_mfma_f32_32x32x16_bf16 v[68:83], v[208:211], v[132:135], v[68:83]
 ds_read_b64_tr_b16 v[200:201], v8 offset:8192
 ds_read_b64_tr_b16 v[202:203], v8 offset:10240
 s_waitcnt lgkmcnt(10)
 v_mfma_f32_32x32x16_bf16 v[84:99], v[212:215], v[132:135], v[84:99]
 ds_read_b64_tr_b16 v[204:205], v9 offset:8192
 ds_read_b64_tr_b16 v[206:207], v9 offset:10240
 s_bitcmp1_b32 s49, 28
 s_cbranch_scc0 C_SLN9_0
C_SBN9_0:
 s_lshl_b32 s70, s47, 12
 s_add_u32 s70, s70, s36
 buffer_load_dwordx4 v[100:103], v4, s[8:11], s70 offen offset:0 sc1
 s_waitcnt vmcnt(16) lgkmcnt(10)
 v_mfma_f32_32x32x16_bf16 v[36:51], v[216:219], v[136:139], v[36:51]
 ds_read_b64_tr_b16 v[208:209], v10 offset:8192
 ds_read_b64_tr_b16 v[210:211], v10 offset:10240
 s_waitcnt lgkmcnt(10)
 v_mfma_f32_32x32x16_bf16 v[52:67], v[220:223], v[136:139], v[52:67]
 ds_read_b64_tr_b16 v[212:213], v11 offset:8192
 ds_read_b64_tr_b16 v[214:215], v11 offset:10240
 s_add_u32 s39, s69, 3072
 buffer_load_dwordx4 v6, s[12:15], s39 offen offset:1024 lds
 s_waitcnt lgkmcnt(10)
 v_mfma_f32_32x32x16_bf16 v[68:83], v[224:227], v[136:139], v[68:83]
 ds_read_b64_tr_b16 v[216:217], v8 offset:12288
 ds_read_b64_tr_b16 v[218:219], v8 offset:14336
 s_waitcnt lgkmcnt(10)
 v_mfma_f32_32x32x16_bf16 v[84:99], v[228:231], v[136:139], v[84:99]
 ds_read_b64_tr_b16 v[220:221], v9 offset:12288
 ds_read_b64_tr_b16 v[222:223], v9 offset:14336
 buffer_load_dwordx4 v[104:107], v4, s[8:11], s70 offen offset:1024 sc1
 s_waitcnt vmcnt(17) lgkmcnt(10)
 v_mfma_f32_32x32x16_bf16 v[36:51], v[200:203], v[140:143], v[36:51]
 ds_read_b64_tr_b16 v[224:225], v10 offset:12288
 ds_read_b64_tr_b16 v[226:227], v10 offset:14336
 s_waitcnt lgkmcnt(10)
 s_waitcnt vmcnt(20)
 s_barrier
 v_mov_b32 v21, s67
 ds_read_b32 v169, v21 offset:35840
 v_mfma_f32_32x32x16_bf16 v[52:67], v[204:207], v[140:143], v[52:67]
 ds_read_b64_tr_b16 v[228:229], v11 offset:12288
 ds_read_b64_tr_b16 v[230:231], v11 offset:14336
 s_add_u32 s39, s69, 6144
 buffer_load_dwordx4 v6, s[12:15], s39 offen offset:2048 lds
 s_waitcnt lgkmcnt(10)
 v_mfma_f32_32x32x16_bf16 v[68:83], v[208:211], v[140:143], v[68:83]
 ds_read_b64_tr_b16 v[200:201], v8 offset:32768
 ds_read_b64_tr_b16 v[202:203], v8 offset:34816
 s_waitcnt lgkmcnt(10)
 v_mfma_f32_32x32x16_bf16 v[84:99], v[212:215], v[140:143], v[84:99]
 ds_read_b64_tr_b16 v[204:205], v9 offset:32768
 ds_read_b64_tr_b16 v[206:207], v9 offset:34816
 buffer_load_dwordx4 v[108:111], v4, s[8:11], s70 offen offset:2048 sc1
 s_waitcnt vmcnt(18) lgkmcnt(10)
 v_mfma_f32_32x32x16_bf16 v[36:51], v[216:219], v[144:147], v[36:51]
 ds_read_b64_tr_b16 v[208:209], v10 offset:32768
 ds_read_b64_tr_b16 v[210:211], v10 offset:34816
 s_waitcnt lgkmcnt(10)
 v_mfma_f32_32x32x16_bf16 v[52:67], v[220:223], v[144:147], v[52:67]
 ds_read_b64_tr_b16 v[212:213], v11 offset:32768
 ds_read_b64_tr_b16 v[214:215], v11 offset:34816
 s_waitcnt lgkmcnt(10)
 s_add_u32 s39, s69, 9216
 buffer_load_dwordx4 v6, s[12:15], s39 offen offset:3072 lds
 s_waitcnt lgkmcnt(10)
 v_mfma_f32_32x32x16_bf16 v[68:83], v[224:227], v[144:147], v[68:83]
 ds_read_b64_tr_b16 v[216:217], v8 offset:36864
 ds_read_b64_tr_b16 v[218:219], v8 offset:38912
 s_waitcnt lgkmcnt(10)
 v_mfma_f32_32x32x16_bf16 v[84:99], v[228:231], v[144:147], v[84:99]
 ds_read_b64_tr_b16 v[220:221], v9 offset:36864
 ds_read_b64_tr_b16 v[222:223], v9 offset:38912
 buffer_load_dwordx4 v[112:115], v4, s[8:11], s70 offen offset:3072 sc1
 s_waitcnt vmcnt(19) lgkmcnt(10)
 v_readfirstlane_b32 s49, v169
 s_and_b32 s45, s49, 63
 v_mfma_f32_32x32x16_bf16 v[36:51], v[200:203], v[148:151], v[36:51]
 ds_read_b64_tr_b16 v[224:225], v10 offset:36864
 ds_read_b64_tr_b16 v[226:227], v10 offset:38912
 s_waitcnt lgkmcnt(10)
 v_mfma_f32_32x32x16_bf16 v[52:67], v[204:207], v[148:151], v[52:67]
 ds_read_b64_tr_b16 v[228:229], v11 offset:36864
 ds_read_b64_tr_b16 v[230:231], v11 offset:38912
 s_lshl_b32 s69, s45, 16
 s_add_u32 s69, s69, s37
 s_add_u32 m0, s68, 0
 s_add_u32 s39, s69, 0
 buffer_load_dwordx4 v6, s[12:15], s39 offen offset:0 lds
 s_waitcnt lgkmcnt(10)
 s_cmp_eq_u32 s55, 4
 s_cbranch_scc0 C_NDN9_1
 s_waitcnt vmcnt(10)
 v_cmp_eq_u64 vcc, s[90:91], v[28:29]
 v_cmp_eq_u64 s[60:61], s[90:91], v[30:31]
 s_and_b64 s[60:61], vcc, s[60:61]
 s_lshr_b64 s[58:59], s[60:61], 1
 s_and_b64 s[58:59], s[58:59], s[60:61]
 s_andn2_b64 s[60:61], s[64:65], s[60:61]
 s_cselect_b64 s[58:59], 0, s[58:59]
 s_and_b64 s[60:61], s[58:59], s[56:57]
 s_cselect_b64 s[60:61], s[60:61], s[56:57]
 s_ff1_i32_b64 s40, s[60:61]
 s_bitset0_b64 s[56:57], s40
 s_bitcmp1_b64 s[58:59], s45
 s_cselect_b32 s44, 0x10000000, 0
 s_or_b32 s40, s40, s44
 v_mov_b32 v165, s40
 s_sub_u32 s44, s68, 0x4000
 v_add_u32 v20, s44, v164
 ds_write_b32 v20, v165 offset:3072
 buffer_load_dwordx4 v[28:31], v4, s[96:99], s50 offen sc1
C_NDN9_1:
 v_mfma_f32_32x32x16_bf16 v[68:83], v[208:211], v[148:151], v[68:83]
 ds_read_b64_tr_b16 v[200:201], v8 offset:40960
 ds_read_b64_tr_b16 v[202:203], v8 offset:43008
 s_waitcnt lgkmcnt(10)
 v_mfma_f32_32x32x16_bf16 v[84:99], v[212:215], v[148:151], v[84:99]
 ds_read_b64_tr_b16 v[204:205], v9 offset:40960
 ds_read_b64_tr_b16 v[206:207], v9 offset:43008
 s_bitcmp1_b32 s49, 28
 s_cbranch_scc0 C_SLN9_1
C_SBN9_1:
 s_lshl_b32 s70, s48, 12
 s_add_u32 s70, s70, s36
 buffer_load_dwordx4 v[116:119], v4, s[8:11], s70 offen offset:0 sc1
 s_waitcnt vmcnt(20) lgkmcnt(10)
 v_mfma_f32_32x32x16_bf16 v[36:51], v[216:219], v[152:155], v[36:51]
 ds_read_b64_tr_b16 v[208:209], v10 offset:40960
 ds_read_b64_tr_b16 v[210:211], v10 offset:43008
 s_waitcnt lgkmcnt(10)
 v_mfma_f32_32x32x16_bf16 v[52:67], v[220:223], v[152:155], v[52:67]
 ds_read_b64_tr_b16 v[212:213], v11 offset:40960
 ds_read_b64_tr_b16 v[214:215], v11 offset:43008
 s_add_u32 s39, s69, 3072
 buffer_load_dwordx4 v6, s[12:15], s39 offen offset:1024 lds
 s_waitcnt lgkmcnt(10)
 v_mfma_f32_32x32x16_bf16 v[68:83], v[224:227], v[152:155], v[68:83]
 ds_read_b64_tr_b16 v[216:217], v8 offset:45056
 ds_read_b64_tr_b16 v[218:219], v8 offset:47104
 s_waitcnt lgkmcnt(10)
 v_mfma_f32_32x32x16_bf16 v[84:99], v[228:231], v[152:155], v[84:99]
 ds_read_b64_tr_b16 v[220:221], v9 offset:45056
 ds_read_b64_tr_b16 v[222:223], v9 offset:47104
 buffer_load_dwordx4 v[120:123], v4, s[8:11], s70 offen offset:1024 sc1
 s_waitcnt vmcnt(21) lgkmcnt(10)
 v_mfma_f32_32x32x16_bf16 v[36:51], v[200:203], v[156:159], v[36:51]
 ds_read_b64_tr_b16 v[224:225], v10 offset:45056
 ds_read_b64_tr_b16 v[226:227], v10 offset:47104
 s_waitcnt lgkmcnt(10)
 s_waitcnt vmcnt(12)
 s_barrier
 v_mov_b32 v21, s68
 ds_read_b32 v169, v21 offset:3072
 v_mfma_f32_32x32x16_bf16 v[52:67], v[204:207], v[156:159], v[52:67]
 ds_read_b64_tr_b16 v[228:229], v11 offset:45056
 ds_read_b64_tr_b16 v[230:231], v11 offset:47104
 s_add_u32 s39, s69, 6144
 buffer_load_dwordx4 v6, s[12:15], s39 offen offset:2048 lds
 s_waitcnt lgkmcnt(10)
 v_mfma_f32_32x32x16_bf16 v[68:83], v[208:211], v[156:159], v[68:83]
 ds_read_b64_tr_b16 v[200:201], v12 offset:0
 ds_read_b64_tr_b16 v[202:203], v12 offset:2048
 s_waitcnt lgkmcnt(10)
 v_mfma_f32_32x32x16_bf16 v[84:99], v[212:215], v[156:159], v[84:99]
 ds_read_b64_tr_b16 v[204:205], v13 offset:0
 ds_read_b64_tr_b16 v[206:207], v13 offset:2048
 buffer_load_dwordx4 v[124:127], v4, s[8:11], s70 offen offset:2048 sc1
 s_waitcnt vmcnt(22) lgkmcnt(10)
 v_mfma_f32_32x32x16_bf16 v[36:51], v[216:219], v[160:163], v[36:51]
 ds_read_b64_tr_b16 v[208:209], v14 offset:0
 ds_read_b64_tr_b16 v[210:211], v14 offset:2048
 s_waitcnt lgkmcnt(10)
 v_mfma_f32_32x32x16_bf16 v[52:67], v[220:223], v[160:163], v[52:67]
 ds_read_b64_tr_b16 v[212:213], v15 offset:0
 ds_read_b64_tr_b16 v[214:215], v15 offset:2048
 s_waitcnt lgkmcnt(10)
 s_add_u32 s39, s69, 9216
 buffer_load_dwordx4 v6, s[12:15], s39 offen offset:3072 lds
 s_waitcnt lgkmcnt(10)
 v_mfma_f32_32x32x16_bf16 v[68:83], v[224:227], v[160:163], v[68:83]
 ds_read_b64_tr_b16 v[216:217], v12 offset:4096
 ds_read_b64_tr_b16 v[218:219], v12 offset:6144
 s_waitcnt lgkmcnt(10)
 v_mfma_f32_32x32x16_bf16 v[84:99], v[228:231], v[160:163], v[84:99]
 ds_read_b64_tr_b16 v[220:221], v13 offset:4096
 ds_read_b64_tr_b16 v[222:223], v13 offset:6144
 buffer_load_dwordx4 v[128:131], v4, s[8:11], s70 offen offset:3072 sc1
 s_waitcnt vmcnt(14) lgkmcnt(10)
 v_readfirstlane_b32 s49, v169
 s_and_b32 s46, s49, 63
 v_mfma_f32_32x32x16_bf16 v[36:51], v[200:203], v[100:103], v[36:51]
 ds_read_b64_tr_b16 v[224:225], v14 offset:4096
 ds_read_b64_tr_b16 v[226:227], v14 offset:6144
 s_waitcnt lgkmcnt(10)
 v_mfma_f32_32x32x16_bf16 v[52:67], v[204:207], v[100:103], v[52:67]
 ds_read_b64_tr_b16 v[228:229], v15 offset:4096
 ds_read_b64_tr_b16 v[230:231], v15 offset:6144
 s_lshl_b32 s69, s46, 16
 s_add_u32 s69, s69, s37
 s_add_u32 m0, s66, 0
 s_add_u32 s39, s69, 0
 buffer_load_dwordx4 v6, s[12:15], s39 offen offset:0 lds
 s_waitcnt lgkmcnt(10)
 s_cmp_eq_u32 s55, 4
 s_cbranch_scc0 C_NDN9_2
 s_waitcnt vmcnt(17)
 v_cmp_eq_u64 vcc, s[90:91], v[24:25]
 v_cmp_eq_u64 s[60:61], s[90:91], v[26:27]
 s_and_b64 s[60:61], vcc, s[60:61]
 s_lshr_b64 s[58:59], s[60:61], 1
 s_and_b64 s[58:59], s[58:59], s[60:61]
 s_andn2_b64 s[60:61], s[64:65], s[60:61]
 s_cselect_b64 s[58:59], 0, s[58:59]
 s_and_b64 s[60:61], s[58:59], s[56:57]
 s_cselect_b64 s[60:61], s[60:61], s[56:57]
 s_ff1_i32_b64 s40, s[60:61]
 s_bitset0_b64 s[56:57], s40
 s_bitcmp1_b64 s[58:59], s46
 s_cselect_b32 s44, 0x10000000, 0
 s_or_b32 s40, s40, s44
 v_mov_b32 v165, s40
 s_sub_u32 s44, s66, 0x4000
 v_add_u32 v20, s44, v164
 ds_write_b32 v20, v165 offset:3072
 buffer_load_dwordx4 v[24:27], v4, s[96:99], s50 offen sc1
C_NDN9_2:
 v_mfma_f32_32x32x16_bf16 v[68:83], v[208:211], v[100:103], v[68:83]
 ds_read_b64_tr_b16 v[200:201], v12 offset:8192
 ds_read_b64_tr_b16 v[202:203], v12 offset:10240
 s_waitcnt lgkmcnt(10)
 v_mfma_f32_32x32x16_bf16 v[84:99], v[212:215], v[100:103], v[84:99]
 ds_read_b64_tr_b16 v[204:205], v13 offset:8192
 ds_read_b64_tr_b16 v[206:207], v13 offset:10240
 s_bitcmp1_b32 s49, 28
 s_cbranch_scc0 C_SLN9_2
C_SBN9_2:
 s_lshl_b32 s70, s45, 12
 s_add_u32 s70, s70, s36
 buffer_load_dwordx4 v[132:135], v4, s[8:11], s70 offen offset:0 sc1
 s_waitcnt vmcnt(14) lgkmcnt(10)
 v_mfma_f32_32x32x16_bf16 v[36:51], v[216:219], v[104:107], v[36:51]
 ds_read_b64_tr_b16 v[208:209], v14 offset:8192
 ds_read_b64_tr_b16 v[210:211], v14 offset:10240
 s_waitcnt lgkmcnt(10)
 v_mfma_f32_32x32x16_bf16 v[52:67], v[220:223], v[104:107], v[52:67]
 ds_read_b64_tr_b16 v[212:213], v15 offset:8192
 ds_read_b64_tr_b16 v[214:215], v15 offset:10240
 s_add_u32 s39, s69, 3072
 buffer_load_dwordx4 v6, s[12:15], s39 offen offset:1024 lds
 s_waitcnt lgkmcnt(10)
 v_mfma_f32_32x32x16_bf16 v[68:83], v[224:227], v[104:107], v[68:83]
 ds_read_b64_tr_b16 v[216:217], v12 offset:12288
 ds_read_b64_tr_b16 v[218:219], v12 offset:14336
 s_waitcnt lgkmcnt(10)
 v_mfma_f32_32x32x16_bf16 v[84:99], v[228:231], v[104:107], v[84:99]
 ds_read_b64_tr_b16 v[220:221], v13 offset:12288
 ds_read_b64_tr_b16 v[222:223], v13 offset:14336
 buffer_load_dwordx4 v[136:139], v4, s[8:11], s70 offen offset:1024 sc1
 s_waitcnt vmcnt(14) lgkmcnt(10)
 v_mfma_f32_32x32x16_bf16 v[36:51], v[200:203], v[108:111], v[36:51]
 ds_read_b64_tr_b16 v[224:225], v14 offset:12288
 ds_read_b64_tr_b16 v[226:227], v14 offset:14336
 s_waitcnt lgkmcnt(10)
 s_waitcnt vmcnt(13)
 s_barrier
 v_mov_b32 v21, s66
 ds_read_b32 v169, v21 offset:3072
 v_mfma_f32_32x32x16_bf16 v[52:67], v[204:207], v[108:111], v[52:67]
 ds_read_b64_tr_b16 v[228:229], v15 offset:12288
 ds_read_b64_tr_b16 v[230:231], v15 offset:14336
 s_add_u32 s39, s69, 6144
 buffer_load_dwordx4 v6, s[12:15], s39 offen offset:2048 lds
 s_waitcnt lgkmcnt(10)
 v_mfma_f32_32x32x16_bf16 v[68:83], v[208:211], v[108:111], v[68:83]
 ds_read_b64_tr_b16 v[200:201], v12 offset:32768
 ds_read_b64_tr_b16 v[202:203], v12 offset:34816
 s_waitcnt lgkmcnt(10)
 v_mfma_f32_32x32x16_bf16 v[84:99], v[212:215], v[108:111], v[84:99]
 ds_read_b64_tr_b16 v[204:205], v13 offset:32768
 ds_read_b64_tr_b16 v[206:207], v13 offset:34816
 buffer_load_dwordx4 v[140:143], v4, s[8:11], s70 offen offset:2048 sc1
 s_waitcnt vmcnt(14) lgkmcnt(10)
 v_mfma_f32_32x32x16_bf16 v[36:51], v[216:219], v[112:115], v[36:51]
 ds_read_b64_tr_b16 v[208:209], v14 offset:32768
 ds_read_b64_tr_b16 v[210:211], v14 offset:34816
 s_waitcnt lgkmcnt(10)
 v_mfma_f32_32x32x16_bf16 v[52:67], v[220:223], v[112:115], v[52:67]
 ds_read_b64_tr_b16 v[212:213], v15 offset:32768
 ds_read_b64_tr_b16 v[214:215], v15 offset:34816
 s_waitcnt lgkmcnt(10)
 s_add_u32 s39, s69, 9216
 buffer_load_dwordx4 v6, s[12:15], s39 offen offset:3072 lds
 s_waitcnt lgkmcnt(10)
 v_mfma_f32_32x32x16_bf16 v[68:83], v[224:227], v[112:115], v[68:83]
 ds_read_b64_tr_b16 v[216:217], v12 offset:36864
 ds_read_b64_tr_b16 v[218:219], v12 offset:38912
 s_waitcnt lgkmcnt(10)
 v_mfma_f32_32x32x16_bf16 v[84:99], v[228:231], v[112:115], v[84:99]
 ds_read_b64_tr_b16 v[220:221], v13 offset:36864
 ds_read_b64_tr_b16 v[222:223], v13 offset:38912
 buffer_load_dwordx4 v[144:147], v4, s[8:11], s70 offen offset:3072 sc1
 s_waitcnt vmcnt(14) lgkmcnt(10)
 v_readfirstlane_b32 s49, v169
 s_and_b32 s47, s49, 63
 v_mfma_f32_32x32x16_bf16 v[36:51], v[200:203], v[116:119], v[36:51]
 ds_read_b64_tr_b16 v[224:225], v14 offset:36864
 ds_read_b64_tr_b16 v[226:227], v14 offset:38912
 s_waitcnt lgkmcnt(10)
 v_mfma_f32_32x32x16_bf16 v[52:67], v[204:207], v[116:119], v[52:67]
 ds_read_b64_tr_b16 v[228:229], v15 offset:36864
 ds_read_b64_tr_b16 v[230:231], v15 offset:38912
 s_lshl_b32 s69, s47, 16
 s_add_u32 s69, s69, s37
 s_add_u32 m0, s66, 32768
 s_add_u32 s39, s69, 0
 buffer_load_dwordx4 v6, s[12:15], s39 offen offset:0 lds
 s_waitcnt lgkmcnt(10)
 s_cmp_eq_u32 s55, 4
 s_cbranch_scc0 C_NDN9_3
 s_waitcnt vmcnt(17)
 v_cmp_eq_u64 vcc, s[90:91], v[28:29]
 v_cmp_eq_u64 s[60:61], s[90:91], v[30:31]
 s_and_b64 s[60:61], vcc, s[60:61]
 s_lshr_b64 s[58:59], s[60:61], 1
 s_and_b64 s[58:59], s[58:59], s[60:61]
 s_andn2_b64 s[60:61], s[64:65], s[60:61]
 s_cselect_b64 s[58:59], 0, s[58:59]
 s_and_b64 s[60:61], s[58:59], s[56:57]
 s_cselect_b64 s[60:61], s[60:61], s[56:57]
 s_ff1_i32_b64 s40, s[60:61]
 s_bitset0_b64 s[56:57], s40
 s_bitcmp1_b64 s[58:59], s47
 s_cselect_b32 s44, 0x10000000, 0
 s_or_b32 s40, s40, s44
 v_mov_b32 v165, s40
 s_sub_u32 s44, s66, 0x4000
 v_add_u32 v20, s44, v164
 ds_write_b32 v20, v165 offset:35840
 buffer_load_dwordx4 v[28:31], v4, s[96:99], s50 offen sc1
C_NDN9_3:
 v_mfma_f32_32x32x16_bf16 v[68:83], v[208:211], v[116:119], v[68:83]
 ds_read_b64_tr_b16 v[200:201], v12 offset:40960
 ds_read_b64_tr_b16 v[202:203], v12 offset:43008
 s_waitcnt lgkmcnt(10)
 v_mfma_f32_32x32x16_bf16 v[84:99], v[212:215], v[116:119], v[84:99]
 ds_read_b64_tr_b16 v[204:205], v13 offset:40960
 ds_read_b64_tr_b16 v[206:207], v13 offset:43008
 s_bitcmp1_b32 s49, 28
 s_cbranch_scc0 C_SLN9_3
C_SBN9_3:
 s_lshl_b32 s70, s46, 12
 s_add_u32 s70, s70, s36
 buffer_load_dwordx4 v[148:151], v4, s[8:11], s70 offen offset:0 sc1
 s_waitcnt vmcnt(14) lgkmcnt(10)
 v_mfma_f32_32x32x16_bf16 v[36:51], v[216:219], v[120:123], v[36:51]
 ds_read_b64_tr_b16 v[208:209], v14 offset:40960
 ds_read_b64_tr_b16 v[210:211], v14 offset:43008
 s_waitcnt lgkmcnt(10)
 v_mfma_f32_32x32x16_bf16 v[52:67], v[220:223], v[120:123], v[52:67]
 ds_read_b64_tr_b16 v[212:213], v15 offset:40960
 ds_read_b64_tr_b16 v[214:215], v15 offset:43008
 s_add_u32 s39, s69, 3072
 buffer_load_dwordx4 v6, s[12:15], s39 offen offset:1024 lds
 s_waitcnt lgkmcnt(10)
 v_mfma_f32_32x32x16_bf16 v[68:83], v[224:227], v[120:123], v[68:83]
 ds_read_b64_tr_b16 v[216:217], v12 offset:45056
 ds_read_b64_tr_b16 v[218:219], v12 offset:47104
 s_waitcnt lgkmcnt(10)
 v_mfma_f32_32x32x16_bf16 v[84:99], v[228:231], v[120:123], v[84:99]
 ds_read_b64_tr_b16 v[220:221], v13 offset:45056
 ds_read_b64_tr_b16 v[222:223], v13 offset:47104
 buffer_load_dwordx4 v[152:155], v4, s[8:11], s70 offen offset:1024 sc1
 s_waitcnt vmcnt(14) lgkmcnt(10)
 v_mfma_f32_32x32x16_bf16 v[36:51], v[200:203], v[124:127], v[36:51]
 ds_read_b64_tr_b16 v[224:225], v14 offset:45056
 ds_read_b64_tr_b16 v[226:227], v14 offset:47104
 s_waitcnt lgkmcnt(10)
 s_waitcnt vmcnt(13)
 s_barrier
 v_mov_b32 v21, s66
 ds_read_b32 v169, v21 offset:35840
 v_mfma_f32_32x32x16_bf16 v[52:67], v[204:207], v[124:127], v[52:67]
 ds_read_b64_tr_b16 v[228:229], v15 offset:45056
 ds_read_b64_tr_b16 v[230:231], v15 offset:47104
 s_add_u32 s39, s69, 6144
 buffer_load_dwordx4 v6, s[12:15], s39 offen offset:2048 lds
 s_waitcnt lgkmcnt(10)
 v_mfma_f32_32x32x16_bf16 v[68:83], v[208:211], v[124:127], v[68:83]
 ds_read_b64_tr_b16 v[200:201], v16 offset:0
 ds_read_b64_tr_b16 v[202:203], v16 offset:2048
 s_waitcnt lgkmcnt(10)
 v_mfma_f32_32x32x16_bf16 v[84:99], v[212:215], v[124:127], v[84:99]
 ds_read_b64_tr_b16 v[204:205], v17 offset:0
 ds_read_b64_tr_b16 v[206:207], v17 offset:2048
 buffer_load_dwordx4 v[156:159], v4, s[8:11], s70 offen offset:2048 sc1
 s_waitcnt vmcnt(14) lgkmcnt(10)
 v_mfma_f32_32x32x16_bf16 v[36:51], v[216:219], v[128:131], v[36:51]
 ds_read_b64_tr_b16 v[208:209], v18 offset:0
 ds_read_b64_tr_b16 v[210:211], v18 offset:2048
 s_waitcnt lgkmcnt(10)
 v_mfma_f32_32x32x16_bf16 v[52:67], v[220:223], v[128:131], v[52:67]
 ds_read_b64_tr_b16 v[212:213], v19 offset:0
 ds_read_b64_tr_b16 v[214:215], v19 offset:2048
 s_waitcnt lgkmcnt(10)
 s_add_u32 s39, s69, 9216
 buffer_load_dwordx4 v6, s[12:15], s39 offen offset:3072 lds
 s_waitcnt lgkmcnt(10)
 v_mfma_f32_32x32x16_bf16 v[68:83], v[224:227], v[128:131], v[68:83]
 ds_read_b64_tr_b16 v[216:217], v16 offset:4096
 ds_read_b64_tr_b16 v[218:219], v16 offset:6144
 s_waitcnt lgkmcnt(10)
 v_mfma_f32_32x32x16_bf16 v[84:99], v[228:231], v[128:131], v[84:99]
 ds_read_b64_tr_b16 v[220:221], v17 offset:4096
 ds_read_b64_tr_b16 v[222:223], v17 offset:6144
 buffer_load_dwordx4 v[160:163], v4, s[8:11], s70 offen offset:3072 sc1
 s_waitcnt vmcnt(14) lgkmcnt(10)
 v_readfirstlane_b32 s49, v169
 s_and_b32 s48, s49, 63
 v_mfma_f32_32x32x16_bf16 v[36:51], v[200:203], v[132:135], v[36:51]
 ds_read_b64_tr_b16 v[224:225], v18 offset:4096
 ds_read_b64_tr_b16 v[226:227], v18 offset:6144
 s_waitcnt lgkmcnt(10)
 v_mfma_f32_32x32x16_bf16 v[52:67], v[204:207], v[132:135], v[52:67]
 ds_read_b64_tr_b16 v[228:229], v19 offset:4096
 ds_read_b64_tr_b16 v[230:231], v19 offset:6144
 s_lshl_b32 s69, s48, 16
 s_add_u32 s69, s69, s37
 s_add_u32 m0, s67, 0
 s_add_u32 s39, s69, 0
 buffer_load_dwordx4 v6, s[12:15], s39 offen offset:0 lds
 s_waitcnt lgkmcnt(10)
 s_cmp_eq_u32 s55, 4
 s_cbranch_scc0 C_NDN9_4
 s_waitcnt vmcnt(17)
 v_cmp_eq_u64 vcc, s[90:91], v[24:25]
 v_cmp_eq_u64 s[60:61], s[90:91], v[26:27]
 s_and_b64 s[60:61], vcc, s[60:61]
 s_lshr_b64 s[58:59], s[60:61], 1
 s_and_b64 s[58:59], s[58:59], s[60:61]
 s_andn2_b64 s[60:61], s[64:65], s[60:61]
 s_cselect_b64 s[58:59], 0, s[58:59]
 s_and_b64 s[60:61], s[58:59], s[56:57]
 s_cselect_b64 s[60:61], s[60:61], s[56:57]
 s_ff1_i32_b64 s40, s[60:61]
 s_bitset0_b64 s[56:57], s40
 s_bitcmp1_b64 s[58:59], s48
 s_cselect_b32 s44, 0x10000000, 0
 s_or_b32 s40, s40, s44
 v_mov_b32 v165, s40
 s_sub_u32 s44, s67, 0x4000
 v_add_u32 v20, s44, v164
 ds_write_b32 v20, v165 offset:3072
C_NDN9_4:
 v_mfma_f32_32x32x16_bf16 v[68:83], v[208:211], v[132:135], v[68:83]
 ds_read_b64_tr_b16 v[200:201], v16 offset:8192
 ds_read_b64_tr_b16 v[202:203], v16 offset:10240
 s_waitcnt lgkmcnt(10)
 v_mfma_f32_32x32x16_bf16 v[84:99], v[212:215], v[132:135], v[84:99]
 ds_read_b64_tr_b16 v[204:205], v17 offset:8192
 ds_read_b64_tr_b16 v[206:207], v17 offset:10240
 s_bitcmp1_b32 s49, 28
 s_cbranch_scc0 C_SLN9_4
C_SBN9_4:
 s_lshl_b32 s70, s47, 12
 s_add_u32 s70, s70, s36
 buffer_load_dwordx4 v[100:103], v4, s[8:11], s70 offen offset:0 sc1
 s_waitcnt vmcnt(14) lgkmcnt(10)
 v_mfma_f32_32x32x16_bf16 v[36:51], v[216:219], v[136:139], v[36:51]
 ds_read_b64_tr_b16 v[208:209], v18 offset:8192
 ds_read_b64_tr_b16 v[210:211], v18 offset:10240
 s_waitcnt lgkmcnt(10)
 v_mfma_f32_32x32x16_bf16 v[52:67], v[220:223], v[136:139], v[52:67]
 ds_read_b64_tr_b16 v[212:213], v19 offset:8192
 ds_read_b64_tr_b16 v[214:215], v19 offset:10240
 s_add_u32 s39, s69, 3072
 buffer_load_dwordx4 v6, s[12:15], s39 offen offset:1024 lds
 s_waitcnt lgkmcnt(10)
 v_mfma_f32_32x32x16_bf16 v[68:83], v[224:227], v[136:139], v[68:83]
 ds_read_b64_tr_b16 v[216:217], v16 offset:12288
 ds_read_b64_tr_b16 v[218:219], v16 offset:14336
 s_waitcnt lgkmcnt(10)
 v_mfma_f32_32x32x16_bf16 v[84:99], v[228:231], v[136:139], v[84:99]
 ds_read_b64_tr_b16 v[220:221], v17 offset:12288
 ds_read_b64_tr_b16 v[222:223], v17 offset:14336
 buffer_load_dwordx4 v[104:107], v4, s[8:11], s70 offen offset:1024 sc1
 s_waitcnt vmcnt(14) lgkmcnt(10)
 v_mfma_f32_32x32x16_bf16 v[36:51], v[200:203], v[140:143], v[36:51]
 ds_read_b64_tr_b16 v[224:225], v18 offset:12288
 ds_read_b64_tr_b16 v[226:227], v18 offset:14336
 s_waitcnt lgkmcnt(10)
 s_waitcnt vmcnt(13)
 s_barrier
 v_mov_b32 v21, s67
 ds_read_b32 v169, v21 offset:3072
 v_mfma_f32_32x32x16_bf16 v[52:67], v[204:207], v[140:143], v[52:67]
 ds_read_b64_tr_b16 v[228:229], v19 offset:12288
 ds_read_b64_tr_b16 v[230:231], v19 offset:14336
 s_add_u32 s39, s69, 6144
 buffer_load_dwordx4 v6, s[12:15], s39 offen offset:2048 lds
 s_waitcnt lgkmcnt(10)
 v_mfma_f32_32x32x16_bf16 v[68:83], v[208:211], v[140:143], v[68:83]
 ds_read_b64_tr_b16 v[200:201], v8 offset:0
 ds_read_b64_tr_b16 v[202:203], v8 offset:2048
 s_waitcnt lgkmcnt(10)
 v_mfma_f32_32x32x16_bf16 v[84:99], v[212:215], v[140:143], v[84:99]
 ds_read_b64_tr_b16 v[204:205], v9 offset:0
 ds_read_b64_tr_b16 v[206:207], v9 offset:2048
 buffer_load_dwordx4 v[108:111], v4, s[8:11], s70 offen offset:2048 sc1
 s_waitcnt vmcnt(14) lgkmcnt(10)
 v_mfma_f32_32x32x16_bf16 v[36:51], v[216:219], v[144:147], v[36:51]
 ds_read_b64_tr_b16 v[208:209], v10 offset:0
 ds_read_b64_tr_b16 v[210:211], v10 offset:2048
 s_waitcnt lgkmcnt(10)
 v_mfma_f32_32x32x16_bf16 v[52:67], v[220:223], v[144:147], v[52:67]
 ds_read_b64_tr_b16 v[212:213], v11 offset:0
 ds_read_b64_tr_b16 v[214:215], v11 offset:2048
 s_waitcnt lgkmcnt(10)
 s_add_u32 s39, s69, 9216
 buffer_load_dwordx4 v6, s[12:15], s39 offen offset:3072 lds
 s_waitcnt lgkmcnt(10)
 v_mfma_f32_32x32x16_bf16 v[68:83], v[224:227], v[144:147], v[68:83]
 ds_read_b64_tr_b16 v[216:217], v8 offset:4096
 ds_read_b64_tr_b16 v[218:219], v8 offset:6144
 s_waitcnt lgkmcnt(10)
 v_mfma_f32_32x32x16_bf16 v[84:99], v[228:231], v[144:147], v[84:99]
 ds_read_b64_tr_b16 v[220:221], v9 offset:4096
 ds_read_b64_tr_b16 v[222:223], v9 offset:6144
 buffer_load_dwordx4 v[112:115], v4, s[8:11], s70 offen offset:3072 sc1
 s_waitcnt vmcnt(14) lgkmcnt(10)
 v_readfirstlane_b32 s49, v169
 s_and_b32 s45, s49, 63
 v_mfma_f32_32x32x16_bf16 v[36:51], v[200:203], v[148:151], v[36:51]
 ds_read_b64_tr_b16 v[224:225], v10 offset:4096
 ds_read_b64_tr_b16 v[226:227], v10 offset:6144
 s_waitcnt lgkmcnt(10)
 v_mfma_f32_32x32x16_bf16 v[52:67], v[204:207], v[148:151], v[52:67]
 ds_read_b64_tr_b16 v[228:229], v11 offset:4096
 ds_read_b64_tr_b16 v[230:231], v11 offset:6144
 s_lshl_b32 s69, s45, 16
 s_add_u32 s69, s69, s37
 s_add_u32 m0, s67, 32768
 s_add_u32 s39, s69, 0
 buffer_load_dwordx4 v6, s[12:15], s39 offen offset:0 lds
 s_waitcnt lgkmcnt(10)
 s_cmp_eq_u32 s55, 4
 s_cbranch_scc0 C_NDN9_5
 s_waitcnt vmcnt(16)
 v_cmp_eq_u64 vcc, s[90:91], v[28:29]
 v_cmp_eq_u64 s[60:61], s[90:91], v[30:31]
 s_and_b64 s[60:61], vcc, s[60:61]
 s_lshr_b64 s[58:59], s[60:61], 1
 s_and_b64 s[58:59], s[58:59], s[60:61]
 s_andn2_b64 s[60:61], s[64:65], s[60:61]
 s_cselect_b64 s[58:59], 0, s[58:59]
 s_mov_b32 s40, 0
 s_bitcmp1_b64 s[58:59], s45
 s_cselect_b32 s44, 0x10000000, 0
 s_or_b32 s40, s40, s44
 v_mov_b32 v165, s40
 s_sub_u32 s44, s67, 0x4000
 v_add_u32 v20, s44, v164
 ds_write_b32 v20, v165 offset:35840
C_NDN9_5:
 v_mfma_f32_32x32x16_bf16 v[68:83], v[208:211], v[148:151], v[68:83]
 ds_read_b64_tr_b16 v[200:201], v8 offset:8192
 ds_read_b64_tr_b16 v[202:203], v8 offset:10240
 s_waitcnt lgkmcnt(10)
 v_mfma_f32_32x32x16_bf16 v[84:99], v[212:215], v[148:151], v[84:99]
 ds_read_b64_tr_b16 v[204:205], v9 offset:8192
 ds_read_b64_tr_b16 v[206:207], v9 offset:10240
 s_bitcmp1_b32 s49, 28
 s_cbranch_scc0 C_SLN9_5
C_SBN9_5:
 s_lshl_b32 s70, s48, 12
 s_add_u32 s70, s70, s36
 buffer_load_dwordx4 v[116:119], v4, s[8:11], s70 offen offset:0 sc1
 s_waitcnt vmcnt(14) lgkmcnt(10)
 v_mfma_f32_32x32x16_bf16 v[36:51], v[216:219], v[152:155], v[36:51]
 ds_read_b64_tr_b16 v[208:209], v10 offset:8192
 ds_read_b64_tr_b16 v[210:211], v10 offset:10240
 s_waitcnt lgkmcnt(10)
 v_mfma_f32_32x32x16_bf16 v[52:67], v[220:223], v[152:155], v[52:67]
 ds_read_b64_tr_b16 v[212:213], v11 offset:8192
 ds_read_b64_tr_b16 v[214:215], v11 offset:10240
 s_add_u32 s39, s69, 3072
 buffer_load_dwordx4 v6, s[12:15], s39 offen offset:1024 lds
 s_waitcnt lgkmcnt(10)
 v_mfma_f32_32x32x16_bf16 v[68:83], v[224:227], v[152:155], v[68:83]
 ds_read_b64_tr_b16 v[216:217], v8 offset:12288
 ds_read_b64_tr_b16 v[218:219], v8 offset:14336
 s_waitcnt lgkmcnt(10)
 v_mfma_f32_32x32x16_bf16 v[84:99], v[228:231], v[152:155], v[84:99]
 ds_read_b64_tr_b16 v[220:221], v9 offset:12288
 ds_read_b64_tr_b16 v[222:223], v9 offset:14336
 buffer_load_dwordx4 v[120:123], v4, s[8:11], s70 offen offset:1024 sc1
 s_waitcnt vmcnt(14) lgkmcnt(10)
 v_mfma_f32_32x32x16_bf16 v[36:51], v[200:203], v[156:159], v[36:51]
 ds_read_b64_tr_b16 v[224:225], v10 offset:12288
 ds_read_b64_tr_b16 v[226:227], v10 offset:14336
 s_waitcnt lgkmcnt(10)
 s_waitcnt vmcnt(13)
 s_barrier
 v_mov_b32 v21, s67
 ds_read_b32 v169, v21 offset:35840
 v_mfma_f32_32x32x16_bf16 v[52:67], v[204:207], v[156:159], v[52:67]
 ds_read_b64_tr_b16 v[228:229], v11 offset:12288
 ds_read_b64_tr_b16 v[230:231], v11 offset:14336
 s_add_u32 s39, s69, 6144
 buffer_load_dwordx4 v6, s[12:15], s39 offen offset:2048 lds
 s_waitcnt lgkmcnt(10)
 v_mfma_f32_32x32x16_bf16 v[68:83], v[208:211], v[156:159], v[68:83]
 ds_read_b64_tr_b16 v[200:201], v8 offset:32768
 ds_read_b64_tr_b16 v[202:203], v8 offset:34816
 s_waitcnt lgkmcnt(10)
 v_mfma_f32_32x32x16_bf16 v[84:99], v[212:215], v[156:159], v[84:99]
 ds_read_b64_tr_b16 v[204:205], v9 offset:32768
 ds_read_b64_tr_b16 v[206:207], v9 offset:34816
 buffer_load_dwordx4 v[124:127], v4, s[8:11], s70 offen offset:2048 sc1
 s_waitcnt vmcnt(14) lgkmcnt(10)
 v_mfma_f32_32x32x16_bf16 v[36:51], v[216:219], v[160:163], v[36:51]
 ds_read_b64_tr_b16 v[208:209], v10 offset:32768
 ds_read_b64_tr_b16 v[210:211], v10 offset:34816
 s_waitcnt lgkmcnt(10)
 v_mfma_f32_32x32x16_bf16 v[52:67], v[220:223], v[160:163], v[52:67]
 ds_read_b64_tr_b16 v[212:213], v11 offset:32768
 ds_read_b64_tr_b16 v[214:215], v11 offset:34816
 s_waitcnt lgkmcnt(10)
 s_add_u32 s39, s69, 9216
 buffer_load_dwordx4 v6, s[12:15], s39 offen offset:3072 lds
 s_waitcnt lgkmcnt(10)
 v_mfma_f32_32x32x16_bf16 v[68:83], v[224:227], v[160:163], v[68:83]
 ds_read_b64_tr_b16 v[216:217], v8 offset:36864
 ds_read_b64_tr_b16 v[218:219], v8 offset:38912
 s_waitcnt lgkmcnt(10)
 v_mfma_f32_32x32x16_bf16 v[84:99], v[228:231], v[160:163], v[84:99]
 ds_read_b64_tr_b16 v[220:221], v9 offset:36864
 ds_read_b64_tr_b16 v[222:223], v9 offset:38912
 buffer_load_dwordx4 v[128:131], v4, s[8:11], s70 offen offset:3072 sc1
 s_waitcnt vmcnt(14) lgkmcnt(10)
 v_readfirstlane_b32 s49, v169
 v_mfma_f32_32x32x16_bf16 v[36:51], v[200:203], v[100:103], v[36:51]
 ds_read_b64_tr_b16 v[224:225], v10 offset:36864
 ds_read_b64_tr_b16 v[226:227], v10 offset:38912
 s_waitcnt lgkmcnt(10)
 v_mfma_f32_32x32x16_bf16 v[52:67], v[204:207], v[100:103], v[52:67]
 ds_read_b64_tr_b16 v[228:229], v11 offset:36864
 ds_read_b64_tr_b16 v[230:231], v11 offset:38912
 s_waitcnt lgkmcnt(10)
 v_mfma_f32_32x32x16_bf16 v[68:83], v[208:211], v[100:103], v[68:83]
 ds_read_b64_tr_b16 v[200:201], v8 offset:40960
 ds_read_b64_tr_b16 v[202:203], v8 offset:43008
 s_waitcnt lgkmcnt(10)
 v_mfma_f32_32x32x16_bf16 v[84:99], v[212:215], v[100:103], v[84:99]
 ds_read_b64_tr_b16 v[204:205], v9 offset:40960
 ds_read_b64_tr_b16 v[206:207], v9 offset:43008
 s_bitcmp1_b32 s49, 28
 s_cbranch_scc0 C_SLN9_6
C_SBN9_6:
 s_lshl_b32 s70, s45, 12
 s_add_u32 s70, s70, s36
 buffer_load_dwordx4 v[132:135], v4, s[8:11], s70 offen offset:0 sc1
 s_waitcnt vmcnt(13) lgkmcnt(10)
 v_mfma_f32_32x32x16_bf16 v[36:51], v[216:219], v[104:107], v[36:51]
 ds_read_b64_tr_b16 v[208:209], v10 offset:40960
 ds_read_b64_tr_b16 v[210:211], v10 offset:43008
 s_waitcnt lgkmcnt(10)
 v_mfma_f32_32x32x16_bf16 v[52:67], v[220:223], v[104:107], v[52:67]
 ds_read_b64_tr_b16 v[212:213], v11 offset:40960
 ds_read_b64_tr_b16 v[214:215], v11 offset:43008
 s_waitcnt lgkmcnt(10)
 v_mfma_f32_32x32x16_bf16 v[68:83], v[224:227], v[104:107], v[68:83]
 ds_read_b64_tr_b16 v[216:217], v8 offset:45056
 ds_read_b64_tr_b16 v[218:219], v8 offset:47104
 s_waitcnt lgkmcnt(10)
 v_mfma_f32_32x32x16_bf16 v[84:99], v[228:231], v[104:107], v[84:99]
 ds_read_b64_tr_b16 v[220:221], v9 offset:45056
 ds_read_b64_tr_b16 v[222:223], v9 offset:47104
 buffer_load_dwordx4 v[136:139], v4, s[8:11], s70 offen offset:1024 sc1
 s_waitcnt vmcnt(12) lgkmcnt(10)
 v_mfma_f32_32x32x16_bf16 v[36:51], v[200:203], v[108:111], v[36:51]
 ds_read_b64_tr_b16 v[224:225], v10 offset:45056
 ds_read_b64_tr_b16 v[226:227], v10 offset:47104
 s_waitcnt lgkmcnt(10)
 s_waitcnt vmcnt(11)
 s_barrier
 v_mfma_f32_32x32x16_bf16 v[52:67], v[204:207], v[108:111], v[52:67]
 ds_read_b64_tr_b16 v[228:229], v11 offset:45056
 ds_read_b64_tr_b16 v[230:231], v11 offset:47104
 s_waitcnt lgkmcnt(10)
 v_mfma_f32_32x32x16_bf16 v[68:83], v[208:211], v[108:111], v[68:83]
 ds_read_b64_tr_b16 v[200:201], v12 offset:0
 ds_read_b64_tr_b16 v[202:203], v12 offset:2048
 s_waitcnt lgkmcnt(10)
 v_mfma_f32_32x32x16_bf16 v[84:99], v[212:215], v[108:111], v[84:99]
 ds_read_b64_tr_b16 v[204:205], v13 offset:0
 ds_read_b64_tr_b16 v[206:207], v13 offset:2048
 buffer_load_dwordx4 v[140:143], v4, s[8:11], s70 offen offset:2048 sc1
 s_waitcnt vmcnt(11) lgkmcnt(10)
 v_mfma_f32_32x32x16_bf16 v[36:51], v[216:219], v[112:115], v[36:51]
 ds_read_b64_tr_b16 v[208:209], v14 offset:0
 ds_read_b64_tr_b16 v[210:211], v14 offset:2048
 s_waitcnt lgkmcnt(10)
 v_mfma_f32_32x32x16_bf16 v[52:67], v[220:223], v[112:115], v[52:67]
 ds_read_b64_tr_b16 v[212:213], v15 offset:0
 ds_read_b64_tr_b16 v[214:215], v15 offset:2048
 s_waitcnt lgkmcnt(10)
 v_mfma_f32_32x32x16_bf16 v[68:83], v[224:227], v[112:115], v[68:83]
 ds_read_b64_tr_b16 v[216:217], v12 offset:4096
 ds_read_b64_tr_b16 v[218:219], v12 offset:6144
 s_waitcnt lgkmcnt(10)
 v_mfma_f32_32x32x16_bf16 v[84:99], v[228:231], v[112:115], v[84:99]
 ds_read_b64_tr_b16 v[220:221], v13 offset:4096
 ds_read_b64_tr_b16 v[222:223], v13 offset:6144
 buffer_load_dwordx4 v[144:147], v4, s[8:11], s70 offen offset:3072 sc1
 s_waitcnt vmcnt(10) lgkmcnt(10)
 v_mfma_f32_32x32x16_bf16 v[36:51], v[200:203], v[116:119], v[36:51]
 ds_read_b64_tr_b16 v[224:225], v14 offset:4096
 ds_read_b64_tr_b16 v[226:227], v14 offset:6144
 s_waitcnt lgkmcnt(10)
 v_mfma_f32_32x32x16_bf16 v[52:67], v[204:207], v[116:119], v[52:67]
 ds_read_b64_tr_b16 v[228:229], v15 offset:4096
 ds_read_b64_tr_b16 v[230:231], v15 offset:6144
 s_waitcnt lgkmcnt(10)
 v_mfma_f32_32x32x16_bf16 v[68:83], v[208:211], v[116:119], v[68:83]
 ds_read_b64_tr_b16 v[200:201], v12 offset:8192
 ds_read_b64_tr_b16 v[202:203], v12 offset:10240
 s_waitcnt lgkmcnt(10)
 v_mfma_f32_32x32x16_bf16 v[84:99], v[212:215], v[116:119], v[84:99]
 ds_read_b64_tr_b16 v[204:205], v13 offset:8192
 ds_read_b64_tr_b16 v[206:207], v13 offset:10240
 s_waitcnt vmcnt(8) lgkmcnt(10)
 v_mfma_f32_32x32x16_bf16 v[36:51], v[216:219], v[120:123], v[36:51]
 ds_read_b64_tr_b16 v[208:209], v14 offset:8192
 ds_read_b64_tr_b16 v[210:211], v14 offset:10240
 s_waitcnt lgkmcnt(10)
 v_mfma_f32_32x32x16_bf16 v[52:67], v[220:223], v[120:123], v[52:67]
 ds_read_b64_tr_b16 v[212:213], v15 offset:8192
 ds_read_b64_tr_b16 v[214:215], v15 offset:10240
 s_add_u32 s16, s4, 0x8000000
 s_addc_u32 s17, s5, 0
 s_and_b32 s17, s17, 0xffff
 s_mov_b32 s18, 0x1000000
 s_mov_b32 s19, 0x00020000
 s_mov_b32 s20, s78
 s_and_b32 s21, s79, 0xffff
 s_mov_b32 s22, 0x200000
 s_mov_b32 s23, 0x00020000
 s_mov_b32 s24, s80
 s_and_b32 s25, s81, 0xffff
 s_mov_b32 s26, 0x200000
 s_mov_b32 s27, 0x00020000
 s_lshl_b32 s39, s32, 2
 s_add_u32 s40, s39, s33
 s_lshl_b32 s40, s40, 3
 s_add_u32 s40, s40, s55
 s_lshl_b32 s40, s40, 13
 s_mul_i32 s71, s31, 0x400000
 s_add_u32 s71, s71, s40
 s_add_u32 s72, s71, 4096
 s_lshl_b32 s28, s31, 7
 s_add_u32 s28, s28, s40
 s_add_u32 s29, s28, 0x400000
 s_add_u32 s30, s28, 0x800000
 s_add_u32 s41, s28, 0xc00000
 s_add_u32 s39, s39, s35
 s_lshl_b32 s39, s39, 2
 s_add_u32 s39, s39, s31
 s_lshl_b32 s73, s39, 13
 s_lshl_b32 s40, s33, 1
 s_add_u32 s40, s40, s34
 s_lshl_b32 s40, s40, 7
 s_add_u32 s73, s73, s40
 s_lshl_b32 s39, s31, 3
 s_lshl_b32 s42, 0xff, s39
 s_mov_b32 s43, s42
 v_lshrrev_b32 v20, 3, v0
 v_and_b32 v21, 7, v0
 v_lshlrev_b32 v168, 10, v20
 v_lshl_add_u32 v168, v21, 4, v168
 v_lshlrev_b32 v172, 9, v21
 v_lshl_add_u32 v172, v20, 4, v172
 v_lshrrev_b32 v22, 1, v21
 v_mul_u32_u24 v22, 1024, v22
 v_add_u32 v173, v22, v172
 v_lshl_add_u32 v22, v21, 9, v172
 s_cmp_eq_u32 s31, 0
 s_cselect_b64 vcc, -1, 0
 v_cndmask_b32 v172, v22, v172, vcc
 buffer_load_dwordx4 v[176:179], v168, s[20:23], s73 offen
 s_waitcnt lgkmcnt(10)
 v_mfma_f32_32x32x16_bf16 v[68:83], v[224:227], v[120:123], v[68:83]
 ds_read_b64_tr_b16 v[216:217], v12 offset:12288
 ds_read_b64_tr_b16 v[218:219], v12 offset:14336
 s_waitcnt lgkmcnt(10)
 v_mfma_f32_32x32x16_bf16 v[84:99], v[228:231], v[120:123], v[84:99]
 ds_read_b64_tr_b16 v[220:221], v13 offset:12288
 ds_read_b64_tr_b16 v[222:223], v13 offset:14336
 s_waitcnt vmcnt(7) lgkmcnt(10)
 v_mfma_f32_32x32x16_bf16 v[36:51], v[200:203], v[124:127], v[36:51]
 ds_read_b64_tr_b16 v[224:225], v14 offset:12288
 ds_read_b64_tr_b16 v[226:227], v14 offset:14336
 s_waitcnt lgkmcnt(10)
 s_waitcnt vmcnt(6)
 s_barrier
 v_mfma_f32_32x32x16_bf16 v[52:67], v[204:207], v[124:127], v[52:67]
 ds_read_b64_tr_b16 v[228:229], v15 offset:12288
 ds_read_b64_tr_b16 v[230:231], v15 offset:14336
 s_waitcnt lgkmcnt(10)
 v_mfma_f32_32x32x16_bf16 v[68:83], v[208:211], v[124:127], v[68:83]
 ds_read_b64_tr_b16 v[200:201], v12 offset:32768
 ds_read_b64_tr_b16 v[202:203], v12 offset:34816
 s_waitcnt lgkmcnt(10)
 v_mfma_f32_32x32x16_bf16 v[84:99], v[212:215], v[124:127], v[84:99]
 ds_read_b64_tr_b16 v[204:205], v13 offset:32768
 ds_read_b64_tr_b16 v[206:207], v13 offset:34816
 s_waitcnt vmcnt(5) lgkmcnt(10)
 v_mfma_f32_32x32x16_bf16 v[36:51], v[216:219], v[128:131], v[36:51]
 ds_read_b64_tr_b16 v[208:209], v14 offset:32768
 ds_read_b64_tr_b16 v[210:211], v14 offset:34816
 s_waitcnt lgkmcnt(10)
 v_mfma_f32_32x32x16_bf16 v[52:67], v[220:223], v[128:131], v[52:67]
 ds_read_b64_tr_b16 v[212:213], v15 offset:32768
 ds_read_b64_tr_b16 v[214:215], v15 offset:34816
 s_waitcnt lgkmcnt(10)
 v_mfma_f32_32x32x16_bf16 v[68:83], v[224:227], v[128:131], v[68:83]
 ds_read_b64_tr_b16 v[216:217], v12 offset:36864
 ds_read_b64_tr_b16 v[218:219], v12 offset:38912
 s_waitcnt lgkmcnt(10)
 v_mfma_f32_32x32x16_bf16 v[84:99], v[228:231], v[128:131], v[84:99]
 ds_read_b64_tr_b16 v[220:221], v13 offset:36864
 ds_read_b64_tr_b16 v[222:223], v13 offset:38912
 s_waitcnt vmcnt(4) lgkmcnt(10)
 v_mfma_f32_32x32x16_bf16 v[36:51], v[200:203], v[132:135], v[36:51]
 ds_read_b64_tr_b16 v[224:225], v14 offset:36864
 ds_read_b64_tr_b16 v[226:227], v14 offset:38912
 s_waitcnt lgkmcnt(10)
 v_mfma_f32_32x32x16_bf16 v[52:67], v[204:207], v[132:135], v[52:67]
 ds_read_b64_tr_b16 v[228:229], v15 offset:36864
 ds_read_b64_tr_b16 v[230:231], v15 offset:38912
 s_waitcnt lgkmcnt(10)
 v_mfma_f32_32x32x16_bf16 v[68:83], v[208:211], v[132:135], v[68:83]
 ds_read_b64_tr_b16 v[200:201], v12 offset:40960
 ds_read_b64_tr_b16 v[202:203], v12 offset:43008
 s_waitcnt lgkmcnt(10)
 v_mfma_f32_32x32x16_bf16 v[84:99], v[212:215], v[132:135], v[84:99]
 ds_read_b64_tr_b16 v[204:205], v13 offset:40960
 ds_read_b64_tr_b16 v[206:207], v13 offset:43008
 s_waitcnt vmcnt(3) lgkmcnt(10)
 v_mfma_f32_32x32x16_bf16 v[36:51], v[216:219], v[136:139], v[36:51]
 ds_read_b64_tr_b16 v[208:209], v14 offset:40960
 ds_read_b64_tr_b16 v[210:211], v14 offset:43008
 s_waitcnt lgkmcnt(10)
 v_mfma_f32_32x32x16_bf16 v[52:67], v[220:223], v[136:139], v[52:67]
 ds_read_b64_tr_b16 v[212:213], v15 offset:40960
 ds_read_b64_tr_b16 v[214:215], v15 offset:43008
 s_waitcnt lgkmcnt(10)
 v_mfma_f32_32x32x16_bf16 v[68:83], v[224:227], v[136:139], v[68:83]
 ds_read_b64_tr_b16 v[216:217], v12 offset:45056
 ds_read_b64_tr_b16 v[218:219], v12 offset:47104
 s_waitcnt lgkmcnt(10)
 v_mfma_f32_32x32x16_bf16 v[84:99], v[228:231], v[136:139], v[84:99]
 ds_read_b64_tr_b16 v[220:221], v13 offset:45056
 ds_read_b64_tr_b16 v[222:223], v13 offset:47104
 s_waitcnt vmcnt(2) lgkmcnt(10)
 v_mfma_f32_32x32x16_bf16 v[36:51], v[200:203], v[140:143], v[36:51]
 ds_read_b64_tr_b16 v[224:225], v14 offset:45056
 ds_read_b64_tr_b16 v[226:227], v14 offset:47104
 s_waitcnt lgkmcnt(10)
 v_mfma_f32_32x32x16_bf16 v[52:67], v[204:207], v[140:143], v[52:67]
 ds_read_b64_tr_b16 v[228:229], v15 offset:45056
 ds_read_b64_tr_b16 v[230:231], v15 offset:47104
 s_waitcnt lgkmcnt(10)
 v_mfma_f32_32x32x16_bf16 v[68:83], v[208:211], v[140:143], v[68:83]
 s_waitcnt lgkmcnt(8)
 v_mfma_f32_32x32x16_bf16 v[84:99], v[212:215], v[140:143], v[84:99]
 s_waitcnt vmcnt(1) lgkmcnt(6)
 v_mfma_f32_32x32x16_bf16 v[36:51], v[216:219], v[144:147], v[36:51]
 s_waitcnt lgkmcnt(4)
 v_mfma_f32_32x32x16_bf16 v[52:67], v[220:223], v[144:147], v[52:67]
 s_waitcnt lgkmcnt(2)
 v_mfma_f32_32x32x16_bf16 v[68:83], v[224:227], v[144:147], v[68:83]
 s_waitcnt lgkmcnt(0)
 v_mfma_f32_32x32x16_bf16 v[84:99], v[228:231], v[144:147], v[84:99]
 s_add_u32 s39, s66, 32768
 s_add_u32 s40, s66, 0
 s_add_u32 s44, s68, 0
 s_branch C_EPI
C_MAINN11:
 ds_read_b32 v169, v5 offset:4
 ds_read_b64_tr_b16 v[200:201], v8 offset:0
 ds_read_b64_tr_b16 v[202:203], v8 offset:2048
 ds_read_b64_tr_b16 v[204:205], v9 offset:0
 ds_read_b64_tr_b16 v[206:207], v9 offset:2048
 ds_read_b64_tr_b16 v[208:209], v10 offset:0
 ds_read_b64_tr_b16 v[210:211], v10 offset:2048
 ds_read_b64_tr_b16 v[212:213], v11 offset:0
 ds_read_b64_tr_b16 v[214:215], v11 offset:2048
 ds_read_b64_tr_b16 v[216:217], v8 offset:4096
 ds_read_b64_tr_b16 v[218:219], v8 offset:6144
 ds_read_b64_tr_b16 v[220:221], v9 offset:4096
 ds_read_b64_tr_b16 v[222:223], v9 offset:6144
 s_waitcnt vmcnt(15) lgkmcnt(10)
 v_readfirstlane_b32 s49, v169
 s_bfe_u32 s47, s49, 0x6000e
 s_bfe_u32 s48, s49, 0x60014
 v_mfma_f32_32x32x16_bf16 v[36:51], v[200:203], v[132:135], v[36:51]
 ds_read_b64_tr_b16 v[224:225], v10 offset:4096
 ds_read_b64_tr_b16 v[226:227], v10 offset:6144
 s_waitcnt lgkmcnt(10)
 v_mfma_f32_32x32x16_bf16 v[52:67], v[204:207], v[132:135], v[52:67]
 ds_read_b64_tr_b16 v[228:229], v11 offset:4096
 ds_read_b64_tr_b16 v[230:231], v11 offset:6144
 s_lshl_b32 s69, s48, 16
 s_add_u32 s69, s69, s37
 s_add_u32 m0, s67, 32768
 s_add_u32 s39, s69, 0
 buffer_load_dwordx4 v6, s[12:15], s39 offen offset:0 lds
 s_waitcnt lgkmcnt(10)
 s_cmp_eq_u32 s55, 4
 s_cbranch_scc0 C_NDN11_0
 s_waitcnt vmcnt(2)
 v_cmp_eq_u64 vcc, s[90:91], v[24:25]
 v_cmp_eq_u64 s[60:61], s[90:91], v[26:27]
 s_and_b64 s[60:61], vcc, s[60:61]
 s_lshr_b64 s[58:59], s[60:61], 1
 s_and_b64 s[58:59], s[58:59], s[60:61]
 s_andn2_b64 s[60:61], s[64:65], s[60:61]
 s_cselect_b64 s[58:59], 0, s[58:59]
 s_and_b64 s[60:61], s[58:59], s[56:57]
 s_cselect_b64 s[60:61], s[60:61], s[56:57]
 s_ff1_i32_b64 s40, s[60:61]
 s_bitset0_b64 s[56:57], s40
 s_bitcmp1_b64 s[58:59], s48
 s_cselect_b32 s44, 0x10000000, 0
 s_or_b32 s40, s40, s44
 v_mov_b32 v165, s40
 s_sub_u32 s44, s67, 0x4000
 v_add_u32 v20, s44, v164
 ds_write_b32 v20, v165 offset:35840
 buffer_load_dwordx4 v[24:27], v4, s[96:99], s50 offen sc1
C_NDN11_0:
 v_mfma_f32_32x32x16_bf16 v[68:83], v[208:211], v[132:135], v[68:83]
 ds_read_b64_tr_b16 v[200:201], v8 offset:8192
 ds_read_b64_tr_b16 v[202:203], v8 offset:10240
 s_waitcnt lgkmcnt(10)
 v_mfma_f32_32x32x16_bf16 v[84:99], v[212:215], v[132:135], v[84:99]
 ds_read_b64_tr_b16 v[204:205], v9 offset:8192
 ds_read_b64_tr_b16 v[206:207], v9 offset:10240
 s_bitcmp1_b32 s49, 28
 s_cbranch_scc0 C_SLN11_0
C_SBN11_0:
 s_lshl_b32 s70, s47, 12
 s_add_u32 s70, s70, s36
 buffer_load_dwordx4 v[100:103], v4, s[8:11], s70 offen offset:0 sc1
 s_waitcnt vmcnt(16) lgkmcnt(10)
 v_mfma_f32_32x32x16_bf16 v[36:51], v[216:219], v[136:139], v[36:51]
 ds_read_b64_tr_b16 v[208:209], v10 offset:8192
 ds_read_b64_tr_b16 v[210:211], v10 offset:10240
 s_waitcnt lgkmcnt(10)
 v_mfma_f32_32x32x16_bf16 v[52:67], v[220:223], v[136:139], v[52:67]
 ds_read_b64_tr_b16 v[212:213], v11 offset:8192
 ds_read_b64_tr_b16 v[214:215], v11 offset:10240
 s_add_u32 s39, s69, 3072
 buffer_load_dwordx4 v6, s[12:15], s39 offen offset:1024 lds
 s_waitcnt lgkmcnt(10)
 v_mfma_f32_32x32x16_bf16 v[68:83], v[224:227], v[136:139], v[68:83]
 ds_read_b64_tr_b16 v[216:217], v8 offset:12288
 ds_read_b64_tr_b16 v[218:219], v8 offset:14336
 s_waitcnt lgkmcnt(10)
 v_mfma_f32_32x32x16_bf16 v[84:99], v[228:231], v[136:139], v[84:99]
 ds_read_b64_tr_b16 v[220:221], v9 offset:12288
 ds_read_b64_tr_b16 v[222:223], v9 offset:14336
 buffer_load_dwordx4 v[104:107], v4, s[8:11], s70 offen offset:1024 sc1
 s_waitcnt vmcnt(17) lgkmcnt(10)
 v_mfma_f32_32x32x16_bf16 v[36:51], v[200:203], v[140:143], v[36:51]
 ds_read_b64_tr_b16 v[224:225], v10 offset:12288
 ds_read_b64_tr_b16 v[226:227], v10 offset:14336
 s_waitcnt lgkmcnt(10)
 s_waitcnt vmcnt(20)
 s_barrier
 v_mov_b32 v21, s67
 ds_read_b32 v169, v21 offset:35840
 v_mfma_f32_32x32x16_bf16 v[52:67], v[204:207], v[140:143], v[52:67]
 ds_read_b64_tr_b16 v[228:229], v11 offset:12288
 ds_read_b64_tr_b16 v[230:231], v11 offset:14336
 s_add_u32 s39, s69, 6144
 buffer_load_dwordx4 v6, s[12:15], s39 offen offset:2048 lds
 s_waitcnt lgkmcnt(10)
 v_mfma_f32_32x32x16_bf16 v[68:83], v[208:211], v[140:143], v[68:83]
 ds_read_b64_tr_b16 v[200:201], v8 offset:32768
 ds_read_b64_tr_b16 v[202:203], v8 offset:34816
 s_waitcnt lgkmcnt(10)
 v_mfma_f32_32x32x16_bf16 v[84:99], v[212:215], v[140:143], v[84:99]
 ds_read_b64_tr_b16 v[204:205], v9 offset:32768
 ds_read_b64_tr_b16 v[206:207], v9 offset:34816
 buffer_load_dwordx4 v[108:111], v4, s[8:11], s70 offen offset:2048 sc1
 s_waitcnt vmcnt(18) lgkmcnt(10)
 v_mfma_f32_32x32x16_bf16 v[36:51], v[216:219], v[144:147], v[36:51]
 ds_read_b64_tr_b16 v[208:209], v10 offset:32768
 ds_read_b64_tr_b16 v[210:211], v10 offset:34816
 s_waitcnt lgkmcnt(10)
 v_mfma_f32_32x32x16_bf16 v[52:67], v[220:223], v[144:147], v[52:67]
 ds_read_b64_tr_b16 v[212:213], v11 offset:32768
 ds_read_b64_tr_b16 v[214:215], v11 offset:34816
 s_waitcnt lgkmcnt(10)
 s_add_u32 s39, s69, 9216
 buffer_load_dwordx4 v6, s[12:15], s39 offen offset:3072 lds
 s_waitcnt lgkmcnt(10)
 v_mfma_f32_32x32x16_bf16 v[68:83], v[224:227], v[144:147], v[68:83]
 ds_read_b64_tr_b16 v[216:217], v8 offset:36864
 ds_read_b64_tr_b16 v[218:219], v8 offset:38912
 s_waitcnt lgkmcnt(10)
 v_mfma_f32_32x32x16_bf16 v[84:99], v[228:231], v[144:147], v[84:99]
 ds_read_b64_tr_b16 v[220:221], v9 offset:36864
 ds_read_b64_tr_b16 v[222:223], v9 offset:38912
 buffer_load_dwordx4 v[112:115], v4, s[8:11], s70 offen offset:3072 sc1
 s_waitcnt vmcnt(19) lgkmcnt(10)
 v_readfirstlane_b32 s49, v169
 s_and_b32 s45, s49, 63
 v_mfma_f32_32x32x16_bf16 v[36:51], v[200:203], v[148:151], v[36:51]
 ds_read_b64_tr_b16 v[224:225], v10 offset:36864
 ds_read_b64_tr_b16 v[226:227], v10 offset:38912
 s_waitcnt lgkmcnt(10)
 v_mfma_f32_32x32x16_bf16 v[52:67], v[204:207], v[148:151], v[52:67]
 ds_read_b64_tr_b16 v[228:229], v11 offset:36864
 ds_read_b64_tr_b16 v[230:231], v11 offset:38912
 s_lshl_b32 s69, s45, 16
 s_add_u32 s69, s69, s37
 s_add_u32 m0, s68, 0
 s_add_u32 s39, s69, 0
 buffer_load_dwordx4 v6, s[12:15], s39 offen offset:0 lds
 s_waitcnt lgkmcnt(10)
 s_cmp_eq_u32 s55, 4
 s_cbranch_scc0 C_NDN11_1
 s_waitcnt vmcnt(10)
 v_cmp_eq_u64 vcc, s[90:91], v[28:29]
 v_cmp_eq_u64 s[60:61], s[90:91], v[30:31]
 s_and_b64 s[60:61], vcc, s[60:61]
 s_lshr_b64 s[58:59], s[60:61], 1
 s_and_b64 s[58:59], s[58:59], s[60:61]
 s_andn2_b64 s[60:61], s[64:65], s[60:61]
 s_cselect_b64 s[58:59], 0, s[58:59]
 s_and_b64 s[60:61], s[58:59], s[56:57]
 s_cselect_b64 s[60:61], s[60:61], s[56:57]
 s_ff1_i32_b64 s40, s[60:61]
 s_bitset0_b64 s[56:57], s40
 s_bitcmp1_b64 s[58:59], s45
 s_cselect_b32 s44, 0x10000000, 0
 s_or_b32 s40, s40, s44
 v_mov_b32 v165, s40
 s_sub_u32 s44, s68, 0x4000
 v_add_u32 v20, s44, v164
 ds_write_b32 v20, v165 offset:3072
 buffer_load_dwordx4 v[28:31], v4, s[96:99], s50 offen sc1
C_NDN11_1:
 v_mfma_f32_32x32x16_bf16 v[68:83], v[208:211], v[148:151], v[68:83]
 ds_read_b64_tr_b16 v[200:201], v8 offset:40960
 ds_read_b64_tr_b16 v[202:203], v8 offset:43008
 s_waitcnt lgkmcnt(10)
 v_mfma_f32_32x32x16_bf16 v[84:99], v[212:215], v[148:151], v[84:99]
 ds_read_b64_tr_b16 v[204:205], v9 offset:40960
 ds_read_b64_tr_b16 v[206:207], v9 offset:43008
 s_bitcmp1_b32 s49, 28
 s_cbranch_scc0 C_SLN11_1
C_SBN11_1:
 s_lshl_b32 s70, s48, 12
 s_add_u32 s70, s70, s36
 buffer_load_dwordx4 v[116:119], v4, s[8:11], s70 offen offset:0 sc1
 s_waitcnt vmcnt(20) lgkmcnt(10)
 v_mfma_f32_32x32x16_bf16 v[36:51], v[216:219], v[152:155], v[36:51]
 ds_read_b64_tr_b16 v[208:209], v10 offset:40960
 ds_read_b64_tr_b16 v[210:211], v10 offset:43008
 s_waitcnt lgkmcnt(10)
 v_mfma_f32_32x32x16_bf16 v[52:67], v[220:223], v[152:155], v[52:67]
 ds_read_b64_tr_b16 v[212:213], v11 offset:40960
 ds_read_b64_tr_b16 v[214:215], v11 offset:43008
 s_add_u32 s39, s69, 3072
 buffer_load_dwordx4 v6, s[12:15], s39 offen offset:1024 lds
 s_waitcnt lgkmcnt(10)
 v_mfma_f32_32x32x16_bf16 v[68:83], v[224:227], v[152:155], v[68:83]
 ds_read_b64_tr_b16 v[216:217], v8 offset:45056
 ds_read_b64_tr_b16 v[218:219], v8 offset:47104
 s_waitcnt lgkmcnt(10)
 v_mfma_f32_32x32x16_bf16 v[84:99], v[228:231], v[152:155], v[84:99]
 ds_read_b64_tr_b16 v[220:221], v9 offset:45056
 ds_read_b64_tr_b16 v[222:223], v9 offset:47104
 buffer_load_dwordx4 v[120:123], v4, s[8:11], s70 offen offset:1024 sc1
 s_waitcnt vmcnt(21) lgkmcnt(10)
 v_mfma_f32_32x32x16_bf16 v[36:51], v[200:203], v[156:159], v[36:51]
 ds_read_b64_tr_b16 v[224:225], v10 offset:45056
 ds_read_b64_tr_b16 v[226:227], v10 offset:47104
 s_waitcnt lgkmcnt(10)
 s_waitcnt vmcnt(12)
 s_barrier
 v_mov_b32 v21, s68
 ds_read_b32 v169, v21 offset:3072
 v_mfma_f32_32x32x16_bf16 v[52:67], v[204:207], v[156:159], v[52:67]
 ds_read_b64_tr_b16 v[228:229], v11 offset:45056
 ds_read_b64_tr_b16 v[230:231], v11 offset:47104
 s_add_u32 s39, s69, 6144
 buffer_load_dwordx4 v6, s[12:15], s39 offen offset:2048 lds
 s_waitcnt lgkmcnt(10)
 v_mfma_f32_32x32x16_bf16 v[68:83], v[208:211], v[156:159], v[68:83]
 ds_read_b64_tr_b16 v[200:201], v12 offset:0
 ds_read_b64_tr_b16 v[202:203], v12 offset:2048
 s_waitcnt lgkmcnt(10)
 v_mfma_f32_32x32x16_bf16 v[84:99], v[212:215], v[156:159], v[84:99]
 ds_read_b64_tr_b16 v[204:205], v13 offset:0
 ds_read_b64_tr_b16 v[206:207], v13 offset:2048
 buffer_load_dwordx4 v[124:127], v4, s[8:11], s70 offen offset:2048 sc1
 s_waitcnt vmcnt(22) lgkmcnt(10)
 v_mfma_f32_32x32x16_bf16 v[36:51], v[216:219], v[160:163], v[36:51]
 ds_read_b64_tr_b16 v[208:209], v14 offset:0
 ds_read_b64_tr_b16 v[210:211], v14 offset:2048
 s_waitcnt lgkmcnt(10)
 v_mfma_f32_32x32x16_bf16 v[52:67], v[220:223], v[160:163], v[52:67]
 ds_read_b64_tr_b16 v[212:213], v15 offset:0
 ds_read_b64_tr_b16 v[214:215], v15 offset:2048
 s_waitcnt lgkmcnt(10)
 s_add_u32 s39, s69, 9216
 buffer_load_dwordx4 v6, s[12:15], s39 offen offset:3072 lds
 s_waitcnt lgkmcnt(10)
 v_mfma_f32_32x32x16_bf16 v[68:83], v[224:227], v[160:163], v[68:83]
 ds_read_b64_tr_b16 v[216:217], v12 offset:4096
 ds_read_b64_tr_b16 v[218:219], v12 offset:6144
 s_waitcnt lgkmcnt(10)
 v_mfma_f32_32x32x16_bf16 v[84:99], v[228:231], v[160:163], v[84:99]
 ds_read_b64_tr_b16 v[220:221], v13 offset:4096
 ds_read_b64_tr_b16 v[222:223], v13 offset:6144
 buffer_load_dwordx4 v[128:131], v4, s[8:11], s70 offen offset:3072 sc1
 s_waitcnt vmcnt(14) lgkmcnt(10)
 v_readfirstlane_b32 s49, v169
 s_and_b32 s46, s49, 63
 v_mfma_f32_32x32x16_bf16 v[36:51], v[200:203], v[100:103], v[36:51]
 ds_read_b64_tr_b16 v[224:225], v14 offset:4096
 ds_read_b64_tr_b16 v[226:227], v14 offset:6144
 s_waitcnt lgkmcnt(10)
 v_mfma_f32_32x32x16_bf16 v[52:67], v[204:207], v[100:103], v[52:67]
 ds_read_b64_tr_b16 v[228:229], v15 offset:4096
 ds_read_b64_tr_b16 v[230:231], v15 offset:6144
 s_lshl_b32 s69, s46, 16
 s_add_u32 s69, s69, s37
 s_add_u32 m0, s66, 0
 s_add_u32 s39, s69, 0
 buffer_load_dwordx4 v6, s[12:15], s39 offen offset:0 lds
 s_waitcnt lgkmcnt(10)
 s_cmp_eq_u32 s55, 4
 s_cbranch_scc0 C_NDN11_2
 s_waitcnt vmcnt(17)
 v_cmp_eq_u64 vcc, s[90:91], v[24:25]
 v_cmp_eq_u64 s[60:61], s[90:91], v[26:27]
 s_and_b64 s[60:61], vcc, s[60:61]
 s_lshr_b64 s[58:59], s[60:61], 1
 s_and_b64 s[58:59], s[58:59], s[60:61]
 s_andn2_b64 s[60:61], s[64:65], s[60:61]
 s_cselect_b64 s[58:59], 0, s[58:59]
 s_and_b64 s[60:61], s[58:59], s[56:57]
 s_cselect_b64 s[60:61], s[60:61], s[56:57]
 s_ff1_i32_b64 s40, s[60:61]
 s_bitset0_b64 s[56:57], s40
 s_bitcmp1_b64 s[58:59], s46
 s_cselect_b32 s44, 0x10000000, 0
 s_or_b32 s40, s40, s44
 v_mov_b32 v165, s40
 s_sub_u32 s44, s66, 0x4000
 v_add_u32 v20, s44, v164
 ds_write_b32 v20, v165 offset:3072
 buffer_load_dwordx4 v[24:27], v4, s[96:99], s50 offen sc1
C_NDN11_2:
 v_mfma_f32_32x32x16_bf16 v[68:83], v[208:211], v[100:103], v[68:83]
 ds_read_b64_tr_b16 v[200:201], v12 offset:8192
 ds_read_b64_tr_b16 v[202:203], v12 offset:10240
 s_waitcnt lgkmcnt(10)
 v_mfma_f32_32x32x16_bf16 v[84:99], v[212:215], v[100:103], v[84:99]
 ds_read_b64_tr_b16 v[204:205], v13 offset:8192
 ds_read_b64_tr_b16 v[206:207], v13 offset:10240
 s_bitcmp1_b32 s49, 28
 s_cbranch_scc0 C_SLN11_2
C_SBN11_2:
 s_lshl_b32 s70, s45, 12
 s_add_u32 s70, s70, s36
 buffer_load_dwordx4 v[132:135], v4, s[8:11], s70 offen offset:0 sc1
 s_waitcnt vmcnt(14) lgkmcnt(10)
 v_mfma_f32_32x32x16_bf16 v[36:51], v[216:219], v[104:107], v[36:51]
 ds_read_b64_tr_b16 v[208:209], v14 offset:8192
 ds_read_b64_tr_b16 v[210:211], v14 offset:10240
 s_waitcnt lgkmcnt(10)
 v_mfma_f32_32x32x16_bf16 v[52:67], v[220:223], v[104:107], v[52:67]
 ds_read_b64_tr_b16 v[212:213], v15 offset:8192
 ds_read_b64_tr_b16 v[214:215], v15 offset:10240
 s_add_u32 s39, s69, 3072
 buffer_load_dwordx4 v6, s[12:15], s39 offen offset:1024 lds
 s_waitcnt lgkmcnt(10)
 v_mfma_f32_32x32x16_bf16 v[68:83], v[224:227], v[104:107], v[68:83]
 ds_read_b64_tr_b16 v[216:217], v12 offset:12288
 ds_read_b64_tr_b16 v[218:219], v12 offset:14336
 s_waitcnt lgkmcnt(10)
 v_mfma_f32_32x32x16_bf16 v[84:99], v[228:231], v[104:107], v[84:99]
 ds_read_b64_tr_b16 v[220:221], v13 offset:12288
 ds_read_b64_tr_b16 v[222:223], v13 offset:14336
 buffer_load_dwordx4 v[136:139], v4, s[8:11], s70 offen offset:1024 sc1
 s_waitcnt vmcnt(14) lgkmcnt(10)
 v_mfma_f32_32x32x16_bf16 v[36:51], v[200:203], v[108:111], v[36:51]
 ds_read_b64_tr_b16 v[224:225], v14 offset:12288
 ds_read_b64_tr_b16 v[226:227], v14 offset:14336
 s_waitcnt lgkmcnt(10)
 s_waitcnt vmcnt(13)
 s_barrier
 v_mov_b32 v21, s66
 ds_read_b32 v169, v21 offset:3072
 v_mfma_f32_32x32x16_bf16 v[52:67], v[204:207], v[108:111], v[52:67]
 ds_read_b64_tr_b16 v[228:229], v15 offset:12288
 ds_read_b64_tr_b16 v[230:231], v15 offset:14336
 s_add_u32 s39, s69, 6144
 buffer_load_dwordx4 v6, s[12:15], s39 offen offset:2048 lds
 s_waitcnt lgkmcnt(10)
 v_mfma_f32_32x32x16_bf16 v[68:83], v[208:211], v[108:111], v[68:83]
 ds_read_b64_tr_b16 v[200:201], v12 offset:32768
 ds_read_b64_tr_b16 v[202:203], v12 offset:34816
 s_waitcnt lgkmcnt(10)
 v_mfma_f32_32x32x16_bf16 v[84:99], v[212:215], v[108:111], v[84:99]
 ds_read_b64_tr_b16 v[204:205], v13 offset:32768
 ds_read_b64_tr_b16 v[206:207], v13 offset:34816
 buffer_load_dwordx4 v[140:143], v4, s[8:11], s70 offen offset:2048 sc1
 s_waitcnt vmcnt(14) lgkmcnt(10)
 v_mfma_f32_32x32x16_bf16 v[36:51], v[216:219], v[112:115], v[36:51]
 ds_read_b64_tr_b16 v[208:209], v14 offset:32768
 ds_read_b64_tr_b16 v[210:211], v14 offset:34816
 s_waitcnt lgkmcnt(10)
 v_mfma_f32_32x32x16_bf16 v[52:67], v[220:223], v[112:115], v[52:67]
 ds_read_b64_tr_b16 v[212:213], v15 offset:32768
 ds_read_b64_tr_b16 v[214:215], v15 offset:34816
 s_waitcnt lgkmcnt(10)
 s_add_u32 s39, s69, 9216
 buffer_load_dwordx4 v6, s[12:15], s39 offen offset:3072 lds
 s_waitcnt lgkmcnt(10)
 v_mfma_f32_32x32x16_bf16 v[68:83], v[224:227], v[112:115], v[68:83]
 ds_read_b64_tr_b16 v[216:217], v12 offset:36864
 ds_read_b64_tr_b16 v[218:219], v12 offset:38912
 s_waitcnt lgkmcnt(10)
 v_mfma_f32_32x32x16_bf16 v[84:99], v[228:231], v[112:115], v[84:99]
 ds_read_b64_tr_b16 v[220:221], v13 offset:36864
 ds_read_b64_tr_b16 v[222:223], v13 offset:38912
 buffer_load_dwordx4 v[144:147], v4, s[8:11], s70 offen offset:3072 sc1
 s_waitcnt vmcnt(14) lgkmcnt(10)
 v_readfirstlane_b32 s49, v169
 s_and_b32 s47, s49, 63
 v_mfma_f32_32x32x16_bf16 v[36:51], v[200:203], v[116:119], v[36:51]
 ds_read_b64_tr_b16 v[224:225], v14 offset:36864
 ds_read_b64_tr_b16 v[226:227], v14 offset:38912
 s_waitcnt lgkmcnt(10)
 v_mfma_f32_32x32x16_bf16 v[52:67], v[204:207], v[116:119], v[52:67]
 ds_read_b64_tr_b16 v[228:229], v15 offset:36864
 ds_read_b64_tr_b16 v[230:231], v15 offset:38912
 s_lshl_b32 s69, s47, 16
 s_add_u32 s69, s69, s37
 s_add_u32 m0, s66, 32768
 s_add_u32 s39, s69, 0
 buffer_load_dwordx4 v6, s[12:15], s39 offen offset:0 lds
 s_waitcnt lgkmcnt(10)
 s_cmp_eq_u32 s55, 4
 s_cbranch_scc0 C_NDN11_3
 s_waitcnt vmcnt(17)
 v_cmp_eq_u64 vcc, s[90:91], v[28:29]
 v_cmp_eq_u64 s[60:61], s[90:91], v[30:31]
 s_and_b64 s[60:61], vcc, s[60:61]
 s_lshr_b64 s[58:59], s[60:61], 1
 s_and_b64 s[58:59], s[58:59], s[60:61]
 s_andn2_b64 s[60:61], s[64:65], s[60:61]
 s_cselect_b64 s[58:59], 0, s[58:59]
 s_and_b64 s[60:61], s[58:59], s[56:57]
 s_cselect_b64 s[60:61], s[60:61], s[56:57]
 s_ff1_i32_b64 s40, s[60:61]
 s_bitset0_b64 s[56:57], s40
 s_bitcmp1_b64 s[58:59], s47
 s_cselect_b32 s44, 0x10000000, 0
 s_or_b32 s40, s40, s44
 v_mov_b32 v165, s40
 s_sub_u32 s44, s66, 0x4000
 v_add_u32 v20, s44, v164
 ds_write_b32 v20, v165 offset:35840
 buffer_load_dwordx4 v[28:31], v4, s[96:99], s50 offen sc1
C_NDN11_3:
 v_mfma_f32_32x32x16_bf16 v[68:83], v[208:211], v[116:119], v[68:83]
 ds_read_b64_tr_b16 v[200:201], v12 offset:40960
 ds_read_b64_tr_b16 v[202:203], v12 offset:43008
 s_waitcnt lgkmcnt(10)
 v_mfma_f32_32x32x16_bf16 v[84:99], v[212:215], v[116:119], v[84:99]
 ds_read_b64_tr_b16 v[204:205], v13 offset:40960
 ds_read_b64_tr_b16 v[206:207], v13 offset:43008
 s_bitcmp1_b32 s49, 28
 s_cbranch_scc0 C_SLN11_3
C_SBN11_3:
 s_lshl_b32 s70, s46, 12
 s_add_u32 s70, s70, s36
 buffer_load_dwordx4 v[148:151], v4, s[8:11], s70 offen offset:0 sc1
 s_waitcnt vmcnt(14) lgkmcnt(10)
 v_mfma_f32_32x32x16_bf16 v[36:51], v[216:219], v[120:123], v[36:51]
 ds_read_b64_tr_b16 v[208:209], v14 offset:40960
 ds_read_b64_tr_b16 v[210:211], v14 offset:43008
 s_waitcnt lgkmcnt(10)
 v_mfma_f32_32x32x16_bf16 v[52:67], v[220:223], v[120:123], v[52:67]
 ds_read_b64_tr_b16 v[212:213], v15 offset:40960
 ds_read_b64_tr_b16 v[214:215], v15 offset:43008
 s_add_u32 s39, s69, 3072
 buffer_load_dwordx4 v6, s[12:15], s39 offen offset:1024 lds
 s_waitcnt lgkmcnt(10)
 v_mfma_f32_32x32x16_bf16 v[68:83], v[224:227], v[120:123], v[68:83]
 ds_read_b64_tr_b16 v[216:217], v12 offset:45056
 ds_read_b64_tr_b16 v[218:219], v12 offset:47104
 s_waitcnt lgkmcnt(10)
 v_mfma_f32_32x32x16_bf16 v[84:99], v[228:231], v[120:123], v[84:99]
 ds_read_b64_tr_b16 v[220:221], v13 offset:45056
 ds_read_b64_tr_b16 v[222:223], v13 offset:47104
 buffer_load_dwordx4 v[152:155], v4, s[8:11], s70 offen offset:1024 sc1
 s_waitcnt vmcnt(14) lgkmcnt(10)
 v_mfma_f32_32x32x16_bf16 v[36:51], v[200:203], v[124:127], v[36:51]
 ds_read_b64_tr_b16 v[224:225], v14 offset:45056
 ds_read_b64_tr_b16 v[226:227], v14 offset:47104
 s_waitcnt lgkmcnt(10)
 s_waitcnt vmcnt(13)
 s_barrier
 v_mov_b32 v21, s66
 ds_read_b32 v169, v21 offset:35840
 v_mfma_f32_32x32x16_bf16 v[52:67], v[204:207], v[124:127], v[52:67]
 ds_read_b64_tr_b16 v[228:229], v15 offset:45056
 ds_read_b64_tr_b16 v[230:231], v15 offset:47104
 s_add_u32 s39, s69, 6144
 buffer_load_dwordx4 v6, s[12:15], s39 offen offset:2048 lds
 s_waitcnt lgkmcnt(10)
 v_mfma_f32_32x32x16_bf16 v[68:83], v[208:211], v[124:127], v[68:83]
 ds_read_b64_tr_b16 v[200:201], v16 offset:0
 ds_read_b64_tr_b16 v[202:203], v16 offset:2048
 s_waitcnt lgkmcnt(10)
 v_mfma_f32_32x32x16_bf16 v[84:99], v[212:215], v[124:127], v[84:99]
 ds_read_b64_tr_b16 v[204:205], v17 offset:0
 ds_read_b64_tr_b16 v[206:207], v17 offset:2048
 buffer_load_dwordx4 v[156:159], v4, s[8:11], s70 offen offset:2048 sc1
 s_waitcnt vmcnt(14) lgkmcnt(10)
 v_mfma_f32_32x32x16_bf16 v[36:51], v[216:219], v[128:131], v[36:51]
 ds_read_b64_tr_b16 v[208:209], v18 offset:0
 ds_read_b64_tr_b16 v[210:211], v18 offset:2048
 s_waitcnt lgkmcnt(10)
 v_mfma_f32_32x32x16_bf16 v[52:67], v[220:223], v[128:131], v[52:67]
 ds_read_b64_tr_b16 v[212:213], v19 offset:0
 ds_read_b64_tr_b16 v[214:215], v19 offset:2048
 s_waitcnt lgkmcnt(10)
 s_add_u32 s39, s69, 9216
 buffer_load_dwordx4 v6, s[12:15], s39 offen offset:3072 lds
 s_waitcnt lgkmcnt(10)
 v_mfma_f32_32x32x16_bf16 v[68:83], v[224:227], v[128:131], v[68:83]
 ds_read_b64_tr_b16 v[216:217], v16 offset:4096
 ds_read_b64_tr_b16 v[218:219], v16 offset:6144
 s_waitcnt lgkmcnt(10)
 v_mfma_f32_32x32x16_bf16 v[84:99], v[228:231], v[128:131], v[84:99]
 ds_read_b64_tr_b16 v[220:221], v17 offset:4096
 ds_read_b64_tr_b16 v[222:223], v17 offset:6144
 buffer_load_dwordx4 v[160:163], v4, s[8:11], s70 offen offset:3072 sc1
 s_waitcnt vmcnt(14) lgkmcnt(10)
 v_readfirstlane_b32 s49, v169
 s_and_b32 s48, s49, 63
 v_mfma_f32_32x32x16_bf16 v[36:51], v[200:203], v[132:135], v[36:51]
 ds_read_b64_tr_b16 v[224:225], v18 offset:4096
 ds_read_b64_tr_b16 v[226:227], v18 offset:6144
 s_waitcnt lgkmcnt(10)
 v_mfma_f32_32x32x16_bf16 v[52:67], v[204:207], v[132:135], v[52:67]
 ds_read_b64_tr_b16 v[228:229], v19 offset:4096
 ds_read_b64_tr_b16 v[230:231], v19 offset:6144
 s_lshl_b32 s69, s48, 16
 s_add_u32 s69, s69, s37
 s_add_u32 m0, s67, 0
 s_add_u32 s39, s69, 0
 buffer_load_dwordx4 v6, s[12:15], s39 offen offset:0 lds
 s_waitcnt lgkmcnt(10)
 s_cmp_eq_u32 s55, 4
 s_cbranch_scc0 C_NDN11_4
 s_waitcnt vmcnt(17)
 v_cmp_eq_u64 vcc, s[90:91], v[24:25]
 v_cmp_eq_u64 s[60:61], s[90:91], v[26:27]
 s_and_b64 s[60:61], vcc, s[60:61]
 s_lshr_b64 s[58:59], s[60:61], 1
 s_and_b64 s[58:59], s[58:59], s[60:61]
 s_andn2_b64 s[60:61], s[64:65], s[60:61]
 s_cselect_b64 s[58:59], 0, s[58:59]
 s_and_b64 s[60:61], s[58:59], s[56:57]
 s_cselect_b64 s[60:61], s[60:61], s[56:57]
 s_ff1_i32_b64 s40, s[60:61]
 s_bitset0_b64 s[56:57], s40
 s_bitcmp1_b64 s[58:59], s48
 s_cselect_b32 s44, 0x10000000, 0
 s_or_b32 s40, s40, s44
 v_mov_b32 v165, s40
 s_sub_u32 s44, s67, 0x4000
 v_add_u32 v20, s44, v164
 ds_write_b32 v20, v165 offset:3072
 buffer_load_dwordx4 v[24:27], v4, s[96:99], s50 offen sc1
C_NDN11_4:
 v_mfma_f32_32x32x16_bf16 v[68:83], v[208:211], v[132:135], v[68:83]
 ds_read_b64_tr_b16 v[200:201], v16 offset:8192
 ds_read_b64_tr_b16 v[202:203], v16 offset:10240
 s_waitcnt lgkmcnt(10)
 v_mfma_f32_32x32x16_bf16 v[84:99], v[212:215], v[132:135], v[84:99]
 ds_read_b64_tr_b16 v[204:205], v17 offset:8192
 ds_read_b64_tr_b16 v[206:207], v17 offset:10240
 s_bitcmp1_b32 s49, 28
 s_cbranch_scc0 C_SLN11_4
C_SBN11_4:
 s_lshl_b32 s70, s47, 12
 s_add_u32 s70, s70, s36
 buffer_load_dwordx4 v[100:103], v4, s[8:11], s70 offen offset:0 sc1
 s_waitcnt vmcnt(14) lgkmcnt(10)
 v_mfma_f32_32x32x16_bf16 v[36:51], v[216:219], v[136:139], v[36:51]
 ds_read_b64_tr_b16 v[208:209], v18 offset:8192
 ds_read_b64_tr_b16 v[210:211], v18 offset:10240
 s_waitcnt lgkmcnt(10)
 v_mfma_f32_32x32x16_bf16 v[52:67], v[220:223], v[136:139], v[52:67]
 ds_read_b64_tr_b16 v[212:213], v19 offset:8192
 ds_read_b64_tr_b16 v[214:215], v19 offset:10240
 s_add_u32 s39, s69, 3072
 buffer_load_dwordx4 v6, s[12:15], s39 offen offset:1024 lds
 s_waitcnt lgkmcnt(10)
 v_mfma_f32_32x32x16_bf16 v[68:83], v[224:227], v[136:139], v[68:83]
 ds_read_b64_tr_b16 v[216:217], v16 offset:12288
 ds_read_b64_tr_b16 v[218:219], v16 offset:14336
 s_waitcnt lgkmcnt(10)
 v_mfma_f32_32x32x16_bf16 v[84:99], v[228:231], v[136:139], v[84:99]
 ds_read_b64_tr_b16 v[220:221], v17 offset:12288
 ds_read_b64_tr_b16 v[222:223], v17 offset:14336
 buffer_load_dwordx4 v[104:107], v4, s[8:11], s70 offen offset:1024 sc1
 s_waitcnt vmcnt(14) lgkmcnt(10)
 v_mfma_f32_32x32x16_bf16 v[36:51], v[200:203], v[140:143], v[36:51]
 ds_read_b64_tr_b16 v[224:225], v18 offset:12288
 ds_read_b64_tr_b16 v[226:227], v18 offset:14336
 s_waitcnt lgkmcnt(10)
 s_waitcnt vmcnt(13)
 s_barrier
 v_mov_b32 v21, s67
 ds_read_b32 v169, v21 offset:3072
 v_mfma_f32_32x32x16_bf16 v[52:67], v[204:207], v[140:143], v[52:67]
 ds_read_b64_tr_b16 v[228:229], v19 offset:12288
 ds_read_b64_tr_b16 v[230:231], v19 offset:14336
 s_add_u32 s39, s69, 6144
 buffer_load_dwordx4 v6, s[12:15], s39 offen offset:2048 lds
 s_waitcnt lgkmcnt(10)
 v_mfma_f32_32x32x16_bf16 v[68:83], v[208:211], v[140:143], v[68:83]
 ds_read_b64_tr_b16 v[200:201], v8 offset:0
 ds_read_b64_tr_b16 v[202:203], v8 offset:2048
 s_waitcnt lgkmcnt(10)
 v_mfma_f32_32x32x16_bf16 v[84:99], v[212:215], v[140:143], v[84:99]
 ds_read_b64_tr_b16 v[204:205], v9 offset:0
 ds_read_b64_tr_b16 v[206:207], v9 offset:2048
 buffer_load_dwordx4 v[108:111], v4, s[8:11], s70 offen offset:2048 sc1
 s_waitcnt vmcnt(14) lgkmcnt(10)
 v_mfma_f32_32x32x16_bf16 v[36:51], v[216:219], v[144:147], v[36:51]
 ds_read_b64_tr_b16 v[208:209], v10 offset:0
 ds_read_b64_tr_b16 v[210:211], v10 offset:2048
 s_waitcnt lgkmcnt(10)
 v_mfma_f32_32x32x16_bf16 v[52:67], v[220:223], v[144:147], v[52:67]
 ds_read_b64_tr_b16 v[212:213], v11 offset:0
 ds_read_b64_tr_b16 v[214:215], v11 offset:2048
 s_waitcnt lgkmcnt(10)
 s_add_u32 s39, s69, 9216
 buffer_load_dwordx4 v6, s[12:15], s39 offen offset:3072 lds
 s_waitcnt lgkmcnt(10)
 v_mfma_f32_32x32x16_bf16 v[68:83], v[224:227], v[144:147], v[68:83]
 ds_read_b64_tr_b16 v[216:217], v8 offset:4096
 ds_read_b64_tr_b16 v[218:219], v8 offset:6144
 s_waitcnt lgkmcnt(10)
 v_mfma_f32_32x32x16_bf16 v[84:99], v[228:231], v[144:147], v[84:99]
 ds_read_b64_tr_b16 v[220:221], v9 offset:4096
 ds_read_b64_tr_b16 v[222:223], v9 offset:6144
 buffer_load_dwordx4 v[112:115], v4, s[8:11], s70 offen offset:3072 sc1
 s_waitcnt vmcnt(14) lgkmcnt(10)
 v_readfirstlane_b32 s49, v169
 s_and_b32 s45, s49, 63
 v_mfma_f32_32x32x16_bf16 v[36:51], v[200:203], v[148:151], v[36:51]
 ds_read_b64_tr_b16 v[224:225], v10 offset:4096
 ds_read_b64_tr_b16 v[226:227], v10 offset:6144
 s_waitcnt lgkmcnt(10)
 v_mfma_f32_32x32x16_bf16 v[52:67], v[204:207], v[148:151], v[52:67]
 ds_read_b64_tr_b16 v[228:229], v11 offset:4096
 ds_read_b64_tr_b16 v[230:231], v11 offset:6144
 s_lshl_b32 s69, s45, 16
 s_add_u32 s69, s69, s37
 s_add_u32 m0, s67, 32768
 s_add_u32 s39, s69, 0
 buffer_load_dwordx4 v6, s[12:15], s39 offen offset:0 lds
 s_waitcnt lgkmcnt(10)
 s_cmp_eq_u32 s55, 4
 s_cbranch_scc0 C_NDN11_5
 s_waitcnt vmcnt(17)
 v_cmp_eq_u64 vcc, s[90:91], v[28:29]
 v_cmp_eq_u64 s[60:61], s[90:91], v[30:31]
 s_and_b64 s[60:61], vcc, s[60:61]
 s_lshr_b64 s[58:59], s[60:61], 1
 s_and_b64 s[58:59], s[58:59], s[60:61]
 s_andn2_b64 s[60:61], s[64:65], s[60:61]
 s_cselect_b64 s[58:59], 0, s[58:59]
 s_and_b64 s[60:61], s[58:59], s[56:57]
 s_cselect_b64 s[60:61], s[60:61], s[56:57]
 s_ff1_i32_b64 s40, s[60:61]
 s_bitset0_b64 s[56:57], s40
 s_bitcmp1_b64 s[58:59], s45
 s_cselect_b32 s44, 0x10000000, 0
 s_or_b32 s40, s40, s44
 v_mov_b32 v165, s40
 s_sub_u32 s44, s67, 0x4000
 v_add_u32 v20, s44, v164
 ds_write_b32 v20, v165 offset:35840
 buffer_load_dwordx4 v[28:31], v4, s[96:99], s50 offen sc1
C_NDN11_5:
 v_mfma_f32_32x32x16_bf16 v[68:83], v[208:211], v[148:151], v[68:83]
 ds_read_b64_tr_b16 v[200:201], v8 offset:8192
 ds_read_b64_tr_b16 v[202:203], v8 offset:10240
 s_waitcnt lgkmcnt(10)
 v_mfma_f32_32x32x16_bf16 v[84:99], v[212:215], v[148:151], v[84:99]
 ds_read_b64_tr_b16 v[204:205], v9 offset:8192
 ds_read_b64_tr_b16 v[206:207], v9 offset:10240
 s_bitcmp1_b32 s49, 28
 s_cbranch_scc0 C_SLN11_5
C_SBN11_5:
 s_lshl_b32 s70, s48, 12
 s_add_u32 s70, s70, s36
 buffer_load_dwordx4 v[116:119], v4, s[8:11], s70 offen offset:0 sc1
 s_waitcnt vmcnt(14) lgkmcnt(10)
 v_mfma_f32_32x32x16_bf16 v[36:51], v[216:219], v[152:155], v[36:51]
 ds_read_b64_tr_b16 v[208:209], v10 offset:8192
 ds_read_b64_tr_b16 v[210:211], v10 offset:10240
 s_waitcnt lgkmcnt(10)
 v_mfma_f32_32x32x16_bf16 v[52:67], v[220:223], v[152:155], v[52:67]
 ds_read_b64_tr_b16 v[212:213], v11 offset:8192
 ds_read_b64_tr_b16 v[214:215], v11 offset:10240
 s_add_u32 s39, s69, 3072
 buffer_load_dwordx4 v6, s[12:15], s39 offen offset:1024 lds
 s_waitcnt lgkmcnt(10)
 v_mfma_f32_32x32x16_bf16 v[68:83], v[224:227], v[152:155], v[68:83]
 ds_read_b64_tr_b16 v[216:217], v8 offset:12288
 ds_read_b64_tr_b16 v[218:219], v8 offset:14336
 s_waitcnt lgkmcnt(10)
 v_mfma_f32_32x32x16_bf16 v[84:99], v[228:231], v[152:155], v[84:99]
 ds_read_b64_tr_b16 v[220:221], v9 offset:12288
 ds_read_b64_tr_b16 v[222:223], v9 offset:14336
 buffer_load_dwordx4 v[120:123], v4, s[8:11], s70 offen offset:1024 sc1
 s_waitcnt vmcnt(14) lgkmcnt(10)
 v_mfma_f32_32x32x16_bf16 v[36:51], v[200:203], v[156:159], v[36:51]
 ds_read_b64_tr_b16 v[224:225], v10 offset:12288
 ds_read_b64_tr_b16 v[226:227], v10 offset:14336
 s_waitcnt lgkmcnt(10)
 s_waitcnt vmcnt(13)
 s_barrier
 v_mov_b32 v21, s67
 ds_read_b32 v169, v21 offset:35840
 v_mfma_f32_32x32x16_bf16 v[52:67], v[204:207], v[156:159], v[52:67]
 ds_read_b64_tr_b16 v[228:229], v11 offset:12288
 ds_read_b64_tr_b16 v[230:231], v11 offset:14336
 s_add_u32 s39, s69, 6144
 buffer_load_dwordx4 v6, s[12:15], s39 offen offset:2048 lds
 s_waitcnt lgkmcnt(10)
 v_mfma_f32_32x32x16_bf16 v[68:83], v[208:211], v[156:159], v[68:83]
 ds_read_b64_tr_b16 v[200:201], v8 offset:32768
 ds_read_b64_tr_b16 v[202:203], v8 offset:34816
 s_waitcnt lgkmcnt(10)
 v_mfma_f32_32x32x16_bf16 v[84:99], v[212:215], v[156:159], v[84:99]
 ds_read_b64_tr_b16 v[204:205], v9 offset:32768
 ds_read_b64_tr_b16 v[206:207], v9 offset:34816
 buffer_load_dwordx4 v[124:127], v4, s[8:11], s70 offen offset:2048 sc1
 s_waitcnt vmcnt(14) lgkmcnt(10)
 v_mfma_f32_32x32x16_bf16 v[36:51], v[216:219], v[160:163], v[36:51]
 ds_read_b64_tr_b16 v[208:209], v10 offset:32768
 ds_read_b64_tr_b16 v[210:211], v10 offset:34816
 s_waitcnt lgkmcnt(10)
 v_mfma_f32_32x32x16_bf16 v[52:67], v[220:223], v[160:163], v[52:67]
 ds_read_b64_tr_b16 v[212:213], v11 offset:32768
 ds_read_b64_tr_b16 v[214:215], v11 offset:34816
 s_waitcnt lgkmcnt(10)
 s_add_u32 s39, s69, 9216
 buffer_load_dwordx4 v6, s[12:15], s39 offen offset:3072 lds
 s_waitcnt lgkmcnt(10)
 v_mfma_f32_32x32x16_bf16 v[68:83], v[224:227], v[160:163], v[68:83]
 ds_read_b64_tr_b16 v[216:217], v8 offset:36864
 ds_read_b64_tr_b16 v[218:219], v8 offset:38912
 s_waitcnt lgkmcnt(10)
 v_mfma_f32_32x32x16_bf16 v[84:99], v[228:231], v[160:163], v[84:99]
 ds_read_b64_tr_b16 v[220:221], v9 offset:36864
 ds_read_b64_tr_b16 v[222:223], v9 offset:38912
 buffer_load_dwordx4 v[128:131], v4, s[8:11], s70 offen offset:3072 sc1
 s_waitcnt vmcnt(14) lgkmcnt(10)
 v_readfirstlane_b32 s49, v169
 s_and_b32 s46, s49, 63
 v_mfma_f32_32x32x16_bf16 v[36:51], v[200:203], v[100:103], v[36:51]
 ds_read_b64_tr_b16 v[224:225], v10 offset:36864
 ds_read_b64_tr_b16 v[226:227], v10 offset:38912
 s_waitcnt lgkmcnt(10)
 v_mfma_f32_32x32x16_bf16 v[52:67], v[204:207], v[100:103], v[52:67]
 ds_read_b64_tr_b16 v[228:229], v11 offset:36864
 ds_read_b64_tr_b16 v[230:231], v11 offset:38912
 s_lshl_b32 s69, s46, 16
 s_add_u32 s69, s69, s37
 s_add_u32 m0, s68, 0
 s_add_u32 s39, s69, 0
 buffer_load_dwordx4 v6, s[12:15], s39 offen offset:0 lds
 s_waitcnt lgkmcnt(10)
 s_cmp_eq_u32 s55, 4
 s_cbranch_scc0 C_NDN11_6
 s_waitcnt vmcnt(17)
 v_cmp_eq_u64 vcc, s[90:91], v[24:25]
 v_cmp_eq_u64 s[60:61], s[90:91], v[26:27]
 s_and_b64 s[60:61], vcc, s[60:61]
 s_lshr_b64 s[58:59], s[60:61], 1
 s_and_b64 s[58:59], s[58:59], s[60:61]
 s_andn2_b64 s[60:61], s[64:65], s[60:61]
 s_cselect_b64 s[58:59], 0, s[58:59]
 s_and_b64 s[60:61], s[58:59], s[56:57]
 s_cselect_b64 s[60:61], s[60:61], s[56:57]
 s_ff1_i32_b64 s40, s[60:61]
 s_bitset0_b64 s[56:57], s40
 s_bitcmp1_b64 s[58:59], s46
 s_cselect_b32 s44, 0x10000000, 0
 s_or_b32 s40, s40, s44
 v_mov_b32 v165, s40
 s_sub_u32 s44, s68, 0x4000
 v_add_u32 v20, s44, v164
 ds_write_b32 v20, v165 offset:3072
C_NDN11_6:
 v_mfma_f32_32x32x16_bf16 v[68:83], v[208:211], v[100:103], v[68:83]
 ds_read_b64_tr_b16 v[200:201], v8 offset:40960
 ds_read_b64_tr_b16 v[202:203], v8 offset:43008
 s_waitcnt lgkmcnt(10)
 v_mfma_f32_32x32x16_bf16 v[84:99], v[212:215], v[100:103], v[84:99]
 ds_read_b64_tr_b16 v[204:205], v9 offset:40960
 ds_read_b64_tr_b16 v[206:207], v9 offset:43008
 s_bitcmp1_b32 s49, 28
 s_cbranch_scc0 C_SLN11_6
C_SBN11_6:
 s_lshl_b32 s70, s45, 12
 s_add_u32 s70, s70, s36
 buffer_load_dwordx4 v[132:135], v4, s[8:11], s70 offen offset:0 sc1
 s_waitcnt vmcnt(14) lgkmcnt(10)
 v_mfma_f32_32x32x16_bf16 v[36:51], v[216:219], v[104:107], v[36:51]
 ds_read_b64_tr_b16 v[208:209], v10 offset:40960
 ds_read_b64_tr_b16 v[210:211], v10 offset:43008
 s_waitcnt lgkmcnt(10)
 v_mfma_f32_32x32x16_bf16 v[52:67], v[220:223], v[104:107], v[52:67]
 ds_read_b64_tr_b16 v[212:213], v11 offset:40960
 ds_read_b64_tr_b16 v[214:215], v11 offset:43008
 s_add_u32 s39, s69, 3072
 buffer_load_dwordx4 v6, s[12:15], s39 offen offset:1024 lds
 s_waitcnt lgkmcnt(10)
 v_mfma_f32_32x32x16_bf16 v[68:83], v[224:227], v[104:107], v[68:83]
 ds_read_b64_tr_b16 v[216:217], v8 offset:45056
 ds_read_b64_tr_b16 v[218:219], v8 offset:47104
 s_waitcnt lgkmcnt(10)
 v_mfma_f32_32x32x16_bf16 v[84:99], v[228:231], v[104:107], v[84:99]
 ds_read_b64_tr_b16 v[220:221], v9 offset:45056
 ds_read_b64_tr_b16 v[222:223], v9 offset:47104
 buffer_load_dwordx4 v[136:139], v4, s[8:11], s70 offen offset:1024 sc1
 s_waitcnt vmcnt(14) lgkmcnt(10)
 v_mfma_f32_32x32x16_bf16 v[36:51], v[200:203], v[108:111], v[36:51]
 ds_read_b64_tr_b16 v[224:225], v10 offset:45056
 ds_read_b64_tr_b16 v[226:227], v10 offset:47104
 s_waitcnt lgkmcnt(10)
 s_waitcnt vmcnt(13)
 s_barrier
 v_mov_b32 v21, s68
 ds_read_b32 v169, v21 offset:3072
 v_mfma_f32_32x32x16_bf16 v[52:67], v[204:207], v[108:111], v[52:67]
 ds_read_b64_tr_b16 v[228:229], v11 offset:45056
 ds_read_b64_tr_b16 v[230:231], v11 offset:47104
 s_add_u32 s39, s69, 6144
 buffer_load_dwordx4 v6, s[12:15], s39 offen offset:2048 lds
 s_waitcnt lgkmcnt(10)
 v_mfma_f32_32x32x16_bf16 v[68:83], v[208:211], v[108:111], v[68:83]
 ds_read_b64_tr_b16 v[200:201], v12 offset:0
 ds_read_b64_tr_b16 v[202:203], v12 offset:2048
 s_waitcnt lgkmcnt(10)
 v_mfma_f32_32x32x16_bf16 v[84:99], v[212:215], v[108:111], v[84:99]
 ds_read_b64_tr_b16 v[204:205], v13 offset:0
 ds_read_b64_tr_b16 v[206:207], v13 offset:2048
 buffer_load_dwordx4 v[140:143], v4, s[8:11], s70 offen offset:2048 sc1
 s_waitcnt vmcnt(14) lgkmcnt(10)
 v_mfma_f32_32x32x16_bf16 v[36:51], v[216:219], v[112:115], v[36:51]
 ds_read_b64_tr_b16 v[208:209], v14 offset:0
 ds_read_b64_tr_b16 v[210:211], v14 offset:2048
 s_waitcnt lgkmcnt(10)
 v_mfma_f32_32x32x16_bf16 v[52:67], v[220:223], v[112:115], v[52:67]
 ds_read_b64_tr_b16 v[212:213], v15 offset:0
 ds_read_b64_tr_b16 v[214:215], v15 offset:2048
 s_waitcnt lgkmcnt(10)
 s_add_u32 s39, s69, 9216
 buffer_load_dwordx4 v6, s[12:15], s39 offen offset:3072 lds
 s_waitcnt lgkmcnt(10)
 v_mfma_f32_32x32x16_bf16 v[68:83], v[224:227], v[112:115], v[68:83]
 ds_read_b64_tr_b16 v[216:217], v12 offset:4096
 ds_read_b64_tr_b16 v[218:219], v12 offset:6144
 s_waitcnt lgkmcnt(10)
 v_mfma_f32_32x32x16_bf16 v[84:99], v[228:231], v[112:115], v[84:99]
 ds_read_b64_tr_b16 v[220:221], v13 offset:4096
 ds_read_b64_tr_b16 v[222:223], v13 offset:6144
 buffer_load_dwordx4 v[144:147], v4, s[8:11], s70 offen offset:3072 sc1
 s_waitcnt vmcnt(14) lgkmcnt(10)
 v_readfirstlane_b32 s49, v169
 s_and_b32 s47, s49, 63
 v_mfma_f32_32x32x16_bf16 v[36:51], v[200:203], v[116:119], v[36:51]
 ds_read_b64_tr_b16 v[224:225], v14 offset:4096
 ds_read_b64_tr_b16 v[226:227], v14 offset:6144
 s_waitcnt lgkmcnt(10)
 v_mfma_f32_32x32x16_bf16 v[52:67], v[204:207], v[116:119], v[52:67]
 ds_read_b64_tr_b16 v[228:229], v15 offset:4096
 ds_read_b64_tr_b16 v[230:231], v15 offset:6144
 s_lshl_b32 s69, s47, 16
 s_add_u32 s69, s69, s37
 s_add_u32 m0, s66, 0
 s_add_u32 s39, s69, 0
 buffer_load_dwordx4 v6, s[12:15], s39 offen offset:0 lds
 s_waitcnt lgkmcnt(10)
 s_cmp_eq_u32 s55, 4
 s_cbranch_scc0 C_NDN11_7
 s_waitcnt vmcnt(16)
 v_cmp_eq_u64 vcc, s[90:91], v[28:29]
 v_cmp_eq_u64 s[60:61], s[90:91], v[30:31]
 s_and_b64 s[60:61], vcc, s[60:61]
 s_lshr_b64 s[58:59], s[60:61], 1
 s_and_b64 s[58:59], s[58:59], s[60:61]
 s_andn2_b64 s[60:61], s[64:65], s[60:61]
 s_cselect_b64 s[58:59], 0, s[58:59]
 s_mov_b32 s40, 0
 s_bitcmp1_b64 s[58:59], s47
 s_cselect_b32 s44, 0x10000000, 0
 s_or_b32 s40, s40, s44
 v_mov_b32 v165, s40
 s_sub_u32 s44, s66, 0x4000
 v_add_u32 v20, s44, v164
 ds_write_b32 v20, v165 offset:3072
C_NDN11_7:
 v_mfma_f32_32x32x16_bf16 v[68:83], v[208:211], v[116:119], v[68:83]
 ds_read_b64_tr_b16 v[200:201], v12 offset:8192
 ds_read_b64_tr_b16 v[202:203], v12 offset:10240
 s_waitcnt lgkmcnt(10)
 v_mfma_f32_32x32x16_bf16 v[84:99], v[212:215], v[116:119], v[84:99]
 ds_read_b64_tr_b16 v[204:205], v13 offset:8192
 ds_read_b64_tr_b16 v[206:207], v13 offset:10240
 s_bitcmp1_b32 s49, 28
 s_cbranch_scc0 C_SLN11_7
C_SBN11_7:
 s_lshl_b32 s70, s46, 12
 s_add_u32 s70, s70, s36
 buffer_load_dwordx4 v[148:151], v4, s[8:11], s70 offen offset:0 sc1
 s_waitcnt vmcnt(14) lgkmcnt(10)
 v_mfma_f32_32x32x16_bf16 v[36:51], v[216:219], v[120:123], v[36:51]
 ds_read_b64_tr_b16 v[208:209], v14 offset:8192
 ds_read_b64_tr_b16 v[210:211], v14 offset:10240
 s_waitcnt lgkmcnt(10)
 v_mfma_f32_32x32x16_bf16 v[52:67], v[220:223], v[120:123], v[52:67]
 ds_read_b64_tr_b16 v[212:213], v15 offset:8192
 ds_read_b64_tr_b16 v[214:215], v15 offset:10240
 s_add_u32 s39, s69, 3072
 buffer_load_dwordx4 v6, s[12:15], s39 offen offset:1024 lds
 s_waitcnt lgkmcnt(10)
 v_mfma_f32_32x32x16_bf16 v[68:83], v[224:227], v[120:123], v[68:83]
 ds_read_b64_tr_b16 v[216:217], v12 offset:12288
 ds_read_b64_tr_b16 v[218:219], v12 offset:14336
 s_waitcnt lgkmcnt(10)
 v_mfma_f32_32x32x16_bf16 v[84:99], v[228:231], v[120:123], v[84:99]
 ds_read_b64_tr_b16 v[220:221], v13 offset:12288
 ds_read_b64_tr_b16 v[222:223], v13 offset:14336
 buffer_load_dwordx4 v[152:155], v4, s[8:11], s70 offen offset:1024 sc1
 s_waitcnt vmcnt(14) lgkmcnt(10)
 v_mfma_f32_32x32x16_bf16 v[36:51], v[200:203], v[124:127], v[36:51]
 ds_read_b64_tr_b16 v[224:225], v14 offset:12288
 ds_read_b64_tr_b16 v[226:227], v14 offset:14336
 s_waitcnt lgkmcnt(10)
 s_waitcnt vmcnt(13)
 s_barrier
 v_mov_b32 v21, s66
 ds_read_b32 v169, v21 offset:3072
 v_mfma_f32_32x32x16_bf16 v[52:67], v[204:207], v[124:127], v[52:67]
 ds_read_b64_tr_b16 v[228:229], v15 offset:12288
 ds_read_b64_tr_b16 v[230:231], v15 offset:14336
 s_add_u32 s39, s69, 6144
 buffer_load_dwordx4 v6, s[12:15], s39 offen offset:2048 lds
 s_waitcnt lgkmcnt(10)
 v_mfma_f32_32x32x16_bf16 v[68:83], v[208:211], v[124:127], v[68:83]
 ds_read_b64_tr_b16 v[200:201], v12 offset:32768
 ds_read_b64_tr_b16 v[202:203], v12 offset:34816
 s_waitcnt lgkmcnt(10)
 v_mfma_f32_32x32x16_bf16 v[84:99], v[212:215], v[124:127], v[84:99]
 ds_read_b64_tr_b16 v[204:205], v13 offset:32768
 ds_read_b64_tr_b16 v[206:207], v13 offset:34816
 buffer_load_dwordx4 v[156:159], v4, s[8:11], s70 offen offset:2048 sc1
 s_waitcnt vmcnt(14) lgkmcnt(10)
 v_mfma_f32_32x32x16_bf16 v[36:51], v[216:219], v[128:131], v[36:51]
 ds_read_b64_tr_b16 v[208:209], v14 offset:32768
 ds_read_b64_tr_b16 v[210:211], v14 offset:34816
 s_waitcnt lgkmcnt(10)
 v_mfma_f32_32x32x16_bf16 v[52:67], v[220:223], v[128:131], v[52:67]
 ds_read_b64_tr_b16 v[212:213], v15 offset:32768
 ds_read_b64_tr_b16 v[214:215], v15 offset:34816
 s_waitcnt lgkmcnt(10)
 s_add_u32 s39, s69, 9216
 buffer_load_dwordx4 v6, s[12:15], s39 offen offset:3072 lds
 s_waitcnt lgkmcnt(10)
 v_mfma_f32_32x32x16_bf16 v[68:83], v[224:227], v[128:131], v[68:83]
 ds_read_b64_tr_b16 v[216:217], v12 offset:36864
 ds_read_b64_tr_b16 v[218:219], v12 offset:38912
 s_waitcnt lgkmcnt(10)
 v_mfma_f32_32x32x16_bf16 v[84:99], v[228:231], v[128:131], v[84:99]
 ds_read_b64_tr_b16 v[220:221], v13 offset:36864
 ds_read_b64_tr_b16 v[222:223], v13 offset:38912
 buffer_load_dwordx4 v[160:163], v4, s[8:11], s70 offen offset:3072 sc1
 s_waitcnt vmcnt(14) lgkmcnt(10)
 v_readfirstlane_b32 s49, v169
 v_mfma_f32_32x32x16_bf16 v[36:51], v[200:203], v[132:135], v[36:51]
 ds_read_b64_tr_b16 v[224:225], v14 offset:36864
 ds_read_b64_tr_b16 v[226:227], v14 offset:38912
 s_waitcnt lgkmcnt(10)
 v_mfma_f32_32x32x16_bf16 v[52:67], v[204:207], v[132:135], v[52:67]
 ds_read_b64_tr_b16 v[228:229], v15 offset:36864
 ds_read_b64_tr_b16 v[230:231], v15 offset:38912
 s_waitcnt lgkmcnt(10)
 v_mfma_f32_32x32x16_bf16 v[68:83], v[208:211], v[132:135], v[68:83]
 ds_read_b64_tr_b16 v[200:201], v12 offset:40960
 ds_read_b64_tr_b16 v[202:203], v12 offset:43008
 s_waitcnt lgkmcnt(10)
 v_mfma_f32_32x32x16_bf16 v[84:99], v[212:215], v[132:135], v[84:99]
 ds_read_b64_tr_b16 v[204:205], v13 offset:40960
 ds_read_b64_tr_b16 v[206:207], v13 offset:43008
 s_bitcmp1_b32 s49, 28
 s_cbranch_scc0 C_SLN11_8
C_SBN11_8:
 s_lshl_b32 s70, s47, 12
 s_add_u32 s70, s70, s36
 buffer_load_dwordx4 v[100:103], v4, s[8:11], s70 offen offset:0 sc1
 s_waitcnt vmcnt(13) lgkmcnt(10)
 v_mfma_f32_32x32x16_bf16 v[36:51], v[216:219], v[136:139], v[36:51]
 ds_read_b64_tr_b16 v[208:209], v14 offset:40960
 ds_read_b64_tr_b16 v[210:211], v14 offset:43008
 s_waitcnt lgkmcnt(10)
 v_mfma_f32_32x32x16_bf16 v[52:67], v[220:223], v[136:139], v[52:67]
 ds_read_b64_tr_b16 v[212:213], v15 offset:40960
 ds_read_b64_tr_b16 v[214:215], v15 offset:43008
 s_waitcnt lgkmcnt(10)
 v_mfma_f32_32x32x16_bf16 v[68:83], v[224:227], v[136:139], v[68:83]
 ds_read_b64_tr_b16 v[216:217], v12 offset:45056
 ds_read_b64_tr_b16 v[218:219], v12 offset:47104
 s_waitcnt lgkmcnt(10)
 v_mfma_f32_32x32x16_bf16 v[84:99], v[228:231], v[136:139], v[84:99]
 ds_read_b64_tr_b16 v[220:221], v13 offset:45056
 ds_read_b64_tr_b16 v[222:223], v13 offset:47104
 buffer_load_dwordx4 v[104:107], v4, s[8:11], s70 offen offset:1024 sc1
 s_waitcnt vmcnt(12) lgkmcnt(10)
 v_mfma_f32_32x32x16_bf16 v[36:51], v[200:203], v[140:143], v[36:51]
 ds_read_b64_tr_b16 v[224:225], v14 offset:45056
 ds_read_b64_tr_b16 v[226:227], v14 offset:47104
 s_waitcnt lgkmcnt(10)
 s_waitcnt vmcnt(11)
 s_barrier
 v_mfma_f32_32x32x16_bf16 v[52:67], v[204:207], v[140:143], v[52:67]
 ds_read_b64_tr_b16 v[228:229], v15 offset:45056
 ds_read_b64_tr_b16 v[230:231], v15 offset:47104
 s_waitcnt lgkmcnt(10)
 v_mfma_f32_32x32x16_bf16 v[68:83], v[208:211], v[140:143], v[68:83]
 ds_read_b64_tr_b16 v[200:201], v16 offset:0
 ds_read_b64_tr_b16 v[202:203], v16 offset:2048
 s_waitcnt lgkmcnt(10)
 v_mfma_f32_32x32x16_bf16 v[84:99], v[212:215], v[140:143], v[84:99]
 ds_read_b64_tr_b16 v[204:205], v17 offset:0
 ds_read_b64_tr_b16 v[206:207], v17 offset:2048
 buffer_load_dwordx4 v[108:111], v4, s[8:11], s70 offen offset:2048 sc1
 s_waitcnt vmcnt(11) lgkmcnt(10)
 v_mfma_f32_32x32x16_bf16 v[36:51], v[216:219], v[144:147], v[36:51]
 ds_read_b64_tr_b16 v[208:209], v18 offset:0
 ds_read_b64_tr_b16 v[210:211], v18 offset:2048
 s_waitcnt lgkmcnt(10)
 v_mfma_f32_32x32x16_bf16 v[52:67], v[220:223], v[144:147], v[52:67]
 ds_read_b64_tr_b16 v[212:213], v19 offset:0
 ds_read_b64_tr_b16 v[214:215], v19 offset:2048
 s_waitcnt lgkmcnt(10)
 v_mfma_f32_32x32x16_bf16 v[68:83], v[224:227], v[144:147], v[68:83]
 ds_read_b64_tr_b16 v[216:217], v16 offset:4096
 ds_read_b64_tr_b16 v[218:219], v16 offset:6144
 s_waitcnt lgkmcnt(10)
 v_mfma_f32_32x32x16_bf16 v[84:99], v[228:231], v[144:147], v[84:99]
 ds_read_b64_tr_b16 v[220:221], v17 offset:4096
 ds_read_b64_tr_b16 v[222:223], v17 offset:6144
 buffer_load_dwordx4 v[112:115], v4, s[8:11], s70 offen offset:3072 sc1
 s_waitcnt vmcnt(10) lgkmcnt(10)
 v_mfma_f32_32x32x16_bf16 v[36:51], v[200:203], v[148:151], v[36:51]
 ds_read_b64_tr_b16 v[224:225], v18 offset:4096
 ds_read_b64_tr_b16 v[226:227], v18 offset:6144
 s_waitcnt lgkmcnt(10)
 v_mfma_f32_32x32x16_bf16 v[52:67], v[204:207], v[148:151], v[52:67]
 ds_read_b64_tr_b16 v[228:229], v19 offset:4096
 ds_read_b64_tr_b16 v[230:231], v19 offset:6144
 s_waitcnt lgkmcnt(10)
 v_mfma_f32_32x32x16_bf16 v[68:83], v[208:211], v[148:151], v[68:83]
 ds_read_b64_tr_b16 v[200:201], v16 offset:8192
 ds_read_b64_tr_b16 v[202:203], v16 offset:10240
 s_waitcnt lgkmcnt(10)
 v_mfma_f32_32x32x16_bf16 v[84:99], v[212:215], v[148:151], v[84:99]
 ds_read_b64_tr_b16 v[204:205], v17 offset:8192
 ds_read_b64_tr_b16 v[206:207], v17 offset:10240
 s_waitcnt vmcnt(8) lgkmcnt(10)
 v_mfma_f32_32x32x16_bf16 v[36:51], v[216:219], v[152:155], v[36:51]
 ds_read_b64_tr_b16 v[208:209], v18 offset:8192
 ds_read_b64_tr_b16 v[210:211], v18 offset:10240
 s_waitcnt lgkmcnt(10)
 v_mfma_f32_32x32x16_bf16 v[52:67], v[220:223], v[152:155], v[52:67]
 ds_read_b64_tr_b16 v[212:213], v19 offset:8192
 ds_read_b64_tr_b16 v[214:215], v19 offset:10240
 s_add_u32 s16, s4, 0x8000000
 s_addc_u32 s17, s5, 0
 s_and_b32 s17, s17, 0xffff
 s_mov_b32 s18, 0x1000000
 s_mov_b32 s19, 0x00020000
 s_mov_b32 s20, s78
 s_and_b32 s21, s79, 0xffff
 s_mov_b32 s22, 0x200000
 s_mov_b32 s23, 0x00020000
 s_mov_b32 s24, s80
 s_and_b32 s25, s81, 0xffff
 s_mov_b32 s26, 0x200000
 s_mov_b32 s27, 0x00020000
 s_lshl_b32 s39, s32, 2
 s_add_u32 s40, s39, s33
 s_lshl_b32 s40, s40, 3
 s_add_u32 s40, s40, s55
 s_lshl_b32 s40, s40, 13
 s_mul_i32 s71, s31, 0x400000
 s_add_u32 s71, s71, s40
 s_add_u32 s72, s71, 4096
 s_lshl_b32 s28, s31, 7
 s_add_u32 s28, s28, s40
 s_add_u32 s29, s28, 0x400000
 s_add_u32 s30, s28, 0x800000
 s_add_u32 s41, s28, 0xc00000
 s_add_u32 s39, s39, s35
 s_lshl_b32 s39, s39, 2
 s_add_u32 s39, s39, s31
 s_lshl_b32 s73, s39, 13
 s_lshl_b32 s40, s33, 1
 s_add_u32 s40, s40, s34
 s_lshl_b32 s40, s40, 7
 s_add_u32 s73, s73, s40
 s_lshl_b32 s39, s31, 3
 s_lshl_b32 s42, 0xff, s39
 s_mov_b32 s43, s42
 v_lshrrev_b32 v20, 3, v0
 v_and_b32 v21, 7, v0
 v_lshlrev_b32 v168, 10, v20
 v_lshl_add_u32 v168, v21, 4, v168
 v_lshlrev_b32 v172, 9, v21
 v_lshl_add_u32 v172, v20, 4, v172
 v_lshrrev_b32 v22, 1, v21
 v_mul_u32_u24 v22, 1024, v22
 v_add_u32 v173, v22, v172
 v_lshl_add_u32 v22, v21, 9, v172
 s_cmp_eq_u32 s31, 0
 s_cselect_b64 vcc, -1, 0
 v_cndmask_b32 v172, v22, v172, vcc
 buffer_load_dwordx4 v[176:179], v168, s[20:23], s73 offen
 s_waitcnt lgkmcnt(10)
 v_mfma_f32_32x32x16_bf16 v[68:83], v[224:227], v[152:155], v[68:83]
 ds_read_b64_tr_b16 v[216:217], v16 offset:12288
 ds_read_b64_tr_b16 v[218:219], v16 offset:14336
 s_waitcnt lgkmcnt(10)
 v_mfma_f32_32x32x16_bf16 v[84:99], v[228:231], v[152:155], v[84:99]
 ds_read_b64_tr_b16 v[220:221], v17 offset:12288
 ds_read_b64_tr_b16 v[222:223], v17 offset:14336
 s_waitcnt vmcnt(7) lgkmcnt(10)
 v_mfma_f32_32x32x16_bf16 v[36:51], v[200:203], v[156:159], v[36:51]
 ds_read_b64_tr_b16 v[224:225], v18 offset:12288
 ds_read_b64_tr_b16 v[226:227], v18 offset:14336
 s_waitcnt lgkmcnt(10)
 s_waitcnt vmcnt(6)
 s_barrier
 v_mfma_f32_32x32x16_bf16 v[52:67], v[204:207], v[156:159], v[52:67]
 ds_read_b64_tr_b16 v[228:229], v19 offset:12288
 ds_read_b64_tr_b16 v[230:231], v19 offset:14336
 s_waitcnt lgkmcnt(10)
 v_mfma_f32_32x32x16_bf16 v[68:83], v[208:211], v[156:159], v[68:83]
 ds_read_b64_tr_b16 v[200:201], v8 offset:0
 ds_read_b64_tr_b16 v[202:203], v8 offset:2048
 s_waitcnt lgkmcnt(10)
 v_mfma_f32_32x32x16_bf16 v[84:99], v[212:215], v[156:159], v[84:99]
 ds_read_b64_tr_b16 v[204:205], v9 offset:0
 ds_read_b64_tr_b16 v[206:207], v9 offset:2048
 s_waitcnt vmcnt(5) lgkmcnt(10)
 v_mfma_f32_32x32x16_bf16 v[36:51], v[216:219], v[160:163], v[36:51]
 ds_read_b64_tr_b16 v[208:209], v10 offset:0
 ds_read_b64_tr_b16 v[210:211], v10 offset:2048
 s_waitcnt lgkmcnt(10)
 v_mfma_f32_32x32x16_bf16 v[52:67], v[220:223], v[160:163], v[52:67]
 ds_read_b64_tr_b16 v[212:213], v11 offset:0
 ds_read_b64_tr_b16 v[214:215], v11 offset:2048
 s_waitcnt lgkmcnt(10)
 v_mfma_f32_32x32x16_bf16 v[68:83], v[224:227], v[160:163], v[68:83]
 ds_read_b64_tr_b16 v[216:217], v8 offset:4096
 ds_read_b64_tr_b16 v[218:219], v8 offset:6144
 s_waitcnt lgkmcnt(10)
 v_mfma_f32_32x32x16_bf16 v[84:99], v[228:231], v[160:163], v[84:99]
 ds_read_b64_tr_b16 v[220:221], v9 offset:4096
 ds_read_b64_tr_b16 v[222:223], v9 offset:6144
 s_waitcnt vmcnt(4) lgkmcnt(10)
 v_mfma_f32_32x32x16_bf16 v[36:51], v[200:203], v[100:103], v[36:51]
 ds_read_b64_tr_b16 v[224:225], v10 offset:4096
 ds_read_b64_tr_b16 v[226:227], v10 offset:6144
 s_waitcnt lgkmcnt(10)
 v_mfma_f32_32x32x16_bf16 v[52:67], v[204:207], v[100:103], v[52:67]
 ds_read_b64_tr_b16 v[228:229], v11 offset:4096
 ds_read_b64_tr_b16 v[230:231], v11 offset:6144
 s_waitcnt lgkmcnt(10)
 v_mfma_f32_32x32x16_bf16 v[68:83], v[208:211], v[100:103], v[68:83]
 ds_read_b64_tr_b16 v[200:201], v8 offset:8192
 ds_read_b64_tr_b16 v[202:203], v8 offset:10240
 s_waitcnt lgkmcnt(10)
 v_mfma_f32_32x32x16_bf16 v[84:99], v[212:215], v[100:103], v[84:99]
 ds_read_b64_tr_b16 v[204:205], v9 offset:8192
 ds_read_b64_tr_b16 v[206:207], v9 offset:10240
 s_waitcnt vmcnt(3) lgkmcnt(10)
 v_mfma_f32_32x32x16_bf16 v[36:51], v[216:219], v[104:107], v[36:51]
 ds_read_b64_tr_b16 v[208:209], v10 offset:8192
 ds_read_b64_tr_b16 v[210:211], v10 offset:10240
 s_waitcnt lgkmcnt(10)
 v_mfma_f32_32x32x16_bf16 v[52:67], v[220:223], v[104:107], v[52:67]
 ds_read_b64_tr_b16 v[212:213], v11 offset:8192
 ds_read_b64_tr_b16 v[214:215], v11 offset:10240
 s_waitcnt lgkmcnt(10)
 v_mfma_f32_32x32x16_bf16 v[68:83], v[224:227], v[104:107], v[68:83]
 ds_read_b64_tr_b16 v[216:217], v8 offset:12288
 ds_read_b64_tr_b16 v[218:219], v8 offset:14336
 s_waitcnt lgkmcnt(10)
 v_mfma_f32_32x32x16_bf16 v[84:99], v[228:231], v[104:107], v[84:99]
 ds_read_b64_tr_b16 v[220:221], v9 offset:12288
 ds_read_b64_tr_b16 v[222:223], v9 offset:14336
 s_waitcnt vmcnt(2) lgkmcnt(10)
 v_mfma_f32_32x32x16_bf16 v[36:51], v[200:203], v[108:111], v[36:51]
 ds_read_b64_tr_b16 v[224:225], v10 offset:12288
 ds_read_b64_tr_b16 v[226:227], v10 offset:14336
 s_waitcnt lgkmcnt(10)
 v_mfma_f32_32x32x16_bf16 v[52:67], v[204:207], v[108:111], v[52:67]
 ds_read_b64_tr_b16 v[228:229], v11 offset:12288
 ds_read_b64_tr_b16 v[230:231], v11 offset:14336
 s_waitcnt lgkmcnt(10)
 v_mfma_f32_32x32x16_bf16 v[68:83], v[208:211], v[108:111], v[68:83]
 s_waitcnt lgkmcnt(8)
 v_mfma_f32_32x32x16_bf16 v[84:99], v[212:215], v[108:111], v[84:99]
 s_waitcnt vmcnt(1) lgkmcnt(6)
 v_mfma_f32_32x32x16_bf16 v[36:51], v[216:219], v[112:115], v[36:51]
 s_waitcnt lgkmcnt(4)
 v_mfma_f32_32x32x16_bf16 v[52:67], v[220:223], v[112:115], v[52:67]
 s_waitcnt lgkmcnt(2)
 v_mfma_f32_32x32x16_bf16 v[68:83], v[224:227], v[112:115], v[68:83]
 s_waitcnt lgkmcnt(0)
 v_mfma_f32_32x32x16_bf16 v[84:99], v[228:231], v[112:115], v[84:99]
 s_add_u32 s39, s67, 32768
 s_add_u32 s40, s67, 0
 s_add_u32 s44, s66, 32768
 s_branch C_EPI
C_MAINN12:
 ds_read_b32 v169, v5 offset:4
 ds_read_b64_tr_b16 v[200:201], v8 offset:0
 ds_read_b64_tr_b16 v[202:203], v8 offset:2048
 ds_read_b64_tr_b16 v[204:205], v9 offset:0
 ds_read_b64_tr_b16 v[206:207], v9 offset:2048
 ds_read_b64_tr_b16 v[208:209], v10 offset:0
 ds_read_b64_tr_b16 v[210:211], v10 offset:2048
 ds_read_b64_tr_b16 v[212:213], v11 offset:0
 ds_read_b64_tr_b16 v[214:215], v11 offset:2048
 ds_read_b64_tr_b16 v[216:217], v8 offset:4096
 ds_read_b64_tr_b16 v[218:219], v8 offset:6144
 ds_read_b64_tr_b16 v[220:221], v9 offset:4096
 ds_read_b64_tr_b16 v[222:223], v9 offset:6144
 s_waitcnt vmcnt(15) lgkmcnt(10)
 v_readfirstlane_b32 s49, v169
 s_bfe_u32 s47, s49, 0x6000e
 s_bfe_u32 s48, s49, 0x60014
 v_mfma_f32_32x32x16_bf16 v[36:51], v[200:203], v[132:135], v[36:51]
 ds_read_b64_tr_b16 v[224:225], v10 offset:4096
 ds_read_b64_tr_b16 v[226:227], v10 offset:6144
 s_waitcnt lgkmcnt(10)
 v_mfma_f32_32x32x16_bf16 v[52:67], v[204:207], v[132:135], v[52:67]
 ds_read_b64_tr_b16 v[228:229], v11 offset:4096
 ds_read_b64_tr_b16 v[230:231], v11 offset:6144
 s_lshl_b32 s69, s48, 16
 s_add_u32 s69, s69, s37
 s_add_u32 m0, s67, 32768
 s_add_u32 s39, s69, 0
 buffer_load_dwordx4 v6, s[12:15], s39 offen offset:0 lds
 s_waitcnt lgkmcnt(10)
 s_cmp_eq_u32 s55, 4
 s_cbranch_scc0 C_NDN12_0
 s_waitcnt vmcnt(2)
 v_cmp_eq_u64 vcc, s[90:91], v[24:25]
 v_cmp_eq_u64 s[60:61], s[90:91], v[26:27]
 s_and_b64 s[60:61], vcc, s[60:61]
 s_lshr_b64 s[58:59], s[60:61], 1
 s_and_b64 s[58:59], s[58:59], s[60:61]
 s_andn2_b64 s[60:61], s[64:65], s[60:61]
 s_cselect_b64 s[58:59], 0, s[58:59]
 s_and_b64 s[60:61], s[58:59], s[56:57]
 s_cselect_b64 s[60:61], s[60:61], s[56:57]
 s_ff1_i32_b64 s40, s[60:61]
 s_bitset0_b64 s[56:57], s40
 s_bitcmp1_b64 s[58:59], s48
 s_cselect_b32 s44, 0x10000000, 0
 s_or_b32 s40, s40, s44
 v_mov_b32 v165, s40
 s_sub_u32 s44, s67, 0x4000
 v_add_u32 v20, s44, v164
 ds_write_b32 v20, v165 offset:35840
 buffer_load_dwordx4 v[24:27], v4, s[96:99], s50 offen sc1
C_NDN12_0:
 v_mfma_f32_32x32x16_bf16 v[68:83], v[208:211], v[132:135], v[68:83]
 ds_read_b64_tr_b16 v[200:201], v8 offset:8192
 ds_read_b64_tr_b16 v[202:203], v8 offset:10240
 s_waitcnt lgkmcnt(10)
 v_mfma_f32_32x32x16_bf16 v[84:99], v[212:215], v[132:135], v[84:99]
 ds_read_b64_tr_b16 v[204:205], v9 offset:8192
 ds_read_b64_tr_b16 v[206:207], v9 offset:10240
 s_bitcmp1_b32 s49, 28
 s_cbranch_scc0 C_SLN12_0
C_SBN12_0:
 s_lshl_b32 s70, s47, 12
 s_add_u32 s70, s70, s36
 buffer_load_dwordx4 v[100:103], v4, s[8:11], s70 offen offset:0 sc1
 s_waitcnt vmcnt(16) lgkmcnt(10)
 v_mfma_f32_32x32x16_bf16 v[36:51], v[216:219], v[136:139], v[36:51]
 ds_read_b64_tr_b16 v[208:209], v10 offset:8192
 ds_read_b64_tr_b16 v[210:211], v10 offset:10240
 s_waitcnt lgkmcnt(10)
 v_mfma_f32_32x32x16_bf16 v[52:67], v[220:223], v[136:139], v[52:67]
 ds_read_b64_tr_b16 v[212:213], v11 offset:8192
 ds_read_b64_tr_b16 v[214:215], v11 offset:10240
 s_add_u32 s39, s69, 3072
 buffer_load_dwordx4 v6, s[12:15], s39 offen offset:1024 lds
 s_waitcnt lgkmcnt(10)
 v_mfma_f32_32x32x16_bf16 v[68:83], v[224:227], v[136:139], v[68:83]
 ds_read_b64_tr_b16 v[216:217], v8 offset:12288
 ds_read_b64_tr_b16 v[218:219], v8 offset:14336
 s_waitcnt lgkmcnt(10)
 v_mfma_f32_32x32x16_bf16 v[84:99], v[228:231], v[136:139], v[84:99]
 ds_read_b64_tr_b16 v[220:221], v9 offset:12288
 ds_read_b64_tr_b16 v[222:223], v9 offset:14336
 buffer_load_dwordx4 v[104:107], v4, s[8:11], s70 offen offset:1024 sc1
 s_waitcnt vmcnt(17) lgkmcnt(10)
 v_mfma_f32_32x32x16_bf16 v[36:51], v[200:203], v[140:143], v[36:51]
 ds_read_b64_tr_b16 v[224:225], v10 offset:12288
 ds_read_b64_tr_b16 v[226:227], v10 offset:14336
 s_waitcnt lgkmcnt(10)
 s_waitcnt vmcnt(20)
 s_barrier
 v_mov_b32 v21, s67
 ds_read_b32 v169, v21 offset:35840
 v_mfma_f32_32x32x16_bf16 v[52:67], v[204:207], v[140:143], v[52:67]
 ds_read_b64_tr_b16 v[228:229], v11 offset:12288
 ds_read_b64_tr_b16 v[230:231], v11 offset:14336
 s_add_u32 s39, s69, 6144
 buffer_load_dwordx4 v6, s[12:15], s39 offen offset:2048 lds
 s_waitcnt lgkmcnt(10)
 v_mfma_f32_32x32x16_bf16 v[68:83], v[208:211], v[140:143], v[68:83]
 ds_read_b64_tr_b16 v[200:201], v8 offset:32768
 ds_read_b64_tr_b16 v[202:203], v8 offset:34816
 s_waitcnt lgkmcnt(10)
 v_mfma_f32_32x32x16_bf16 v[84:99], v[212:215], v[140:143], v[84:99]
 ds_read_b64_tr_b16 v[204:205], v9 offset:32768
 ds_read_b64_tr_b16 v[206:207], v9 offset:34816
 buffer_load_dwordx4 v[108:111], v4, s[8:11], s70 offen offset:2048 sc1
 s_waitcnt vmcnt(18) lgkmcnt(10)
 v_mfma_f32_32x32x16_bf16 v[36:51], v[216:219], v[144:147], v[36:51]
 ds_read_b64_tr_b16 v[208:209], v10 offset:32768
 ds_read_b64_tr_b16 v[210:211], v10 offset:34816
 s_waitcnt lgkmcnt(10)
 v_mfma_f32_32x32x16_bf16 v[52:67], v[220:223], v[144:147], v[52:67]
 ds_read_b64_tr_b16 v[212:213], v11 offset:32768
 ds_read_b64_tr_b16 v[214:215], v11 offset:34816
 s_waitcnt lgkmcnt(10)
 s_add_u32 s39, s69, 9216
 buffer_load_dwordx4 v6, s[12:15], s39 offen offset:3072 lds
 s_waitcnt lgkmcnt(10)
 v_mfma_f32_32x32x16_bf16 v[68:83], v[224:227], v[144:147], v[68:83]
 ds_read_b64_tr_b16 v[216:217], v8 offset:36864
 ds_read_b64_tr_b16 v[218:219], v8 offset:38912
 s_waitcnt lgkmcnt(10)
 v_mfma_f32_32x32x16_bf16 v[84:99], v[228:231], v[144:147], v[84:99]
 ds_read_b64_tr_b16 v[220:221], v9 offset:36864
 ds_read_b64_tr_b16 v[222:223], v9 offset:38912
 buffer_load_dwordx4 v[112:115], v4, s[8:11], s70 offen offset:3072 sc1
 s_waitcnt vmcnt(19) lgkmcnt(10)
 v_readfirstlane_b32 s49, v169
 s_and_b32 s45, s49, 63
 v_mfma_f32_32x32x16_bf16 v[36:51], v[200:203], v[148:151], v[36:51]
 ds_read_b64_tr_b16 v[224:225], v10 offset:36864
 ds_read_b64_tr_b16 v[226:227], v10 offset:38912
 s_waitcnt lgkmcnt(10)
 v_mfma_f32_32x32x16_bf16 v[52:67], v[204:207], v[148:151], v[52:67]
 ds_read_b64_tr_b16 v[228:229], v11 offset:36864
 ds_read_b64_tr_b16 v[230:231], v11 offset:38912
 s_lshl_b32 s69, s45, 16
 s_add_u32 s69, s69, s37
 s_add_u32 m0, s68, 0
 s_add_u32 s39, s69, 0
 buffer_load_dwordx4 v6, s[12:15], s39 offen offset:0 lds
 s_waitcnt lgkmcnt(10)
 s_cmp_eq_u32 s55, 4
 s_cbranch_scc0 C_NDN12_1
 s_waitcnt vmcnt(10)
 v_cmp_eq_u64 vcc, s[90:91], v[28:29]
 v_cmp_eq_u64 s[60:61], s[90:91], v[30:31]
 s_and_b64 s[60:61], vcc, s[60:61]
 s_lshr_b64 s[58:59], s[60:61], 1
 s_and_b64 s[58:59], s[58:59], s[60:61]
 s_andn2_b64 s[60:61], s[64:65], s[60:61]
 s_cselect_b64 s[58:59], 0, s[58:59]
 s_and_b64 s[60:61], s[58:59], s[56:57]
 s_cselect_b64 s[60:61], s[60:61], s[56:57]
 s_ff1_i32_b64 s40, s[60:61]
 s_bitset0_b64 s[56:57], s40
 s_bitcmp1_b64 s[58:59], s45
 s_cselect_b32 s44, 0x10000000, 0
 s_or_b32 s40, s40, s44
 v_mov_b32 v165, s40
 s_sub_u32 s44, s68, 0x4000
 v_add_u32 v20, s44, v164
 ds_write_b32 v20, v165 offset:3072
 buffer_load_dwordx4 v[28:31], v4, s[96:99], s50 offen sc1
C_NDN12_1:
 v_mfma_f32_32x32x16_bf16 v[68:83], v[208:211], v[148:151], v[68:83]
 ds_read_b64_tr_b16 v[200:201], v8 offset:40960
 ds_read_b64_tr_b16 v[202:203], v8 offset:43008
 s_waitcnt lgkmcnt(10)
 v_mfma_f32_32x32x16_bf16 v[84:99], v[212:215], v[148:151], v[84:99]
 ds_read_b64_tr_b16 v[204:205], v9 offset:40960
 ds_read_b64_tr_b16 v[206:207], v9 offset:43008
 s_bitcmp1_b32 s49, 28
 s_cbranch_scc0 C_SLN12_1
C_SBN12_1:
 s_lshl_b32 s70, s48, 12
 s_add_u32 s70, s70, s36
 buffer_load_dwordx4 v[116:119], v4, s[8:11], s70 offen offset:0 sc1
 s_waitcnt vmcnt(20) lgkmcnt(10)
 v_mfma_f32_32x32x16_bf16 v[36:51], v[216:219], v[152:155], v[36:51]
 ds_read_b64_tr_b16 v[208:209], v10 offset:40960
 ds_read_b64_tr_b16 v[210:211], v10 offset:43008
 s_waitcnt lgkmcnt(10)
 v_mfma_f32_32x32x16_bf16 v[52:67], v[220:223], v[152:155], v[52:67]
 ds_read_b64_tr_b16 v[212:213], v11 offset:40960
 ds_read_b64_tr_b16 v[214:215], v11 offset:43008
 s_add_u32 s39, s69, 3072
 buffer_load_dwordx4 v6, s[12:15], s39 offen offset:1024 lds
 s_waitcnt lgkmcnt(10)
 v_mfma_f32_32x32x16_bf16 v[68:83], v[224:227], v[152:155], v[68:83]
 ds_read_b64_tr_b16 v[216:217], v8 offset:45056
 ds_read_b64_tr_b16 v[218:219], v8 offset:47104
 s_waitcnt lgkmcnt(10)
 v_mfma_f32_32x32x16_bf16 v[84:99], v[228:231], v[152:155], v[84:99]
 ds_read_b64_tr_b16 v[220:221], v9 offset:45056
 ds_read_b64_tr_b16 v[222:223], v9 offset:47104
 buffer_load_dwordx4 v[120:123], v4, s[8:11], s70 offen offset:1024 sc1
 s_waitcnt vmcnt(21) lgkmcnt(10)
 v_mfma_f32_32x32x16_bf16 v[36:51], v[200:203], v[156:159], v[36:51]
 ds_read_b64_tr_b16 v[224:225], v10 offset:45056
 ds_read_b64_tr_b16 v[226:227], v10 offset:47104
 s_waitcnt lgkmcnt(10)
 s_waitcnt vmcnt(12)
 s_barrier
 v_mov_b32 v21, s68
 ds_read_b32 v169, v21 offset:3072
 v_mfma_f32_32x32x16_bf16 v[52:67], v[204:207], v[156:159], v[52:67]
 ds_read_b64_tr_b16 v[228:229], v11 offset:45056
 ds_read_b64_tr_b16 v[230:231], v11 offset:47104
 s_add_u32 s39, s69, 6144
 buffer_load_dwordx4 v6, s[12:15], s39 offen offset:2048 lds
 s_waitcnt lgkmcnt(10)
 v_mfma_f32_32x32x16_bf16 v[68:83], v[208:211], v[156:159], v[68:83]
 ds_read_b64_tr_b16 v[200:201], v12 offset:0
 ds_read_b64_tr_b16 v[202:203], v12 offset:2048
 s_waitcnt lgkmcnt(10)
 v_mfma_f32_32x32x16_bf16 v[84:99], v[212:215], v[156:159], v[84:99]
 ds_read_b64_tr_b16 v[204:205], v13 offset:0
 ds_read_b64_tr_b16 v[206:207], v13 offset:2048
 buffer_load_dwordx4 v[124:127], v4, s[8:11], s70 offen offset:2048 sc1
 s_waitcnt vmcnt(22) lgkmcnt(10)
 v_mfma_f32_32x32x16_bf16 v[36:51], v[216:219], v[160:163], v[36:51]
 ds_read_b64_tr_b16 v[208:209], v14 offset:0
 ds_read_b64_tr_b16 v[210:211], v14 offset:2048
 s_waitcnt lgkmcnt(10)
 v_mfma_f32_32x32x16_bf16 v[52:67], v[220:223], v[160:163], v[52:67]
 ds_read_b64_tr_b16 v[212:213], v15 offset:0
 ds_read_b64_tr_b16 v[214:215], v15 offset:2048
 s_waitcnt lgkmcnt(10)
 s_add_u32 s39, s69, 9216
 buffer_load_dwordx4 v6, s[12:15], s39 offen offset:3072 lds
 s_waitcnt lgkmcnt(10)
 v_mfma_f32_32x32x16_bf16 v[68:83], v[224:227], v[160:163], v[68:83]
 ds_read_b64_tr_b16 v[216:217], v12 offset:4096
 ds_read_b64_tr_b16 v[218:219], v12 offset:6144
 s_waitcnt lgkmcnt(10)
 v_mfma_f32_32x32x16_bf16 v[84:99], v[228:231], v[160:163], v[84:99]
 ds_read_b64_tr_b16 v[220:221], v13 offset:4096
 ds_read_b64_tr_b16 v[222:223], v13 offset:6144
 buffer_load_dwordx4 v[128:131], v4, s[8:11], s70 offen offset:3072 sc1
 s_waitcnt vmcnt(14) lgkmcnt(10)
 v_readfirstlane_b32 s49, v169
 s_and_b32 s46, s49, 63
 v_mfma_f32_32x32x16_bf16 v[36:51], v[200:203], v[100:103], v[36:51]
 ds_read_b64_tr_b16 v[224:225], v14 offset:4096
 ds_read_b64_tr_b16 v[226:227], v14 offset:6144
 s_waitcnt lgkmcnt(10)
 v_mfma_f32_32x32x16_bf16 v[52:67], v[204:207], v[100:103], v[52:67]
 ds_read_b64_tr_b16 v[228:229], v15 offset:4096
 ds_read_b64_tr_b16 v[230:231], v15 offset:6144
 s_lshl_b32 s69, s46, 16
 s_add_u32 s69, s69, s37
 s_add_u32 m0, s66, 0
 s_add_u32 s39, s69, 0
 buffer_load_dwordx4 v6, s[12:15], s39 offen offset:0 lds
 s_waitcnt lgkmcnt(10)
 s_cmp_eq_u32 s55, 4
 s_cbranch_scc0 C_NDN12_2
 s_waitcnt vmcnt(17)
 v_cmp_eq_u64 vcc, s[90:91], v[24:25]
 v_cmp_eq_u64 s[60:61], s[90:91], v[26:27]
 s_and_b64 s[60:61], vcc, s[60:61]
 s_lshr_b64 s[58:59], s[60:61], 1
 s_and_b64 s[58:59], s[58:59], s[60:61]
 s_andn2_b64 s[60:61], s[64:65], s[60:61]
 s_cselect_b64 s[58:59], 0, s[58:59]
 s_and_b64 s[60:61], s[58:59], s[56:57]
 s_cselect_b64 s[60:61], s[60:61], s[56:57]
 s_ff1_i32_b64 s40, s[60:61]
 s_bitset0_b64 s[56:57], s40
 s_bitcmp1_b64 s[58:59], s46
 s_cselect_b32 s44, 0x10000000, 0
 s_or_b32 s40, s40, s44
 v_mov_b32 v165, s40
 s_sub_u32 s44, s66, 0x4000
 v_add_u32 v20, s44, v164
 ds_write_b32 v20, v165 offset:3072
 buffer_load_dwordx4 v[24:27], v4, s[96:99], s50 offen sc1
C_NDN12_2:
 v_mfma_f32_32x32x16_bf16 v[68:83], v[208:211], v[100:103], v[68:83]
 ds_read_b64_tr_b16 v[200:201], v12 offset:8192
 ds_read_b64_tr_b16 v[202:203], v12 offset:10240
 s_waitcnt lgkmcnt(10)
 v_mfma_f32_32x32x16_bf16 v[84:99], v[212:215], v[100:103], v[84:99]
 ds_read_b64_tr_b16 v[204:205], v13 offset:8192
 ds_read_b64_tr_b16 v[206:207], v13 offset:10240
 s_bitcmp1_b32 s49, 28
 s_cbranch_scc0 C_SLN12_2
C_SBN12_2:
 s_lshl_b32 s70, s45, 12
 s_add_u32 s70, s70, s36
 buffer_load_dwordx4 v[132:135], v4, s[8:11], s70 offen offset:0 sc1
 s_waitcnt vmcnt(14) lgkmcnt(10)
 v_mfma_f32_32x32x16_bf16 v[36:51], v[216:219], v[104:107], v[36:51]
 ds_read_b64_tr_b16 v[208:209], v14 offset:8192
 ds_read_b64_tr_b16 v[210:211], v14 offset:10240
 s_waitcnt lgkmcnt(10)
 v_mfma_f32_32x32x16_bf16 v[52:67], v[220:223], v[104:107], v[52:67]
 ds_read_b64_tr_b16 v[212:213], v15 offset:8192
 ds_read_b64_tr_b16 v[214:215], v15 offset:10240
 s_add_u32 s39, s69, 3072
 buffer_load_dwordx4 v6, s[12:15], s39 offen offset:1024 lds
 s_waitcnt lgkmcnt(10)
 v_mfma_f32_32x32x16_bf16 v[68:83], v[224:227], v[104:107], v[68:83]
 ds_read_b64_tr_b16 v[216:217], v12 offset:12288
 ds_read_b64_tr_b16 v[218:219], v12 offset:14336
 s_waitcnt lgkmcnt(10)
 v_mfma_f32_32x32x16_bf16 v[84:99], v[228:231], v[104:107], v[84:99]
 ds_read_b64_tr_b16 v[220:221], v13 offset:12288
 ds_read_b64_tr_b16 v[222:223], v13 offset:14336
 buffer_load_dwordx4 v[136:139], v4, s[8:11], s70 offen offset:1024 sc1
 s_waitcnt vmcnt(14) lgkmcnt(10)
 v_mfma_f32_32x32x16_bf16 v[36:51], v[200:203], v[108:111], v[36:51]
 ds_read_b64_tr_b16 v[224:225], v14 offset:12288
 ds_read_b64_tr_b16 v[226:227], v14 offset:14336
 s_waitcnt lgkmcnt(10)
 s_waitcnt vmcnt(13)
 s_barrier
 v_mov_b32 v21, s66
 ds_read_b32 v169, v21 offset:3072
 v_mfma_f32_32x32x16_bf16 v[52:67], v[204:207], v[108:111], v[52:67]
 ds_read_b64_tr_b16 v[228:229], v15 offset:12288
 ds_read_b64_tr_b16 v[230:231], v15 offset:14336
 s_add_u32 s39, s69, 6144
 buffer_load_dwordx4 v6, s[12:15], s39 offen offset:2048 lds
 s_waitcnt lgkmcnt(10)
 v_mfma_f32_32x32x16_bf16 v[68:83], v[208:211], v[108:111], v[68:83]
 ds_read_b64_tr_b16 v[200:201], v12 offset:32768
 ds_read_b64_tr_b16 v[202:203], v12 offset:34816
 s_waitcnt lgkmcnt(10)
 v_mfma_f32_32x32x16_bf16 v[84:99], v[212:215], v[108:111], v[84:99]
 ds_read_b64_tr_b16 v[204:205], v13 offset:32768
 ds_read_b64_tr_b16 v[206:207], v13 offset:34816
 buffer_load_dwordx4 v[140:143], v4, s[8:11], s70 offen offset:2048 sc1
 s_waitcnt vmcnt(14) lgkmcnt(10)
 v_mfma_f32_32x32x16_bf16 v[36:51], v[216:219], v[112:115], v[36:51]
 ds_read_b64_tr_b16 v[208:209], v14 offset:32768
 ds_read_b64_tr_b16 v[210:211], v14 offset:34816
 s_waitcnt lgkmcnt(10)
 v_mfma_f32_32x32x16_bf16 v[52:67], v[220:223], v[112:115], v[52:67]
 ds_read_b64_tr_b16 v[212:213], v15 offset:32768
 ds_read_b64_tr_b16 v[214:215], v15 offset:34816
 s_waitcnt lgkmcnt(10)
 s_add_u32 s39, s69, 9216
 buffer_load_dwordx4 v6, s[12:15], s39 offen offset:3072 lds
 s_waitcnt lgkmcnt(10)
 v_mfma_f32_32x32x16_bf16 v[68:83], v[224:227], v[112:115], v[68:83]
 ds_read_b64_tr_b16 v[216:217], v12 offset:36864
 ds_read_b64_tr_b16 v[218:219], v12 offset:38912
 s_waitcnt lgkmcnt(10)
 v_mfma_f32_32x32x16_bf16 v[84:99], v[228:231], v[112:115], v[84:99]
 ds_read_b64_tr_b16 v[220:221], v13 offset:36864
 ds_read_b64_tr_b16 v[222:223], v13 offset:38912
 buffer_load_dwordx4 v[144:147], v4, s[8:11], s70 offen offset:3072 sc1
 s_waitcnt vmcnt(14) lgkmcnt(10)
 v_readfirstlane_b32 s49, v169
 s_and_b32 s47, s49, 63
 v_mfma_f32_32x32x16_bf16 v[36:51], v[200:203], v[116:119], v[36:51]
 ds_read_b64_tr_b16 v[224:225], v14 offset:36864
 ds_read_b64_tr_b16 v[226:227], v14 offset:38912
 s_waitcnt lgkmcnt(10)
 v_mfma_f32_32x32x16_bf16 v[52:67], v[204:207], v[116:119], v[52:67]
 ds_read_b64_tr_b16 v[228:229], v15 offset:36864
 ds_read_b64_tr_b16 v[230:231], v15 offset:38912
 s_lshl_b32 s69, s47, 16
 s_add_u32 s69, s69, s37
 s_add_u32 m0, s66, 32768
 s_add_u32 s39, s69, 0
 buffer_load_dwordx4 v6, s[12:15], s39 offen offset:0 lds
 s_waitcnt lgkmcnt(10)
 s_cmp_eq_u32 s55, 4
 s_cbranch_scc0 C_NDN12_3
 s_waitcnt vmcnt(17)
 v_cmp_eq_u64 vcc, s[90:91], v[28:29]
 v_cmp_eq_u64 s[60:61], s[90:91], v[30:31]
 s_and_b64 s[60:61], vcc, s[60:61]
 s_lshr_b64 s[58:59], s[60:61], 1
 s_and_b64 s[58:59], s[58:59], s[60:61]
 s_andn2_b64 s[60:61], s[64:65], s[60:61]
 s_cselect_b64 s[58:59], 0, s[58:59]
 s_and_b64 s[60:61], s[58:59], s[56:57]
 s_cselect_b64 s[60:61], s[60:61], s[56:57]
 s_ff1_i32_b64 s40, s[60:61]
 s_bitset0_b64 s[56:57], s40
 s_bitcmp1_b64 s[58:59], s47
 s_cselect_b32 s44, 0x10000000, 0
 s_or_b32 s40, s40, s44
 v_mov_b32 v165, s40
 s_sub_u32 s44, s66, 0x4000
 v_add_u32 v20, s44, v164
 ds_write_b32 v20, v165 offset:35840
 buffer_load_dwordx4 v[28:31], v4, s[96:99], s50 offen sc1
C_NDN12_3:
 v_mfma_f32_32x32x16_bf16 v[68:83], v[208:211], v[116:119], v[68:83]
 ds_read_b64_tr_b16 v[200:201], v12 offset:40960
 ds_read_b64_tr_b16 v[202:203], v12 offset:43008
 s_waitcnt lgkmcnt(10)
 v_mfma_f32_32x32x16_bf16 v[84:99], v[212:215], v[116:119], v[84:99]
 ds_read_b64_tr_b16 v[204:205], v13 offset:40960
 ds_read_b64_tr_b16 v[206:207], v13 offset:43008
 s_bitcmp1_b32 s49, 28
 s_cbranch_scc0 C_SLN12_3
C_SBN12_3:
 s_lshl_b32 s70, s46, 12
 s_add_u32 s70, s70, s36
 buffer_load_dwordx4 v[148:151], v4, s[8:11], s70 offen offset:0 sc1
 s_waitcnt vmcnt(14) lgkmcnt(10)
 v_mfma_f32_32x32x16_bf16 v[36:51], v[216:219], v[120:123], v[36:51]
 ds_read_b64_tr_b16 v[208:209], v14 offset:40960
 ds_read_b64_tr_b16 v[210:211], v14 offset:43008
 s_waitcnt lgkmcnt(10)
 v_mfma_f32_32x32x16_bf16 v[52:67], v[220:223], v[120:123], v[52:67]
 ds_read_b64_tr_b16 v[212:213], v15 offset:40960
 ds_read_b64_tr_b16 v[214:215], v15 offset:43008
 s_add_u32 s39, s69, 3072
 buffer_load_dwordx4 v6, s[12:15], s39 offen offset:1024 lds
 s_waitcnt lgkmcnt(10)
 v_mfma_f32_32x32x16_bf16 v[68:83], v[224:227], v[120:123], v[68:83]
 ds_read_b64_tr_b16 v[216:217], v12 offset:45056
 ds_read_b64_tr_b16 v[218:219], v12 offset:47104
 s_waitcnt lgkmcnt(10)
 v_mfma_f32_32x32x16_bf16 v[84:99], v[228:231], v[120:123], v[84:99]
 ds_read_b64_tr_b16 v[220:221], v13 offset:45056
 ds_read_b64_tr_b16 v[222:223], v13 offset:47104
 buffer_load_dwordx4 v[152:155], v4, s[8:11], s70 offen offset:1024 sc1
 s_waitcnt vmcnt(14) lgkmcnt(10)
 v_mfma_f32_32x32x16_bf16 v[36:51], v[200:203], v[124:127], v[36:51]
 ds_read_b64_tr_b16 v[224:225], v14 offset:45056
 ds_read_b64_tr_b16 v[226:227], v14 offset:47104
 s_waitcnt lgkmcnt(10)
 s_waitcnt vmcnt(13)
 s_barrier
 v_mov_b32 v21, s66
 ds_read_b32 v169, v21 offset:35840
 v_mfma_f32_32x32x16_bf16 v[52:67], v[204:207], v[124:127], v[52:67]
 ds_read_b64_tr_b16 v[228:229], v15 offset:45056
 ds_read_b64_tr_b16 v[230:231], v15 offset:47104
 s_add_u32 s39, s69, 6144
 buffer_load_dwordx4 v6, s[12:15], s39 offen offset:2048 lds
 s_waitcnt lgkmcnt(10)
 v_mfma_f32_32x32x16_bf16 v[68:83], v[208:211], v[124:127], v[68:83]
 ds_read_b64_tr_b16 v[200:201], v16 offset:0
 ds_read_b64_tr_b16 v[202:203], v16 offset:2048
 s_waitcnt lgkmcnt(10)
 v_mfma_f32_32x32x16_bf16 v[84:99], v[212:215], v[124:127], v[84:99]
 ds_read_b64_tr_b16 v[204:205], v17 offset:0
 ds_read_b64_tr_b16 v[206:207], v17 offset:2048
 buffer_load_dwordx4 v[156:159], v4, s[8:11], s70 offen offset:2048 sc1
 s_waitcnt vmcnt(14) lgkmcnt(10)
 v_mfma_f32_32x32x16_bf16 v[36:51], v[216:219], v[128:131], v[36:51]
 ds_read_b64_tr_b16 v[208:209], v18 offset:0
 ds_read_b64_tr_b16 v[210:211], v18 offset:2048
 s_waitcnt lgkmcnt(10)
 v_mfma_f32_32x32x16_bf16 v[52:67], v[220:223], v[128:131], v[52:67]
 ds_read_b64_tr_b16 v[212:213], v19 offset:0
 ds_read_b64_tr_b16 v[214:215], v19 offset:2048
 s_waitcnt lgkmcnt(10)
 s_add_u32 s39, s69, 9216
 buffer_load_dwordx4 v6, s[12:15], s39 offen offset:3072 lds
 s_waitcnt lgkmcnt(10)
 v_mfma_f32_32x32x16_bf16 v[68:83], v[224:227], v[128:131], v[68:83]
 ds_read_b64_tr_b16 v[216:217], v16 offset:4096
 ds_read_b64_tr_b16 v[218:219], v16 offset:6144
 s_waitcnt lgkmcnt(10)
 v_mfma_f32_32x32x16_bf16 v[84:99], v[228:231], v[128:131], v[84:99]
 ds_read_b64_tr_b16 v[220:221], v17 offset:4096
 ds_read_b64_tr_b16 v[222:223], v17 offset:6144
 buffer_load_dwordx4 v[160:163], v4, s[8:11], s70 offen offset:3072 sc1
 s_waitcnt vmcnt(14) lgkmcnt(10)
 v_readfirstlane_b32 s49, v169
 s_and_b32 s48, s49, 63
 v_mfma_f32_32x32x16_bf16 v[36:51], v[200:203], v[132:135], v[36:51]
 ds_read_b64_tr_b16 v[224:225], v18 offset:4096
 ds_read_b64_tr_b16 v[226:227], v18 offset:6144
 s_waitcnt lgkmcnt(10)
 v_mfma_f32_32x32x16_bf16 v[52:67], v[204:207], v[132:135], v[52:67]
 ds_read_b64_tr_b16 v[228:229], v19 offset:4096
 ds_read_b64_tr_b16 v[230:231], v19 offset:6144
 s_lshl_b32 s69, s48, 16
 s_add_u32 s69, s69, s37
 s_add_u32 m0, s67, 0
 s_add_u32 s39, s69, 0
 buffer_load_dwordx4 v6, s[12:15], s39 offen offset:0 lds
 s_waitcnt lgkmcnt(10)
 s_cmp_eq_u32 s55, 4
 s_cbranch_scc0 C_NDN12_4
 s_waitcnt vmcnt(17)
 v_cmp_eq_u64 vcc, s[90:91], v[24:25]
 v_cmp_eq_u64 s[60:61], s[90:91], v[26:27]
 s_and_b64 s[60:61], vcc, s[60:61]
 s_lshr_b64 s[58:59], s[60:61], 1
 s_and_b64 s[58:59], s[58:59], s[60:61]
 s_andn2_b64 s[60:61], s[64:65], s[60:61]
 s_cselect_b64 s[58:59], 0, s[58:59]
 s_and_b64 s[60:61], s[58:59], s[56:57]
 s_cselect_b64 s[60:61], s[60:61], s[56:57]
 s_ff1_i32_b64 s40, s[60:61]
 s_bitset0_b64 s[56:57], s40
 s_bitcmp1_b64 s[58:59], s48
 s_cselect_b32 s44, 0x10000000, 0
 s_or_b32 s40, s40, s44
 v_mov_b32 v165, s40
 s_sub_u32 s44, s67, 0x4000
 v_add_u32 v20, s44, v164
 ds_write_b32 v20, v165 offset:3072
 buffer_load_dwordx4 v[24:27], v4, s[96:99], s50 offen sc1
C_NDN12_4:
 v_mfma_f32_32x32x16_bf16 v[68:83], v[208:211], v[132:135], v[68:83]
 ds_read_b64_tr_b16 v[200:201], v16 offset:8192
 ds_read_b64_tr_b16 v[202:203], v16 offset:10240
 s_waitcnt lgkmcnt(10)
 v_mfma_f32_32x32x16_bf16 v[84:99], v[212:215], v[132:135], v[84:99]
 ds_read_b64_tr_b16 v[204:205], v17 offset:8192
 ds_read_b64_tr_b16 v[206:207], v17 offset:10240
 s_bitcmp1_b32 s49, 28
 s_cbranch_scc0 C_SLN12_4
C_SBN12_4:
 s_lshl_b32 s70, s47, 12
 s_add_u32 s70, s70, s36
 buffer_load_dwordx4 v[100:103], v4, s[8:11], s70 offen offset:0 sc1
 s_waitcnt vmcnt(14) lgkmcnt(10)
 v_mfma_f32_32x32x16_bf16 v[36:51], v[216:219], v[136:139], v[36:51]
 ds_read_b64_tr_b16 v[208:209], v18 offset:8192
 ds_read_b64_tr_b16 v[210:211], v18 offset:10240
 s_waitcnt lgkmcnt(10)
 v_mfma_f32_32x32x16_bf16 v[52:67], v[220:223], v[136:139], v[52:67]
 ds_read_b64_tr_b16 v[212:213], v19 offset:8192
 ds_read_b64_tr_b16 v[214:215], v19 offset:10240
 s_add_u32 s39, s69, 3072
 buffer_load_dwordx4 v6, s[12:15], s39 offen offset:1024 lds
 s_waitcnt lgkmcnt(10)
 v_mfma_f32_32x32x16_bf16 v[68:83], v[224:227], v[136:139], v[68:83]
 ds_read_b64_tr_b16 v[216:217], v16 offset:12288
 ds_read_b64_tr_b16 v[218:219], v16 offset:14336
 s_waitcnt lgkmcnt(10)
 v_mfma_f32_32x32x16_bf16 v[84:99], v[228:231], v[136:139], v[84:99]
 ds_read_b64_tr_b16 v[220:221], v17 offset:12288
 ds_read_b64_tr_b16 v[222:223], v17 offset:14336
 buffer_load_dwordx4 v[104:107], v4, s[8:11], s70 offen offset:1024 sc1
 s_waitcnt vmcnt(14) lgkmcnt(10)
 v_mfma_f32_32x32x16_bf16 v[36:51], v[200:203], v[140:143], v[36:51]
 ds_read_b64_tr_b16 v[224:225], v18 offset:12288
 ds_read_b64_tr_b16 v[226:227], v18 offset:14336
 s_waitcnt lgkmcnt(10)
 s_waitcnt vmcnt(13)
 s_barrier
 v_mov_b32 v21, s67
 ds_read_b32 v169, v21 offset:3072
 v_mfma_f32_32x32x16_bf16 v[52:67], v[204:207], v[140:143], v[52:67]
 ds_read_b64_tr_b16 v[228:229], v19 offset:12288
 ds_read_b64_tr_b16 v[230:231], v19 offset:14336
 s_add_u32 s39, s69, 6144
 buffer_load_dwordx4 v6, s[12:15], s39 offen offset:2048 lds
 s_waitcnt lgkmcnt(10)
 v_mfma_f32_32x32x16_bf16 v[68:83], v[208:211], v[140:143], v[68:83]
 ds_read_b64_tr_b16 v[200:201], v8 offset:0
 ds_read_b64_tr_b16 v[202:203], v8 offset:2048
 s_waitcnt lgkmcnt(10)
 v_mfma_f32_32x32x16_bf16 v[84:99], v[212:215], v[140:143], v[84:99]
 ds_read_b64_tr_b16 v[204:205], v9 offset:0
 ds_read_b64_tr_b16 v[206:207], v9 offset:2048
 buffer_load_dwordx4 v[108:111], v4, s[8:11], s70 offen offset:2048 sc1
 s_waitcnt vmcnt(14) lgkmcnt(10)
 v_mfma_f32_32x32x16_bf16 v[36:51], v[216:219], v[144:147], v[36:51]
 ds_read_b64_tr_b16 v[208:209], v10 offset:0
 ds_read_b64_tr_b16 v[210:211], v10 offset:2048
 s_waitcnt lgkmcnt(10)
 v_mfma_f32_32x32x16_bf16 v[52:67], v[220:223], v[144:147], v[52:67]
 ds_read_b64_tr_b16 v[212:213], v11 offset:0
 ds_read_b64_tr_b16 v[214:215], v11 offset:2048
 s_waitcnt lgkmcnt(10)
 s_add_u32 s39, s69, 9216
 buffer_load_dwordx4 v6, s[12:15], s39 offen offset:3072 lds
 s_waitcnt lgkmcnt(10)
 v_mfma_f32_32x32x16_bf16 v[68:83], v[224:227], v[144:147], v[68:83]
 ds_read_b64_tr_b16 v[216:217], v8 offset:4096
 ds_read_b64_tr_b16 v[218:219], v8 offset:6144
 s_waitcnt lgkmcnt(10)
 v_mfma_f32_32x32x16_bf16 v[84:99], v[228:231], v[144:147], v[84:99]
 ds_read_b64_tr_b16 v[220:221], v9 offset:4096
 ds_read_b64_tr_b16 v[222:223], v9 offset:6144
 buffer_load_dwordx4 v[112:115], v4, s[8:11], s70 offen offset:3072 sc1
 s_waitcnt vmcnt(14) lgkmcnt(10)
 v_readfirstlane_b32 s49, v169
 s_and_b32 s45, s49, 63
 v_mfma_f32_32x32x16_bf16 v[36:51], v[200:203], v[148:151], v[36:51]
 ds_read_b64_tr_b16 v[224:225], v10 offset:4096
 ds_read_b64_tr_b16 v[226:227], v10 offset:6144
 s_waitcnt lgkmcnt(10)
 v_mfma_f32_32x32x16_bf16 v[52:67], v[204:207], v[148:151], v[52:67]
 ds_read_b64_tr_b16 v[228:229], v11 offset:4096
 ds_read_b64_tr_b16 v[230:231], v11 offset:6144
 s_lshl_b32 s69, s45, 16
 s_add_u32 s69, s69, s37
 s_add_u32 m0, s67, 32768
 s_add_u32 s39, s69, 0
 buffer_load_dwordx4 v6, s[12:15], s39 offen offset:0 lds
 s_waitcnt lgkmcnt(10)
 s_cmp_eq_u32 s55, 4
 s_cbranch_scc0 C_NDN12_5
 s_waitcnt vmcnt(17)
 v_cmp_eq_u64 vcc, s[90:91], v[28:29]
 v_cmp_eq_u64 s[60:61], s[90:91], v[30:31]
 s_and_b64 s[60:61], vcc, s[60:61]
 s_lshr_b64 s[58:59], s[60:61], 1
 s_and_b64 s[58:59], s[58:59], s[60:61]
 s_andn2_b64 s[60:61], s[64:65], s[60:61]
 s_cselect_b64 s[58:59], 0, s[58:59]
 s_and_b64 s[60:61], s[58:59], s[56:57]
 s_cselect_b64 s[60:61], s[60:61], s[56:57]
 s_ff1_i32_b64 s40, s[60:61]
 s_bitset0_b64 s[56:57], s40
 s_bitcmp1_b64 s[58:59], s45
 s_cselect_b32 s44, 0x10000000, 0
 s_or_b32 s40, s40, s44
 v_mov_b32 v165, s40
 s_sub_u32 s44, s67, 0x4000
 v_add_u32 v20, s44, v164
 ds_write_b32 v20, v165 offset:35840
 buffer_load_dwordx4 v[28:31], v4, s[96:99], s50 offen sc1
C_NDN12_5:
 v_mfma_f32_32x32x16_bf16 v[68:83], v[208:211], v[148:151], v[68:83]
 ds_read_b64_tr_b16 v[200:201], v8 offset:8192
 ds_read_b64_tr_b16 v[202:203], v8 offset:10240
 s_waitcnt lgkmcnt(10)
 v_mfma_f32_32x32x16_bf16 v[84:99], v[212:215], v[148:151], v[84:99]
 ds_read_b64_tr_b16 v[204:205], v9 offset:8192
 ds_read_b64_tr_b16 v[206:207], v9 offset:10240
 s_bitcmp1_b32 s49, 28
 s_cbranch_scc0 C_SLN12_5
C_SBN12_5:
 s_lshl_b32 s70, s48, 12
 s_add_u32 s70, s70, s36
 buffer_load_dwordx4 v[116:119], v4, s[8:11], s70 offen offset:0 sc1
 s_waitcnt vmcnt(14) lgkmcnt(10)
 v_mfma_f32_32x32x16_bf16 v[36:51], v[216:219], v[152:155], v[36:51]
 ds_read_b64_tr_b16 v[208:209], v10 offset:8192
 ds_read_b64_tr_b16 v[210:211], v10 offset:10240
 s_waitcnt lgkmcnt(10)
 v_mfma_f32_32x32x16_bf16 v[52:67], v[220:223], v[152:155], v[52:67]
 ds_read_b64_tr_b16 v[212:213], v11 offset:8192
 ds_read_b64_tr_b16 v[214:215], v11 offset:10240
 s_add_u32 s39, s69, 3072
 buffer_load_dwordx4 v6, s[12:15], s39 offen offset:1024 lds
 s_waitcnt lgkmcnt(10)
 v_mfma_f32_32x32x16_bf16 v[68:83], v[224:227], v[152:155], v[68:83]
 ds_read_b64_tr_b16 v[216:217], v8 offset:12288
 ds_read_b64_tr_b16 v[218:219], v8 offset:14336
 s_waitcnt lgkmcnt(10)
 v_mfma_f32_32x32x16_bf16 v[84:99], v[228:231], v[152:155], v[84:99]
 ds_read_b64_tr_b16 v[220:221], v9 offset:12288
 ds_read_b64_tr_b16 v[222:223], v9 offset:14336
 buffer_load_dwordx4 v[120:123], v4, s[8:11], s70 offen offset:1024 sc1
 s_waitcnt vmcnt(14) lgkmcnt(10)
 v_mfma_f32_32x32x16_bf16 v[36:51], v[200:203], v[156:159], v[36:51]
 ds_read_b64_tr_b16 v[224:225], v10 offset:12288
 ds_read_b64_tr_b16 v[226:227], v10 offset:14336
 s_waitcnt lgkmcnt(10)
 s_waitcnt vmcnt(13)
 s_barrier
 v_mov_b32 v21, s67
 ds_read_b32 v169, v21 offset:35840
 v_mfma_f32_32x32x16_bf16 v[52:67], v[204:207], v[156:159], v[52:67]
 ds_read_b64_tr_b16 v[228:229], v11 offset:12288
 ds_read_b64_tr_b16 v[230:231], v11 offset:14336
 s_add_u32 s39, s69, 6144
 buffer_load_dwordx4 v6, s[12:15], s39 offen offset:2048 lds
 s_waitcnt lgkmcnt(10)
 v_mfma_f32_32x32x16_bf16 v[68:83], v[208:211], v[156:159], v[68:83]
 ds_read_b64_tr_b16 v[200:201], v8 offset:32768
 ds_read_b64_tr_b16 v[202:203], v8 offset:34816
 s_waitcnt lgkmcnt(10)
 v_mfma_f32_32x32x16_bf16 v[84:99], v[212:215], v[156:159], v[84:99]
 ds_read_b64_tr_b16 v[204:205], v9 offset:32768
 ds_read_b64_tr_b16 v[206:207], v9 offset:34816
 buffer_load_dwordx4 v[124:127], v4, s[8:11], s70 offen offset:2048 sc1
 s_waitcnt vmcnt(14) lgkmcnt(10)
 v_mfma_f32_32x32x16_bf16 v[36:51], v[216:219], v[160:163], v[36:51]
 ds_read_b64_tr_b16 v[208:209], v10 offset:32768
 ds_read_b64_tr_b16 v[210:211], v10 offset:34816
 s_waitcnt lgkmcnt(10)
 v_mfma_f32_32x32x16_bf16 v[52:67], v[220:223], v[160:163], v[52:67]
 ds_read_b64_tr_b16 v[212:213], v11 offset:32768
 ds_read_b64_tr_b16 v[214:215], v11 offset:34816
 s_waitcnt lgkmcnt(10)
 s_add_u32 s39, s69, 9216
 buffer_load_dwordx4 v6, s[12:15], s39 offen offset:3072 lds
 s_waitcnt lgkmcnt(10)
 v_mfma_f32_32x32x16_bf16 v[68:83], v[224:227], v[160:163], v[68:83]
 ds_read_b64_tr_b16 v[216:217], v8 offset:36864
 ds_read_b64_tr_b16 v[218:219], v8 offset:38912
 s_waitcnt lgkmcnt(10)
 v_mfma_f32_32x32x16_bf16 v[84:99], v[228:231], v[160:163], v[84:99]
 ds_read_b64_tr_b16 v[220:221], v9 offset:36864
 ds_read_b64_tr_b16 v[222:223], v9 offset:38912
 buffer_load_dwordx4 v[128:131], v4, s[8:11], s70 offen offset:3072 sc1
 s_waitcnt vmcnt(14) lgkmcnt(10)
 v_readfirstlane_b32 s49, v169
 s_and_b32 s46, s49, 63
 v_mfma_f32_32x32x16_bf16 v[36:51], v[200:203], v[100:103], v[36:51]
 ds_read_b64_tr_b16 v[224:225], v10 offset:36864
 ds_read_b64_tr_b16 v[226:227], v10 offset:38912
 s_waitcnt lgkmcnt(10)
 v_mfma_f32_32x32x16_bf16 v[52:67], v[204:207], v[100:103], v[52:67]
 ds_read_b64_tr_b16 v[228:229], v11 offset:36864
 ds_read_b64_tr_b16 v[230:231], v11 offset:38912
 s_lshl_b32 s69, s46, 16
 s_add_u32 s69, s69, s37
 s_add_u32 m0, s68, 0
 s_add_u32 s39, s69, 0
 buffer_load_dwordx4 v6, s[12:15], s39 offen offset:0 lds
 s_waitcnt lgkmcnt(10)
 s_cmp_eq_u32 s55, 4
 s_cbranch_scc0 C_NDN12_6
 s_waitcnt vmcnt(17)
 v_cmp_eq_u64 vcc, s[90:91], v[24:25]
 v_cmp_eq_u64 s[60:61], s[90:91], v[26:27]
 s_and_b64 s[60:61], vcc, s[60:61]
 s_lshr_b64 s[58:59], s[60:61], 1
 s_and_b64 s[58:59], s[58:59], s[60:61]
 s_andn2_b64 s[60:61], s[64:65], s[60:61]
 s_cselect_b64 s[58:59], 0, s[58:59]
 s_and_b64 s[60:61], s[58:59], s[56:57]
 s_cselect_b64 s[60:61], s[60:61], s[56:57]
 s_ff1_i32_b64 s40, s[60:61]
 s_bitset0_b64 s[56:57], s40
 s_bitcmp1_b64 s[58:59], s46
 s_cselect_b32 s44, 0x10000000, 0
 s_or_b32 s40, s40, s44
 v_mov_b32 v165, s40
 s_sub_u32 s44, s68, 0x4000
 v_add_u32 v20, s44, v164
 ds_write_b32 v20, v165 offset:3072
 buffer_load_dwordx4 v[24:27], v4, s[96:99], s50 offen sc1
C_NDN12_6:
 v_mfma_f32_32x32x16_bf16 v[68:83], v[208:211], v[100:103], v[68:83]
 ds_read_b64_tr_b16 v[200:201], v8 offset:40960
 ds_read_b64_tr_b16 v[202:203], v8 offset:43008
 s_waitcnt lgkmcnt(10)
 v_mfma_f32_32x32x16_bf16 v[84:99], v[212:215], v[100:103], v[84:99]
 ds_read_b64_tr_b16 v[204:205], v9 offset:40960
 ds_read_b64_tr_b16 v[206:207], v9 offset:43008
 s_bitcmp1_b32 s49, 28
 s_cbranch_scc0 C_SLN12_6
C_SBN12_6:
 s_lshl_b32 s70, s45, 12
 s_add_u32 s70, s70, s36
 buffer_load_dwordx4 v[132:135], v4, s[8:11], s70 offen offset:0 sc1
 s_waitcnt vmcnt(14) lgkmcnt(10)
 v_mfma_f32_32x32x16_bf16 v[36:51], v[216:219], v[104:107], v[36:51]
 ds_read_b64_tr_b16 v[208:209], v10 offset:40960
 ds_read_b64_tr_b16 v[210:211], v10 offset:43008
 s_waitcnt lgkmcnt(10)
 v_mfma_f32_32x32x16_bf16 v[52:67], v[220:223], v[104:107], v[52:67]
 ds_read_b64_tr_b16 v[212:213], v11 offset:40960
 ds_read_b64_tr_b16 v[214:215], v11 offset:43008
 s_add_u32 s39, s69, 3072
 buffer_load_dwordx4 v6, s[12:15], s39 offen offset:1024 lds
 s_waitcnt lgkmcnt(10)
 v_mfma_f32_32x32x16_bf16 v[68:83], v[224:227], v[104:107], v[68:83]
 ds_read_b64_tr_b16 v[216:217], v8 offset:45056
 ds_read_b64_tr_b16 v[218:219], v8 offset:47104
 s_waitcnt lgkmcnt(10)
 v_mfma_f32_32x32x16_bf16 v[84:99], v[228:231], v[104:107], v[84:99]
 ds_read_b64_tr_b16 v[220:221], v9 offset:45056
 ds_read_b64_tr_b16 v[222:223], v9 offset:47104
 buffer_load_dwordx4 v[136:139], v4, s[8:11], s70 offen offset:1024 sc1
 s_waitcnt vmcnt(14) lgkmcnt(10)
 v_mfma_f32_32x32x16_bf16 v[36:51], v[200:203], v[108:111], v[36:51]
 ds_read_b64_tr_b16 v[224:225], v10 offset:45056
 ds_read_b64_tr_b16 v[226:227], v10 offset:47104
 s_waitcnt lgkmcnt(10)
 s_waitcnt vmcnt(13)
 s_barrier
 v_mov_b32 v21, s68
 ds_read_b32 v169, v21 offset:3072
 v_mfma_f32_32x32x16_bf16 v[52:67], v[204:207], v[108:111], v[52:67]
 ds_read_b64_tr_b16 v[228:229], v11 offset:45056
 ds_read_b64_tr_b16 v[230:231], v11 offset:47104
 s_add_u32 s39, s69, 6144
 buffer_load_dwordx4 v6, s[12:15], s39 offen offset:2048 lds
 s_waitcnt lgkmcnt(10)
 v_mfma_f32_32x32x16_bf16 v[68:83], v[208:211], v[108:111], v[68:83]
 ds_read_b64_tr_b16 v[200:201], v12 offset:0
 ds_read_b64_tr_b16 v[202:203], v12 offset:2048
 s_waitcnt lgkmcnt(10)
 v_mfma_f32_32x32x16_bf16 v[84:99], v[212:215], v[108:111], v[84:99]
 ds_read_b64_tr_b16 v[204:205], v13 offset:0
 ds_read_b64_tr_b16 v[206:207], v13 offset:2048
 buffer_load_dwordx4 v[140:143], v4, s[8:11], s70 offen offset:2048 sc1
 s_waitcnt vmcnt(14) lgkmcnt(10)
 v_mfma_f32_32x32x16_bf16 v[36:51], v[216:219], v[112:115], v[36:51]
 ds_read_b64_tr_b16 v[208:209], v14 offset:0
 ds_read_b64_tr_b16 v[210:211], v14 offset:2048
 s_waitcnt lgkmcnt(10)
 v_mfma_f32_32x32x16_bf16 v[52:67], v[220:223], v[112:115], v[52:67]
 ds_read_b64_tr_b16 v[212:213], v15 offset:0
 ds_read_b64_tr_b16 v[214:215], v15 offset:2048
 s_waitcnt lgkmcnt(10)
 s_add_u32 s39, s69, 9216
 buffer_load_dwordx4 v6, s[12:15], s39 offen offset:3072 lds
 s_waitcnt lgkmcnt(10)
 v_mfma_f32_32x32x16_bf16 v[68:83], v[224:227], v[112:115], v[68:83]
 ds_read_b64_tr_b16 v[216:217], v12 offset:4096
 ds_read_b64_tr_b16 v[218:219], v12 offset:6144
 s_waitcnt lgkmcnt(10)
 v_mfma_f32_32x32x16_bf16 v[84:99], v[228:231], v[112:115], v[84:99]
 ds_read_b64_tr_b16 v[220:221], v13 offset:4096
 ds_read_b64_tr_b16 v[222:223], v13 offset:6144
 buffer_load_dwordx4 v[144:147], v4, s[8:11], s70 offen offset:3072 sc1
 s_waitcnt vmcnt(14) lgkmcnt(10)
 v_readfirstlane_b32 s49, v169
 s_and_b32 s47, s49, 63
 v_mfma_f32_32x32x16_bf16 v[36:51], v[200:203], v[116:119], v[36:51]
 ds_read_b64_tr_b16 v[224:225], v14 offset:4096
 ds_read_b64_tr_b16 v[226:227], v14 offset:6144
 s_waitcnt lgkmcnt(10)
 v_mfma_f32_32x32x16_bf16 v[52:67], v[204:207], v[116:119], v[52:67]
 ds_read_b64_tr_b16 v[228:229], v15 offset:4096
 ds_read_b64_tr_b16 v[230:231], v15 offset:6144
 s_lshl_b32 s69, s47, 16
 s_add_u32 s69, s69, s37
 s_add_u32 m0, s66, 0
 s_add_u32 s39, s69, 0
 buffer_load_dwordx4 v6, s[12:15], s39 offen offset:0 lds
 s_waitcnt lgkmcnt(10)
 s_cmp_eq_u32 s55, 4
 s_cbranch_scc0 C_NDN12_7
 s_waitcnt vmcnt(17)
 v_cmp_eq_u64 vcc, s[90:91], v[28:29]
 v_cmp_eq_u64 s[60:61], s[90:91], v[30:31]
 s_and_b64 s[60:61], vcc, s[60:61]
 s_lshr_b64 s[58:59], s[60:61], 1
 s_and_b64 s[58:59], s[58:59], s[60:61]
 s_andn2_b64 s[60:61], s[64:65], s[60:61]
 s_cselect_b64 s[58:59], 0, s[58:59]
 s_and_b64 s[60:61], s[58:59], s[56:57]
 s_cselect_b64 s[60:61], s[60:61], s[56:57]
 s_ff1_i32_b64 s40, s[60:61]
 s_bitset0_b64 s[56:57], s40
 s_bitcmp1_b64 s[58:59], s47
 s_cselect_b32 s44, 0x10000000, 0
 s_or_b32 s40, s40, s44
 v_mov_b32 v165, s40
 s_sub_u32 s44, s66, 0x4000
 v_add_u32 v20, s44, v164
 ds_write_b32 v20, v165 offset:3072
C_NDN12_7:
 v_mfma_f32_32x32x16_bf16 v[68:83], v[208:211], v[116:119], v[68:83]
 ds_read_b64_tr_b16 v[200:201], v12 offset:8192
 ds_read_b64_tr_b16 v[202:203], v12 offset:10240
 s_waitcnt lgkmcnt(10)
 v_mfma_f32_32x32x16_bf16 v[84:99], v[212:215], v[116:119], v[84:99]
 ds_read_b64_tr_b16 v[204:205], v13 offset:8192
 ds_read_b64_tr_b16 v[206:207], v13 offset:10240
 s_bitcmp1_b32 s49, 28
 s_cbranch_scc0 C_SLN12_7
C_SBN12_7:
 s_lshl_b32 s70, s46, 12
 s_add_u32 s70, s70, s36
 buffer_load_dwordx4 v[148:151], v4, s[8:11], s70 offen offset:0 sc1
 s_waitcnt vmcnt(14) lgkmcnt(10)
 v_mfma_f32_32x32x16_bf16 v[36:51], v[216:219], v[120:123], v[36:51]
 ds_read_b64_tr_b16 v[208:209], v14 offset:8192
 ds_read_b64_tr_b16 v[210:211], v14 offset:10240
 s_waitcnt lgkmcnt(10)
 v_mfma_f32_32x32x16_bf16 v[52:67], v[220:223], v[120:123], v[52:67]
 ds_read_b64_tr_b16 v[212:213], v15 offset:8192
 ds_read_b64_tr_b16 v[214:215], v15 offset:10240
 s_add_u32 s39, s69, 3072
 buffer_load_dwordx4 v6, s[12:15], s39 offen offset:1024 lds
 s_waitcnt lgkmcnt(10)
 v_mfma_f32_32x32x16_bf16 v[68:83], v[224:227], v[120:123], v[68:83]
 ds_read_b64_tr_b16 v[216:217], v12 offset:12288
 ds_read_b64_tr_b16 v[218:219], v12 offset:14336
 s_waitcnt lgkmcnt(10)
 v_mfma_f32_32x32x16_bf16 v[84:99], v[228:231], v[120:123], v[84:99]
 ds_read_b64_tr_b16 v[220:221], v13 offset:12288
 ds_read_b64_tr_b16 v[222:223], v13 offset:14336
 buffer_load_dwordx4 v[152:155], v4, s[8:11], s70 offen offset:1024 sc1
 s_waitcnt vmcnt(14) lgkmcnt(10)
 v_mfma_f32_32x32x16_bf16 v[36:51], v[200:203], v[124:127], v[36:51]
 ds_read_b64_tr_b16 v[224:225], v14 offset:12288
 ds_read_b64_tr_b16 v[226:227], v14 offset:14336
 s_waitcnt lgkmcnt(10)
 s_waitcnt vmcnt(13)
 s_barrier
 v_mov_b32 v21, s66
 ds_read_b32 v169, v21 offset:3072
 v_mfma_f32_32x32x16_bf16 v[52:67], v[204:207], v[124:127], v[52:67]
 ds_read_b64_tr_b16 v[228:229], v15 offset:12288
 ds_read_b64_tr_b16 v[230:231], v15 offset:14336
 s_add_u32 s39, s69, 6144
 buffer_load_dwordx4 v6, s[12:15], s39 offen offset:2048 lds
 s_waitcnt lgkmcnt(10)
 v_mfma_f32_32x32x16_bf16 v[68:83], v[208:211], v[124:127], v[68:83]
 ds_read_b64_tr_b16 v[200:201], v12 offset:32768
 ds_read_b64_tr_b16 v[202:203], v12 offset:34816
 s_waitcnt lgkmcnt(10)
 v_mfma_f32_32x32x16_bf16 v[84:99], v[212:215], v[124:127], v[84:99]
 ds_read_b64_tr_b16 v[204:205], v13 offset:32768
 ds_read_b64_tr_b16 v[206:207], v13 offset:34816
 buffer_load_dwordx4 v[156:159], v4, s[8:11], s70 offen offset:2048 sc1
 s_waitcnt vmcnt(14) lgkmcnt(10)
 v_mfma_f32_32x32x16_bf16 v[36:51], v[216:219], v[128:131], v[36:51]
 ds_read_b64_tr_b16 v[208:209], v14 offset:32768
 ds_read_b64_tr_b16 v[210:211], v14 offset:34816
 s_waitcnt lgkmcnt(10)
 v_mfma_f32_32x32x16_bf16 v[52:67], v[220:223], v[128:131], v[52:67]
 ds_read_b64_tr_b16 v[212:213], v15 offset:32768
 ds_read_b64_tr_b16 v[214:215], v15 offset:34816
 s_waitcnt lgkmcnt(10)
 s_add_u32 s39, s69, 9216
 buffer_load_dwordx4 v6, s[12:15], s39 offen offset:3072 lds
 s_waitcnt lgkmcnt(10)
 v_mfma_f32_32x32x16_bf16 v[68:83], v[224:227], v[128:131], v[68:83]
 ds_read_b64_tr_b16 v[216:217], v12 offset:36864
 ds_read_b64_tr_b16 v[218:219], v12 offset:38912
 s_waitcnt lgkmcnt(10)
 v_mfma_f32_32x32x16_bf16 v[84:99], v[228:231], v[128:131], v[84:99]
 ds_read_b64_tr_b16 v[220:221], v13 offset:36864
 ds_read_b64_tr_b16 v[222:223], v13 offset:38912
 buffer_load_dwordx4 v[160:163], v4, s[8:11], s70 offen offset:3072 sc1
 s_waitcnt vmcnt(14) lgkmcnt(10)
 v_readfirstlane_b32 s49, v169
 s_and_b32 s48, s49, 63
 v_mfma_f32_32x32x16_bf16 v[36:51], v[200:203], v[132:135], v[36:51]
 ds_read_b64_tr_b16 v[224:225], v14 offset:36864
 ds_read_b64_tr_b16 v[226:227], v14 offset:38912
 s_waitcnt lgkmcnt(10)
 v_mfma_f32_32x32x16_bf16 v[52:67], v[204:207], v[132:135], v[52:67]
 ds_read_b64_tr_b16 v[228:229], v15 offset:36864
 ds_read_b64_tr_b16 v[230:231], v15 offset:38912
 s_lshl_b32 s69, s48, 16
 s_add_u32 s69, s69, s37
 s_add_u32 m0, s66, 32768
 s_add_u32 s39, s69, 0
 buffer_load_dwordx4 v6, s[12:15], s39 offen offset:0 lds
 s_waitcnt lgkmcnt(10)
 s_cmp_eq_u32 s55, 4
 s_cbranch_scc0 C_NDN12_8
 s_waitcnt vmcnt(16)
 v_cmp_eq_u64 vcc, s[90:91], v[24:25]
 v_cmp_eq_u64 s[60:61], s[90:91], v[26:27]
 s_and_b64 s[60:61], vcc, s[60:61]
 s_lshr_b64 s[58:59], s[60:61], 1
 s_and_b64 s[58:59], s[58:59], s[60:61]
 s_andn2_b64 s[60:61], s[64:65], s[60:61]
 s_cselect_b64 s[58:59], 0, s[58:59]
 s_mov_b32 s40, 0
 s_bitcmp1_b64 s[58:59], s48
 s_cselect_b32 s44, 0x10000000, 0
 s_or_b32 s40, s40, s44
 v_mov_b32 v165, s40
 s_sub_u32 s44, s66, 0x4000
 v_add_u32 v20, s44, v164
 ds_write_b32 v20, v165 offset:35840
C_NDN12_8:
 v_mfma_f32_32x32x16_bf16 v[68:83], v[208:211], v[132:135], v[68:83]
 ds_read_b64_tr_b16 v[200:201], v12 offset:40960
 ds_read_b64_tr_b16 v[202:203], v12 offset:43008
 s_waitcnt lgkmcnt(10)
 v_mfma_f32_32x32x16_bf16 v[84:99], v[212:215], v[132:135], v[84:99]
 ds_read_b64_tr_b16 v[204:205], v13 offset:40960
 ds_read_b64_tr_b16 v[206:207], v13 offset:43008
 s_bitcmp1_b32 s49, 28
 s_cbranch_scc0 C_SLN12_8
C_SBN12_8:
 s_lshl_b32 s70, s47, 12
 s_add_u32 s70, s70, s36
 buffer_load_dwordx4 v[100:103], v4, s[8:11], s70 offen offset:0 sc1
 s_waitcnt vmcnt(14) lgkmcnt(10)
 v_mfma_f32_32x32x16_bf16 v[36:51], v[216:219], v[136:139], v[36:51]
 ds_read_b64_tr_b16 v[208:209], v14 offset:40960
 ds_read_b64_tr_b16 v[210:211], v14 offset:43008
 s_waitcnt lgkmcnt(10)
 v_mfma_f32_32x32x16_bf16 v[52:67], v[220:223], v[136:139], v[52:67]
 ds_read_b64_tr_b16 v[212:213], v15 offset:40960
 ds_read_b64_tr_b16 v[214:215], v15 offset:43008
 s_add_u32 s39, s69, 3072
 buffer_load_dwordx4 v6, s[12:15], s39 offen offset:1024 lds
 s_waitcnt lgkmcnt(10)
 v_mfma_f32_32x32x16_bf16 v[68:83], v[224:227], v[136:139], v[68:83]
 ds_read_b64_tr_b16 v[216:217], v12 offset:45056
 ds_read_b64_tr_b16 v[218:219], v12 offset:47104
 s_waitcnt lgkmcnt(10)
 v_mfma_f32_32x32x16_bf16 v[84:99], v[228:231], v[136:139], v[84:99]
 ds_read_b64_tr_b16 v[220:221], v13 offset:45056
 ds_read_b64_tr_b16 v[222:223], v13 offset:47104
 buffer_load_dwordx4 v[104:107], v4, s[8:11], s70 offen offset:1024 sc1
 s_waitcnt vmcnt(14) lgkmcnt(10)
 v_mfma_f32_32x32x16_bf16 v[36:51], v[200:203], v[140:143], v[36:51]
 ds_read_b64_tr_b16 v[224:225], v14 offset:45056
 ds_read_b64_tr_b16 v[226:227], v14 offset:47104
 s_waitcnt lgkmcnt(10)
 s_waitcnt vmcnt(13)
 s_barrier
 v_mov_b32 v21, s66
 ds_read_b32 v169, v21 offset:35840
 v_mfma_f32_32x32x16_bf16 v[52:67], v[204:207], v[140:143], v[52:67]
 ds_read_b64_tr_b16 v[228:229], v15 offset:45056
 ds_read_b64_tr_b16 v[230:231], v15 offset:47104
 s_add_u32 s39, s69, 6144
 buffer_load_dwordx4 v6, s[12:15], s39 offen offset:2048 lds
 s_waitcnt lgkmcnt(10)
 v_mfma_f32_32x32x16_bf16 v[68:83], v[208:211], v[140:143], v[68:83]
 ds_read_b64_tr_b16 v[200:201], v16 offset:0
 ds_read_b64_tr_b16 v[202:203], v16 offset:2048
 s_waitcnt lgkmcnt(10)
 v_mfma_f32_32x32x16_bf16 v[84:99], v[212:215], v[140:143], v[84:99]
 ds_read_b64_tr_b16 v[204:205], v17 offset:0
 ds_read_b64_tr_b16 v[206:207], v17 offset:2048
 buffer_load_dwordx4 v[108:111], v4, s[8:11], s70 offen offset:2048 sc1
 s_waitcnt vmcnt(14) lgkmcnt(10)
 v_mfma_f32_32x32x16_bf16 v[36:51], v[216:219], v[144:147], v[36:51]
 ds_read_b64_tr_b16 v[208:209], v18 offset:0
 ds_read_b64_tr_b16 v[210:211], v18 offset:2048
 s_waitcnt lgkmcnt(10)
 v_mfma_f32_32x32x16_bf16 v[52:67], v[220:223], v[144:147], v[52:67]
 ds_read_b64_tr_b16 v[212:213], v19 offset:0
 ds_read_b64_tr_b16 v[214:215], v19 offset:2048
 s_waitcnt lgkmcnt(10)
 s_add_u32 s39, s69, 9216
 buffer_load_dwordx4 v6, s[12:15], s39 offen offset:3072 lds
 s_waitcnt lgkmcnt(10)
 v_mfma_f32_32x32x16_bf16 v[68:83], v[224:227], v[144:147], v[68:83]
 ds_read_b64_tr_b16 v[216:217], v16 offset:4096
 ds_read_b64_tr_b16 v[218:219], v16 offset:6144
 s_waitcnt lgkmcnt(10)
 v_mfma_f32_32x32x16_bf16 v[84:99], v[228:231], v[144:147], v[84:99]
 ds_read_b64_tr_b16 v[220:221], v17 offset:4096
 ds_read_b64_tr_b16 v[222:223], v17 offset:6144
 buffer_load_dwordx4 v[112:115], v4, s[8:11], s70 offen offset:3072 sc1
 s_waitcnt vmcnt(14) lgkmcnt(10)
 v_readfirstlane_b32 s49, v169
 v_mfma_f32_32x32x16_bf16 v[36:51], v[200:203], v[148:151], v[36:51]
 ds_read_b64_tr_b16 v[224:225], v18 offset:4096
 ds_read_b64_tr_b16 v[226:227], v18 offset:6144
 s_waitcnt lgkmcnt(10)
 v_mfma_f32_32x32x16_bf16 v[52:67], v[204:207], v[148:151], v[52:67]
 ds_read_b64_tr_b16 v[228:229], v19 offset:4096
 ds_read_b64_tr_b16 v[230:231], v19 offset:6144
 s_waitcnt lgkmcnt(10)
 v_mfma_f32_32x32x16_bf16 v[68:83], v[208:211], v[148:151], v[68:83]
 ds_read_b64_tr_b16 v[200:201], v16 offset:8192
 ds_read_b64_tr_b16 v[202:203], v16 offset:10240
 s_waitcnt lgkmcnt(10)
 v_mfma_f32_32x32x16_bf16 v[84:99], v[212:215], v[148:151], v[84:99]
 ds_read_b64_tr_b16 v[204:205], v17 offset:8192
 ds_read_b64_tr_b16 v[206:207], v17 offset:10240
 s_bitcmp1_b32 s49, 28
 s_cbranch_scc0 C_SLN12_9
C_SBN12_9:
 s_lshl_b32 s70, s48, 12
 s_add_u32 s70, s70, s36
 buffer_load_dwordx4 v[116:119], v4, s[8:11], s70 offen offset:0 sc1
 s_waitcnt vmcnt(13) lgkmcnt(10)
 v_mfma_f32_32x32x16_bf16 v[36:51], v[216:219], v[152:155], v[36:51]
 ds_read_b64_tr_b16 v[208:209], v18 offset:8192
 ds_read_b64_tr_b16 v[210:211], v18 offset:10240
 s_waitcnt lgkmcnt(10)
 v_mfma_f32_32x32x16_bf16 v[52:67], v[220:223], v[152:155], v[52:67]
 ds_read_b64_tr_b16 v[212:213], v19 offset:8192
 ds_read_b64_tr_b16 v[214:215], v19 offset:10240
 s_waitcnt lgkmcnt(10)
 v_mfma_f32_32x32x16_bf16 v[68:83], v[224:227], v[152:155], v[68:83]
 ds_read_b64_tr_b16 v[216:217], v16 offset:12288
 ds_read_b64_tr_b16 v[218:219], v16 offset:14336
 s_waitcnt lgkmcnt(10)
 v_mfma_f32_32x32x16_bf16 v[84:99], v[228:231], v[152:155], v[84:99]
 ds_read_b64_tr_b16 v[220:221], v17 offset:12288
 ds_read_b64_tr_b16 v[222:223], v17 offset:14336
 buffer_load_dwordx4 v[120:123], v4, s[8:11], s70 offen offset:1024 sc1
 s_waitcnt vmcnt(12) lgkmcnt(10)
 v_mfma_f32_32x32x16_bf16 v[36:51], v[200:203], v[156:159], v[36:51]
 ds_read_b64_tr_b16 v[224:225], v18 offset:12288
 ds_read_b64_tr_b16 v[226:227], v18 offset:14336
 s_waitcnt lgkmcnt(10)
 s_waitcnt vmcnt(11)
 s_barrier
 v_mfma_f32_32x32x16_bf16 v[52:67], v[204:207], v[156:159], v[52:67]
 ds_read_b64_tr_b16 v[228:229], v19 offset:12288
 ds_read_b64_tr_b16 v[230:231], v19 offset:14336
 s_waitcnt lgkmcnt(10)
 v_mfma_f32_32x32x16_bf16 v[68:83], v[208:211], v[156:159], v[68:83]
 ds_read_b64_tr_b16 v[200:201], v8 offset:0
 ds_read_b64_tr_b16 v[202:203], v8 offset:2048
 s_waitcnt lgkmcnt(10)
 v_mfma_f32_32x32x16_bf16 v[84:99], v[212:215], v[156:159], v[84:99]
 ds_read_b64_tr_b16 v[204:205], v9 offset:0
 ds_read_b64_tr_b16 v[206:207], v9 offset:2048
 buffer_load_dwordx4 v[124:127], v4, s[8:11], s70 offen offset:2048 sc1
 s_waitcnt vmcnt(11) lgkmcnt(10)
 v_mfma_f32_32x32x16_bf16 v[36:51], v[216:219], v[160:163], v[36:51]
 ds_read_b64_tr_b16 v[208:209], v10 offset:0
 ds_read_b64_tr_b16 v[210:211], v10 offset:2048
 s_waitcnt lgkmcnt(10)
 v_mfma_f32_32x32x16_bf16 v[52:67], v[220:223], v[160:163], v[52:67]
 ds_read_b64_tr_b16 v[212:213], v11 offset:0
 ds_read_b64_tr_b16 v[214:215], v11 offset:2048
 s_waitcnt lgkmcnt(10)
 v_mfma_f32_32x32x16_bf16 v[68:83], v[224:227], v[160:163], v[68:83]
 ds_read_b64_tr_b16 v[216:217], v8 offset:4096
 ds_read_b64_tr_b16 v[218:219], v8 offset:6144
 s_waitcnt lgkmcnt(10)
 v_mfma_f32_32x32x16_bf16 v[84:99], v[228:231], v[160:163], v[84:99]
 ds_read_b64_tr_b16 v[220:221], v9 offset:4096
 ds_read_b64_tr_b16 v[222:223], v9 offset:6144
 buffer_load_dwordx4 v[128:131], v4, s[8:11], s70 offen offset:3072 sc1
 s_waitcnt vmcnt(10) lgkmcnt(10)
 v_mfma_f32_32x32x16_bf16 v[36:51], v[200:203], v[100:103], v[36:51]
 ds_read_b64_tr_b16 v[224:225], v10 offset:4096
 ds_read_b64_tr_b16 v[226:227], v10 offset:6144
 s_waitcnt lgkmcnt(10)
 v_mfma_f32_32x32x16_bf16 v[52:67], v[204:207], v[100:103], v[52:67]
 ds_read_b64_tr_b16 v[228:229], v11 offset:4096
 ds_read_b64_tr_b16 v[230:231], v11 offset:6144
 s_waitcnt lgkmcnt(10)
 v_mfma_f32_32x32x16_bf16 v[68:83], v[208:211], v[100:103], v[68:83]
 ds_read_b64_tr_b16 v[200:201], v8 offset:8192
 ds_read_b64_tr_b16 v[202:203], v8 offset:10240
 s_waitcnt lgkmcnt(10)
 v_mfma_f32_32x32x16_bf16 v[84:99], v[212:215], v[100:103], v[84:99]
 ds_read_b64_tr_b16 v[204:205], v9 offset:8192
 ds_read_b64_tr_b16 v[206:207], v9 offset:10240
 s_waitcnt vmcnt(8) lgkmcnt(10)
 v_mfma_f32_32x32x16_bf16 v[36:51], v[216:219], v[104:107], v[36:51]
 ds_read_b64_tr_b16 v[208:209], v10 offset:8192
 ds_read_b64_tr_b16 v[210:211], v10 offset:10240
 s_waitcnt lgkmcnt(10)
 v_mfma_f32_32x32x16_bf16 v[52:67], v[220:223], v[104:107], v[52:67]
 ds_read_b64_tr_b16 v[212:213], v11 offset:8192
 ds_read_b64_tr_b16 v[214:215], v11 offset:10240
 s_add_u32 s16, s4, 0x8000000
 s_addc_u32 s17, s5, 0
 s_and_b32 s17, s17, 0xffff
 s_mov_b32 s18, 0x1000000
 s_mov_b32 s19, 0x00020000
 s_mov_b32 s20, s78
 s_and_b32 s21, s79, 0xffff
 s_mov_b32 s22, 0x200000
 s_mov_b32 s23, 0x00020000
 s_mov_b32 s24, s80
 s_and_b32 s25, s81, 0xffff
 s_mov_b32 s26, 0x200000
 s_mov_b32 s27, 0x00020000
 s_lshl_b32 s39, s32, 2
 s_add_u32 s40, s39, s33
 s_lshl_b32 s40, s40, 3
 s_add_u32 s40, s40, s55
 s_lshl_b32 s40, s40, 13
 s_mul_i32 s71, s31, 0x400000
 s_add_u32 s71, s71, s40
 s_add_u32 s72, s71, 4096
 s_lshl_b32 s28, s31, 7
 s_add_u32 s28, s28, s40
 s_add_u32 s29, s28, 0x400000
 s_add_u32 s30, s28, 0x800000
 s_add_u32 s41, s28, 0xc00000
 s_add_u32 s39, s39, s35
 s_lshl_b32 s39, s39, 2
 s_add_u32 s39, s39, s31
 s_lshl_b32 s73, s39, 13
 s_lshl_b32 s40, s33, 1
 s_add_u32 s40, s40, s34
 s_lshl_b32 s40, s40, 7
 s_add_u32 s73, s73, s40
 s_lshl_b32 s39, s31, 3
 s_lshl_b32 s42, 0xff, s39
 s_mov_b32 s43, s42
 v_lshrrev_b32 v20, 3, v0
 v_and_b32 v21, 7, v0
 v_lshlrev_b32 v168, 10, v20
 v_lshl_add_u32 v168, v21, 4, v168
 v_lshlrev_b32 v172, 9, v21
 v_lshl_add_u32 v172, v20, 4, v172
 v_lshrrev_b32 v22, 1, v21
 v_mul_u32_u24 v22, 1024, v22
 v_add_u32 v173, v22, v172
 v_lshl_add_u32 v22, v21, 9, v172
 s_cmp_eq_u32 s31, 0
 s_cselect_b64 vcc, -1, 0
 v_cndmask_b32 v172, v22, v172, vcc
 buffer_load_dwordx4 v[176:179], v168, s[20:23], s73 offen
 s_waitcnt lgkmcnt(10)
 v_mfma_f32_32x32x16_bf16 v[68:83], v[224:227], v[104:107], v[68:83]
 ds_read_b64_tr_b16 v[216:217], v8 offset:12288
 ds_read_b64_tr_b16 v[218:219], v8 offset:14336
 s_waitcnt lgkmcnt(10)
 v_mfma_f32_32x32x16_bf16 v[84:99], v[228:231], v[104:107], v[84:99]
 ds_read_b64_tr_b16 v[220:221], v9 offset:12288
 ds_read_b64_tr_b16 v[222:223], v9 offset:14336
 s_waitcnt vmcnt(7) lgkmcnt(10)
 v_mfma_f32_32x32x16_bf16 v[36:51], v[200:203], v[108:111], v[36:51]
 ds_read_b64_tr_b16 v[224:225], v10 offset:12288
 ds_read_b64_tr_b16 v[226:227], v10 offset:14336
 s_waitcnt lgkmcnt(10)
 s_waitcnt vmcnt(6)
 s_barrier
 v_mfma_f32_32x32x16_bf16 v[52:67], v[204:207], v[108:111], v[52:67]
 ds_read_b64_tr_b16 v[228:229], v11 offset:12288
 ds_read_b64_tr_b16 v[230:231], v11 offset:14336
 s_waitcnt lgkmcnt(10)
 v_mfma_f32_32x32x16_bf16 v[68:83], v[208:211], v[108:111], v[68:83]
 ds_read_b64_tr_b16 v[200:201], v8 offset:32768
 ds_read_b64_tr_b16 v[202:203], v8 offset:34816
 s_waitcnt lgkmcnt(10)
 v_mfma_f32_32x32x16_bf16 v[84:99], v[212:215], v[108:111], v[84:99]
 ds_read_b64_tr_b16 v[204:205], v9 offset:32768
 ds_read_b64_tr_b16 v[206:207], v9 offset:34816
 s_waitcnt vmcnt(5) lgkmcnt(10)
 v_mfma_f32_32x32x16_bf16 v[36:51], v[216:219], v[112:115], v[36:51]
 ds_read_b64_tr_b16 v[208:209], v10 offset:32768
 ds_read_b64_tr_b16 v[210:211], v10 offset:34816
 s_waitcnt lgkmcnt(10)
 v_mfma_f32_32x32x16_bf16 v[52:67], v[220:223], v[112:115], v[52:67]
 ds_read_b64_tr_b16 v[212:213], v11 offset:32768
 ds_read_b64_tr_b16 v[214:215], v11 offset:34816
 s_waitcnt lgkmcnt(10)
 v_mfma_f32_32x32x16_bf16 v[68:83], v[224:227], v[112:115], v[68:83]
 ds_read_b64_tr_b16 v[216:217], v8 offset:36864
 ds_read_b64_tr_b16 v[218:219], v8 offset:38912
 s_waitcnt lgkmcnt(10)
 v_mfma_f32_32x32x16_bf16 v[84:99], v[228:231], v[112:115], v[84:99]
 ds_read_b64_tr_b16 v[220:221], v9 offset:36864
 ds_read_b64_tr_b16 v[222:223], v9 offset:38912
 s_waitcnt vmcnt(4) lgkmcnt(10)
 v_mfma_f32_32x32x16_bf16 v[36:51], v[200:203], v[116:119], v[36:51]
 ds_read_b64_tr_b16 v[224:225], v10 offset:36864
 ds_read_b64_tr_b16 v[226:227], v10 offset:38912
 s_waitcnt lgkmcnt(10)
 v_mfma_f32_32x32x16_bf16 v[52:67], v[204:207], v[116:119], v[52:67]
 ds_read_b64_tr_b16 v[228:229], v11 offset:36864
 ds_read_b64_tr_b16 v[230:231], v11 offset:38912
 s_waitcnt lgkmcnt(10)
 v_mfma_f32_32x32x16_bf16 v[68:83], v[208:211], v[116:119], v[68:83]
 ds_read_b64_tr_b16 v[200:201], v8 offset:40960
 ds_read_b64_tr_b16 v[202:203], v8 offset:43008
 s_waitcnt lgkmcnt(10)
 v_mfma_f32_32x32x16_bf16 v[84:99], v[212:215], v[116:119], v[84:99]
 ds_read_b64_tr_b16 v[204:205], v9 offset:40960
 ds_read_b64_tr_b16 v[206:207], v9 offset:43008
 s_waitcnt vmcnt(3) lgkmcnt(10)
 v_mfma_f32_32x32x16_bf16 v[36:51], v[216:219], v[120:123], v[36:51]
 ds_read_b64_tr_b16 v[208:209], v10 offset:40960
 ds_read_b64_tr_b16 v[210:211], v10 offset:43008
 s_waitcnt lgkmcnt(10)
 v_mfma_f32_32x32x16_bf16 v[52:67], v[220:223], v[120:123], v[52:67]
 ds_read_b64_tr_b16 v[212:213], v11 offset:40960
 ds_read_b64_tr_b16 v[214:215], v11 offset:43008
 s_waitcnt lgkmcnt(10)
 v_mfma_f32_32x32x16_bf16 v[68:83], v[224:227], v[120:123], v[68:83]
 ds_read_b64_tr_b16 v[216:217], v8 offset:45056
 ds_read_b64_tr_b16 v[218:219], v8 offset:47104
 s_waitcnt lgkmcnt(10)
 v_mfma_f32_32x32x16_bf16 v[84:99], v[228:231], v[120:123], v[84:99]
 ds_read_b64_tr_b16 v[220:221], v9 offset:45056
 ds_read_b64_tr_b16 v[222:223], v9 offset:47104
 s_waitcnt vmcnt(2) lgkmcnt(10)
 v_mfma_f32_32x32x16_bf16 v[36:51], v[200:203], v[124:127], v[36:51]
 ds_read_b64_tr_b16 v[224:225], v10 offset:45056
 ds_read_b64_tr_b16 v[226:227], v10 offset:47104
 s_waitcnt lgkmcnt(10)
 v_mfma_f32_32x32x16_bf16 v[52:67], v[204:207], v[124:127], v[52:67]
 ds_read_b64_tr_b16 v[228:229], v11 offset:45056
 ds_read_b64_tr_b16 v[230:231], v11 offset:47104
 s_waitcnt lgkmcnt(10)
 v_mfma_f32_32x32x16_bf16 v[68:83], v[208:211], v[124:127], v[68:83]
 s_waitcnt lgkmcnt(8)
 v_mfma_f32_32x32x16_bf16 v[84:99], v[212:215], v[124:127], v[84:99]
 s_waitcnt vmcnt(1) lgkmcnt(6)
 v_mfma_f32_32x32x16_bf16 v[36:51], v[216:219], v[128:131], v[36:51]
 s_waitcnt lgkmcnt(4)
 v_mfma_f32_32x32x16_bf16 v[52:67], v[220:223], v[128:131], v[52:67]
 s_waitcnt lgkmcnt(2)
 v_mfma_f32_32x32x16_bf16 v[68:83], v[224:227], v[128:131], v[68:83]
 s_waitcnt lgkmcnt(0)
 v_mfma_f32_32x32x16_bf16 v[84:99], v[228:231], v[128:131], v[84:99]
 s_add_u32 s39, s68, 0
 s_add_u32 s40, s67, 32768
 s_add_u32 s44, s67, 0
 s_branch C_EPI
C_SLA0:
 s_cmp_lg_u32 s101, 0
 s_cbranch_scc1 C_SBA0
 s_lshl_b64 s[62:63], 3, s45
 s_or_b64 s[62:63], s[62:63], s[64:65]
 s_mov_b32 s51, 4096
C_SMA0:
 buffer_load_dwordx4 v[32:35], v4, s[96:99], s50 offen sc1
 s_waitcnt vmcnt(0)
 v_cmp_eq_u64 vcc, s[90:91], v[32:33]
 v_cmp_eq_u64 s[60:61], s[90:91], v[34:35]
 s_and_b64 s[60:61], vcc, s[60:61]
 s_andn2_b64 s[60:61], s[62:63], s[60:61]
 s_cbranch_scc0 C_SBA0
 s_sleep 2
 s_sub_u32 s51, s51, 1
 s_cmp_eq_u32 s51, 0
 s_cbranch_scc0 C_SMA0
 s_mov_b32 s101, 1
 s_branch C_SBA0
C_SLA1:
 s_cmp_lg_u32 s101, 0
 s_cbranch_scc1 C_SBA1
 s_lshl_b64 s[62:63], 3, s46
 s_or_b64 s[62:63], s[62:63], s[64:65]
 s_mov_b32 s51, 4096
C_SMA1:
 buffer_load_dwordx4 v[32:35], v4, s[96:99], s50 offen sc1
 s_waitcnt vmcnt(0)
 v_cmp_eq_u64 vcc, s[90:91], v[32:33]
 v_cmp_eq_u64 s[60:61], s[90:91], v[34:35]
 s_and_b64 s[60:61], vcc, s[60:61]
 s_andn2_b64 s[60:61], s[62:63], s[60:61]
 s_cbranch_scc0 C_SBA1
 s_sleep 2
 s_sub_u32 s51, s51, 1
 s_cmp_eq_u32 s51, 0
 s_cbranch_scc0 C_SMA1
 s_mov_b32 s101, 1
 s_branch C_SBA1
C_SLL0:
 s_cmp_lg_u32 s101, 0
 s_cbranch_scc1 C_SBL0
 s_lshl_b64 s[62:63], 3, s45
 s_or_b64 s[62:63], s[62:63], s[64:65]
 s_mov_b32 s51, 4096
C_SML0:
 buffer_load_dwordx4 v[32:35], v4, s[96:99], s50 offen sc1
 s_waitcnt vmcnt(0)
 v_cmp_eq_u64 vcc, s[90:91], v[32:33]
 v_cmp_eq_u64 s[60:61], s[90:91], v[34:35]
 s_and_b64 s[60:61], vcc, s[60:61]
 s_andn2_b64 s[60:61], s[62:63], s[60:61]
 s_cbranch_scc0 C_SBL0
 s_sleep 2
 s_sub_u32 s51, s51, 1
 s_cmp_eq_u32 s51, 0
 s_cbranch_scc0 C_SML0
 s_mov_b32 s101, 1
 s_branch C_SBL0
C_SLL1:
 s_cmp_lg_u32 s101, 0
 s_cbranch_scc1 C_SBL1
 s_lshl_b64 s[62:63], 3, s46
 s_or_b64 s[62:63], s[62:63], s[64:65]
 s_mov_b32 s51, 4096
C_SML1:
 buffer_load_dwordx4 v[32:35], v4, s[96:99], s50 offen sc1
 s_waitcnt vmcnt(0)
 v_cmp_eq_u64 vcc, s[90:91], v[32:33]
 v_cmp_eq_u64 s[60:61], s[90:91], v[34:35]
 s_and_b64 s[60:61], vcc, s[60:61]
 s_andn2_b64 s[60:61], s[62:63], s[60:61]
 s_cbranch_scc0 C_SBL1
 s_sleep 2
 s_sub_u32 s51, s51, 1
 s_cmp_eq_u32 s51, 0
 s_cbranch_scc0 C_SML1
 s_mov_b32 s101, 1
 s_branch C_SBL1
C_SLN9_0:
 s_cmp_lg_u32 s101, 0
 s_cbranch_scc1 C_SBN9_0
 s_lshl_b64 s[62:63], 3, s47
 s_or_b64 s[62:63], s[62:63], s[64:65]
 s_mov_b32 s51, 4096
C_SMN9_0:
 buffer_load_dwordx4 v[32:35], v4, s[96:99], s50 offen sc1
 s_waitcnt vmcnt(0)
 v_cmp_eq_u64 vcc, s[90:91], v[32:33]
 v_cmp_eq_u64 s[60:61], s[90:91], v[34:35]
 s_and_b64 s[60:61], vcc, s[60:61]
 s_andn2_b64 s[60:61], s[62:63], s[60:61]
 s_cbranch_scc0 C_SBN9_0
 s_sleep 2
 s_sub_u32 s51, s51, 1
 s_cmp_eq_u32 s51, 0
 s_cbranch_scc0 C_SMN9_0
 s_mov_b32 s101, 1
 s_branch C_SBN9_0
C_SLN9_1:
 s_cmp_lg_u32 s101, 0
 s_cbranch_scc1 C_SBN9_1
 s_lshl_b64 s[62:63], 3, s48
 s_or_b64 s[62:63], s[62:63], s[64:65]
 s_mov_b32 s51, 4096
C_SMN9_1:
 buffer_load_dwordx4 v[32:35], v4, s[96:99], s50 offen sc1
 s_waitcnt vmcnt(0)
 v_cmp_eq_u64 vcc, s[90:91], v[32:33]
 v_cmp_eq_u64 s[60:61], s[90:91], v[34:35]
 s_and_b64 s[60:61], vcc, s[60:61]
 s_andn2_b64 s[60:61], s[62:63], s[60:61]
 s_cbranch_scc0 C_SBN9_1
 s_sleep 2
 s_sub_u32 s51, s51, 1
 s_cmp_eq_u32 s51, 0
 s_cbranch_scc0 C_SMN9_1
 s_mov_b32 s101, 1
 s_branch C_SBN9_1
C_SLN9_2:
 s_cmp_lg_u32 s101, 0
 s_cbranch_scc1 C_SBN9_2
 s_lshl_b64 s[62:63], 3, s45
 s_or_b64 s[62:63], s[62:63], s[64:65]
 s_mov_b32 s51, 4096
C_SMN9_2:
 buffer_load_dwordx4 v[32:35], v4, s[96:99], s50 offen sc1
 s_waitcnt vmcnt(0)
 v_cmp_eq_u64 vcc, s[90:91], v[32:33]
 v_cmp_eq_u64 s[60:61], s[90:91], v[34:35]
 s_and_b64 s[60:61], vcc, s[60:61]
 s_andn2_b64 s[60:61], s[62:63], s[60:61]
 s_cbranch_scc0 C_SBN9_2
 s_sleep 2
 s_sub_u32 s51, s51, 1
 s_cmp_eq_u32 s51, 0
 s_cbranch_scc0 C_SMN9_2
 s_mov_b32 s101, 1
 s_branch C_SBN9_2
C_SLN9_3:
 s_cmp_lg_u32 s101, 0
 s_cbranch_scc1 C_SBN9_3
 s_lshl_b64 s[62:63], 3, s46
 s_or_b64 s[62:63], s[62:63], s[64:65]
 s_mov_b32 s51, 4096
C_SMN9_3:
 buffer_load_dwordx4 v[32:35], v4, s[96:99], s50 offen sc1
 s_waitcnt vmcnt(0)
 v_cmp_eq_u64 vcc, s[90:91], v[32:33]
 v_cmp_eq_u64 s[60:61], s[90:91], v[34:35]
 s_and_b64 s[60:61], vcc, s[60:61]
 s_andn2_b64 s[60:61], s[62:63], s[60:61]
 s_cbranch_scc0 C_SBN9_3
 s_sleep 2
 s_sub_u32 s51, s51, 1
 s_cmp_eq_u32 s51, 0
 s_cbranch_scc0 C_SMN9_3
 s_mov_b32 s101, 1
 s_branch C_SBN9_3
C_SLN9_4:
 s_cmp_lg_u32 s101, 0
 s_cbranch_scc1 C_SBN9_4
 s_lshl_b64 s[62:63], 3, s47
 s_or_b64 s[62:63], s[62:63], s[64:65]
 s_mov_b32 s51, 4096
C_SMN9_4:
 buffer_load_dwordx4 v[32:35], v4, s[96:99], s50 offen sc1
 s_waitcnt vmcnt(0)
 v_cmp_eq_u64 vcc, s[90:91], v[32:33]
 v_cmp_eq_u64 s[60:61], s[90:91], v[34:35]
 s_and_b64 s[60:61], vcc, s[60:61]
 s_andn2_b64 s[60:61], s[62:63], s[60:61]
 s_cbranch_scc0 C_SBN9_4
 s_sleep 2
 s_sub_u32 s51, s51, 1
 s_cmp_eq_u32 s51, 0
 s_cbranch_scc0 C_SMN9_4
 s_mov_b32 s101, 1
 s_branch C_SBN9_4
C_SLN9_5:
 s_cmp_lg_u32 s101, 0
 s_cbranch_scc1 C_SBN9_5
 s_lshl_b64 s[62:63], 3, s48
 s_or_b64 s[62:63], s[62:63], s[64:65]
 s_mov_b32 s51, 4096
C_SMN9_5:
 buffer_load_dwordx4 v[32:35], v4, s[96:99], s50 offen sc1
 s_waitcnt vmcnt(0)
 v_cmp_eq_u64 vcc, s[90:91], v[32:33]
 v_cmp_eq_u64 s[60:61], s[90:91], v[34:35]
 s_and_b64 s[60:61], vcc, s[60:61]
 s_andn2_b64 s[60:61], s[62:63], s[60:61]
 s_cbranch_scc0 C_SBN9_5
 s_sleep 2
 s_sub_u32 s51, s51, 1
 s_cmp_eq_u32 s51, 0
 s_cbranch_scc0 C_SMN9_5
 s_mov_b32 s101, 1
 s_branch C_SBN9_5
C_SLN9_6:
 s_cmp_lg_u32 s101, 0
 s_cbranch_scc1 C_SBN9_6
 s_lshl_b64 s[62:63], 3, s45
 s_or_b64 s[62:63], s[62:63], s[64:65]
 s_mov_b32 s51, 4096
C_SMN9_6:
 buffer_load_dwordx4 v[32:35], v4, s[96:99], s50 offen sc1
 s_waitcnt vmcnt(0)
 v_cmp_eq_u64 vcc, s[90:91], v[32:33]
 v_cmp_eq_u64 s[60:61], s[90:91], v[34:35]
 s_and_b64 s[60:61], vcc, s[60:61]
 s_andn2_b64 s[60:61], s[62:63], s[60:61]
 s_cbranch_scc0 C_SBN9_6
 s_sleep 2
 s_sub_u32 s51, s51, 1
 s_cmp_eq_u32 s51, 0
 s_cbranch_scc0 C_SMN9_6
 s_mov_b32 s101, 1
 s_branch C_SBN9_6
C_SLN11_0:
 s_cmp_lg_u32 s101, 0
 s_cbranch_scc1 C_SBN11_0
 s_lshl_b64 s[62:63], 3, s47
 s_or_b64 s[62:63], s[62:63], s[64:65]
 s_mov_b32 s51, 4096
C_SMN11_0:
 buffer_load_dwordx4 v[32:35], v4, s[96:99], s50 offen sc1
 s_waitcnt vmcnt(0)
 v_cmp_eq_u64 vcc, s[90:91], v[32:33]
 v_cmp_eq_u64 s[60:61], s[90:91], v[34:35]
 s_and_b64 s[60:61], vcc, s[60:61]
 s_andn2_b64 s[60:61], s[62:63], s[60:61]
 s_cbranch_scc0 C_SBN11_0
 s_sleep 2
 s_sub_u32 s51, s51, 1
 s_cmp_eq_u32 s51, 0
 s_cbranch_scc0 C_SMN11_0
 s_mov_b32 s101, 1
 s_branch C_SBN11_0
C_SLN11_1:
 s_cmp_lg_u32 s101, 0
 s_cbranch_scc1 C_SBN11_1
 s_lshl_b64 s[62:63], 3, s48
 s_or_b64 s[62:63], s[62:63], s[64:65]
 s_mov_b32 s51, 4096
C_SMN11_1:
 buffer_load_dwordx4 v[32:35], v4, s[96:99], s50 offen sc1
 s_waitcnt vmcnt(0)
 v_cmp_eq_u64 vcc, s[90:91], v[32:33]
 v_cmp_eq_u64 s[60:61], s[90:91], v[34:35]
 s_and_b64 s[60:61], vcc, s[60:61]
 s_andn2_b64 s[60:61], s[62:63], s[60:61]
 s_cbranch_scc0 C_SBN11_1
 s_sleep 2
 s_sub_u32 s51, s51, 1
 s_cmp_eq_u32 s51, 0
 s_cbranch_scc0 C_SMN11_1
 s_mov_b32 s101, 1
 s_branch C_SBN11_1
C_SLN11_2:
 s_cmp_lg_u32 s101, 0
 s_cbranch_scc1 C_SBN11_2
 s_lshl_b64 s[62:63], 3, s45
 s_or_b64 s[62:63], s[62:63], s[64:65]
 s_mov_b32 s51, 4096
C_SMN11_2:
 buffer_load_dwordx4 v[32:35], v4, s[96:99], s50 offen sc1
 s_waitcnt vmcnt(0)
 v_cmp_eq_u64 vcc, s[90:91], v[32:33]
 v_cmp_eq_u64 s[60:61], s[90:91], v[34:35]
 s_and_b64 s[60:61], vcc, s[60:61]
 s_andn2_b64 s[60:61], s[62:63], s[60:61]
 s_cbranch_scc0 C_SBN11_2
 s_sleep 2
 s_sub_u32 s51, s51, 1
 s_cmp_eq_u32 s51, 0
 s_cbranch_scc0 C_SMN11_2
 s_mov_b32 s101, 1
 s_branch C_SBN11_2
C_SLN11_3:
 s_cmp_lg_u32 s101, 0
 s_cbranch_scc1 C_SBN11_3
 s_lshl_b64 s[62:63], 3, s46
 s_or_b64 s[62:63], s[62:63], s[64:65]
 s_mov_b32 s51, 4096
C_SMN11_3:
 buffer_load_dwordx4 v[32:35], v4, s[96:99], s50 offen sc1
 s_waitcnt vmcnt(0)
 v_cmp_eq_u64 vcc, s[90:91], v[32:33]
 v_cmp_eq_u64 s[60:61], s[90:91], v[34:35]
 s_and_b64 s[60:61], vcc, s[60:61]
 s_andn2_b64 s[60:61], s[62:63], s[60:61]
 s_cbranch_scc0 C_SBN11_3
 s_sleep 2
 s_sub_u32 s51, s51, 1
 s_cmp_eq_u32 s51, 0
 s_cbranch_scc0 C_SMN11_3
 s_mov_b32 s101, 1
 s_branch C_SBN11_3
C_SLN11_4:
 s_cmp_lg_u32 s101, 0
 s_cbranch_scc1 C_SBN11_4
 s_lshl_b64 s[62:63], 3, s47
 s_or_b64 s[62:63], s[62:63], s[64:65]
 s_mov_b32 s51, 4096
C_SMN11_4:
 buffer_load_dwordx4 v[32:35], v4, s[96:99], s50 offen sc1
 s_waitcnt vmcnt(0)
 v_cmp_eq_u64 vcc, s[90:91], v[32:33]
 v_cmp_eq_u64 s[60:61], s[90:91], v[34:35]
 s_and_b64 s[60:61], vcc, s[60:61]
 s_andn2_b64 s[60:61], s[62:63], s[60:61]
 s_cbranch_scc0 C_SBN11_4
 s_sleep 2
 s_sub_u32 s51, s51, 1
 s_cmp_eq_u32 s51, 0
 s_cbranch_scc0 C_SMN11_4
 s_mov_b32 s101, 1
 s_branch C_SBN11_4
C_SLN11_5:
 s_cmp_lg_u32 s101, 0
 s_cbranch_scc1 C_SBN11_5
 s_lshl_b64 s[62:63], 3, s48
 s_or_b64 s[62:63], s[62:63], s[64:65]
 s_mov_b32 s51, 4096
C_SMN11_5:
 buffer_load_dwordx4 v[32:35], v4, s[96:99], s50 offen sc1
 s_waitcnt vmcnt(0)
 v_cmp_eq_u64 vcc, s[90:91], v[32:33]
 v_cmp_eq_u64 s[60:61], s[90:91], v[34:35]
 s_and_b64 s[60:61], vcc, s[60:61]
 s_andn2_b64 s[60:61], s[62:63], s[60:61]
 s_cbranch_scc0 C_SBN11_5
 s_sleep 2
 s_sub_u32 s51, s51, 1
 s_cmp_eq_u32 s51, 0
 s_cbranch_scc0 C_SMN11_5
 s_mov_b32 s101, 1
 s_branch C_SBN11_5
C_SLN11_6:
 s_cmp_lg_u32 s101, 0
 s_cbranch_scc1 C_SBN11_6
 s_lshl_b64 s[62:63], 3, s45
 s_or_b64 s[62:63], s[62:63], s[64:65]
 s_mov_b32 s51, 4096
C_SMN11_6:
 buffer_load_dwordx4 v[32:35], v4, s[96:99], s50 offen sc1
 s_waitcnt vmcnt(0)
 v_cmp_eq_u64 vcc, s[90:91], v[32:33]
 v_cmp_eq_u64 s[60:61], s[90:91], v[34:35]
 s_and_b64 s[60:61], vcc, s[60:61]
 s_andn2_b64 s[60:61], s[62:63], s[60:61]
 s_cbranch_scc0 C_SBN11_6
 s_sleep 2
 s_sub_u32 s51, s51, 1
 s_cmp_eq_u32 s51, 0
 s_cbranch_scc0 C_SMN11_6
 s_mov_b32 s101, 1
 s_branch C_SBN11_6
C_SLN11_7:
 s_cmp_lg_u32 s101, 0
 s_cbranch_scc1 C_SBN11_7
 s_lshl_b64 s[62:63], 3, s46
 s_or_b64 s[62:63], s[62:63], s[64:65]
 s_mov_b32 s51, 4096
C_SMN11_7:
 buffer_load_dwordx4 v[32:35], v4, s[96:99], s50 offen sc1
 s_waitcnt vmcnt(0)
 v_cmp_eq_u64 vcc, s[90:91], v[32:33]
 v_cmp_eq_u64 s[60:61], s[90:91], v[34:35]
 s_and_b64 s[60:61], vcc, s[60:61]
 s_andn2_b64 s[60:61], s[62:63], s[60:61]
 s_cbranch_scc0 C_SBN11_7
 s_sleep 2
 s_sub_u32 s51, s51, 1
 s_cmp_eq_u32 s51, 0
 s_cbranch_scc0 C_SMN11_7
 s_mov_b32 s101, 1
 s_branch C_SBN11_7
C_SLN11_8:
 s_cmp_lg_u32 s101, 0
 s_cbranch_scc1 C_SBN11_8
 s_lshl_b64 s[62:63], 3, s47
 s_or_b64 s[62:63], s[62:63], s[64:65]
 s_mov_b32 s51, 4096
C_SMN11_8:
 buffer_load_dwordx4 v[32:35], v4, s[96:99], s50 offen sc1
 s_waitcnt vmcnt(0)
 v_cmp_eq_u64 vcc, s[90:91], v[32:33]
 v_cmp_eq_u64 s[60:61], s[90:91], v[34:35]
 s_and_b64 s[60:61], vcc, s[60:61]
 s_andn2_b64 s[60:61], s[62:63], s[60:61]
 s_cbranch_scc0 C_SBN11_8
 s_sleep 2
 s_sub_u32 s51, s51, 1
 s_cmp_eq_u32 s51, 0
 s_cbranch_scc0 C_SMN11_8
 s_mov_b32 s101, 1
 s_branch C_SBN11_8
C_SLN12_0:
 s_cmp_lg_u32 s101, 0
 s_cbranch_scc1 C_SBN12_0
 s_lshl_b64 s[62:63], 3, s47
 s_or_b64 s[62:63], s[62:63], s[64:65]
 s_mov_b32 s51, 4096
C_SMN12_0:
 buffer_load_dwordx4 v[32:35], v4, s[96:99], s50 offen sc1
 s_waitcnt vmcnt(0)
 v_cmp_eq_u64 vcc, s[90:91], v[32:33]
 v_cmp_eq_u64 s[60:61], s[90:91], v[34:35]
 s_and_b64 s[60:61], vcc, s[60:61]
 s_andn2_b64 s[60:61], s[62:63], s[60:61]
 s_cbranch_scc0 C_SBN12_0
 s_sleep 2
 s_sub_u32 s51, s51, 1
 s_cmp_eq_u32 s51, 0
 s_cbranch_scc0 C_SMN12_0
 s_mov_b32 s101, 1
 s_branch C_SBN12_0
C_SLN12_1:
 s_cmp_lg_u32 s101, 0
 s_cbranch_scc1 C_SBN12_1
 s_lshl_b64 s[62:63], 3, s48
 s_or_b64 s[62:63], s[62:63], s[64:65]
 s_mov_b32 s51, 4096
C_SMN12_1:
 buffer_load_dwordx4 v[32:35], v4, s[96:99], s50 offen sc1
 s_waitcnt vmcnt(0)
 v_cmp_eq_u64 vcc, s[90:91], v[32:33]
 v_cmp_eq_u64 s[60:61], s[90:91], v[34:35]
 s_and_b64 s[60:61], vcc, s[60:61]
 s_andn2_b64 s[60:61], s[62:63], s[60:61]
 s_cbranch_scc0 C_SBN12_1
 s_sleep 2
 s_sub_u32 s51, s51, 1
 s_cmp_eq_u32 s51, 0
 s_cbranch_scc0 C_SMN12_1
 s_mov_b32 s101, 1
 s_branch C_SBN12_1
C_SLN12_2:
 s_cmp_lg_u32 s101, 0
 s_cbranch_scc1 C_SBN12_2
 s_lshl_b64 s[62:63], 3, s45
 s_or_b64 s[62:63], s[62:63], s[64:65]
 s_mov_b32 s51, 4096
C_SMN12_2:
 buffer_load_dwordx4 v[32:35], v4, s[96:99], s50 offen sc1
 s_waitcnt vmcnt(0)
 v_cmp_eq_u64 vcc, s[90:91], v[32:33]
 v_cmp_eq_u64 s[60:61], s[90:91], v[34:35]
 s_and_b64 s[60:61], vcc, s[60:61]
 s_andn2_b64 s[60:61], s[62:63], s[60:61]
 s_cbranch_scc0 C_SBN12_2
 s_sleep 2
 s_sub_u32 s51, s51, 1
 s_cmp_eq_u32 s51, 0
 s_cbranch_scc0 C_SMN12_2
 s_mov_b32 s101, 1
 s_branch C_SBN12_2
C_SLN12_3:
 s_cmp_lg_u32 s101, 0
 s_cbranch_scc1 C_SBN12_3
 s_lshl_b64 s[62:63], 3, s46
 s_or_b64 s[62:63], s[62:63], s[64:65]
 s_mov_b32 s51, 4096
C_SMN12_3:
 buffer_load_dwordx4 v[32:35], v4, s[96:99], s50 offen sc1
 s_waitcnt vmcnt(0)
 v_cmp_eq_u64 vcc, s[90:91], v[32:33]
 v_cmp_eq_u64 s[60:61], s[90:91], v[34:35]
 s_and_b64 s[60:61], vcc, s[60:61]
 s_andn2_b64 s[60:61], s[62:63], s[60:61]
 s_cbranch_scc0 C_SBN12_3
 s_sleep 2
 s_sub_u32 s51, s51, 1
 s_cmp_eq_u32 s51, 0
 s_cbranch_scc0 C_SMN12_3
 s_mov_b32 s101, 1
 s_branch C_SBN12_3
C_SLN12_4:
 s_cmp_lg_u32 s101, 0
 s_cbranch_scc1 C_SBN12_4
 s_lshl_b64 s[62:63], 3, s47
 s_or_b64 s[62:63], s[62:63], s[64:65]
 s_mov_b32 s51, 4096
C_SMN12_4:
 buffer_load_dwordx4 v[32:35], v4, s[96:99], s50 offen sc1
 s_waitcnt vmcnt(0)
 v_cmp_eq_u64 vcc, s[90:91], v[32:33]
 v_cmp_eq_u64 s[60:61], s[90:91], v[34:35]
 s_and_b64 s[60:61], vcc, s[60:61]
 s_andn2_b64 s[60:61], s[62:63], s[60:61]
 s_cbranch_scc0 C_SBN12_4
 s_sleep 2
 s_sub_u32 s51, s51, 1
 s_cmp_eq_u32 s51, 0
 s_cbranch_scc0 C_SMN12_4
 s_mov_b32 s101, 1
 s_branch C_SBN12_4
C_SLN12_5:
 s_cmp_lg_u32 s101, 0
 s_cbranch_scc1 C_SBN12_5
 s_lshl_b64 s[62:63], 3, s48
 s_or_b64 s[62:63], s[62:63], s[64:65]
 s_mov_b32 s51, 4096
C_SMN12_5:
 buffer_load_dwordx4 v[32:35], v4, s[96:99], s50 offen sc1
 s_waitcnt vmcnt(0)
 v_cmp_eq_u64 vcc, s[90:91], v[32:33]
 v_cmp_eq_u64 s[60:61], s[90:91], v[34:35]
 s_and_b64 s[60:61], vcc, s[60:61]
 s_andn2_b64 s[60:61], s[62:63], s[60:61]
 s_cbranch_scc0 C_SBN12_5
 s_sleep 2
 s_sub_u32 s51, s51, 1
 s_cmp_eq_u32 s51, 0
 s_cbranch_scc0 C_SMN12_5
 s_mov_b32 s101, 1
 s_branch C_SBN12_5
C_SLN12_6:
 s_cmp_lg_u32 s101, 0
 s_cbranch_scc1 C_SBN12_6
 s_lshl_b64 s[62:63], 3, s45
 s_or_b64 s[62:63], s[62:63], s[64:65]
 s_mov_b32 s51, 4096
C_SMN12_6:
 buffer_load_dwordx4 v[32:35], v4, s[96:99], s50 offen sc1
 s_waitcnt vmcnt(0)
 v_cmp_eq_u64 vcc, s[90:91], v[32:33]
 v_cmp_eq_u64 s[60:61], s[90:91], v[34:35]
 s_and_b64 s[60:61], vcc, s[60:61]
 s_andn2_b64 s[60:61], s[62:63], s[60:61]
 s_cbranch_scc0 C_SBN12_6
 s_sleep 2
 s_sub_u32 s51, s51, 1
 s_cmp_eq_u32 s51, 0
 s_cbranch_scc0 C_SMN12_6
 s_mov_b32 s101, 1
 s_branch C_SBN12_6
C_SLN12_7:
 s_cmp_lg_u32 s101, 0
 s_cbranch_scc1 C_SBN12_7
 s_lshl_b64 s[62:63], 3, s46
 s_or_b64 s[62:63], s[62:63], s[64:65]
 s_mov_b32 s51, 4096
C_SMN12_7:
 buffer_load_dwordx4 v[32:35], v4, s[96:99], s50 offen sc1
 s_waitcnt vmcnt(0)
 v_cmp_eq_u64 vcc, s[90:91], v[32:33]
 v_cmp_eq_u64 s[60:61], s[90:91], v[34:35]
 s_and_b64 s[60:61], vcc, s[60:61]
 s_andn2_b64 s[60:61], s[62:63], s[60:61]
 s_cbranch_scc0 C_SBN12_7
 s_sleep 2
 s_sub_u32 s51, s51, 1
 s_cmp_eq_u32 s51, 0
 s_cbranch_scc0 C_SMN12_7
 s_mov_b32 s101, 1
 s_branch C_SBN12_7
C_SLN12_8:
 s_cmp_lg_u32 s101, 0
 s_cbranch_scc1 C_SBN12_8
 s_lshl_b64 s[62:63], 3, s47
 s_or_b64 s[62:63], s[62:63], s[64:65]
 s_mov_b32 s51, 4096
C_SMN12_8:
 buffer_load_dwordx4 v[32:35], v4, s[96:99], s50 offen sc1
 s_waitcnt vmcnt(0)
 v_cmp_eq_u64 vcc, s[90:91], v[32:33]
 v_cmp_eq_u64 s[60:61], s[90:91], v[34:35]
 s_and_b64 s[60:61], vcc, s[60:61]
 s_andn2_b64 s[60:61], s[62:63], s[60:61]
 s_cbranch_scc0 C_SBN12_8
 s_sleep 2
 s_sub_u32 s51, s51, 1
 s_cmp_eq_u32 s51, 0
 s_cbranch_scc0 C_SMN12_8
 s_mov_b32 s101, 1
 s_branch C_SBN12_8
C_SLN12_9:
 s_cmp_lg_u32 s101, 0
 s_cbranch_scc1 C_SBN12_9
 s_lshl_b64 s[62:63], 3, s48
 s_or_b64 s[62:63], s[62:63], s[64:65]
 s_mov_b32 s51, 4096
C_SMN12_9:
 buffer_load_dwordx4 v[32:35], v4, s[96:99], s50 offen sc1
 s_waitcnt vmcnt(0)
 v_cmp_eq_u64 vcc, s[90:91], v[32:33]
 v_cmp_eq_u64 s[60:61], s[90:91], v[34:35]
 s_and_b64 s[60:61], vcc, s[60:61]
 s_andn2_b64 s[60:61], s[62:63], s[60:61]
 s_cbranch_scc0 C_SBN12_9
 s_sleep 2
 s_sub_u32 s51, s51, 1
 s_cmp_eq_u32 s51, 0
 s_cbranch_scc0 C_SMN12_9
 s_mov_b32 s101, 1
 s_branch C_SBN12_9
C_EPI:
 v_mov_b32 v165, s44
 v_mov_b32 v21, s101
 ds_write_b32 v165, v21
 s_sub_u32 s44, s44, s38
 v_add_u32 v164, s44, v164
 s_lshl_b32 s44, s35, 13
 s_sub_u32 s44, s44, s38
 s_add_u32 s39, s39, s44
 s_add_u32 s40, s40, s44
 s_cmp_eq_u32 s34, 0
 s_cselect_b32 s44, s39, s40
 s_cselect_b32 s40, s40, s39
 v_add_u32 v7, s44, v4
 v_add_u32 v170, s40, v4
 s_lshl_b32 s39, s31, 7
 s_add_u32 s40, s40, s39
 v_add_u32 v172, s40, v172
 s_cmp_eq_u32 s34, 0
 s_cbranch_scc0 C_X1
C_X0:
 ds_write_b128 v7, v[68:71] offset:0
 ds_write_b128 v7, v[72:75] offset:1024
 ds_write_b128 v7, v[76:79] offset:2048
 ds_write_b128 v7, v[80:83] offset:3072
 ds_write_b128 v7, v[84:87] offset:4096
 ds_write_b128 v7, v[88:91] offset:5120
 ds_write_b128 v7, v[92:95] offset:6144
 ds_write_b128 v7, v[96:99] offset:7168
 s_waitcnt lgkmcnt(0)
 s_barrier
 ds_read_b32 v21, v164
 ds_read_b128 v[100:103], v170 offset:0
 ds_read_b128 v[104:107], v170 offset:1024
 ds_read_b128 v[108:111], v170 offset:2048
 ds_read_b128 v[112:115], v170 offset:3072
 ds_read_b128 v[116:119], v170 offset:4096
 ds_read_b128 v[120:123], v170 offset:5120
 ds_read_b128 v[124:127], v170 offset:6144
 ds_read_b128 v[128:131], v170 offset:7168
 s_waitcnt lgkmcnt(7)
 v_pk_add_f32 v[132:133], v[36:37], v[100:101]
 v_pk_add_f32 v[134:135], v[38:39], v[102:103]
 s_waitcnt lgkmcnt(6)
 v_pk_add_f32 v[136:137], v[40:41], v[104:105]
 v_pk_add_f32 v[138:139], v[42:43], v[106:107]
 s_waitcnt lgkmcnt(5)
 v_pk_add_f32 v[140:141], v[44:45], v[108:109]
 v_pk_add_f32 v[142:143], v[46:47], v[110:111]
 s_waitcnt lgkmcnt(4)
 v_pk_add_f32 v[144:145], v[48:49], v[112:113]
 v_pk_add_f32 v[146:147], v[50:51], v[114:115]
 s_waitcnt lgkmcnt(3)
 v_pk_add_f32 v[148:149], v[52:53], v[116:117]
 v_pk_add_f32 v[150:151], v[54:55], v[118:119]
 s_waitcnt lgkmcnt(2)
 v_pk_add_f32 v[152:153], v[56:57], v[120:121]
 v_pk_add_f32 v[154:155], v[58:59], v[122:123]
 s_waitcnt lgkmcnt(1)
 v_pk_add_f32 v[156:157], v[60:61], v[124:125]
 v_pk_add_f32 v[158:159], v[62:63], v[126:127]
 s_waitcnt lgkmcnt(0)
 v_pk_add_f32 v[160:161], v[64:65], v[128:129]
 v_pk_add_f32 v[162:163], v[66:67], v[130:131]
 s_branch C_E2
C_X1:
 ds_write_b128 v7, v[36:39] offset:0
 ds_write_b128 v7, v[40:43] offset:1024
 ds_write_b128 v7, v[44:47] offset:2048
 ds_write_b128 v7, v[48:51] offset:3072
 ds_write_b128 v7, v[52:55] offset:4096
 ds_write_b128 v7, v[56:59] offset:5120
 ds_write_b128 v7, v[60:63] offset:6144
 ds_write_b128 v7, v[64:67] offset:7168
 s_waitcnt lgkmcnt(0)
 s_barrier
 ds_read_b32 v21, v164
 ds_read_b128 v[100:103], v170 offset:0
 ds_read_b128 v[104:107], v170 offset:1024
 ds_read_b128 v[108:111], v170 offset:2048
 ds_read_b128 v[112:115], v170 offset:3072
 ds_read_b128 v[116:119], v170 offset:4096
 ds_read_b128 v[120:123], v170 offset:5120
 ds_read_b128 v[124:127], v170 offset:6144
 ds_read_b128 v[128:131], v170 offset:7168
 s_waitcnt lgkmcnt(7)
 v_pk_add_f32 v[132:133], v[68:69], v[100:101]
 v_pk_add_f32 v[134:135], v[70:71], v[102:103]
 s_waitcnt lgkmcnt(6)
 v_pk_add_f32 v[136:137], v[72:73], v[104:105]
 v_pk_add_f32 v[138:139], v[74:75], v[106:107]
 s_waitcnt lgkmcnt(5)
 v_pk_add_f32 v[140:141], v[76:77], v[108:109]
 v_pk_add_f32 v[142:143], v[78:79], v[110:111]
 s_waitcnt lgkmcnt(4)
 v_pk_add_f32 v[144:145], v[80:81], v[112:113]
 v_pk_add_f32 v[146:147], v[82:83], v[114:115]
 s_waitcnt lgkmcnt(3)
 v_pk_add_f32 v[148:149], v[84:85], v[116:117]
 v_pk_add_f32 v[150:151], v[86:87], v[118:119]
 s_waitcnt lgkmcnt(2)
 v_pk_add_f32 v[152:153], v[88:89], v[120:121]
 v_pk_add_f32 v[154:155], v[90:91], v[122:123]
 s_waitcnt lgkmcnt(1)
 v_pk_add_f32 v[156:157], v[92:93], v[124:125]
 v_pk_add_f32 v[158:159], v[94:95], v[126:127]
 s_waitcnt lgkmcnt(0)
 v_pk_add_f32 v[160:161], v[96:97], v[128:129]
 v_pk_add_f32 v[162:163], v[98:99], v[130:131]
C_E2:
 v_cmp_ne_u32 vcc, 0, v21
 s_cbranch_vccnz C_RECOVER
 s_not_b64 vcc, s[42:43]
 v_cvt_pk_bf16_f32 v200, v132, v133
 v_cvt_pk_bf16_f32 v201, v134, v135
 v_cvt_pk_bf16_f32 v204, v136, v137
 v_cvt_pk_bf16_f32 v205, v138, v139
 s_nop 0
 v_permlane32_swap_b32 v200, v204
 v_permlane32_swap_b32 v201, v205
 v_xor_b32 v202, s90, v200
 v_xor_b32 v203, s91, v201
 v_xor_b32 v206, s90, v204
 v_xor_b32 v207, s91, v205
 s_mov_b64 exec, vcc
 buffer_store_dwordx4 v[200:203], v4, s[16:19], s71 offen offset:0 sc1
 buffer_store_dwordx4 v[204:207], v4, s[16:19], s71 offen offset:1024 sc1
 s_mov_b64 exec, -1
 v_cvt_pk_bf16_f32 v208, v140, v141
 v_cvt_pk_bf16_f32 v209, v142, v143
 v_cvt_pk_bf16_f32 v212, v144, v145
 v_cvt_pk_bf16_f32 v213, v146, v147
 s_nop 0
 v_permlane32_swap_b32 v208, v212
 v_permlane32_swap_b32 v209, v213
 v_xor_b32 v210, s90, v208
 v_xor_b32 v211, s91, v209
 v_xor_b32 v214, s90, v212
 v_xor_b32 v215, s91, v213
 s_mov_b64 exec, vcc
 buffer_store_dwordx4 v[208:211], v4, s[16:19], s71 offen offset:2048 sc1
 buffer_store_dwordx4 v[212:215], v4, s[16:19], s71 offen offset:3072 sc1
 s_mov_b64 exec, -1
 v_cvt_pk_bf16_f32 v216, v148, v149
 v_cvt_pk_bf16_f32 v217, v150, v151
 v_cvt_pk_bf16_f32 v220, v152, v153
 v_cvt_pk_bf16_f32 v221, v154, v155
 s_nop 0
 v_permlane32_swap_b32 v216, v220
 v_permlane32_swap_b32 v217, v221
 v_xor_b32 v218, s90, v216
 v_xor_b32 v219, s91, v217
 v_xor_b32 v222, s90, v220
 v_xor_b32 v223, s91, v221
 s_mov_b64 exec, vcc
 buffer_store_dwordx4 v[216:219], v4, s[16:19], s72 offen offset:0 sc1
 buffer_store_dwordx4 v[220:223], v4, s[16:19], s72 offen offset:1024 sc1
 s_mov_b64 exec, -1
 v_cvt_pk_bf16_f32 v224, v156, v157
 v_cvt_pk_bf16_f32 v225, v158, v159
 v_cvt_pk_bf16_f32 v228, v160, v161
 v_cvt_pk_bf16_f32 v229, v162, v163
 s_nop 0
 v_permlane32_swap_b32 v224, v228
 v_permlane32_swap_b32 v225, v229
 v_xor_b32 v226, s90, v224
 v_xor_b32 v227, s91, v225
 v_xor_b32 v230, s90, v228
 v_xor_b32 v231, s91, v229
 s_mov_b64 exec, vcc
 buffer_store_dwordx4 v[224:227], v4, s[16:19], s72 offen offset:2048 sc1
 buffer_store_dwordx4 v[228:231], v4, s[16:19], s72 offen offset:3072 sc1
 s_mov_b64 exec, -1
 s_lshr_b32 s39, s88, 8
 s_cmp_lg_u32 s88, 0
 s_cselect_b32 s39, s39, s31
 s_cmp_eq_u32 s39, s31
 s_cbranch_scc0 C_DONE
 s_mov_b64 exec, s[42:43]
 s_lshl_b32 s49, 1, s31
 s_xor_b32 s49, s49, 15
 s_cmp_eq_u32 s31, 0
 s_cbranch_scc1 C_XF
 ds_write_b128 v170, v[132:135] offset:0
 ds_write_b128 v170, v[136:139] offset:1024
 ds_write_b128 v170, v[140:143] offset:2048
 ds_write_b128 v170, v[144:147] offset:3072
 ds_write_b128 v170, v[148:151] offset:4096
 ds_write_b128 v170, v[152:155] offset:5120
 ds_write_b128 v170, v[156:159] offset:6144
 ds_write_b128 v170, v[160:163] offset:7168
 s_mov_b64 exec, -1
 v_mov_b32 v44, 0
 v_mov_b32 v45, 0
 v_mov_b32 v48, 0
 v_mov_b32 v49, 0
 v_mov_b32 v52, 0
 v_mov_b32 v53, 0
 v_mov_b32 v56, 0
 v_mov_b32 v57, 0
 v_mov_b32 v60, 0
 v_mov_b32 v61, 0
 v_mov_b32 v64, 0
 v_mov_b32 v65, 0
 s_waitcnt lgkmcnt(0)
 ds_read_b128 v[68:71], v172
 ds_read_b128 v[72:75], v172 offset:512
 s_branch C_FIN
C_XF:
 ds_write_b64 v170, v[200:201] offset:0
 ds_write_b64 v170, v[204:205] offset:8
 ds_write_b64 v170, v[208:209] offset:1024
 ds_write_b64 v170, v[212:213] offset:1032
 ds_write_b64 v170, v[216:217] offset:2048
 ds_write_b64 v170, v[220:221] offset:2056
 ds_write_b64 v170, v[224:225] offset:3072
 ds_write_b64 v170, v[228:229] offset:3080
 s_mov_b64 exec, -1
 v_mov_b32 v68, 0
 v_mov_b32 v69, 0
 v_mov_b32 v70, 0
 v_mov_b32 v71, 0
 v_mov_b32 v72, 0
 v_mov_b32 v73, 0
 v_mov_b32 v74, 0
 v_mov_b32 v75, 0
 s_waitcnt lgkmcnt(0)
 ds_read_b64 v[36:37], v172 offset:0
 ds_read_b64 v[40:41], v172 offset:8
C_FIN:
 s_mov_b32 s51, 4096
 s_waitcnt vmcnt(0)
C_ROUND:
 s_bitcmp1_b32 s49, 0
 s_cbranch_scc0 C_SK0
 buffer_load_dwordx4 v[36:39], v173, s[16:19], s28 offen offset:0 sc1
 buffer_load_dwordx4 v[40:43], v173, s[16:19], s28 offen offset:1024 sc1
C_SK0:
 s_bitcmp1_b32 s49, 1
 s_cbranch_scc0 C_SK1
 buffer_load_dwordx4 v[44:47], v173, s[16:19], s29 offen offset:0 sc1
 buffer_load_dwordx4 v[48:51], v173, s[16:19], s29 offen offset:1024 sc1
C_SK1:
 s_bitcmp1_b32 s49, 2
 s_cbranch_scc0 C_SK2
 buffer_load_dwordx4 v[52:55], v173, s[16:19], s30 offen offset:0 sc1
 buffer_load_dwordx4 v[56:59], v173, s[16:19], s30 offen offset:1024 sc1
C_SK2:
 s_bitcmp1_b32 s49, 3
 s_cbranch_scc0 C_SK3
 buffer_load_dwordx4 v[60:63], v173, s[16:19], s41 offen offset:0 sc1
 buffer_load_dwordx4 v[64:67], v173, s[16:19], s41 offen offset:1024 sc1
C_SK3:
 s_waitcnt vmcnt(0)
 v_xor_b32 v100, v36, v38
 v_xor_b32 v101, v37, v39
 v_xor_b32 v102, v40, v42
 v_xor_b32 v103, v41, v43
 v_xor_b32 v104, v44, v46
 v_xor_b32 v105, v45, v47
 v_xor_b32 v106, v48, v50
 v_xor_b32 v107, v49, v51
 v_xor_b32 v108, v52, v54
 v_xor_b32 v109, v53, v55
 v_xor_b32 v110, v56, v58
 v_xor_b32 v111, v57, v59
 v_xor_b32 v112, v60, v62
 v_xor_b32 v113, v61, v63
 v_xor_b32 v114, v64, v66
 v_xor_b32 v115, v65, v67
 v_cmp_ne_u64 vcc, s[90:91], v[100:101]
 v_cmp_ne_u64 s[60:61], s[90:91], v[102:103]
 s_or_b64 s[60:61], vcc, s[60:61]
 s_cselect_b32 s39, -1, 0xe
 s_and_b32 s49, s49, s39
 v_cmp_ne_u64 vcc, s[90:91], v[104:105]
 v_cmp_ne_u64 s[60:61], s[90:91], v[106:107]
 s_or_b64 s[60:61], vcc, s[60:61]
 s_cselect_b32 s39, -1, 0xd
 s_and_b32 s49, s49, s39
 v_cmp_ne_u64 vcc, s[90:91], v[108:109]
 v_cmp_ne_u64 s[60:61], s[90:91], v[110:111]
 s_or_b64 s[60:61], vcc, s[60:61]
 s_cselect_b32 s39, -1, 0xb
 s_and_b32 s49, s49, s39
 v_cmp_ne_u64 vcc, s[90:91], v[112:113]
 v_cmp_ne_u64 s[60:61], s[90:91], v[114:115]
 s_or_b64 s[60:61], vcc, s[60:61]
 s_cselect_b32 s39, -1, 0x7
 s_and_b32 s49, s49, s39
 s_cbranch_scc0 C_COMP
 s_sub_u32 s51, s51, 1
 s_cmp_eq_u32 s51, 0
 s_cbranch_scc0 C_ROUND
 s_mov_b32 s101, 1
C_COMP:
 v_mov_b32 v21, s101
 ds_write_b32 v165, v21 offset:64
 s_waitcnt lgkmcnt(0)
 v_lshlrev_b32 v200, 16, v36
 v_and_b32 v201, 0xffff0000, v36
 v_lshlrev_b32 v202, 16, v37
 v_and_b32 v203, 0xffff0000, v37
 v_lshlrev_b32 v204, 16, v40
 v_and_b32 v205, 0xffff0000, v40
 v_lshlrev_b32 v206, 16, v41
 v_and_b32 v207, 0xffff0000, v41
 v_mul_f32 v208, 0xbfb8aa3b, v200
 v_mul_f32 v209, 0xbfb8aa3b, v201
 v_mul_f32 v210, 0xbfb8aa3b, v202
 v_mul_f32 v211, 0xbfb8aa3b, v203
 v_mul_f32 v212, 0xbfb8aa3b, v204
 v_mul_f32 v213, 0xbfb8aa3b, v205
 v_mul_f32 v214, 0xbfb8aa3b, v206
 v_mul_f32 v215, 0xbfb8aa3b, v207
 v_exp_f32 v208, v208
 v_exp_f32 v209, v209
 v_exp_f32 v210, v210
 v_exp_f32 v211, v211
 v_exp_f32 v212, v212
 v_exp_f32 v213, v213
 v_exp_f32 v214, v214
 v_exp_f32 v215, v215
 v_lshlrev_b32 v216, 16, v44
 v_and_b32 v217, 0xffff0000, v44
 v_lshlrev_b32 v218, 16, v45
 v_and_b32 v219, 0xffff0000, v45
 v_lshlrev_b32 v220, 16, v48
 v_and_b32 v221, 0xffff0000, v48
 v_lshlrev_b32 v222, 16, v49
 v_and_b32 v223, 0xffff0000, v49
 v_pk_add_f32 v[68:69], v[68:69], v[216:217]
 v_pk_add_f32 v[70:71], v[70:71], v[218:219]
 v_pk_add_f32 v[72:73], v[72:73], v[220:221]
 v_pk_add_f32 v[74:75], v[74:75], v[222:223]
 v_lshlrev_b32 v216, 16, v52
 v_and_b32 v217, 0xffff0000, v52
 v_lshlrev_b32 v218, 16, v53
 v_and_b32 v219, 0xffff0000, v53
 v_lshlrev_b32 v220, 16, v56
 v_and_b32 v221, 0xffff0000, v56
 v_lshlrev_b32 v222, 16, v57
 v_and_b32 v223, 0xffff0000, v57
 v_pk_add_f32 v[68:69], v[68:69], v[216:217]
 v_pk_add_f32 v[70:71], v[70:71], v[218:219]
 v_pk_add_f32 v[72:73], v[72:73], v[220:221]
 v_pk_add_f32 v[74:75], v[74:75], v[222:223]
 v_lshlrev_b32 v216, 16, v60
 v_and_b32 v217, 0xffff0000, v60
 v_lshlrev_b32 v218, 16, v61
 v_and_b32 v219, 0xffff0000, v61
 v_lshlrev_b32 v220, 16, v64
 v_and_b32 v221, 0xffff0000, v64
 v_lshlrev_b32 v222, 16, v65
 v_and_b32 v223, 0xffff0000, v65
 v_pk_add_f32 v[68:69], v[68:69], v[216:217]
 v_pk_add_f32 v[70:71], v[70:71], v[218:219]
 v_pk_add_f32 v[72:73], v[72:73], v[220:221]
 v_pk_add_f32 v[74:75], v[74:75], v[222:223]
 v_add_f32 v208, 1.0, v208
 v_add_f32 v209, 1.0, v209
 v_add_f32 v210, 1.0, v210
 v_add_f32 v211, 1.0, v211
 v_add_f32 v212, 1.0, v212
 v_add_f32 v213, 1.0, v213
 v_add_f32 v214, 1.0, v214
 v_add_f32 v215, 1.0, v215
 v_rcp_f32 v208, v208
 v_rcp_f32 v209, v209
 v_rcp_f32 v210, v210
 v_rcp_f32 v211, v211
 v_rcp_f32 v212, v212
 v_rcp_f32 v213, v213
 v_rcp_f32 v214, v214
 v_rcp_f32 v215, v215
 v_cvt_pk_bf16_f32 v224, v68, v69
 v_cvt_pk_bf16_f32 v225, v70, v71
 v_cvt_pk_bf16_f32 v226, v72, v73
 v_cvt_pk_bf16_f32 v227, v74, v75
 v_lshlrev_b32 v68, 16, v224
 v_and_b32 v69, 0xffff0000, v224
 v_lshlrev_b32 v70, 16, v225
 v_and_b32 v71, 0xffff0000, v225
 v_lshlrev_b32 v72, 16, v226
 v_and_b32 v73, 0xffff0000, v226
 v_lshlrev_b32 v74, 16, v227
 v_and_b32 v75, 0xffff0000, v227
 v_pk_mul_f32 v[216:217], v[208:209], v[200:201]
 v_pk_mul_f32 v[218:219], v[210:211], v[202:203]
 v_pk_mul_f32 v[220:221], v[212:213], v[204:205]
 v_pk_mul_f32 v[222:223], v[214:215], v[206:207]
 v_cvt_pk_bf16_f32 v224, v216, v217
 v_cvt_pk_bf16_f32 v225, v218, v219
 v_cvt_pk_bf16_f32 v226, v220, v221
 v_cvt_pk_bf16_f32 v227, v222, v223
 v_lshlrev_b32 v216, 16, v224
 v_and_b32 v217, 0xffff0000, v224
 v_lshlrev_b32 v218, 16, v225
 v_and_b32 v219, 0xffff0000, v225
 v_lshlrev_b32 v220, 16, v226
 v_and_b32 v221, 0xffff0000, v226
 v_lshlrev_b32 v222, 16, v227
 v_and_b32 v223, 0xffff0000, v227
 v_pk_mul_f32 v[216:217], v[216:217], v[68:69]
 v_pk_mul_f32 v[218:219], v[218:219], v[70:71]
 v_pk_mul_f32 v[220:221], v[220:221], v[72:73]
 v_pk_mul_f32 v[222:223], v[222:223], v[74:75]
 v_cvt_pk_bf16_f32 v224, v216, v217
 v_cvt_pk_bf16_f32 v225, v218, v219
 v_cvt_pk_bf16_f32 v226, v220, v221
 v_cvt_pk_bf16_f32 v227, v222, v223
 v_lshlrev_b32 v216, 16, v224
 v_and_b32 v217, 0xffff0000, v224
 v_lshlrev_b32 v218, 16, v225
 v_and_b32 v219, 0xffff0000, v225
 v_lshlrev_b32 v220, 16, v226
 v_and_b32 v221, 0xffff0000, v226
 v_lshlrev_b32 v222, 16, v227
 v_and_b32 v223, 0xffff0000, v227
 v_lshlrev_b32 v208, 16, v176
 v_and_b32 v209, 0xffff0000, v176
 v_lshlrev_b32 v210, 16, v177
 v_and_b32 v211, 0xffff0000, v177
 v_lshlrev_b32 v212, 16, v178
 v_and_b32 v213, 0xffff0000, v178
 v_lshlrev_b32 v214, 16, v179
 v_and_b32 v215, 0xffff0000, v179
 v_pk_add_f32 v[216:217], v[216:217], v[208:209]
 v_pk_add_f32 v[218:219], v[218:219], v[210:211]
 v_pk_add_f32 v[220:221], v[220:221], v[212:213]
 v_pk_add_f32 v[222:223], v[222:223], v[214:215]
 v_cvt_pk_bf16_f32 v224, v216, v217
 v_cvt_pk_bf16_f32 v225, v218, v219
 v_cvt_pk_bf16_f32 v226, v220, v221
 v_cvt_pk_bf16_f32 v227, v222, v223
 buffer_store_dwordx4 v[224:227], v168, s[24:27], s73 offen
 s_barrier
 ds_read_b32 v21, v164 offset:64
 s_waitcnt lgkmcnt(0)
 v_cmp_ne_u32 vcc, 0, v21
 s_cbranch_vccnz C_RECOVER
C_DONE:
 s_cmp_lg_u32 s88, 0
 s_cbranch_scc1 C_JOBN
 s_branch KA_END
C_RECOVER:
 s_cmp_lg_u32 s88, 0
 s_cbranch_scc1 KA_END
 s_lshl_b32 s88, s31, 8
KB_JOBN:
 s_add_u32 s88, s88, 1
 s_and_b32 s41, s88, 63
 s_cmp_le_u32 s41, 32
 s_cbranch_scc0 C_JC
 s_sub_u32 s41, s41, 1
 s_and_b32 s42, s41, 3
 s_lshl_b32 s42, s42, 6
 s_lshr_b32 s41, s41, 2
 s_add_u32 s41, s41, s42
 s_bfe_u32 s42, s93, 0x30005
 s_xor_b32 s3, s42, 7
 s_bitcmp1_b32 s93, 0
 s_cselect_b32 s42, s3, s42
 s_lshl_b32 s42, s42, 3
 s_add_u32 s41, s41, s42
 s_lshl_b32 s41, s41, 8
 s_and_b32 s93, s93, 255
 s_or_b32 s93, s93, s41
 s_branch KB_RECOVER
C_JC:
 s_branch C_RERUN
C_JOBN:
 s_lshr_b32 s41, s88, 8
 s_cmp_eq_u32 s41, s31
 s_cbranch_scc1 KA_END
 s_add_u32 s88, s88, 1
C_RERUN:
 s_waitcnt vmcnt(0) lgkmcnt(0)
 s_barrier
 v_and_b32 v232, 7, v0
 v_mul_u32_u24 v232, 260, v232
 v_add_u32 v232, 155648, v232
 v_mov_b32 v237, 0x7fffffff
 ds_write_b32 v232, v237
 v_mov_b32 v237, 162816
 v_mov_b32 v239, 0
 ds_write_b32 v237, v239
 ds_write_b32 v237, v239 offset:4
 s_load_dwordx2 s[74:75], s[0:1], 40
 s_load_dwordx2 s[76:77], s[0:1], 64
 s_load_dwordx2 s[78:79], s[0:1], 0
 s_load_dwordx4 s[80:83], s[0:1], 72
 s_mov_b32 s41, 0
 s_and_b32 s39, s93, 1
 s_lshl_b32 s39, s39, 3
 s_bfe_u32 s32, s93, 0x30005
 s_add_u32 s32, s32, s39
 s_bfe_u32 s33, s93, 0x20003
 s_lshr_b32 s34, s55, 2
 s_and_b32 s35, s55, 3
 s_lshl_b32 s38, s55, 12
 s_and_b32 s39, s41, 2
 s_lshl_b32 s39, s39, 15
 s_add_u32 s66, s38, s39
 s_xor_b32 s67, s66, 0x10000
 s_add_u32 s68, s38, 0x20000
 v_lshlrev_b32 v4, 4, v0
 v_mov_b32 v5, 162816
 s_waitcnt lgkmcnt(0)
 s_barrier
 s_cmp_lt_u32 s55, 4
 s_cbranch_scc1 C_AENT
 s_branch C_LENT
KB_RECOVER:
 s_mov_b32 s92, 1
 s_mov_b32 s100, 0
KAB_NEXT:
 s_waitcnt vmcnt(0) lgkmcnt(0)
 s_barrier
 s_bfe_u32 s41, s93, 0x3000b
 s_sub_u32 s42, 15, s41
 s_cmp_lt_u32 s100, 16
 s_cselect_b32 s41, s42, s41
 s_lshl_b32 s41, s41, 4
 s_and_b32 s42, s100, 15
 s_add_u32 s2, s41, s42
 s_bfe_u32 s41, s100, 0x10003
 s_lshl_b32 s41, s41, 7
 s_and_b32 s42, s100, 7
 s_lshl_b32 s42, s42, 3
 s_add_u32 s41, s41, s42
 s_lshr_b32 s42, s93, 15
 s_lshl_b32 s42, s42, 6
 s_add_u32 s41, s41, s42
 s_and_b32 s42, s93, 7
 s_add_u32 s41, s41, s42
 s_cmp_lt_u32 s100, 32
 s_cselect_b32 s2, s2, s41
 s_and_b32 s41, s93, 255
 s_cmp_eq_u32 s100, 48
 s_cselect_b32 s2, s41, s2
 s_cselect_b32 s92, 2, 1
 s_add_u32 s100, s100, 1
 v_lshl_add_u32 v0, s55, 6, v0
 s_branch KA_TRAMP
KA_END:
 s_endpgm
TEXT_END:
.section .rodata,"a"
.p2align 6
.amdhsa_kernel kab_kernel
  .amdhsa_next_free_vgpr 256
  .amdhsa_next_free_sgpr 102
  .amdhsa_accum_offset 256
  .amdhsa_group_segment_fixed_size 0
  .amdhsa_kernarg_size 96
  .amdhsa_user_sgpr_count 2
  .amdhsa_user_sgpr_kernarg_segment_ptr 1
  .amdhsa_system_sgpr_workgroup_id_x 1
.end_amdhsa_kernel
```
